```python
import torch

def _softmax(x, axis=-1):
    return torch.softmax(x, dim=axis)
def _gelu(x):
    return torch.nn.functional.gelu(x, approximate="tanh")
def _silu(x):
    return torch.nn.functional.silu(x)
def _sigmoid(x):
    return torch.sigmoid(x)
def _layernorm(x, axis=-1, eps=1e-5):
    m = x.mean(dim=axis, keepdim=True)
    v = x.var(dim=axis, keepdim=True, unbiased=False)
    return (x - m) / torch.sqrt(v + eps)
def _scatter_add(tgt, idx, src, axis=0):
    return tgt.clone().index_add_(axis, idx, src)
def _segment_sum(src, seg, n):
    out = torch.zeros((n,) + src.shape[1:], dtype=src.dtype)
    return out.index_add_(0, seg, src)
def _pad(x, pw):
    flat = tuple(v for pair in reversed(pw) for v in pair)
    return torch.nn.functional.pad(x, flat)

kernel_name = 'recurrent_scan__sliding_block_cached__geglu_ffn__prompt'

def setup_inputs():

    _w = (lambda a: (lambda t: t.to(torch.bfloat16) if t.is_floating_point() else t)(torch.as_tensor(a)))
    def _A_setup():
        B, Sq, D = 1, 2048, 1024
        Hq, Hkv, Sk, Dh = 32, 4, 2048, 128
        assert Hq % Hkv == 0, (Hq, Hkv)
        return {
            "x": _w((lambda *s: torch.randn(*s, dtype=torch.bfloat16) * 0.05)(B, Sq, D)),
            "k_cache": _w((lambda *s: torch.randn(*s, dtype=torch.bfloat16) * 0.8)(B, Hkv, Sk, Dh)),
            "v_cache": _w((lambda *s: torch.randn(*s, dtype=torch.bfloat16) * 0.2)(B, Hkv, Sk, Dh)),
            "wq": _w((lambda *s: torch.randn(*s, dtype=torch.bfloat16) * 0.8)(D, Hq * Dh) * (D ** -0.5)),
            "wo": _w((lambda *s: torch.randn(*s, dtype=torch.bfloat16) * 0.2)(Hq * Dh, D) * ((Hq * Dh) ** -0.5)),
        }
    _A_in = _A_setup()

    def _B_setup():
        B, S, D, F = 1, 2048, 1024, 3584
        return {
            "x": _w((lambda *s: torch.randn(*s, dtype=torch.bfloat16) * 0.05)(B, S, D)),
            "w_gate": _w((lambda *s: torch.randn(*s, dtype=torch.bfloat16) * 0.1)(D, F)),
            "w_up": _w((lambda *s: torch.randn(*s, dtype=torch.bfloat16) * 0.1)(D, F)),
            "w_down": _w((lambda *s: torch.randn(*s, dtype=torch.bfloat16) * 0.1)(F, D)),
        }
    _B_in = _B_setup()

    return {
        "A_x": _A_in["x"],
        "A_k_cache": _A_in["k_cache"],
        "A_v_cache": _A_in["v_cache"],
        "A_wq": _A_in["wq"],
        "A_wo": _A_in["wo"],
        "B_x": _B_in["x"],
        "B_w_gate": _B_in["w_gate"],
        "B_w_up": _B_in["w_up"],
        "B_w_down": _B_in["w_down"],
    }

def reference(A_x, A_k_cache, A_v_cache, A_wq, A_wo, B_x, B_w_gate, B_w_up, B_w_down):
    def _A_ref(x, k_cache, v_cache, wq, wo):
        B, Sq, D = x.shape
        Hq, Dh = 32, 128
        Hkv, Sk = k_cache.shape[1], k_cache.shape[2]
        W = min(4096, max(256, Sk // 4))
        rep = Hq // Hkv
        q = (lambda x, *d: x.permute(*d))((x @ wq).reshape(B, Sq, Hq, Dh), 0, 2, 1, 3)
        k = (lambda x, n, axis: torch.repeat_interleave(x, n, dim=axis))(k_cache[:, :, Sk - W:, :], rep, axis=1)
        v = (lambda x, n, axis: torch.repeat_interleave(x, n, dim=axis))(v_cache[:, :, Sk - W:, :], rep, axis=1)
        scores = torch.einsum("bhqd,bhkd->bhqk", q, k) * (Dh ** -0.5)
        p = _softmax(scores, axis=-1)
        o = torch.einsum("bhqk,bhkd->bhqd", p, v)
        return (lambda x, *d: x.permute(*d))(o, 0, 2, 1, 3).reshape(B, Sq, Hq * Dh) @ wo

    def _B_ref(x, w_gate, w_up, w_down):
        return (_gelu(x @ w_gate) * (x @ w_up)) @ w_down

    x = A_x
    xn = _layernorm(x, axis=-1)
    s = _A_ref(xn, A_k_cache, A_v_cache, A_wq, A_wo)
    g = _silu(_B_ref(xn, B_w_gate, B_w_up, B_w_down))
    return x + s * g
```

```asm
; @launch grid=(256,1,1) block=(256,1,1) lds=163840
.amdgcn_target "amdgcn-amd-amdhsa--gfx950"
.text
.globl recurrent_scan__sliding_block_cached__geglu_ffn__prompt_kernel
.p2align 8
.type recurrent_scan__sliding_block_cached__geglu_ffn__prompt_kernel,@function
recurrent_scan__sliding_block_cached__geglu_ffn__prompt_kernel:
K_first:
 s_cmp_ge_u32 s2, 256
 s_cbranch_scc0 K_go
 s_endpgm
K_go:
 s_load_dwordx16 s[64:79], s[0:1], 0
 s_load_dwordx8 s[80:87], s[0:1], 64
 v_lshrrev_b32 v2, 6, v0
 v_and_b32 v1, 63, v0
 v_readfirstlane_b32 s36, v2
 s_and_b32 s50, s2, 7
 s_lshr_b32 s51, s2, 3
 s_and_b32 s37, s51, 7
 s_lshl_b32 s38, s50, 2
 s_lshr_b32 s52, s51, 3
 s_add_u32 s38, s38, s52
 s_lshl_b32 s50, s37, 8
 s_lshl_b32 s51, s38, 3
 s_add_u32 s50, s50, s51
 s_lshl_b32 s50, s50, 11
 s_lshl_b32 s51, s36, 9
 s_add_u32 s50, s50, s51
 v_and_b32 v132, 7, v1
 v_bfe_u32 v133, v1, 3, 1
 v_lshrrev_b32 v134, 4, v1
 v_lshlrev_b32 v135, 11, v132
 v_lshlrev_b32 v136, 8, v133
 v_lshlrev_b32 v137, 4, v134
 v_add3_u32 v135, v135, v136, v137
 v_add_u32 v128, s50, v135
 s_waitcnt lgkmcnt(0)
 s_mov_b32 s20, s64
 s_mov_b32 s21, s65
 s_mov_b32 s22, 0x400000
 s_mov_b32 s23, 0x20000
 buffer_load_dwordx4 v[144:147], v128, s[20:23], 0 offen
 buffer_load_dwordx4 v[148:151], v128, s[20:23], 0 offen offset:64
 buffer_load_dwordx4 v[152:155], v128, s[20:23], 0 offen offset:128
 buffer_load_dwordx4 v[156:159], v128, s[20:23], 0 offen offset:192
 s_getpc_b64 s[32:33]
L_pc1:
 s_sub_u32 s32, s32, L_pc1-K_first
 s_subb_u32 s33, s33, 0
 s_mov_b32 s34, K_last-K_first
 s_mov_b32 s35, 0x20000
 s_lshr_b32 s50, s2, 3
 s_lshl_b32 s50, s50, 2
 s_add_u32 s50, s50, s36
 s_lshl_b32 s50, s50, 10
 v_and_b32 v32, 15, v1
 v_lshl_add_u32 v0, v32, 6, s50
 buffer_load_dword v138, v0, s[32:35], 0 offen
 s_mov_b32 s60, s84
 s_mov_b32 s61, s85
 s_mov_b32 s62, 0x100
 s_mov_b32 s63, 0x20000
 s_lshl_b32 s50, s2, 2
 s_add_u32 s50, s50, s36
 s_cmp_eq_u32 s50, 1
 s_cbranch_scc0 L_no_nonce
 s_memrealtime s[6:7]
 v_mov_b32 v34, 0
 s_waitcnt lgkmcnt(0)
 s_and_b32 s6, s6, 0xffffffc0
 s_or_b32 s6, s6, 1
 s_getreg_b32 s50, hwreg(HW_REG_XCC_ID, 0, 1)
 s_lshl_b32 s50, s50, 5
 s_or_b32 s6, s6, s50
 v_mov_b32 v32, s6
 v_mov_b32 v33, s7
 buffer_store_dwordx2 v[32:33], v34, s[60:63], 0 offen sc1
L_no_nonce:
 s_lshl_b32 s50, s37, 4
 s_lshr_b32 s51, s38, 1
 s_add_u32 s50, s50, s51
 s_mul_i32 s50, s50, 33024
 s_lshl_b32 s51, s36, 13
 s_add_u32 s50, s50, s51
 s_and_b32 s51, s38, 1
 s_lshl_b32 s51, s51, 7
 s_add_u32 s50, s50, s51
 v_lshlrev_b32 v135, 4, v132
 v_lshlrev_b32 v136, 12, v133
 v_lshlrev_b32 v137, 8, v134
 v_add3_u32 v136, v135, v136, v137
 v_add_u32 v129, s50, v136
 v_add_u32 v130, 157696, v135
 v_lshl_add_u32 v131, v2, 2, v130
 s_and_b32 s50, s36, 1
 s_mul_i32 s50, s50, 229376
 s_mul_i32 s51, s38, 224
 s_add_u32 s50, s50, s51
 s_mov_b32 s51, 4682
 s_mov_b32 s52, 7168
 v_add_u32 v32, 0, v1
 v_mul_u32_u24 v33, s51, v32
 v_lshrrev_b32 v33, 16, v33
 v_mul_u32_u24 v34, 14, v33
 v_sub_u32 v34, v32, v34
 v_and_b32 v35, 0x13, v33
 v_and_b32 v36, 4, v33
 v_lshl_or_b32 v35, v36, 1, v35
 v_bfe_u32 v36, v33, 3, 1
 v_lshl_or_b32 v35, v36, 2, v35
 v_mul_u32_u24 v35, s52, v35
 v_lshlrev_b32 v34, 4, v34
 v_add3_u32 v8, v35, v34, s50
 v_add_u32 v32, 64, v1
 v_mul_u32_u24 v33, s51, v32
 v_lshrrev_b32 v33, 16, v33
 v_mul_u32_u24 v34, 14, v33
 v_sub_u32 v34, v32, v34
 v_and_b32 v35, 0x13, v33
 v_and_b32 v36, 4, v33
 v_lshl_or_b32 v35, v36, 1, v35
 v_bfe_u32 v36, v33, 3, 1
 v_lshl_or_b32 v35, v36, 2, v35
 v_mul_u32_u24 v35, s52, v35
 v_lshlrev_b32 v34, 4, v34
 v_add3_u32 v9, v35, v34, s50
 v_subrev_u32 v9, 1024, v9
 v_add_u32 v32, 128, v1
 v_mul_u32_u24 v33, s51, v32
 v_lshrrev_b32 v33, 16, v33
 v_mul_u32_u24 v34, 14, v33
 v_sub_u32 v34, v32, v34
 v_and_b32 v35, 0x13, v33
 v_and_b32 v36, 4, v33
 v_lshl_or_b32 v35, v36, 1, v35
 v_bfe_u32 v36, v33, 3, 1
 v_lshl_or_b32 v35, v36, 2, v35
 v_mul_u32_u24 v35, s52, v35
 v_lshlrev_b32 v34, 4, v34
 v_add3_u32 v10, v35, v34, s50
 v_subrev_u32 v10, 2048, v10
 v_add_u32 v32, 192, v1
 v_mul_u32_u24 v33, s51, v32
 v_lshrrev_b32 v33, 16, v33
 v_mul_u32_u24 v34, 14, v33
 v_sub_u32 v34, v32, v34
 v_and_b32 v35, 0x13, v33
 v_and_b32 v36, 4, v33
 v_lshl_or_b32 v35, v36, 1, v35
 v_bfe_u32 v36, v33, 3, 1
 v_lshl_or_b32 v35, v36, 2, v35
 v_mul_u32_u24 v35, s52, v35
 v_lshlrev_b32 v34, 4, v34
 v_add3_u32 v11, v35, v34, s50
 v_subrev_u32 v11, 3072, v11
 v_add_u32 v32, 256, v1
 v_mul_u32_u24 v33, s51, v32
 v_lshrrev_b32 v33, 16, v33
 v_mul_u32_u24 v34, 14, v33
 v_sub_u32 v34, v32, v34
 v_and_b32 v35, 0x13, v33
 v_and_b32 v36, 4, v33
 v_lshl_or_b32 v35, v36, 1, v35
 v_bfe_u32 v36, v33, 3, 1
 v_lshl_or_b32 v35, v36, 2, v35
 v_mul_u32_u24 v35, s52, v35
 v_lshlrev_b32 v34, 4, v34
 v_add3_u32 v12, v35, v34, s50
 v_add_u32 v32, 320, v1
 v_mul_u32_u24 v33, s51, v32
 v_lshrrev_b32 v33, 16, v33
 v_mul_u32_u24 v34, 14, v33
 v_sub_u32 v34, v32, v34
 v_and_b32 v35, 0x13, v33
 v_and_b32 v36, 4, v33
 v_lshl_or_b32 v35, v36, 1, v35
 v_bfe_u32 v36, v33, 3, 1
 v_lshl_or_b32 v35, v36, 2, v35
 v_mul_u32_u24 v35, s52, v35
 v_lshlrev_b32 v34, 4, v34
 v_add3_u32 v13, v35, v34, s50
 v_subrev_u32 v13, 1024, v13
 v_add_u32 v32, 384, v1
 v_mul_u32_u24 v33, s51, v32
 v_lshrrev_b32 v33, 16, v33
 v_mul_u32_u24 v34, 14, v33
 v_sub_u32 v34, v32, v34
 v_and_b32 v35, 0x13, v33
 v_and_b32 v36, 4, v33
 v_lshl_or_b32 v35, v36, 1, v35
 v_bfe_u32 v36, v33, 3, 1
 v_lshl_or_b32 v35, v36, 2, v35
 v_mul_u32_u24 v35, s52, v35
 v_lshlrev_b32 v34, 4, v34
 v_add3_u32 v14, v35, v34, s50
 v_subrev_u32 v14, 2048, v14
 s_lshl_b32 s50, s36, 17
 s_lshl_b32 s51, s38, 8
 s_add_u32 s50, s50, s51
 v_lshrrev_b32 v32, 4, v1
 v_and_b32 v33, 15, v1
 v_lshlrev_b32 v34, 1, v32
 v_xor_b32 v33, v33, v34
 v_lshlrev_b32 v32, 13, v32
 v_add_u32 v32, s50, v32
 v_xor_b32 v34, 0, v33
 v_lshl_add_u32 v34, v34, 4, v32
 v_add_u32 v15, 0, v34
 v_xor_b32 v34, 0, v33
 v_lshl_add_u32 v34, v34, 4, v32
 v_add_u32 v16, 31744, v34
 v_xor_b32 v34, 8, v33
 v_lshl_add_u32 v34, v34, 4, v32
 v_add_u32 v17, 63488, v34
 v_xor_b32 v34, 8, v33
 v_lshl_add_u32 v34, v34, 4, v32
 v_add_u32 v18, 95232, v34
 s_and_b32 s50, s36, 1
 s_lshr_b32 s51, s36, 1
 s_mul_i32 s43, s50, 22528
 s_mul_i32 s49, s51, 7168
 s_mul_i32 s44, s51, 22528
 s_lshl_b32 s3, s50, 12
 s_add_u32 s3, s3, 14336
 s_mov_b32 s39, 0
 s_mov_b32 s40, 0
 s_mov_b32 s41, 4096
 s_mov_b32 s45, 0
 s_lshl_b32 s50, s37, 8
 s_lshl_b32 s51, s36, 6
 s_add_u32 s55, s50, s51
 s_lshl_b32 s50, s55, 11
 v_and_b32 v32, 15, v1
 v_lshrrev_b32 v34, 4, v1
 v_add_u32 v33, 0, v34
 v_xor_b32 v35, v33, v32
 v_lshlrev_b32 v33, 11, v33
 v_lshl_add_u32 v33, v35, 4, v33
 s_sub_u32 s51, s50, 0
 v_add_u32 v140, s51, v33
 v_add_u32 v33, 4, v34
 v_xor_b32 v35, v33, v32
 v_lshlrev_b32 v33, 11, v33
 v_lshl_add_u32 v33, v35, 4, v33
 s_sub_u32 s51, s50, 1024
 v_add_u32 v141, s51, v33
 v_add_u32 v33, 8, v34
 v_xor_b32 v35, v33, v32
 v_lshlrev_b32 v33, 11, v33
 v_lshl_add_u32 v33, v35, 4, v33
 s_sub_u32 s51, s50, 2048
 v_add_u32 v142, s51, v33
 v_add_u32 v33, 12, v34
 v_xor_b32 v35, v33, v32
 v_lshlrev_b32 v33, 11, v33
 v_lshl_add_u32 v33, v35, 4, v33
 s_sub_u32 s51, s50, 3072
 v_add_u32 v143, s51, v33
 s_lshl_b32 s50, s55, 4
 v_lshl_add_u32 v139, v32, 4, s50
 s_cmp_ge_u32 s36, 2
 s_cselect_b32 s8, s78, s76
 s_cselect_b32 s9, s79, s77
 s_mov_b32 s10, 0x700000
 s_mov_b32 s11, 0x20000
 s_mov_b32 s12, s70
 s_mov_b32 s13, s71
 s_mov_b32 s14, 0x800000
 s_mov_b32 s15, 0x20000
 s_add_u32 s56, s86, 0x2800000
 s_addc_u32 s57, s87, 0
 s_mov_b32 s58, 0x88000
 s_mov_b32 s59, 0x20000
 s_mov_b32 s16, s86
 s_mov_b32 s17, s87
 s_mov_b32 s18, 0x500000
 s_mov_b32 s19, 0x20000
 s_lshl_b32 s50, s37, 4
 s_lshl_b32 s51, s36, 2
 s_add_u32 s50, s50, s51
 s_mul_i32 s50, s50, 33024
 v_lshlrev_b32 v28, 4, v1
 v_add_u32 v4, s50, v28
 v_add_u32 v5, 0x8100, v4
 v_add_u32 v6, 0x10200, v4
 v_add_u32 v7, 0x18300, v4
 v_lshrrev_b32 v32, 5, v1
 v_lshlrev_b32 v32, 4, v32
 v_bfe_u32 v33, v1, 4, 1
 v_lshlrev_b32 v33, 2, v33
 v_bfe_u32 v34, v1, 2, 2
 v_add3_u32 v32, v32, v33, v34
 v_mul_u32_u24 v32, 224, v32
 v_and_b32 v35, 3, v1
 v_lshlrev_b32 v35, 3, v35
 v_add_u32 v19, v32, v35
 v_or_b32 v33, v33, v34
 v_lshrrev_b32 v32, 4, v1
 v_lshlrev_b32 v32, 3, v32
 v_add_u32 v32, v32, v34
 v_lshlrev_b32 v32, 8, v32
 v_add_u32 v32, 14336, v32
 v_add_u32 v32, v32, v35
 v_xor_b32 v34, 0, v33
 v_lshl_add_u32 v20, v34, 5, v32
 v_xor_b32 v34, 1, v33
 v_lshl_add_u32 v21, v34, 5, v32
 v_xor_b32 v34, 2, v33
 v_lshl_add_u32 v22, v34, 5, v32
 v_xor_b32 v34, 3, v33
 v_lshl_add_u32 v23, v34, 5, v32
 v_xor_b32 v34, 4, v33
 v_lshl_add_u32 v24, v34, 5, v32
 v_xor_b32 v34, 5, v33
 v_lshl_add_u32 v25, v34, 5, v32
 v_xor_b32 v34, 6, v33
 v_lshl_add_u32 v26, v34, 5, v32
 v_xor_b32 v34, 7, v33
 v_lshl_add_u32 v27, v34, 5, v32
 v_lshrrev_b32 v32, 3, v1
 v_and_b32 v33, 7, v1
 s_lshl_b32 s50, s37, 3
 s_add_u32 s50, s50, 128
 v_add_u32 v32, s50, v32
 v_lshlrev_b32 v35, 6, v33
 s_mul_i32 s51, s38, 224
 s_add_u32 s52, s51, 351
 s_and_b32 s51, s51, -128
 s_and_b32 s52, s52, -128
 s_sub_u32 s52, s52, s51
 v_mul_u32_u24 v34, 7168, v32
 v_add3_u32 v136, v34, v35, s51
 v_lshlrev_b32 v34, 13, v32
 s_lshl_b32 s51, s38, 8
 v_add3_u32 v137, v34, v35, s51
 v_cmp_gt_u32 vcc, s52, v35
 s_and_b32 s50, s36, 1
 s_cmp_eq_u32 s50, 0
 s_cselect_b64 vcc, vcc, 0
 v_mov_b32 v34, 0xf0000000
 s_nop 1
 v_cndmask_b32 v136, v34, v136, vcc
 v_cmp_gt_u32 vcc, 4, v33
 s_cmp_eq_u32 s36, 1
 s_cselect_b64 vcc, vcc, 0
 s_nop 1
 v_cndmask_b32 v137, v34, v137, vcc
 v_subrev_u32 v34, 917504, v136
 v_subrev_u32 v35, 1048576, v137
 s_mov_b32 s50, 0
 s_mov_b32 s51, 0
 buffer_load_dword v138, v34, s[8:11], s50 offen
 buffer_load_dword v138, v35, s[12:15], s51 offen
 s_mov_b32 s50, 458752
 s_mov_b32 s51, 524288
 buffer_load_dword v138, v34, s[8:11], s50 offen
 buffer_load_dword v138, v35, s[12:15], s51 offen
 s_mov_b32 s54, 0xffff0000
 s_lshl_b32 s50, s37, 5
 s_add_u32 s51, s50, s38
 s_lshl_b32 s51, s51, 7
 v_mov_b32 v45, s51
 s_lshl_b32 s53, s51, 2
 s_lshl_b32 s52, s36, 7
 s_add_u32 s53, s53, s52
 s_add_u32 s53, s53, 163840
 v_mov_b32 v31, s53
 s_lshl_b32 s52, s36, 3
 s_add_u32 s50, s50, s52
 s_lshl_b32 s50, s50, 9
 s_add_u32 s50, s50, 163840
 v_and_b32 v30, 31, v1
 v_lshl_add_u32 v30, v30, 7, s50
 v_lshl_add_u32 v46, v1, 4, v45
 v_cmp_gt_u32 vcc, 8, v1
 v_mov_b32 v47, -1
 s_nop 0
 v_cndmask_b32 v46, v47, v46, vcc
 v_mov_b32 v44, 0
 s_waitcnt vmcnt(8)
 v_lshlrev_b32 v160, 16, v144
 v_and_b32 v161, s54, v144
 v_lshlrev_b32 v162, 16, v145
 v_and_b32 v163, s54, v145
 v_lshlrev_b32 v164, 16, v146
 v_and_b32 v165, s54, v146
 v_lshlrev_b32 v166, 16, v147
 v_and_b32 v167, s54, v147
 s_waitcnt vmcnt(7)
 v_lshlrev_b32 v168, 16, v148
 v_and_b32 v169, s54, v148
 v_lshlrev_b32 v170, 16, v149
 v_and_b32 v171, s54, v149
 v_lshlrev_b32 v172, 16, v150
 v_and_b32 v173, s54, v150
 v_lshlrev_b32 v174, 16, v151
 v_and_b32 v175, s54, v151
 s_waitcnt vmcnt(6)
 v_lshlrev_b32 v176, 16, v152
 v_and_b32 v177, s54, v152
 v_lshlrev_b32 v178, 16, v153
 v_and_b32 v179, s54, v153
 v_lshlrev_b32 v180, 16, v154
 v_and_b32 v181, s54, v154
 v_lshlrev_b32 v182, 16, v155
 v_and_b32 v183, s54, v155
 s_waitcnt vmcnt(5)
 v_lshlrev_b32 v184, 16, v156
 v_and_b32 v185, s54, v156
 v_lshlrev_b32 v186, 16, v157
 v_and_b32 v187, s54, v157
 v_lshlrev_b32 v188, 16, v158
 v_and_b32 v189, s54, v158
 v_lshlrev_b32 v190, 16, v159
 v_and_b32 v191, s54, v159
 buffer_load_dwordx2 v[2:3], v44, s[60:63], 0 offen sc1
 v_pk_add_f32 v[32:33], v[160:161], v[164:165]
 v_pk_add_f32 v[34:35], v[162:163], v[166:167]
 v_pk_add_f32 v[32:33], v[32:33], v[168:169]
 v_pk_add_f32 v[34:35], v[34:35], v[170:171]
 v_pk_add_f32 v[32:33], v[32:33], v[172:173]
 v_pk_add_f32 v[34:35], v[34:35], v[174:175]
 v_pk_add_f32 v[32:33], v[32:33], v[176:177]
 v_pk_add_f32 v[34:35], v[34:35], v[178:179]
 v_pk_add_f32 v[32:33], v[32:33], v[180:181]
 v_pk_add_f32 v[34:35], v[34:35], v[182:183]
 v_pk_add_f32 v[32:33], v[32:33], v[184:185]
 v_pk_add_f32 v[34:35], v[34:35], v[186:187]
 v_pk_add_f32 v[32:33], v[32:33], v[188:189]
 v_pk_add_f32 v[34:35], v[34:35], v[190:191]
 v_pk_add_f32 v[32:33], v[32:33], v[34:35]
 v_add_f32 v32, v32, v33
 s_nop 1
 v_add_f32_dpp v32, v32, v32 row_ror:8 row_mask:0xf bank_mask:0xf
 v_mov_b32 v33, v32
 s_nop 1
 v_permlane16_swap_b32 v32, v33
 s_nop 1
 v_add_f32 v32, v32, v33
 v_mov_b32 v33, v32
 s_nop 1
 v_permlane32_swap_b32 v32, v33
 s_nop 1
 v_add_f32 v32, v32, v33
 ds_write_b32 v131, v32
 s_waitcnt lgkmcnt(0)
 s_barrier
 ds_read_b128 v[40:43], v130
 s_waitcnt lgkmcnt(0)
 v_add_f32 v40, v40, v41
 v_add_f32 v42, v42, v43
 v_add_f32 v32, v40, v42
 v_mul_f32 v32, 0x3a800000, v32
 v_mov_b32 v33, v32
 v_pk_add_f32 v[192:193], v[160:161], v[32:33] neg_lo:[0,1] neg_hi:[0,1]
 v_pk_add_f32 v[194:195], v[162:163], v[32:33] neg_lo:[0,1] neg_hi:[0,1]
 v_pk_add_f32 v[196:197], v[164:165], v[32:33] neg_lo:[0,1] neg_hi:[0,1]
 v_pk_add_f32 v[198:199], v[166:167], v[32:33] neg_lo:[0,1] neg_hi:[0,1]
 v_pk_add_f32 v[200:201], v[168:169], v[32:33] neg_lo:[0,1] neg_hi:[0,1]
 v_pk_add_f32 v[202:203], v[170:171], v[32:33] neg_lo:[0,1] neg_hi:[0,1]
 v_pk_add_f32 v[204:205], v[172:173], v[32:33] neg_lo:[0,1] neg_hi:[0,1]
 v_pk_add_f32 v[206:207], v[174:175], v[32:33] neg_lo:[0,1] neg_hi:[0,1]
 v_pk_add_f32 v[208:209], v[176:177], v[32:33] neg_lo:[0,1] neg_hi:[0,1]
 v_pk_add_f32 v[210:211], v[178:179], v[32:33] neg_lo:[0,1] neg_hi:[0,1]
 v_pk_add_f32 v[212:213], v[180:181], v[32:33] neg_lo:[0,1] neg_hi:[0,1]
 v_pk_add_f32 v[214:215], v[182:183], v[32:33] neg_lo:[0,1] neg_hi:[0,1]
 v_pk_add_f32 v[216:217], v[184:185], v[32:33] neg_lo:[0,1] neg_hi:[0,1]
 v_pk_add_f32 v[218:219], v[186:187], v[32:33] neg_lo:[0,1] neg_hi:[0,1]
 v_pk_add_f32 v[220:221], v[188:189], v[32:33] neg_lo:[0,1] neg_hi:[0,1]
 v_pk_add_f32 v[222:223], v[190:191], v[32:33] neg_lo:[0,1] neg_hi:[0,1]
 v_pk_mul_f32 v[36:37], v[192:193], v[192:193]
 v_pk_mul_f32 v[38:39], v[194:195], v[194:195]
 v_pk_fma_f32 v[36:37], v[196:197], v[196:197], v[36:37]
 v_pk_fma_f32 v[38:39], v[198:199], v[198:199], v[38:39]
 v_pk_fma_f32 v[36:37], v[200:201], v[200:201], v[36:37]
 v_pk_fma_f32 v[38:39], v[202:203], v[202:203], v[38:39]
 v_pk_fma_f32 v[36:37], v[204:205], v[204:205], v[36:37]
 v_pk_fma_f32 v[38:39], v[206:207], v[206:207], v[38:39]
 v_pk_fma_f32 v[36:37], v[208:209], v[208:209], v[36:37]
 v_pk_fma_f32 v[38:39], v[210:211], v[210:211], v[38:39]
 v_pk_fma_f32 v[36:37], v[212:213], v[212:213], v[36:37]
 v_pk_fma_f32 v[38:39], v[214:215], v[214:215], v[38:39]
 v_pk_fma_f32 v[36:37], v[216:217], v[216:217], v[36:37]
 v_pk_fma_f32 v[38:39], v[218:219], v[218:219], v[38:39]
 v_pk_fma_f32 v[36:37], v[220:221], v[220:221], v[36:37]
 v_pk_fma_f32 v[38:39], v[222:223], v[222:223], v[38:39]
 v_pk_add_f32 v[36:37], v[36:37], v[38:39]
 v_add_f32 v36, v36, v37
 s_nop 1
 v_add_f32_dpp v36, v36, v36 row_ror:8 row_mask:0xf bank_mask:0xf
 v_mov_b32 v37, v36
 s_nop 1
 v_permlane16_swap_b32 v36, v37
 s_nop 1
 v_add_f32 v36, v36, v37
 v_mov_b32 v37, v36
 s_nop 1
 v_permlane32_swap_b32 v36, v37
 s_nop 1
 v_add_f32 v36, v36, v37
 ds_write_b32 v131, v36 offset:128
 s_waitcnt lgkmcnt(0)
 s_barrier
 ds_read_b128 v[40:43], v130 offset:128
 s_waitcnt lgkmcnt(0)
 v_add_f32 v40, v40, v41
 v_add_f32 v42, v42, v43
 v_add_f32 v36, v40, v42
 v_mul_f32 v36, 0x3a800000, v36
 v_cvt_pk_bf16_f32 v32, v32, v32
 v_lshlrev_b32 v32, 16, v32
 v_cvt_pk_bf16_f32 v36, v36, v36
 v_lshlrev_b32 v36, 16, v36
 v_add_f32 v36, 0x3727c5ac, v36
 v_cvt_pk_bf16_f32 v36, v36, v36
 v_lshlrev_b32 v36, 16, v36
 v_sqrt_f32 v36, v36
 s_nop 0
 v_cvt_pk_bf16_f32 v36, v36, v36
 v_lshlrev_b32 v36, 16, v36
 v_rcp_f32 v36, v36
 s_add_u32 s28, s86, 0x2900000
 s_addc_u32 s29, s87, 0
 s_mov_b32 s30, 0x8000
 s_mov_b32 s31, 0x20000
 s_waitcnt vmcnt(0)
L_no_retry:
 v_readfirstlane_b32 s6, v2
 v_readfirstlane_b32 s7, v3
 s_nop 0
 s_cmp_lg_u32 s6, 0
 s_cbranch_scc1 L_no_ok
 buffer_load_dwordx2 v[2:3], v44, s[60:63], 0 offen sc1
 s_waitcnt vmcnt(0)
 s_branch L_no_retry
L_no_ok:
 s_cmp_eq_u32 s36, 1
 s_cbranch_scc0 L_st_skip
 v_mov_b32 v40, v32
 v_mov_b32 v41, v36
 v_mov_b32 v42, v2
 v_mov_b32 v43, v3
 buffer_store_dwordx4 v[40:43], v46, s[28:31], 0 offen sc1
L_st_skip:
 v_mov_b32 v33, v32
 v_mov_b32 v37, v36
 s_add_u32 m0, s43, s49
 s_nop 0
 buffer_load_dwordx4 v8, s[8:11], s39 offen  lds
 buffer_load_dwordx4 v9, s[8:11], s39 offen offset:1024  lds
 buffer_load_dwordx4 v10, s[8:11], s39 offen offset:2048  lds
 buffer_load_dwordx4 v11, s[8:11], s39 offen offset:3072  lds
 s_add_u32 m0, m0, 4096
 s_nop 0
 buffer_load_dwordx4 v12, s[8:11], s39 offen  lds
 buffer_load_dwordx4 v13, s[8:11], s39 offen offset:1024  lds
 buffer_load_dwordx4 v14, s[8:11], s39 offen offset:2048  lds
 s_add_u32 s39, s39, 458752
 s_add_u32 s43, s43, 45056
 s_cmp_ge_u32 s43, 157696
 s_cselect_b32 s50, 157696, 0
 s_sub_u32 s43, s43, s50
 s_add_u32 m0, s44, s3
 s_nop 0
 buffer_load_dwordx4 v15, s[12:15], s40 offen  lds
 buffer_load_dwordx4 v16, s[12:15], s40 offen offset:1024  lds
 buffer_load_dwordx4 v17, s[12:15], s40 offen offset:2048  lds
 buffer_load_dwordx4 v18, s[12:15], s40 offen offset:3072  lds
 s_add_u32 s40, s40, 524288
 s_add_u32 s44, s44, 45056
 s_cmp_ge_u32 s44, 157696
 s_cselect_b32 s50, 157696, 0
 s_sub_u32 s44, s44, s50
 s_lshl_b32 s50, s36, 14
 s_add_u32 m0, s50, 90112
 s_mov_b32 s50, 0
 buffer_load_dwordx4 v140, s[20:23], s50 offen lds
 buffer_load_dwordx4 v141, s[20:23], s50 offen offset:1024 lds
 buffer_load_dwordx4 v142, s[20:23], s50 offen offset:2048 lds
 buffer_load_dwordx4 v143, s[20:23], s50 offen offset:3072 lds
 v_pk_add_f32 v[160:161], v[160:161], v[32:33] neg_lo:[0,1] neg_hi:[0,1]
 v_cvt_pk_bf16_f32 v160, v160, v161
 v_and_b32 v161, s54, v160
 v_lshlrev_b32 v160, 16, v160
 v_pk_mul_f32 v[160:161], v[160:161], v[36:37]
 v_cvt_pk_bf16_f32 v240, v160, v161
 v_pk_add_f32 v[162:163], v[162:163], v[32:33] neg_lo:[0,1] neg_hi:[0,1]
 v_cvt_pk_bf16_f32 v162, v162, v163
 v_and_b32 v163, s54, v162
 v_lshlrev_b32 v162, 16, v162
 v_pk_mul_f32 v[162:163], v[162:163], v[36:37]
 v_cvt_pk_bf16_f32 v241, v162, v163
 v_pk_add_f32 v[164:165], v[164:165], v[32:33] neg_lo:[0,1] neg_hi:[0,1]
 v_cvt_pk_bf16_f32 v164, v164, v165
 v_and_b32 v165, s54, v164
 v_lshlrev_b32 v164, 16, v164
 v_pk_mul_f32 v[164:165], v[164:165], v[36:37]
 v_cvt_pk_bf16_f32 v242, v164, v165
 v_pk_add_f32 v[166:167], v[166:167], v[32:33] neg_lo:[0,1] neg_hi:[0,1]
 v_cvt_pk_bf16_f32 v166, v166, v167
 v_and_b32 v167, s54, v166
 v_lshlrev_b32 v166, 16, v166
 v_pk_mul_f32 v[166:167], v[166:167], v[36:37]
 v_cvt_pk_bf16_f32 v243, v166, v167
 s_lshl_b32 s50, s36, 14
 s_add_u32 m0, s50, 94208
 s_mov_b32 s50, 32768
 buffer_load_dwordx4 v140, s[20:23], s50 offen lds
 buffer_load_dwordx4 v141, s[20:23], s50 offen offset:1024 lds
 buffer_load_dwordx4 v142, s[20:23], s50 offen offset:2048 lds
 buffer_load_dwordx4 v143, s[20:23], s50 offen offset:3072 lds
 v_pk_add_f32 v[168:169], v[168:169], v[32:33] neg_lo:[0,1] neg_hi:[0,1]
 v_cvt_pk_bf16_f32 v168, v168, v169
 v_and_b32 v169, s54, v168
 v_lshlrev_b32 v168, 16, v168
 v_pk_mul_f32 v[168:169], v[168:169], v[36:37]
 v_cvt_pk_bf16_f32 v244, v168, v169
 v_pk_add_f32 v[170:171], v[170:171], v[32:33] neg_lo:[0,1] neg_hi:[0,1]
 v_cvt_pk_bf16_f32 v170, v170, v171
 v_and_b32 v171, s54, v170
 v_lshlrev_b32 v170, 16, v170
 v_pk_mul_f32 v[170:171], v[170:171], v[36:37]
 v_cvt_pk_bf16_f32 v245, v170, v171
 v_pk_add_f32 v[172:173], v[172:173], v[32:33] neg_lo:[0,1] neg_hi:[0,1]
 v_cvt_pk_bf16_f32 v172, v172, v173
 v_and_b32 v173, s54, v172
 v_lshlrev_b32 v172, 16, v172
 v_pk_mul_f32 v[172:173], v[172:173], v[36:37]
 v_cvt_pk_bf16_f32 v246, v172, v173
 v_pk_add_f32 v[174:175], v[174:175], v[32:33] neg_lo:[0,1] neg_hi:[0,1]
 v_cvt_pk_bf16_f32 v174, v174, v175
 v_and_b32 v175, s54, v174
 v_lshlrev_b32 v174, 16, v174
 v_pk_mul_f32 v[174:175], v[174:175], v[36:37]
 v_cvt_pk_bf16_f32 v247, v174, v175
 s_lshl_b32 s50, s36, 14
 s_add_u32 m0, s50, 98304
 s_mov_b32 s50, 65536
 buffer_load_dwordx4 v140, s[20:23], s50 offen lds
 buffer_load_dwordx4 v141, s[20:23], s50 offen offset:1024 lds
 buffer_load_dwordx4 v142, s[20:23], s50 offen offset:2048 lds
 buffer_load_dwordx4 v143, s[20:23], s50 offen offset:3072 lds
 v_pk_add_f32 v[176:177], v[176:177], v[32:33] neg_lo:[0,1] neg_hi:[0,1]
 v_cvt_pk_bf16_f32 v176, v176, v177
 v_and_b32 v177, s54, v176
 v_lshlrev_b32 v176, 16, v176
 v_pk_mul_f32 v[176:177], v[176:177], v[36:37]
 v_cvt_pk_bf16_f32 v248, v176, v177
 v_pk_add_f32 v[178:179], v[178:179], v[32:33] neg_lo:[0,1] neg_hi:[0,1]
 v_cvt_pk_bf16_f32 v178, v178, v179
 v_and_b32 v179, s54, v178
 v_lshlrev_b32 v178, 16, v178
 v_pk_mul_f32 v[178:179], v[178:179], v[36:37]
 v_cvt_pk_bf16_f32 v249, v178, v179
 v_pk_add_f32 v[180:181], v[180:181], v[32:33] neg_lo:[0,1] neg_hi:[0,1]
 v_cvt_pk_bf16_f32 v180, v180, v181
 v_and_b32 v181, s54, v180
 v_lshlrev_b32 v180, 16, v180
 v_pk_mul_f32 v[180:181], v[180:181], v[36:37]
 v_cvt_pk_bf16_f32 v250, v180, v181
 v_pk_add_f32 v[182:183], v[182:183], v[32:33] neg_lo:[0,1] neg_hi:[0,1]
 v_cvt_pk_bf16_f32 v182, v182, v183
 v_and_b32 v183, s54, v182
 v_lshlrev_b32 v182, 16, v182
 v_pk_mul_f32 v[182:183], v[182:183], v[36:37]
 v_cvt_pk_bf16_f32 v251, v182, v183
 s_lshl_b32 s50, s36, 14
 s_add_u32 m0, s50, 102400
 s_mov_b32 s50, 98304
 buffer_load_dwordx4 v140, s[20:23], s50 offen lds
 buffer_load_dwordx4 v141, s[20:23], s50 offen offset:1024 lds
 buffer_load_dwordx4 v142, s[20:23], s50 offen offset:2048 lds
 buffer_load_dwordx4 v143, s[20:23], s50 offen offset:3072 lds
 v_pk_add_f32 v[184:185], v[184:185], v[32:33] neg_lo:[0,1] neg_hi:[0,1]
 v_cvt_pk_bf16_f32 v184, v184, v185
 v_and_b32 v185, s54, v184
 v_lshlrev_b32 v184, 16, v184
 v_pk_mul_f32 v[184:185], v[184:185], v[36:37]
 v_cvt_pk_bf16_f32 v252, v184, v185
 v_pk_add_f32 v[186:187], v[186:187], v[32:33] neg_lo:[0,1] neg_hi:[0,1]
 v_cvt_pk_bf16_f32 v186, v186, v187
 v_and_b32 v187, s54, v186
 v_lshlrev_b32 v186, 16, v186
 v_pk_mul_f32 v[186:187], v[186:187], v[36:37]
 v_cvt_pk_bf16_f32 v253, v186, v187
 v_pk_add_f32 v[188:189], v[188:189], v[32:33] neg_lo:[0,1] neg_hi:[0,1]
 v_cvt_pk_bf16_f32 v188, v188, v189
 v_and_b32 v189, s54, v188
 v_lshlrev_b32 v188, 16, v188
 v_pk_mul_f32 v[188:189], v[188:189], v[36:37]
 v_cvt_pk_bf16_f32 v254, v188, v189
 v_pk_add_f32 v[190:191], v[190:191], v[32:33] neg_lo:[0,1] neg_hi:[0,1]
 v_cvt_pk_bf16_f32 v190, v190, v191
 v_and_b32 v191, s54, v190
 v_lshlrev_b32 v190, 16, v190
 v_pk_mul_f32 v[190:191], v[190:191], v[36:37]
 v_cvt_pk_bf16_f32 v255, v190, v191
 buffer_load_dwordx4 v[224:227], v139, s[28:31], 0 offen sc1
 buffer_load_dwordx4 v[228:231], v139, s[28:31], 0 offen offset:256 sc1
 buffer_load_dwordx4 v[232:235], v139, s[28:31], 0 offen offset:512 sc1
 buffer_load_dwordx4 v[236:239], v139, s[28:31], 0 offen offset:768 sc1
 buffer_store_dwordx4 v[240:243], v129, s[16:19], 0 offen sc1
 buffer_store_dwordx4 v[244:247], v129, s[16:19], 0 offen offset:1024 sc1
 buffer_store_dwordx4 v[248:251], v129, s[16:19], 0 offen offset:2048 sc1
 buffer_store_dwordx4 v[252:255], v129, s[16:19], 0 offen offset:3072 sc1
 v_and_b32 v32, 15, v1
 v_lshrrev_b32 v33, 4, v1
 v_xor_b32 v33, v33, v32
 v_lshlrev_b32 v32, 8, v32
 s_lshl_b32 s50, s36, 14
 s_add_u32 s50, s50, 90112
 v_add_u32 v32, s50, v32
 v_xor_b32 v34, 0, v33
 v_lshl_add_u32 v36, v34, 4, v32
 v_xor_b32 v34, 4, v33
 v_lshl_add_u32 v37, v34, 4, v32
 v_xor_b32 v34, 8, v33
 v_lshl_add_u32 v38, v34, 4, v32
 v_xor_b32 v34, 12, v33
 v_lshl_add_u32 v39, v34, 4, v32
 s_waitcnt vmcnt(8)
 ds_read_b128 v[64:67], v36
 ds_read_b128 v[68:71], v36 offset:4096
 ds_read_b128 v[72:75], v36 offset:8192
 ds_read_b128 v[76:79], v36 offset:12288
 ds_read_b128 v[80:83], v37
 ds_read_b128 v[84:87], v37 offset:4096
 ds_read_b128 v[88:91], v37 offset:8192
 ds_read_b128 v[92:95], v37 offset:12288
 ds_read_b128 v[96:99], v38
 ds_read_b128 v[100:103], v38 offset:4096
 ds_read_b128 v[104:107], v38 offset:8192
 ds_read_b128 v[108:111], v38 offset:12288
 ds_read_b128 v[112:115], v39
 ds_read_b128 v[116:119], v39 offset:4096
 ds_read_b128 v[120:123], v39 offset:8192
 ds_read_b128 v[124:127], v39 offset:12288
 v_add_u32 v144, 22528, v19
 v_add_u32 v145, 22528, v20
 v_add_u32 v146, 22528, v21
 v_add_u32 v147, 22528, v22
 v_add_u32 v148, 22528, v23
 v_add_u32 v149, 22528, v24
 v_add_u32 v150, 22528, v25
 v_add_u32 v151, 22528, v26
 v_add_u32 v152, 22528, v27
 s_waitcnt lgkmcnt(15)
 v_lshlrev_b32 v160, 16, v64
 v_and_b32 v161, s54, v64
 v_lshlrev_b32 v162, 16, v65
 v_and_b32 v163, s54, v65
 v_lshlrev_b32 v164, 16, v66
 v_and_b32 v165, s54, v66
 v_lshlrev_b32 v166, 16, v67
 v_and_b32 v167, s54, v67
 s_waitcnt lgkmcnt(14)
 v_lshlrev_b32 v168, 16, v68
 v_and_b32 v169, s54, v68
 v_lshlrev_b32 v170, 16, v69
 v_and_b32 v171, s54, v69
 v_lshlrev_b32 v172, 16, v70
 v_and_b32 v173, s54, v70
 v_lshlrev_b32 v174, 16, v71
 v_and_b32 v175, s54, v71
 s_waitcnt lgkmcnt(13)
 v_lshlrev_b32 v176, 16, v72
 v_and_b32 v177, s54, v72
 v_lshlrev_b32 v178, 16, v73
 v_and_b32 v179, s54, v73
 v_lshlrev_b32 v180, 16, v74
 v_and_b32 v181, s54, v74
 v_lshlrev_b32 v182, 16, v75
 v_and_b32 v183, s54, v75
 s_waitcnt lgkmcnt(12)
 v_lshlrev_b32 v184, 16, v76
 v_and_b32 v185, s54, v76
 v_lshlrev_b32 v186, 16, v77
 v_and_b32 v187, s54, v77
 v_lshlrev_b32 v188, 16, v78
 v_and_b32 v189, s54, v78
 v_lshlrev_b32 v190, 16, v79
 v_and_b32 v191, s54, v79
 s_waitcnt lgkmcnt(11)
 v_lshlrev_b32 v192, 16, v80
 v_and_b32 v193, s54, v80
 v_lshlrev_b32 v194, 16, v81
 v_and_b32 v195, s54, v81
 v_lshlrev_b32 v196, 16, v82
 v_and_b32 v197, s54, v82
 v_lshlrev_b32 v198, 16, v83
 v_and_b32 v199, s54, v83
 s_waitcnt lgkmcnt(10)
 v_lshlrev_b32 v200, 16, v84
 v_and_b32 v201, s54, v84
 v_lshlrev_b32 v202, 16, v85
 v_and_b32 v203, s54, v85
 v_lshlrev_b32 v204, 16, v86
 v_and_b32 v205, s54, v86
 v_lshlrev_b32 v206, 16, v87
 v_and_b32 v207, s54, v87
 s_waitcnt lgkmcnt(9)
 v_lshlrev_b32 v208, 16, v88
 v_and_b32 v209, s54, v88
 v_lshlrev_b32 v210, 16, v89
 v_and_b32 v211, s54, v89
 v_lshlrev_b32 v212, 16, v90
 v_and_b32 v213, s54, v90
 v_lshlrev_b32 v214, 16, v91
 v_and_b32 v215, s54, v91
 s_waitcnt lgkmcnt(8)
 v_lshlrev_b32 v216, 16, v92
 v_and_b32 v217, s54, v92
 v_lshlrev_b32 v218, 16, v93
 v_and_b32 v219, s54, v93
 v_lshlrev_b32 v220, 16, v94
 v_and_b32 v221, s54, v94
 v_lshlrev_b32 v222, 16, v95
 v_and_b32 v223, s54, v95
 s_waitcnt vmcnt(4)
L_rec_chk:
 v_cmp_ne_u64 vcc, s[6:7], v[226:227]
 v_cmp_ne_u64 s[52:53], s[6:7], v[230:231]
 s_nop 0
 s_or_b64 vcc, vcc, s[52:53]
 v_cmp_ne_u64 s[52:53], s[6:7], v[234:235]
 s_nop 0
 s_or_b64 vcc, vcc, s[52:53]
 v_cmp_ne_u64 s[52:53], s[6:7], v[238:239]
 s_nop 0
 s_or_b64 vcc, vcc, s[52:53]
 s_cbranch_vccz L_rec_ok
 buffer_load_dwordx4 v[224:227], v139, s[28:31], 0 offen sc1
 buffer_load_dwordx4 v[228:231], v139, s[28:31], 0 offen offset:256 sc1
 buffer_load_dwordx4 v[232:235], v139, s[28:31], 0 offen offset:512 sc1
 buffer_load_dwordx4 v[236:239], v139, s[28:31], 0 offen offset:768 sc1
 s_waitcnt vmcnt(0)
 s_branch L_rec_chk
L_rec_ok:
 v_mov_b32 v132, v225
 v_mul_f32 v128, v224, v225
 v_mov_b32 v133, v229
 v_mul_f32 v130, v228, v229
 v_mov_b32 v134, v233
 v_mul_f32 v131, v232, v233
 v_mov_b32 v135, v237
 v_mul_f32 v139, v236, v237
 s_nop 0
 v_sub_f32 v32, 0, v128
 v_mov_b32 v224, v132
 v_mov_b32 v33, v32
 v_sub_f32 v34, 0, v130
 v_mov_b32 v228, v133
 v_mov_b32 v35, v34
 v_sub_f32 v36, 0, v131
 v_mov_b32 v232, v134
 v_mov_b32 v37, v36
 v_sub_f32 v38, 0, v139
 v_mov_b32 v236, v135
 v_mov_b32 v39, v38
 v_pk_fma_f32 v[160:161], v[160:161], v[224:225], v[32:33]
 v_pk_fma_f32 v[162:163], v[162:163], v[224:225], v[32:33]
 v_pk_fma_f32 v[164:165], v[164:165], v[224:225], v[32:33]
 v_pk_fma_f32 v[166:167], v[166:167], v[224:225], v[32:33]
 v_pk_fma_f32 v[192:193], v[192:193], v[224:225], v[32:33]
 v_pk_fma_f32 v[194:195], v[194:195], v[224:225], v[32:33]
 v_pk_fma_f32 v[196:197], v[196:197], v[224:225], v[32:33]
 v_pk_fma_f32 v[198:199], v[198:199], v[224:225], v[32:33]
 v_pk_fma_f32 v[168:169], v[168:169], v[228:229], v[34:35]
 v_pk_fma_f32 v[170:171], v[170:171], v[228:229], v[34:35]
 v_pk_fma_f32 v[172:173], v[172:173], v[228:229], v[34:35]
 v_pk_fma_f32 v[174:175], v[174:175], v[228:229], v[34:35]
 v_pk_fma_f32 v[200:201], v[200:201], v[228:229], v[34:35]
 v_pk_fma_f32 v[202:203], v[202:203], v[228:229], v[34:35]
 v_pk_fma_f32 v[204:205], v[204:205], v[228:229], v[34:35]
 v_pk_fma_f32 v[206:207], v[206:207], v[228:229], v[34:35]
 v_pk_fma_f32 v[176:177], v[176:177], v[232:233], v[36:37]
 v_pk_fma_f32 v[178:179], v[178:179], v[232:233], v[36:37]
 v_pk_fma_f32 v[180:181], v[180:181], v[232:233], v[36:37]
 v_pk_fma_f32 v[182:183], v[182:183], v[232:233], v[36:37]
 v_pk_fma_f32 v[208:209], v[208:209], v[232:233], v[36:37]
 v_pk_fma_f32 v[210:211], v[210:211], v[232:233], v[36:37]
 v_pk_fma_f32 v[212:213], v[212:213], v[232:233], v[36:37]
 v_pk_fma_f32 v[214:215], v[214:215], v[232:233], v[36:37]
 v_pk_fma_f32 v[184:185], v[184:185], v[236:237], v[38:39]
 v_pk_fma_f32 v[186:187], v[186:187], v[236:237], v[38:39]
 v_pk_fma_f32 v[188:189], v[188:189], v[236:237], v[38:39]
 v_pk_fma_f32 v[190:191], v[190:191], v[236:237], v[38:39]
 v_pk_fma_f32 v[216:217], v[216:217], v[236:237], v[38:39]
 v_pk_fma_f32 v[218:219], v[218:219], v[236:237], v[38:39]
 v_pk_fma_f32 v[220:221], v[220:221], v[236:237], v[38:39]
 v_pk_fma_f32 v[222:223], v[222:223], v[236:237], v[38:39]
 v_cvt_pk_bf16_f32 v64, v160, v161
 v_cvt_pk_bf16_f32 v65, v162, v163
 v_cvt_pk_bf16_f32 v66, v164, v165
 v_cvt_pk_bf16_f32 v67, v166, v167
 v_cvt_pk_bf16_f32 v68, v168, v169
 v_cvt_pk_bf16_f32 v69, v170, v171
 v_cvt_pk_bf16_f32 v70, v172, v173
 v_cvt_pk_bf16_f32 v71, v174, v175
 v_cvt_pk_bf16_f32 v72, v176, v177
 v_cvt_pk_bf16_f32 v73, v178, v179
 v_cvt_pk_bf16_f32 v74, v180, v181
 v_cvt_pk_bf16_f32 v75, v182, v183
 v_cvt_pk_bf16_f32 v76, v184, v185
 v_cvt_pk_bf16_f32 v77, v186, v187
 v_cvt_pk_bf16_f32 v78, v188, v189
 v_cvt_pk_bf16_f32 v79, v190, v191
 v_cvt_pk_bf16_f32 v80, v192, v193
 v_cvt_pk_bf16_f32 v81, v194, v195
 v_cvt_pk_bf16_f32 v82, v196, v197
 v_cvt_pk_bf16_f32 v83, v198, v199
 v_cvt_pk_bf16_f32 v84, v200, v201
 v_cvt_pk_bf16_f32 v85, v202, v203
 v_cvt_pk_bf16_f32 v86, v204, v205
 v_cvt_pk_bf16_f32 v87, v206, v207
 v_cvt_pk_bf16_f32 v88, v208, v209
 v_cvt_pk_bf16_f32 v89, v210, v211
 v_cvt_pk_bf16_f32 v90, v212, v213
 v_cvt_pk_bf16_f32 v91, v214, v215
 v_cvt_pk_bf16_f32 v92, v216, v217
 v_cvt_pk_bf16_f32 v93, v218, v219
 v_cvt_pk_bf16_f32 v94, v220, v221
 v_cvt_pk_bf16_f32 v95, v222, v223
 s_mov_b32 s24, s66
 s_mov_b32 s25, s67
 s_mov_b32 s26, 0x200000
 s_mov_b32 s27, 0x20000
 s_mov_b32 s28, s68
 s_mov_b32 s29, s69
 s_mov_b32 s30, 0x200000
 s_mov_b32 s31, 0x20000
 v_subrev_u32 v34, 917504, v136
 v_subrev_u32 v35, 1048576, v137
 s_mov_b32 s50, 917504
 s_mov_b32 s51, 1048576
 buffer_load_dword v138, v34, s[8:11], s50 offen
 buffer_load_dword v138, v35, s[12:15], s51 offen
 s_mov_b32 s50, 1376256
 s_mov_b32 s51, 1572864
 buffer_load_dword v138, v34, s[8:11], s50 offen
 buffer_load_dword v138, v35, s[12:15], s51 offen
 s_lshr_b32 s50, s2, 3
 s_lshl_b32 s50, s50, 2
 s_add_u32 s50, s50, s36
 s_lshl_b32 s50, s50, 10
 s_lshr_b32 s51, s38, 3
 s_lshl_b32 s51, s51, 19
 s_add_u32 s50, s50, s51
 s_add_u32 s50, s50, 393216
 v_and_b32 v40, 15, v1
 v_lshlrev_b32 v40, 6, v40
 buffer_load_dword v138, v40, s[24:27], s50 offen
 buffer_load_dword v138, v40, s[28:31], s50 offen
 s_add_u32 s20, s86, 0x1700000
 s_addc_u32 s21, s87, 0
 s_mov_b32 s22, 0xf00000
 s_mov_b32 s23, 0x20000
 s_mov_b32 s60, s32
 s_mov_b32 s61, s33
 s_mov_b32 s62, s34
 s_mov_b32 s63, 0x20000
 s_waitcnt lgkmcnt(0)
 s_barrier
 ds_read_b64_tr_b16 v[32:33], v19
 ds_read_b64_tr_b16 v[34:35], v19 offset:1792
 ds_read_b64_tr_b16 v[36:37], v144
 ds_read_b64_tr_b16 v[38:39], v144 offset:1792
 ds_read_b64_tr_b16 v[40:41], v19 offset:32
 ds_read_b64_tr_b16 v[42:43], v19 offset:1824
 ds_read_b64_tr_b16 v[44:45], v144 offset:32
 ds_read_b64_tr_b16 v[46:47], v144 offset:1824
 s_mov_b32 s46, 0
 s_mov_b32 s48, 0
 s_mov_b32 s47, 22528
 s_mov_b32 s42, 6
 s_waitcnt lgkmcnt(6)
 v_mfma_f32_16x16x32_bf16 a[0:3], v[32:35], v[64:67], 0
 ds_read_b64_tr_b16 v[48:49], v19 offset:64
 s_waitcnt lgkmcnt(5)
 v_add_u32 v22, s46, v22
 v_mfma_f32_16x16x32_bf16 a[0:3], v[36:39], v[80:83], a[0:3]
 ds_read_b64_tr_b16 v[50:51], v19 offset:1856
 v_lshlrev_b32 v140, 16, v96
 v_mfma_f32_16x16x32_bf16 a[4:7], v[36:39], v[84:87], 0
 v_and_b32 v141, s54, v96
 v_fma_f32 v140, v140, v132, -v128
 v_mfma_f32_16x16x32_bf16 a[4:7], v[32:35], v[68:71], a[4:7]
 v_fma_f32 v141, v141, v132, -v128
 v_mfma_f32_16x16x32_bf16 a[8:11], v[32:35], v[72:75], 0
 ds_read_b64_tr_b16 v[52:53], v144 offset:64
 v_add_u32 v23, s46, v23
 v_mfma_f32_16x16x32_bf16 a[8:11], v[36:39], v[88:91], a[8:11]
 ds_read_b64_tr_b16 v[54:55], v144 offset:1856
 v_cvt_pk_bf16_f32 v96, v140, v141
 v_mfma_f32_16x16x32_bf16 a[12:15], v[36:39], v[92:95], 0
 v_lshlrev_b32 v142, 16, v97
 v_and_b32 v143, s54, v97
 v_mfma_f32_16x16x32_bf16 a[12:15], v[32:35], v[76:79], a[12:15]
 s_waitcnt lgkmcnt(4)
 v_mfma_f32_16x16x32_bf16 a[28:31], v[40:43], v[76:79], 0
 ds_read_b64_tr_b16 v[56:57], v19 offset:96
 s_add_u32 m0, s43, s49
 v_mfma_f32_16x16x32_bf16 a[28:31], v[44:47], v[92:95], a[28:31]
 ds_read_b64_tr_b16 v[58:59], v19 offset:1888
 v_fma_f32 v142, v142, v132, -v128
 v_mfma_f32_16x16x32_bf16 a[24:27], v[44:47], v[88:91], 0
 s_waitcnt vmcnt(6)
 buffer_store_dwordx2 v[2:3], v31, s[56:59], 0 offen sc1
 v_fma_f32 v143, v143, v132, -v128
 v_mfma_f32_16x16x32_bf16 a[24:27], v[40:43], v[72:75], a[24:27]
 buffer_load_dwordx4 v8, s[8:11], s39 offen  lds
 v_add_u32 v24, s46, v24
 v_mfma_f32_16x16x32_bf16 a[20:23], v[40:43], v[68:71], 0
 ds_read_b64_tr_b16 v[60:61], v144 offset:96
 v_add_u32 v25, s46, v25
 v_cvt_pk_bf16_f32 v97, v142, v143
 v_mfma_f32_16x16x32_bf16 a[20:23], v[44:47], v[84:87], a[20:23]
 ds_read_b64_tr_b16 v[62:63], v144 offset:1888
 v_lshlrev_b32 v140, 16, v98
 v_mfma_f32_16x16x32_bf16 a[16:19], v[44:47], v[80:83], 0
 v_and_b32 v141, s54, v98
 v_fma_f32 v140, v140, v132, -v128
 v_mfma_f32_16x16x32_bf16 a[16:19], v[40:43], v[64:67], a[16:19]
 s_waitcnt lgkmcnt(4)
 v_mfma_f32_16x16x32_bf16 a[32:35], v[48:51], v[64:67], 0
 ds_read_b64_tr_b16 v[32:33], v19 offset:128
 v_add_u32 v26, s46, v26
 v_mfma_f32_16x16x32_bf16 a[32:35], v[52:55], v[80:83], a[32:35]
 ds_read_b64_tr_b16 v[34:35], v19 offset:1920
 v_fma_f32 v141, v141, v132, -v128
 v_mfma_f32_16x16x32_bf16 a[36:39], v[52:55], v[84:87], 0
 v_cvt_pk_bf16_f32 v98, v140, v141
 v_lshlrev_b32 v142, 16, v99
 v_mfma_f32_16x16x32_bf16 a[36:39], v[48:51], v[68:71], a[36:39]
 v_and_b32 v143, s54, v99
 v_mfma_f32_16x16x32_bf16 a[40:43], v[48:51], v[72:75], 0
 ds_read_b64_tr_b16 v[36:37], v144 offset:128
 buffer_load_dwordx4 v9, s[8:11], s39 offen offset:1024  lds
 v_mfma_f32_16x16x32_bf16 a[40:43], v[52:55], v[88:91], a[40:43]
 ds_read_b64_tr_b16 v[38:39], v144 offset:1920
 v_add_u32 v27, s46, v27
 v_fma_f32 v142, v142, v132, -v128
 v_mfma_f32_16x16x32_bf16 a[44:47], v[52:55], v[92:95], 0
 v_fma_f32 v143, v143, v132, -v128
 v_cvt_pk_bf16_f32 v99, v142, v143
 v_mfma_f32_16x16x32_bf16 a[44:47], v[48:51], v[76:79], a[44:47]
 s_waitcnt lgkmcnt(4)
 v_mfma_f32_16x16x32_bf16 a[60:63], v[56:59], v[76:79], 0
 ds_read_b64_tr_b16 v[40:41], v19 offset:160
 v_add_u32 v145, s48, v145
 v_lshlrev_b32 v140, 16, v100
 v_mfma_f32_16x16x32_bf16 a[60:63], v[60:63], v[92:95], a[60:63]
 ds_read_b64_tr_b16 v[42:43], v19 offset:1952
 v_and_b32 v141, s54, v100
 v_mfma_f32_16x16x32_bf16 a[56:59], v[60:63], v[88:91], 0
 v_fma_f32 v140, v140, v133, -v130
 v_fma_f32 v141, v141, v133, -v130
 v_mfma_f32_16x16x32_bf16 a[56:59], v[56:59], v[72:75], a[56:59]
 v_cvt_pk_bf16_f32 v100, v140, v141
 v_mfma_f32_16x16x32_bf16 a[52:55], v[56:59], v[68:71], 0
 ds_read_b64_tr_b16 v[44:45], v144 offset:160
 v_add_u32 v146, s48, v146
 v_mfma_f32_16x16x32_bf16 a[52:55], v[60:63], v[84:87], a[52:55]
 ds_read_b64_tr_b16 v[46:47], v144 offset:1952
 v_lshlrev_b32 v142, 16, v101
 v_mfma_f32_16x16x32_bf16 a[48:51], v[60:63], v[80:83], 0
 v_and_b32 v143, s54, v101
 v_fma_f32 v142, v142, v133, -v130
 v_mfma_f32_16x16x32_bf16 a[48:51], v[56:59], v[64:67], a[48:51]
 s_waitcnt lgkmcnt(4)
 v_mfma_f32_16x16x32_bf16 a[64:67], v[32:35], v[64:67], 0
 ds_read_b64_tr_b16 v[48:49], v19 offset:192
 buffer_load_dwordx4 v10, s[8:11], s39 offen offset:2048  lds
 v_mfma_f32_16x16x32_bf16 a[64:67], v[36:39], v[80:83], a[64:67]
 ds_read_b64_tr_b16 v[50:51], v19 offset:1984
 v_add_u32 v147, s48, v147
 v_fma_f32 v143, v143, v133, -v130
 v_mfma_f32_16x16x32_bf16 a[68:71], v[36:39], v[84:87], 0
 v_cvt_pk_bf16_f32 v101, v142, v143
 v_lshlrev_b32 v140, 16, v102
 v_mfma_f32_16x16x32_bf16 a[68:71], v[32:35], v[68:71], a[68:71]
 v_and_b32 v141, s54, v102
 v_mfma_f32_16x16x32_bf16 a[72:75], v[32:35], v[72:75], 0
 ds_read_b64_tr_b16 v[52:53], v144 offset:192
 v_add_u32 v148, s48, v148
 v_mfma_f32_16x16x32_bf16 a[72:75], v[36:39], v[88:91], a[72:75]
 ds_read_b64_tr_b16 v[54:55], v144 offset:1984
 v_fma_f32 v140, v140, v133, -v130
 v_mfma_f32_16x16x32_bf16 a[76:79], v[36:39], v[92:95], 0
 v_fma_f32 v141, v141, v133, -v130
 v_cvt_pk_bf16_f32 v102, v140, v141
 v_mfma_f32_16x16x32_bf16 a[76:79], v[32:35], v[76:79], a[76:79]
 s_waitcnt lgkmcnt(4)
 v_mfma_f32_16x16x32_bf16 a[92:95], v[40:43], v[76:79], 0
 ds_read_b64_tr_b16 v[56:57], v19 offset:7168
 v_add_u32 v149, s48, v149
 v_lshlrev_b32 v142, 16, v103
 v_mfma_f32_16x16x32_bf16 a[92:95], v[44:47], v[92:95], a[92:95]
 ds_read_b64_tr_b16 v[58:59], v19 offset:8960
 v_and_b32 v143, s54, v103
 v_mfma_f32_16x16x32_bf16 a[88:91], v[44:47], v[88:91], 0
 v_fma_f32 v142, v142, v133, -v130
 v_fma_f32 v143, v143, v133, -v130
 v_mfma_f32_16x16x32_bf16 a[88:91], v[40:43], v[72:75], a[88:91]
 v_cvt_pk_bf16_f32 v103, v142, v143
 v_mfma_f32_16x16x32_bf16 a[84:87], v[40:43], v[68:71], 0
 ds_read_b64_tr_b16 v[60:61], v144 offset:7168
 buffer_load_dwordx4 v11, s[8:11], s39 offen offset:3072  lds
 v_mfma_f32_16x16x32_bf16 a[84:87], v[44:47], v[84:87], a[84:87]
 ds_read_b64_tr_b16 v[62:63], v144 offset:8960
 v_add_u32 v150, s48, v150
 v_mfma_f32_16x16x32_bf16 a[80:83], v[44:47], v[80:83], 0
 v_lshlrev_b32 v140, 16, v104
 v_and_b32 v141, s54, v104
 v_mfma_f32_16x16x32_bf16 a[80:83], v[40:43], v[64:67], a[80:83]
 s_waitcnt lgkmcnt(4)
 v_mfma_f32_16x16x32_bf16 a[96:99], v[48:51], v[64:67], 0
 ds_read_b64_tr_b16 v[32:33], v19 offset:7200
 v_add_u32 v151, s48, v151
 v_fma_f32 v140, v140, v134, -v131
 v_mfma_f32_16x16x32_bf16 a[96:99], v[52:55], v[80:83], a[96:99]
 ds_read_b64_tr_b16 v[34:35], v19 offset:8992
 v_fma_f32 v141, v141, v134, -v131
 v_mfma_f32_16x16x32_bf16 a[100:103], v[52:55], v[84:87], 0
 s_add_u32 m0, m0, 4096
 v_cvt_pk_bf16_f32 v104, v140, v141
 v_mfma_f32_16x16x32_bf16 a[100:103], v[48:51], v[68:71], a[100:103]
 buffer_load_dwordx4 v12, s[8:11], s39 offen  lds
 v_lshlrev_b32 v142, 16, v105
 v_mfma_f32_16x16x32_bf16 a[104:107], v[48:51], v[72:75], 0
 ds_read_b64_tr_b16 v[36:37], v144 offset:7200
 v_add_u32 v152, s48, v152
 v_and_b32 v143, s54, v105
 v_mfma_f32_16x16x32_bf16 a[104:107], v[52:55], v[88:91], a[104:107]
 ds_read_b64_tr_b16 v[38:39], v144 offset:8992
 v_fma_f32 v142, v142, v134, -v131
 v_mfma_f32_16x16x32_bf16 a[108:111], v[52:55], v[92:95], 0
 v_fma_f32 v143, v143, v134, -v131
 v_cvt_pk_bf16_f32 v105, v142, v143
 v_mfma_f32_16x16x32_bf16 a[108:111], v[48:51], v[76:79], a[108:111]
 s_waitcnt lgkmcnt(4)
 v_mfma_f32_16x16x32_bf16 a[124:127], v[56:59], v[76:79], 0
 ds_read_b64_tr_b16 v[40:41], v19 offset:7232
 buffer_load_dwordx4 v13, s[8:11], s39 offen offset:1024  lds
 v_lshlrev_b32 v140, 16, v106
 v_mfma_f32_16x16x32_bf16 a[124:127], v[60:63], v[92:95], a[124:127]
 ds_read_b64_tr_b16 v[42:43], v19 offset:9024
 s_add_u32 s45, s45, 45056
 v_mfma_f32_16x16x32_bf16 a[120:123], v[60:63], v[88:91], 0
 s_mov_b32 s46, 45056
 s_cmp_ge_u32 s45, 157696
 s_cselect_b32 s46, -112640, s46
 s_cselect_b32 s50, 157696, 0
 v_and_b32 v141, s54, v106
 v_mfma_f32_16x16x32_bf16 a[120:123], v[56:59], v[72:75], a[120:123]
 s_sub_u32 s45, s45, s50
 v_fma_f32 v140, v140, v134, -v131
 v_mfma_f32_16x16x32_bf16 a[116:119], v[56:59], v[68:71], 0
 ds_read_b64_tr_b16 v[44:45], v144 offset:7232
 v_fma_f32 v141, v141, v134, -v131
 v_mfma_f32_16x16x32_bf16 a[116:119], v[60:63], v[84:87], a[116:119]
 ds_read_b64_tr_b16 v[46:47], v144 offset:9024
 v_cvt_pk_bf16_f32 v106, v140, v141
 v_mfma_f32_16x16x32_bf16 a[112:115], v[60:63], v[80:83], 0
 buffer_load_dwordx4 v14, s[8:11], s39 offen offset:2048  lds
 s_add_u32 s39, s39, 458752
 v_lshlrev_b32 v142, 16, v107
 v_mfma_f32_16x16x32_bf16 a[112:115], v[56:59], v[64:67], a[112:115]
 s_waitcnt lgkmcnt(4)
 s_add_u32 s43, s43, 45056
 v_and_b32 v143, s54, v107
 v_mfma_f32_16x16x32_bf16 a[128:131], v[32:35], v[64:67], 0
 ds_read_b64_tr_b16 v[48:49], v19 offset:7264
 s_cmp_ge_u32 s43, 157696
 s_cselect_b32 s50, 157696, 0
 s_sub_u32 s43, s43, s50
 v_fma_f32 v142, v142, v134, -v131
 v_mfma_f32_16x16x32_bf16 a[128:131], v[36:39], v[80:83], a[128:131]
 ds_read_b64_tr_b16 v[50:51], v19 offset:9056
 s_add_u32 s47, s47, 45056
 v_fma_f32 v143, v143, v134, -v131
 v_mfma_f32_16x16x32_bf16 a[132:135], v[36:39], v[84:87], 0
 s_mov_b32 s48, 45056
 s_cmp_ge_u32 s47, 157696
 s_cselect_b32 s48, -112640, s48
 s_cselect_b32 s50, 157696, 0
 v_cvt_pk_bf16_f32 v107, v142, v143
 v_mfma_f32_16x16x32_bf16 a[132:135], v[32:35], v[68:71], a[132:135]
 s_sub_u32 s47, s47, s50
 v_lshlrev_b32 v140, 16, v108
 v_mfma_f32_16x16x32_bf16 a[136:139], v[32:35], v[72:75], 0
 ds_read_b64_tr_b16 v[52:53], v144 offset:7264
 s_add_u32 m0, s44, s3
 v_and_b32 v141, s54, v108
 v_mfma_f32_16x16x32_bf16 a[136:139], v[36:39], v[88:91], a[136:139]
 ds_read_b64_tr_b16 v[54:55], v144 offset:9056
 v_fma_f32 v140, v140, v135, -v139
 v_mfma_f32_16x16x32_bf16 a[140:143], v[36:39], v[92:95], 0
 buffer_load_dwordx4 v15, s[12:15], s40 offen  lds
 v_fma_f32 v141, v141, v135, -v139
 v_mfma_f32_16x16x32_bf16 a[140:143], v[32:35], v[76:79], a[140:143]
 s_waitcnt lgkmcnt(4)
 v_mfma_f32_16x16x32_bf16 a[156:159], v[40:43], v[76:79], 0
 ds_read_b64_tr_b16 v[56:57], v19 offset:7296
 v_cvt_pk_bf16_f32 v108, v140, v141
 v_mfma_f32_16x16x32_bf16 a[156:159], v[44:47], v[92:95], a[156:159]
 ds_read_b64_tr_b16 v[58:59], v19 offset:9088
 v_lshlrev_b32 v142, 16, v109
 v_mfma_f32_16x16x32_bf16 a[152:155], v[44:47], v[88:91], 0
 buffer_load_dwordx4 v16, s[12:15], s40 offen offset:1024  lds
 v_and_b32 v143, s54, v109
 v_mfma_f32_16x16x32_bf16 a[152:155], v[40:43], v[72:75], a[152:155]
 v_fma_f32 v142, v142, v135, -v139
 v_mfma_f32_16x16x32_bf16 a[148:151], v[40:43], v[68:71], 0
 ds_read_b64_tr_b16 v[60:61], v144 offset:7296
 v_fma_f32 v143, v143, v135, -v139
 v_mfma_f32_16x16x32_bf16 a[148:151], v[44:47], v[84:87], a[148:151]
 ds_read_b64_tr_b16 v[62:63], v144 offset:9088
 v_cvt_pk_bf16_f32 v109, v142, v143
 v_mfma_f32_16x16x32_bf16 a[144:147], v[44:47], v[80:83], 0
 v_lshlrev_b32 v140, 16, v110
 v_and_b32 v141, s54, v110
 v_mfma_f32_16x16x32_bf16 a[144:147], v[40:43], v[64:67], a[144:147]
 s_waitcnt lgkmcnt(4)
 v_mfma_f32_16x16x32_bf16 a[160:163], v[48:51], v[64:67], 0
 ds_read_b64_tr_b16 v[32:33], v19 offset:7328
 buffer_load_dwordx4 v17, s[12:15], s40 offen offset:2048  lds
 v_fma_f32 v140, v140, v135, -v139
 v_mfma_f32_16x16x32_bf16 a[160:163], v[52:55], v[80:83], a[160:163]
 ds_read_b64_tr_b16 v[34:35], v19 offset:9120
 v_fma_f32 v141, v141, v135, -v139
 v_mfma_f32_16x16x32_bf16 a[164:167], v[52:55], v[84:87], 0
 v_cvt_pk_bf16_f32 v110, v140, v141
 v_lshlrev_b32 v142, 16, v111
 v_mfma_f32_16x16x32_bf16 a[164:167], v[48:51], v[68:71], a[164:167]
 v_and_b32 v143, s54, v111
 v_mfma_f32_16x16x32_bf16 a[168:171], v[48:51], v[72:75], 0
 ds_read_b64_tr_b16 v[36:37], v144 offset:7328
 v_fma_f32 v142, v142, v135, -v139
 v_mfma_f32_16x16x32_bf16 a[168:171], v[52:55], v[88:91], a[168:171]
 ds_read_b64_tr_b16 v[38:39], v144 offset:9120
 v_fma_f32 v143, v143, v135, -v139
 v_cvt_pk_bf16_f32 v111, v142, v143
 v_mfma_f32_16x16x32_bf16 a[172:175], v[52:55], v[92:95], 0
 buffer_load_dwordx4 v18, s[12:15], s40 offen offset:3072  lds
 s_add_u32 s40, s40, 524288
 v_mfma_f32_16x16x32_bf16 a[172:175], v[48:51], v[76:79], a[172:175]
 s_waitcnt lgkmcnt(4)
 s_add_u32 s44, s44, 45056
 v_mfma_f32_16x16x32_bf16 a[188:191], v[56:59], v[76:79], 0
 ds_read_b64_tr_b16 v[40:41], v19 offset:7360
 s_cmp_ge_u32 s44, 157696
 s_cselect_b32 s50, 157696, 0
 s_sub_u32 s44, s44, s50
 v_mfma_f32_16x16x32_bf16 a[188:191], v[60:63], v[92:95], a[188:191]
 ds_read_b64_tr_b16 v[42:43], v19 offset:9152
 v_lshlrev_b32 v140, 16, v112
 v_mfma_f32_16x16x32_bf16 a[184:187], v[60:63], v[88:91], 0
 v_and_b32 v141, s54, v112
 v_fma_f32 v140, v140, v132, -v128
 v_mfma_f32_16x16x32_bf16 a[184:187], v[56:59], v[72:75], a[184:187]
 v_fma_f32 v141, v141, v132, -v128
 v_mfma_f32_16x16x32_bf16 a[180:183], v[56:59], v[68:71], 0
 ds_read_b64_tr_b16 v[44:45], v144 offset:7360
 buffer_load_dword v138, v136, s[8:11], s39 offen
 v_mfma_f32_16x16x32_bf16 a[180:183], v[60:63], v[84:87], a[180:183]
 ds_read_b64_tr_b16 v[46:47], v144 offset:9152
 buffer_load_dword v138, v137, s[12:15], s40 offen
 v_cvt_pk_bf16_f32 v112, v140, v141
 v_mfma_f32_16x16x32_bf16 a[176:179], v[60:63], v[80:83], 0
 s_add_u32 m0, s43, s49
 v_lshlrev_b32 v142, 16, v113
 v_mfma_f32_16x16x32_bf16 a[176:179], v[56:59], v[64:67], a[176:179]
 s_waitcnt lgkmcnt(4)
 buffer_load_dwordx4 v8, s[8:11], s39 offen  lds
 v_and_b32 v143, s54, v113
 v_mfma_f32_16x16x32_bf16 a[192:195], v[32:35], v[64:67], 0
 ds_read_b64_tr_b16 v[48:49], v20
 v_fma_f32 v142, v142, v132, -v128
 v_mfma_f32_16x16x32_bf16 a[192:195], v[36:39], v[80:83], a[192:195]
 ds_read_b64_tr_b16 v[50:51], v20 offset:1024
 v_fma_f32 v143, v143, v132, -v128
 v_mfma_f32_16x16x32_bf16 a[196:199], v[36:39], v[84:87], 0
 buffer_load_dwordx4 v9, s[8:11], s39 offen offset:1024  lds
 v_cvt_pk_bf16_f32 v113, v142, v143
 v_mfma_f32_16x16x32_bf16 a[196:199], v[32:35], v[68:71], a[196:199]
 v_lshlrev_b32 v140, 16, v114
 v_mfma_f32_16x16x32_bf16 a[200:203], v[32:35], v[72:75], 0
 ds_read_b64_tr_b16 v[52:53], v145
 v_and_b32 v141, s54, v114
 v_mfma_f32_16x16x32_bf16 a[200:203], v[36:39], v[88:91], a[200:203]
 ds_read_b64_tr_b16 v[54:55], v145 offset:1024
 v_fma_f32 v140, v140, v132, -v128
 v_mfma_f32_16x16x32_bf16 a[204:207], v[36:39], v[92:95], 0
 v_add_u32 v19, s46, v19
 v_fma_f32 v141, v141, v132, -v128
 v_mfma_f32_16x16x32_bf16 a[204:207], v[32:35], v[76:79], a[204:207]
 s_waitcnt lgkmcnt(4)
 v_mfma_f32_16x16x32_bf16 a[220:223], v[40:43], v[76:79], 0
 ds_read_b64_tr_b16 v[56:57], v21
 buffer_load_dwordx4 v10, s[8:11], s39 offen offset:2048  lds
 v_cvt_pk_bf16_f32 v114, v140, v141
 v_mfma_f32_16x16x32_bf16 a[220:223], v[44:47], v[92:95], a[220:223]
 ds_read_b64_tr_b16 v[58:59], v21 offset:1024
 v_lshlrev_b32 v142, 16, v115
 v_mfma_f32_16x16x32_bf16 a[216:219], v[44:47], v[88:91], 0
 v_add_u32 v144, s48, v144
 v_and_b32 v143, s54, v115
 v_mfma_f32_16x16x32_bf16 a[216:219], v[40:43], v[72:75], a[216:219]
 v_fma_f32 v142, v142, v132, -v128
 v_mfma_f32_16x16x32_bf16 a[212:215], v[40:43], v[68:71], 0
 ds_read_b64_tr_b16 v[60:61], v146
 v_fma_f32 v143, v143, v132, -v128
 v_mfma_f32_16x16x32_bf16 a[212:215], v[44:47], v[84:87], a[212:215]
 ds_read_b64_tr_b16 v[62:63], v146 offset:1024
 v_cvt_pk_bf16_f32 v115, v142, v143
 v_mfma_f32_16x16x32_bf16 a[208:211], v[44:47], v[80:83], 0
 buffer_load_dwordx4 v11, s[8:11], s39 offen offset:3072  lds
 v_lshlrev_b32 v140, 16, v116
 v_mfma_f32_16x16x32_bf16 a[208:211], v[40:43], v[64:67], a[208:211]
 s_waitcnt lgkmcnt(4)
 v_and_b32 v141, s54, v116
 v_mfma_f32_16x16x32_bf16 a[224:227], v[48:51], v[64:67], 0
 ds_read_b64_tr_b16 v[32:33], v22
 v_fma_f32 v140, v140, v133, -v130
 v_mfma_f32_16x16x32_bf16 a[224:227], v[52:55], v[80:83], a[224:227]
 ds_read_b64_tr_b16 v[34:35], v22 offset:1024
 v_fma_f32 v141, v141, v133, -v130
 v_mfma_f32_16x16x32_bf16 a[228:231], v[52:55], v[84:87], 0
 v_cvt_pk_bf16_f32 v116, v140, v141
 v_lshlrev_b32 v142, 16, v117
 v_mfma_f32_16x16x32_bf16 a[228:231], v[48:51], v[68:71], a[228:231]
 v_and_b32 v143, s54, v117
 v_mfma_f32_16x16x32_bf16 a[232:235], v[48:51], v[72:75], 0
 ds_read_b64_tr_b16 v[36:37], v147
 s_add_u32 m0, m0, 4096
 v_mfma_f32_16x16x32_bf16 a[232:235], v[52:55], v[88:91], a[232:235]
 ds_read_b64_tr_b16 v[38:39], v147 offset:1024
 v_fma_f32 v142, v142, v133, -v130
 v_mfma_f32_16x16x32_bf16 a[236:239], v[52:55], v[92:95], 0
 buffer_load_dwordx4 v12, s[8:11], s39 offen  lds
 v_fma_f32 v143, v143, v133, -v130
 v_mfma_f32_16x16x32_bf16 a[236:239], v[48:51], v[76:79], a[236:239]
 s_waitcnt lgkmcnt(4)
 v_mfma_f32_16x16x32_bf16 a[252:255], v[56:59], v[76:79], 0
 ds_read_b64_tr_b16 v[40:41], v23
 buffer_load_dwordx2 v[28:29], v30, s[56:59], 0 offen sc1
 v_cvt_pk_bf16_f32 v117, v142, v143
 v_mfma_f32_16x16x32_bf16 a[252:255], v[60:63], v[92:95], a[252:255]
 ds_read_b64_tr_b16 v[42:43], v23 offset:1024
 v_lshlrev_b32 v140, 16, v118
 v_mfma_f32_16x16x32_bf16 a[248:251], v[60:63], v[88:91], 0
 buffer_load_dwordx4 v13, s[8:11], s39 offen offset:1024  lds
 v_and_b32 v141, s54, v118
 v_mfma_f32_16x16x32_bf16 a[248:251], v[56:59], v[72:75], a[248:251]
 v_fma_f32 v140, v140, v133, -v130
 v_mfma_f32_16x16x32_bf16 a[244:247], v[56:59], v[68:71], 0
 ds_read_b64_tr_b16 v[44:45], v148
 v_fma_f32 v141, v141, v133, -v130
 v_mfma_f32_16x16x32_bf16 a[244:247], v[60:63], v[84:87], a[244:247]
 ds_read_b64_tr_b16 v[46:47], v148 offset:1024
 v_cvt_pk_bf16_f32 v118, v140, v141
 v_mfma_f32_16x16x32_bf16 a[240:243], v[60:63], v[80:83], 0
 v_lshlrev_b32 v142, 16, v119
 v_and_b32 v143, s54, v119
 v_mfma_f32_16x16x32_bf16 a[240:243], v[56:59], v[64:67], a[240:243]
 s_waitcnt lgkmcnt(4)
 v_mfma_f32_16x16x32_bf16 v[160:163], v[32:35], v[64:67], 0
 ds_read_b64_tr_b16 v[48:49], v24
 buffer_load_dwordx4 v14, s[8:11], s39 offen offset:2048  lds
 v_fma_f32 v142, v142, v133, -v130
 v_mfma_f32_16x16x32_bf16 v[160:163], v[36:39], v[80:83], v[160:163]
 ds_read_b64_tr_b16 v[50:51], v24 offset:1024
 s_add_u32 s39, s39, 458752
 v_mfma_f32_16x16x32_bf16 v[164:167], v[36:39], v[84:87], 0
 s_add_u32 s43, s43, 45056
 s_cmp_ge_u32 s43, 157696
 s_cselect_b32 s50, 157696, 0
 s_sub_u32 s43, s43, s50
 v_fma_f32 v143, v143, v133, -v130
 v_mfma_f32_16x16x32_bf16 v[164:167], v[32:35], v[68:71], v[164:167]
 v_cvt_pk_bf16_f32 v119, v142, v143
 v_mfma_f32_16x16x32_bf16 v[168:171], v[32:35], v[72:75], 0
 ds_read_b64_tr_b16 v[52:53], v149
 v_lshlrev_b32 v140, 16, v120
 v_mfma_f32_16x16x32_bf16 v[168:171], v[36:39], v[88:91], v[168:171]
 ds_read_b64_tr_b16 v[54:55], v149 offset:1024
 v_and_b32 v141, s54, v120
 v_mfma_f32_16x16x32_bf16 v[172:175], v[36:39], v[92:95], 0
 s_add_u32 m0, s44, s3
 v_fma_f32 v140, v140, v134, -v131
 v_mfma_f32_16x16x32_bf16 v[172:175], v[32:35], v[76:79], v[172:175]
 s_waitcnt lgkmcnt(4)
 buffer_load_dwordx4 v15, s[12:15], s40 offen  lds
 v_fma_f32 v141, v141, v134, -v131
 v_mfma_f32_16x16x32_bf16 v[188:191], v[40:43], v[76:79], 0
 ds_read_b64_tr_b16 v[56:57], v25
 v_cvt_pk_bf16_f32 v120, v140, v141
 v_mfma_f32_16x16x32_bf16 v[188:191], v[44:47], v[92:95], v[188:191]
 ds_read_b64_tr_b16 v[58:59], v25 offset:1024
 v_lshlrev_b32 v142, 16, v121
 v_mfma_f32_16x16x32_bf16 v[184:187], v[44:47], v[88:91], 0
 v_and_b32 v143, s54, v121
 v_fma_f32 v142, v142, v134, -v131
 v_mfma_f32_16x16x32_bf16 v[184:187], v[40:43], v[72:75], v[184:187]
 v_fma_f32 v143, v143, v134, -v131
 v_mfma_f32_16x16x32_bf16 v[180:183], v[40:43], v[68:71], 0
 ds_read_b64_tr_b16 v[60:61], v150
 buffer_load_dwordx4 v16, s[12:15], s40 offen offset:1024  lds
 v_mfma_f32_16x16x32_bf16 v[180:183], v[44:47], v[84:87], v[180:183]
 ds_read_b64_tr_b16 v[62:63], v150 offset:1024
 v_cvt_pk_bf16_f32 v121, v142, v143
 v_mfma_f32_16x16x32_bf16 v[176:179], v[44:47], v[80:83], 0
 v_lshlrev_b32 v140, 16, v122
 v_and_b32 v141, s54, v122
 v_mfma_f32_16x16x32_bf16 v[176:179], v[40:43], v[64:67], v[176:179]
 s_waitcnt lgkmcnt(4)
 v_mfma_f32_16x16x32_bf16 v[192:195], v[48:51], v[64:67], 0
 ds_read_b64_tr_b16 v[32:33], v26
 v_fma_f32 v140, v140, v134, -v131
 v_mfma_f32_16x16x32_bf16 v[192:195], v[52:55], v[80:83], v[192:195]
 ds_read_b64_tr_b16 v[34:35], v26 offset:1024
 v_fma_f32 v141, v141, v134, -v131
 v_mfma_f32_16x16x32_bf16 v[196:199], v[52:55], v[84:87], 0
 buffer_load_dwordx4 v17, s[12:15], s40 offen offset:2048  lds
 v_cvt_pk_bf16_f32 v122, v140, v141
 v_mfma_f32_16x16x32_bf16 v[196:199], v[48:51], v[68:71], v[196:199]
 v_lshlrev_b32 v142, 16, v123
 v_mfma_f32_16x16x32_bf16 v[200:203], v[48:51], v[72:75], 0
 ds_read_b64_tr_b16 v[40:41], v27
 v_and_b32 v143, s54, v123
 v_mfma_f32_16x16x32_bf16 v[200:203], v[52:55], v[88:91], v[200:203]
 ds_read_b64_tr_b16 v[42:43], v27 offset:1024
 v_fma_f32 v142, v142, v134, -v131
 v_mfma_f32_16x16x32_bf16 v[204:207], v[52:55], v[92:95], 0
 v_fma_f32 v143, v143, v134, -v131
 v_cvt_pk_bf16_f32 v123, v142, v143
 v_mfma_f32_16x16x32_bf16 v[204:207], v[48:51], v[76:79], v[204:207]
 s_waitcnt lgkmcnt(4)
 v_mfma_f32_16x16x32_bf16 v[220:223], v[56:59], v[76:79], 0
 ds_read_b64_tr_b16 v[36:37], v151
 buffer_load_dwordx4 v18, s[12:15], s40 offen offset:3072  lds
 v_mfma_f32_16x16x32_bf16 v[220:223], v[60:63], v[92:95], v[220:223]
 ds_read_b64_tr_b16 v[38:39], v151 offset:1024
 s_add_u32 s40, s40, 524288
 v_lshlrev_b32 v140, 16, v124
 v_mfma_f32_16x16x32_bf16 v[216:219], v[60:63], v[88:91], 0
 s_add_u32 s44, s44, 45056
 s_cmp_ge_u32 s44, 157696
 s_cselect_b32 s50, 157696, 0
 s_sub_u32 s44, s44, s50
 v_and_b32 v141, s54, v124
 v_mfma_f32_16x16x32_bf16 v[216:219], v[56:59], v[72:75], v[216:219]
 buffer_load_dword v138, v0, s[60:63], 0 offen
 v_fma_f32 v140, v140, v135, -v139
 v_mfma_f32_16x16x32_bf16 v[212:215], v[56:59], v[68:71], 0
 ds_read_b64_tr_b16 v[44:45], v152
 v_fma_f32 v141, v141, v135, -v139
 v_mfma_f32_16x16x32_bf16 v[212:215], v[60:63], v[84:87], v[212:215]
 ds_read_b64_tr_b16 v[46:47], v152 offset:1024
 v_cvt_pk_bf16_f32 v124, v140, v141
 v_mfma_f32_16x16x32_bf16 v[208:211], v[60:63], v[80:83], 0
 v_lshlrev_b32 v142, 16, v125
 v_and_b32 v143, s54, v125
 v_mfma_f32_16x16x32_bf16 v[208:211], v[56:59], v[64:67], v[208:211]
 s_waitcnt lgkmcnt(2)
 s_waitcnt vmcnt(15)
 s_barrier
 v_mfma_f32_16x16x32_bf16 v[224:227], v[32:35], v[64:67], 0
 ds_read_b64_tr_b16 v[48:49], v19
 v_fma_f32 v142, v142, v135, -v139
 v_mfma_f32_16x16x32_bf16 v[224:227], v[36:39], v[80:83], v[224:227]
 ds_read_b64_tr_b16 v[50:51], v19 offset:1792
 v_fma_f32 v143, v143, v135, -v139
 v_mfma_f32_16x16x32_bf16 v[228:231], v[36:39], v[84:87], 0
 v_cvt_pk_bf16_f32 v125, v142, v143
 v_lshlrev_b32 v140, 16, v126
 v_mfma_f32_16x16x32_bf16 v[228:231], v[32:35], v[68:71], v[228:231]
 v_and_b32 v141, s54, v126
 v_mfma_f32_16x16x32_bf16 v[232:235], v[32:35], v[72:75], 0
 ds_read_b64_tr_b16 v[52:53], v144
 v_fma_f32 v140, v140, v135, -v139
 v_mfma_f32_16x16x32_bf16 v[232:235], v[36:39], v[88:91], v[232:235]
 ds_read_b64_tr_b16 v[54:55], v144 offset:1792
 v_fma_f32 v141, v141, v135, -v139
 v_mfma_f32_16x16x32_bf16 v[236:239], v[36:39], v[92:95], 0
 v_cvt_pk_bf16_f32 v126, v140, v141
 v_lshlrev_b32 v142, 16, v127
 v_mfma_f32_16x16x32_bf16 v[236:239], v[32:35], v[76:79], v[236:239]
 s_waitcnt lgkmcnt(4)
 v_mfma_f32_16x16x32_bf16 v[252:255], v[40:43], v[76:79], 0
 ds_read_b64_tr_b16 v[56:57], v19 offset:32
 v_add_u32 v20, s46, v20
 v_mfma_f32_16x16x32_bf16 v[252:255], v[44:47], v[92:95], v[252:255]
 ds_read_b64_tr_b16 v[58:59], v19 offset:1824
 v_and_b32 v143, s54, v127
 v_mfma_f32_16x16x32_bf16 v[248:251], v[44:47], v[88:91], 0
 v_fma_f32 v142, v142, v135, -v139
 v_fma_f32 v143, v143, v135, -v139
 v_mfma_f32_16x16x32_bf16 v[248:251], v[40:43], v[72:75], v[248:251]
 v_cvt_pk_bf16_f32 v127, v142, v143
 v_mfma_f32_16x16x32_bf16 v[244:247], v[40:43], v[68:71], 0
 ds_read_b64_tr_b16 v[60:61], v144 offset:32
 v_add_u32 v21, s46, v21
 v_mfma_f32_16x16x32_bf16 v[244:247], v[44:47], v[84:87], v[244:247]
 ds_read_b64_tr_b16 v[62:63], v144 offset:1824
 v_mfma_f32_16x16x32_bf16 v[240:243], v[44:47], v[80:83], 0
 v_mfma_f32_16x16x32_bf16 v[240:243], v[40:43], v[64:67], v[240:243]
 s_waitcnt lgkmcnt(4)
 v_mfma_f32_16x16x32_bf16 a[0:3], v[48:51], v[96:99], a[0:3]
 ds_read_b64_tr_b16 v[32:33], v19 offset:64
 v_add_u32 v22, s46, v22
 v_mfma_f32_16x16x32_bf16 a[0:3], v[52:55], v[112:115], a[0:3]
 ds_read_b64_tr_b16 v[34:35], v19 offset:1856
 v_mfma_f32_16x16x32_bf16 a[4:7], v[52:55], v[116:119], a[4:7]
 v_mfma_f32_16x16x32_bf16 a[4:7], v[48:51], v[100:103], a[4:7]
 v_mfma_f32_16x16x32_bf16 a[8:11], v[48:51], v[104:107], a[8:11]
 ds_read_b64_tr_b16 v[36:37], v144 offset:64
 s_waitcnt vmcnt(7)
 v_cmp_ne_u64 vcc, s[6:7], v[28:29]
 s_nop 0
 s_nop 0
 s_cbranch_vccz L_x_ok
L_x_spin:
 s_sleep 4
 buffer_load_dwordx2 v[28:29], v30, s[56:59], 0 offen sc1
 s_waitcnt vmcnt(0)
 v_cmp_ne_u64 vcc, s[6:7], v[28:29]
 s_nop 1
 s_cbranch_vccnz L_x_spin
L_x_ok:
 v_mfma_f32_16x16x32_bf16 a[8:11], v[52:55], v[120:123], a[8:11]
 ds_read_b64_tr_b16 v[38:39], v144 offset:1856
 v_add_u32 v23, s46, v23
 v_mfma_f32_16x16x32_bf16 a[12:15], v[52:55], v[124:127], a[12:15]
 v_mfma_f32_16x16x32_bf16 a[12:15], v[48:51], v[108:111], a[12:15]
 s_waitcnt lgkmcnt(4)
 v_mfma_f32_16x16x32_bf16 a[28:31], v[56:59], v[108:111], a[28:31]
 ds_read_b64_tr_b16 v[40:41], v19 offset:96
 buffer_load_dwordx4 v[64:67], v4, s[16:19], s41 offen sc1
 v_mfma_f32_16x16x32_bf16 a[28:31], v[60:63], v[124:127], a[28:31]
 ds_read_b64_tr_b16 v[42:43], v19 offset:1888
 v_add_u32 v24, s46, v24
 v_mfma_f32_16x16x32_bf16 a[24:27], v[60:63], v[120:123], a[24:27]
 v_mfma_f32_16x16x32_bf16 a[24:27], v[56:59], v[104:107], a[24:27]
 v_mfma_f32_16x16x32_bf16 a[20:23], v[56:59], v[100:103], a[20:23]
 ds_read_b64_tr_b16 v[44:45], v144 offset:96
 v_add_u32 v25, s46, v25
 v_mfma_f32_16x16x32_bf16 a[20:23], v[60:63], v[116:119], a[20:23]
 ds_read_b64_tr_b16 v[46:47], v144 offset:1888
 v_mfma_f32_16x16x32_bf16 a[16:19], v[60:63], v[112:115], a[16:19]
 v_mfma_f32_16x16x32_bf16 a[16:19], v[56:59], v[96:99], a[16:19]
 s_waitcnt lgkmcnt(4)
 v_mfma_f32_16x16x32_bf16 a[32:35], v[32:35], v[96:99], a[32:35]
 ds_read_b64_tr_b16 v[48:49], v19 offset:128
 buffer_load_dwordx4 v[68:71], v5, s[16:19], s41 offen sc1
 v_mfma_f32_16x16x32_bf16 a[32:35], v[36:39], v[112:115], a[32:35]
 ds_read_b64_tr_b16 v[50:51], v19 offset:1920
 v_add_u32 v26, s46, v26
 v_mfma_f32_16x16x32_bf16 a[36:39], v[36:39], v[116:119], a[36:39]
 v_mfma_f32_16x16x32_bf16 a[36:39], v[32:35], v[100:103], a[36:39]
 v_mfma_f32_16x16x32_bf16 a[40:43], v[32:35], v[104:107], a[40:43]
 ds_read_b64_tr_b16 v[52:53], v144 offset:128
 v_add_u32 v27, s46, v27
 v_mfma_f32_16x16x32_bf16 a[40:43], v[36:39], v[120:123], a[40:43]
 ds_read_b64_tr_b16 v[54:55], v144 offset:1920
 v_mfma_f32_16x16x32_bf16 a[44:47], v[36:39], v[124:127], a[44:47]
 v_mfma_f32_16x16x32_bf16 a[44:47], v[32:35], v[108:111], a[44:47]
 s_waitcnt lgkmcnt(4)
 v_mfma_f32_16x16x32_bf16 a[60:63], v[40:43], v[108:111], a[60:63]
 ds_read_b64_tr_b16 v[56:57], v19 offset:160
 buffer_load_dwordx4 v[72:75], v6, s[16:19], s41 offen sc1
 v_mfma_f32_16x16x32_bf16 a[60:63], v[44:47], v[124:127], a[60:63]
 ds_read_b64_tr_b16 v[58:59], v19 offset:1952
 v_add_u32 v145, s48, v145
 v_mfma_f32_16x16x32_bf16 a[56:59], v[44:47], v[120:123], a[56:59]
 v_mfma_f32_16x16x32_bf16 a[56:59], v[40:43], v[104:107], a[56:59]
 v_mfma_f32_16x16x32_bf16 a[52:55], v[40:43], v[100:103], a[52:55]
 ds_read_b64_tr_b16 v[60:61], v144 offset:160
 v_add_u32 v146, s48, v146
 v_mfma_f32_16x16x32_bf16 a[52:55], v[44:47], v[116:119], a[52:55]
 ds_read_b64_tr_b16 v[62:63], v144 offset:1952
 v_mfma_f32_16x16x32_bf16 a[48:51], v[44:47], v[112:115], a[48:51]
 v_mfma_f32_16x16x32_bf16 a[48:51], v[40:43], v[96:99], a[48:51]
 s_waitcnt lgkmcnt(4)
 v_mfma_f32_16x16x32_bf16 a[64:67], v[48:51], v[96:99], a[64:67]
 ds_read_b64_tr_b16 v[32:33], v19 offset:192
 buffer_load_dwordx4 v[76:79], v7, s[16:19], s41 offen sc1
 v_mfma_f32_16x16x32_bf16 a[64:67], v[52:55], v[112:115], a[64:67]
 ds_read_b64_tr_b16 v[34:35], v19 offset:1984
 v_add_u32 v147, s48, v147
 v_mfma_f32_16x16x32_bf16 a[68:71], v[52:55], v[116:119], a[68:71]
 buffer_load_dword v138, v136, s[8:11], s39 offen
 buffer_load_dword v138, v137, s[12:15], s40 offen
 v_mfma_f32_16x16x32_bf16 a[68:71], v[48:51], v[100:103], a[68:71]
 s_add_u32 m0, s43, s49
 v_mfma_f32_16x16x32_bf16 a[72:75], v[48:51], v[104:107], a[72:75]
 ds_read_b64_tr_b16 v[36:37], v144 offset:192
 buffer_load_dwordx4 v8, s[8:11], s39 offen  lds
 v_mfma_f32_16x16x32_bf16 a[72:75], v[52:55], v[120:123], a[72:75]
 ds_read_b64_tr_b16 v[38:39], v144 offset:1984
 v_add_u32 v148, s48, v148
 v_mfma_f32_16x16x32_bf16 a[76:79], v[52:55], v[124:127], a[76:79]
 v_mfma_f32_16x16x32_bf16 a[76:79], v[48:51], v[108:111], a[76:79]
 s_waitcnt lgkmcnt(4)
 v_mfma_f32_16x16x32_bf16 a[92:95], v[56:59], v[108:111], a[92:95]
 ds_read_b64_tr_b16 v[40:41], v19 offset:7168
 buffer_load_dwordx4 v[80:83], v4, s[16:19], s41 offen offset:1024 sc1
 v_mfma_f32_16x16x32_bf16 a[92:95], v[60:63], v[124:127], a[92:95]
 ds_read_b64_tr_b16 v[42:43], v19 offset:8960
 v_add_u32 v149, s48, v149
 v_mfma_f32_16x16x32_bf16 a[88:91], v[60:63], v[120:123], a[88:91]
 v_mfma_f32_16x16x32_bf16 a[88:91], v[56:59], v[104:107], a[88:91]
 v_mfma_f32_16x16x32_bf16 a[84:87], v[56:59], v[100:103], a[84:87]
 ds_read_b64_tr_b16 v[44:45], v144 offset:7168
 v_add_u32 v150, s48, v150
 v_mfma_f32_16x16x32_bf16 a[84:87], v[60:63], v[116:119], a[84:87]
 ds_read_b64_tr_b16 v[46:47], v144 offset:8960
 buffer_load_dwordx4 v9, s[8:11], s39 offen offset:1024  lds
 v_mfma_f32_16x16x32_bf16 a[80:83], v[60:63], v[112:115], a[80:83]
 v_mfma_f32_16x16x32_bf16 a[80:83], v[56:59], v[96:99], a[80:83]
 s_waitcnt lgkmcnt(4)
 v_mfma_f32_16x16x32_bf16 a[96:99], v[32:35], v[96:99], a[96:99]
 ds_read_b64_tr_b16 v[48:49], v19 offset:7200
 buffer_load_dwordx4 v[84:87], v5, s[16:19], s41 offen offset:1024 sc1
 v_mfma_f32_16x16x32_bf16 a[96:99], v[36:39], v[112:115], a[96:99]
 ds_read_b64_tr_b16 v[50:51], v19 offset:8992
 v_add_u32 v151, s48, v151
 v_mfma_f32_16x16x32_bf16 a[100:103], v[36:39], v[116:119], a[100:103]
 v_mfma_f32_16x16x32_bf16 a[100:103], v[32:35], v[100:103], a[100:103]
 v_mfma_f32_16x16x32_bf16 a[104:107], v[32:35], v[104:107], a[104:107]
 ds_read_b64_tr_b16 v[52:53], v144 offset:7200
 v_add_u32 v152, s48, v152
 v_mfma_f32_16x16x32_bf16 a[104:107], v[36:39], v[120:123], a[104:107]
 ds_read_b64_tr_b16 v[54:55], v144 offset:8992
 v_mfma_f32_16x16x32_bf16 a[108:111], v[36:39], v[124:127], a[108:111]
 v_mfma_f32_16x16x32_bf16 a[108:111], v[32:35], v[108:111], a[108:111]
 s_waitcnt lgkmcnt(4)
 v_mfma_f32_16x16x32_bf16 a[124:127], v[40:43], v[108:111], a[124:127]
 ds_read_b64_tr_b16 v[56:57], v19 offset:7232
 buffer_load_dwordx4 v[88:91], v6, s[16:19], s41 offen offset:1024 sc1
 v_mfma_f32_16x16x32_bf16 a[124:127], v[44:47], v[124:127], a[124:127]
 ds_read_b64_tr_b16 v[58:59], v19 offset:9024
 s_add_u32 s45, s45, 45056
 v_mfma_f32_16x16x32_bf16 a[120:123], v[44:47], v[120:123], a[120:123]
 s_mov_b32 s46, 45056
 s_cmp_ge_u32 s45, 157696
 s_cselect_b32 s46, -112640, s46
 s_cselect_b32 s50, 157696, 0
 v_mfma_f32_16x16x32_bf16 a[120:123], v[40:43], v[104:107], a[120:123]
 s_sub_u32 s45, s45, s50
 buffer_load_dwordx4 v10, s[8:11], s39 offen offset:2048  lds
 v_mfma_f32_16x16x32_bf16 a[116:119], v[40:43], v[100:103], a[116:119]
 ds_read_b64_tr_b16 v[60:61], v144 offset:7232
 v_mfma_f32_16x16x32_bf16 a[116:119], v[44:47], v[116:119], a[116:119]
 ds_read_b64_tr_b16 v[62:63], v144 offset:9024
 v_mfma_f32_16x16x32_bf16 a[112:115], v[44:47], v[112:115], a[112:115]
 v_mfma_f32_16x16x32_bf16 a[112:115], v[40:43], v[96:99], a[112:115]
 s_waitcnt lgkmcnt(4)
 v_mfma_f32_16x16x32_bf16 a[128:131], v[48:51], v[96:99], a[128:131]
 ds_read_b64_tr_b16 v[32:33], v19 offset:7264
 buffer_load_dwordx4 v[92:95], v7, s[16:19], s41 offen offset:1024 sc1
 v_mfma_f32_16x16x32_bf16 a[128:131], v[52:55], v[112:115], a[128:131]
 ds_read_b64_tr_b16 v[34:35], v19 offset:9056
 s_add_u32 s41, s41, 2048
 v_mfma_f32_16x16x32_bf16 a[132:135], v[52:55], v[116:119], a[132:135]
 s_cmp_eq_u32 s41, 32768
 s_cselect_b32 s18, 0, s18
 s_add_u32 s47, s47, 45056
 v_mfma_f32_16x16x32_bf16 a[132:135], v[48:51], v[100:103], a[132:135]
 s_mov_b32 s48, 45056
 s_cmp_ge_u32 s47, 157696
 s_cselect_b32 s48, -112640, s48
 s_cselect_b32 s50, 157696, 0
 v_mfma_f32_16x16x32_bf16 a[136:139], v[48:51], v[104:107], a[136:139]
 ds_read_b64_tr_b16 v[36:37], v144 offset:7264
 s_sub_u32 s47, s47, s50
 v_mfma_f32_16x16x32_bf16 a[136:139], v[52:55], v[120:123], a[136:139]
 ds_read_b64_tr_b16 v[38:39], v144 offset:9056
 buffer_load_dwordx4 v11, s[8:11], s39 offen offset:3072  lds
 v_mfma_f32_16x16x32_bf16 a[140:143], v[52:55], v[124:127], a[140:143]
 v_mfma_f32_16x16x32_bf16 a[140:143], v[48:51], v[108:111], a[140:143]
 s_waitcnt lgkmcnt(4)
 v_mfma_f32_16x16x32_bf16 a[156:159], v[56:59], v[108:111], a[156:159]
 ds_read_b64_tr_b16 v[40:41], v19 offset:7296
 v_mfma_f32_16x16x32_bf16 a[156:159], v[60:63], v[124:127], a[156:159]
 ds_read_b64_tr_b16 v[42:43], v19 offset:9088
 v_mfma_f32_16x16x32_bf16 a[152:155], v[60:63], v[120:123], a[152:155]
 v_mfma_f32_16x16x32_bf16 a[152:155], v[56:59], v[104:107], a[152:155]
 v_mfma_f32_16x16x32_bf16 a[148:151], v[56:59], v[100:103], a[148:151]
 ds_read_b64_tr_b16 v[44:45], v144 offset:7296
 v_mfma_f32_16x16x32_bf16 a[148:151], v[60:63], v[116:119], a[148:151]
 ds_read_b64_tr_b16 v[46:47], v144 offset:9088
 v_mfma_f32_16x16x32_bf16 a[144:147], v[60:63], v[112:115], a[144:147]
 v_mfma_f32_16x16x32_bf16 a[144:147], v[56:59], v[96:99], a[144:147]
 s_waitcnt lgkmcnt(4)
 v_mfma_f32_16x16x32_bf16 a[160:163], v[32:35], v[96:99], a[160:163]
 ds_read_b64_tr_b16 v[48:49], v19 offset:7328
 s_add_u32 m0, m0, 4096
 v_mfma_f32_16x16x32_bf16 a[160:163], v[36:39], v[112:115], a[160:163]
 ds_read_b64_tr_b16 v[50:51], v19 offset:9120
 v_mfma_f32_16x16x32_bf16 a[164:167], v[36:39], v[116:119], a[164:167]
 buffer_load_dwordx4 v12, s[8:11], s39 offen  lds
 v_mfma_f32_16x16x32_bf16 a[164:167], v[32:35], v[100:103], a[164:167]
 v_mfma_f32_16x16x32_bf16 a[168:171], v[32:35], v[104:107], a[168:171]
 ds_read_b64_tr_b16 v[52:53], v144 offset:7328
 v_mfma_f32_16x16x32_bf16 a[168:171], v[36:39], v[120:123], a[168:171]
 ds_read_b64_tr_b16 v[54:55], v144 offset:9120
 v_mfma_f32_16x16x32_bf16 a[172:175], v[36:39], v[124:127], a[172:175]
 v_mfma_f32_16x16x32_bf16 a[172:175], v[32:35], v[108:111], a[172:175]
 s_waitcnt lgkmcnt(4)
 v_mfma_f32_16x16x32_bf16 a[188:191], v[40:43], v[108:111], a[188:191]
 ds_read_b64_tr_b16 v[56:57], v19 offset:7360
 v_mfma_f32_16x16x32_bf16 a[188:191], v[44:47], v[124:127], a[188:191]
 ds_read_b64_tr_b16 v[58:59], v19 offset:9152
 v_mfma_f32_16x16x32_bf16 a[184:187], v[44:47], v[120:123], a[184:187]
 v_mfma_f32_16x16x32_bf16 a[184:187], v[40:43], v[104:107], a[184:187]
 v_mfma_f32_16x16x32_bf16 a[180:183], v[40:43], v[100:103], a[180:183]
 ds_read_b64_tr_b16 v[60:61], v144 offset:7360
 buffer_load_dwordx4 v13, s[8:11], s39 offen offset:1024  lds
 v_mfma_f32_16x16x32_bf16 a[180:183], v[44:47], v[116:119], a[180:183]
 ds_read_b64_tr_b16 v[62:63], v144 offset:9152
 v_mfma_f32_16x16x32_bf16 a[176:179], v[44:47], v[112:115], a[176:179]
 v_mfma_f32_16x16x32_bf16 a[176:179], v[40:43], v[96:99], a[176:179]
 s_waitcnt lgkmcnt(4)
 v_mfma_f32_16x16x32_bf16 a[192:195], v[48:51], v[96:99], a[192:195]
 ds_read_b64_tr_b16 v[32:33], v20
 v_mfma_f32_16x16x32_bf16 a[192:195], v[52:55], v[112:115], a[192:195]
 ds_read_b64_tr_b16 v[34:35], v20 offset:1024
 v_mfma_f32_16x16x32_bf16 a[196:199], v[52:55], v[116:119], a[196:199]
 v_mfma_f32_16x16x32_bf16 a[196:199], v[48:51], v[100:103], a[196:199]
 v_mfma_f32_16x16x32_bf16 a[200:203], v[48:51], v[104:107], a[200:203]
 ds_read_b64_tr_b16 v[36:37], v145
 v_mfma_f32_16x16x32_bf16 a[200:203], v[52:55], v[120:123], a[200:203]
 ds_read_b64_tr_b16 v[38:39], v145 offset:1024
 v_mfma_f32_16x16x32_bf16 a[204:207], v[52:55], v[124:127], a[204:207]
 v_add_u32 v19, s46, v19
 v_mfma_f32_16x16x32_bf16 a[204:207], v[48:51], v[108:111], a[204:207]
 s_waitcnt lgkmcnt(4)
 v_mfma_f32_16x16x32_bf16 a[220:223], v[56:59], v[108:111], a[220:223]
 ds_read_b64_tr_b16 v[40:41], v21
 buffer_load_dwordx4 v14, s[8:11], s39 offen offset:2048  lds
 v_mfma_f32_16x16x32_bf16 a[220:223], v[60:63], v[124:127], a[220:223]
 ds_read_b64_tr_b16 v[42:43], v21 offset:1024
 s_add_u32 s39, s39, 458752
 v_mfma_f32_16x16x32_bf16 a[216:219], v[60:63], v[120:123], a[216:219]
 s_add_u32 s43, s43, 45056
 v_add_u32 v144, s48, v144
 v_mfma_f32_16x16x32_bf16 a[216:219], v[56:59], v[104:107], a[216:219]
 s_cmp_ge_u32 s43, 157696
 s_cselect_b32 s50, 157696, 0
 s_sub_u32 s43, s43, s50
 v_mfma_f32_16x16x32_bf16 a[212:215], v[56:59], v[100:103], a[212:215]
 ds_read_b64_tr_b16 v[44:45], v146
 v_mfma_f32_16x16x32_bf16 a[212:215], v[60:63], v[116:119], a[212:215]
 ds_read_b64_tr_b16 v[46:47], v146 offset:1024
 v_mfma_f32_16x16x32_bf16 a[208:211], v[60:63], v[112:115], a[208:211]
 v_mfma_f32_16x16x32_bf16 a[208:211], v[56:59], v[96:99], a[208:211]
 s_waitcnt lgkmcnt(4)
 v_mfma_f32_16x16x32_bf16 a[224:227], v[32:35], v[96:99], a[224:227]
 ds_read_b64_tr_b16 v[48:49], v22
 v_mfma_f32_16x16x32_bf16 a[224:227], v[36:39], v[112:115], a[224:227]
 ds_read_b64_tr_b16 v[50:51], v22 offset:1024
 v_mfma_f32_16x16x32_bf16 a[228:231], v[36:39], v[116:119], a[228:231]
 v_mfma_f32_16x16x32_bf16 a[228:231], v[32:35], v[100:103], a[228:231]
 v_mfma_f32_16x16x32_bf16 a[232:235], v[32:35], v[104:107], a[232:235]
 ds_read_b64_tr_b16 v[52:53], v147
 s_add_u32 m0, s44, s3
 v_mfma_f32_16x16x32_bf16 a[232:235], v[36:39], v[120:123], a[232:235]
 ds_read_b64_tr_b16 v[54:55], v147 offset:1024
 v_mfma_f32_16x16x32_bf16 a[236:239], v[36:39], v[124:127], a[236:239]
 buffer_load_dwordx4 v15, s[12:15], s40 offen  lds
 v_mfma_f32_16x16x32_bf16 a[236:239], v[32:35], v[108:111], a[236:239]
 s_waitcnt lgkmcnt(4)
 v_mfma_f32_16x16x32_bf16 a[252:255], v[40:43], v[108:111], a[252:255]
 ds_read_b64_tr_b16 v[56:57], v23
 v_mfma_f32_16x16x32_bf16 a[252:255], v[44:47], v[124:127], a[252:255]
 ds_read_b64_tr_b16 v[58:59], v23 offset:1024
 v_mfma_f32_16x16x32_bf16 a[248:251], v[44:47], v[120:123], a[248:251]
 v_mfma_f32_16x16x32_bf16 a[248:251], v[40:43], v[104:107], a[248:251]
 v_mfma_f32_16x16x32_bf16 a[244:247], v[40:43], v[100:103], a[244:247]
 ds_read_b64_tr_b16 v[60:61], v148
 v_mfma_f32_16x16x32_bf16 a[244:247], v[44:47], v[116:119], a[244:247]
 ds_read_b64_tr_b16 v[62:63], v148 offset:1024
 v_mfma_f32_16x16x32_bf16 a[240:243], v[44:47], v[112:115], a[240:243]
 v_mfma_f32_16x16x32_bf16 a[240:243], v[40:43], v[96:99], a[240:243]
 s_waitcnt lgkmcnt(4)
 v_mfma_f32_16x16x32_bf16 v[160:163], v[48:51], v[96:99], v[160:163]
 ds_read_b64_tr_b16 v[32:33], v24
 buffer_load_dwordx4 v16, s[12:15], s40 offen offset:1024  lds
 v_mfma_f32_16x16x32_bf16 v[160:163], v[52:55], v[112:115], v[160:163]
 ds_read_b64_tr_b16 v[34:35], v24 offset:1024
 v_mfma_f32_16x16x32_bf16 v[164:167], v[52:55], v[116:119], v[164:167]
 v_mfma_f32_16x16x32_bf16 v[164:167], v[48:51], v[100:103], v[164:167]
 v_mfma_f32_16x16x32_bf16 v[168:171], v[48:51], v[104:107], v[168:171]
 ds_read_b64_tr_b16 v[36:37], v149
 v_mfma_f32_16x16x32_bf16 v[168:171], v[52:55], v[120:123], v[168:171]
 ds_read_b64_tr_b16 v[38:39], v149 offset:1024
 v_mfma_f32_16x16x32_bf16 v[172:175], v[52:55], v[124:127], v[172:175]
 v_mfma_f32_16x16x32_bf16 v[172:175], v[48:51], v[108:111], v[172:175]
 s_waitcnt lgkmcnt(4)
 v_mfma_f32_16x16x32_bf16 v[188:191], v[56:59], v[108:111], v[188:191]
 ds_read_b64_tr_b16 v[40:41], v25
 v_mfma_f32_16x16x32_bf16 v[188:191], v[60:63], v[124:127], v[188:191]
 ds_read_b64_tr_b16 v[42:43], v25 offset:1024
 v_mfma_f32_16x16x32_bf16 v[184:187], v[60:63], v[120:123], v[184:187]
 v_mfma_f32_16x16x32_bf16 v[184:187], v[56:59], v[104:107], v[184:187]
 v_mfma_f32_16x16x32_bf16 v[180:183], v[56:59], v[100:103], v[180:183]
 ds_read_b64_tr_b16 v[44:45], v150
 buffer_load_dwordx4 v17, s[12:15], s40 offen offset:2048  lds
 v_mfma_f32_16x16x32_bf16 v[180:183], v[60:63], v[116:119], v[180:183]
 ds_read_b64_tr_b16 v[46:47], v150 offset:1024
 v_mfma_f32_16x16x32_bf16 v[176:179], v[60:63], v[112:115], v[176:179]
 v_mfma_f32_16x16x32_bf16 v[176:179], v[56:59], v[96:99], v[176:179]
 s_waitcnt lgkmcnt(4)
 v_mfma_f32_16x16x32_bf16 v[192:195], v[32:35], v[96:99], v[192:195]
 ds_read_b64_tr_b16 v[48:49], v26
 v_mfma_f32_16x16x32_bf16 v[192:195], v[36:39], v[112:115], v[192:195]
 ds_read_b64_tr_b16 v[50:51], v26 offset:1024
 v_mfma_f32_16x16x32_bf16 v[196:199], v[36:39], v[116:119], v[196:199]
 v_mfma_f32_16x16x32_bf16 v[196:199], v[32:35], v[100:103], v[196:199]
 v_mfma_f32_16x16x32_bf16 v[200:203], v[32:35], v[104:107], v[200:203]
 ds_read_b64_tr_b16 v[56:57], v27
 v_mfma_f32_16x16x32_bf16 v[200:203], v[36:39], v[120:123], v[200:203]
 ds_read_b64_tr_b16 v[58:59], v27 offset:1024
 v_mfma_f32_16x16x32_bf16 v[204:207], v[36:39], v[124:127], v[204:207]
 v_mfma_f32_16x16x32_bf16 v[204:207], v[32:35], v[108:111], v[204:207]
 s_waitcnt lgkmcnt(4)
 v_mfma_f32_16x16x32_bf16 v[220:223], v[40:43], v[108:111], v[220:223]
 ds_read_b64_tr_b16 v[52:53], v151
 buffer_load_dwordx4 v18, s[12:15], s40 offen offset:3072  lds
 v_mfma_f32_16x16x32_bf16 v[220:223], v[44:47], v[124:127], v[220:223]
 ds_read_b64_tr_b16 v[54:55], v151 offset:1024
 s_add_u32 s40, s40, 524288
 v_mfma_f32_16x16x32_bf16 v[216:219], v[44:47], v[120:123], v[216:219]
 s_add_u32 s44, s44, 45056
 s_cmp_ge_u32 s44, 157696
 s_cselect_b32 s50, 157696, 0
 s_sub_u32 s44, s44, s50
 v_mfma_f32_16x16x32_bf16 v[216:219], v[40:43], v[104:107], v[216:219]
 v_mfma_f32_16x16x32_bf16 v[212:215], v[40:43], v[100:103], v[212:215]
 ds_read_b64_tr_b16 v[60:61], v152
 v_mfma_f32_16x16x32_bf16 v[212:215], v[44:47], v[116:119], v[212:215]
 ds_read_b64_tr_b16 v[62:63], v152 offset:1024
 v_mfma_f32_16x16x32_bf16 v[208:211], v[44:47], v[112:115], v[208:211]
 v_mfma_f32_16x16x32_bf16 v[208:211], v[40:43], v[96:99], v[208:211]
 s_waitcnt lgkmcnt(2)
 s_waitcnt vmcnt(22)
 s_waitcnt vmcnt(8)
 s_barrier
 v_mfma_f32_16x16x32_bf16 v[224:227], v[48:51], v[96:99], v[224:227]
 ds_read_b64_tr_b16 v[32:33], v19
 v_mfma_f32_16x16x32_bf16 v[224:227], v[52:55], v[112:115], v[224:227]
 ds_read_b64_tr_b16 v[34:35], v19 offset:1792
 v_mfma_f32_16x16x32_bf16 v[228:231], v[52:55], v[116:119], v[228:231]
 v_mfma_f32_16x16x32_bf16 v[228:231], v[48:51], v[100:103], v[228:231]
 v_mfma_f32_16x16x32_bf16 v[232:235], v[48:51], v[104:107], v[232:235]
 ds_read_b64_tr_b16 v[36:37], v144
 v_mfma_f32_16x16x32_bf16 v[232:235], v[52:55], v[120:123], v[232:235]
 ds_read_b64_tr_b16 v[38:39], v144 offset:1792
 v_mfma_f32_16x16x32_bf16 v[236:239], v[52:55], v[124:127], v[236:239]
 v_mfma_f32_16x16x32_bf16 v[236:239], v[48:51], v[108:111], v[236:239]
 s_waitcnt lgkmcnt(4)
 v_mfma_f32_16x16x32_bf16 v[252:255], v[56:59], v[108:111], v[252:255]
 ds_read_b64_tr_b16 v[40:41], v19 offset:32
 v_add_u32 v20, s46, v20
 v_mfma_f32_16x16x32_bf16 v[252:255], v[60:63], v[124:127], v[252:255]
 ds_read_b64_tr_b16 v[42:43], v19 offset:1824
 v_mfma_f32_16x16x32_bf16 v[248:251], v[60:63], v[120:123], v[248:251]
 v_mfma_f32_16x16x32_bf16 v[248:251], v[56:59], v[104:107], v[248:251]
 v_mfma_f32_16x16x32_bf16 v[244:247], v[56:59], v[100:103], v[244:247]
 ds_read_b64_tr_b16 v[44:45], v144 offset:32
 v_add_u32 v21, s46, v21
 v_mfma_f32_16x16x32_bf16 v[244:247], v[60:63], v[116:119], v[244:247]
 ds_read_b64_tr_b16 v[46:47], v144 offset:1824
 v_mfma_f32_16x16x32_bf16 v[240:243], v[60:63], v[112:115], v[240:243]
 v_mfma_f32_16x16x32_bf16 v[240:243], v[56:59], v[96:99], v[240:243]
 s_waitcnt lgkmcnt(4)
.p2align 6
G_loop:
 v_mfma_f32_16x16x32_bf16 a[0:3], v[32:35], v[64:67], a[0:3]
 ds_read_b64_tr_b16 v[48:49], v19 offset:64
 v_add_u32 v22, s46, v22
 v_mfma_f32_16x16x32_bf16 a[0:3], v[36:39], v[80:83], a[0:3]
 ds_read_b64_tr_b16 v[50:51], v19 offset:1856
 buffer_load_dwordx4 v[96:99], v4, s[16:19], s41 offen sc1
 v_mfma_f32_16x16x32_bf16 a[4:7], v[36:39], v[84:87], a[4:7]
 v_mfma_f32_16x16x32_bf16 a[4:7], v[32:35], v[68:71], a[4:7]
 v_mfma_f32_16x16x32_bf16 a[8:11], v[32:35], v[72:75], a[8:11]
 ds_read_b64_tr_b16 v[52:53], v144 offset:64
 v_add_u32 v23, s46, v23
 v_mfma_f32_16x16x32_bf16 a[8:11], v[36:39], v[88:91], a[8:11]
 ds_read_b64_tr_b16 v[54:55], v144 offset:1856
 buffer_load_dwordx4 v[100:103], v5, s[16:19], s41 offen sc1
 v_mfma_f32_16x16x32_bf16 a[12:15], v[36:39], v[92:95], a[12:15]
 v_mfma_f32_16x16x32_bf16 a[12:15], v[32:35], v[76:79], a[12:15]
 s_waitcnt lgkmcnt(4)
 v_mfma_f32_16x16x32_bf16 a[28:31], v[40:43], v[76:79], a[28:31]
 ds_read_b64_tr_b16 v[56:57], v19 offset:96
 v_add_u32 v24, s46, v24
 v_mfma_f32_16x16x32_bf16 a[28:31], v[44:47], v[92:95], a[28:31]
 ds_read_b64_tr_b16 v[58:59], v19 offset:1888
 buffer_load_dwordx4 v[104:107], v6, s[16:19], s41 offen sc1
 v_mfma_f32_16x16x32_bf16 a[24:27], v[44:47], v[88:91], a[24:27]
 v_mfma_f32_16x16x32_bf16 a[24:27], v[40:43], v[72:75], a[24:27]
 v_mfma_f32_16x16x32_bf16 a[20:23], v[40:43], v[68:71], a[20:23]
 ds_read_b64_tr_b16 v[60:61], v144 offset:96
 v_add_u32 v25, s46, v25
 v_mfma_f32_16x16x32_bf16 a[20:23], v[44:47], v[84:87], a[20:23]
 ds_read_b64_tr_b16 v[62:63], v144 offset:1888
 buffer_load_dwordx4 v[108:111], v7, s[16:19], s41 offen sc1
 v_mfma_f32_16x16x32_bf16 a[16:19], v[44:47], v[80:83], a[16:19]
 v_mfma_f32_16x16x32_bf16 a[16:19], v[40:43], v[64:67], a[16:19]
 s_waitcnt lgkmcnt(4)
 v_mfma_f32_16x16x32_bf16 a[32:35], v[48:51], v[64:67], a[32:35]
 ds_read_b64_tr_b16 v[32:33], v19 offset:128
 v_add_u32 v26, s46, v26
 v_mfma_f32_16x16x32_bf16 a[32:35], v[52:55], v[80:83], a[32:35]
 ds_read_b64_tr_b16 v[34:35], v19 offset:1920
 buffer_load_dwordx4 v[112:115], v4, s[16:19], s41 offen offset:1024 sc1
 v_mfma_f32_16x16x32_bf16 a[36:39], v[52:55], v[84:87], a[36:39]
 v_mfma_f32_16x16x32_bf16 a[36:39], v[48:51], v[68:71], a[36:39]
 v_mfma_f32_16x16x32_bf16 a[40:43], v[48:51], v[72:75], a[40:43]
 ds_read_b64_tr_b16 v[36:37], v144 offset:128
 v_add_u32 v27, s46, v27
 v_mfma_f32_16x16x32_bf16 a[40:43], v[52:55], v[88:91], a[40:43]
 ds_read_b64_tr_b16 v[38:39], v144 offset:1920
 buffer_load_dwordx4 v[116:119], v5, s[16:19], s41 offen offset:1024 sc1
 v_mfma_f32_16x16x32_bf16 a[44:47], v[52:55], v[92:95], a[44:47]
 v_mfma_f32_16x16x32_bf16 a[44:47], v[48:51], v[76:79], a[44:47]
 s_waitcnt lgkmcnt(4)
 v_mfma_f32_16x16x32_bf16 a[60:63], v[56:59], v[76:79], a[60:63]
 ds_read_b64_tr_b16 v[40:41], v19 offset:160
 v_add_u32 v145, s48, v145
 v_mfma_f32_16x16x32_bf16 a[60:63], v[60:63], v[92:95], a[60:63]
 ds_read_b64_tr_b16 v[42:43], v19 offset:1952
 buffer_load_dwordx4 v[120:123], v6, s[16:19], s41 offen offset:1024 sc1
 v_mfma_f32_16x16x32_bf16 a[56:59], v[60:63], v[88:91], a[56:59]
 v_mfma_f32_16x16x32_bf16 a[56:59], v[56:59], v[72:75], a[56:59]
 v_mfma_f32_16x16x32_bf16 a[52:55], v[56:59], v[68:71], a[52:55]
 ds_read_b64_tr_b16 v[44:45], v144 offset:160
 v_add_u32 v146, s48, v146
 v_mfma_f32_16x16x32_bf16 a[52:55], v[60:63], v[84:87], a[52:55]
 ds_read_b64_tr_b16 v[46:47], v144 offset:1952
 buffer_load_dwordx4 v[124:127], v7, s[16:19], s41 offen offset:1024 sc1
 v_mfma_f32_16x16x32_bf16 a[48:51], v[60:63], v[80:83], a[48:51]
 s_add_u32 s41, s41, 2048
 s_cmp_eq_u32 s41, 32768
 s_cselect_b32 s18, 0, s18
 v_mfma_f32_16x16x32_bf16 a[48:51], v[56:59], v[64:67], a[48:51]
 s_waitcnt lgkmcnt(4)
 v_mfma_f32_16x16x32_bf16 a[64:67], v[32:35], v[64:67], a[64:67]
 ds_read_b64_tr_b16 v[48:49], v19 offset:192
 v_add_u32 v147, s48, v147
 v_mfma_f32_16x16x32_bf16 a[64:67], v[36:39], v[80:83], a[64:67]
 ds_read_b64_tr_b16 v[50:51], v19 offset:1984
 buffer_load_dword v138, v136, s[8:11], s39 offen
 v_mfma_f32_16x16x32_bf16 a[68:71], v[36:39], v[84:87], a[68:71]
 buffer_load_dword v138, v137, s[12:15], s40 offen
 s_add_u32 m0, s43, s49
 v_mfma_f32_16x16x32_bf16 a[68:71], v[32:35], v[68:71], a[68:71]
 buffer_load_dwordx4 v8, s[8:11], s39 offen  lds
 v_mfma_f32_16x16x32_bf16 a[72:75], v[32:35], v[72:75], a[72:75]
 ds_read_b64_tr_b16 v[52:53], v144 offset:192
 v_add_u32 v148, s48, v148
 v_mfma_f32_16x16x32_bf16 a[72:75], v[36:39], v[88:91], a[72:75]
 ds_read_b64_tr_b16 v[54:55], v144 offset:1984
 v_mfma_f32_16x16x32_bf16 a[76:79], v[36:39], v[92:95], a[76:79]
 v_mfma_f32_16x16x32_bf16 a[76:79], v[32:35], v[76:79], a[76:79]
 s_waitcnt lgkmcnt(4)
 v_mfma_f32_16x16x32_bf16 a[92:95], v[40:43], v[76:79], a[92:95]
 ds_read_b64_tr_b16 v[56:57], v19 offset:7168
 v_add_u32 v149, s48, v149
 v_mfma_f32_16x16x32_bf16 a[92:95], v[44:47], v[92:95], a[92:95]
 ds_read_b64_tr_b16 v[58:59], v19 offset:8960
 v_mfma_f32_16x16x32_bf16 a[88:91], v[44:47], v[88:91], a[88:91]
 v_mfma_f32_16x16x32_bf16 a[88:91], v[40:43], v[72:75], a[88:91]
 v_mfma_f32_16x16x32_bf16 a[84:87], v[40:43], v[68:71], a[84:87]
 ds_read_b64_tr_b16 v[60:61], v144 offset:7168
 v_add_u32 v150, s48, v150
 v_mfma_f32_16x16x32_bf16 a[84:87], v[44:47], v[84:87], a[84:87]
 ds_read_b64_tr_b16 v[62:63], v144 offset:8960
 buffer_load_dwordx4 v9, s[8:11], s39 offen offset:1024  lds
 v_mfma_f32_16x16x32_bf16 a[80:83], v[44:47], v[80:83], a[80:83]
 v_mfma_f32_16x16x32_bf16 a[80:83], v[40:43], v[64:67], a[80:83]
 s_waitcnt lgkmcnt(4)
 v_mfma_f32_16x16x32_bf16 a[96:99], v[48:51], v[64:67], a[96:99]
 ds_read_b64_tr_b16 v[32:33], v19 offset:7200
 v_add_u32 v151, s48, v151
 v_mfma_f32_16x16x32_bf16 a[96:99], v[52:55], v[80:83], a[96:99]
 ds_read_b64_tr_b16 v[34:35], v19 offset:8992
 v_mfma_f32_16x16x32_bf16 a[100:103], v[52:55], v[84:87], a[100:103]
 v_mfma_f32_16x16x32_bf16 a[100:103], v[48:51], v[68:71], a[100:103]
 v_mfma_f32_16x16x32_bf16 a[104:107], v[48:51], v[72:75], a[104:107]
 ds_read_b64_tr_b16 v[36:37], v144 offset:7200
 v_add_u32 v152, s48, v152
 v_mfma_f32_16x16x32_bf16 a[104:107], v[52:55], v[88:91], a[104:107]
 ds_read_b64_tr_b16 v[38:39], v144 offset:8992
 v_mfma_f32_16x16x32_bf16 a[108:111], v[52:55], v[92:95], a[108:111]
 v_mfma_f32_16x16x32_bf16 a[108:111], v[48:51], v[76:79], a[108:111]
 s_waitcnt lgkmcnt(4)
 v_mfma_f32_16x16x32_bf16 a[124:127], v[56:59], v[76:79], a[124:127]
 ds_read_b64_tr_b16 v[40:41], v19 offset:7232
 s_add_u32 s45, s45, 45056
 v_mfma_f32_16x16x32_bf16 a[124:127], v[60:63], v[92:95], a[124:127]
 ds_read_b64_tr_b16 v[42:43], v19 offset:9024
 s_mov_b32 s46, 45056
 v_mfma_f32_16x16x32_bf16 a[120:123], v[60:63], v[88:91], a[120:123]
 s_cmp_ge_u32 s45, 157696
 s_cselect_b32 s46, -112640, s46
 s_cselect_b32 s50, 157696, 0
 s_sub_u32 s45, s45, s50
 v_mfma_f32_16x16x32_bf16 a[120:123], v[56:59], v[72:75], a[120:123]
 buffer_load_dwordx4 v10, s[8:11], s39 offen offset:2048  lds
 v_mfma_f32_16x16x32_bf16 a[116:119], v[56:59], v[68:71], a[116:119]
 ds_read_b64_tr_b16 v[44:45], v144 offset:7232
 v_mfma_f32_16x16x32_bf16 a[116:119], v[60:63], v[84:87], a[116:119]
 ds_read_b64_tr_b16 v[46:47], v144 offset:9024
 v_mfma_f32_16x16x32_bf16 a[112:115], v[60:63], v[80:83], a[112:115]
 v_mfma_f32_16x16x32_bf16 a[112:115], v[56:59], v[64:67], a[112:115]
 s_waitcnt lgkmcnt(4)
 v_mfma_f32_16x16x32_bf16 a[128:131], v[32:35], v[64:67], a[128:131]
 ds_read_b64_tr_b16 v[48:49], v19 offset:7264
 s_add_u32 s47, s47, 45056
 v_mfma_f32_16x16x32_bf16 a[128:131], v[36:39], v[80:83], a[128:131]
 ds_read_b64_tr_b16 v[50:51], v19 offset:9056
 s_mov_b32 s48, 45056
 v_mfma_f32_16x16x32_bf16 a[132:135], v[36:39], v[84:87], a[132:135]
 s_cmp_ge_u32 s47, 157696
 s_cselect_b32 s48, -112640, s48
 s_cselect_b32 s50, 157696, 0
 s_sub_u32 s47, s47, s50
 v_mfma_f32_16x16x32_bf16 a[132:135], v[32:35], v[68:71], a[132:135]
 v_mfma_f32_16x16x32_bf16 a[136:139], v[32:35], v[72:75], a[136:139]
 ds_read_b64_tr_b16 v[52:53], v144 offset:7264
 buffer_load_dwordx4 v11, s[8:11], s39 offen offset:3072  lds
 v_mfma_f32_16x16x32_bf16 a[136:139], v[36:39], v[88:91], a[136:139]
 ds_read_b64_tr_b16 v[54:55], v144 offset:9056
 v_mfma_f32_16x16x32_bf16 a[140:143], v[36:39], v[92:95], a[140:143]
 v_mfma_f32_16x16x32_bf16 a[140:143], v[32:35], v[76:79], a[140:143]
 s_waitcnt lgkmcnt(4)
 v_mfma_f32_16x16x32_bf16 a[156:159], v[40:43], v[76:79], a[156:159]
 ds_read_b64_tr_b16 v[56:57], v19 offset:7296
 v_mfma_f32_16x16x32_bf16 a[156:159], v[44:47], v[92:95], a[156:159]
 ds_read_b64_tr_b16 v[58:59], v19 offset:9088
 v_mfma_f32_16x16x32_bf16 a[152:155], v[44:47], v[88:91], a[152:155]
 v_mfma_f32_16x16x32_bf16 a[152:155], v[40:43], v[72:75], a[152:155]
 v_mfma_f32_16x16x32_bf16 a[148:151], v[40:43], v[68:71], a[148:151]
 ds_read_b64_tr_b16 v[60:61], v144 offset:7296
 v_mfma_f32_16x16x32_bf16 a[148:151], v[44:47], v[84:87], a[148:151]
 ds_read_b64_tr_b16 v[62:63], v144 offset:9088
 v_mfma_f32_16x16x32_bf16 a[144:147], v[44:47], v[80:83], a[144:147]
 v_mfma_f32_16x16x32_bf16 a[144:147], v[40:43], v[64:67], a[144:147]
 s_waitcnt lgkmcnt(4)
 v_mfma_f32_16x16x32_bf16 a[160:163], v[48:51], v[64:67], a[160:163]
 ds_read_b64_tr_b16 v[32:33], v19 offset:7328
 s_add_u32 m0, m0, 4096
 v_mfma_f32_16x16x32_bf16 a[160:163], v[52:55], v[80:83], a[160:163]
 ds_read_b64_tr_b16 v[34:35], v19 offset:9120
 v_mfma_f32_16x16x32_bf16 a[164:167], v[52:55], v[84:87], a[164:167]
 buffer_load_dwordx4 v12, s[8:11], s39 offen  lds
 v_mfma_f32_16x16x32_bf16 a[164:167], v[48:51], v[68:71], a[164:167]
 v_mfma_f32_16x16x32_bf16 a[168:171], v[48:51], v[72:75], a[168:171]
 ds_read_b64_tr_b16 v[36:37], v144 offset:7328
 v_mfma_f32_16x16x32_bf16 a[168:171], v[52:55], v[88:91], a[168:171]
 ds_read_b64_tr_b16 v[38:39], v144 offset:9120
 v_mfma_f32_16x16x32_bf16 a[172:175], v[52:55], v[92:95], a[172:175]
 v_mfma_f32_16x16x32_bf16 a[172:175], v[48:51], v[76:79], a[172:175]
 s_waitcnt lgkmcnt(4)
 v_mfma_f32_16x16x32_bf16 a[188:191], v[56:59], v[76:79], a[188:191]
 ds_read_b64_tr_b16 v[40:41], v19 offset:7360
 v_mfma_f32_16x16x32_bf16 a[188:191], v[60:63], v[92:95], a[188:191]
 ds_read_b64_tr_b16 v[42:43], v19 offset:9152
 v_mfma_f32_16x16x32_bf16 a[184:187], v[60:63], v[88:91], a[184:187]
 v_mfma_f32_16x16x32_bf16 a[184:187], v[56:59], v[72:75], a[184:187]
 v_mfma_f32_16x16x32_bf16 a[180:183], v[56:59], v[68:71], a[180:183]
 ds_read_b64_tr_b16 v[44:45], v144 offset:7360
 buffer_load_dwordx4 v13, s[8:11], s39 offen offset:1024  lds
 v_mfma_f32_16x16x32_bf16 a[180:183], v[60:63], v[84:87], a[180:183]
 ds_read_b64_tr_b16 v[46:47], v144 offset:9152
 v_mfma_f32_16x16x32_bf16 a[176:179], v[60:63], v[80:83], a[176:179]
 v_mfma_f32_16x16x32_bf16 a[176:179], v[56:59], v[64:67], a[176:179]
 s_waitcnt lgkmcnt(4)
 v_mfma_f32_16x16x32_bf16 a[192:195], v[32:35], v[64:67], a[192:195]
 ds_read_b64_tr_b16 v[48:49], v20
 v_mfma_f32_16x16x32_bf16 a[192:195], v[36:39], v[80:83], a[192:195]
 ds_read_b64_tr_b16 v[50:51], v20 offset:1024
 v_mfma_f32_16x16x32_bf16 a[196:199], v[36:39], v[84:87], a[196:199]
 v_mfma_f32_16x16x32_bf16 a[196:199], v[32:35], v[68:71], a[196:199]
 v_mfma_f32_16x16x32_bf16 a[200:203], v[32:35], v[72:75], a[200:203]
 ds_read_b64_tr_b16 v[52:53], v145
 v_mfma_f32_16x16x32_bf16 a[200:203], v[36:39], v[88:91], a[200:203]
 ds_read_b64_tr_b16 v[54:55], v145 offset:1024
 v_mfma_f32_16x16x32_bf16 a[204:207], v[36:39], v[92:95], a[204:207]
 v_add_u32 v19, s46, v19
 v_mfma_f32_16x16x32_bf16 a[204:207], v[32:35], v[76:79], a[204:207]
 s_waitcnt lgkmcnt(4)
 v_mfma_f32_16x16x32_bf16 a[220:223], v[40:43], v[76:79], a[220:223]
 ds_read_b64_tr_b16 v[56:57], v21
 buffer_load_dwordx4 v14, s[8:11], s39 offen offset:2048  lds
 v_mfma_f32_16x16x32_bf16 a[220:223], v[44:47], v[92:95], a[220:223]
 ds_read_b64_tr_b16 v[58:59], v21 offset:1024
 s_add_u32 s39, s39, 458752
 v_mfma_f32_16x16x32_bf16 a[216:219], v[44:47], v[88:91], a[216:219]
 s_add_u32 s43, s43, 45056
 v_add_u32 v144, s48, v144
 v_mfma_f32_16x16x32_bf16 a[216:219], v[40:43], v[72:75], a[216:219]
 s_cmp_ge_u32 s43, 157696
 s_cselect_b32 s50, 157696, 0
 s_sub_u32 s43, s43, s50
 v_mfma_f32_16x16x32_bf16 a[212:215], v[40:43], v[68:71], a[212:215]
 ds_read_b64_tr_b16 v[60:61], v146
 v_mfma_f32_16x16x32_bf16 a[212:215], v[44:47], v[84:87], a[212:215]
 ds_read_b64_tr_b16 v[62:63], v146 offset:1024
 v_mfma_f32_16x16x32_bf16 a[208:211], v[44:47], v[80:83], a[208:211]
 v_mfma_f32_16x16x32_bf16 a[208:211], v[40:43], v[64:67], a[208:211]
 s_waitcnt lgkmcnt(4)
 v_mfma_f32_16x16x32_bf16 a[224:227], v[48:51], v[64:67], a[224:227]
 ds_read_b64_tr_b16 v[32:33], v22
 v_mfma_f32_16x16x32_bf16 a[224:227], v[52:55], v[80:83], a[224:227]
 ds_read_b64_tr_b16 v[34:35], v22 offset:1024
 v_mfma_f32_16x16x32_bf16 a[228:231], v[52:55], v[84:87], a[228:231]
 v_mfma_f32_16x16x32_bf16 a[228:231], v[48:51], v[68:71], a[228:231]
 v_mfma_f32_16x16x32_bf16 a[232:235], v[48:51], v[72:75], a[232:235]
 ds_read_b64_tr_b16 v[36:37], v147
 s_add_u32 m0, s44, s3
 v_mfma_f32_16x16x32_bf16 a[232:235], v[52:55], v[88:91], a[232:235]
 ds_read_b64_tr_b16 v[38:39], v147 offset:1024
 v_mfma_f32_16x16x32_bf16 a[236:239], v[52:55], v[92:95], a[236:239]
 buffer_load_dwordx4 v15, s[12:15], s40 offen  lds
 v_mfma_f32_16x16x32_bf16 a[236:239], v[48:51], v[76:79], a[236:239]
 s_waitcnt lgkmcnt(4)
 v_mfma_f32_16x16x32_bf16 a[252:255], v[56:59], v[76:79], a[252:255]
 ds_read_b64_tr_b16 v[40:41], v23
 v_mfma_f32_16x16x32_bf16 a[252:255], v[60:63], v[92:95], a[252:255]
 ds_read_b64_tr_b16 v[42:43], v23 offset:1024
 v_mfma_f32_16x16x32_bf16 a[248:251], v[60:63], v[88:91], a[248:251]
 v_mfma_f32_16x16x32_bf16 a[248:251], v[56:59], v[72:75], a[248:251]
 v_mfma_f32_16x16x32_bf16 a[244:247], v[56:59], v[68:71], a[244:247]
 ds_read_b64_tr_b16 v[44:45], v148
 v_mfma_f32_16x16x32_bf16 a[244:247], v[60:63], v[84:87], a[244:247]
 ds_read_b64_tr_b16 v[46:47], v148 offset:1024
 v_mfma_f32_16x16x32_bf16 a[240:243], v[60:63], v[80:83], a[240:243]
 v_mfma_f32_16x16x32_bf16 a[240:243], v[56:59], v[64:67], a[240:243]
 s_waitcnt lgkmcnt(4)
 v_mfma_f32_16x16x32_bf16 v[160:163], v[32:35], v[64:67], v[160:163]
 ds_read_b64_tr_b16 v[48:49], v24
 buffer_load_dwordx4 v16, s[12:15], s40 offen offset:1024  lds
 v_mfma_f32_16x16x32_bf16 v[160:163], v[36:39], v[80:83], v[160:163]
 ds_read_b64_tr_b16 v[50:51], v24 offset:1024
 v_mfma_f32_16x16x32_bf16 v[164:167], v[36:39], v[84:87], v[164:167]
 v_mfma_f32_16x16x32_bf16 v[164:167], v[32:35], v[68:71], v[164:167]
 v_mfma_f32_16x16x32_bf16 v[168:171], v[32:35], v[72:75], v[168:171]
 ds_read_b64_tr_b16 v[52:53], v149
 v_mfma_f32_16x16x32_bf16 v[168:171], v[36:39], v[88:91], v[168:171]
 ds_read_b64_tr_b16 v[54:55], v149 offset:1024
 v_mfma_f32_16x16x32_bf16 v[172:175], v[36:39], v[92:95], v[172:175]
 v_mfma_f32_16x16x32_bf16 v[172:175], v[32:35], v[76:79], v[172:175]
 s_waitcnt lgkmcnt(4)
 v_mfma_f32_16x16x32_bf16 v[188:191], v[40:43], v[76:79], v[188:191]
 ds_read_b64_tr_b16 v[56:57], v25
 v_mfma_f32_16x16x32_bf16 v[188:191], v[44:47], v[92:95], v[188:191]
 ds_read_b64_tr_b16 v[58:59], v25 offset:1024
 v_mfma_f32_16x16x32_bf16 v[184:187], v[44:47], v[88:91], v[184:187]
 v_mfma_f32_16x16x32_bf16 v[184:187], v[40:43], v[72:75], v[184:187]
 v_mfma_f32_16x16x32_bf16 v[180:183], v[40:43], v[68:71], v[180:183]
 ds_read_b64_tr_b16 v[60:61], v150
 buffer_load_dwordx4 v17, s[12:15], s40 offen offset:2048  lds
 v_mfma_f32_16x16x32_bf16 v[180:183], v[44:47], v[84:87], v[180:183]
 ds_read_b64_tr_b16 v[62:63], v150 offset:1024
 v_mfma_f32_16x16x32_bf16 v[176:179], v[44:47], v[80:83], v[176:179]
 v_mfma_f32_16x16x32_bf16 v[176:179], v[40:43], v[64:67], v[176:179]
 s_waitcnt lgkmcnt(4)
 v_mfma_f32_16x16x32_bf16 v[192:195], v[48:51], v[64:67], v[192:195]
 ds_read_b64_tr_b16 v[32:33], v26
 v_mfma_f32_16x16x32_bf16 v[192:195], v[52:55], v[80:83], v[192:195]
 ds_read_b64_tr_b16 v[34:35], v26 offset:1024
 v_mfma_f32_16x16x32_bf16 v[196:199], v[52:55], v[84:87], v[196:199]
 v_mfma_f32_16x16x32_bf16 v[196:199], v[48:51], v[68:71], v[196:199]
 v_mfma_f32_16x16x32_bf16 v[200:203], v[48:51], v[72:75], v[200:203]
 ds_read_b64_tr_b16 v[40:41], v27
 v_mfma_f32_16x16x32_bf16 v[200:203], v[52:55], v[88:91], v[200:203]
 ds_read_b64_tr_b16 v[42:43], v27 offset:1024
 v_mfma_f32_16x16x32_bf16 v[204:207], v[52:55], v[92:95], v[204:207]
 v_mfma_f32_16x16x32_bf16 v[204:207], v[48:51], v[76:79], v[204:207]
 s_waitcnt lgkmcnt(4)
 v_mfma_f32_16x16x32_bf16 v[220:223], v[56:59], v[76:79], v[220:223]
 ds_read_b64_tr_b16 v[36:37], v151
 buffer_load_dwordx4 v18, s[12:15], s40 offen offset:3072  lds
 v_mfma_f32_16x16x32_bf16 v[220:223], v[60:63], v[92:95], v[220:223]
 ds_read_b64_tr_b16 v[38:39], v151 offset:1024
 s_add_u32 s40, s40, 524288
 v_mfma_f32_16x16x32_bf16 v[216:219], v[60:63], v[88:91], v[216:219]
 s_add_u32 s44, s44, 45056
 s_cmp_ge_u32 s44, 157696
 s_cselect_b32 s50, 157696, 0
 s_sub_u32 s44, s44, s50
 v_mfma_f32_16x16x32_bf16 v[216:219], v[56:59], v[72:75], v[216:219]
 buffer_load_dword v138, v0, s[60:63], 0 offen
 v_mfma_f32_16x16x32_bf16 v[212:215], v[56:59], v[68:71], v[212:215]
 ds_read_b64_tr_b16 v[44:45], v152
 v_mfma_f32_16x16x32_bf16 v[212:215], v[60:63], v[84:87], v[212:215]
 ds_read_b64_tr_b16 v[46:47], v152 offset:1024
 v_mfma_f32_16x16x32_bf16 v[208:211], v[60:63], v[80:83], v[208:211]
 v_mfma_f32_16x16x32_bf16 v[208:211], v[56:59], v[64:67], v[208:211]
 s_waitcnt lgkmcnt(2)
 s_waitcnt vmcnt(22)
 s_waitcnt vmcnt(14)
 s_barrier
 v_mfma_f32_16x16x32_bf16 v[224:227], v[32:35], v[64:67], v[224:227]
 ds_read_b64_tr_b16 v[48:49], v19
 v_mfma_f32_16x16x32_bf16 v[224:227], v[36:39], v[80:83], v[224:227]
 ds_read_b64_tr_b16 v[50:51], v19 offset:1792
 v_mfma_f32_16x16x32_bf16 v[228:231], v[36:39], v[84:87], v[228:231]
 v_mfma_f32_16x16x32_bf16 v[228:231], v[32:35], v[68:71], v[228:231]
 v_mfma_f32_16x16x32_bf16 v[232:235], v[32:35], v[72:75], v[232:235]
 ds_read_b64_tr_b16 v[52:53], v144
 v_mfma_f32_16x16x32_bf16 v[232:235], v[36:39], v[88:91], v[232:235]
 ds_read_b64_tr_b16 v[54:55], v144 offset:1792
 v_mfma_f32_16x16x32_bf16 v[236:239], v[36:39], v[92:95], v[236:239]
 v_mfma_f32_16x16x32_bf16 v[236:239], v[32:35], v[76:79], v[236:239]
 s_waitcnt lgkmcnt(4)
 v_mfma_f32_16x16x32_bf16 v[252:255], v[40:43], v[76:79], v[252:255]
 ds_read_b64_tr_b16 v[56:57], v19 offset:32
 v_add_u32 v20, s46, v20
 v_mfma_f32_16x16x32_bf16 v[252:255], v[44:47], v[92:95], v[252:255]
 ds_read_b64_tr_b16 v[58:59], v19 offset:1824
 v_mfma_f32_16x16x32_bf16 v[248:251], v[44:47], v[88:91], v[248:251]
 v_mfma_f32_16x16x32_bf16 v[248:251], v[40:43], v[72:75], v[248:251]
 v_mfma_f32_16x16x32_bf16 v[244:247], v[40:43], v[68:71], v[244:247]
 ds_read_b64_tr_b16 v[60:61], v144 offset:32
 v_add_u32 v21, s46, v21
 v_mfma_f32_16x16x32_bf16 v[244:247], v[44:47], v[84:87], v[244:247]
 ds_read_b64_tr_b16 v[62:63], v144 offset:1824
 v_mfma_f32_16x16x32_bf16 v[240:243], v[44:47], v[80:83], v[240:243]
 v_mfma_f32_16x16x32_bf16 v[240:243], v[40:43], v[64:67], v[240:243]
 s_waitcnt lgkmcnt(4)
 v_mfma_f32_16x16x32_bf16 a[0:3], v[48:51], v[96:99], a[0:3]
 ds_read_b64_tr_b16 v[32:33], v19 offset:64
 v_add_u32 v22, s46, v22
 v_mfma_f32_16x16x32_bf16 a[0:3], v[52:55], v[112:115], a[0:3]
 ds_read_b64_tr_b16 v[34:35], v19 offset:1856
 buffer_load_dwordx4 v[64:67], v4, s[16:19], s41 offen sc1
 v_mfma_f32_16x16x32_bf16 a[4:7], v[52:55], v[116:119], a[4:7]
 v_mfma_f32_16x16x32_bf16 a[4:7], v[48:51], v[100:103], a[4:7]
 v_mfma_f32_16x16x32_bf16 a[8:11], v[48:51], v[104:107], a[8:11]
 ds_read_b64_tr_b16 v[36:37], v144 offset:64
 v_add_u32 v23, s46, v23
 v_mfma_f32_16x16x32_bf16 a[8:11], v[52:55], v[120:123], a[8:11]
 ds_read_b64_tr_b16 v[38:39], v144 offset:1856
 buffer_load_dwordx4 v[68:71], v5, s[16:19], s41 offen sc1
 v_mfma_f32_16x16x32_bf16 a[12:15], v[52:55], v[124:127], a[12:15]
 v_mfma_f32_16x16x32_bf16 a[12:15], v[48:51], v[108:111], a[12:15]
 s_waitcnt lgkmcnt(4)
 v_mfma_f32_16x16x32_bf16 a[28:31], v[56:59], v[108:111], a[28:31]
 ds_read_b64_tr_b16 v[40:41], v19 offset:96
 v_add_u32 v24, s46, v24
 v_mfma_f32_16x16x32_bf16 a[28:31], v[60:63], v[124:127], a[28:31]
 ds_read_b64_tr_b16 v[42:43], v19 offset:1888
 buffer_load_dwordx4 v[72:75], v6, s[16:19], s41 offen sc1
 v_mfma_f32_16x16x32_bf16 a[24:27], v[60:63], v[120:123], a[24:27]
 v_mfma_f32_16x16x32_bf16 a[24:27], v[56:59], v[104:107], a[24:27]
 v_mfma_f32_16x16x32_bf16 a[20:23], v[56:59], v[100:103], a[20:23]
 ds_read_b64_tr_b16 v[44:45], v144 offset:96
 v_add_u32 v25, s46, v25
 v_mfma_f32_16x16x32_bf16 a[20:23], v[60:63], v[116:119], a[20:23]
 ds_read_b64_tr_b16 v[46:47], v144 offset:1888
 buffer_load_dwordx4 v[76:79], v7, s[16:19], s41 offen sc1
 v_mfma_f32_16x16x32_bf16 a[16:19], v[60:63], v[112:115], a[16:19]
 v_mfma_f32_16x16x32_bf16 a[16:19], v[56:59], v[96:99], a[16:19]
 s_waitcnt lgkmcnt(4)
 v_mfma_f32_16x16x32_bf16 a[32:35], v[32:35], v[96:99], a[32:35]
 ds_read_b64_tr_b16 v[48:49], v19 offset:128
 v_add_u32 v26, s46, v26
 v_mfma_f32_16x16x32_bf16 a[32:35], v[36:39], v[112:115], a[32:35]
 ds_read_b64_tr_b16 v[50:51], v19 offset:1920
 buffer_load_dwordx4 v[80:83], v4, s[16:19], s41 offen offset:1024 sc1
 v_mfma_f32_16x16x32_bf16 a[36:39], v[36:39], v[116:119], a[36:39]
 v_mfma_f32_16x16x32_bf16 a[36:39], v[32:35], v[100:103], a[36:39]
 v_mfma_f32_16x16x32_bf16 a[40:43], v[32:35], v[104:107], a[40:43]
 ds_read_b64_tr_b16 v[52:53], v144 offset:128
 v_add_u32 v27, s46, v27
 v_mfma_f32_16x16x32_bf16 a[40:43], v[36:39], v[120:123], a[40:43]
 ds_read_b64_tr_b16 v[54:55], v144 offset:1920
 buffer_load_dwordx4 v[84:87], v5, s[16:19], s41 offen offset:1024 sc1
 v_mfma_f32_16x16x32_bf16 a[44:47], v[36:39], v[124:127], a[44:47]
 v_mfma_f32_16x16x32_bf16 a[44:47], v[32:35], v[108:111], a[44:47]
 s_waitcnt lgkmcnt(4)
 v_mfma_f32_16x16x32_bf16 a[60:63], v[40:43], v[108:111], a[60:63]
 ds_read_b64_tr_b16 v[56:57], v19 offset:160
 v_add_u32 v145, s48, v145
 v_mfma_f32_16x16x32_bf16 a[60:63], v[44:47], v[124:127], a[60:63]
 ds_read_b64_tr_b16 v[58:59], v19 offset:1952
 buffer_load_dwordx4 v[88:91], v6, s[16:19], s41 offen offset:1024 sc1
 v_mfma_f32_16x16x32_bf16 a[56:59], v[44:47], v[120:123], a[56:59]
 v_mfma_f32_16x16x32_bf16 a[56:59], v[40:43], v[104:107], a[56:59]
 v_mfma_f32_16x16x32_bf16 a[52:55], v[40:43], v[100:103], a[52:55]
 ds_read_b64_tr_b16 v[60:61], v144 offset:160
 v_add_u32 v146, s48, v146
 v_mfma_f32_16x16x32_bf16 a[52:55], v[44:47], v[116:119], a[52:55]
 ds_read_b64_tr_b16 v[62:63], v144 offset:1952
 buffer_load_dwordx4 v[92:95], v7, s[16:19], s41 offen offset:1024 sc1
 v_mfma_f32_16x16x32_bf16 a[48:51], v[44:47], v[112:115], a[48:51]
 s_add_u32 s41, s41, 2048
 s_cmp_eq_u32 s41, 32768
 s_cselect_b32 s18, 0, s18
 v_mfma_f32_16x16x32_bf16 a[48:51], v[40:43], v[96:99], a[48:51]
 s_waitcnt lgkmcnt(4)
 v_mfma_f32_16x16x32_bf16 a[64:67], v[48:51], v[96:99], a[64:67]
 ds_read_b64_tr_b16 v[32:33], v19 offset:192
 v_add_u32 v147, s48, v147
 v_mfma_f32_16x16x32_bf16 a[64:67], v[52:55], v[112:115], a[64:67]
 ds_read_b64_tr_b16 v[34:35], v19 offset:1984
 buffer_load_dword v138, v136, s[8:11], s39 offen
 v_mfma_f32_16x16x32_bf16 a[68:71], v[52:55], v[116:119], a[68:71]
 buffer_load_dword v138, v137, s[12:15], s40 offen
 s_add_u32 m0, s43, s49
 v_mfma_f32_16x16x32_bf16 a[68:71], v[48:51], v[100:103], a[68:71]
 buffer_load_dwordx4 v8, s[8:11], s39 offen  lds
 v_mfma_f32_16x16x32_bf16 a[72:75], v[48:51], v[104:107], a[72:75]
 ds_read_b64_tr_b16 v[36:37], v144 offset:192
 v_add_u32 v148, s48, v148
 v_mfma_f32_16x16x32_bf16 a[72:75], v[52:55], v[120:123], a[72:75]
 ds_read_b64_tr_b16 v[38:39], v144 offset:1984
 v_mfma_f32_16x16x32_bf16 a[76:79], v[52:55], v[124:127], a[76:79]
 v_mfma_f32_16x16x32_bf16 a[76:79], v[48:51], v[108:111], a[76:79]
 s_waitcnt lgkmcnt(4)
 v_mfma_f32_16x16x32_bf16 a[92:95], v[56:59], v[108:111], a[92:95]
 ds_read_b64_tr_b16 v[40:41], v19 offset:7168
 v_add_u32 v149, s48, v149
 v_mfma_f32_16x16x32_bf16 a[92:95], v[60:63], v[124:127], a[92:95]
 ds_read_b64_tr_b16 v[42:43], v19 offset:8960
 v_mfma_f32_16x16x32_bf16 a[88:91], v[60:63], v[120:123], a[88:91]
 v_mfma_f32_16x16x32_bf16 a[88:91], v[56:59], v[104:107], a[88:91]
 v_mfma_f32_16x16x32_bf16 a[84:87], v[56:59], v[100:103], a[84:87]
 ds_read_b64_tr_b16 v[44:45], v144 offset:7168
 v_add_u32 v150, s48, v150
 v_mfma_f32_16x16x32_bf16 a[84:87], v[60:63], v[116:119], a[84:87]
 ds_read_b64_tr_b16 v[46:47], v144 offset:8960
 buffer_load_dwordx4 v9, s[8:11], s39 offen offset:1024  lds
 v_mfma_f32_16x16x32_bf16 a[80:83], v[60:63], v[112:115], a[80:83]
 v_mfma_f32_16x16x32_bf16 a[80:83], v[56:59], v[96:99], a[80:83]
 s_waitcnt lgkmcnt(4)
 v_mfma_f32_16x16x32_bf16 a[96:99], v[32:35], v[96:99], a[96:99]
 ds_read_b64_tr_b16 v[48:49], v19 offset:7200
 v_add_u32 v151, s48, v151
 v_mfma_f32_16x16x32_bf16 a[96:99], v[36:39], v[112:115], a[96:99]
 ds_read_b64_tr_b16 v[50:51], v19 offset:8992
 v_mfma_f32_16x16x32_bf16 a[100:103], v[36:39], v[116:119], a[100:103]
 v_mfma_f32_16x16x32_bf16 a[100:103], v[32:35], v[100:103], a[100:103]
 v_mfma_f32_16x16x32_bf16 a[104:107], v[32:35], v[104:107], a[104:107]
 ds_read_b64_tr_b16 v[52:53], v144 offset:7200
 v_add_u32 v152, s48, v152
 v_mfma_f32_16x16x32_bf16 a[104:107], v[36:39], v[120:123], a[104:107]
 ds_read_b64_tr_b16 v[54:55], v144 offset:8992
 v_mfma_f32_16x16x32_bf16 a[108:111], v[36:39], v[124:127], a[108:111]
 v_mfma_f32_16x16x32_bf16 a[108:111], v[32:35], v[108:111], a[108:111]
 s_waitcnt lgkmcnt(4)
 v_mfma_f32_16x16x32_bf16 a[124:127], v[40:43], v[108:111], a[124:127]
 ds_read_b64_tr_b16 v[56:57], v19 offset:7232
 s_add_u32 s45, s45, 45056
 v_mfma_f32_16x16x32_bf16 a[124:127], v[44:47], v[124:127], a[124:127]
 ds_read_b64_tr_b16 v[58:59], v19 offset:9024
 s_mov_b32 s46, 45056
 v_mfma_f32_16x16x32_bf16 a[120:123], v[44:47], v[120:123], a[120:123]
 s_cmp_ge_u32 s45, 157696
 s_cselect_b32 s46, -112640, s46
 s_cselect_b32 s50, 157696, 0
 s_sub_u32 s45, s45, s50
 v_mfma_f32_16x16x32_bf16 a[120:123], v[40:43], v[104:107], a[120:123]
 buffer_load_dwordx4 v10, s[8:11], s39 offen offset:2048  lds
 v_mfma_f32_16x16x32_bf16 a[116:119], v[40:43], v[100:103], a[116:119]
 ds_read_b64_tr_b16 v[60:61], v144 offset:7232
 v_mfma_f32_16x16x32_bf16 a[116:119], v[44:47], v[116:119], a[116:119]
 ds_read_b64_tr_b16 v[62:63], v144 offset:9024
 v_mfma_f32_16x16x32_bf16 a[112:115], v[44:47], v[112:115], a[112:115]
 v_mfma_f32_16x16x32_bf16 a[112:115], v[40:43], v[96:99], a[112:115]
 s_waitcnt lgkmcnt(4)
 v_mfma_f32_16x16x32_bf16 a[128:131], v[48:51], v[96:99], a[128:131]
 ds_read_b64_tr_b16 v[32:33], v19 offset:7264
 s_add_u32 s47, s47, 45056
 v_mfma_f32_16x16x32_bf16 a[128:131], v[52:55], v[112:115], a[128:131]
 ds_read_b64_tr_b16 v[34:35], v19 offset:9056
 s_mov_b32 s48, 45056
 v_mfma_f32_16x16x32_bf16 a[132:135], v[52:55], v[116:119], a[132:135]
 s_cmp_ge_u32 s47, 157696
 s_cselect_b32 s48, -112640, s48
 s_cselect_b32 s50, 157696, 0
 s_sub_u32 s47, s47, s50
 v_mfma_f32_16x16x32_bf16 a[132:135], v[48:51], v[100:103], a[132:135]
 v_mfma_f32_16x16x32_bf16 a[136:139], v[48:51], v[104:107], a[136:139]
 ds_read_b64_tr_b16 v[36:37], v144 offset:7264
 buffer_load_dwordx4 v11, s[8:11], s39 offen offset:3072  lds
 v_mfma_f32_16x16x32_bf16 a[136:139], v[52:55], v[120:123], a[136:139]
 ds_read_b64_tr_b16 v[38:39], v144 offset:9056
 v_mfma_f32_16x16x32_bf16 a[140:143], v[52:55], v[124:127], a[140:143]
 v_mfma_f32_16x16x32_bf16 a[140:143], v[48:51], v[108:111], a[140:143]
 s_waitcnt lgkmcnt(4)
 v_mfma_f32_16x16x32_bf16 a[156:159], v[56:59], v[108:111], a[156:159]
 ds_read_b64_tr_b16 v[40:41], v19 offset:7296
 v_mfma_f32_16x16x32_bf16 a[156:159], v[60:63], v[124:127], a[156:159]
 ds_read_b64_tr_b16 v[42:43], v19 offset:9088
 v_mfma_f32_16x16x32_bf16 a[152:155], v[60:63], v[120:123], a[152:155]
 v_mfma_f32_16x16x32_bf16 a[152:155], v[56:59], v[104:107], a[152:155]
 v_mfma_f32_16x16x32_bf16 a[148:151], v[56:59], v[100:103], a[148:151]
 ds_read_b64_tr_b16 v[44:45], v144 offset:7296
 v_mfma_f32_16x16x32_bf16 a[148:151], v[60:63], v[116:119], a[148:151]
 ds_read_b64_tr_b16 v[46:47], v144 offset:9088
 v_mfma_f32_16x16x32_bf16 a[144:147], v[60:63], v[112:115], a[144:147]
 v_mfma_f32_16x16x32_bf16 a[144:147], v[56:59], v[96:99], a[144:147]
 s_waitcnt lgkmcnt(4)
 v_mfma_f32_16x16x32_bf16 a[160:163], v[32:35], v[96:99], a[160:163]
 ds_read_b64_tr_b16 v[48:49], v19 offset:7328
 s_add_u32 m0, m0, 4096
 v_mfma_f32_16x16x32_bf16 a[160:163], v[36:39], v[112:115], a[160:163]
 ds_read_b64_tr_b16 v[50:51], v19 offset:9120
 v_mfma_f32_16x16x32_bf16 a[164:167], v[36:39], v[116:119], a[164:167]
 buffer_load_dwordx4 v12, s[8:11], s39 offen  lds
 v_mfma_f32_16x16x32_bf16 a[164:167], v[32:35], v[100:103], a[164:167]
 v_mfma_f32_16x16x32_bf16 a[168:171], v[32:35], v[104:107], a[168:171]
 ds_read_b64_tr_b16 v[52:53], v144 offset:7328
 v_mfma_f32_16x16x32_bf16 a[168:171], v[36:39], v[120:123], a[168:171]
 ds_read_b64_tr_b16 v[54:55], v144 offset:9120
 v_mfma_f32_16x16x32_bf16 a[172:175], v[36:39], v[124:127], a[172:175]
 v_mfma_f32_16x16x32_bf16 a[172:175], v[32:35], v[108:111], a[172:175]
 s_waitcnt lgkmcnt(4)
 v_mfma_f32_16x16x32_bf16 a[188:191], v[40:43], v[108:111], a[188:191]
 ds_read_b64_tr_b16 v[56:57], v19 offset:7360
 v_mfma_f32_16x16x32_bf16 a[188:191], v[44:47], v[124:127], a[188:191]
 ds_read_b64_tr_b16 v[58:59], v19 offset:9152
 v_mfma_f32_16x16x32_bf16 a[184:187], v[44:47], v[120:123], a[184:187]
 v_mfma_f32_16x16x32_bf16 a[184:187], v[40:43], v[104:107], a[184:187]
 v_mfma_f32_16x16x32_bf16 a[180:183], v[40:43], v[100:103], a[180:183]
 ds_read_b64_tr_b16 v[60:61], v144 offset:7360
 buffer_load_dwordx4 v13, s[8:11], s39 offen offset:1024  lds
 v_mfma_f32_16x16x32_bf16 a[180:183], v[44:47], v[116:119], a[180:183]
 ds_read_b64_tr_b16 v[62:63], v144 offset:9152
 v_mfma_f32_16x16x32_bf16 a[176:179], v[44:47], v[112:115], a[176:179]
 v_mfma_f32_16x16x32_bf16 a[176:179], v[40:43], v[96:99], a[176:179]
 s_waitcnt lgkmcnt(4)
 v_mfma_f32_16x16x32_bf16 a[192:195], v[48:51], v[96:99], a[192:195]
 ds_read_b64_tr_b16 v[32:33], v20
 v_mfma_f32_16x16x32_bf16 a[192:195], v[52:55], v[112:115], a[192:195]
 ds_read_b64_tr_b16 v[34:35], v20 offset:1024
 v_mfma_f32_16x16x32_bf16 a[196:199], v[52:55], v[116:119], a[196:199]
 v_mfma_f32_16x16x32_bf16 a[196:199], v[48:51], v[100:103], a[196:199]
 v_mfma_f32_16x16x32_bf16 a[200:203], v[48:51], v[104:107], a[200:203]
 ds_read_b64_tr_b16 v[36:37], v145
 v_mfma_f32_16x16x32_bf16 a[200:203], v[52:55], v[120:123], a[200:203]
 ds_read_b64_tr_b16 v[38:39], v145 offset:1024
 v_mfma_f32_16x16x32_bf16 a[204:207], v[52:55], v[124:127], a[204:207]
 v_add_u32 v19, s46, v19
 v_mfma_f32_16x16x32_bf16 a[204:207], v[48:51], v[108:111], a[204:207]
 s_waitcnt lgkmcnt(4)
 v_mfma_f32_16x16x32_bf16 a[220:223], v[56:59], v[108:111], a[220:223]
 ds_read_b64_tr_b16 v[40:41], v21
 buffer_load_dwordx4 v14, s[8:11], s39 offen offset:2048  lds
 v_mfma_f32_16x16x32_bf16 a[220:223], v[60:63], v[124:127], a[220:223]
 ds_read_b64_tr_b16 v[42:43], v21 offset:1024
 s_add_u32 s39, s39, 458752
 v_mfma_f32_16x16x32_bf16 a[216:219], v[60:63], v[120:123], a[216:219]
 s_add_u32 s43, s43, 45056
 v_add_u32 v144, s48, v144
 v_mfma_f32_16x16x32_bf16 a[216:219], v[56:59], v[104:107], a[216:219]
 s_cmp_ge_u32 s43, 157696
 s_cselect_b32 s50, 157696, 0
 s_sub_u32 s43, s43, s50
 v_mfma_f32_16x16x32_bf16 a[212:215], v[56:59], v[100:103], a[212:215]
 ds_read_b64_tr_b16 v[44:45], v146
 v_mfma_f32_16x16x32_bf16 a[212:215], v[60:63], v[116:119], a[212:215]
 ds_read_b64_tr_b16 v[46:47], v146 offset:1024
 v_mfma_f32_16x16x32_bf16 a[208:211], v[60:63], v[112:115], a[208:211]
 v_mfma_f32_16x16x32_bf16 a[208:211], v[56:59], v[96:99], a[208:211]
 s_waitcnt lgkmcnt(4)
 v_mfma_f32_16x16x32_bf16 a[224:227], v[32:35], v[96:99], a[224:227]
 ds_read_b64_tr_b16 v[48:49], v22
 v_mfma_f32_16x16x32_bf16 a[224:227], v[36:39], v[112:115], a[224:227]
 ds_read_b64_tr_b16 v[50:51], v22 offset:1024
 v_mfma_f32_16x16x32_bf16 a[228:231], v[36:39], v[116:119], a[228:231]
 v_mfma_f32_16x16x32_bf16 a[228:231], v[32:35], v[100:103], a[228:231]
 v_mfma_f32_16x16x32_bf16 a[232:235], v[32:35], v[104:107], a[232:235]
 ds_read_b64_tr_b16 v[52:53], v147
 s_add_u32 m0, s44, s3
 v_mfma_f32_16x16x32_bf16 a[232:235], v[36:39], v[120:123], a[232:235]
 ds_read_b64_tr_b16 v[54:55], v147 offset:1024
 v_mfma_f32_16x16x32_bf16 a[236:239], v[36:39], v[124:127], a[236:239]
 buffer_load_dwordx4 v15, s[12:15], s40 offen  lds
 v_mfma_f32_16x16x32_bf16 a[236:239], v[32:35], v[108:111], a[236:239]
 s_waitcnt lgkmcnt(4)
 v_mfma_f32_16x16x32_bf16 a[252:255], v[40:43], v[108:111], a[252:255]
 ds_read_b64_tr_b16 v[56:57], v23
 v_mfma_f32_16x16x32_bf16 a[252:255], v[44:47], v[124:127], a[252:255]
 ds_read_b64_tr_b16 v[58:59], v23 offset:1024
 v_mfma_f32_16x16x32_bf16 a[248:251], v[44:47], v[120:123], a[248:251]
 v_mfma_f32_16x16x32_bf16 a[248:251], v[40:43], v[104:107], a[248:251]
 v_mfma_f32_16x16x32_bf16 a[244:247], v[40:43], v[100:103], a[244:247]
 ds_read_b64_tr_b16 v[60:61], v148
 v_mfma_f32_16x16x32_bf16 a[244:247], v[44:47], v[116:119], a[244:247]
 ds_read_b64_tr_b16 v[62:63], v148 offset:1024
 v_mfma_f32_16x16x32_bf16 a[240:243], v[44:47], v[112:115], a[240:243]
 v_mfma_f32_16x16x32_bf16 a[240:243], v[40:43], v[96:99], a[240:243]
 s_waitcnt lgkmcnt(4)
 v_mfma_f32_16x16x32_bf16 v[160:163], v[48:51], v[96:99], v[160:163]
 ds_read_b64_tr_b16 v[32:33], v24
 buffer_load_dwordx4 v16, s[12:15], s40 offen offset:1024  lds
 v_mfma_f32_16x16x32_bf16 v[160:163], v[52:55], v[112:115], v[160:163]
 ds_read_b64_tr_b16 v[34:35], v24 offset:1024
 v_mfma_f32_16x16x32_bf16 v[164:167], v[52:55], v[116:119], v[164:167]
 v_mfma_f32_16x16x32_bf16 v[164:167], v[48:51], v[100:103], v[164:167]
 v_mfma_f32_16x16x32_bf16 v[168:171], v[48:51], v[104:107], v[168:171]
 ds_read_b64_tr_b16 v[36:37], v149
 v_mfma_f32_16x16x32_bf16 v[168:171], v[52:55], v[120:123], v[168:171]
 ds_read_b64_tr_b16 v[38:39], v149 offset:1024
 v_mfma_f32_16x16x32_bf16 v[172:175], v[52:55], v[124:127], v[172:175]
 v_mfma_f32_16x16x32_bf16 v[172:175], v[48:51], v[108:111], v[172:175]
 s_waitcnt lgkmcnt(4)
 v_mfma_f32_16x16x32_bf16 v[188:191], v[56:59], v[108:111], v[188:191]
 ds_read_b64_tr_b16 v[40:41], v25
 v_mfma_f32_16x16x32_bf16 v[188:191], v[60:63], v[124:127], v[188:191]
 ds_read_b64_tr_b16 v[42:43], v25 offset:1024
 v_mfma_f32_16x16x32_bf16 v[184:187], v[60:63], v[120:123], v[184:187]
 v_mfma_f32_16x16x32_bf16 v[184:187], v[56:59], v[104:107], v[184:187]
 v_mfma_f32_16x16x32_bf16 v[180:183], v[56:59], v[100:103], v[180:183]
 ds_read_b64_tr_b16 v[44:45], v150
 buffer_load_dwordx4 v17, s[12:15], s40 offen offset:2048  lds
 v_mfma_f32_16x16x32_bf16 v[180:183], v[60:63], v[116:119], v[180:183]
 ds_read_b64_tr_b16 v[46:47], v150 offset:1024
 v_mfma_f32_16x16x32_bf16 v[176:179], v[60:63], v[112:115], v[176:179]
 v_mfma_f32_16x16x32_bf16 v[176:179], v[56:59], v[96:99], v[176:179]
 s_waitcnt lgkmcnt(4)
 v_mfma_f32_16x16x32_bf16 v[192:195], v[32:35], v[96:99], v[192:195]
 ds_read_b64_tr_b16 v[48:49], v26
 v_mfma_f32_16x16x32_bf16 v[192:195], v[36:39], v[112:115], v[192:195]
 ds_read_b64_tr_b16 v[50:51], v26 offset:1024
 v_mfma_f32_16x16x32_bf16 v[196:199], v[36:39], v[116:119], v[196:199]
 v_mfma_f32_16x16x32_bf16 v[196:199], v[32:35], v[100:103], v[196:199]
 v_mfma_f32_16x16x32_bf16 v[200:203], v[32:35], v[104:107], v[200:203]
 ds_read_b64_tr_b16 v[56:57], v27
 v_mfma_f32_16x16x32_bf16 v[200:203], v[36:39], v[120:123], v[200:203]
 ds_read_b64_tr_b16 v[58:59], v27 offset:1024
 v_mfma_f32_16x16x32_bf16 v[204:207], v[36:39], v[124:127], v[204:207]
 v_mfma_f32_16x16x32_bf16 v[204:207], v[32:35], v[108:111], v[204:207]
 s_waitcnt lgkmcnt(4)
 v_mfma_f32_16x16x32_bf16 v[220:223], v[40:43], v[108:111], v[220:223]
 ds_read_b64_tr_b16 v[52:53], v151
 buffer_load_dwordx4 v18, s[12:15], s40 offen offset:3072  lds
 v_mfma_f32_16x16x32_bf16 v[220:223], v[44:47], v[124:127], v[220:223]
 ds_read_b64_tr_b16 v[54:55], v151 offset:1024
 s_add_u32 s40, s40, 524288
 v_mfma_f32_16x16x32_bf16 v[216:219], v[44:47], v[120:123], v[216:219]
 s_add_u32 s44, s44, 45056
 s_cmp_ge_u32 s44, 157696
 s_cselect_b32 s50, 157696, 0
 s_sub_u32 s44, s44, s50
 v_mfma_f32_16x16x32_bf16 v[216:219], v[40:43], v[104:107], v[216:219]
 v_mfma_f32_16x16x32_bf16 v[212:215], v[40:43], v[100:103], v[212:215]
 ds_read_b64_tr_b16 v[60:61], v152
 v_mfma_f32_16x16x32_bf16 v[212:215], v[44:47], v[116:119], v[212:215]
 ds_read_b64_tr_b16 v[62:63], v152 offset:1024
 v_mfma_f32_16x16x32_bf16 v[208:211], v[44:47], v[112:115], v[208:211]
 v_mfma_f32_16x16x32_bf16 v[208:211], v[40:43], v[96:99], v[208:211]
 s_waitcnt lgkmcnt(2)
 s_waitcnt vmcnt(22)
 s_waitcnt vmcnt(13)
 s_barrier
 v_mfma_f32_16x16x32_bf16 v[224:227], v[48:51], v[96:99], v[224:227]
 ds_read_b64_tr_b16 v[32:33], v19
 v_mfma_f32_16x16x32_bf16 v[224:227], v[52:55], v[112:115], v[224:227]
 ds_read_b64_tr_b16 v[34:35], v19 offset:1792
 v_mfma_f32_16x16x32_bf16 v[228:231], v[52:55], v[116:119], v[228:231]
 v_mfma_f32_16x16x32_bf16 v[228:231], v[48:51], v[100:103], v[228:231]
 v_mfma_f32_16x16x32_bf16 v[232:235], v[48:51], v[104:107], v[232:235]
 ds_read_b64_tr_b16 v[36:37], v144
 v_mfma_f32_16x16x32_bf16 v[232:235], v[52:55], v[120:123], v[232:235]
 ds_read_b64_tr_b16 v[38:39], v144 offset:1792
 v_mfma_f32_16x16x32_bf16 v[236:239], v[52:55], v[124:127], v[236:239]
 v_mfma_f32_16x16x32_bf16 v[236:239], v[48:51], v[108:111], v[236:239]
 s_waitcnt lgkmcnt(4)
 v_mfma_f32_16x16x32_bf16 v[252:255], v[56:59], v[108:111], v[252:255]
 ds_read_b64_tr_b16 v[40:41], v19 offset:32
 v_add_u32 v20, s46, v20
 v_mfma_f32_16x16x32_bf16 v[252:255], v[60:63], v[124:127], v[252:255]
 ds_read_b64_tr_b16 v[42:43], v19 offset:1824
 v_mfma_f32_16x16x32_bf16 v[248:251], v[60:63], v[120:123], v[248:251]
 v_mfma_f32_16x16x32_bf16 v[248:251], v[56:59], v[104:107], v[248:251]
 v_mfma_f32_16x16x32_bf16 v[244:247], v[56:59], v[100:103], v[244:247]
 ds_read_b64_tr_b16 v[44:45], v144 offset:32
 v_add_u32 v21, s46, v21
 v_mfma_f32_16x16x32_bf16 v[244:247], v[60:63], v[116:119], v[244:247]
 ds_read_b64_tr_b16 v[46:47], v144 offset:1824
 s_sub_u32 s42, s42, 1
 v_mfma_f32_16x16x32_bf16 v[240:243], v[60:63], v[112:115], v[240:243]
 s_cmp_lg_u32 s42, 0
 v_mfma_f32_16x16x32_bf16 v[240:243], v[56:59], v[96:99], v[240:243]
 s_waitcnt lgkmcnt(4)
 s_cbranch_scc1 G_loop
 v_mfma_f32_16x16x32_bf16 a[0:3], v[32:35], v[64:67], a[0:3]
 ds_read_b64_tr_b16 v[48:49], v19 offset:64
 v_add_u32 v22, s46, v22
 v_mfma_f32_16x16x32_bf16 a[0:3], v[36:39], v[80:83], a[0:3]
 ds_read_b64_tr_b16 v[50:51], v19 offset:1856
 buffer_load_dwordx4 v[96:99], v4, s[16:19], s41 offen sc1
 v_mfma_f32_16x16x32_bf16 a[4:7], v[36:39], v[84:87], a[4:7]
 v_mfma_f32_16x16x32_bf16 a[4:7], v[32:35], v[68:71], a[4:7]
 v_mfma_f32_16x16x32_bf16 a[8:11], v[32:35], v[72:75], a[8:11]
 ds_read_b64_tr_b16 v[52:53], v144 offset:64
 v_add_u32 v23, s46, v23
 v_mfma_f32_16x16x32_bf16 a[8:11], v[36:39], v[88:91], a[8:11]
 ds_read_b64_tr_b16 v[54:55], v144 offset:1856
 buffer_load_dwordx4 v[100:103], v5, s[16:19], s41 offen sc1
 v_mfma_f32_16x16x32_bf16 a[12:15], v[36:39], v[92:95], a[12:15]
 v_mfma_f32_16x16x32_bf16 a[12:15], v[32:35], v[76:79], a[12:15]
 s_waitcnt lgkmcnt(4)
 v_mfma_f32_16x16x32_bf16 a[28:31], v[40:43], v[76:79], a[28:31]
 ds_read_b64_tr_b16 v[56:57], v19 offset:96
 v_add_u32 v24, s46, v24
 v_mfma_f32_16x16x32_bf16 a[28:31], v[44:47], v[92:95], a[28:31]
 ds_read_b64_tr_b16 v[58:59], v19 offset:1888
 buffer_load_dwordx4 v[104:107], v6, s[16:19], s41 offen sc1
 v_mfma_f32_16x16x32_bf16 a[24:27], v[44:47], v[88:91], a[24:27]
 v_mfma_f32_16x16x32_bf16 a[24:27], v[40:43], v[72:75], a[24:27]
 v_mfma_f32_16x16x32_bf16 a[20:23], v[40:43], v[68:71], a[20:23]
 ds_read_b64_tr_b16 v[60:61], v144 offset:96
 v_add_u32 v25, s46, v25
 v_mfma_f32_16x16x32_bf16 a[20:23], v[44:47], v[84:87], a[20:23]
 ds_read_b64_tr_b16 v[62:63], v144 offset:1888
 buffer_load_dwordx4 v[108:111], v7, s[16:19], s41 offen sc1
 v_mfma_f32_16x16x32_bf16 a[16:19], v[44:47], v[80:83], a[16:19]
 v_mfma_f32_16x16x32_bf16 a[16:19], v[40:43], v[64:67], a[16:19]
 s_waitcnt lgkmcnt(4)
 v_mfma_f32_16x16x32_bf16 a[32:35], v[48:51], v[64:67], a[32:35]
 ds_read_b64_tr_b16 v[32:33], v19 offset:128
 v_add_u32 v26, s46, v26
 v_mfma_f32_16x16x32_bf16 a[32:35], v[52:55], v[80:83], a[32:35]
 ds_read_b64_tr_b16 v[34:35], v19 offset:1920
 buffer_load_dwordx4 v[112:115], v4, s[16:19], s41 offen offset:1024 sc1
 v_mfma_f32_16x16x32_bf16 a[36:39], v[52:55], v[84:87], a[36:39]
 v_mfma_f32_16x16x32_bf16 a[36:39], v[48:51], v[68:71], a[36:39]
 v_mfma_f32_16x16x32_bf16 a[40:43], v[48:51], v[72:75], a[40:43]
 ds_read_b64_tr_b16 v[36:37], v144 offset:128
 v_add_u32 v27, s46, v27
 v_mfma_f32_16x16x32_bf16 a[40:43], v[52:55], v[88:91], a[40:43]
 ds_read_b64_tr_b16 v[38:39], v144 offset:1920
 buffer_load_dwordx4 v[116:119], v5, s[16:19], s41 offen offset:1024 sc1
 v_mfma_f32_16x16x32_bf16 a[44:47], v[52:55], v[92:95], a[44:47]
 v_mfma_f32_16x16x32_bf16 a[44:47], v[48:51], v[76:79], a[44:47]
 s_waitcnt lgkmcnt(4)
 v_mfma_f32_16x16x32_bf16 a[60:63], v[56:59], v[76:79], a[60:63]
 ds_read_b64_tr_b16 v[40:41], v19 offset:160
 v_add_u32 v145, s48, v145
 v_mfma_f32_16x16x32_bf16 a[60:63], v[60:63], v[92:95], a[60:63]
 ds_read_b64_tr_b16 v[42:43], v19 offset:1952
 buffer_load_dwordx4 v[120:123], v6, s[16:19], s41 offen offset:1024 sc1
 v_mfma_f32_16x16x32_bf16 a[56:59], v[60:63], v[88:91], a[56:59]
 v_mfma_f32_16x16x32_bf16 a[56:59], v[56:59], v[72:75], a[56:59]
 v_mfma_f32_16x16x32_bf16 a[52:55], v[56:59], v[68:71], a[52:55]
 ds_read_b64_tr_b16 v[44:45], v144 offset:160
 v_add_u32 v146, s48, v146
 v_mfma_f32_16x16x32_bf16 a[52:55], v[60:63], v[84:87], a[52:55]
 ds_read_b64_tr_b16 v[46:47], v144 offset:1952
 buffer_load_dwordx4 v[124:127], v7, s[16:19], s41 offen offset:1024 sc1
 v_mfma_f32_16x16x32_bf16 a[48:51], v[60:63], v[80:83], a[48:51]
 s_add_u32 s41, s41, 2048
 s_cmp_eq_u32 s41, 32768
 s_cselect_b32 s18, 0, s18
 v_mfma_f32_16x16x32_bf16 a[48:51], v[56:59], v[64:67], a[48:51]
 s_waitcnt lgkmcnt(4)
 v_mfma_f32_16x16x32_bf16 a[64:67], v[32:35], v[64:67], a[64:67]
 ds_read_b64_tr_b16 v[48:49], v19 offset:192
 v_add_u32 v147, s48, v147
 v_mfma_f32_16x16x32_bf16 a[64:67], v[36:39], v[80:83], a[64:67]
 ds_read_b64_tr_b16 v[50:51], v19 offset:1984
 v_mfma_f32_16x16x32_bf16 a[68:71], v[36:39], v[84:87], a[68:71]
 v_mfma_f32_16x16x32_bf16 a[68:71], v[32:35], v[68:71], a[68:71]
 v_mfma_f32_16x16x32_bf16 a[72:75], v[32:35], v[72:75], a[72:75]
 ds_read_b64_tr_b16 v[52:53], v144 offset:192
 v_add_u32 v148, s48, v148
 v_mfma_f32_16x16x32_bf16 a[72:75], v[36:39], v[88:91], a[72:75]
 ds_read_b64_tr_b16 v[54:55], v144 offset:1984
 v_mfma_f32_16x16x32_bf16 a[76:79], v[36:39], v[92:95], a[76:79]
 v_mfma_f32_16x16x32_bf16 a[76:79], v[32:35], v[76:79], a[76:79]
 s_waitcnt lgkmcnt(4)
 v_mfma_f32_16x16x32_bf16 a[92:95], v[40:43], v[76:79], a[92:95]
 ds_read_b64_tr_b16 v[56:57], v19 offset:7168
 v_add_u32 v149, s48, v149
 v_mfma_f32_16x16x32_bf16 a[92:95], v[44:47], v[92:95], a[92:95]
 ds_read_b64_tr_b16 v[58:59], v19 offset:8960
 v_mfma_f32_16x16x32_bf16 a[88:91], v[44:47], v[88:91], a[88:91]
 v_mfma_f32_16x16x32_bf16 a[88:91], v[40:43], v[72:75], a[88:91]
 v_mfma_f32_16x16x32_bf16 a[84:87], v[40:43], v[68:71], a[84:87]
 ds_read_b64_tr_b16 v[60:61], v144 offset:7168
 v_add_u32 v150, s48, v150
 v_mfma_f32_16x16x32_bf16 a[84:87], v[44:47], v[84:87], a[84:87]
 ds_read_b64_tr_b16 v[62:63], v144 offset:8960
 v_mfma_f32_16x16x32_bf16 a[80:83], v[44:47], v[80:83], a[80:83]
 v_mfma_f32_16x16x32_bf16 a[80:83], v[40:43], v[64:67], a[80:83]
 s_waitcnt lgkmcnt(4)
 v_mfma_f32_16x16x32_bf16 a[96:99], v[48:51], v[64:67], a[96:99]
 ds_read_b64_tr_b16 v[32:33], v19 offset:7200
 v_add_u32 v151, s48, v151
 v_mfma_f32_16x16x32_bf16 a[96:99], v[52:55], v[80:83], a[96:99]
 ds_read_b64_tr_b16 v[34:35], v19 offset:8992
 v_mfma_f32_16x16x32_bf16 a[100:103], v[52:55], v[84:87], a[100:103]
 v_mfma_f32_16x16x32_bf16 a[100:103], v[48:51], v[68:71], a[100:103]
 v_mfma_f32_16x16x32_bf16 a[104:107], v[48:51], v[72:75], a[104:107]
 ds_read_b64_tr_b16 v[36:37], v144 offset:7200
 v_add_u32 v152, s48, v152
 v_mfma_f32_16x16x32_bf16 a[104:107], v[52:55], v[88:91], a[104:107]
 ds_read_b64_tr_b16 v[38:39], v144 offset:8992
 v_mfma_f32_16x16x32_bf16 a[108:111], v[52:55], v[92:95], a[108:111]
 v_mfma_f32_16x16x32_bf16 a[108:111], v[48:51], v[76:79], a[108:111]
 s_waitcnt lgkmcnt(4)
 v_mfma_f32_16x16x32_bf16 a[124:127], v[56:59], v[76:79], a[124:127]
 ds_read_b64_tr_b16 v[40:41], v19 offset:7232
 s_add_u32 s45, s45, 45056
 v_mfma_f32_16x16x32_bf16 a[124:127], v[60:63], v[92:95], a[124:127]
 ds_read_b64_tr_b16 v[42:43], v19 offset:9024
 s_mov_b32 s46, 45056
 v_mfma_f32_16x16x32_bf16 a[120:123], v[60:63], v[88:91], a[120:123]
 s_cmp_ge_u32 s45, 157696
 s_cselect_b32 s46, -112640, s46
 s_cselect_b32 s50, 157696, 0
 s_sub_u32 s45, s45, s50
 v_mfma_f32_16x16x32_bf16 a[120:123], v[56:59], v[72:75], a[120:123]
 v_mfma_f32_16x16x32_bf16 a[116:119], v[56:59], v[68:71], a[116:119]
 ds_read_b64_tr_b16 v[44:45], v144 offset:7232
 v_mfma_f32_16x16x32_bf16 a[116:119], v[60:63], v[84:87], a[116:119]
 ds_read_b64_tr_b16 v[46:47], v144 offset:9024
 v_mfma_f32_16x16x32_bf16 a[112:115], v[60:63], v[80:83], a[112:115]
 v_mfma_f32_16x16x32_bf16 a[112:115], v[56:59], v[64:67], a[112:115]
 s_waitcnt lgkmcnt(4)
 v_mfma_f32_16x16x32_bf16 a[128:131], v[32:35], v[64:67], a[128:131]
 ds_read_b64_tr_b16 v[48:49], v19 offset:7264
 s_add_u32 s47, s47, 45056
 v_mfma_f32_16x16x32_bf16 a[128:131], v[36:39], v[80:83], a[128:131]
 ds_read_b64_tr_b16 v[50:51], v19 offset:9056
 s_mov_b32 s48, 45056
 v_mfma_f32_16x16x32_bf16 a[132:135], v[36:39], v[84:87], a[132:135]
 s_cmp_ge_u32 s47, 157696
 s_cselect_b32 s48, -112640, s48
 s_cselect_b32 s50, 157696, 0
 s_sub_u32 s47, s47, s50
 v_mfma_f32_16x16x32_bf16 a[132:135], v[32:35], v[68:71], a[132:135]
 v_mfma_f32_16x16x32_bf16 a[136:139], v[32:35], v[72:75], a[136:139]
 ds_read_b64_tr_b16 v[52:53], v144 offset:7264
 v_mfma_f32_16x16x32_bf16 a[136:139], v[36:39], v[88:91], a[136:139]
 ds_read_b64_tr_b16 v[54:55], v144 offset:9056
 v_mfma_f32_16x16x32_bf16 a[140:143], v[36:39], v[92:95], a[140:143]
 v_mfma_f32_16x16x32_bf16 a[140:143], v[32:35], v[76:79], a[140:143]
 s_waitcnt lgkmcnt(4)
 v_mfma_f32_16x16x32_bf16 a[156:159], v[40:43], v[76:79], a[156:159]
 ds_read_b64_tr_b16 v[56:57], v19 offset:7296
 v_mfma_f32_16x16x32_bf16 a[156:159], v[44:47], v[92:95], a[156:159]
 ds_read_b64_tr_b16 v[58:59], v19 offset:9088
 v_mfma_f32_16x16x32_bf16 a[152:155], v[44:47], v[88:91], a[152:155]
 v_mfma_f32_16x16x32_bf16 a[152:155], v[40:43], v[72:75], a[152:155]
 v_mfma_f32_16x16x32_bf16 a[148:151], v[40:43], v[68:71], a[148:151]
 ds_read_b64_tr_b16 v[60:61], v144 offset:7296
 s_add_u32 s32, s86, 0x500000
 s_addc_u32 s33, s87, 0
 v_mfma_f32_16x16x32_bf16 a[148:151], v[44:47], v[84:87], a[148:151]
 ds_read_b64_tr_b16 v[62:63], v144 offset:9088
 s_mov_b32 s34, 0x1100000
 v_mfma_f32_16x16x32_bf16 a[144:147], v[44:47], v[80:83], a[144:147]
 s_mov_b32 s35, 0x20000
 v_lshrrev_b32 v128, 4, v1
 v_mfma_f32_16x16x32_bf16 a[144:147], v[40:43], v[64:67], a[144:147]
 s_waitcnt lgkmcnt(4)
 v_and_b32 v129, 15, v1
 v_mfma_f32_16x16x32_bf16 a[160:163], v[48:51], v[64:67], a[160:163]
 ds_read_b64_tr_b16 v[32:33], v19 offset:7328
 s_lshl_b32 s40, s36, 12
 v_mfma_f32_16x16x32_bf16 a[160:163], v[52:55], v[80:83], a[160:163]
 ds_read_b64_tr_b16 v[34:35], v19 offset:9120
 v_lshlrev_b32 v130, 8, v128
 v_mfma_f32_16x16x32_bf16 a[164:167], v[52:55], v[84:87], a[164:167]
 v_add_u32 v130, s40, v130
 v_add_u32 v131, 0, v128
 v_mfma_f32_16x16x32_bf16 a[164:167], v[48:51], v[68:71], a[164:167]
 v_xor_b32 v131, v131, v129
 v_lshl_add_u32 v8, v131, 4, v130
 v_mfma_f32_16x16x32_bf16 a[168:171], v[48:51], v[72:75], a[168:171]
 ds_read_b64_tr_b16 v[36:37], v144 offset:7328
 v_add_u32 v131, 4, v128
 v_mfma_f32_16x16x32_bf16 a[168:171], v[52:55], v[88:91], a[168:171]
 ds_read_b64_tr_b16 v[38:39], v144 offset:9120
 v_xor_b32 v131, v131, v129
 v_mfma_f32_16x16x32_bf16 a[172:175], v[52:55], v[92:95], a[172:175]
 v_lshl_add_u32 v9, v131, 4, v130
 v_add_u32 v131, 8, v128
 v_mfma_f32_16x16x32_bf16 a[172:175], v[48:51], v[76:79], a[172:175]
 s_waitcnt lgkmcnt(4)
 v_xor_b32 v131, v131, v129
 v_mfma_f32_16x16x32_bf16 a[188:191], v[56:59], v[76:79], a[188:191]
 ds_read_b64_tr_b16 v[40:41], v19 offset:7360
 v_lshl_add_u32 v10, v131, 4, v130
 v_mfma_f32_16x16x32_bf16 a[188:191], v[60:63], v[92:95], a[188:191]
 ds_read_b64_tr_b16 v[42:43], v19 offset:9152
 v_add_u32 v131, 12, v128
 v_mfma_f32_16x16x32_bf16 a[184:187], v[60:63], v[88:91], a[184:187]
 v_xor_b32 v131, v131, v129
 v_lshl_add_u32 v11, v131, 4, v130
 v_mfma_f32_16x16x32_bf16 a[184:187], v[56:59], v[72:75], a[184:187]
 v_lshlrev_b32 v131, 1, v128
 v_xor_b32 v131, v131, v129
 v_mfma_f32_16x16x32_bf16 a[180:183], v[56:59], v[68:71], a[180:183]
 ds_read_b64_tr_b16 v[44:45], v144 offset:7360
 v_lshl_add_u32 v12, v131, 4, v130
 v_mfma_f32_16x16x32_bf16 a[180:183], v[60:63], v[84:87], a[180:183]
 ds_read_b64_tr_b16 v[46:47], v144 offset:9152
 v_xor_b32 v13, 128, v12
 v_mfma_f32_16x16x32_bf16 a[176:179], v[60:63], v[80:83], a[176:179]
 s_lshr_b32 s39, s38, 3
 s_lshl_b32 s39, s39, 19
 v_mfma_f32_16x16x32_bf16 a[176:179], v[56:59], v[64:67], a[176:179]
 s_waitcnt lgkmcnt(4)
 s_add_u32 s39, s39, 393216
 v_mfma_f32_16x16x32_bf16 a[192:195], v[32:35], v[64:67], a[192:195]
 ds_read_b64_tr_b16 v[48:49], v20
 v_mov_b32 v28, 0xc0135761
 v_mfma_f32_16x16x32_bf16 a[192:195], v[36:39], v[80:83], a[192:195]
 ds_read_b64_tr_b16 v[50:51], v20 offset:1024
 v_mov_b32 v29, 0xc0135761
 v_mfma_f32_16x16x32_bf16 a[196:199], v[36:39], v[84:87], a[196:199]
 v_mov_b32 v30, 0xbdd2d3e8
 v_mov_b32 v31, 0xbdd2d3e8
 v_mfma_f32_16x16x32_bf16 a[196:199], v[32:35], v[68:71], a[196:199]
 s_lshl_b32 s52, s37, 4
 s_lshl_b32 s53, s36, 2
 v_mfma_f32_16x16x32_bf16 a[200:203], v[32:35], v[72:75], a[200:203]
 ds_read_b64_tr_b16 v[52:53], v145
 s_add_u32 s52, s52, s53
 v_mfma_f32_16x16x32_bf16 a[200:203], v[36:39], v[88:91], a[200:203]
 ds_read_b64_tr_b16 v[54:55], v145 offset:1024
 s_mul_i32 s52, s52, 114688
 v_mfma_f32_16x16x32_bf16 a[204:207], v[36:39], v[92:95], a[204:207]
 s_mul_i32 s53, s38, 7
 v_add_u32 v19, s46, v19
 v_mfma_f32_16x16x32_bf16 a[204:207], v[32:35], v[76:79], a[204:207]
 s_waitcnt lgkmcnt(4)
 s_add_u32 s53, s53, 1
 v_mfma_f32_16x16x32_bf16 a[220:223], v[40:43], v[76:79], a[220:223]
 ds_read_b64_tr_b16 v[56:57], v21
 s_lshr_b32 s53, s53, 1
 v_mfma_f32_16x16x32_bf16 a[220:223], v[44:47], v[92:95], a[220:223]
 ds_read_b64_tr_b16 v[58:59], v21 offset:1024
 s_lshl_b32 s53, s53, 10
 v_mfma_f32_16x16x32_bf16 a[216:219], v[44:47], v[88:91], a[216:219]
 s_add_u32 s52, s52, s53
 v_add_u32 v144, s48, v144
 v_mfma_f32_16x16x32_bf16 a[216:219], v[40:43], v[72:75], a[216:219]
 v_lshlrev_b32 v128, 4, v1
 v_add_u32 v4, s52, v128
 v_mfma_f32_16x16x32_bf16 a[212:215], v[40:43], v[68:71], a[212:215]
 ds_read_b64_tr_b16 v[60:61], v146
 v_add_u32 v5, 0x1c000, v4
 v_mfma_f32_16x16x32_bf16 a[212:215], v[44:47], v[84:87], a[212:215]
 ds_read_b64_tr_b16 v[62:63], v146 offset:1024
 v_add_u32 v6, 0x38000, v4
 v_mfma_f32_16x16x32_bf16 a[208:211], v[44:47], v[80:83], a[208:211]
 s_and_b32 s53, s38, 1
 v_add_u32 v7, 0x54000, v4
 v_mfma_f32_16x16x32_bf16 a[208:211], v[40:43], v[64:67], a[208:211]
 s_waitcnt lgkmcnt(4)
 s_mul_i32 s54, s53, -4088
 v_mfma_f32_16x16x32_bf16 a[224:227], v[48:51], v[64:67], a[224:227]
 ds_read_b64_tr_b16 v[32:33], v22
 s_add_u32 s54, s54, 3072
 v_mfma_f32_16x16x32_bf16 a[224:227], v[52:55], v[80:83], a[224:227]
 ds_read_b64_tr_b16 v[34:35], v22 offset:1024
 v_add_u32 v132, s54, v4
 v_mfma_f32_16x16x32_bf16 a[228:231], v[52:55], v[84:87], a[228:231]
 v_add_u32 v133, s54, v5
 v_add_u32 v134, s54, v6
 v_mfma_f32_16x16x32_bf16 a[228:231], v[48:51], v[68:71], a[228:231]
 v_add_u32 v135, s54, v7
 v_mfma_f32_16x16x32_bf16 a[232:235], v[48:51], v[72:75], a[232:235]
 ds_read_b64_tr_b16 v[36:37], v147
 v_mfma_f32_16x16x32_bf16 a[232:235], v[52:55], v[88:91], a[232:235]
 ds_read_b64_tr_b16 v[38:39], v147 offset:1024
 v_mfma_f32_16x16x32_bf16 a[236:239], v[52:55], v[92:95], a[236:239]
 v_mfma_f32_16x16x32_bf16 a[236:239], v[48:51], v[76:79], a[236:239]
 s_waitcnt lgkmcnt(4)
 v_mfma_f32_16x16x32_bf16 a[252:255], v[56:59], v[76:79], a[252:255]
 ds_read_b64_tr_b16 v[40:41], v23
 v_mfma_f32_16x16x32_bf16 a[252:255], v[60:63], v[92:95], a[252:255]
 ds_read_b64_tr_b16 v[42:43], v23 offset:1024
 v_mfma_f32_16x16x32_bf16 a[248:251], v[60:63], v[88:91], a[248:251]
 v_mfma_f32_16x16x32_bf16 a[248:251], v[56:59], v[72:75], a[248:251]
 v_mfma_f32_16x16x32_bf16 a[244:247], v[56:59], v[68:71], a[244:247]
 ds_read_b64_tr_b16 v[44:45], v148
 v_mfma_f32_16x16x32_bf16 a[244:247], v[60:63], v[84:87], a[244:247]
 ds_read_b64_tr_b16 v[46:47], v148 offset:1024
 v_mfma_f32_16x16x32_bf16 a[240:243], v[60:63], v[80:83], a[240:243]
 v_mfma_f32_16x16x32_bf16 a[240:243], v[56:59], v[64:67], a[240:243]
 s_waitcnt lgkmcnt(4)
 v_mfma_f32_16x16x32_bf16 v[160:163], v[32:35], v[64:67], v[160:163]
 ds_read_b64_tr_b16 v[48:49], v24
 v_mfma_f32_16x16x32_bf16 v[160:163], v[36:39], v[80:83], v[160:163]
 ds_read_b64_tr_b16 v[50:51], v24 offset:1024
 v_mfma_f32_16x16x32_bf16 v[164:167], v[36:39], v[84:87], v[164:167]
 v_mfma_f32_16x16x32_bf16 v[164:167], v[32:35], v[68:71], v[164:167]
 v_mfma_f32_16x16x32_bf16 v[168:171], v[32:35], v[72:75], v[168:171]
 ds_read_b64_tr_b16 v[52:53], v149
 v_mfma_f32_16x16x32_bf16 v[168:171], v[36:39], v[88:91], v[168:171]
 ds_read_b64_tr_b16 v[54:55], v149 offset:1024
 v_mfma_f32_16x16x32_bf16 v[172:175], v[36:39], v[92:95], v[172:175]
 v_mfma_f32_16x16x32_bf16 v[172:175], v[32:35], v[76:79], v[172:175]
 s_waitcnt lgkmcnt(4)
 v_mfma_f32_16x16x32_bf16 v[188:191], v[40:43], v[76:79], v[188:191]
 ds_read_b64_tr_b16 v[56:57], v25
 v_mfma_f32_16x16x32_bf16 v[188:191], v[44:47], v[92:95], v[188:191]
 ds_read_b64_tr_b16 v[58:59], v25 offset:1024
 v_mfma_f32_16x16x32_bf16 v[184:187], v[44:47], v[88:91], v[184:187]
 v_mfma_f32_16x16x32_bf16 v[184:187], v[40:43], v[72:75], v[184:187]
 v_mfma_f32_16x16x32_bf16 v[180:183], v[40:43], v[68:71], v[180:183]
 ds_read_b64_tr_b16 v[60:61], v150
 v_mfma_f32_16x16x32_bf16 v[180:183], v[44:47], v[84:87], v[180:183]
 ds_read_b64_tr_b16 v[62:63], v150 offset:1024
 v_mfma_f32_16x16x32_bf16 v[176:179], v[44:47], v[80:83], v[176:179]
 v_mfma_f32_16x16x32_bf16 v[176:179], v[40:43], v[64:67], v[176:179]
 s_waitcnt lgkmcnt(4)
 v_mfma_f32_16x16x32_bf16 v[192:195], v[48:51], v[64:67], v[192:195]
 ds_read_b64_tr_b16 v[32:33], v26
 v_mfma_f32_16x16x32_bf16 v[192:195], v[52:55], v[80:83], v[192:195]
 ds_read_b64_tr_b16 v[34:35], v26 offset:1024
 v_mfma_f32_16x16x32_bf16 v[196:199], v[52:55], v[84:87], v[196:199]
 v_mfma_f32_16x16x32_bf16 v[196:199], v[48:51], v[68:71], v[196:199]
 v_mfma_f32_16x16x32_bf16 v[200:203], v[48:51], v[72:75], v[200:203]
 ds_read_b64_tr_b16 v[40:41], v27
 v_mfma_f32_16x16x32_bf16 v[200:203], v[52:55], v[88:91], v[200:203]
 ds_read_b64_tr_b16 v[42:43], v27 offset:1024
 v_mfma_f32_16x16x32_bf16 v[204:207], v[52:55], v[92:95], v[204:207]
 v_mfma_f32_16x16x32_bf16 v[204:207], v[48:51], v[76:79], v[204:207]
 s_waitcnt lgkmcnt(4)
 v_mfma_f32_16x16x32_bf16 v[220:223], v[56:59], v[76:79], v[220:223]
 ds_read_b64_tr_b16 v[36:37], v151
 v_mfma_f32_16x16x32_bf16 v[220:223], v[60:63], v[92:95], v[220:223]
 ds_read_b64_tr_b16 v[38:39], v151 offset:1024
 buffer_load_dword v138, v0, s[60:63], 0 offen
 v_mfma_f32_16x16x32_bf16 v[216:219], v[60:63], v[88:91], v[216:219]
 v_mfma_f32_16x16x32_bf16 v[216:219], v[56:59], v[72:75], v[216:219]
 v_mfma_f32_16x16x32_bf16 v[212:215], v[56:59], v[68:71], v[212:215]
 ds_read_b64_tr_b16 v[44:45], v152
 v_mfma_f32_16x16x32_bf16 v[212:215], v[60:63], v[84:87], v[212:215]
 ds_read_b64_tr_b16 v[46:47], v152 offset:1024
 v_mfma_f32_16x16x32_bf16 v[208:211], v[60:63], v[80:83], v[208:211]
 v_mfma_f32_16x16x32_bf16 v[208:211], v[56:59], v[64:67], v[208:211]
 s_waitcnt lgkmcnt(2)
 s_waitcnt vmcnt(9)
 s_waitcnt vmcnt(1)
 s_barrier
 v_mfma_f32_16x16x32_bf16 v[224:227], v[32:35], v[64:67], v[224:227]
 ds_read_b64_tr_b16 v[48:49], v19
 v_mfma_f32_16x16x32_bf16 v[224:227], v[36:39], v[80:83], v[224:227]
 ds_read_b64_tr_b16 v[50:51], v19 offset:1792
 v_mfma_f32_16x16x32_bf16 v[228:231], v[36:39], v[84:87], v[228:231]
 v_mfma_f32_16x16x32_bf16 v[228:231], v[32:35], v[68:71], v[228:231]
 v_mfma_f32_16x16x32_bf16 v[232:235], v[32:35], v[72:75], v[232:235]
 ds_read_b64_tr_b16 v[52:53], v144
 v_mfma_f32_16x16x32_bf16 v[232:235], v[36:39], v[88:91], v[232:235]
 ds_read_b64_tr_b16 v[54:55], v144 offset:1792
 v_mfma_f32_16x16x32_bf16 v[236:239], v[36:39], v[92:95], v[236:239]
 v_mfma_f32_16x16x32_bf16 v[236:239], v[32:35], v[76:79], v[236:239]
 s_waitcnt lgkmcnt(4)
 v_mfma_f32_16x16x32_bf16 v[252:255], v[40:43], v[76:79], v[252:255]
 ds_read_b64_tr_b16 v[56:57], v19 offset:32
 v_add_u32 v20, s46, v20
 v_mfma_f32_16x16x32_bf16 v[252:255], v[44:47], v[92:95], v[252:255]
 ds_read_b64_tr_b16 v[58:59], v19 offset:1824
 v_mfma_f32_16x16x32_bf16 v[248:251], v[44:47], v[88:91], v[248:251]
 v_mfma_f32_16x16x32_bf16 v[248:251], v[40:43], v[72:75], v[248:251]
 v_mfma_f32_16x16x32_bf16 v[244:247], v[40:43], v[68:71], v[244:247]
 ds_read_b64_tr_b16 v[60:61], v144 offset:32
 v_add_u32 v21, s46, v21
 v_mfma_f32_16x16x32_bf16 v[244:247], v[44:47], v[84:87], v[244:247]
 ds_read_b64_tr_b16 v[62:63], v144 offset:1824
 v_mfma_f32_16x16x32_bf16 v[240:243], v[44:47], v[80:83], v[240:243]
 v_mfma_f32_16x16x32_bf16 v[240:243], v[40:43], v[64:67], v[240:243]
 s_waitcnt lgkmcnt(4)
 v_mfma_f32_16x16x32_bf16 a[0:3], v[48:51], v[96:99], a[0:3]
 ds_read_b64_tr_b16 v[32:33], v19 offset:64
 v_add_u32 v22, s46, v22
 v_mfma_f32_16x16x32_bf16 a[0:3], v[52:55], v[112:115], a[0:3]
 ds_read_b64_tr_b16 v[34:35], v19 offset:1856
 v_mfma_f32_16x16x32_bf16 a[4:7], v[52:55], v[116:119], a[4:7]
 v_mfma_f32_16x16x32_bf16 a[4:7], v[48:51], v[100:103], a[4:7]
 v_mfma_f32_16x16x32_bf16 a[8:11], v[48:51], v[104:107], a[8:11]
 ds_read_b64_tr_b16 v[36:37], v144 offset:64
 v_add_u32 v23, s46, v23
 v_mfma_f32_16x16x32_bf16 a[8:11], v[52:55], v[120:123], a[8:11]
 ds_read_b64_tr_b16 v[38:39], v144 offset:1856
 v_mfma_f32_16x16x32_bf16 a[12:15], v[52:55], v[124:127], a[12:15]
 v_mfma_f32_16x16x32_bf16 a[12:15], v[48:51], v[108:111], a[12:15]
 s_waitcnt lgkmcnt(4)
 v_mfma_f32_16x16x32_bf16 a[28:31], v[56:59], v[108:111], a[28:31]
 ds_read_b64_tr_b16 v[40:41], v19 offset:96
 v_add_u32 v24, s46, v24
 v_mfma_f32_16x16x32_bf16 a[28:31], v[60:63], v[124:127], a[28:31]
 ds_read_b64_tr_b16 v[42:43], v19 offset:1888
 v_mfma_f32_16x16x32_bf16 a[24:27], v[60:63], v[120:123], a[24:27]
 v_mfma_f32_16x16x32_bf16 a[24:27], v[56:59], v[104:107], a[24:27]
 v_mfma_f32_16x16x32_bf16 a[20:23], v[56:59], v[100:103], a[20:23]
 ds_read_b64_tr_b16 v[44:45], v144 offset:96
 v_add_u32 v25, s46, v25
 v_mfma_f32_16x16x32_bf16 a[20:23], v[60:63], v[116:119], a[20:23]
 ds_read_b64_tr_b16 v[46:47], v144 offset:1888
 v_mfma_f32_16x16x32_bf16 a[16:19], v[60:63], v[112:115], a[16:19]
 v_mfma_f32_16x16x32_bf16 a[16:19], v[56:59], v[96:99], a[16:19]
 s_waitcnt lgkmcnt(4)
 v_mfma_f32_16x16x32_bf16 a[32:35], v[32:35], v[96:99], a[32:35]
 ds_read_b64_tr_b16 v[48:49], v19 offset:128
 v_add_u32 v26, s46, v26
 v_mfma_f32_16x16x32_bf16 a[32:35], v[36:39], v[112:115], a[32:35]
 ds_read_b64_tr_b16 v[50:51], v19 offset:1920
 v_mfma_f32_16x16x32_bf16 a[36:39], v[36:39], v[116:119], a[36:39]
 v_mfma_f32_16x16x32_bf16 a[36:39], v[32:35], v[100:103], a[36:39]
 v_mfma_f32_16x16x32_bf16 a[40:43], v[32:35], v[104:107], a[40:43]
 ds_read_b64_tr_b16 v[52:53], v144 offset:128
 v_add_u32 v27, s46, v27
 v_mfma_f32_16x16x32_bf16 a[40:43], v[36:39], v[120:123], a[40:43]
 ds_read_b64_tr_b16 v[54:55], v144 offset:1920
 v_mfma_f32_16x16x32_bf16 a[44:47], v[36:39], v[124:127], a[44:47]
 v_mfma_f32_16x16x32_bf16 a[44:47], v[32:35], v[108:111], a[44:47]
 s_waitcnt lgkmcnt(4)
 v_mfma_f32_16x16x32_bf16 a[60:63], v[40:43], v[108:111], a[60:63]
 ds_read_b64_tr_b16 v[56:57], v19 offset:160
 v_add_u32 v145, s48, v145
 v_mfma_f32_16x16x32_bf16 a[60:63], v[44:47], v[124:127], a[60:63]
 ds_read_b64_tr_b16 v[58:59], v19 offset:1952
 v_mfma_f32_16x16x32_bf16 a[56:59], v[44:47], v[120:123], a[56:59]
 v_mfma_f32_16x16x32_bf16 a[56:59], v[40:43], v[104:107], a[56:59]
 v_mfma_f32_16x16x32_bf16 a[52:55], v[40:43], v[100:103], a[52:55]
 ds_read_b64_tr_b16 v[60:61], v144 offset:160
 v_add_u32 v146, s48, v146
 v_mfma_f32_16x16x32_bf16 a[52:55], v[44:47], v[116:119], a[52:55]
 ds_read_b64_tr_b16 v[62:63], v144 offset:1952
 v_mfma_f32_16x16x32_bf16 a[48:51], v[44:47], v[112:115], a[48:51]
 v_mfma_f32_16x16x32_bf16 a[48:51], v[40:43], v[96:99], a[48:51]
 s_waitcnt lgkmcnt(4)
 v_mfma_f32_16x16x32_bf16 a[64:67], v[48:51], v[96:99], a[64:67]
 ds_read_b64_tr_b16 v[32:33], v19 offset:192
 v_add_u32 v147, s48, v147
 v_mfma_f32_16x16x32_bf16 a[64:67], v[52:55], v[112:115], a[64:67]
 ds_read_b64_tr_b16 v[34:35], v19 offset:1984
 v_mfma_f32_16x16x32_bf16 a[68:71], v[52:55], v[116:119], a[68:71]
 v_mfma_f32_16x16x32_bf16 a[68:71], v[48:51], v[100:103], a[68:71]
 v_mfma_f32_16x16x32_bf16 a[72:75], v[48:51], v[104:107], a[72:75]
 ds_read_b64_tr_b16 v[36:37], v144 offset:192
 v_add_u32 v148, s48, v148
 v_mfma_f32_16x16x32_bf16 a[72:75], v[52:55], v[120:123], a[72:75]
 ds_read_b64_tr_b16 v[38:39], v144 offset:1984
 v_mfma_f32_16x16x32_bf16 a[76:79], v[52:55], v[124:127], a[76:79]
 v_mfma_f32_16x16x32_bf16 a[76:79], v[48:51], v[108:111], a[76:79]
 s_waitcnt lgkmcnt(4)
 v_mfma_f32_16x16x32_bf16 a[92:95], v[56:59], v[108:111], a[92:95]
 ds_read_b64_tr_b16 v[40:41], v19 offset:7168
 v_add_u32 v149, s48, v149
 v_mfma_f32_16x16x32_bf16 a[92:95], v[60:63], v[124:127], a[92:95]
 ds_read_b64_tr_b16 v[42:43], v19 offset:8960
 v_mfma_f32_16x16x32_bf16 a[88:91], v[60:63], v[120:123], a[88:91]
 v_mfma_f32_16x16x32_bf16 a[88:91], v[56:59], v[104:107], a[88:91]
 v_mfma_f32_16x16x32_bf16 a[84:87], v[56:59], v[100:103], a[84:87]
 ds_read_b64_tr_b16 v[44:45], v144 offset:7168
 v_add_u32 v150, s48, v150
 v_mfma_f32_16x16x32_bf16 a[84:87], v[60:63], v[116:119], a[84:87]
 ds_read_b64_tr_b16 v[46:47], v144 offset:8960
 v_mfma_f32_16x16x32_bf16 a[80:83], v[60:63], v[112:115], a[80:83]
 v_mfma_f32_16x16x32_bf16 a[80:83], v[56:59], v[96:99], a[80:83]
 s_waitcnt lgkmcnt(4)
 v_mfma_f32_16x16x32_bf16 a[96:99], v[32:35], v[96:99], a[96:99]
 ds_read_b64_tr_b16 v[48:49], v19 offset:7200
 v_add_u32 v151, s48, v151
 v_mfma_f32_16x16x32_bf16 a[96:99], v[36:39], v[112:115], a[96:99]
 ds_read_b64_tr_b16 v[50:51], v19 offset:8992
 v_mfma_f32_16x16x32_bf16 a[100:103], v[36:39], v[116:119], a[100:103]
 v_mfma_f32_16x16x32_bf16 a[100:103], v[32:35], v[100:103], a[100:103]
 v_mfma_f32_16x16x32_bf16 a[104:107], v[32:35], v[104:107], a[104:107]
 ds_read_b64_tr_b16 v[52:53], v144 offset:7200
 v_add_u32 v152, s48, v152
 v_mfma_f32_16x16x32_bf16 a[104:107], v[36:39], v[120:123], a[104:107]
 ds_read_b64_tr_b16 v[54:55], v144 offset:8992
 v_mfma_f32_16x16x32_bf16 a[108:111], v[36:39], v[124:127], a[108:111]
 v_mfma_f32_16x16x32_bf16 a[108:111], v[32:35], v[108:111], a[108:111]
 s_waitcnt lgkmcnt(4)
 v_mfma_f32_16x16x32_bf16 a[124:127], v[40:43], v[108:111], a[124:127]
 ds_read_b64_tr_b16 v[56:57], v19 offset:7232
 s_add_u32 s45, s45, 45056
 v_mfma_f32_16x16x32_bf16 a[124:127], v[44:47], v[124:127], a[124:127]
 ds_read_b64_tr_b16 v[58:59], v19 offset:9024
 s_mov_b32 s46, 45056
 v_mfma_f32_16x16x32_bf16 a[120:123], v[44:47], v[120:123], a[120:123]
 s_cmp_ge_u32 s45, 157696
 s_cselect_b32 s46, -112640, s46
 s_cselect_b32 s50, 157696, 0
 s_sub_u32 s45, s45, s50
 v_mfma_f32_16x16x32_bf16 a[120:123], v[40:43], v[104:107], a[120:123]
 v_mfma_f32_16x16x32_bf16 a[116:119], v[40:43], v[100:103], a[116:119]
 ds_read_b64_tr_b16 v[60:61], v144 offset:7232
 v_mfma_f32_16x16x32_bf16 a[116:119], v[44:47], v[116:119], a[116:119]
 ds_read_b64_tr_b16 v[62:63], v144 offset:9024
 v_mfma_f32_16x16x32_bf16 a[112:115], v[44:47], v[112:115], a[112:115]
 v_mfma_f32_16x16x32_bf16 a[112:115], v[40:43], v[96:99], a[112:115]
 s_waitcnt lgkmcnt(4)
 v_mfma_f32_16x16x32_bf16 a[128:131], v[48:51], v[96:99], a[128:131]
 ds_read_b64_tr_b16 v[32:33], v19 offset:7264
 s_add_u32 s47, s47, 45056
 v_mfma_f32_16x16x32_bf16 a[128:131], v[52:55], v[112:115], a[128:131]
 ds_read_b64_tr_b16 v[34:35], v19 offset:9056
 s_mov_b32 s48, 45056
 v_mfma_f32_16x16x32_bf16 a[132:135], v[52:55], v[116:119], a[132:135]
 s_cmp_ge_u32 s47, 157696
 s_cselect_b32 s48, -112640, s48
 s_cselect_b32 s50, 157696, 0
 s_sub_u32 s47, s47, s50
 v_mfma_f32_16x16x32_bf16 a[132:135], v[48:51], v[100:103], a[132:135]
 v_mfma_f32_16x16x32_bf16 a[136:139], v[48:51], v[104:107], a[136:139]
 ds_read_b64_tr_b16 v[36:37], v144 offset:7264
 v_mfma_f32_16x16x32_bf16 a[136:139], v[52:55], v[120:123], a[136:139]
 ds_read_b64_tr_b16 v[38:39], v144 offset:9056
 v_mfma_f32_16x16x32_bf16 a[140:143], v[52:55], v[124:127], a[140:143]
 v_mfma_f32_16x16x32_bf16 a[140:143], v[48:51], v[108:111], a[140:143]
 s_waitcnt lgkmcnt(4)
 v_mfma_f32_16x16x32_bf16 a[156:159], v[56:59], v[108:111], a[156:159]
 ds_read_b64_tr_b16 v[40:41], v19 offset:7296
 v_mfma_f32_16x16x32_bf16 a[156:159], v[60:63], v[124:127], a[156:159]
 ds_read_b64_tr_b16 v[42:43], v19 offset:9088
 v_mfma_f32_16x16x32_bf16 a[152:155], v[60:63], v[120:123], a[152:155]
 v_mfma_f32_16x16x32_bf16 a[152:155], v[56:59], v[104:107], a[152:155]
 v_mfma_f32_16x16x32_bf16 a[148:151], v[56:59], v[100:103], a[148:151]
 ds_read_b64_tr_b16 v[44:45], v144 offset:7296
 v_mfma_f32_16x16x32_bf16 a[148:151], v[60:63], v[116:119], a[148:151]
 ds_read_b64_tr_b16 v[46:47], v144 offset:9088
 v_mfma_f32_16x16x32_bf16 a[144:147], v[60:63], v[112:115], a[144:147]
 v_mfma_f32_16x16x32_bf16 a[144:147], v[56:59], v[96:99], a[144:147]
 s_waitcnt lgkmcnt(4)
 v_mfma_f32_16x16x32_bf16 a[160:163], v[32:35], v[96:99], a[160:163]
 ds_read_b64_tr_b16 v[48:49], v19 offset:7328
 v_mfma_f32_16x16x32_bf16 a[160:163], v[36:39], v[112:115], a[160:163]
 ds_read_b64_tr_b16 v[50:51], v19 offset:9120
 v_mfma_f32_16x16x32_bf16 a[164:167], v[36:39], v[116:119], a[164:167]
 v_mfma_f32_16x16x32_bf16 a[164:167], v[32:35], v[100:103], a[164:167]
 v_mfma_f32_16x16x32_bf16 a[168:171], v[32:35], v[104:107], a[168:171]
 ds_read_b64_tr_b16 v[52:53], v144 offset:7328
 v_mfma_f32_16x16x32_bf16 a[168:171], v[36:39], v[120:123], a[168:171]
 ds_read_b64_tr_b16 v[54:55], v144 offset:9120
 v_mfma_f32_16x16x32_bf16 a[172:175], v[36:39], v[124:127], a[172:175]
 v_mfma_f32_16x16x32_bf16 a[172:175], v[32:35], v[108:111], a[172:175]
 s_waitcnt lgkmcnt(4)
 v_mfma_f32_16x16x32_bf16 a[188:191], v[40:43], v[108:111], a[188:191]
 ds_read_b64_tr_b16 v[56:57], v19 offset:7360
 v_mfma_f32_16x16x32_bf16 a[188:191], v[44:47], v[124:127], a[188:191]
 ds_read_b64_tr_b16 v[58:59], v19 offset:9152
 v_mfma_f32_16x16x32_bf16 a[184:187], v[44:47], v[120:123], a[184:187]
 v_mfma_f32_16x16x32_bf16 a[184:187], v[40:43], v[104:107], a[184:187]
 v_mfma_f32_16x16x32_bf16 a[180:183], v[40:43], v[100:103], a[180:183]
 ds_read_b64_tr_b16 v[60:61], v144 offset:7360
 v_mfma_f32_16x16x32_bf16 a[180:183], v[44:47], v[116:119], a[180:183]
 ds_read_b64_tr_b16 v[62:63], v144 offset:9152
 v_mfma_f32_16x16x32_bf16 a[176:179], v[44:47], v[112:115], a[176:179]
 v_mfma_f32_16x16x32_bf16 a[176:179], v[40:43], v[96:99], a[176:179]
 s_waitcnt lgkmcnt(4)
 v_mfma_f32_16x16x32_bf16 a[192:195], v[48:51], v[96:99], a[192:195]
 ds_read_b64_tr_b16 v[32:33], v20
 v_mfma_f32_16x16x32_bf16 a[192:195], v[52:55], v[112:115], a[192:195]
 ds_read_b64_tr_b16 v[34:35], v20 offset:1024
 v_mfma_f32_16x16x32_bf16 a[196:199], v[52:55], v[116:119], a[196:199]
 v_mfma_f32_16x16x32_bf16 a[196:199], v[48:51], v[100:103], a[196:199]
 v_mfma_f32_16x16x32_bf16 a[200:203], v[48:51], v[104:107], a[200:203]
 ds_read_b64_tr_b16 v[36:37], v145
 v_mfma_f32_16x16x32_bf16 a[200:203], v[52:55], v[120:123], a[200:203]
 ds_read_b64_tr_b16 v[38:39], v145 offset:1024
 v_mfma_f32_16x16x32_bf16 a[204:207], v[52:55], v[124:127], a[204:207]
 v_add_u32 v19, s46, v19
 v_mfma_f32_16x16x32_bf16 a[204:207], v[48:51], v[108:111], a[204:207]
 s_waitcnt lgkmcnt(4)
 v_mfma_f32_16x16x32_bf16 a[220:223], v[56:59], v[108:111], a[220:223]
 ds_read_b64_tr_b16 v[40:41], v21
 v_mfma_f32_16x16x32_bf16 a[220:223], v[60:63], v[124:127], a[220:223]
 ds_read_b64_tr_b16 v[42:43], v21 offset:1024
 v_mfma_f32_16x16x32_bf16 a[216:219], v[60:63], v[120:123], a[216:219]
 v_add_u32 v144, s48, v144
 v_mfma_f32_16x16x32_bf16 a[216:219], v[56:59], v[104:107], a[216:219]
 v_mfma_f32_16x16x32_bf16 a[212:215], v[56:59], v[100:103], a[212:215]
 ds_read_b64_tr_b16 v[44:45], v146
 v_mfma_f32_16x16x32_bf16 a[212:215], v[60:63], v[116:119], a[212:215]
 ds_read_b64_tr_b16 v[46:47], v146 offset:1024
 v_mfma_f32_16x16x32_bf16 a[208:211], v[60:63], v[112:115], a[208:211]
 v_mfma_f32_16x16x32_bf16 a[208:211], v[56:59], v[96:99], a[208:211]
 s_waitcnt lgkmcnt(4)
 v_mfma_f32_16x16x32_bf16 a[224:227], v[32:35], v[96:99], a[224:227]
 ds_read_b64_tr_b16 v[48:49], v22
 v_mfma_f32_16x16x32_bf16 a[224:227], v[36:39], v[112:115], a[224:227]
 ds_read_b64_tr_b16 v[50:51], v22 offset:1024
 v_mfma_f32_16x16x32_bf16 a[228:231], v[36:39], v[116:119], a[228:231]
 v_mfma_f32_16x16x32_bf16 a[228:231], v[32:35], v[100:103], a[228:231]
 v_mfma_f32_16x16x32_bf16 a[232:235], v[32:35], v[104:107], a[232:235]
 ds_read_b64_tr_b16 v[52:53], v147
 v_mfma_f32_16x16x32_bf16 a[232:235], v[36:39], v[120:123], a[232:235]
 ds_read_b64_tr_b16 v[54:55], v147 offset:1024
 v_mfma_f32_16x16x32_bf16 a[236:239], v[36:39], v[124:127], a[236:239]
 v_mfma_f32_16x16x32_bf16 a[236:239], v[32:35], v[108:111], a[236:239]
 s_waitcnt lgkmcnt(4)
 v_mfma_f32_16x16x32_bf16 a[252:255], v[40:43], v[108:111], a[252:255]
 ds_read_b64_tr_b16 v[56:57], v23
 v_mfma_f32_16x16x32_bf16 a[252:255], v[44:47], v[124:127], a[252:255]
 ds_read_b64_tr_b16 v[58:59], v23 offset:1024
 v_mfma_f32_16x16x32_bf16 a[248:251], v[44:47], v[120:123], a[248:251]
 v_mfma_f32_16x16x32_bf16 a[248:251], v[40:43], v[104:107], a[248:251]
 v_mfma_f32_16x16x32_bf16 a[244:247], v[40:43], v[100:103], a[244:247]
 ds_read_b64_tr_b16 v[60:61], v148
 v_mfma_f32_16x16x32_bf16 a[244:247], v[44:47], v[116:119], a[244:247]
 ds_read_b64_tr_b16 v[62:63], v148 offset:1024
 v_mfma_f32_16x16x32_bf16 a[240:243], v[44:47], v[112:115], a[240:243]
 v_mfma_f32_16x16x32_bf16 a[240:243], v[40:43], v[96:99], a[240:243]
 s_waitcnt lgkmcnt(4)
 v_mfma_f32_16x16x32_bf16 v[160:163], v[48:51], v[96:99], v[160:163]
 ds_read_b64_tr_b16 v[32:33], v24
 v_mfma_f32_16x16x32_bf16 v[160:163], v[52:55], v[112:115], v[160:163]
 ds_read_b64_tr_b16 v[34:35], v24 offset:1024
 v_mfma_f32_16x16x32_bf16 v[164:167], v[52:55], v[116:119], v[164:167]
 v_mfma_f32_16x16x32_bf16 v[164:167], v[48:51], v[100:103], v[164:167]
 v_mfma_f32_16x16x32_bf16 v[168:171], v[48:51], v[104:107], v[168:171]
 ds_read_b64_tr_b16 v[36:37], v149
 v_mfma_f32_16x16x32_bf16 v[168:171], v[52:55], v[120:123], v[168:171]
 ds_read_b64_tr_b16 v[38:39], v149 offset:1024
 v_mfma_f32_16x16x32_bf16 v[172:175], v[52:55], v[124:127], v[172:175]
 v_mfma_f32_16x16x32_bf16 v[172:175], v[48:51], v[108:111], v[172:175]
 s_waitcnt lgkmcnt(4)
 v_mfma_f32_16x16x32_bf16 v[188:191], v[56:59], v[108:111], v[188:191]
 ds_read_b64_tr_b16 v[40:41], v25
 v_mfma_f32_16x16x32_bf16 v[188:191], v[60:63], v[124:127], v[188:191]
 ds_read_b64_tr_b16 v[42:43], v25 offset:1024
 v_mfma_f32_16x16x32_bf16 v[184:187], v[60:63], v[120:123], v[184:187]
 v_mfma_f32_16x16x32_bf16 v[184:187], v[56:59], v[104:107], v[184:187]
 v_mfma_f32_16x16x32_bf16 v[180:183], v[56:59], v[100:103], v[180:183]
 ds_read_b64_tr_b16 v[44:45], v150
 v_mfma_f32_16x16x32_bf16 v[180:183], v[60:63], v[116:119], v[180:183]
 ds_read_b64_tr_b16 v[46:47], v150 offset:1024
 v_mfma_f32_16x16x32_bf16 v[176:179], v[60:63], v[112:115], v[176:179]
 v_mfma_f32_16x16x32_bf16 v[176:179], v[56:59], v[96:99], v[176:179]
 s_waitcnt lgkmcnt(4)
 v_mfma_f32_16x16x32_bf16 v[192:195], v[32:35], v[96:99], v[192:195]
 ds_read_b64_tr_b16 v[48:49], v26
 v_mfma_f32_16x16x32_bf16 v[192:195], v[36:39], v[112:115], v[192:195]
 ds_read_b64_tr_b16 v[50:51], v26 offset:1024
 v_mfma_f32_16x16x32_bf16 v[196:199], v[36:39], v[116:119], v[196:199]
 v_mfma_f32_16x16x32_bf16 v[196:199], v[32:35], v[100:103], v[196:199]
 v_mfma_f32_16x16x32_bf16 v[200:203], v[32:35], v[104:107], v[200:203]
 ds_read_b64_tr_b16 v[56:57], v27
 v_mfma_f32_16x16x32_bf16 v[200:203], v[36:39], v[120:123], v[200:203]
 ds_read_b64_tr_b16 v[58:59], v27 offset:1024
 v_mfma_f32_16x16x32_bf16 v[204:207], v[36:39], v[124:127], v[204:207]
 v_mfma_f32_16x16x32_bf16 v[204:207], v[32:35], v[108:111], v[204:207]
 s_waitcnt lgkmcnt(4)
 v_mfma_f32_16x16x32_bf16 v[220:223], v[40:43], v[108:111], v[220:223]
 ds_read_b64_tr_b16 v[52:53], v151
 v_mfma_f32_16x16x32_bf16 v[220:223], v[44:47], v[124:127], v[220:223]
 ds_read_b64_tr_b16 v[54:55], v151 offset:1024
 v_mfma_f32_16x16x32_bf16 v[216:219], v[44:47], v[120:123], v[216:219]
 v_mfma_f32_16x16x32_bf16 v[216:219], v[40:43], v[104:107], v[216:219]
 v_mfma_f32_16x16x32_bf16 v[212:215], v[40:43], v[100:103], v[212:215]
 ds_read_b64_tr_b16 v[60:61], v152
 v_mfma_f32_16x16x32_bf16 v[212:215], v[44:47], v[116:119], v[212:215]
 ds_read_b64_tr_b16 v[62:63], v152 offset:1024
 v_mfma_f32_16x16x32_bf16 v[208:211], v[44:47], v[112:115], v[208:211]
 v_mfma_f32_16x16x32_bf16 v[208:211], v[40:43], v[96:99], v[208:211]
 s_waitcnt lgkmcnt(2)
 v_mfma_f32_16x16x32_bf16 v[224:227], v[48:51], v[96:99], v[224:227]
 v_mfma_f32_16x16x32_bf16 v[224:227], v[52:55], v[112:115], v[224:227]
 v_mfma_f32_16x16x32_bf16 v[228:231], v[52:55], v[116:119], v[228:231]
 v_mfma_f32_16x16x32_bf16 v[228:231], v[48:51], v[100:103], v[228:231]
 v_mfma_f32_16x16x32_bf16 v[232:235], v[48:51], v[104:107], v[232:235]
 v_mfma_f32_16x16x32_bf16 v[232:235], v[52:55], v[120:123], v[232:235]
 v_mfma_f32_16x16x32_bf16 v[236:239], v[52:55], v[124:127], v[236:239]
 v_mfma_f32_16x16x32_bf16 v[236:239], v[48:51], v[108:111], v[236:239]
 s_waitcnt lgkmcnt(0)
 v_mfma_f32_16x16x32_bf16 v[252:255], v[56:59], v[108:111], v[252:255]
 v_mfma_f32_16x16x32_bf16 v[252:255], v[60:63], v[124:127], v[252:255]
 v_mfma_f32_16x16x32_bf16 v[248:251], v[60:63], v[120:123], v[248:251]
 s_waitcnt lgkmcnt(0)
 s_barrier
 v_mfma_f32_16x16x32_bf16 v[248:251], v[56:59], v[104:107], v[248:251]
 v_mfma_f32_16x16x32_bf16 v[244:247], v[56:59], v[100:103], v[244:247]
 v_mfma_f32_16x16x32_bf16 v[244:247], v[60:63], v[116:119], v[244:247]
 v_mfma_f32_16x16x32_bf16 v[240:243], v[60:63], v[112:115], v[240:243]
 v_mfma_f32_16x16x32_bf16 v[240:243], v[56:59], v[96:99], v[240:243]
 s_nop 3
 s_bitcmp0_b32 s38, 0
 s_cbranch_scc0 B_epi_odd
 s_add_u32 s55, s39, 0
 s_add_u32 m0, s40, 0
 s_nop 0
 buffer_load_dwordx4 v8, s[24:27], s55 offen lds
 buffer_load_dwordx4 v9, s[24:27], s55 offen offset:1024 lds
 v_accvgpr_read_b32 v32, a0
 v_accvgpr_read_b32 v33, a1
 v_accvgpr_read_b32 v34, a2
 v_accvgpr_read_b32 v35, a3
 v_accvgpr_read_b32 v44, a16
 v_accvgpr_read_b32 v45, a17
 v_accvgpr_read_b32 v46, a18
 v_accvgpr_read_b32 v47, a19
 v_pk_mul_f32 v[40:41], v[32:33], v[32:33]
 v_pk_mul_f32 v[42:43], v[34:35], v[34:35]
 v_pk_mul_f32 v[52:53], v[44:45], v[44:45]
 v_pk_mul_f32 v[54:55], v[46:47], v[46:47]
 v_pk_fma_f32 v[40:41], v[40:41], v[30:31], v[28:29]
 v_pk_fma_f32 v[42:43], v[42:43], v[30:31], v[28:29]
 v_pk_fma_f32 v[52:53], v[52:53], v[30:31], v[28:29]
 v_pk_fma_f32 v[54:55], v[54:55], v[30:31], v[28:29]
 v_pk_mul_f32 v[40:41], v[40:41], v[32:33]
 v_pk_mul_f32 v[42:43], v[42:43], v[34:35]
 v_pk_mul_f32 v[52:53], v[52:53], v[44:45]
 v_pk_mul_f32 v[54:55], v[54:55], v[46:47]
 v_exp_f32 v40, v40
 v_exp_f32 v41, v41
 v_exp_f32 v42, v42
 v_exp_f32 v43, v43
 v_accvgpr_read_b32 v36, a112
 v_accvgpr_read_b32 v37, a113
 v_accvgpr_read_b32 v38, a114
 v_accvgpr_read_b32 v39, a115
 v_exp_f32 v52, v52
 v_exp_f32 v53, v53
 v_exp_f32 v54, v54
 v_exp_f32 v55, v55
 v_accvgpr_read_b32 v48, a128
 v_accvgpr_read_b32 v49, a129
 v_accvgpr_read_b32 v50, a130
 v_accvgpr_read_b32 v51, a131
 v_pk_add_f32 v[40:41], v[40:41], 1.0 op_sel_hi:[1,0]
 v_pk_add_f32 v[42:43], v[42:43], 1.0 op_sel_hi:[1,0]
 v_pk_add_f32 v[52:53], v[52:53], 1.0 op_sel_hi:[1,0]
 v_pk_add_f32 v[54:55], v[54:55], 1.0 op_sel_hi:[1,0]
 v_rcp_f32 v40, v40
 v_rcp_f32 v41, v41
 v_rcp_f32 v42, v42
 v_rcp_f32 v43, v43
 v_pk_mul_f32 v[36:37], v[36:37], v[32:33]
 v_pk_mul_f32 v[38:39], v[38:39], v[34:35]
 v_rcp_f32 v52, v52
 v_rcp_f32 v53, v53
 v_rcp_f32 v54, v54
 v_rcp_f32 v55, v55
 v_pk_mul_f32 v[48:49], v[48:49], v[44:45]
 v_pk_mul_f32 v[50:51], v[50:51], v[46:47]
 v_pk_mul_f32 v[36:37], v[36:37], v[40:41]
 v_pk_mul_f32 v[38:39], v[38:39], v[42:43]
 v_pk_mul_f32 v[48:49], v[48:49], v[52:53]
 v_pk_mul_f32 v[50:51], v[50:51], v[54:55]
 v_cvt_pk_bf16_f32 v64, v36, v37
 v_cvt_pk_bf16_f32 v65, v38, v39
 v_cvt_pk_bf16_f32 v66, v48, v49
 v_cvt_pk_bf16_f32 v67, v50, v51
 buffer_store_dwordx4 v[64:67], v4, s[20:23], 0 offen sc1
 buffer_load_dwordx4 v10, s[24:27], s55 offen offset:2048 lds
 buffer_load_dwordx4 v11, s[24:27], s55 offen offset:3072 lds
 v_accvgpr_read_b32 v32, a32
 v_accvgpr_read_b32 v33, a33
 v_accvgpr_read_b32 v34, a34
 v_accvgpr_read_b32 v35, a35
 v_accvgpr_read_b32 v44, a48
 v_accvgpr_read_b32 v45, a49
 v_accvgpr_read_b32 v46, a50
 v_accvgpr_read_b32 v47, a51
 v_pk_mul_f32 v[40:41], v[32:33], v[32:33]
 v_pk_mul_f32 v[42:43], v[34:35], v[34:35]
 v_pk_mul_f32 v[52:53], v[44:45], v[44:45]
 v_pk_mul_f32 v[54:55], v[46:47], v[46:47]
 v_pk_fma_f32 v[40:41], v[40:41], v[30:31], v[28:29]
 v_pk_fma_f32 v[42:43], v[42:43], v[30:31], v[28:29]
 v_pk_fma_f32 v[52:53], v[52:53], v[30:31], v[28:29]
 v_pk_fma_f32 v[54:55], v[54:55], v[30:31], v[28:29]
 v_pk_mul_f32 v[40:41], v[40:41], v[32:33]
 v_pk_mul_f32 v[42:43], v[42:43], v[34:35]
 v_pk_mul_f32 v[52:53], v[52:53], v[44:45]
 v_pk_mul_f32 v[54:55], v[54:55], v[46:47]
 v_exp_f32 v40, v40
 v_exp_f32 v41, v41
 v_exp_f32 v42, v42
 v_exp_f32 v43, v43
 v_accvgpr_read_b32 v36, a144
 v_accvgpr_read_b32 v37, a145
 v_accvgpr_read_b32 v38, a146
 v_accvgpr_read_b32 v39, a147
 v_exp_f32 v52, v52
 v_exp_f32 v53, v53
 v_exp_f32 v54, v54
 v_exp_f32 v55, v55
 v_accvgpr_read_b32 v48, a160
 v_accvgpr_read_b32 v49, a161
 v_accvgpr_read_b32 v50, a162
 v_accvgpr_read_b32 v51, a163
 v_pk_add_f32 v[40:41], v[40:41], 1.0 op_sel_hi:[1,0]
 v_pk_add_f32 v[42:43], v[42:43], 1.0 op_sel_hi:[1,0]
 v_pk_add_f32 v[52:53], v[52:53], 1.0 op_sel_hi:[1,0]
 v_pk_add_f32 v[54:55], v[54:55], 1.0 op_sel_hi:[1,0]
 v_rcp_f32 v40, v40
 v_rcp_f32 v41, v41
 v_rcp_f32 v42, v42
 v_rcp_f32 v43, v43
 v_pk_mul_f32 v[36:37], v[36:37], v[32:33]
 v_pk_mul_f32 v[38:39], v[38:39], v[34:35]
 v_rcp_f32 v52, v52
 v_rcp_f32 v53, v53
 v_rcp_f32 v54, v54
 v_rcp_f32 v55, v55
 v_pk_mul_f32 v[48:49], v[48:49], v[44:45]
 v_pk_mul_f32 v[50:51], v[50:51], v[46:47]
 v_pk_mul_f32 v[36:37], v[36:37], v[40:41]
 v_pk_mul_f32 v[38:39], v[38:39], v[42:43]
 v_pk_mul_f32 v[48:49], v[48:49], v[52:53]
 v_pk_mul_f32 v[50:51], v[50:51], v[54:55]
 v_cvt_pk_bf16_f32 v68, v36, v37
 v_cvt_pk_bf16_f32 v69, v38, v39
 v_cvt_pk_bf16_f32 v70, v48, v49
 v_cvt_pk_bf16_f32 v71, v50, v51
 buffer_store_dwordx4 v[68:71], v4, s[20:23], 0 offen offset:1024 sc1
 s_add_u32 s55, s39, 16384
 s_add_u32 m0, s40, 16384
 s_nop 0
 buffer_load_dwordx4 v8, s[24:27], s55 offen lds
 buffer_load_dwordx4 v9, s[24:27], s55 offen offset:1024 lds
 v_accvgpr_read_b32 v32, a64
 v_accvgpr_read_b32 v33, a65
 v_accvgpr_read_b32 v34, a66
 v_accvgpr_read_b32 v35, a67
 v_accvgpr_read_b32 v44, a80
 v_accvgpr_read_b32 v45, a81
 v_accvgpr_read_b32 v46, a82
 v_accvgpr_read_b32 v47, a83
 v_pk_mul_f32 v[40:41], v[32:33], v[32:33]
 v_pk_mul_f32 v[42:43], v[34:35], v[34:35]
 v_pk_mul_f32 v[52:53], v[44:45], v[44:45]
 v_pk_mul_f32 v[54:55], v[46:47], v[46:47]
 v_pk_fma_f32 v[40:41], v[40:41], v[30:31], v[28:29]
 v_pk_fma_f32 v[42:43], v[42:43], v[30:31], v[28:29]
 v_pk_fma_f32 v[52:53], v[52:53], v[30:31], v[28:29]
 v_pk_fma_f32 v[54:55], v[54:55], v[30:31], v[28:29]
 v_pk_mul_f32 v[40:41], v[40:41], v[32:33]
 v_pk_mul_f32 v[42:43], v[42:43], v[34:35]
 v_pk_mul_f32 v[52:53], v[52:53], v[44:45]
 v_pk_mul_f32 v[54:55], v[54:55], v[46:47]
 v_exp_f32 v40, v40
 v_exp_f32 v41, v41
 v_exp_f32 v42, v42
 v_exp_f32 v43, v43
 v_accvgpr_read_b32 v36, a176
 v_accvgpr_read_b32 v37, a177
 v_accvgpr_read_b32 v38, a178
 v_accvgpr_read_b32 v39, a179
 v_exp_f32 v52, v52
 v_exp_f32 v53, v53
 v_exp_f32 v54, v54
 v_exp_f32 v55, v55
 v_accvgpr_read_b32 v48, a192
 v_accvgpr_read_b32 v49, a193
 v_accvgpr_read_b32 v50, a194
 v_accvgpr_read_b32 v51, a195
 v_pk_add_f32 v[40:41], v[40:41], 1.0 op_sel_hi:[1,0]
 v_pk_add_f32 v[42:43], v[42:43], 1.0 op_sel_hi:[1,0]
 v_pk_add_f32 v[52:53], v[52:53], 1.0 op_sel_hi:[1,0]
 v_pk_add_f32 v[54:55], v[54:55], 1.0 op_sel_hi:[1,0]
 v_rcp_f32 v40, v40
 v_rcp_f32 v41, v41
 v_rcp_f32 v42, v42
 v_rcp_f32 v43, v43
 v_pk_mul_f32 v[36:37], v[36:37], v[32:33]
 v_pk_mul_f32 v[38:39], v[38:39], v[34:35]
 v_rcp_f32 v52, v52
 v_rcp_f32 v53, v53
 v_rcp_f32 v54, v54
 v_rcp_f32 v55, v55
 v_pk_mul_f32 v[48:49], v[48:49], v[44:45]
 v_pk_mul_f32 v[50:51], v[50:51], v[46:47]
 v_pk_mul_f32 v[36:37], v[36:37], v[40:41]
 v_pk_mul_f32 v[38:39], v[38:39], v[42:43]
 v_pk_mul_f32 v[48:49], v[48:49], v[52:53]
 v_pk_mul_f32 v[50:51], v[50:51], v[54:55]
 v_cvt_pk_bf16_f32 v72, v36, v37
 v_cvt_pk_bf16_f32 v73, v38, v39
 v_cvt_pk_bf16_f32 v74, v48, v49
 v_cvt_pk_bf16_f32 v75, v50, v51
 buffer_store_dwordx4 v[72:75], v4, s[20:23], 0 offen offset:2048 sc1
 buffer_load_dwordx4 v10, s[24:27], s55 offen offset:2048 lds
 buffer_load_dwordx4 v11, s[24:27], s55 offen offset:3072 lds
 v_accvgpr_read_b32 v32, a4
 v_accvgpr_read_b32 v33, a5
 v_accvgpr_read_b32 v34, a6
 v_accvgpr_read_b32 v35, a7
 v_accvgpr_read_b32 v44, a20
 v_accvgpr_read_b32 v45, a21
 v_accvgpr_read_b32 v46, a22
 v_accvgpr_read_b32 v47, a23
 v_pk_mul_f32 v[40:41], v[32:33], v[32:33]
 v_pk_mul_f32 v[42:43], v[34:35], v[34:35]
 v_pk_mul_f32 v[52:53], v[44:45], v[44:45]
 v_pk_mul_f32 v[54:55], v[46:47], v[46:47]
 v_pk_fma_f32 v[40:41], v[40:41], v[30:31], v[28:29]
 v_pk_fma_f32 v[42:43], v[42:43], v[30:31], v[28:29]
 v_pk_fma_f32 v[52:53], v[52:53], v[30:31], v[28:29]
 v_pk_fma_f32 v[54:55], v[54:55], v[30:31], v[28:29]
 v_pk_mul_f32 v[40:41], v[40:41], v[32:33]
 v_pk_mul_f32 v[42:43], v[42:43], v[34:35]
 v_pk_mul_f32 v[52:53], v[52:53], v[44:45]
 v_pk_mul_f32 v[54:55], v[54:55], v[46:47]
 v_exp_f32 v40, v40
 v_exp_f32 v41, v41
 v_exp_f32 v42, v42
 v_exp_f32 v43, v43
 v_accvgpr_read_b32 v36, a116
 v_accvgpr_read_b32 v37, a117
 v_accvgpr_read_b32 v38, a118
 v_accvgpr_read_b32 v39, a119
 v_exp_f32 v52, v52
 v_exp_f32 v53, v53
 v_exp_f32 v54, v54
 v_exp_f32 v55, v55
 v_accvgpr_read_b32 v48, a132
 v_accvgpr_read_b32 v49, a133
 v_accvgpr_read_b32 v50, a134
 v_accvgpr_read_b32 v51, a135
 v_pk_add_f32 v[40:41], v[40:41], 1.0 op_sel_hi:[1,0]
 v_pk_add_f32 v[42:43], v[42:43], 1.0 op_sel_hi:[1,0]
 v_pk_add_f32 v[52:53], v[52:53], 1.0 op_sel_hi:[1,0]
 v_pk_add_f32 v[54:55], v[54:55], 1.0 op_sel_hi:[1,0]
 v_rcp_f32 v40, v40
 v_rcp_f32 v41, v41
 v_rcp_f32 v42, v42
 v_rcp_f32 v43, v43
 v_pk_mul_f32 v[36:37], v[36:37], v[32:33]
 v_pk_mul_f32 v[38:39], v[38:39], v[34:35]
 v_rcp_f32 v52, v52
 v_rcp_f32 v53, v53
 v_rcp_f32 v54, v54
 v_rcp_f32 v55, v55
 v_pk_mul_f32 v[48:49], v[48:49], v[44:45]
 v_pk_mul_f32 v[50:51], v[50:51], v[46:47]
 v_pk_mul_f32 v[36:37], v[36:37], v[40:41]
 v_pk_mul_f32 v[38:39], v[38:39], v[42:43]
 v_pk_mul_f32 v[48:49], v[48:49], v[52:53]
 v_pk_mul_f32 v[50:51], v[50:51], v[54:55]
 v_cvt_pk_bf16_f32 v76, v36, v37
 v_cvt_pk_bf16_f32 v77, v38, v39
 v_cvt_pk_bf16_f32 v78, v48, v49
 v_cvt_pk_bf16_f32 v79, v50, v51
 buffer_store_dwordx4 v[76:79], v5, s[20:23], 0 offen sc1
 s_add_u32 s55, s39, 0
 s_add_u32 m0, s40, 65536
 s_nop 0
 buffer_load_dwordx4 v12, s[28:31], s55 offen lds
 buffer_load_dwordx4 v13, s[28:31], s55 offen offset:1024 lds
 v_accvgpr_read_b32 v32, a36
 v_accvgpr_read_b32 v33, a37
 v_accvgpr_read_b32 v34, a38
 v_accvgpr_read_b32 v35, a39
 v_accvgpr_read_b32 v44, a52
 v_accvgpr_read_b32 v45, a53
 v_accvgpr_read_b32 v46, a54
 v_accvgpr_read_b32 v47, a55
 v_pk_mul_f32 v[40:41], v[32:33], v[32:33]
 v_pk_mul_f32 v[42:43], v[34:35], v[34:35]
 v_pk_mul_f32 v[52:53], v[44:45], v[44:45]
 v_pk_mul_f32 v[54:55], v[46:47], v[46:47]
 v_pk_fma_f32 v[40:41], v[40:41], v[30:31], v[28:29]
 v_pk_fma_f32 v[42:43], v[42:43], v[30:31], v[28:29]
 v_pk_fma_f32 v[52:53], v[52:53], v[30:31], v[28:29]
 v_pk_fma_f32 v[54:55], v[54:55], v[30:31], v[28:29]
 v_pk_mul_f32 v[40:41], v[40:41], v[32:33]
 v_pk_mul_f32 v[42:43], v[42:43], v[34:35]
 v_pk_mul_f32 v[52:53], v[52:53], v[44:45]
 v_pk_mul_f32 v[54:55], v[54:55], v[46:47]
 v_exp_f32 v40, v40
 v_exp_f32 v41, v41
 v_exp_f32 v42, v42
 v_exp_f32 v43, v43
 v_accvgpr_read_b32 v36, a148
 v_accvgpr_read_b32 v37, a149
 v_accvgpr_read_b32 v38, a150
 v_accvgpr_read_b32 v39, a151
 v_exp_f32 v52, v52
 v_exp_f32 v53, v53
 v_exp_f32 v54, v54
 v_exp_f32 v55, v55
 v_accvgpr_read_b32 v48, a164
 v_accvgpr_read_b32 v49, a165
 v_accvgpr_read_b32 v50, a166
 v_accvgpr_read_b32 v51, a167
 v_pk_add_f32 v[40:41], v[40:41], 1.0 op_sel_hi:[1,0]
 v_pk_add_f32 v[42:43], v[42:43], 1.0 op_sel_hi:[1,0]
 v_pk_add_f32 v[52:53], v[52:53], 1.0 op_sel_hi:[1,0]
 v_pk_add_f32 v[54:55], v[54:55], 1.0 op_sel_hi:[1,0]
 v_rcp_f32 v40, v40
 v_rcp_f32 v41, v41
 v_rcp_f32 v42, v42
 v_rcp_f32 v43, v43
 v_pk_mul_f32 v[36:37], v[36:37], v[32:33]
 v_pk_mul_f32 v[38:39], v[38:39], v[34:35]
 v_rcp_f32 v52, v52
 v_rcp_f32 v53, v53
 v_rcp_f32 v54, v54
 v_rcp_f32 v55, v55
 v_pk_mul_f32 v[48:49], v[48:49], v[44:45]
 v_pk_mul_f32 v[50:51], v[50:51], v[46:47]
 v_pk_mul_f32 v[36:37], v[36:37], v[40:41]
 v_pk_mul_f32 v[38:39], v[38:39], v[42:43]
 v_pk_mul_f32 v[48:49], v[48:49], v[52:53]
 v_pk_mul_f32 v[50:51], v[50:51], v[54:55]
 v_cvt_pk_bf16_f32 v80, v36, v37
 v_cvt_pk_bf16_f32 v81, v38, v39
 v_cvt_pk_bf16_f32 v82, v48, v49
 v_cvt_pk_bf16_f32 v83, v50, v51
 buffer_store_dwordx4 v[80:83], v5, s[20:23], 0 offen offset:1024 sc1
 buffer_load_dwordx4 v12, s[28:31], s55 offen offset:2048 lds
 buffer_load_dwordx4 v13, s[28:31], s55 offen offset:3072 lds
 v_accvgpr_read_b32 v32, a68
 v_accvgpr_read_b32 v33, a69
 v_accvgpr_read_b32 v34, a70
 v_accvgpr_read_b32 v35, a71
 v_accvgpr_read_b32 v44, a84
 v_accvgpr_read_b32 v45, a85
 v_accvgpr_read_b32 v46, a86
 v_accvgpr_read_b32 v47, a87
 v_pk_mul_f32 v[40:41], v[32:33], v[32:33]
 v_pk_mul_f32 v[42:43], v[34:35], v[34:35]
 v_pk_mul_f32 v[52:53], v[44:45], v[44:45]
 v_pk_mul_f32 v[54:55], v[46:47], v[46:47]
 v_pk_fma_f32 v[40:41], v[40:41], v[30:31], v[28:29]
 v_pk_fma_f32 v[42:43], v[42:43], v[30:31], v[28:29]
 v_pk_fma_f32 v[52:53], v[52:53], v[30:31], v[28:29]
 v_pk_fma_f32 v[54:55], v[54:55], v[30:31], v[28:29]
 v_pk_mul_f32 v[40:41], v[40:41], v[32:33]
 v_pk_mul_f32 v[42:43], v[42:43], v[34:35]
 v_pk_mul_f32 v[52:53], v[52:53], v[44:45]
 v_pk_mul_f32 v[54:55], v[54:55], v[46:47]
 v_exp_f32 v40, v40
 v_exp_f32 v41, v41
 v_exp_f32 v42, v42
 v_exp_f32 v43, v43
 v_accvgpr_read_b32 v36, a180
 v_accvgpr_read_b32 v37, a181
 v_accvgpr_read_b32 v38, a182
 v_accvgpr_read_b32 v39, a183
 v_exp_f32 v52, v52
 v_exp_f32 v53, v53
 v_exp_f32 v54, v54
 v_exp_f32 v55, v55
 v_accvgpr_read_b32 v48, a196
 v_accvgpr_read_b32 v49, a197
 v_accvgpr_read_b32 v50, a198
 v_accvgpr_read_b32 v51, a199
 v_pk_add_f32 v[40:41], v[40:41], 1.0 op_sel_hi:[1,0]
 v_pk_add_f32 v[42:43], v[42:43], 1.0 op_sel_hi:[1,0]
 v_pk_add_f32 v[52:53], v[52:53], 1.0 op_sel_hi:[1,0]
 v_pk_add_f32 v[54:55], v[54:55], 1.0 op_sel_hi:[1,0]
 v_rcp_f32 v40, v40
 v_rcp_f32 v41, v41
 v_rcp_f32 v42, v42
 v_rcp_f32 v43, v43
 v_pk_mul_f32 v[36:37], v[36:37], v[32:33]
 v_pk_mul_f32 v[38:39], v[38:39], v[34:35]
 v_rcp_f32 v52, v52
 v_rcp_f32 v53, v53
 v_rcp_f32 v54, v54
 v_rcp_f32 v55, v55
 v_pk_mul_f32 v[48:49], v[48:49], v[44:45]
 v_pk_mul_f32 v[50:51], v[50:51], v[46:47]
 v_pk_mul_f32 v[36:37], v[36:37], v[40:41]
 v_pk_mul_f32 v[38:39], v[38:39], v[42:43]
 v_pk_mul_f32 v[48:49], v[48:49], v[52:53]
 v_pk_mul_f32 v[50:51], v[50:51], v[54:55]
 v_cvt_pk_bf16_f32 v84, v36, v37
 v_cvt_pk_bf16_f32 v85, v38, v39
 v_cvt_pk_bf16_f32 v86, v48, v49
 v_cvt_pk_bf16_f32 v87, v50, v51
 buffer_store_dwordx4 v[84:87], v5, s[20:23], 0 offen offset:2048 sc1
 s_add_u32 s55, s39, 32768
 s_add_u32 m0, s40, 32768
 s_nop 0
 buffer_load_dwordx4 v8, s[24:27], s55 offen lds
 buffer_load_dwordx4 v9, s[24:27], s55 offen offset:1024 lds
 v_accvgpr_read_b32 v32, a8
 v_accvgpr_read_b32 v33, a9
 v_accvgpr_read_b32 v34, a10
 v_accvgpr_read_b32 v35, a11
 v_accvgpr_read_b32 v44, a24
 v_accvgpr_read_b32 v45, a25
 v_accvgpr_read_b32 v46, a26
 v_accvgpr_read_b32 v47, a27
 v_pk_mul_f32 v[40:41], v[32:33], v[32:33]
 v_pk_mul_f32 v[42:43], v[34:35], v[34:35]
 v_pk_mul_f32 v[52:53], v[44:45], v[44:45]
 v_pk_mul_f32 v[54:55], v[46:47], v[46:47]
 v_pk_fma_f32 v[40:41], v[40:41], v[30:31], v[28:29]
 v_pk_fma_f32 v[42:43], v[42:43], v[30:31], v[28:29]
 v_pk_fma_f32 v[52:53], v[52:53], v[30:31], v[28:29]
 v_pk_fma_f32 v[54:55], v[54:55], v[30:31], v[28:29]
 v_pk_mul_f32 v[40:41], v[40:41], v[32:33]
 v_pk_mul_f32 v[42:43], v[42:43], v[34:35]
 v_pk_mul_f32 v[52:53], v[52:53], v[44:45]
 v_pk_mul_f32 v[54:55], v[54:55], v[46:47]
 v_exp_f32 v40, v40
 v_exp_f32 v41, v41
 v_exp_f32 v42, v42
 v_exp_f32 v43, v43
 v_accvgpr_read_b32 v36, a120
 v_accvgpr_read_b32 v37, a121
 v_accvgpr_read_b32 v38, a122
 v_accvgpr_read_b32 v39, a123
 v_exp_f32 v52, v52
 v_exp_f32 v53, v53
 v_exp_f32 v54, v54
 v_exp_f32 v55, v55
 v_accvgpr_read_b32 v48, a136
 v_accvgpr_read_b32 v49, a137
 v_accvgpr_read_b32 v50, a138
 v_accvgpr_read_b32 v51, a139
 v_pk_add_f32 v[40:41], v[40:41], 1.0 op_sel_hi:[1,0]
 v_pk_add_f32 v[42:43], v[42:43], 1.0 op_sel_hi:[1,0]
 v_pk_add_f32 v[52:53], v[52:53], 1.0 op_sel_hi:[1,0]
 v_pk_add_f32 v[54:55], v[54:55], 1.0 op_sel_hi:[1,0]
 v_rcp_f32 v40, v40
 v_rcp_f32 v41, v41
 v_rcp_f32 v42, v42
 v_rcp_f32 v43, v43
 v_pk_mul_f32 v[36:37], v[36:37], v[32:33]
 v_pk_mul_f32 v[38:39], v[38:39], v[34:35]
 v_rcp_f32 v52, v52
 v_rcp_f32 v53, v53
 v_rcp_f32 v54, v54
 v_rcp_f32 v55, v55
 v_pk_mul_f32 v[48:49], v[48:49], v[44:45]
 v_pk_mul_f32 v[50:51], v[50:51], v[46:47]
 v_pk_mul_f32 v[36:37], v[36:37], v[40:41]
 v_pk_mul_f32 v[38:39], v[38:39], v[42:43]
 v_pk_mul_f32 v[48:49], v[48:49], v[52:53]
 v_pk_mul_f32 v[50:51], v[50:51], v[54:55]
 v_cvt_pk_bf16_f32 v88, v36, v37
 v_cvt_pk_bf16_f32 v89, v38, v39
 v_cvt_pk_bf16_f32 v90, v48, v49
 v_cvt_pk_bf16_f32 v91, v50, v51
 buffer_store_dwordx4 v[88:91], v6, s[20:23], 0 offen sc1
 buffer_load_dwordx4 v10, s[24:27], s55 offen offset:2048 lds
 buffer_load_dwordx4 v11, s[24:27], s55 offen offset:3072 lds
 v_accvgpr_read_b32 v32, a40
 v_accvgpr_read_b32 v33, a41
 v_accvgpr_read_b32 v34, a42
 v_accvgpr_read_b32 v35, a43
 v_accvgpr_read_b32 v44, a56
 v_accvgpr_read_b32 v45, a57
 v_accvgpr_read_b32 v46, a58
 v_accvgpr_read_b32 v47, a59
 v_pk_mul_f32 v[40:41], v[32:33], v[32:33]
 v_pk_mul_f32 v[42:43], v[34:35], v[34:35]
 v_pk_mul_f32 v[52:53], v[44:45], v[44:45]
 v_pk_mul_f32 v[54:55], v[46:47], v[46:47]
 v_pk_fma_f32 v[40:41], v[40:41], v[30:31], v[28:29]
 v_pk_fma_f32 v[42:43], v[42:43], v[30:31], v[28:29]
 v_pk_fma_f32 v[52:53], v[52:53], v[30:31], v[28:29]
 v_pk_fma_f32 v[54:55], v[54:55], v[30:31], v[28:29]
 v_pk_mul_f32 v[40:41], v[40:41], v[32:33]
 v_pk_mul_f32 v[42:43], v[42:43], v[34:35]
 v_pk_mul_f32 v[52:53], v[52:53], v[44:45]
 v_pk_mul_f32 v[54:55], v[54:55], v[46:47]
 v_exp_f32 v40, v40
 v_exp_f32 v41, v41
 v_exp_f32 v42, v42
 v_exp_f32 v43, v43
 v_accvgpr_read_b32 v36, a152
 v_accvgpr_read_b32 v37, a153
 v_accvgpr_read_b32 v38, a154
 v_accvgpr_read_b32 v39, a155
 v_exp_f32 v52, v52
 v_exp_f32 v53, v53
 v_exp_f32 v54, v54
 v_exp_f32 v55, v55
 v_accvgpr_read_b32 v48, a168
 v_accvgpr_read_b32 v49, a169
 v_accvgpr_read_b32 v50, a170
 v_accvgpr_read_b32 v51, a171
 v_pk_add_f32 v[40:41], v[40:41], 1.0 op_sel_hi:[1,0]
 v_pk_add_f32 v[42:43], v[42:43], 1.0 op_sel_hi:[1,0]
 v_pk_add_f32 v[52:53], v[52:53], 1.0 op_sel_hi:[1,0]
 v_pk_add_f32 v[54:55], v[54:55], 1.0 op_sel_hi:[1,0]
 v_rcp_f32 v40, v40
 v_rcp_f32 v41, v41
 v_rcp_f32 v42, v42
 v_rcp_f32 v43, v43
 v_pk_mul_f32 v[36:37], v[36:37], v[32:33]
 v_pk_mul_f32 v[38:39], v[38:39], v[34:35]
 v_rcp_f32 v52, v52
 v_rcp_f32 v53, v53
 v_rcp_f32 v54, v54
 v_rcp_f32 v55, v55
 v_pk_mul_f32 v[48:49], v[48:49], v[44:45]
 v_pk_mul_f32 v[50:51], v[50:51], v[46:47]
 v_pk_mul_f32 v[36:37], v[36:37], v[40:41]
 v_pk_mul_f32 v[38:39], v[38:39], v[42:43]
 v_pk_mul_f32 v[48:49], v[48:49], v[52:53]
 v_pk_mul_f32 v[50:51], v[50:51], v[54:55]
 v_cvt_pk_bf16_f32 v92, v36, v37
 v_cvt_pk_bf16_f32 v93, v38, v39
 v_cvt_pk_bf16_f32 v94, v48, v49
 v_cvt_pk_bf16_f32 v95, v50, v51
 buffer_store_dwordx4 v[92:95], v6, s[20:23], 0 offen offset:1024 sc1
 s_add_u32 s55, s39, 16384
 s_add_u32 m0, s40, 81920
 s_nop 0
 buffer_load_dwordx4 v12, s[28:31], s55 offen lds
 buffer_load_dwordx4 v13, s[28:31], s55 offen offset:1024 lds
 v_accvgpr_read_b32 v32, a72
 v_accvgpr_read_b32 v33, a73
 v_accvgpr_read_b32 v34, a74
 v_accvgpr_read_b32 v35, a75
 v_accvgpr_read_b32 v44, a88
 v_accvgpr_read_b32 v45, a89
 v_accvgpr_read_b32 v46, a90
 v_accvgpr_read_b32 v47, a91
 v_pk_mul_f32 v[40:41], v[32:33], v[32:33]
 v_pk_mul_f32 v[42:43], v[34:35], v[34:35]
 v_pk_mul_f32 v[52:53], v[44:45], v[44:45]
 v_pk_mul_f32 v[54:55], v[46:47], v[46:47]
 v_pk_fma_f32 v[40:41], v[40:41], v[30:31], v[28:29]
 v_pk_fma_f32 v[42:43], v[42:43], v[30:31], v[28:29]
 v_pk_fma_f32 v[52:53], v[52:53], v[30:31], v[28:29]
 v_pk_fma_f32 v[54:55], v[54:55], v[30:31], v[28:29]
 v_pk_mul_f32 v[40:41], v[40:41], v[32:33]
 v_pk_mul_f32 v[42:43], v[42:43], v[34:35]
 v_pk_mul_f32 v[52:53], v[52:53], v[44:45]
 v_pk_mul_f32 v[54:55], v[54:55], v[46:47]
 v_exp_f32 v40, v40
 v_exp_f32 v41, v41
 v_exp_f32 v42, v42
 v_exp_f32 v43, v43
 v_accvgpr_read_b32 v36, a184
 v_accvgpr_read_b32 v37, a185
 v_accvgpr_read_b32 v38, a186
 v_accvgpr_read_b32 v39, a187
 v_exp_f32 v52, v52
 v_exp_f32 v53, v53
 v_exp_f32 v54, v54
 v_exp_f32 v55, v55
 v_accvgpr_read_b32 v48, a200
 v_accvgpr_read_b32 v49, a201
 v_accvgpr_read_b32 v50, a202
 v_accvgpr_read_b32 v51, a203
 v_pk_add_f32 v[40:41], v[40:41], 1.0 op_sel_hi:[1,0]
 v_pk_add_f32 v[42:43], v[42:43], 1.0 op_sel_hi:[1,0]
 v_pk_add_f32 v[52:53], v[52:53], 1.0 op_sel_hi:[1,0]
 v_pk_add_f32 v[54:55], v[54:55], 1.0 op_sel_hi:[1,0]
 v_rcp_f32 v40, v40
 v_rcp_f32 v41, v41
 v_rcp_f32 v42, v42
 v_rcp_f32 v43, v43
 v_pk_mul_f32 v[36:37], v[36:37], v[32:33]
 v_pk_mul_f32 v[38:39], v[38:39], v[34:35]
 v_rcp_f32 v52, v52
 v_rcp_f32 v53, v53
 v_rcp_f32 v54, v54
 v_rcp_f32 v55, v55
 v_pk_mul_f32 v[48:49], v[48:49], v[44:45]
 v_pk_mul_f32 v[50:51], v[50:51], v[46:47]
 v_pk_mul_f32 v[36:37], v[36:37], v[40:41]
 v_pk_mul_f32 v[38:39], v[38:39], v[42:43]
 v_pk_mul_f32 v[48:49], v[48:49], v[52:53]
 v_pk_mul_f32 v[50:51], v[50:51], v[54:55]
 v_cvt_pk_bf16_f32 v64, v36, v37
 v_cvt_pk_bf16_f32 v65, v38, v39
 v_cvt_pk_bf16_f32 v66, v48, v49
 v_cvt_pk_bf16_f32 v67, v50, v51
 buffer_store_dwordx4 v[64:67], v6, s[20:23], 0 offen offset:2048 sc1
 buffer_load_dwordx4 v12, s[28:31], s55 offen offset:2048 lds
 buffer_load_dwordx4 v13, s[28:31], s55 offen offset:3072 lds
 v_accvgpr_read_b32 v32, a12
 v_accvgpr_read_b32 v33, a13
 v_accvgpr_read_b32 v34, a14
 v_accvgpr_read_b32 v35, a15
 v_accvgpr_read_b32 v44, a28
 v_accvgpr_read_b32 v45, a29
 v_accvgpr_read_b32 v46, a30
 v_accvgpr_read_b32 v47, a31
 v_pk_mul_f32 v[40:41], v[32:33], v[32:33]
 v_pk_mul_f32 v[42:43], v[34:35], v[34:35]
 v_pk_mul_f32 v[52:53], v[44:45], v[44:45]
 v_pk_mul_f32 v[54:55], v[46:47], v[46:47]
 v_pk_fma_f32 v[40:41], v[40:41], v[30:31], v[28:29]
 v_pk_fma_f32 v[42:43], v[42:43], v[30:31], v[28:29]
 v_pk_fma_f32 v[52:53], v[52:53], v[30:31], v[28:29]
 v_pk_fma_f32 v[54:55], v[54:55], v[30:31], v[28:29]
 v_pk_mul_f32 v[40:41], v[40:41], v[32:33]
 v_pk_mul_f32 v[42:43], v[42:43], v[34:35]
 v_pk_mul_f32 v[52:53], v[52:53], v[44:45]
 v_pk_mul_f32 v[54:55], v[54:55], v[46:47]
 v_exp_f32 v40, v40
 v_exp_f32 v41, v41
 v_exp_f32 v42, v42
 v_exp_f32 v43, v43
 v_accvgpr_read_b32 v36, a124
 v_accvgpr_read_b32 v37, a125
 v_accvgpr_read_b32 v38, a126
 v_accvgpr_read_b32 v39, a127
 v_exp_f32 v52, v52
 v_exp_f32 v53, v53
 v_exp_f32 v54, v54
 v_exp_f32 v55, v55
 v_accvgpr_read_b32 v48, a140
 v_accvgpr_read_b32 v49, a141
 v_accvgpr_read_b32 v50, a142
 v_accvgpr_read_b32 v51, a143
 v_pk_add_f32 v[40:41], v[40:41], 1.0 op_sel_hi:[1,0]
 v_pk_add_f32 v[42:43], v[42:43], 1.0 op_sel_hi:[1,0]
 v_pk_add_f32 v[52:53], v[52:53], 1.0 op_sel_hi:[1,0]
 v_pk_add_f32 v[54:55], v[54:55], 1.0 op_sel_hi:[1,0]
 v_rcp_f32 v40, v40
 v_rcp_f32 v41, v41
 v_rcp_f32 v42, v42
 v_rcp_f32 v43, v43
 v_pk_mul_f32 v[36:37], v[36:37], v[32:33]
 v_pk_mul_f32 v[38:39], v[38:39], v[34:35]
 v_rcp_f32 v52, v52
 v_rcp_f32 v53, v53
 v_rcp_f32 v54, v54
 v_rcp_f32 v55, v55
 v_pk_mul_f32 v[48:49], v[48:49], v[44:45]
 v_pk_mul_f32 v[50:51], v[50:51], v[46:47]
 v_pk_mul_f32 v[36:37], v[36:37], v[40:41]
 v_pk_mul_f32 v[38:39], v[38:39], v[42:43]
 v_pk_mul_f32 v[48:49], v[48:49], v[52:53]
 v_pk_mul_f32 v[50:51], v[50:51], v[54:55]
 v_cvt_pk_bf16_f32 v68, v36, v37
 v_cvt_pk_bf16_f32 v69, v38, v39
 v_cvt_pk_bf16_f32 v70, v48, v49
 v_cvt_pk_bf16_f32 v71, v50, v51
 buffer_store_dwordx4 v[68:71], v7, s[20:23], 0 offen sc1
 v_accvgpr_read_b32 v32, a44
 v_accvgpr_read_b32 v33, a45
 v_accvgpr_read_b32 v34, a46
 v_accvgpr_read_b32 v35, a47
 v_accvgpr_read_b32 v44, a60
 v_accvgpr_read_b32 v45, a61
 v_accvgpr_read_b32 v46, a62
 v_accvgpr_read_b32 v47, a63
 v_pk_mul_f32 v[40:41], v[32:33], v[32:33]
 v_pk_mul_f32 v[42:43], v[34:35], v[34:35]
 v_pk_mul_f32 v[52:53], v[44:45], v[44:45]
 v_pk_mul_f32 v[54:55], v[46:47], v[46:47]
 v_pk_fma_f32 v[40:41], v[40:41], v[30:31], v[28:29]
 v_pk_fma_f32 v[42:43], v[42:43], v[30:31], v[28:29]
 v_pk_fma_f32 v[52:53], v[52:53], v[30:31], v[28:29]
 v_pk_fma_f32 v[54:55], v[54:55], v[30:31], v[28:29]
 v_pk_mul_f32 v[40:41], v[40:41], v[32:33]
 v_pk_mul_f32 v[42:43], v[42:43], v[34:35]
 v_pk_mul_f32 v[52:53], v[52:53], v[44:45]
 v_pk_mul_f32 v[54:55], v[54:55], v[46:47]
 v_exp_f32 v40, v40
 v_exp_f32 v41, v41
 v_exp_f32 v42, v42
 v_exp_f32 v43, v43
 v_accvgpr_read_b32 v36, a156
 v_accvgpr_read_b32 v37, a157
 v_accvgpr_read_b32 v38, a158
 v_accvgpr_read_b32 v39, a159
 v_exp_f32 v52, v52
 v_exp_f32 v53, v53
 v_exp_f32 v54, v54
 v_exp_f32 v55, v55
 v_accvgpr_read_b32 v48, a172
 v_accvgpr_read_b32 v49, a173
 v_accvgpr_read_b32 v50, a174
 v_accvgpr_read_b32 v51, a175
 v_pk_add_f32 v[40:41], v[40:41], 1.0 op_sel_hi:[1,0]
 v_pk_add_f32 v[42:43], v[42:43], 1.0 op_sel_hi:[1,0]
 v_pk_add_f32 v[52:53], v[52:53], 1.0 op_sel_hi:[1,0]
 v_pk_add_f32 v[54:55], v[54:55], 1.0 op_sel_hi:[1,0]
 v_rcp_f32 v40, v40
 v_rcp_f32 v41, v41
 v_rcp_f32 v42, v42
 v_rcp_f32 v43, v43
 v_pk_mul_f32 v[36:37], v[36:37], v[32:33]
 v_pk_mul_f32 v[38:39], v[38:39], v[34:35]
 v_rcp_f32 v52, v52
 v_rcp_f32 v53, v53
 v_rcp_f32 v54, v54
 v_rcp_f32 v55, v55
 v_pk_mul_f32 v[48:49], v[48:49], v[44:45]
 v_pk_mul_f32 v[50:51], v[50:51], v[46:47]
 v_pk_mul_f32 v[36:37], v[36:37], v[40:41]
 v_pk_mul_f32 v[38:39], v[38:39], v[42:43]
 v_pk_mul_f32 v[48:49], v[48:49], v[52:53]
 v_pk_mul_f32 v[50:51], v[50:51], v[54:55]
 v_cvt_pk_bf16_f32 v72, v36, v37
 v_cvt_pk_bf16_f32 v73, v38, v39
 v_cvt_pk_bf16_f32 v74, v48, v49
 v_cvt_pk_bf16_f32 v75, v50, v51
 buffer_store_dwordx4 v[72:75], v7, s[20:23], 0 offen offset:1024 sc1
 v_accvgpr_read_b32 v32, a76
 v_accvgpr_read_b32 v33, a77
 v_accvgpr_read_b32 v34, a78
 v_accvgpr_read_b32 v35, a79
 v_accvgpr_read_b32 v44, a92
 v_accvgpr_read_b32 v45, a93
 v_accvgpr_read_b32 v46, a94
 v_accvgpr_read_b32 v47, a95
 v_pk_mul_f32 v[40:41], v[32:33], v[32:33]
 v_pk_mul_f32 v[42:43], v[34:35], v[34:35]
 v_pk_mul_f32 v[52:53], v[44:45], v[44:45]
 v_pk_mul_f32 v[54:55], v[46:47], v[46:47]
 v_pk_fma_f32 v[40:41], v[40:41], v[30:31], v[28:29]
 v_pk_fma_f32 v[42:43], v[42:43], v[30:31], v[28:29]
 v_pk_fma_f32 v[52:53], v[52:53], v[30:31], v[28:29]
 v_pk_fma_f32 v[54:55], v[54:55], v[30:31], v[28:29]
 v_pk_mul_f32 v[40:41], v[40:41], v[32:33]
 v_pk_mul_f32 v[42:43], v[42:43], v[34:35]
 v_pk_mul_f32 v[52:53], v[52:53], v[44:45]
 v_pk_mul_f32 v[54:55], v[54:55], v[46:47]
 v_exp_f32 v40, v40
 v_exp_f32 v41, v41
 v_exp_f32 v42, v42
 v_exp_f32 v43, v43
 v_accvgpr_read_b32 v36, a188
 v_accvgpr_read_b32 v37, a189
 v_accvgpr_read_b32 v38, a190
 v_accvgpr_read_b32 v39, a191
 v_exp_f32 v52, v52
 v_exp_f32 v53, v53
 v_exp_f32 v54, v54
 v_exp_f32 v55, v55
 v_accvgpr_read_b32 v48, a204
 v_accvgpr_read_b32 v49, a205
 v_accvgpr_read_b32 v50, a206
 v_accvgpr_read_b32 v51, a207
 v_pk_add_f32 v[40:41], v[40:41], 1.0 op_sel_hi:[1,0]
 v_pk_add_f32 v[42:43], v[42:43], 1.0 op_sel_hi:[1,0]
 v_pk_add_f32 v[52:53], v[52:53], 1.0 op_sel_hi:[1,0]
 v_pk_add_f32 v[54:55], v[54:55], 1.0 op_sel_hi:[1,0]
 v_rcp_f32 v40, v40
 v_rcp_f32 v41, v41
 v_rcp_f32 v42, v42
 v_rcp_f32 v43, v43
 v_pk_mul_f32 v[36:37], v[36:37], v[32:33]
 v_pk_mul_f32 v[38:39], v[38:39], v[34:35]
 v_rcp_f32 v52, v52
 v_rcp_f32 v53, v53
 v_rcp_f32 v54, v54
 v_rcp_f32 v55, v55
 v_pk_mul_f32 v[48:49], v[48:49], v[44:45]
 v_pk_mul_f32 v[50:51], v[50:51], v[46:47]
 v_pk_mul_f32 v[36:37], v[36:37], v[40:41]
 v_pk_mul_f32 v[38:39], v[38:39], v[42:43]
 v_pk_mul_f32 v[48:49], v[48:49], v[52:53]
 v_pk_mul_f32 v[50:51], v[50:51], v[54:55]
 v_cvt_pk_bf16_f32 v76, v36, v37
 v_cvt_pk_bf16_f32 v77, v38, v39
 v_cvt_pk_bf16_f32 v78, v48, v49
 v_cvt_pk_bf16_f32 v79, v50, v51
 buffer_store_dwordx4 v[76:79], v7, s[20:23], 0 offen offset:2048 sc1
 v_accvgpr_read_b32 v32, a96
 v_accvgpr_read_b32 v33, a97
 v_accvgpr_read_b32 v34, a98
 v_accvgpr_read_b32 v35, a99
 v_accvgpr_read_b32 v44, a100
 v_accvgpr_read_b32 v45, a101
 v_accvgpr_read_b32 v46, a102
 v_accvgpr_read_b32 v47, a103
 v_pk_mul_f32 v[40:41], v[32:33], v[32:33]
 v_pk_mul_f32 v[42:43], v[34:35], v[34:35]
 v_pk_mul_f32 v[52:53], v[44:45], v[44:45]
 v_pk_mul_f32 v[54:55], v[46:47], v[46:47]
 v_pk_fma_f32 v[40:41], v[40:41], v[30:31], v[28:29]
 v_pk_fma_f32 v[42:43], v[42:43], v[30:31], v[28:29]
 v_pk_fma_f32 v[52:53], v[52:53], v[30:31], v[28:29]
 v_pk_fma_f32 v[54:55], v[54:55], v[30:31], v[28:29]
 v_pk_mul_f32 v[40:41], v[40:41], v[32:33]
 v_pk_mul_f32 v[42:43], v[42:43], v[34:35]
 v_pk_mul_f32 v[52:53], v[52:53], v[44:45]
 v_pk_mul_f32 v[54:55], v[54:55], v[46:47]
 v_exp_f32 v40, v40
 v_exp_f32 v41, v41
 v_exp_f32 v42, v42
 v_exp_f32 v43, v43
 v_accvgpr_read_b32 v36, a208
 v_accvgpr_read_b32 v37, a209
 v_accvgpr_read_b32 v38, a210
 v_accvgpr_read_b32 v39, a211
 v_exp_f32 v52, v52
 v_exp_f32 v53, v53
 v_exp_f32 v54, v54
 v_exp_f32 v55, v55
 v_accvgpr_read_b32 v48, a212
 v_accvgpr_read_b32 v49, a213
 v_accvgpr_read_b32 v50, a214
 v_accvgpr_read_b32 v51, a215
 v_pk_add_f32 v[40:41], v[40:41], 1.0 op_sel_hi:[1,0]
 v_pk_add_f32 v[42:43], v[42:43], 1.0 op_sel_hi:[1,0]
 v_pk_add_f32 v[52:53], v[52:53], 1.0 op_sel_hi:[1,0]
 v_pk_add_f32 v[54:55], v[54:55], 1.0 op_sel_hi:[1,0]
 v_rcp_f32 v40, v40
 v_rcp_f32 v41, v41
 v_rcp_f32 v42, v42
 v_rcp_f32 v43, v43
 v_pk_mul_f32 v[36:37], v[36:37], v[32:33]
 v_pk_mul_f32 v[38:39], v[38:39], v[34:35]
 v_rcp_f32 v52, v52
 v_rcp_f32 v53, v53
 v_rcp_f32 v54, v54
 v_rcp_f32 v55, v55
 v_pk_mul_f32 v[48:49], v[48:49], v[44:45]
 v_pk_mul_f32 v[50:51], v[50:51], v[46:47]
 v_pk_mul_f32 v[36:37], v[36:37], v[40:41]
 v_pk_mul_f32 v[38:39], v[38:39], v[42:43]
 v_pk_mul_f32 v[48:49], v[48:49], v[52:53]
 v_pk_mul_f32 v[50:51], v[50:51], v[54:55]
 v_cvt_pk_bf16_f32 v80, v36, v37
 v_cvt_pk_bf16_f32 v81, v38, v39
 v_cvt_pk_bf16_f32 v82, v48, v49
 v_cvt_pk_bf16_f32 v83, v50, v51
 buffer_store_dwordx2 v[80:81], v132, s[20:23], 0 offen sc1
 buffer_store_dwordx2 v[82:83], v133, s[20:23], 0 offen sc1
 v_accvgpr_read_b32 v32, a104
 v_accvgpr_read_b32 v33, a105
 v_accvgpr_read_b32 v34, a106
 v_accvgpr_read_b32 v35, a107
 v_accvgpr_read_b32 v44, a108
 v_accvgpr_read_b32 v45, a109
 v_accvgpr_read_b32 v46, a110
 v_accvgpr_read_b32 v47, a111
 v_pk_mul_f32 v[40:41], v[32:33], v[32:33]
 v_pk_mul_f32 v[42:43], v[34:35], v[34:35]
 v_pk_mul_f32 v[52:53], v[44:45], v[44:45]
 v_pk_mul_f32 v[54:55], v[46:47], v[46:47]
 v_pk_fma_f32 v[40:41], v[40:41], v[30:31], v[28:29]
 v_pk_fma_f32 v[42:43], v[42:43], v[30:31], v[28:29]
 v_pk_fma_f32 v[52:53], v[52:53], v[30:31], v[28:29]
 v_pk_fma_f32 v[54:55], v[54:55], v[30:31], v[28:29]
 v_pk_mul_f32 v[40:41], v[40:41], v[32:33]
 v_pk_mul_f32 v[42:43], v[42:43], v[34:35]
 v_pk_mul_f32 v[52:53], v[52:53], v[44:45]
 v_pk_mul_f32 v[54:55], v[54:55], v[46:47]
 v_exp_f32 v40, v40
 v_exp_f32 v41, v41
 v_exp_f32 v42, v42
 v_exp_f32 v43, v43
 v_accvgpr_read_b32 v36, a216
 v_accvgpr_read_b32 v37, a217
 v_accvgpr_read_b32 v38, a218
 v_accvgpr_read_b32 v39, a219
 v_exp_f32 v52, v52
 v_exp_f32 v53, v53
 v_exp_f32 v54, v54
 v_exp_f32 v55, v55
 v_accvgpr_read_b32 v48, a220
 v_accvgpr_read_b32 v49, a221
 v_accvgpr_read_b32 v50, a222
 v_accvgpr_read_b32 v51, a223
 v_pk_add_f32 v[40:41], v[40:41], 1.0 op_sel_hi:[1,0]
 v_pk_add_f32 v[42:43], v[42:43], 1.0 op_sel_hi:[1,0]
 v_pk_add_f32 v[52:53], v[52:53], 1.0 op_sel_hi:[1,0]
 v_pk_add_f32 v[54:55], v[54:55], 1.0 op_sel_hi:[1,0]
 v_rcp_f32 v40, v40
 v_rcp_f32 v41, v41
 v_rcp_f32 v42, v42
 v_rcp_f32 v43, v43
 v_pk_mul_f32 v[36:37], v[36:37], v[32:33]
 v_pk_mul_f32 v[38:39], v[38:39], v[34:35]
 v_rcp_f32 v52, v52
 v_rcp_f32 v53, v53
 v_rcp_f32 v54, v54
 v_rcp_f32 v55, v55
 v_pk_mul_f32 v[48:49], v[48:49], v[44:45]
 v_pk_mul_f32 v[50:51], v[50:51], v[46:47]
 v_pk_mul_f32 v[36:37], v[36:37], v[40:41]
 v_pk_mul_f32 v[38:39], v[38:39], v[42:43]
 v_pk_mul_f32 v[48:49], v[48:49], v[52:53]
 v_pk_mul_f32 v[50:51], v[50:51], v[54:55]
 v_cvt_pk_bf16_f32 v84, v36, v37
 v_cvt_pk_bf16_f32 v85, v38, v39
 v_cvt_pk_bf16_f32 v86, v48, v49
 v_cvt_pk_bf16_f32 v87, v50, v51
 buffer_store_dwordx2 v[84:85], v134, s[20:23], 0 offen sc1
 buffer_store_dwordx2 v[86:87], v135, s[20:23], 0 offen sc1
 s_branch B_epi_done
B_epi_odd:
 s_add_u32 s55, s39, 0
 s_add_u32 m0, s40, 0
 s_nop 0
 buffer_load_dwordx4 v8, s[24:27], s55 offen lds
 buffer_load_dwordx4 v9, s[24:27], s55 offen offset:1024 lds
 v_accvgpr_read_b32 v32, a16
 v_accvgpr_read_b32 v33, a17
 v_accvgpr_read_b32 v34, a18
 v_accvgpr_read_b32 v35, a19
 v_accvgpr_read_b32 v44, a32
 v_accvgpr_read_b32 v45, a33
 v_accvgpr_read_b32 v46, a34
 v_accvgpr_read_b32 v47, a35
 v_pk_mul_f32 v[40:41], v[32:33], v[32:33]
 v_pk_mul_f32 v[42:43], v[34:35], v[34:35]
 v_pk_mul_f32 v[52:53], v[44:45], v[44:45]
 v_pk_mul_f32 v[54:55], v[46:47], v[46:47]
 v_pk_fma_f32 v[40:41], v[40:41], v[30:31], v[28:29]
 v_pk_fma_f32 v[42:43], v[42:43], v[30:31], v[28:29]
 v_pk_fma_f32 v[52:53], v[52:53], v[30:31], v[28:29]
 v_pk_fma_f32 v[54:55], v[54:55], v[30:31], v[28:29]
 v_pk_mul_f32 v[40:41], v[40:41], v[32:33]
 v_pk_mul_f32 v[42:43], v[42:43], v[34:35]
 v_pk_mul_f32 v[52:53], v[52:53], v[44:45]
 v_pk_mul_f32 v[54:55], v[54:55], v[46:47]
 v_exp_f32 v40, v40
 v_exp_f32 v41, v41
 v_exp_f32 v42, v42
 v_exp_f32 v43, v43
 v_accvgpr_read_b32 v36, a128
 v_accvgpr_read_b32 v37, a129
 v_accvgpr_read_b32 v38, a130
 v_accvgpr_read_b32 v39, a131
 v_exp_f32 v52, v52
 v_exp_f32 v53, v53
 v_exp_f32 v54, v54
 v_exp_f32 v55, v55
 v_accvgpr_read_b32 v48, a144
 v_accvgpr_read_b32 v49, a145
 v_accvgpr_read_b32 v50, a146
 v_accvgpr_read_b32 v51, a147
 v_pk_add_f32 v[40:41], v[40:41], 1.0 op_sel_hi:[1,0]
 v_pk_add_f32 v[42:43], v[42:43], 1.0 op_sel_hi:[1,0]
 v_pk_add_f32 v[52:53], v[52:53], 1.0 op_sel_hi:[1,0]
 v_pk_add_f32 v[54:55], v[54:55], 1.0 op_sel_hi:[1,0]
 v_rcp_f32 v40, v40
 v_rcp_f32 v41, v41
 v_rcp_f32 v42, v42
 v_rcp_f32 v43, v43
 v_pk_mul_f32 v[36:37], v[36:37], v[32:33]
 v_pk_mul_f32 v[38:39], v[38:39], v[34:35]
 v_rcp_f32 v52, v52
 v_rcp_f32 v53, v53
 v_rcp_f32 v54, v54
 v_rcp_f32 v55, v55
 v_pk_mul_f32 v[48:49], v[48:49], v[44:45]
 v_pk_mul_f32 v[50:51], v[50:51], v[46:47]
 v_pk_mul_f32 v[36:37], v[36:37], v[40:41]
 v_pk_mul_f32 v[38:39], v[38:39], v[42:43]
 v_pk_mul_f32 v[48:49], v[48:49], v[52:53]
 v_pk_mul_f32 v[50:51], v[50:51], v[54:55]
 v_cvt_pk_bf16_f32 v64, v36, v37
 v_cvt_pk_bf16_f32 v65, v38, v39
 v_cvt_pk_bf16_f32 v66, v48, v49
 v_cvt_pk_bf16_f32 v67, v50, v51
 buffer_store_dwordx4 v[64:67], v4, s[20:23], 0 offen sc1
 buffer_load_dwordx4 v10, s[24:27], s55 offen offset:2048 lds
 buffer_load_dwordx4 v11, s[24:27], s55 offen offset:3072 lds
 v_accvgpr_read_b32 v32, a48
 v_accvgpr_read_b32 v33, a49
 v_accvgpr_read_b32 v34, a50
 v_accvgpr_read_b32 v35, a51
 v_accvgpr_read_b32 v44, a64
 v_accvgpr_read_b32 v45, a65
 v_accvgpr_read_b32 v46, a66
 v_accvgpr_read_b32 v47, a67
 v_pk_mul_f32 v[40:41], v[32:33], v[32:33]
 v_pk_mul_f32 v[42:43], v[34:35], v[34:35]
 v_pk_mul_f32 v[52:53], v[44:45], v[44:45]
 v_pk_mul_f32 v[54:55], v[46:47], v[46:47]
 v_pk_fma_f32 v[40:41], v[40:41], v[30:31], v[28:29]
 v_pk_fma_f32 v[42:43], v[42:43], v[30:31], v[28:29]
 v_pk_fma_f32 v[52:53], v[52:53], v[30:31], v[28:29]
 v_pk_fma_f32 v[54:55], v[54:55], v[30:31], v[28:29]
 v_pk_mul_f32 v[40:41], v[40:41], v[32:33]
 v_pk_mul_f32 v[42:43], v[42:43], v[34:35]
 v_pk_mul_f32 v[52:53], v[52:53], v[44:45]
 v_pk_mul_f32 v[54:55], v[54:55], v[46:47]
 v_exp_f32 v40, v40
 v_exp_f32 v41, v41
 v_exp_f32 v42, v42
 v_exp_f32 v43, v43
 v_accvgpr_read_b32 v36, a160
 v_accvgpr_read_b32 v37, a161
 v_accvgpr_read_b32 v38, a162
 v_accvgpr_read_b32 v39, a163
 v_exp_f32 v52, v52
 v_exp_f32 v53, v53
 v_exp_f32 v54, v54
 v_exp_f32 v55, v55
 v_accvgpr_read_b32 v48, a176
 v_accvgpr_read_b32 v49, a177
 v_accvgpr_read_b32 v50, a178
 v_accvgpr_read_b32 v51, a179
 v_pk_add_f32 v[40:41], v[40:41], 1.0 op_sel_hi:[1,0]
 v_pk_add_f32 v[42:43], v[42:43], 1.0 op_sel_hi:[1,0]
 v_pk_add_f32 v[52:53], v[52:53], 1.0 op_sel_hi:[1,0]
 v_pk_add_f32 v[54:55], v[54:55], 1.0 op_sel_hi:[1,0]
 v_rcp_f32 v40, v40
 v_rcp_f32 v41, v41
 v_rcp_f32 v42, v42
 v_rcp_f32 v43, v43
 v_pk_mul_f32 v[36:37], v[36:37], v[32:33]
 v_pk_mul_f32 v[38:39], v[38:39], v[34:35]
 v_rcp_f32 v52, v52
 v_rcp_f32 v53, v53
 v_rcp_f32 v54, v54
 v_rcp_f32 v55, v55
 v_pk_mul_f32 v[48:49], v[48:49], v[44:45]
 v_pk_mul_f32 v[50:51], v[50:51], v[46:47]
 v_pk_mul_f32 v[36:37], v[36:37], v[40:41]
 v_pk_mul_f32 v[38:39], v[38:39], v[42:43]
 v_pk_mul_f32 v[48:49], v[48:49], v[52:53]
 v_pk_mul_f32 v[50:51], v[50:51], v[54:55]
 v_cvt_pk_bf16_f32 v68, v36, v37
 v_cvt_pk_bf16_f32 v69, v38, v39
 v_cvt_pk_bf16_f32 v70, v48, v49
 v_cvt_pk_bf16_f32 v71, v50, v51
 buffer_store_dwordx4 v[68:71], v4, s[20:23], 0 offen offset:1024 sc1
 s_add_u32 s55, s39, 16384
 s_add_u32 m0, s40, 16384
 s_nop 0
 buffer_load_dwordx4 v8, s[24:27], s55 offen lds
 buffer_load_dwordx4 v9, s[24:27], s55 offen offset:1024 lds
 v_accvgpr_read_b32 v32, a80
 v_accvgpr_read_b32 v33, a81
 v_accvgpr_read_b32 v34, a82
 v_accvgpr_read_b32 v35, a83
 v_accvgpr_read_b32 v44, a96
 v_accvgpr_read_b32 v45, a97
 v_accvgpr_read_b32 v46, a98
 v_accvgpr_read_b32 v47, a99
 v_pk_mul_f32 v[40:41], v[32:33], v[32:33]
 v_pk_mul_f32 v[42:43], v[34:35], v[34:35]
 v_pk_mul_f32 v[52:53], v[44:45], v[44:45]
 v_pk_mul_f32 v[54:55], v[46:47], v[46:47]
 v_pk_fma_f32 v[40:41], v[40:41], v[30:31], v[28:29]
 v_pk_fma_f32 v[42:43], v[42:43], v[30:31], v[28:29]
 v_pk_fma_f32 v[52:53], v[52:53], v[30:31], v[28:29]
 v_pk_fma_f32 v[54:55], v[54:55], v[30:31], v[28:29]
 v_pk_mul_f32 v[40:41], v[40:41], v[32:33]
 v_pk_mul_f32 v[42:43], v[42:43], v[34:35]
 v_pk_mul_f32 v[52:53], v[52:53], v[44:45]
 v_pk_mul_f32 v[54:55], v[54:55], v[46:47]
 v_exp_f32 v40, v40
 v_exp_f32 v41, v41
 v_exp_f32 v42, v42
 v_exp_f32 v43, v43
 v_accvgpr_read_b32 v36, a192
 v_accvgpr_read_b32 v37, a193
 v_accvgpr_read_b32 v38, a194
 v_accvgpr_read_b32 v39, a195
 v_exp_f32 v52, v52
 v_exp_f32 v53, v53
 v_exp_f32 v54, v54
 v_exp_f32 v55, v55
 v_accvgpr_read_b32 v48, a208
 v_accvgpr_read_b32 v49, a209
 v_accvgpr_read_b32 v50, a210
 v_accvgpr_read_b32 v51, a211
 v_pk_add_f32 v[40:41], v[40:41], 1.0 op_sel_hi:[1,0]
 v_pk_add_f32 v[42:43], v[42:43], 1.0 op_sel_hi:[1,0]
 v_pk_add_f32 v[52:53], v[52:53], 1.0 op_sel_hi:[1,0]
 v_pk_add_f32 v[54:55], v[54:55], 1.0 op_sel_hi:[1,0]
 v_rcp_f32 v40, v40
 v_rcp_f32 v41, v41
 v_rcp_f32 v42, v42
 v_rcp_f32 v43, v43
 v_pk_mul_f32 v[36:37], v[36:37], v[32:33]
 v_pk_mul_f32 v[38:39], v[38:39], v[34:35]
 v_rcp_f32 v52, v52
 v_rcp_f32 v53, v53
 v_rcp_f32 v54, v54
 v_rcp_f32 v55, v55
 v_pk_mul_f32 v[48:49], v[48:49], v[44:45]
 v_pk_mul_f32 v[50:51], v[50:51], v[46:47]
 v_pk_mul_f32 v[36:37], v[36:37], v[40:41]
 v_pk_mul_f32 v[38:39], v[38:39], v[42:43]
 v_pk_mul_f32 v[48:49], v[48:49], v[52:53]
 v_pk_mul_f32 v[50:51], v[50:51], v[54:55]
 v_cvt_pk_bf16_f32 v72, v36, v37
 v_cvt_pk_bf16_f32 v73, v38, v39
 v_cvt_pk_bf16_f32 v74, v48, v49
 v_cvt_pk_bf16_f32 v75, v50, v51
 buffer_store_dwordx4 v[72:75], v4, s[20:23], 0 offen offset:2048 sc1
 buffer_load_dwordx4 v10, s[24:27], s55 offen offset:2048 lds
 buffer_load_dwordx4 v11, s[24:27], s55 offen offset:3072 lds
 v_accvgpr_read_b32 v32, a20
 v_accvgpr_read_b32 v33, a21
 v_accvgpr_read_b32 v34, a22
 v_accvgpr_read_b32 v35, a23
 v_accvgpr_read_b32 v44, a36
 v_accvgpr_read_b32 v45, a37
 v_accvgpr_read_b32 v46, a38
 v_accvgpr_read_b32 v47, a39
 v_pk_mul_f32 v[40:41], v[32:33], v[32:33]
 v_pk_mul_f32 v[42:43], v[34:35], v[34:35]
 v_pk_mul_f32 v[52:53], v[44:45], v[44:45]
 v_pk_mul_f32 v[54:55], v[46:47], v[46:47]
 v_pk_fma_f32 v[40:41], v[40:41], v[30:31], v[28:29]
 v_pk_fma_f32 v[42:43], v[42:43], v[30:31], v[28:29]
 v_pk_fma_f32 v[52:53], v[52:53], v[30:31], v[28:29]
 v_pk_fma_f32 v[54:55], v[54:55], v[30:31], v[28:29]
 v_pk_mul_f32 v[40:41], v[40:41], v[32:33]
 v_pk_mul_f32 v[42:43], v[42:43], v[34:35]
 v_pk_mul_f32 v[52:53], v[52:53], v[44:45]
 v_pk_mul_f32 v[54:55], v[54:55], v[46:47]
 v_exp_f32 v40, v40
 v_exp_f32 v41, v41
 v_exp_f32 v42, v42
 v_exp_f32 v43, v43
 v_accvgpr_read_b32 v36, a132
 v_accvgpr_read_b32 v37, a133
 v_accvgpr_read_b32 v38, a134
 v_accvgpr_read_b32 v39, a135
 v_exp_f32 v52, v52
 v_exp_f32 v53, v53
 v_exp_f32 v54, v54
 v_exp_f32 v55, v55
 v_accvgpr_read_b32 v48, a148
 v_accvgpr_read_b32 v49, a149
 v_accvgpr_read_b32 v50, a150
 v_accvgpr_read_b32 v51, a151
 v_pk_add_f32 v[40:41], v[40:41], 1.0 op_sel_hi:[1,0]
 v_pk_add_f32 v[42:43], v[42:43], 1.0 op_sel_hi:[1,0]
 v_pk_add_f32 v[52:53], v[52:53], 1.0 op_sel_hi:[1,0]
 v_pk_add_f32 v[54:55], v[54:55], 1.0 op_sel_hi:[1,0]
 v_rcp_f32 v40, v40
 v_rcp_f32 v41, v41
 v_rcp_f32 v42, v42
 v_rcp_f32 v43, v43
 v_pk_mul_f32 v[36:37], v[36:37], v[32:33]
 v_pk_mul_f32 v[38:39], v[38:39], v[34:35]
 v_rcp_f32 v52, v52
 v_rcp_f32 v53, v53
 v_rcp_f32 v54, v54
 v_rcp_f32 v55, v55
 v_pk_mul_f32 v[48:49], v[48:49], v[44:45]
 v_pk_mul_f32 v[50:51], v[50:51], v[46:47]
 v_pk_mul_f32 v[36:37], v[36:37], v[40:41]
 v_pk_mul_f32 v[38:39], v[38:39], v[42:43]
 v_pk_mul_f32 v[48:49], v[48:49], v[52:53]
 v_pk_mul_f32 v[50:51], v[50:51], v[54:55]
 v_cvt_pk_bf16_f32 v76, v36, v37
 v_cvt_pk_bf16_f32 v77, v38, v39
 v_cvt_pk_bf16_f32 v78, v48, v49
 v_cvt_pk_bf16_f32 v79, v50, v51
 buffer_store_dwordx4 v[76:79], v5, s[20:23], 0 offen sc1
 s_add_u32 s55, s39, 0
 s_add_u32 m0, s40, 65536
 s_nop 0
 buffer_load_dwordx4 v12, s[28:31], s55 offen lds
 buffer_load_dwordx4 v13, s[28:31], s55 offen offset:1024 lds
 v_accvgpr_read_b32 v32, a52
 v_accvgpr_read_b32 v33, a53
 v_accvgpr_read_b32 v34, a54
 v_accvgpr_read_b32 v35, a55
 v_accvgpr_read_b32 v44, a68
 v_accvgpr_read_b32 v45, a69
 v_accvgpr_read_b32 v46, a70
 v_accvgpr_read_b32 v47, a71
 v_pk_mul_f32 v[40:41], v[32:33], v[32:33]
 v_pk_mul_f32 v[42:43], v[34:35], v[34:35]
 v_pk_mul_f32 v[52:53], v[44:45], v[44:45]
 v_pk_mul_f32 v[54:55], v[46:47], v[46:47]
 v_pk_fma_f32 v[40:41], v[40:41], v[30:31], v[28:29]
 v_pk_fma_f32 v[42:43], v[42:43], v[30:31], v[28:29]
 v_pk_fma_f32 v[52:53], v[52:53], v[30:31], v[28:29]
 v_pk_fma_f32 v[54:55], v[54:55], v[30:31], v[28:29]
 v_pk_mul_f32 v[40:41], v[40:41], v[32:33]
 v_pk_mul_f32 v[42:43], v[42:43], v[34:35]
 v_pk_mul_f32 v[52:53], v[52:53], v[44:45]
 v_pk_mul_f32 v[54:55], v[54:55], v[46:47]
 v_exp_f32 v40, v40
 v_exp_f32 v41, v41
 v_exp_f32 v42, v42
 v_exp_f32 v43, v43
 v_accvgpr_read_b32 v36, a164
 v_accvgpr_read_b32 v37, a165
 v_accvgpr_read_b32 v38, a166
 v_accvgpr_read_b32 v39, a167
 v_exp_f32 v52, v52
 v_exp_f32 v53, v53
 v_exp_f32 v54, v54
 v_exp_f32 v55, v55
 v_accvgpr_read_b32 v48, a180
 v_accvgpr_read_b32 v49, a181
 v_accvgpr_read_b32 v50, a182
 v_accvgpr_read_b32 v51, a183
 v_pk_add_f32 v[40:41], v[40:41], 1.0 op_sel_hi:[1,0]
 v_pk_add_f32 v[42:43], v[42:43], 1.0 op_sel_hi:[1,0]
 v_pk_add_f32 v[52:53], v[52:53], 1.0 op_sel_hi:[1,0]
 v_pk_add_f32 v[54:55], v[54:55], 1.0 op_sel_hi:[1,0]
 v_rcp_f32 v40, v40
 v_rcp_f32 v41, v41
 v_rcp_f32 v42, v42
 v_rcp_f32 v43, v43
 v_pk_mul_f32 v[36:37], v[36:37], v[32:33]
 v_pk_mul_f32 v[38:39], v[38:39], v[34:35]
 v_rcp_f32 v52, v52
 v_rcp_f32 v53, v53
 v_rcp_f32 v54, v54
 v_rcp_f32 v55, v55
 v_pk_mul_f32 v[48:49], v[48:49], v[44:45]
 v_pk_mul_f32 v[50:51], v[50:51], v[46:47]
 v_pk_mul_f32 v[36:37], v[36:37], v[40:41]
 v_pk_mul_f32 v[38:39], v[38:39], v[42:43]
 v_pk_mul_f32 v[48:49], v[48:49], v[52:53]
 v_pk_mul_f32 v[50:51], v[50:51], v[54:55]
 v_cvt_pk_bf16_f32 v80, v36, v37
 v_cvt_pk_bf16_f32 v81, v38, v39
 v_cvt_pk_bf16_f32 v82, v48, v49
 v_cvt_pk_bf16_f32 v83, v50, v51
 buffer_store_dwordx4 v[80:83], v5, s[20:23], 0 offen offset:1024 sc1
 buffer_load_dwordx4 v12, s[28:31], s55 offen offset:2048 lds
 buffer_load_dwordx4 v13, s[28:31], s55 offen offset:3072 lds
 v_accvgpr_read_b32 v32, a84
 v_accvgpr_read_b32 v33, a85
 v_accvgpr_read_b32 v34, a86
 v_accvgpr_read_b32 v35, a87
 v_accvgpr_read_b32 v44, a100
 v_accvgpr_read_b32 v45, a101
 v_accvgpr_read_b32 v46, a102
 v_accvgpr_read_b32 v47, a103
 v_pk_mul_f32 v[40:41], v[32:33], v[32:33]
 v_pk_mul_f32 v[42:43], v[34:35], v[34:35]
 v_pk_mul_f32 v[52:53], v[44:45], v[44:45]
 v_pk_mul_f32 v[54:55], v[46:47], v[46:47]
 v_pk_fma_f32 v[40:41], v[40:41], v[30:31], v[28:29]
 v_pk_fma_f32 v[42:43], v[42:43], v[30:31], v[28:29]
 v_pk_fma_f32 v[52:53], v[52:53], v[30:31], v[28:29]
 v_pk_fma_f32 v[54:55], v[54:55], v[30:31], v[28:29]
 v_pk_mul_f32 v[40:41], v[40:41], v[32:33]
 v_pk_mul_f32 v[42:43], v[42:43], v[34:35]
 v_pk_mul_f32 v[52:53], v[52:53], v[44:45]
 v_pk_mul_f32 v[54:55], v[54:55], v[46:47]
 v_exp_f32 v40, v40
 v_exp_f32 v41, v41
 v_exp_f32 v42, v42
 v_exp_f32 v43, v43
 v_accvgpr_read_b32 v36, a196
 v_accvgpr_read_b32 v37, a197
 v_accvgpr_read_b32 v38, a198
 v_accvgpr_read_b32 v39, a199
 v_exp_f32 v52, v52
 v_exp_f32 v53, v53
 v_exp_f32 v54, v54
 v_exp_f32 v55, v55
 v_accvgpr_read_b32 v48, a212
 v_accvgpr_read_b32 v49, a213
 v_accvgpr_read_b32 v50, a214
 v_accvgpr_read_b32 v51, a215
 v_pk_add_f32 v[40:41], v[40:41], 1.0 op_sel_hi:[1,0]
 v_pk_add_f32 v[42:43], v[42:43], 1.0 op_sel_hi:[1,0]
 v_pk_add_f32 v[52:53], v[52:53], 1.0 op_sel_hi:[1,0]
 v_pk_add_f32 v[54:55], v[54:55], 1.0 op_sel_hi:[1,0]
 v_rcp_f32 v40, v40
 v_rcp_f32 v41, v41
 v_rcp_f32 v42, v42
 v_rcp_f32 v43, v43
 v_pk_mul_f32 v[36:37], v[36:37], v[32:33]
 v_pk_mul_f32 v[38:39], v[38:39], v[34:35]
 v_rcp_f32 v52, v52
 v_rcp_f32 v53, v53
 v_rcp_f32 v54, v54
 v_rcp_f32 v55, v55
 v_pk_mul_f32 v[48:49], v[48:49], v[44:45]
 v_pk_mul_f32 v[50:51], v[50:51], v[46:47]
 v_pk_mul_f32 v[36:37], v[36:37], v[40:41]
 v_pk_mul_f32 v[38:39], v[38:39], v[42:43]
 v_pk_mul_f32 v[48:49], v[48:49], v[52:53]
 v_pk_mul_f32 v[50:51], v[50:51], v[54:55]
 v_cvt_pk_bf16_f32 v84, v36, v37
 v_cvt_pk_bf16_f32 v85, v38, v39
 v_cvt_pk_bf16_f32 v86, v48, v49
 v_cvt_pk_bf16_f32 v87, v50, v51
 buffer_store_dwordx4 v[84:87], v5, s[20:23], 0 offen offset:2048 sc1
 s_add_u32 s55, s39, 32768
 s_add_u32 m0, s40, 32768
 s_nop 0
 buffer_load_dwordx4 v8, s[24:27], s55 offen lds
 buffer_load_dwordx4 v9, s[24:27], s55 offen offset:1024 lds
 v_accvgpr_read_b32 v32, a24
 v_accvgpr_read_b32 v33, a25
 v_accvgpr_read_b32 v34, a26
 v_accvgpr_read_b32 v35, a27
 v_accvgpr_read_b32 v44, a40
 v_accvgpr_read_b32 v45, a41
 v_accvgpr_read_b32 v46, a42
 v_accvgpr_read_b32 v47, a43
 v_pk_mul_f32 v[40:41], v[32:33], v[32:33]
 v_pk_mul_f32 v[42:43], v[34:35], v[34:35]
 v_pk_mul_f32 v[52:53], v[44:45], v[44:45]
 v_pk_mul_f32 v[54:55], v[46:47], v[46:47]
 v_pk_fma_f32 v[40:41], v[40:41], v[30:31], v[28:29]
 v_pk_fma_f32 v[42:43], v[42:43], v[30:31], v[28:29]
 v_pk_fma_f32 v[52:53], v[52:53], v[30:31], v[28:29]
 v_pk_fma_f32 v[54:55], v[54:55], v[30:31], v[28:29]
 v_pk_mul_f32 v[40:41], v[40:41], v[32:33]
 v_pk_mul_f32 v[42:43], v[42:43], v[34:35]
 v_pk_mul_f32 v[52:53], v[52:53], v[44:45]
 v_pk_mul_f32 v[54:55], v[54:55], v[46:47]
 v_exp_f32 v40, v40
 v_exp_f32 v41, v41
 v_exp_f32 v42, v42
 v_exp_f32 v43, v43
 v_accvgpr_read_b32 v36, a136
 v_accvgpr_read_b32 v37, a137
 v_accvgpr_read_b32 v38, a138
 v_accvgpr_read_b32 v39, a139
 v_exp_f32 v52, v52
 v_exp_f32 v53, v53
 v_exp_f32 v54, v54
 v_exp_f32 v55, v55
 v_accvgpr_read_b32 v48, a152
 v_accvgpr_read_b32 v49, a153
 v_accvgpr_read_b32 v50, a154
 v_accvgpr_read_b32 v51, a155
 v_pk_add_f32 v[40:41], v[40:41], 1.0 op_sel_hi:[1,0]
 v_pk_add_f32 v[42:43], v[42:43], 1.0 op_sel_hi:[1,0]
 v_pk_add_f32 v[52:53], v[52:53], 1.0 op_sel_hi:[1,0]
 v_pk_add_f32 v[54:55], v[54:55], 1.0 op_sel_hi:[1,0]
 v_rcp_f32 v40, v40
 v_rcp_f32 v41, v41
 v_rcp_f32 v42, v42
 v_rcp_f32 v43, v43
 v_pk_mul_f32 v[36:37], v[36:37], v[32:33]
 v_pk_mul_f32 v[38:39], v[38:39], v[34:35]
 v_rcp_f32 v52, v52
 v_rcp_f32 v53, v53
 v_rcp_f32 v54, v54
 v_rcp_f32 v55, v55
 v_pk_mul_f32 v[48:49], v[48:49], v[44:45]
 v_pk_mul_f32 v[50:51], v[50:51], v[46:47]
 v_pk_mul_f32 v[36:37], v[36:37], v[40:41]
 v_pk_mul_f32 v[38:39], v[38:39], v[42:43]
 v_pk_mul_f32 v[48:49], v[48:49], v[52:53]
 v_pk_mul_f32 v[50:51], v[50:51], v[54:55]
 v_cvt_pk_bf16_f32 v88, v36, v37
 v_cvt_pk_bf16_f32 v89, v38, v39
 v_cvt_pk_bf16_f32 v90, v48, v49
 v_cvt_pk_bf16_f32 v91, v50, v51
 buffer_store_dwordx4 v[88:91], v6, s[20:23], 0 offen sc1
 buffer_load_dwordx4 v10, s[24:27], s55 offen offset:2048 lds
 buffer_load_dwordx4 v11, s[24:27], s55 offen offset:3072 lds
 v_accvgpr_read_b32 v32, a56
 v_accvgpr_read_b32 v33, a57
 v_accvgpr_read_b32 v34, a58
 v_accvgpr_read_b32 v35, a59
 v_accvgpr_read_b32 v44, a72
 v_accvgpr_read_b32 v45, a73
 v_accvgpr_read_b32 v46, a74
 v_accvgpr_read_b32 v47, a75
 v_pk_mul_f32 v[40:41], v[32:33], v[32:33]
 v_pk_mul_f32 v[42:43], v[34:35], v[34:35]
 v_pk_mul_f32 v[52:53], v[44:45], v[44:45]
 v_pk_mul_f32 v[54:55], v[46:47], v[46:47]
 v_pk_fma_f32 v[40:41], v[40:41], v[30:31], v[28:29]
 v_pk_fma_f32 v[42:43], v[42:43], v[30:31], v[28:29]
 v_pk_fma_f32 v[52:53], v[52:53], v[30:31], v[28:29]
 v_pk_fma_f32 v[54:55], v[54:55], v[30:31], v[28:29]
 v_pk_mul_f32 v[40:41], v[40:41], v[32:33]
 v_pk_mul_f32 v[42:43], v[42:43], v[34:35]
 v_pk_mul_f32 v[52:53], v[52:53], v[44:45]
 v_pk_mul_f32 v[54:55], v[54:55], v[46:47]
 v_exp_f32 v40, v40
 v_exp_f32 v41, v41
 v_exp_f32 v42, v42
 v_exp_f32 v43, v43
 v_accvgpr_read_b32 v36, a168
 v_accvgpr_read_b32 v37, a169
 v_accvgpr_read_b32 v38, a170
 v_accvgpr_read_b32 v39, a171
 v_exp_f32 v52, v52
 v_exp_f32 v53, v53
 v_exp_f32 v54, v54
 v_exp_f32 v55, v55
 v_accvgpr_read_b32 v48, a184
 v_accvgpr_read_b32 v49, a185
 v_accvgpr_read_b32 v50, a186
 v_accvgpr_read_b32 v51, a187
 v_pk_add_f32 v[40:41], v[40:41], 1.0 op_sel_hi:[1,0]
 v_pk_add_f32 v[42:43], v[42:43], 1.0 op_sel_hi:[1,0]
 v_pk_add_f32 v[52:53], v[52:53], 1.0 op_sel_hi:[1,0]
 v_pk_add_f32 v[54:55], v[54:55], 1.0 op_sel_hi:[1,0]
 v_rcp_f32 v40, v40
 v_rcp_f32 v41, v41
 v_rcp_f32 v42, v42
 v_rcp_f32 v43, v43
 v_pk_mul_f32 v[36:37], v[36:37], v[32:33]
 v_pk_mul_f32 v[38:39], v[38:39], v[34:35]
 v_rcp_f32 v52, v52
 v_rcp_f32 v53, v53
 v_rcp_f32 v54, v54
 v_rcp_f32 v55, v55
 v_pk_mul_f32 v[48:49], v[48:49], v[44:45]
 v_pk_mul_f32 v[50:51], v[50:51], v[46:47]
 v_pk_mul_f32 v[36:37], v[36:37], v[40:41]
 v_pk_mul_f32 v[38:39], v[38:39], v[42:43]
 v_pk_mul_f32 v[48:49], v[48:49], v[52:53]
 v_pk_mul_f32 v[50:51], v[50:51], v[54:55]
 v_cvt_pk_bf16_f32 v92, v36, v37
 v_cvt_pk_bf16_f32 v93, v38, v39
 v_cvt_pk_bf16_f32 v94, v48, v49
 v_cvt_pk_bf16_f32 v95, v50, v51
 buffer_store_dwordx4 v[92:95], v6, s[20:23], 0 offen offset:1024 sc1
 s_add_u32 s55, s39, 16384
 s_add_u32 m0, s40, 81920
 s_nop 0
 buffer_load_dwordx4 v12, s[28:31], s55 offen lds
 buffer_load_dwordx4 v13, s[28:31], s55 offen offset:1024 lds
 v_accvgpr_read_b32 v32, a88
 v_accvgpr_read_b32 v33, a89
 v_accvgpr_read_b32 v34, a90
 v_accvgpr_read_b32 v35, a91
 v_accvgpr_read_b32 v44, a104
 v_accvgpr_read_b32 v45, a105
 v_accvgpr_read_b32 v46, a106
 v_accvgpr_read_b32 v47, a107
 v_pk_mul_f32 v[40:41], v[32:33], v[32:33]
 v_pk_mul_f32 v[42:43], v[34:35], v[34:35]
 v_pk_mul_f32 v[52:53], v[44:45], v[44:45]
 v_pk_mul_f32 v[54:55], v[46:47], v[46:47]
 v_pk_fma_f32 v[40:41], v[40:41], v[30:31], v[28:29]
 v_pk_fma_f32 v[42:43], v[42:43], v[30:31], v[28:29]
 v_pk_fma_f32 v[52:53], v[52:53], v[30:31], v[28:29]
 v_pk_fma_f32 v[54:55], v[54:55], v[30:31], v[28:29]
 v_pk_mul_f32 v[40:41], v[40:41], v[32:33]
 v_pk_mul_f32 v[42:43], v[42:43], v[34:35]
 v_pk_mul_f32 v[52:53], v[52:53], v[44:45]
 v_pk_mul_f32 v[54:55], v[54:55], v[46:47]
 v_exp_f32 v40, v40
 v_exp_f32 v41, v41
 v_exp_f32 v42, v42
 v_exp_f32 v43, v43
 v_accvgpr_read_b32 v36, a200
 v_accvgpr_read_b32 v37, a201
 v_accvgpr_read_b32 v38, a202
 v_accvgpr_read_b32 v39, a203
 v_exp_f32 v52, v52
 v_exp_f32 v53, v53
 v_exp_f32 v54, v54
 v_exp_f32 v55, v55
 v_accvgpr_read_b32 v48, a216
 v_accvgpr_read_b32 v49, a217
 v_accvgpr_read_b32 v50, a218
 v_accvgpr_read_b32 v51, a219
 v_pk_add_f32 v[40:41], v[40:41], 1.0 op_sel_hi:[1,0]
 v_pk_add_f32 v[42:43], v[42:43], 1.0 op_sel_hi:[1,0]
 v_pk_add_f32 v[52:53], v[52:53], 1.0 op_sel_hi:[1,0]
 v_pk_add_f32 v[54:55], v[54:55], 1.0 op_sel_hi:[1,0]
 v_rcp_f32 v40, v40
 v_rcp_f32 v41, v41
 v_rcp_f32 v42, v42
 v_rcp_f32 v43, v43
 v_pk_mul_f32 v[36:37], v[36:37], v[32:33]
 v_pk_mul_f32 v[38:39], v[38:39], v[34:35]
 v_rcp_f32 v52, v52
 v_rcp_f32 v53, v53
 v_rcp_f32 v54, v54
 v_rcp_f32 v55, v55
 v_pk_mul_f32 v[48:49], v[48:49], v[44:45]
 v_pk_mul_f32 v[50:51], v[50:51], v[46:47]
 v_pk_mul_f32 v[36:37], v[36:37], v[40:41]
 v_pk_mul_f32 v[38:39], v[38:39], v[42:43]
 v_pk_mul_f32 v[48:49], v[48:49], v[52:53]
 v_pk_mul_f32 v[50:51], v[50:51], v[54:55]
 v_cvt_pk_bf16_f32 v64, v36, v37
 v_cvt_pk_bf16_f32 v65, v38, v39
 v_cvt_pk_bf16_f32 v66, v48, v49
 v_cvt_pk_bf16_f32 v67, v50, v51
 buffer_store_dwordx4 v[64:67], v6, s[20:23], 0 offen offset:2048 sc1
 buffer_load_dwordx4 v12, s[28:31], s55 offen offset:2048 lds
 buffer_load_dwordx4 v13, s[28:31], s55 offen offset:3072 lds
 v_accvgpr_read_b32 v32, a28
 v_accvgpr_read_b32 v33, a29
 v_accvgpr_read_b32 v34, a30
 v_accvgpr_read_b32 v35, a31
 v_accvgpr_read_b32 v44, a44
 v_accvgpr_read_b32 v45, a45
 v_accvgpr_read_b32 v46, a46
 v_accvgpr_read_b32 v47, a47
 v_pk_mul_f32 v[40:41], v[32:33], v[32:33]
 v_pk_mul_f32 v[42:43], v[34:35], v[34:35]
 v_pk_mul_f32 v[52:53], v[44:45], v[44:45]
 v_pk_mul_f32 v[54:55], v[46:47], v[46:47]
 v_pk_fma_f32 v[40:41], v[40:41], v[30:31], v[28:29]
 v_pk_fma_f32 v[42:43], v[42:43], v[30:31], v[28:29]
 v_pk_fma_f32 v[52:53], v[52:53], v[30:31], v[28:29]
 v_pk_fma_f32 v[54:55], v[54:55], v[30:31], v[28:29]
 v_pk_mul_f32 v[40:41], v[40:41], v[32:33]
 v_pk_mul_f32 v[42:43], v[42:43], v[34:35]
 v_pk_mul_f32 v[52:53], v[52:53], v[44:45]
 v_pk_mul_f32 v[54:55], v[54:55], v[46:47]
 v_exp_f32 v40, v40
 v_exp_f32 v41, v41
 v_exp_f32 v42, v42
 v_exp_f32 v43, v43
 v_accvgpr_read_b32 v36, a140
 v_accvgpr_read_b32 v37, a141
 v_accvgpr_read_b32 v38, a142
 v_accvgpr_read_b32 v39, a143
 v_exp_f32 v52, v52
 v_exp_f32 v53, v53
 v_exp_f32 v54, v54
 v_exp_f32 v55, v55
 v_accvgpr_read_b32 v48, a156
 v_accvgpr_read_b32 v49, a157
 v_accvgpr_read_b32 v50, a158
 v_accvgpr_read_b32 v51, a159
 v_pk_add_f32 v[40:41], v[40:41], 1.0 op_sel_hi:[1,0]
 v_pk_add_f32 v[42:43], v[42:43], 1.0 op_sel_hi:[1,0]
 v_pk_add_f32 v[52:53], v[52:53], 1.0 op_sel_hi:[1,0]
 v_pk_add_f32 v[54:55], v[54:55], 1.0 op_sel_hi:[1,0]
 v_rcp_f32 v40, v40
 v_rcp_f32 v41, v41
 v_rcp_f32 v42, v42
 v_rcp_f32 v43, v43
 v_pk_mul_f32 v[36:37], v[36:37], v[32:33]
 v_pk_mul_f32 v[38:39], v[38:39], v[34:35]
 v_rcp_f32 v52, v52
 v_rcp_f32 v53, v53
 v_rcp_f32 v54, v54
 v_rcp_f32 v55, v55
 v_pk_mul_f32 v[48:49], v[48:49], v[44:45]
 v_pk_mul_f32 v[50:51], v[50:51], v[46:47]
 v_pk_mul_f32 v[36:37], v[36:37], v[40:41]
 v_pk_mul_f32 v[38:39], v[38:39], v[42:43]
 v_pk_mul_f32 v[48:49], v[48:49], v[52:53]
 v_pk_mul_f32 v[50:51], v[50:51], v[54:55]
 v_cvt_pk_bf16_f32 v68, v36, v37
 v_cvt_pk_bf16_f32 v69, v38, v39
 v_cvt_pk_bf16_f32 v70, v48, v49
 v_cvt_pk_bf16_f32 v71, v50, v51
 buffer_store_dwordx4 v[68:71], v7, s[20:23], 0 offen sc1
 v_accvgpr_read_b32 v32, a60
 v_accvgpr_read_b32 v33, a61
 v_accvgpr_read_b32 v34, a62
 v_accvgpr_read_b32 v35, a63
 v_accvgpr_read_b32 v44, a76
 v_accvgpr_read_b32 v45, a77
 v_accvgpr_read_b32 v46, a78
 v_accvgpr_read_b32 v47, a79
 v_pk_mul_f32 v[40:41], v[32:33], v[32:33]
 v_pk_mul_f32 v[42:43], v[34:35], v[34:35]
 v_pk_mul_f32 v[52:53], v[44:45], v[44:45]
 v_pk_mul_f32 v[54:55], v[46:47], v[46:47]
 v_pk_fma_f32 v[40:41], v[40:41], v[30:31], v[28:29]
 v_pk_fma_f32 v[42:43], v[42:43], v[30:31], v[28:29]
 v_pk_fma_f32 v[52:53], v[52:53], v[30:31], v[28:29]
 v_pk_fma_f32 v[54:55], v[54:55], v[30:31], v[28:29]
 v_pk_mul_f32 v[40:41], v[40:41], v[32:33]
 v_pk_mul_f32 v[42:43], v[42:43], v[34:35]
 v_pk_mul_f32 v[52:53], v[52:53], v[44:45]
 v_pk_mul_f32 v[54:55], v[54:55], v[46:47]
 v_exp_f32 v40, v40
 v_exp_f32 v41, v41
 v_exp_f32 v42, v42
 v_exp_f32 v43, v43
 v_accvgpr_read_b32 v36, a172
 v_accvgpr_read_b32 v37, a173
 v_accvgpr_read_b32 v38, a174
 v_accvgpr_read_b32 v39, a175
 v_exp_f32 v52, v52
 v_exp_f32 v53, v53
 v_exp_f32 v54, v54
 v_exp_f32 v55, v55
 v_accvgpr_read_b32 v48, a188
 v_accvgpr_read_b32 v49, a189
 v_accvgpr_read_b32 v50, a190
 v_accvgpr_read_b32 v51, a191
 v_pk_add_f32 v[40:41], v[40:41], 1.0 op_sel_hi:[1,0]
 v_pk_add_f32 v[42:43], v[42:43], 1.0 op_sel_hi:[1,0]
 v_pk_add_f32 v[52:53], v[52:53], 1.0 op_sel_hi:[1,0]
 v_pk_add_f32 v[54:55], v[54:55], 1.0 op_sel_hi:[1,0]
 v_rcp_f32 v40, v40
 v_rcp_f32 v41, v41
 v_rcp_f32 v42, v42
 v_rcp_f32 v43, v43
 v_pk_mul_f32 v[36:37], v[36:37], v[32:33]
 v_pk_mul_f32 v[38:39], v[38:39], v[34:35]
 v_rcp_f32 v52, v52
 v_rcp_f32 v53, v53
 v_rcp_f32 v54, v54
 v_rcp_f32 v55, v55
 v_pk_mul_f32 v[48:49], v[48:49], v[44:45]
 v_pk_mul_f32 v[50:51], v[50:51], v[46:47]
 v_pk_mul_f32 v[36:37], v[36:37], v[40:41]
 v_pk_mul_f32 v[38:39], v[38:39], v[42:43]
 v_pk_mul_f32 v[48:49], v[48:49], v[52:53]
 v_pk_mul_f32 v[50:51], v[50:51], v[54:55]
 v_cvt_pk_bf16_f32 v72, v36, v37
 v_cvt_pk_bf16_f32 v73, v38, v39
 v_cvt_pk_bf16_f32 v74, v48, v49
 v_cvt_pk_bf16_f32 v75, v50, v51
 buffer_store_dwordx4 v[72:75], v7, s[20:23], 0 offen offset:1024 sc1
 v_accvgpr_read_b32 v32, a92
 v_accvgpr_read_b32 v33, a93
 v_accvgpr_read_b32 v34, a94
 v_accvgpr_read_b32 v35, a95
 v_accvgpr_read_b32 v44, a108
 v_accvgpr_read_b32 v45, a109
 v_accvgpr_read_b32 v46, a110
 v_accvgpr_read_b32 v47, a111
 v_pk_mul_f32 v[40:41], v[32:33], v[32:33]
 v_pk_mul_f32 v[42:43], v[34:35], v[34:35]
 v_pk_mul_f32 v[52:53], v[44:45], v[44:45]
 v_pk_mul_f32 v[54:55], v[46:47], v[46:47]
 v_pk_fma_f32 v[40:41], v[40:41], v[30:31], v[28:29]
 v_pk_fma_f32 v[42:43], v[42:43], v[30:31], v[28:29]
 v_pk_fma_f32 v[52:53], v[52:53], v[30:31], v[28:29]
 v_pk_fma_f32 v[54:55], v[54:55], v[30:31], v[28:29]
 v_pk_mul_f32 v[40:41], v[40:41], v[32:33]
 v_pk_mul_f32 v[42:43], v[42:43], v[34:35]
 v_pk_mul_f32 v[52:53], v[52:53], v[44:45]
 v_pk_mul_f32 v[54:55], v[54:55], v[46:47]
 v_exp_f32 v40, v40
 v_exp_f32 v41, v41
 v_exp_f32 v42, v42
 v_exp_f32 v43, v43
 v_accvgpr_read_b32 v36, a204
 v_accvgpr_read_b32 v37, a205
 v_accvgpr_read_b32 v38, a206
 v_accvgpr_read_b32 v39, a207
 v_exp_f32 v52, v52
 v_exp_f32 v53, v53
 v_exp_f32 v54, v54
 v_exp_f32 v55, v55
 v_accvgpr_read_b32 v48, a220
 v_accvgpr_read_b32 v49, a221
 v_accvgpr_read_b32 v50, a222
 v_accvgpr_read_b32 v51, a223
 v_pk_add_f32 v[40:41], v[40:41], 1.0 op_sel_hi:[1,0]
 v_pk_add_f32 v[42:43], v[42:43], 1.0 op_sel_hi:[1,0]
 v_pk_add_f32 v[52:53], v[52:53], 1.0 op_sel_hi:[1,0]
 v_pk_add_f32 v[54:55], v[54:55], 1.0 op_sel_hi:[1,0]
 v_rcp_f32 v40, v40
 v_rcp_f32 v41, v41
 v_rcp_f32 v42, v42
 v_rcp_f32 v43, v43
 v_pk_mul_f32 v[36:37], v[36:37], v[32:33]
 v_pk_mul_f32 v[38:39], v[38:39], v[34:35]
 v_rcp_f32 v52, v52
 v_rcp_f32 v53, v53
 v_rcp_f32 v54, v54
 v_rcp_f32 v55, v55
 v_pk_mul_f32 v[48:49], v[48:49], v[44:45]
 v_pk_mul_f32 v[50:51], v[50:51], v[46:47]
 v_pk_mul_f32 v[36:37], v[36:37], v[40:41]
 v_pk_mul_f32 v[38:39], v[38:39], v[42:43]
 v_pk_mul_f32 v[48:49], v[48:49], v[52:53]
 v_pk_mul_f32 v[50:51], v[50:51], v[54:55]
 v_cvt_pk_bf16_f32 v76, v36, v37
 v_cvt_pk_bf16_f32 v77, v38, v39
 v_cvt_pk_bf16_f32 v78, v48, v49
 v_cvt_pk_bf16_f32 v79, v50, v51
 buffer_store_dwordx4 v[76:79], v7, s[20:23], 0 offen offset:2048 sc1
 v_accvgpr_read_b32 v32, a0
 v_accvgpr_read_b32 v33, a1
 v_accvgpr_read_b32 v34, a2
 v_accvgpr_read_b32 v35, a3
 v_accvgpr_read_b32 v44, a4
 v_accvgpr_read_b32 v45, a5
 v_accvgpr_read_b32 v46, a6
 v_accvgpr_read_b32 v47, a7
 v_pk_mul_f32 v[40:41], v[32:33], v[32:33]
 v_pk_mul_f32 v[42:43], v[34:35], v[34:35]
 v_pk_mul_f32 v[52:53], v[44:45], v[44:45]
 v_pk_mul_f32 v[54:55], v[46:47], v[46:47]
 v_pk_fma_f32 v[40:41], v[40:41], v[30:31], v[28:29]
 v_pk_fma_f32 v[42:43], v[42:43], v[30:31], v[28:29]
 v_pk_fma_f32 v[52:53], v[52:53], v[30:31], v[28:29]
 v_pk_fma_f32 v[54:55], v[54:55], v[30:31], v[28:29]
 v_pk_mul_f32 v[40:41], v[40:41], v[32:33]
 v_pk_mul_f32 v[42:43], v[42:43], v[34:35]
 v_pk_mul_f32 v[52:53], v[52:53], v[44:45]
 v_pk_mul_f32 v[54:55], v[54:55], v[46:47]
 v_exp_f32 v40, v40
 v_exp_f32 v41, v41
 v_exp_f32 v42, v42
 v_exp_f32 v43, v43
 v_accvgpr_read_b32 v36, a112
 v_accvgpr_read_b32 v37, a113
 v_accvgpr_read_b32 v38, a114
 v_accvgpr_read_b32 v39, a115
 v_exp_f32 v52, v52
 v_exp_f32 v53, v53
 v_exp_f32 v54, v54
 v_exp_f32 v55, v55
 v_accvgpr_read_b32 v48, a116
 v_accvgpr_read_b32 v49, a117
 v_accvgpr_read_b32 v50, a118
 v_accvgpr_read_b32 v51, a119
 v_pk_add_f32 v[40:41], v[40:41], 1.0 op_sel_hi:[1,0]
 v_pk_add_f32 v[42:43], v[42:43], 1.0 op_sel_hi:[1,0]
 v_pk_add_f32 v[52:53], v[52:53], 1.0 op_sel_hi:[1,0]
 v_pk_add_f32 v[54:55], v[54:55], 1.0 op_sel_hi:[1,0]
 v_rcp_f32 v40, v40
 v_rcp_f32 v41, v41
 v_rcp_f32 v42, v42
 v_rcp_f32 v43, v43
 v_pk_mul_f32 v[36:37], v[36:37], v[32:33]
 v_pk_mul_f32 v[38:39], v[38:39], v[34:35]
 v_rcp_f32 v52, v52
 v_rcp_f32 v53, v53
 v_rcp_f32 v54, v54
 v_rcp_f32 v55, v55
 v_pk_mul_f32 v[48:49], v[48:49], v[44:45]
 v_pk_mul_f32 v[50:51], v[50:51], v[46:47]
 v_pk_mul_f32 v[36:37], v[36:37], v[40:41]
 v_pk_mul_f32 v[38:39], v[38:39], v[42:43]
 v_pk_mul_f32 v[48:49], v[48:49], v[52:53]
 v_pk_mul_f32 v[50:51], v[50:51], v[54:55]
 v_cvt_pk_bf16_f32 v80, v36, v37
 v_cvt_pk_bf16_f32 v81, v38, v39
 v_cvt_pk_bf16_f32 v82, v48, v49
 v_cvt_pk_bf16_f32 v83, v50, v51
 buffer_store_dwordx2 v[80:81], v132, s[20:23], 0 offen sc1
 buffer_store_dwordx2 v[82:83], v133, s[20:23], 0 offen sc1
 v_accvgpr_read_b32 v32, a8
 v_accvgpr_read_b32 v33, a9
 v_accvgpr_read_b32 v34, a10
 v_accvgpr_read_b32 v35, a11
 v_accvgpr_read_b32 v44, a12
 v_accvgpr_read_b32 v45, a13
 v_accvgpr_read_b32 v46, a14
 v_accvgpr_read_b32 v47, a15
 v_pk_mul_f32 v[40:41], v[32:33], v[32:33]
 v_pk_mul_f32 v[42:43], v[34:35], v[34:35]
 v_pk_mul_f32 v[52:53], v[44:45], v[44:45]
 v_pk_mul_f32 v[54:55], v[46:47], v[46:47]
 v_pk_fma_f32 v[40:41], v[40:41], v[30:31], v[28:29]
 v_pk_fma_f32 v[42:43], v[42:43], v[30:31], v[28:29]
 v_pk_fma_f32 v[52:53], v[52:53], v[30:31], v[28:29]
 v_pk_fma_f32 v[54:55], v[54:55], v[30:31], v[28:29]
 v_pk_mul_f32 v[40:41], v[40:41], v[32:33]
 v_pk_mul_f32 v[42:43], v[42:43], v[34:35]
 v_pk_mul_f32 v[52:53], v[52:53], v[44:45]
 v_pk_mul_f32 v[54:55], v[54:55], v[46:47]
 v_exp_f32 v40, v40
 v_exp_f32 v41, v41
 v_exp_f32 v42, v42
 v_exp_f32 v43, v43
 v_accvgpr_read_b32 v36, a120
 v_accvgpr_read_b32 v37, a121
 v_accvgpr_read_b32 v38, a122
 v_accvgpr_read_b32 v39, a123
 v_exp_f32 v52, v52
 v_exp_f32 v53, v53
 v_exp_f32 v54, v54
 v_exp_f32 v55, v55
 v_accvgpr_read_b32 v48, a124
 v_accvgpr_read_b32 v49, a125
 v_accvgpr_read_b32 v50, a126
 v_accvgpr_read_b32 v51, a127
 v_pk_add_f32 v[40:41], v[40:41], 1.0 op_sel_hi:[1,0]
 v_pk_add_f32 v[42:43], v[42:43], 1.0 op_sel_hi:[1,0]
 v_pk_add_f32 v[52:53], v[52:53], 1.0 op_sel_hi:[1,0]
 v_pk_add_f32 v[54:55], v[54:55], 1.0 op_sel_hi:[1,0]
 v_rcp_f32 v40, v40
 v_rcp_f32 v41, v41
 v_rcp_f32 v42, v42
 v_rcp_f32 v43, v43
 v_pk_mul_f32 v[36:37], v[36:37], v[32:33]
 v_pk_mul_f32 v[38:39], v[38:39], v[34:35]
 v_rcp_f32 v52, v52
 v_rcp_f32 v53, v53
 v_rcp_f32 v54, v54
 v_rcp_f32 v55, v55
 v_pk_mul_f32 v[48:49], v[48:49], v[44:45]
 v_pk_mul_f32 v[50:51], v[50:51], v[46:47]
 v_pk_mul_f32 v[36:37], v[36:37], v[40:41]
 v_pk_mul_f32 v[38:39], v[38:39], v[42:43]
 v_pk_mul_f32 v[48:49], v[48:49], v[52:53]
 v_pk_mul_f32 v[50:51], v[50:51], v[54:55]
 v_cvt_pk_bf16_f32 v84, v36, v37
 v_cvt_pk_bf16_f32 v85, v38, v39
 v_cvt_pk_bf16_f32 v86, v48, v49
 v_cvt_pk_bf16_f32 v87, v50, v51
 buffer_store_dwordx2 v[84:85], v134, s[20:23], 0 offen sc1
 buffer_store_dwordx2 v[86:87], v135, s[20:23], 0 offen sc1
B_epi_done:
 v_bfe_u32 v33, v1, 4, 1
 v_lshlrev_b32 v33, 1, v33
 v_lshrrev_b32 v34, 5, v1
 v_or_b32 v33, v33, v34
 v_and_b32 v32, 15, v1
 v_xor_b32 v33, v33, v32
 v_lshlrev_b32 v32, 8, v32
 v_xor_b32 v34, 0, v33
 v_lshl_add_u32 v14, v34, 4, v32
 v_xor_b32 v34, 4, v33
 v_lshl_add_u32 v15, v34, 4, v32
 v_xor_b32 v34, 8, v33
 v_lshl_add_u32 v16, v34, 4, v32
 v_xor_b32 v34, 12, v33
 v_lshl_add_u32 v17, v34, 4, v32
 v_mov_b32 v28, 0x3e0293ee
 v_mov_b32 v29, 0x3e0293ee
 s_waitcnt vmcnt(31)
 s_barrier
 ds_read_b128 a[192:195], v14
 ds_read_b128 a[196:199], v15
 ds_read_b128 a[200:203], v16
 ds_read_b128 a[204:207], v17
 ds_read_b128 a[208:211], v14 offset:4096
 ds_read_b128 a[212:215], v15 offset:4096
 ds_read_b128 a[216:219], v16 offset:4096
 ds_read_b128 a[220:223], v17 offset:4096
 v_accvgpr_read_b32 v32, a224
 v_accvgpr_read_b32 v33, a225
 v_accvgpr_read_b32 v34, a226
 v_accvgpr_read_b32 v35, a227
 v_pk_mul_f32 v[32:33], v[32:33], v[28:29]
 v_pk_mul_f32 v[34:35], v[34:35], v[28:29]
 v_cvt_pk_bf16_f32 v64, v32, v33
 v_cvt_pk_bf16_f32 v65, v34, v35
 v_accvgpr_read_b32 v36, a240
 v_accvgpr_read_b32 v37, a241
 v_accvgpr_read_b32 v38, a242
 v_accvgpr_read_b32 v39, a243
 v_pk_mul_f32 v[36:37], v[36:37], v[28:29]
 v_pk_mul_f32 v[38:39], v[38:39], v[28:29]
 v_cvt_pk_bf16_f32 v66, v36, v37
 v_cvt_pk_bf16_f32 v67, v38, v39
 v_accvgpr_read_b32 v32, a228
 v_accvgpr_read_b32 v33, a229
 v_accvgpr_read_b32 v34, a230
 v_accvgpr_read_b32 v35, a231
 v_pk_mul_f32 v[32:33], v[32:33], v[28:29]
 v_pk_mul_f32 v[34:35], v[34:35], v[28:29]
 v_cvt_pk_bf16_f32 v68, v32, v33
 v_cvt_pk_bf16_f32 v69, v34, v35
 v_accvgpr_read_b32 v36, a244
 v_accvgpr_read_b32 v37, a245
 v_accvgpr_read_b32 v38, a246
 v_accvgpr_read_b32 v39, a247
 v_pk_mul_f32 v[36:37], v[36:37], v[28:29]
 v_pk_mul_f32 v[38:39], v[38:39], v[28:29]
 v_cvt_pk_bf16_f32 v70, v36, v37
 v_cvt_pk_bf16_f32 v71, v38, v39
 v_accvgpr_read_b32 v32, a232
 v_accvgpr_read_b32 v33, a233
 v_accvgpr_read_b32 v34, a234
 v_accvgpr_read_b32 v35, a235
 v_pk_mul_f32 v[32:33], v[32:33], v[28:29]
 v_pk_mul_f32 v[34:35], v[34:35], v[28:29]
 v_cvt_pk_bf16_f32 v72, v32, v33
 v_cvt_pk_bf16_f32 v73, v34, v35
 v_accvgpr_read_b32 v36, a248
 v_accvgpr_read_b32 v37, a249
 v_accvgpr_read_b32 v38, a250
 v_accvgpr_read_b32 v39, a251
 v_pk_mul_f32 v[36:37], v[36:37], v[28:29]
 v_pk_mul_f32 v[38:39], v[38:39], v[28:29]
 v_cvt_pk_bf16_f32 v74, v36, v37
 v_cvt_pk_bf16_f32 v75, v38, v39
 v_accvgpr_read_b32 v32, a236
 v_accvgpr_read_b32 v33, a237
 v_accvgpr_read_b32 v34, a238
 v_accvgpr_read_b32 v35, a239
 v_pk_mul_f32 v[32:33], v[32:33], v[28:29]
 v_pk_mul_f32 v[34:35], v[34:35], v[28:29]
 v_cvt_pk_bf16_f32 v76, v32, v33
 v_cvt_pk_bf16_f32 v77, v34, v35
 v_accvgpr_read_b32 v36, a252
 v_accvgpr_read_b32 v37, a253
 v_accvgpr_read_b32 v38, a254
 v_accvgpr_read_b32 v39, a255
 v_pk_mul_f32 v[36:37], v[36:37], v[28:29]
 v_pk_mul_f32 v[38:39], v[38:39], v[28:29]
 v_cvt_pk_bf16_f32 v78, v36, v37
 v_cvt_pk_bf16_f32 v79, v38, v39
 v_permlane16_swap_b32 v64, v66
 v_permlane16_swap_b32 v65, v67
 v_permlane16_swap_b32 v68, v70
 v_permlane16_swap_b32 v69, v71
 v_permlane16_swap_b32 v72, v74
 v_permlane16_swap_b32 v73, v75
 v_permlane16_swap_b32 v76, v78
 v_permlane16_swap_b32 v77, v79
 v_pk_mul_f32 v[32:33], v[160:161], v[28:29]
 v_pk_mul_f32 v[34:35], v[162:163], v[28:29]
 v_cvt_pk_bf16_f32 v80, v32, v33
 v_cvt_pk_bf16_f32 v81, v34, v35
 v_pk_mul_f32 v[36:37], v[176:177], v[28:29]
 v_pk_mul_f32 v[38:39], v[178:179], v[28:29]
 v_cvt_pk_bf16_f32 v82, v36, v37
 v_cvt_pk_bf16_f32 v83, v38, v39
 v_pk_mul_f32 v[32:33], v[164:165], v[28:29]
 v_pk_mul_f32 v[34:35], v[166:167], v[28:29]
 v_cvt_pk_bf16_f32 v84, v32, v33
 v_cvt_pk_bf16_f32 v85, v34, v35
 v_pk_mul_f32 v[36:37], v[180:181], v[28:29]
 v_pk_mul_f32 v[38:39], v[182:183], v[28:29]
 v_cvt_pk_bf16_f32 v86, v36, v37
 v_cvt_pk_bf16_f32 v87, v38, v39
 v_pk_mul_f32 v[32:33], v[168:169], v[28:29]
 v_pk_mul_f32 v[34:35], v[170:171], v[28:29]
 v_cvt_pk_bf16_f32 v88, v32, v33
 v_cvt_pk_bf16_f32 v89, v34, v35
 v_pk_mul_f32 v[36:37], v[184:185], v[28:29]
 v_pk_mul_f32 v[38:39], v[186:187], v[28:29]
 v_cvt_pk_bf16_f32 v90, v36, v37
 v_cvt_pk_bf16_f32 v91, v38, v39
 v_pk_mul_f32 v[32:33], v[172:173], v[28:29]
 v_pk_mul_f32 v[34:35], v[174:175], v[28:29]
 v_cvt_pk_bf16_f32 v92, v32, v33
 v_cvt_pk_bf16_f32 v93, v34, v35
 v_pk_mul_f32 v[36:37], v[188:189], v[28:29]
 v_pk_mul_f32 v[38:39], v[190:191], v[28:29]
 v_cvt_pk_bf16_f32 v94, v36, v37
 v_cvt_pk_bf16_f32 v95, v38, v39
 v_permlane16_swap_b32 v80, v82
 v_permlane16_swap_b32 v81, v83
 v_permlane16_swap_b32 v84, v86
 v_permlane16_swap_b32 v85, v87
 v_permlane16_swap_b32 v88, v90
 v_permlane16_swap_b32 v89, v91
 v_permlane16_swap_b32 v92, v94
 v_permlane16_swap_b32 v93, v95
 v_pk_mul_f32 v[32:33], v[192:193], v[28:29]
 v_pk_mul_f32 v[34:35], v[194:195], v[28:29]
 v_cvt_pk_bf16_f32 v96, v32, v33
 v_cvt_pk_bf16_f32 v97, v34, v35
 v_pk_mul_f32 v[36:37], v[208:209], v[28:29]
 v_pk_mul_f32 v[38:39], v[210:211], v[28:29]
 v_cvt_pk_bf16_f32 v98, v36, v37
 v_cvt_pk_bf16_f32 v99, v38, v39
 s_waitcnt lgkmcnt(7)
 v_mfma_f32_16x16x32_bf16 v[128:131], a[192:195], v[64:67], 0
 s_waitcnt lgkmcnt(3)
 v_mfma_f32_16x16x32_bf16 v[132:135], a[208:211], v[64:67], 0
 v_pk_mul_f32 v[32:33], v[196:197], v[28:29]
 v_pk_mul_f32 v[34:35], v[198:199], v[28:29]
 v_cvt_pk_bf16_f32 v100, v32, v33
 v_cvt_pk_bf16_f32 v101, v34, v35
 v_pk_mul_f32 v[36:37], v[212:213], v[28:29]
 v_pk_mul_f32 v[38:39], v[214:215], v[28:29]
 v_cvt_pk_bf16_f32 v102, v36, v37
 v_cvt_pk_bf16_f32 v103, v38, v39
 v_permlane16_swap_b32 v96, v98
 v_permlane16_swap_b32 v97, v99
 v_mfma_f32_16x16x32_bf16 v[128:131], a[196:199], v[80:83], v[128:131]
 s_waitcnt lgkmcnt(2)
 v_mfma_f32_16x16x32_bf16 v[132:135], a[212:215], v[80:83], v[132:135]
 v_pk_mul_f32 v[32:33], v[200:201], v[28:29]
 v_pk_mul_f32 v[34:35], v[202:203], v[28:29]
 v_cvt_pk_bf16_f32 v104, v32, v33
 v_cvt_pk_bf16_f32 v105, v34, v35
 v_pk_mul_f32 v[36:37], v[216:217], v[28:29]
 v_pk_mul_f32 v[38:39], v[218:219], v[28:29]
 v_cvt_pk_bf16_f32 v106, v36, v37
 v_cvt_pk_bf16_f32 v107, v38, v39
 v_permlane16_swap_b32 v100, v102
 v_permlane16_swap_b32 v101, v103
 v_mfma_f32_16x16x32_bf16 v[136:139], a[196:199], v[84:87], 0
 v_mfma_f32_16x16x32_bf16 v[140:143], a[212:215], v[84:87], 0
 v_pk_mul_f32 v[32:33], v[204:205], v[28:29]
 v_pk_mul_f32 v[34:35], v[206:207], v[28:29]
 v_cvt_pk_bf16_f32 v108, v32, v33
 v_cvt_pk_bf16_f32 v109, v34, v35
 v_pk_mul_f32 v[36:37], v[220:221], v[28:29]
 v_pk_mul_f32 v[38:39], v[222:223], v[28:29]
 v_cvt_pk_bf16_f32 v110, v36, v37
 v_cvt_pk_bf16_f32 v111, v38, v39
 v_permlane16_swap_b32 v104, v106
 v_permlane16_swap_b32 v105, v107
 v_mfma_f32_16x16x32_bf16 v[136:139], a[192:195], v[68:71], v[136:139]
 v_mfma_f32_16x16x32_bf16 v[140:143], a[208:211], v[68:71], v[140:143]
 v_pk_mul_f32 v[32:33], v[224:225], v[28:29]
 v_pk_mul_f32 v[34:35], v[226:227], v[28:29]
 v_cvt_pk_bf16_f32 v112, v32, v33
 v_cvt_pk_bf16_f32 v113, v34, v35
 v_pk_mul_f32 v[36:37], v[240:241], v[28:29]
 v_pk_mul_f32 v[38:39], v[242:243], v[28:29]
 v_cvt_pk_bf16_f32 v114, v36, v37
 v_cvt_pk_bf16_f32 v115, v38, v39
 v_permlane16_swap_b32 v108, v110
 v_permlane16_swap_b32 v109, v111
 v_mfma_f32_16x16x32_bf16 v[144:147], a[192:195], v[72:75], 0
 v_mfma_f32_16x16x32_bf16 v[148:151], a[208:211], v[72:75], 0
 v_pk_mul_f32 v[32:33], v[228:229], v[28:29]
 v_pk_mul_f32 v[34:35], v[230:231], v[28:29]
 v_cvt_pk_bf16_f32 v116, v32, v33
 v_cvt_pk_bf16_f32 v117, v34, v35
 v_pk_mul_f32 v[36:37], v[244:245], v[28:29]
 v_pk_mul_f32 v[38:39], v[246:247], v[28:29]
 v_cvt_pk_bf16_f32 v118, v36, v37
 v_cvt_pk_bf16_f32 v119, v38, v39
 v_permlane16_swap_b32 v112, v114
 v_permlane16_swap_b32 v113, v115
 v_mfma_f32_16x16x32_bf16 v[144:147], a[196:199], v[88:91], v[144:147]
 v_mfma_f32_16x16x32_bf16 v[148:151], a[212:215], v[88:91], v[148:151]
 v_pk_mul_f32 v[32:33], v[232:233], v[28:29]
 v_pk_mul_f32 v[34:35], v[234:235], v[28:29]
 v_cvt_pk_bf16_f32 v120, v32, v33
 v_cvt_pk_bf16_f32 v121, v34, v35
 v_pk_mul_f32 v[36:37], v[248:249], v[28:29]
 v_pk_mul_f32 v[38:39], v[250:251], v[28:29]
 v_cvt_pk_bf16_f32 v122, v36, v37
 v_cvt_pk_bf16_f32 v123, v38, v39
 v_permlane16_swap_b32 v116, v118
 v_permlane16_swap_b32 v117, v119
 v_mfma_f32_16x16x32_bf16 v[152:155], a[196:199], v[92:95], 0
 v_mfma_f32_16x16x32_bf16 v[156:159], a[212:215], v[92:95], 0
 v_pk_mul_f32 v[32:33], v[236:237], v[28:29]
 v_pk_mul_f32 v[34:35], v[238:239], v[28:29]
 v_cvt_pk_bf16_f32 v124, v32, v33
 v_cvt_pk_bf16_f32 v125, v34, v35
 v_pk_mul_f32 v[36:37], v[252:253], v[28:29]
 v_pk_mul_f32 v[38:39], v[254:255], v[28:29]
 v_cvt_pk_bf16_f32 v126, v36, v37
 v_cvt_pk_bf16_f32 v127, v38, v39
 v_permlane16_swap_b32 v120, v122
 v_permlane16_swap_b32 v121, v123
 v_mfma_f32_16x16x32_bf16 v[152:155], a[192:195], v[76:79], v[152:155]
 v_mfma_f32_16x16x32_bf16 v[156:159], a[208:211], v[76:79], v[156:159]
 ds_read_b128 a[192:195], v14 offset:8192
 ds_read_b128 a[196:199], v15 offset:8192
 ds_read_b128 a[208:211], v14 offset:12288
 ds_read_b128 a[212:215], v15 offset:12288
 v_permlane16_swap_b32 v124, v126
 v_permlane16_swap_b32 v125, v127
 v_lshrrev_b32 v36, 2, v1
 v_and_b32 v37, 7, v36
 v_lshlrev_b32 v36, 8, v36
 v_and_b32 v38, 3, v1
 v_lshl_add_u32 v36, v38, 3, v36
 v_add_u32 v36, 0x10000, v36
 v_mfma_f32_16x16x32_bf16 v[152:155], a[200:203], v[108:111], v[152:155]
 s_waitcnt lgkmcnt(5)
 v_mfma_f32_16x16x32_bf16 v[156:159], a[216:219], v[108:111], v[156:159]
 v_xor_b32 v38, 0, v37
 v_lshl_add_u32 v18, v38, 5, v36
 v_mfma_f32_16x16x32_bf16 v[152:155], a[204:207], v[124:127], v[152:155]
 s_waitcnt lgkmcnt(4)
 v_mfma_f32_16x16x32_bf16 v[156:159], a[220:223], v[124:127], v[156:159]
 v_xor_b32 v38, 1, v37
 v_lshl_add_u32 v19, v38, 5, v36
 v_mfma_f32_16x16x32_bf16 v[144:147], a[204:207], v[120:123], v[144:147]
 v_mfma_f32_16x16x32_bf16 v[148:151], a[220:223], v[120:123], v[148:151]
 v_xor_b32 v38, 2, v37
 v_lshl_add_u32 v20, v38, 5, v36
 v_mfma_f32_16x16x32_bf16 v[144:147], a[200:203], v[104:107], v[144:147]
 v_mfma_f32_16x16x32_bf16 v[148:151], a[216:219], v[104:107], v[148:151]
 v_xor_b32 v38, 3, v37
 v_lshl_add_u32 v21, v38, 5, v36
 v_mfma_f32_16x16x32_bf16 v[136:139], a[200:203], v[100:103], v[136:139]
 v_mfma_f32_16x16x32_bf16 v[140:143], a[216:219], v[100:103], v[140:143]
 v_xor_b32 v38, 4, v37
 v_lshl_add_u32 v22, v38, 5, v36
 v_mfma_f32_16x16x32_bf16 v[136:139], a[204:207], v[116:119], v[136:139]
 v_mfma_f32_16x16x32_bf16 v[140:143], a[220:223], v[116:119], v[140:143]
 v_xor_b32 v38, 5, v37
 v_lshl_add_u32 v23, v38, 5, v36
 v_mfma_f32_16x16x32_bf16 v[128:131], a[204:207], v[112:115], v[128:131]
 v_mfma_f32_16x16x32_bf16 v[132:135], a[220:223], v[112:115], v[132:135]
 v_xor_b32 v38, 6, v37
 v_lshl_add_u32 v24, v38, 5, v36
 v_mfma_f32_16x16x32_bf16 v[128:131], a[200:203], v[96:99], v[128:131]
 v_mfma_f32_16x16x32_bf16 v[132:135], a[216:219], v[96:99], v[132:135]
 ds_read_b128 a[200:203], v16 offset:8192
 ds_read_b128 a[204:207], v17 offset:8192
 ds_read_b128 a[216:219], v16 offset:12288
 ds_read_b128 a[220:223], v17 offset:12288
 v_xor_b32 v38, 7, v37
 v_lshl_add_u32 v25, v38, 5, v36
 v_mov_b32 v28, 0
 v_mov_b32 v240, 0
 v_mov_b32 v29, 0
 v_mov_b32 v241, 0
 v_mov_b32 v30, 0
 v_mov_b32 v242, 0
 v_mov_b32 v31, 0
 v_mov_b32 v243, 0
 v_max3_f32 v32, v128, v129, v130
 v_max3_f32 v32, v32, v131, v132
 v_max3_f32 v32, v32, v133, v134
 v_max_f32 v32, v32, v135
 v_max3_f32 v33, v136, v137, v138
 v_max3_f32 v33, v33, v139, v140
 v_max3_f32 v33, v33, v141, v142
 v_max_f32 v33, v33, v143
 v_max3_f32 v34, v144, v145, v146
 v_max3_f32 v34, v34, v147, v148
 v_max3_f32 v34, v34, v149, v150
 v_max_f32 v34, v34, v151
 v_max3_f32 v35, v152, v153, v154
 v_max3_f32 v35, v35, v155, v156
 v_max3_f32 v35, v35, v157, v158
 v_max_f32 v35, v35, v159
 v_mov_b32 v36, v32
 v_mov_b32 v37, v33
 v_mov_b32 v38, v34
 v_mov_b32 v39, v35
 s_nop 0
 v_permlane16_swap_b32 v32, v36
 v_permlane16_swap_b32 v33, v37
 v_permlane16_swap_b32 v34, v38
 v_permlane16_swap_b32 v35, v39
 s_nop 0
 v_max_f32 v32, v32, v36
 v_max_f32 v33, v33, v37
 v_max_f32 v34, v34, v38
 v_max_f32 v35, v35, v39
 v_mov_b32 v36, v32
 v_mov_b32 v37, v33
 v_mov_b32 v38, v34
 v_mov_b32 v39, v35
 s_nop 0
 v_permlane32_swap_b32 v32, v36
 v_permlane32_swap_b32 v33, v37
 v_permlane32_swap_b32 v34, v38
 v_permlane32_swap_b32 v35, v39
 s_nop 0
 v_max_f32 v32, v32, v36
 v_max_f32 v33, v33, v37
 v_max_f32 v34, v34, v38
 v_max_f32 v35, v35, v39
 v_sub_f32 v224, 0, v32
 v_sub_f32 v225, 0, v32
 v_pk_mul_f32 v[226:227], v[224:225], 1.0 op_sel_hi:[1,0]
 v_sub_f32 v228, 0, v33
 v_sub_f32 v229, 0, v33
 v_pk_mul_f32 v[230:231], v[228:229], 1.0 op_sel_hi:[1,0]
 v_sub_f32 v232, 0, v34
 v_sub_f32 v233, 0, v34
 v_pk_mul_f32 v[234:235], v[232:233], 1.0 op_sel_hi:[1,0]
 v_sub_f32 v236, 0, v35
 v_sub_f32 v237, 0, v35
 v_pk_mul_f32 v[238:239], v[236:237], 1.0 op_sel_hi:[1,0]
 v_pk_add_f32 v[128:129], v[128:129], v[224:225]
 v_pk_add_f32 v[130:131], v[130:131], v[224:225]
 v_pk_add_f32 v[132:133], v[132:133], v[224:225]
 v_pk_add_f32 v[134:135], v[134:135], v[224:225]
 v_pk_add_f32 v[136:137], v[136:137], v[228:229]
 v_pk_add_f32 v[138:139], v[138:139], v[228:229]
 v_pk_add_f32 v[140:141], v[140:141], v[228:229]
 v_pk_add_f32 v[142:143], v[142:143], v[228:229]
 v_pk_add_f32 v[144:145], v[144:145], v[232:233]
 v_pk_add_f32 v[146:147], v[146:147], v[232:233]
 v_pk_add_f32 v[148:149], v[148:149], v[232:233]
 v_pk_add_f32 v[150:151], v[150:151], v[232:233]
 v_pk_add_f32 v[152:153], v[152:153], v[236:237]
 v_pk_add_f32 v[154:155], v[154:155], v[236:237]
 v_pk_add_f32 v[156:157], v[156:157], v[236:237]
 v_pk_add_f32 v[158:159], v[158:159], v[236:237]
 s_waitcnt lgkmcnt(7)
 v_mfma_f32_16x16x32_bf16 v[160:163], a[192:195], v[64:67], v[224:227]
 s_waitcnt lgkmcnt(6)
 v_exp_f32 v128, v128
 v_mfma_f32_16x16x32_bf16 v[160:163], a[196:199], v[80:83], v[160:163]
 v_exp_f32 v129, v129
 v_mfma_f32_16x16x32_bf16 v[168:171], a[196:199], v[84:87], v[228:231]
 v_add_f32 v28, v28, v128
 v_exp_f32 v130, v130
 v_mfma_f32_16x16x32_bf16 v[168:171], a[192:195], v[68:71], v[168:171]
 v_cvt_pk_bf16_f32 v192, v128, v129
 v_add_f32 v28, v28, v129
 v_exp_f32 v131, v131
 v_mfma_f32_16x16x32_bf16 v[176:179], a[192:195], v[72:75], v[232:235]
 v_add_f32 v28, v28, v130
 v_exp_f32 v132, v132
 v_mfma_f32_16x16x32_bf16 v[176:179], a[196:199], v[88:91], v[176:179]
 v_cvt_pk_bf16_f32 v193, v130, v131
 v_add_f32 v28, v28, v131
 v_exp_f32 v133, v133
 v_mfma_f32_16x16x32_bf16 v[184:187], a[196:199], v[92:95], v[236:239]
 v_add_f32 v28, v28, v132
 v_exp_f32 v134, v134
 v_mfma_f32_16x16x32_bf16 v[184:187], a[192:195], v[76:79], v[184:187]
 s_waitcnt lgkmcnt(2)
 v_cvt_pk_bf16_f32 v194, v132, v133
 v_add_f32 v28, v28, v133
 v_exp_f32 v135, v135
 v_mfma_f32_16x16x32_bf16 v[184:187], a[200:203], v[108:111], v[184:187]
 v_add_f32 v28, v28, v134
 v_exp_f32 v136, v136
 v_mfma_f32_16x16x32_bf16 v[184:187], a[204:207], v[124:127], v[184:187]
 v_cvt_pk_bf16_f32 v195, v134, v135
 v_add_f32 v28, v28, v135
 v_exp_f32 v137, v137
 v_mfma_f32_16x16x32_bf16 v[176:179], a[204:207], v[120:123], v[176:179]
 v_add_f32 v29, v29, v136
 v_exp_f32 v138, v138
 v_mfma_f32_16x16x32_bf16 v[176:179], a[200:203], v[104:107], v[176:179]
 v_cvt_pk_bf16_f32 v196, v136, v137
 v_add_f32 v29, v29, v137
 v_exp_f32 v139, v139
 v_mfma_f32_16x16x32_bf16 v[168:171], a[200:203], v[100:103], v[168:171]
 v_add_f32 v29, v29, v138
 v_exp_f32 v140, v140
 v_mfma_f32_16x16x32_bf16 v[168:171], a[204:207], v[116:119], v[168:171]
 v_cvt_pk_bf16_f32 v197, v138, v139
 v_add_f32 v29, v29, v139
 v_exp_f32 v141, v141
 v_mfma_f32_16x16x32_bf16 v[160:163], a[204:207], v[112:115], v[160:163]
 v_add_f32 v29, v29, v140
 v_exp_f32 v142, v142
 v_mfma_f32_16x16x32_bf16 v[160:163], a[200:203], v[96:99], v[160:163]
 s_waitcnt vmcnt(25)
 s_waitcnt vmcnt(19)
 s_barrier
 v_cvt_pk_bf16_f32 v198, v140, v141
 v_add_f32 v29, v29, v141
 v_exp_f32 v143, v143
 v_mfma_f32_16x16x32_bf16 v[164:167], a[208:211], v[64:67], v[224:227]
 ds_read_b128 a[192:195], v14 offset:16384
 s_add_u32 s54, s39, 49152
 v_add_f32 v29, v29, v142
 v_exp_f32 v144, v144
 v_mfma_f32_16x16x32_bf16 v[164:167], a[212:215], v[80:83], v[164:167]
 s_add_u32 m0, s40, 49152
 v_cvt_pk_bf16_f32 v199, v142, v143
 v_add_f32 v29, v29, v143
 v_exp_f32 v145, v145
 v_mfma_f32_16x16x32_bf16 v[172:175], a[212:215], v[84:87], v[228:231]
 buffer_load_dwordx4 v8, s[24:27], s54 offen lds
 v_add_f32 v30, v30, v144
 v_exp_f32 v146, v146
 v_mfma_f32_16x16x32_bf16 v[172:175], a[208:211], v[68:71], v[172:175]
 v_cvt_pk_bf16_f32 v200, v144, v145
 v_add_f32 v30, v30, v145
 v_exp_f32 v147, v147
 v_mfma_f32_16x16x32_bf16 v[180:183], a[208:211], v[72:75], v[232:235]
 ds_read_b128 a[196:199], v15 offset:16384
 v_add_f32 v30, v30, v146
 v_exp_f32 v148, v148
 v_mfma_f32_16x16x32_bf16 v[180:183], a[212:215], v[88:91], v[180:183]
 v_cvt_pk_bf16_f32 v201, v146, v147
 v_add_f32 v30, v30, v147
 v_exp_f32 v149, v149
 v_mfma_f32_16x16x32_bf16 v[188:191], a[212:215], v[92:95], v[236:239]
 buffer_load_dwordx4 v9, s[24:27], s54 offen offset:1024 lds
 v_add_f32 v30, v30, v148
 v_exp_f32 v150, v150
 v_mfma_f32_16x16x32_bf16 v[188:191], a[208:211], v[76:79], v[188:191]
 s_waitcnt lgkmcnt(2)
 v_cvt_pk_bf16_f32 v202, v148, v149
 v_add_f32 v30, v30, v149
 v_exp_f32 v151, v151
 v_mfma_f32_16x16x32_bf16 v[188:191], a[216:219], v[108:111], v[188:191]
 ds_read_b128 a[200:203], v16 offset:16384
 v_add_f32 v30, v30, v150
 v_exp_f32 v152, v152
 v_mfma_f32_16x16x32_bf16 v[188:191], a[220:223], v[124:127], v[188:191]
 v_cvt_pk_bf16_f32 v203, v150, v151
 v_add_f32 v30, v30, v151
 v_exp_f32 v153, v153
 v_mfma_f32_16x16x32_bf16 v[180:183], a[220:223], v[120:123], v[180:183]
 v_add_f32 v31, v31, v152
 v_exp_f32 v154, v154
 v_mfma_f32_16x16x32_bf16 v[180:183], a[216:219], v[104:107], v[180:183]
 v_cvt_pk_bf16_f32 v204, v152, v153
 v_add_f32 v31, v31, v153
 v_exp_f32 v155, v155
 v_mfma_f32_16x16x32_bf16 v[172:175], a[216:219], v[100:103], v[172:175]
 ds_read_b128 a[204:207], v17 offset:16384
 buffer_load_dwordx4 v10, s[24:27], s54 offen offset:2048 lds
 v_add_f32 v31, v31, v154
 v_exp_f32 v156, v156
 v_mfma_f32_16x16x32_bf16 v[172:175], a[220:223], v[116:119], v[172:175]
 v_cvt_pk_bf16_f32 v205, v154, v155
 v_add_f32 v31, v31, v155
 v_exp_f32 v157, v157
 v_mfma_f32_16x16x32_bf16 v[164:167], a[220:223], v[112:115], v[164:167]
 v_add_f32 v31, v31, v156
 v_exp_f32 v158, v158
 v_mfma_f32_16x16x32_bf16 v[164:167], a[216:219], v[96:99], v[164:167]
 s_waitcnt lgkmcnt(2)
 v_cvt_pk_bf16_f32 v206, v156, v157
 v_add_f32 v31, v31, v157
 v_exp_f32 v159, v159
 v_mfma_f32_16x16x32_bf16 v[128:131], a[192:195], v[64:67], v[224:227]
 ds_read_b128 a[208:211], v14 offset:20480
 s_lshl_b32 s50, s2, 2
 v_add_f32 v31, v31, v158
 v_mfma_f32_16x16x32_bf16 v[128:131], a[196:199], v[80:83], v[128:131]
 s_add_u32 s50, s50, s36
 s_lshl_b32 s51, s50, 13
 v_cvt_pk_bf16_f32 v207, v158, v159
 v_add_f32 v31, v31, v159
 v_exp_f32 v160, v160
 v_mfma_f32_16x16x32_bf16 v[136:139], a[196:199], v[84:87], v[228:231]
 s_mul_i32 s50, s50, 7168
 v_lshlrev_b32 v33, 4, v1
 v_add_u32 v34, s50, v33
 v_mfma_f32_16x16x32_bf16 v[136:139], a[192:195], v[68:71], v[136:139]
 v_exp_f32 v161, v161
 v_mfma_f32_16x16x32_bf16 v[144:147], a[192:195], v[72:75], v[232:235]
 ds_read_b128 a[212:215], v15 offset:20480
 v_add_f32 v28, v28, v160
 v_add_u32 v33, s51, v33
 v_mfma_f32_16x16x32_bf16 v[144:147], a[196:199], v[88:91], v[144:147]
 s_mov_b32 s8, s72
 s_mov_b32 s9, s73
 v_exp_f32 v162, v162
 v_mfma_f32_16x16x32_bf16 v[152:155], a[196:199], v[92:95], v[236:239]
 s_mov_b32 s10, 0x800000
 s_mov_b32 s11, 0x20000
 v_add_f32 v28, v28, v161
 v_cvt_pk_bf16_f32 v208, v160, v161
 v_mfma_f32_16x16x32_bf16 v[152:155], a[192:195], v[76:79], v[152:155]
 s_waitcnt lgkmcnt(2)
 s_mov_b32 s12, s80
 v_exp_f32 v163, v163
 v_mfma_f32_16x16x32_bf16 v[152:155], a[200:203], v[108:111], v[152:155]
 ds_read_b128 a[216:219], v16 offset:20480
 s_mov_b32 s13, s81
 v_add_f32 v28, v28, v162
 v_mfma_f32_16x16x32_bf16 v[152:155], a[204:207], v[124:127], v[152:155]
 s_mov_b32 s14, 0x700000
 s_mov_b32 s15, 0x20000
 v_exp_f32 v164, v164
 v_mfma_f32_16x16x32_bf16 v[144:147], a[204:207], v[120:123], v[144:147]
 s_lshl_b32 s55, s40, 1
 s_add_u32 s55, s55, 0x20000
 v_add_f32 v28, v28, v163
 v_cvt_pk_bf16_f32 v209, v162, v163
 v_mfma_f32_16x16x32_bf16 v[144:147], a[200:203], v[104:107], v[144:147]
 s_mov_b32 s44, 0
 s_lshl_b32 s50, s37, 12
 v_exp_f32 v165, v165
 v_mfma_f32_16x16x32_bf16 v[136:139], a[200:203], v[100:103], v[136:139]
 ds_read_b128 a[220:223], v17 offset:20480
 s_lshl_b32 s51, s38, 7
 v_add_f32 v28, v28, v164
 v_mfma_f32_16x16x32_bf16 v[136:139], a[204:207], v[116:119], v[136:139]
 s_add_u32 s50, s50, s51
 s_add_u32 s50, s50, 32768
 v_exp_f32 v166, v166
 v_mfma_f32_16x16x32_bf16 v[128:131], a[204:207], v[112:115], v[128:131]
 v_add_f32 v28, v28, v165
 v_cvt_pk_bf16_f32 v210, v164, v165
 v_mfma_f32_16x16x32_bf16 v[128:131], a[200:203], v[96:99], v[128:131]
 s_waitcnt lgkmcnt(2)
 v_exp_f32 v167, v167
 v_mfma_f32_16x16x32_bf16 v[132:135], a[208:211], v[64:67], v[224:227]
 ds_read_b64_tr_b16 a[224:225], v18
 v_add_f32 v28, v28, v166
 v_mov_b32 v27, s50
 v_mfma_f32_16x16x32_bf16 v[132:135], a[212:215], v[80:83], v[132:135]
 ds_read_b64_tr_b16 a[226:227], v18 offset:4096
 buffer_load_dwordx4 v11, s[24:27], s54 offen offset:3072 lds
 v_exp_f32 v168, v168
 v_mfma_f32_16x16x32_bf16 v[140:143], a[212:215], v[84:87], v[228:231]
 s_add_u32 s54, s39, 32768
 s_add_u32 m0, s40, 98304
 v_add_f32 v28, v28, v167
 v_cvt_pk_bf16_f32 v211, v166, v167
 v_mfma_f32_16x16x32_bf16 v[140:143], a[208:211], v[68:71], v[140:143]
 v_exp_f32 v169, v169
 s_nop 0
 buffer_load_dwordx4 v12, s[28:31], s54 offen lds
 v_mfma_f32_16x16x32_bf16 v[148:151], a[208:211], v[72:75], v[232:235]
 ds_read_b64_tr_b16 a[228:229], v19
 buffer_load_dwordx4 v13, s[28:31], s54 offen offset:1024 lds
 v_add_f32 v29, v29, v168
 v_mfma_f32_16x16x32_bf16 v[148:151], a[212:215], v[88:91], v[148:151]
 ds_read_b64_tr_b16 a[230:231], v19 offset:4096
 buffer_load_dwordx4 v12, s[28:31], s54 offen offset:2048 lds
 v_exp_f32 v170, v170
 v_mfma_f32_16x16x32_bf16 v[156:159], a[212:215], v[92:95], v[236:239]
 v_add_f32 v29, v29, v169
 v_cvt_pk_bf16_f32 v212, v168, v169
 v_mfma_f32_16x16x32_bf16 v[156:159], a[208:211], v[76:79], v[156:159]
 s_waitcnt lgkmcnt(4)
 v_exp_f32 v171, v171
 v_mfma_f32_16x16x32_bf16 v[156:159], a[216:219], v[108:111], v[156:159]
 ds_read_b64_tr_b16 a[232:233], v20
 v_add_f32 v29, v29, v170
 v_mfma_f32_16x16x32_bf16 v[156:159], a[220:223], v[124:127], v[156:159]
 ds_read_b64_tr_b16 a[234:235], v20 offset:4096
 v_exp_f32 v172, v172
 v_mfma_f32_16x16x32_bf16 v[148:151], a[220:223], v[120:123], v[148:151]
 buffer_load_dwordx4 v13, s[28:31], s54 offen offset:3072 lds
 v_add_f32 v29, v29, v171
 v_cvt_pk_bf16_f32 v213, v170, v171
 v_mfma_f32_16x16x32_bf16 v[148:151], a[216:219], v[104:107], v[148:151]
 v_exp_f32 v173, v173
 v_mfma_f32_16x16x32_bf16 v[140:143], a[216:219], v[100:103], v[140:143]
 ds_read_b64_tr_b16 a[236:237], v21
 v_add_f32 v29, v29, v172
 v_mfma_f32_16x16x32_bf16 v[140:143], a[220:223], v[116:119], v[140:143]
 ds_read_b64_tr_b16 a[238:239], v21 offset:4096
 v_exp_f32 v174, v174
 v_mfma_f32_16x16x32_bf16 v[132:135], a[220:223], v[112:115], v[132:135]
 v_add_f32 v29, v29, v173
 v_cvt_pk_bf16_f32 v214, v172, v173
 v_mfma_f32_16x16x32_bf16 v[132:135], a[216:219], v[96:99], v[132:135]
 s_waitcnt lgkmcnt(6)
 v_exp_f32 v175, v175
 v_mfma_f32_16x16x32_bf16 a[0:3], a[224:227], v[192:195], 0
 ds_read_b64_tr_b16 a[240:241], v22
 s_mov_b32 m0, s55
 v_add_f32 v29, v29, v174
 v_mfma_f32_16x16x32_bf16 a[4:7], a[224:227], v[196:199], 0
 ds_read_b64_tr_b16 a[242:243], v22 offset:4096
 v_exp_f32 v176, v176
 v_mfma_f32_16x16x32_bf16 a[8:11], a[224:227], v[200:203], 0
 buffer_load_dwordx4 v33, s[8:11], s44 offen lds
 v_add_f32 v29, v29, v175
 v_cvt_pk_bf16_f32 v215, v174, v175
 v_mfma_f32_16x16x32_bf16 a[12:15], a[224:227], v[204:207], 0
 s_waitcnt lgkmcnt(6)
 v_exp_f32 v177, v177
 v_mfma_f32_16x16x32_bf16 a[28:31], a[228:231], v[204:207], 0
 ds_read_b64_tr_b16 a[244:245], v23
 v_add_f32 v30, v30, v176
 v_mfma_f32_16x16x32_bf16 a[24:27], a[228:231], v[200:203], 0
 ds_read_b64_tr_b16 a[246:247], v23 offset:4096
 v_exp_f32 v178, v178
 v_mfma_f32_16x16x32_bf16 a[20:23], a[228:231], v[196:199], 0
 v_add_f32 v30, v30, v177
 v_cvt_pk_bf16_f32 v216, v176, v177
 v_mfma_f32_16x16x32_bf16 a[16:19], a[228:231], v[192:195], 0
 s_waitcnt lgkmcnt(6)
 v_exp_f32 v179, v179
 v_mfma_f32_16x16x32_bf16 a[32:35], a[232:235], v[192:195], 0
 ds_read_b64_tr_b16 a[248:249], v24
 buffer_load_dwordx4 v34, s[12:15], s44 offen lds
 v_add_f32 v30, v30, v178
 v_mfma_f32_16x16x32_bf16 a[36:39], a[232:235], v[196:199], 0
 ds_read_b64_tr_b16 a[250:251], v24 offset:4096
 s_add_u32 s44, s44, 1024
 v_exp_f32 v180, v180
 v_mfma_f32_16x16x32_bf16 a[40:43], a[232:235], v[200:203], 0
 v_add_f32 v30, v30, v179
 v_cvt_pk_bf16_f32 v217, v178, v179
 v_mfma_f32_16x16x32_bf16 a[44:47], a[232:235], v[204:207], 0
 s_waitcnt lgkmcnt(6)
 v_exp_f32 v181, v181
 v_mfma_f32_16x16x32_bf16 a[60:63], a[236:239], v[204:207], 0
 ds_read_b64_tr_b16 a[252:253], v25
 v_add_f32 v30, v30, v180
 v_mfma_f32_16x16x32_bf16 a[56:59], a[236:239], v[200:203], 0
 ds_read_b64_tr_b16 a[254:255], v25 offset:4096
 v_exp_f32 v182, v182
 v_mfma_f32_16x16x32_bf16 a[52:55], a[236:239], v[196:199], 0
 v_add_f32 v30, v30, v181
 v_cvt_pk_bf16_f32 v218, v180, v181
 v_mfma_f32_16x16x32_bf16 a[48:51], a[236:239], v[192:195], 0
 s_waitcnt lgkmcnt(6)
 v_exp_f32 v183, v183
 v_mfma_f32_16x16x32_bf16 a[64:67], a[240:243], v[192:195], 0
 ds_read_b128 a[192:195], v14 offset:24576
 buffer_load_dwordx4 v33, s[8:11], s44 offen lds
 v_add_f32 v30, v30, v182
 v_mfma_f32_16x16x32_bf16 a[68:71], a[240:243], v[196:199], 0
 v_exp_f32 v184, v184
 v_mfma_f32_16x16x32_bf16 a[72:75], a[240:243], v[200:203], 0
 v_add_f32 v30, v30, v183
 v_cvt_pk_bf16_f32 v219, v182, v183
 v_mfma_f32_16x16x32_bf16 a[76:79], a[240:243], v[204:207], 0
 s_waitcnt lgkmcnt(5)
 v_exp_f32 v185, v185
 v_mfma_f32_16x16x32_bf16 a[92:95], a[244:247], v[204:207], 0
 ds_read_b128 a[196:199], v15 offset:24576
 v_add_f32 v31, v31, v184
 v_mfma_f32_16x16x32_bf16 a[88:91], a[244:247], v[200:203], 0
 v_exp_f32 v186, v186
 v_mfma_f32_16x16x32_bf16 a[84:87], a[244:247], v[196:199], 0
 buffer_load_dword v61, v0, s[60:63], 0 offen
 v_add_f32 v31, v31, v185
 v_cvt_pk_bf16_f32 v220, v184, v185
 v_mfma_f32_16x16x32_bf16 a[80:83], a[244:247], v[192:195], 0
 s_waitcnt lgkmcnt(4)
 v_exp_f32 v187, v187
 v_mfma_f32_16x16x32_bf16 a[96:99], a[248:251], v[192:195], 0
 ds_read_b128 a[200:203], v16 offset:24576
 s_lshr_b32 s50, s6, 5
 v_add_f32 v31, v31, v186
 v_mfma_f32_16x16x32_bf16 a[100:103], a[248:251], v[196:199], 0
 s_xor_b32 s50, s50, s2
 s_and_b32 s50, s50, 1
 v_exp_f32 v188, v188
 v_mfma_f32_16x16x32_bf16 a[104:107], a[248:251], v[200:203], 0
 s_and_b32 s70, s2, 2
 s_or_b32 s70, s70, s50
 v_add_f32 v31, v31, v187
 v_cvt_pk_bf16_f32 v221, v186, v187
 v_mfma_f32_16x16x32_bf16 a[108:111], a[248:251], v[204:207], 0
 s_and_b32 s71, s2, 4
 s_waitcnt lgkmcnt(3)
 v_exp_f32 v189, v189
 v_mfma_f32_16x16x32_bf16 a[124:127], a[252:255], v[204:207], 0
 ds_read_b128 a[204:207], v17 offset:24576
 s_bfe_u32 s51, s2, 0x20003
 v_add_f32 v31, v31, v188
 v_mfma_f32_16x16x32_bf16 a[120:123], a[252:255], v[200:203], 0
 s_add_u32 s71, s71, s51
 s_lshr_b32 s76, s2, 5
 v_exp_f32 v190, v190
 v_mfma_f32_16x16x32_bf16 a[116:119], a[252:255], v[196:199], 0
 s_xor_b32 s76, s76, 0
 s_lshl_b32 s50, s71, 5
 v_add_f32 v31, v31, v189
 v_cvt_pk_bf16_f32 v222, v188, v189
 v_mfma_f32_16x16x32_bf16 a[112:115], a[252:255], v[192:195], 0
 s_waitcnt lgkmcnt(2)
 s_lshl_b32 s51, s70, 3
 v_exp_f32 v191, v191
 v_mfma_f32_16x16x32_bf16 v[160:163], a[192:195], v[64:67], v[224:227]
 ds_read_b128 a[208:211], v14 offset:28672
 s_add_u32 s50, s50, s51
 v_add_f32 v31, v31, v190
 v_mfma_f32_16x16x32_bf16 v[160:163], a[196:199], v[80:83], v[160:163]
 s_add_u32 s50, s50, 256
 s_lshl_b32 s50, s50, 7
 v_exp_f32 v128, v128
 v_mfma_f32_16x16x32_bf16 v[168:171], a[196:199], v[84:87], v[228:231]
 v_add_f32 v31, v31, v191
 v_cvt_pk_bf16_f32 v223, v190, v191
 v_mfma_f32_16x16x32_bf16 v[168:171], a[192:195], v[68:71], v[168:171]
 v_exp_f32 v129, v129
 v_mfma_f32_16x16x32_bf16 v[176:179], a[192:195], v[72:75], v[232:235]
 ds_read_b128 a[212:215], v15 offset:28672
 v_add_f32 v28, v28, v128
 v_and_b32 v60, 7, v1
 v_mfma_f32_16x16x32_bf16 v[176:179], a[196:199], v[88:91], v[176:179]
 v_exp_f32 v130, v130
 v_mfma_f32_16x16x32_bf16 v[184:187], a[196:199], v[92:95], v[236:239]
 v_add_f32 v28, v28, v129
 v_cvt_pk_bf16_f32 v192, v128, v129
 v_mfma_f32_16x16x32_bf16 v[184:187], a[192:195], v[76:79], v[184:187]
 s_waitcnt lgkmcnt(2)
 v_exp_f32 v131, v131
 v_mfma_f32_16x16x32_bf16 v[184:187], a[200:203], v[108:111], v[184:187]
 ds_read_b128 a[216:219], v16 offset:28672
 v_add_f32 v28, v28, v130
 v_lshl_add_u32 v60, v60, 7, s50
 v_mfma_f32_16x16x32_bf16 v[184:187], a[204:207], v[124:127], v[184:187]
 s_mul_i32 s77, s70, 1835008
 s_mul_i32 s78, s70, 28672
 v_exp_f32 v132, v132
 v_mfma_f32_16x16x32_bf16 v[176:179], a[204:207], v[120:123], v[176:179]
 s_lshl_b32 s50, s76, 8
 s_add_u32 s50, s50, 128
 v_add_f32 v28, v28, v131
 v_cvt_pk_bf16_f32 v193, v130, v131
 v_mfma_f32_16x16x32_bf16 v[176:179], a[200:203], v[104:107], v[176:179]
 s_add_u32 s85, s50, 0
 v_exp_f32 v133, v133
 v_mfma_f32_16x16x32_bf16 v[168:171], a[200:203], v[100:103], v[168:171]
 ds_read_b128 a[220:223], v17 offset:28672
 v_add_f32 v28, v28, v132
 v_mfma_f32_16x16x32_bf16 v[168:171], a[204:207], v[116:119], v[168:171]
 v_exp_f32 v134, v134
 v_mfma_f32_16x16x32_bf16 v[160:163], a[204:207], v[112:115], v[160:163]
 v_add_f32 v28, v28, v133
 v_cvt_pk_bf16_f32 v194, v132, v133
 v_mfma_f32_16x16x32_bf16 v[160:163], a[200:203], v[96:99], v[160:163]
 s_waitcnt lgkmcnt(2)
 v_exp_f32 v135, v135
 v_mfma_f32_16x16x32_bf16 v[164:167], a[208:211], v[64:67], v[224:227]
 ds_read_b64_tr_b16 a[224:225], v18 offset:8192
 v_add_f32 v28, v28, v134
 v_mfma_f32_16x16x32_bf16 v[164:167], a[212:215], v[80:83], v[164:167]
 ds_read_b64_tr_b16 a[226:227], v18 offset:12288
 v_exp_f32 v136, v136
 v_mfma_f32_16x16x32_bf16 v[172:175], a[212:215], v[84:87], v[228:231]
 v_add_f32 v28, v28, v135
 v_cvt_pk_bf16_f32 v195, v134, v135
 v_mfma_f32_16x16x32_bf16 v[172:175], a[208:211], v[68:71], v[172:175]
 v_exp_f32 v137, v137
 v_mfma_f32_16x16x32_bf16 v[180:183], a[208:211], v[72:75], v[232:235]
 ds_read_b64_tr_b16 a[228:229], v19 offset:8192
 v_add_f32 v29, v29, v136
 v_mfma_f32_16x16x32_bf16 v[180:183], a[212:215], v[88:91], v[180:183]
 ds_read_b64_tr_b16 a[230:231], v19 offset:12288
 v_exp_f32 v138, v138
 v_mfma_f32_16x16x32_bf16 v[188:191], a[212:215], v[92:95], v[236:239]
 v_add_f32 v29, v29, v137
 v_cvt_pk_bf16_f32 v196, v136, v137
 v_mfma_f32_16x16x32_bf16 v[188:191], a[208:211], v[76:79], v[188:191]
 s_waitcnt lgkmcnt(4)
 v_exp_f32 v139, v139
 v_mfma_f32_16x16x32_bf16 v[188:191], a[216:219], v[108:111], v[188:191]
 ds_read_b64_tr_b16 a[232:233], v20 offset:8192
 v_add_f32 v29, v29, v138
 v_mfma_f32_16x16x32_bf16 v[188:191], a[220:223], v[124:127], v[188:191]
 ds_read_b64_tr_b16 a[234:235], v20 offset:12288
 v_exp_f32 v140, v140
 v_mfma_f32_16x16x32_bf16 v[180:183], a[220:223], v[120:123], v[180:183]
 v_add_f32 v29, v29, v139
 v_cvt_pk_bf16_f32 v197, v138, v139
 v_mfma_f32_16x16x32_bf16 v[180:183], a[216:219], v[104:107], v[180:183]
 v_exp_f32 v141, v141
 v_mfma_f32_16x16x32_bf16 v[172:175], a[216:219], v[100:103], v[172:175]
 ds_read_b64_tr_b16 a[236:237], v21 offset:8192
 v_add_f32 v29, v29, v140
 v_mfma_f32_16x16x32_bf16 v[172:175], a[220:223], v[116:119], v[172:175]
 ds_read_b64_tr_b16 a[238:239], v21 offset:12288
 v_exp_f32 v142, v142
 v_mfma_f32_16x16x32_bf16 v[164:167], a[220:223], v[112:115], v[164:167]
 v_add_f32 v29, v29, v141
 v_cvt_pk_bf16_f32 v198, v140, v141
 v_mfma_f32_16x16x32_bf16 v[164:167], a[216:219], v[96:99], v[164:167]
 s_waitcnt lgkmcnt(6)
 v_exp_f32 v143, v143
 v_mfma_f32_16x16x32_bf16 a[0:3], a[224:227], v[208:211], a[0:3]
 ds_read_b64_tr_b16 a[240:241], v22 offset:8192
 v_add_f32 v29, v29, v142
 v_mfma_f32_16x16x32_bf16 a[4:7], a[224:227], v[212:215], a[4:7]
 ds_read_b64_tr_b16 a[242:243], v22 offset:12288
 v_exp_f32 v144, v144
 v_mfma_f32_16x16x32_bf16 a[8:11], a[224:227], v[216:219], a[8:11]
 v_add_f32 v29, v29, v143
 v_cvt_pk_bf16_f32 v199, v142, v143
 v_mfma_f32_16x16x32_bf16 a[12:15], a[224:227], v[220:223], a[12:15]
 s_waitcnt lgkmcnt(6)
 v_exp_f32 v145, v145
 v_mfma_f32_16x16x32_bf16 a[28:31], a[228:231], v[220:223], a[28:31]
 ds_read_b64_tr_b16 a[244:245], v23 offset:8192
 v_add_f32 v30, v30, v144
 v_mfma_f32_16x16x32_bf16 a[24:27], a[228:231], v[216:219], a[24:27]
 ds_read_b64_tr_b16 a[246:247], v23 offset:12288
 v_exp_f32 v146, v146
 v_mfma_f32_16x16x32_bf16 a[20:23], a[228:231], v[212:215], a[20:23]
 v_add_f32 v30, v30, v145
 v_cvt_pk_bf16_f32 v200, v144, v145
 v_mfma_f32_16x16x32_bf16 a[16:19], a[228:231], v[208:211], a[16:19]
 s_waitcnt lgkmcnt(6)
 v_exp_f32 v147, v147
 v_mfma_f32_16x16x32_bf16 a[32:35], a[232:235], v[208:211], a[32:35]
 ds_read_b64_tr_b16 a[248:249], v24 offset:8192
 v_add_f32 v30, v30, v146
 v_mfma_f32_16x16x32_bf16 a[36:39], a[232:235], v[212:215], a[36:39]
 ds_read_b64_tr_b16 a[250:251], v24 offset:12288
 v_exp_f32 v148, v148
 v_mfma_f32_16x16x32_bf16 a[40:43], a[232:235], v[216:219], a[40:43]
 v_add_f32 v30, v30, v147
 v_cvt_pk_bf16_f32 v201, v146, v147
 v_mfma_f32_16x16x32_bf16 a[44:47], a[232:235], v[220:223], a[44:47]
 s_waitcnt lgkmcnt(6)
 v_exp_f32 v149, v149
 v_mfma_f32_16x16x32_bf16 a[60:63], a[236:239], v[220:223], a[60:63]
 ds_read_b64_tr_b16 a[252:253], v25 offset:8192
 v_add_f32 v30, v30, v148
 v_mfma_f32_16x16x32_bf16 a[56:59], a[236:239], v[216:219], a[56:59]
 ds_read_b64_tr_b16 a[254:255], v25 offset:12288
 v_exp_f32 v150, v150
 v_mfma_f32_16x16x32_bf16 a[52:55], a[236:239], v[212:215], a[52:55]
 v_add_f32 v30, v30, v149
 v_cvt_pk_bf16_f32 v202, v148, v149
 v_mfma_f32_16x16x32_bf16 a[48:51], a[236:239], v[208:211], a[48:51]
 s_waitcnt vmcnt(25)
 s_waitcnt vmcnt(19)
 s_barrier
 s_waitcnt lgkmcnt(6)
 v_exp_f32 v151, v151
 v_mfma_f32_16x16x32_bf16 a[64:67], a[240:243], v[208:211], a[64:67]
 ds_read_b128 a[192:195], v14 offset:32768
 s_add_u32 s54, s39, 65536
 v_add_f32 v30, v30, v150
 v_mfma_f32_16x16x32_bf16 a[68:71], a[240:243], v[212:215], a[68:71]
 s_add_u32 m0, s40, 0
 v_exp_f32 v152, v152
 v_mfma_f32_16x16x32_bf16 a[72:75], a[240:243], v[216:219], a[72:75]
 buffer_load_dwordx4 v8, s[24:27], s54 offen lds
 v_add_f32 v30, v30, v151
 v_cvt_pk_bf16_f32 v203, v150, v151
 v_mfma_f32_16x16x32_bf16 a[76:79], a[240:243], v[220:223], a[76:79]
 s_waitcnt lgkmcnt(5)
 v_exp_f32 v153, v153
 v_mfma_f32_16x16x32_bf16 a[92:95], a[244:247], v[220:223], a[92:95]
 ds_read_b128 a[196:199], v15 offset:32768
 v_add_f32 v31, v31, v152
 v_mfma_f32_16x16x32_bf16 a[88:91], a[244:247], v[216:219], a[88:91]
 v_exp_f32 v154, v154
 v_mfma_f32_16x16x32_bf16 a[84:87], a[244:247], v[212:215], a[84:87]
 buffer_load_dwordx4 v9, s[24:27], s54 offen offset:1024 lds
 v_add_f32 v31, v31, v153
 v_cvt_pk_bf16_f32 v204, v152, v153
 v_mfma_f32_16x16x32_bf16 a[80:83], a[244:247], v[208:211], a[80:83]
 s_waitcnt lgkmcnt(4)
 v_exp_f32 v155, v155
 v_mfma_f32_16x16x32_bf16 a[96:99], a[248:251], v[208:211], a[96:99]
 ds_read_b128 a[200:203], v16 offset:32768
 v_add_f32 v31, v31, v154
 v_mfma_f32_16x16x32_bf16 a[100:103], a[248:251], v[212:215], a[100:103]
 v_exp_f32 v156, v156
 v_mfma_f32_16x16x32_bf16 a[104:107], a[248:251], v[216:219], a[104:107]
 v_add_f32 v31, v31, v155
 v_cvt_pk_bf16_f32 v205, v154, v155
 v_mfma_f32_16x16x32_bf16 a[108:111], a[248:251], v[220:223], a[108:111]
 s_waitcnt lgkmcnt(3)
 v_exp_f32 v157, v157
 v_mfma_f32_16x16x32_bf16 a[124:127], a[252:255], v[220:223], a[124:127]
 ds_read_b128 a[204:207], v17 offset:32768
 buffer_load_dwordx4 v10, s[24:27], s54 offen offset:2048 lds
 v_add_f32 v31, v31, v156
 v_mfma_f32_16x16x32_bf16 a[120:123], a[252:255], v[216:219], a[120:123]
 v_exp_f32 v158, v158
 v_mfma_f32_16x16x32_bf16 a[116:119], a[252:255], v[212:215], a[116:119]
 v_add_f32 v31, v31, v157
 v_cvt_pk_bf16_f32 v206, v156, v157
 v_mfma_f32_16x16x32_bf16 a[112:115], a[252:255], v[208:211], a[112:115]
 s_waitcnt lgkmcnt(2)
 v_exp_f32 v159, v159
 v_mfma_f32_16x16x32_bf16 v[128:131], a[192:195], v[64:67], v[224:227]
 ds_read_b128 a[208:211], v14 offset:36864
 v_add_f32 v31, v31, v158
 v_mfma_f32_16x16x32_bf16 v[128:131], a[196:199], v[80:83], v[128:131]
 v_exp_f32 v160, v160
 v_mfma_f32_16x16x32_bf16 v[136:139], a[196:199], v[84:87], v[228:231]
 buffer_load_dwordx4 v11, s[24:27], s54 offen offset:3072 lds
 v_add_f32 v31, v31, v159
 v_cvt_pk_bf16_f32 v207, v158, v159
 v_mfma_f32_16x16x32_bf16 v[136:139], a[192:195], v[68:71], v[136:139]
 v_exp_f32 v161, v161
 v_mfma_f32_16x16x32_bf16 v[144:147], a[192:195], v[72:75], v[232:235]
 ds_read_b128 a[212:215], v15 offset:36864
 v_add_f32 v28, v28, v160
 v_mfma_f32_16x16x32_bf16 v[144:147], a[196:199], v[88:91], v[144:147]
 v_exp_f32 v162, v162
 v_mfma_f32_16x16x32_bf16 v[152:155], a[196:199], v[92:95], v[236:239]
 v_add_f32 v28, v28, v161
 v_cvt_pk_bf16_f32 v208, v160, v161
 v_mfma_f32_16x16x32_bf16 v[152:155], a[192:195], v[76:79], v[152:155]
 s_waitcnt lgkmcnt(2)
 v_exp_f32 v163, v163
 v_mfma_f32_16x16x32_bf16 v[152:155], a[200:203], v[108:111], v[152:155]
 ds_read_b128 a[216:219], v16 offset:36864
 s_add_u32 s54, s39, 49152
 v_add_f32 v28, v28, v162
 v_mfma_f32_16x16x32_bf16 v[152:155], a[204:207], v[124:127], v[152:155]
 s_add_u32 m0, s40, 114688
 v_exp_f32 v164, v164
 v_mfma_f32_16x16x32_bf16 v[144:147], a[204:207], v[120:123], v[144:147]
 buffer_load_dwordx4 v12, s[28:31], s54 offen lds
 v_add_f32 v28, v28, v163
 v_cvt_pk_bf16_f32 v209, v162, v163
 v_mfma_f32_16x16x32_bf16 v[144:147], a[200:203], v[104:107], v[144:147]
 v_exp_f32 v165, v165
 v_mfma_f32_16x16x32_bf16 v[136:139], a[200:203], v[100:103], v[136:139]
 ds_read_b128 a[220:223], v17 offset:36864
 v_add_f32 v28, v28, v164
 v_mfma_f32_16x16x32_bf16 v[136:139], a[204:207], v[116:119], v[136:139]
 v_exp_f32 v166, v166
 v_mfma_f32_16x16x32_bf16 v[128:131], a[204:207], v[112:115], v[128:131]
 buffer_load_dwordx4 v13, s[28:31], s54 offen offset:1024 lds
 v_add_f32 v28, v28, v165
 v_cvt_pk_bf16_f32 v210, v164, v165
 v_mfma_f32_16x16x32_bf16 v[128:131], a[200:203], v[96:99], v[128:131]
 s_waitcnt lgkmcnt(2)
 v_exp_f32 v167, v167
 v_mfma_f32_16x16x32_bf16 v[132:135], a[208:211], v[64:67], v[224:227]
 ds_read_b64_tr_b16 a[224:225], v18 offset:16384
 v_add_f32 v28, v28, v166
 v_mfma_f32_16x16x32_bf16 v[132:135], a[212:215], v[80:83], v[132:135]
 ds_read_b64_tr_b16 a[226:227], v18 offset:20480
 v_exp_f32 v168, v168
 v_mfma_f32_16x16x32_bf16 v[140:143], a[212:215], v[84:87], v[228:231]
 v_add_f32 v28, v28, v167
 v_cvt_pk_bf16_f32 v211, v166, v167
 v_mfma_f32_16x16x32_bf16 v[140:143], a[208:211], v[68:71], v[140:143]
 v_exp_f32 v169, v169
 v_mfma_f32_16x16x32_bf16 v[148:151], a[208:211], v[72:75], v[232:235]
 ds_read_b64_tr_b16 a[228:229], v19 offset:16384
 buffer_load_dwordx4 v12, s[28:31], s54 offen offset:2048 lds
 v_add_f32 v29, v29, v168
 v_mfma_f32_16x16x32_bf16 v[148:151], a[212:215], v[88:91], v[148:151]
 ds_read_b64_tr_b16 a[230:231], v19 offset:20480
 v_exp_f32 v170, v170
 v_mfma_f32_16x16x32_bf16 v[156:159], a[212:215], v[92:95], v[236:239]
 v_add_f32 v29, v29, v169
 v_cvt_pk_bf16_f32 v212, v168, v169
 v_mfma_f32_16x16x32_bf16 v[156:159], a[208:211], v[76:79], v[156:159]
 s_waitcnt lgkmcnt(4)
 v_exp_f32 v171, v171
 v_mfma_f32_16x16x32_bf16 v[156:159], a[216:219], v[108:111], v[156:159]
 ds_read_b64_tr_b16 a[232:233], v20 offset:16384
 v_add_f32 v29, v29, v170
 v_mfma_f32_16x16x32_bf16 v[156:159], a[220:223], v[124:127], v[156:159]
 ds_read_b64_tr_b16 a[234:235], v20 offset:20480
 v_exp_f32 v172, v172
 v_mfma_f32_16x16x32_bf16 v[148:151], a[220:223], v[120:123], v[148:151]
 buffer_load_dwordx4 v13, s[28:31], s54 offen offset:3072 lds
 v_add_f32 v29, v29, v171
 v_cvt_pk_bf16_f32 v213, v170, v171
 v_mfma_f32_16x16x32_bf16 v[148:151], a[216:219], v[104:107], v[148:151]
 v_exp_f32 v173, v173
 v_mfma_f32_16x16x32_bf16 v[140:143], a[216:219], v[100:103], v[140:143]
 ds_read_b64_tr_b16 a[236:237], v21 offset:16384
 v_add_f32 v29, v29, v172
 v_mfma_f32_16x16x32_bf16 v[140:143], a[220:223], v[116:119], v[140:143]
 ds_read_b64_tr_b16 a[238:239], v21 offset:20480
 v_exp_f32 v174, v174
 v_mfma_f32_16x16x32_bf16 v[132:135], a[220:223], v[112:115], v[132:135]
 v_add_f32 v29, v29, v173
 v_cvt_pk_bf16_f32 v214, v172, v173
 v_mfma_f32_16x16x32_bf16 v[132:135], a[216:219], v[96:99], v[132:135]
 s_waitcnt lgkmcnt(6)
 v_exp_f32 v175, v175
 v_mfma_f32_16x16x32_bf16 a[0:3], a[224:227], v[192:195], a[0:3]
 ds_read_b64_tr_b16 a[240:241], v22 offset:16384
 s_mov_b32 m0, s55
 v_add_f32 v29, v29, v174
 v_mfma_f32_16x16x32_bf16 a[4:7], a[224:227], v[196:199], a[4:7]
 ds_read_b64_tr_b16 a[242:243], v22 offset:20480
 v_exp_f32 v176, v176
 v_mfma_f32_16x16x32_bf16 a[8:11], a[224:227], v[200:203], a[8:11]
 buffer_load_dwordx4 v34, s[12:15], s44 offen lds
 s_add_u32 s44, s44, 1024
 v_add_f32 v29, v29, v175
 v_cvt_pk_bf16_f32 v215, v174, v175
 v_mfma_f32_16x16x32_bf16 a[12:15], a[224:227], v[204:207], a[12:15]
 s_waitcnt lgkmcnt(6)
 v_exp_f32 v177, v177
 v_mfma_f32_16x16x32_bf16 a[28:31], a[228:231], v[204:207], a[28:31]
 ds_read_b64_tr_b16 a[244:245], v23 offset:16384
 v_add_f32 v30, v30, v176
 v_mfma_f32_16x16x32_bf16 a[24:27], a[228:231], v[200:203], a[24:27]
 ds_read_b64_tr_b16 a[246:247], v23 offset:20480
 v_exp_f32 v178, v178
 v_mfma_f32_16x16x32_bf16 a[20:23], a[228:231], v[196:199], a[20:23]
 v_add_f32 v30, v30, v177
 v_cvt_pk_bf16_f32 v216, v176, v177
 v_mfma_f32_16x16x32_bf16 a[16:19], a[228:231], v[192:195], a[16:19]
 s_waitcnt lgkmcnt(6)
 v_exp_f32 v179, v179
 v_mfma_f32_16x16x32_bf16 a[32:35], a[232:235], v[192:195], a[32:35]
 ds_read_b64_tr_b16 a[248:249], v24 offset:16384
 buffer_load_dwordx4 v33, s[8:11], s44 offen lds
 v_add_f32 v30, v30, v178
 v_mfma_f32_16x16x32_bf16 a[36:39], a[232:235], v[196:199], a[36:39]
 ds_read_b64_tr_b16 a[250:251], v24 offset:20480
 v_exp_f32 v180, v180
 v_mfma_f32_16x16x32_bf16 a[40:43], a[232:235], v[200:203], a[40:43]
 v_add_f32 v30, v30, v179
 v_cvt_pk_bf16_f32 v217, v178, v179
 v_mfma_f32_16x16x32_bf16 a[44:47], a[232:235], v[204:207], a[44:47]
 s_waitcnt lgkmcnt(6)
 v_exp_f32 v181, v181
 v_mfma_f32_16x16x32_bf16 a[60:63], a[236:239], v[204:207], a[60:63]
 ds_read_b64_tr_b16 a[252:253], v25 offset:16384
 v_add_f32 v30, v30, v180
 v_mfma_f32_16x16x32_bf16 a[56:59], a[236:239], v[200:203], a[56:59]
 ds_read_b64_tr_b16 a[254:255], v25 offset:20480
 v_exp_f32 v182, v182
 v_mfma_f32_16x16x32_bf16 a[52:55], a[236:239], v[196:199], a[52:55]
 v_add_f32 v30, v30, v181
 v_cvt_pk_bf16_f32 v218, v180, v181
 v_mfma_f32_16x16x32_bf16 a[48:51], a[236:239], v[192:195], a[48:51]
 s_waitcnt lgkmcnt(6)
 v_exp_f32 v183, v183
 v_mfma_f32_16x16x32_bf16 a[64:67], a[240:243], v[192:195], a[64:67]
 ds_read_b128 a[192:195], v14 offset:40960
 buffer_load_dwordx4 v34, s[12:15], s44 offen lds
 v_add_f32 v30, v30, v182
 v_mfma_f32_16x16x32_bf16 a[68:71], a[240:243], v[196:199], a[68:71]
 s_add_u32 s44, s44, 1024
 v_exp_f32 v184, v184
 v_mfma_f32_16x16x32_bf16 a[72:75], a[240:243], v[200:203], a[72:75]
 v_add_f32 v30, v30, v183
 v_cvt_pk_bf16_f32 v219, v182, v183
 v_mfma_f32_16x16x32_bf16 a[76:79], a[240:243], v[204:207], a[76:79]
 s_waitcnt lgkmcnt(5)
 v_exp_f32 v185, v185
 v_mfma_f32_16x16x32_bf16 a[92:95], a[244:247], v[204:207], a[92:95]
 ds_read_b128 a[196:199], v15 offset:40960
 v_add_f32 v31, v31, v184
 v_mfma_f32_16x16x32_bf16 a[88:91], a[244:247], v[200:203], a[88:91]
 v_exp_f32 v186, v186
 v_mfma_f32_16x16x32_bf16 a[84:87], a[244:247], v[196:199], a[84:87]
 buffer_load_dword v61, v0, s[60:63], 0 offen
 v_add_f32 v31, v31, v185
 v_cvt_pk_bf16_f32 v220, v184, v185
 v_mfma_f32_16x16x32_bf16 a[80:83], a[244:247], v[192:195], a[80:83]
 s_waitcnt lgkmcnt(4)
 v_exp_f32 v187, v187
 v_mfma_f32_16x16x32_bf16 a[96:99], a[248:251], v[192:195], a[96:99]
 ds_read_b128 a[200:203], v16 offset:40960
 s_and_b32 s85, s85, 2047
 v_add_f32 v31, v31, v186
 v_mfma_f32_16x16x32_bf16 a[100:103], a[248:251], v[196:199], a[100:103]
 s_sub_u32 s85, s85, s50
 s_lshl_b32 s52, s36, 16
 v_exp_f32 v188, v188
 v_mfma_f32_16x16x32_bf16 a[104:107], a[248:251], v[200:203], a[104:107]
 s_lshl_b32 s53, s76, 8
 s_add_u32 s52, s52, s53
 v_add_f32 v31, v31, v187
 v_cvt_pk_bf16_f32 v221, v186, v187
 v_mfma_f32_16x16x32_bf16 a[108:111], a[248:251], v[204:207], a[108:111]
 s_waitcnt lgkmcnt(3)
 v_exp_f32 v189, v189
 v_mfma_f32_16x16x32_bf16 a[124:127], a[252:255], v[204:207], a[124:127]
 ds_read_b128 a[204:207], v17 offset:40960
 v_add_f32 v31, v31, v188
 v_lshrrev_b32 v36, 4, v1
 v_mfma_f32_16x16x32_bf16 a[120:123], a[252:255], v[200:203], a[120:123]
 v_exp_f32 v190, v190
 v_mfma_f32_16x16x32_bf16 a[116:119], a[252:255], v[196:199], a[116:119]
 v_add_f32 v31, v31, v189
 v_cvt_pk_bf16_f32 v222, v188, v189
 v_mfma_f32_16x16x32_bf16 a[112:115], a[252:255], v[192:195], a[112:115]
 s_waitcnt lgkmcnt(2)
 v_exp_f32 v191, v191
 v_mfma_f32_16x16x32_bf16 v[160:163], a[192:195], v[64:67], v[224:227]
 ds_read_b128 a[208:211], v14 offset:45056
 v_add_f32 v31, v31, v190
 v_and_b32 v37, 15, v1
 v_mfma_f32_16x16x32_bf16 v[160:163], a[196:199], v[80:83], v[160:163]
 v_exp_f32 v128, v128
 v_mfma_f32_16x16x32_bf16 v[168:171], a[196:199], v[84:87], v[228:231]
 v_add_f32 v31, v31, v191
 v_cvt_pk_bf16_f32 v223, v190, v191
 v_mfma_f32_16x16x32_bf16 v[168:171], a[192:195], v[68:71], v[168:171]
 v_exp_f32 v129, v129
 v_mfma_f32_16x16x32_bf16 v[176:179], a[192:195], v[72:75], v[232:235]
 ds_read_b128 a[212:215], v15 offset:45056
 v_add_f32 v28, v28, v128
 v_lshlrev_b32 v38, 1, v36
 v_mfma_f32_16x16x32_bf16 v[176:179], a[196:199], v[88:91], v[176:179]
 v_exp_f32 v130, v130
 v_mfma_f32_16x16x32_bf16 v[184:187], a[196:199], v[92:95], v[236:239]
 v_add_f32 v28, v28, v129
 v_cvt_pk_bf16_f32 v192, v128, v129
 v_mfma_f32_16x16x32_bf16 v[184:187], a[192:195], v[76:79], v[184:187]
 s_waitcnt lgkmcnt(2)
 v_exp_f32 v131, v131
 v_mfma_f32_16x16x32_bf16 v[184:187], a[200:203], v[108:111], v[184:187]
 ds_read_b128 a[216:219], v16 offset:45056
 v_add_f32 v28, v28, v130
 v_xor_b32 v37, v37, v38
 v_mfma_f32_16x16x32_bf16 v[184:187], a[204:207], v[124:127], v[184:187]
 v_exp_f32 v132, v132
 v_mfma_f32_16x16x32_bf16 v[176:179], a[204:207], v[120:123], v[176:179]
 v_add_f32 v28, v28, v131
 v_cvt_pk_bf16_f32 v193, v130, v131
 v_mfma_f32_16x16x32_bf16 v[176:179], a[200:203], v[104:107], v[176:179]
 v_exp_f32 v133, v133
 v_mfma_f32_16x16x32_bf16 v[168:171], a[200:203], v[100:103], v[168:171]
 ds_read_b128 a[220:223], v17 offset:45056
 v_add_f32 v28, v28, v132
 v_lshlrev_b32 v36, 11, v36
 v_mfma_f32_16x16x32_bf16 v[168:171], a[204:207], v[116:119], v[168:171]
 v_exp_f32 v134, v134
 v_mfma_f32_16x16x32_bf16 v[160:163], a[204:207], v[112:115], v[160:163]
 v_add_f32 v28, v28, v133
 v_cvt_pk_bf16_f32 v194, v132, v133
 v_mfma_f32_16x16x32_bf16 v[160:163], a[200:203], v[96:99], v[160:163]
 s_waitcnt lgkmcnt(2)
 v_exp_f32 v135, v135
 v_mfma_f32_16x16x32_bf16 v[164:167], a[208:211], v[64:67], v[224:227]
 ds_read_b64_tr_b16 a[224:225], v18 offset:24576
 v_add_f32 v28, v28, v134
 v_add_u32 v36, s52, v36
 v_mfma_f32_16x16x32_bf16 v[164:167], a[212:215], v[80:83], v[164:167]
 ds_read_b64_tr_b16 a[226:227], v18 offset:28672
 v_exp_f32 v136, v136
 v_mfma_f32_16x16x32_bf16 v[172:175], a[212:215], v[84:87], v[228:231]
 v_add_f32 v28, v28, v135
 v_cvt_pk_bf16_f32 v195, v134, v135
 v_mfma_f32_16x16x32_bf16 v[172:175], a[208:211], v[68:71], v[172:175]
 v_exp_f32 v137, v137
 v_mfma_f32_16x16x32_bf16 v[180:183], a[208:211], v[72:75], v[232:235]
 ds_read_b64_tr_b16 a[228:229], v19 offset:24576
 v_add_f32 v29, v29, v136
 v_xor_b32 v38, 0, v37
 v_mfma_f32_16x16x32_bf16 v[180:183], a[212:215], v[88:91], v[180:183]
 ds_read_b64_tr_b16 a[230:231], v19 offset:28672
 v_exp_f32 v138, v138
 v_mfma_f32_16x16x32_bf16 v[188:191], a[212:215], v[92:95], v[236:239]
 v_add_f32 v29, v29, v137
 v_cvt_pk_bf16_f32 v196, v136, v137
 v_mfma_f32_16x16x32_bf16 v[188:191], a[208:211], v[76:79], v[188:191]
 s_waitcnt lgkmcnt(4)
 v_exp_f32 v139, v139
 v_mfma_f32_16x16x32_bf16 v[188:191], a[216:219], v[108:111], v[188:191]
 ds_read_b64_tr_b16 a[232:233], v20 offset:24576
 v_add_f32 v29, v29, v138
 v_lshl_add_u32 v40, v38, 4, v36
 v_mfma_f32_16x16x32_bf16 v[188:191], a[220:223], v[124:127], v[188:191]
 ds_read_b64_tr_b16 a[234:235], v20 offset:28672
 v_exp_f32 v140, v140
 v_mfma_f32_16x16x32_bf16 v[180:183], a[220:223], v[120:123], v[180:183]
 v_add_f32 v29, v29, v139
 v_cvt_pk_bf16_f32 v197, v138, v139
 v_mfma_f32_16x16x32_bf16 v[180:183], a[216:219], v[104:107], v[180:183]
 v_exp_f32 v141, v141
 v_mfma_f32_16x16x32_bf16 v[172:175], a[216:219], v[100:103], v[172:175]
 ds_read_b64_tr_b16 a[236:237], v21 offset:24576
 v_add_f32 v29, v29, v140
 v_xor_b32 v38, 8, v37
 v_mfma_f32_16x16x32_bf16 v[172:175], a[220:223], v[116:119], v[172:175]
 ds_read_b64_tr_b16 a[238:239], v21 offset:28672
 v_exp_f32 v142, v142
 v_mfma_f32_16x16x32_bf16 v[164:167], a[220:223], v[112:115], v[164:167]
 v_add_f32 v29, v29, v141
 v_cvt_pk_bf16_f32 v198, v140, v141
 v_mfma_f32_16x16x32_bf16 v[164:167], a[216:219], v[96:99], v[164:167]
 s_waitcnt lgkmcnt(6)
 v_exp_f32 v143, v143
 v_mfma_f32_16x16x32_bf16 a[0:3], a[224:227], v[208:211], a[0:3]
 ds_read_b64_tr_b16 a[240:241], v22 offset:24576
 v_add_f32 v29, v29, v142
 v_lshl_add_u32 v41, v38, 4, v36
 v_mfma_f32_16x16x32_bf16 a[4:7], a[224:227], v[212:215], a[4:7]
 ds_read_b64_tr_b16 a[242:243], v22 offset:28672
 v_exp_f32 v144, v144
 v_mfma_f32_16x16x32_bf16 a[8:11], a[224:227], v[216:219], a[8:11]
 v_add_f32 v29, v29, v143
 v_cvt_pk_bf16_f32 v199, v142, v143
 v_mfma_f32_16x16x32_bf16 a[12:15], a[224:227], v[220:223], a[12:15]
 s_waitcnt lgkmcnt(6)
 v_exp_f32 v145, v145
 v_mfma_f32_16x16x32_bf16 a[28:31], a[228:231], v[220:223], a[28:31]
 ds_read_b64_tr_b16 a[244:245], v23 offset:24576
 v_add_f32 v30, v30, v144
 v_add_u32 v47, 54272, v41
 v_mfma_f32_16x16x32_bf16 a[24:27], a[228:231], v[216:219], a[24:27]
 ds_read_b64_tr_b16 a[246:247], v23 offset:28672
 v_exp_f32 v146, v146
 v_mfma_f32_16x16x32_bf16 a[20:23], a[228:231], v[212:215], a[20:23]
 v_add_f32 v30, v30, v145
 v_cvt_pk_bf16_f32 v200, v144, v145
 v_mfma_f32_16x16x32_bf16 a[16:19], a[228:231], v[208:211], a[16:19]
 s_waitcnt lgkmcnt(6)
 v_exp_f32 v147, v147
 v_mfma_f32_16x16x32_bf16 a[32:35], a[232:235], v[208:211], a[32:35]
 ds_read_b64_tr_b16 a[248:249], v24 offset:24576
 v_add_f32 v30, v30, v146
 v_add_u32 v46, 47104, v40
 v_mfma_f32_16x16x32_bf16 a[36:39], a[232:235], v[212:215], a[36:39]
 ds_read_b64_tr_b16 a[250:251], v24 offset:28672
 v_exp_f32 v148, v148
 v_mfma_f32_16x16x32_bf16 a[40:43], a[232:235], v[216:219], a[40:43]
 v_add_f32 v30, v30, v147
 v_cvt_pk_bf16_f32 v201, v146, v147
 v_mfma_f32_16x16x32_bf16 a[44:47], a[232:235], v[220:223], a[44:47]
 s_waitcnt lgkmcnt(6)
 v_exp_f32 v149, v149
 v_mfma_f32_16x16x32_bf16 a[60:63], a[236:239], v[220:223], a[60:63]
 ds_read_b64_tr_b16 a[252:253], v25 offset:24576
 v_add_f32 v30, v30, v148
 v_add_u32 v45, 39936, v41
 v_mfma_f32_16x16x32_bf16 a[56:59], a[236:239], v[216:219], a[56:59]
 ds_read_b64_tr_b16 a[254:255], v25 offset:28672
 v_exp_f32 v150, v150
 v_mfma_f32_16x16x32_bf16 a[52:55], a[236:239], v[212:215], a[52:55]
 v_add_f32 v30, v30, v149
 v_cvt_pk_bf16_f32 v202, v148, v149
 v_mfma_f32_16x16x32_bf16 a[48:51], a[236:239], v[208:211], a[48:51]
 s_waitcnt vmcnt(20)
 s_waitcnt vmcnt(16)
 s_barrier
 s_waitcnt lgkmcnt(6)
 v_exp_f32 v151, v151
 v_mfma_f32_16x16x32_bf16 a[64:67], a[240:243], v[208:211], a[64:67]
 ds_read_b128 a[192:195], v14 offset:49152
 s_cmp_eq_u32 s36, 1
 v_add_f32 v30, v30, v150
 s_cbranch_scc0 A_hf
 buffer_store_dwordx2 v[2:3], v27, s[56:59], 0 offen sc1
A_hf:
 v_add_u32 v44, 32768, v40
 v_mfma_f32_16x16x32_bf16 a[68:71], a[240:243], v[212:215], a[68:71]
 v_exp_f32 v152, v152
 v_mfma_f32_16x16x32_bf16 a[72:75], a[240:243], v[216:219], a[72:75]
 v_add_f32 v30, v30, v151
 v_cvt_pk_bf16_f32 v203, v150, v151
 v_mfma_f32_16x16x32_bf16 a[76:79], a[240:243], v[220:223], a[76:79]
 s_waitcnt lgkmcnt(5)
 v_exp_f32 v153, v153
 v_mfma_f32_16x16x32_bf16 a[92:95], a[244:247], v[220:223], a[92:95]
 ds_read_b128 a[196:199], v15 offset:49152
 v_add_f32 v31, v31, v152
 v_add_u32 v43, 21504, v41
 v_mfma_f32_16x16x32_bf16 a[88:91], a[244:247], v[216:219], a[88:91]
 v_exp_f32 v154, v154
 v_mfma_f32_16x16x32_bf16 a[84:87], a[244:247], v[212:215], a[84:87]
 v_add_f32 v31, v31, v153
 v_cvt_pk_bf16_f32 v204, v152, v153
 v_mfma_f32_16x16x32_bf16 a[80:83], a[244:247], v[208:211], a[80:83]
 s_waitcnt lgkmcnt(4)
 v_exp_f32 v155, v155
 v_mfma_f32_16x16x32_bf16 a[96:99], a[248:251], v[208:211], a[96:99]
 ds_read_b128 a[200:203], v16 offset:49152
 v_add_f32 v31, v31, v154
 v_add_u32 v42, 14336, v40
 v_mfma_f32_16x16x32_bf16 a[100:103], a[248:251], v[212:215], a[100:103]
 v_exp_f32 v156, v156
 v_mfma_f32_16x16x32_bf16 a[104:107], a[248:251], v[216:219], a[104:107]
 v_add_f32 v31, v31, v155
 v_cvt_pk_bf16_f32 v205, v154, v155
 v_mfma_f32_16x16x32_bf16 a[108:111], a[248:251], v[220:223], a[108:111]
 s_waitcnt lgkmcnt(3)
 v_exp_f32 v157, v157
 v_mfma_f32_16x16x32_bf16 a[124:127], a[252:255], v[220:223], a[124:127]
 ds_read_b128 a[204:207], v17 offset:49152
 v_add_f32 v31, v31, v156
 v_add_u32 v41, 7168, v41
 v_mfma_f32_16x16x32_bf16 a[120:123], a[252:255], v[216:219], a[120:123]
 s_add_u32 s54, s39, 81920
 s_add_u32 m0, s40, 16384
 v_exp_f32 v158, v158
 v_mfma_f32_16x16x32_bf16 a[116:119], a[252:255], v[212:215], a[116:119]
 v_add_f32 v31, v31, v157
 v_cvt_pk_bf16_f32 v206, v156, v157
 s_nop 0
 buffer_load_dwordx4 v8, s[24:27], s54 offen lds
 v_mfma_f32_16x16x32_bf16 a[112:115], a[252:255], v[208:211], a[112:115]
 s_waitcnt lgkmcnt(2)
 buffer_load_dwordx4 v9, s[24:27], s54 offen offset:1024 lds
 v_exp_f32 v159, v159
 v_mfma_f32_16x16x32_bf16 v[128:131], a[192:195], v[64:67], v[224:227]
 ds_read_b128 a[208:211], v14 offset:53248
 buffer_load_dwordx4 v10, s[24:27], s54 offen offset:2048 lds
 v_add_f32 v31, v31, v158
 v_mfma_f32_16x16x32_bf16 v[128:131], a[196:199], v[80:83], v[128:131]
 v_exp_f32 v160, v160
 v_mfma_f32_16x16x32_bf16 v[136:139], a[196:199], v[84:87], v[228:231]
 buffer_load_dwordx4 v11, s[24:27], s54 offen offset:3072 lds
 v_add_f32 v31, v31, v159
 v_cvt_pk_bf16_f32 v207, v158, v159
 v_mfma_f32_16x16x32_bf16 v[136:139], a[192:195], v[68:71], v[136:139]
 v_exp_f32 v161, v161
 v_mfma_f32_16x16x32_bf16 v[144:147], a[192:195], v[72:75], v[232:235]
 ds_read_b128 a[212:215], v15 offset:53248
 v_add_f32 v28, v28, v160
 v_mfma_f32_16x16x32_bf16 v[144:147], a[196:199], v[88:91], v[144:147]
 v_exp_f32 v162, v162
 v_mfma_f32_16x16x32_bf16 v[152:155], a[196:199], v[92:95], v[236:239]
 v_add_f32 v28, v28, v161
 v_cvt_pk_bf16_f32 v208, v160, v161
 v_mfma_f32_16x16x32_bf16 v[152:155], a[192:195], v[76:79], v[152:155]
 s_waitcnt lgkmcnt(2)
 v_exp_f32 v163, v163
 v_mfma_f32_16x16x32_bf16 v[152:155], a[200:203], v[108:111], v[152:155]
 ds_read_b128 a[216:219], v16 offset:53248
 s_add_u32 s54, s39, 65536
 v_add_f32 v28, v28, v162
 v_mfma_f32_16x16x32_bf16 v[152:155], a[204:207], v[124:127], v[152:155]
 s_add_u32 m0, s40, 65536
 v_exp_f32 v164, v164
 v_mfma_f32_16x16x32_bf16 v[144:147], a[204:207], v[120:123], v[144:147]
 buffer_load_dwordx4 v12, s[28:31], s54 offen lds
 v_add_f32 v28, v28, v163
 v_cvt_pk_bf16_f32 v209, v162, v163
 v_mfma_f32_16x16x32_bf16 v[144:147], a[200:203], v[104:107], v[144:147]
 v_exp_f32 v165, v165
 v_mfma_f32_16x16x32_bf16 v[136:139], a[200:203], v[100:103], v[136:139]
 ds_read_b128 a[220:223], v17 offset:53248
 v_add_f32 v28, v28, v164
 v_mfma_f32_16x16x32_bf16 v[136:139], a[204:207], v[116:119], v[136:139]
 v_exp_f32 v166, v166
 v_mfma_f32_16x16x32_bf16 v[128:131], a[204:207], v[112:115], v[128:131]
 buffer_load_dwordx4 v13, s[28:31], s54 offen offset:1024 lds
 v_add_f32 v28, v28, v165
 v_cvt_pk_bf16_f32 v210, v164, v165
 v_mfma_f32_16x16x32_bf16 v[128:131], a[200:203], v[96:99], v[128:131]
 s_waitcnt lgkmcnt(2)
 v_exp_f32 v167, v167
 v_mfma_f32_16x16x32_bf16 v[132:135], a[208:211], v[64:67], v[224:227]
 ds_read_b64_tr_b16 a[224:225], v18 offset:32768
 v_add_f32 v28, v28, v166
 v_mfma_f32_16x16x32_bf16 v[132:135], a[212:215], v[80:83], v[132:135]
 ds_read_b64_tr_b16 a[226:227], v18 offset:36864
 v_exp_f32 v168, v168
 v_mfma_f32_16x16x32_bf16 v[140:143], a[212:215], v[84:87], v[228:231]
 v_add_f32 v28, v28, v167
 v_cvt_pk_bf16_f32 v211, v166, v167
 v_mfma_f32_16x16x32_bf16 v[140:143], a[208:211], v[68:71], v[140:143]
 v_exp_f32 v169, v169
 v_mfma_f32_16x16x32_bf16 v[148:151], a[208:211], v[72:75], v[232:235]
 ds_read_b64_tr_b16 a[228:229], v19 offset:32768
 buffer_load_dwordx4 v12, s[28:31], s54 offen offset:2048 lds
 v_add_f32 v29, v29, v168
 v_mfma_f32_16x16x32_bf16 v[148:151], a[212:215], v[88:91], v[148:151]
 ds_read_b64_tr_b16 a[230:231], v19 offset:36864
 v_exp_f32 v170, v170
 v_mfma_f32_16x16x32_bf16 v[156:159], a[212:215], v[92:95], v[236:239]
 v_add_f32 v29, v29, v169
 v_cvt_pk_bf16_f32 v212, v168, v169
 v_mfma_f32_16x16x32_bf16 v[156:159], a[208:211], v[76:79], v[156:159]
 s_waitcnt lgkmcnt(4)
 v_exp_f32 v171, v171
 v_mfma_f32_16x16x32_bf16 v[156:159], a[216:219], v[108:111], v[156:159]
 ds_read_b64_tr_b16 a[232:233], v20 offset:32768
 v_add_f32 v29, v29, v170
 v_mfma_f32_16x16x32_bf16 v[156:159], a[220:223], v[124:127], v[156:159]
 ds_read_b64_tr_b16 a[234:235], v20 offset:36864
 v_exp_f32 v172, v172
 v_mfma_f32_16x16x32_bf16 v[148:151], a[220:223], v[120:123], v[148:151]
 buffer_load_dwordx4 v13, s[28:31], s54 offen offset:3072 lds
 v_add_f32 v29, v29, v171
 v_cvt_pk_bf16_f32 v213, v170, v171
 v_mfma_f32_16x16x32_bf16 v[148:151], a[216:219], v[104:107], v[148:151]
 v_exp_f32 v173, v173
 v_mfma_f32_16x16x32_bf16 v[140:143], a[216:219], v[100:103], v[140:143]
 ds_read_b64_tr_b16 a[236:237], v21 offset:32768
 v_add_f32 v29, v29, v172
 v_mfma_f32_16x16x32_bf16 v[140:143], a[220:223], v[116:119], v[140:143]
 ds_read_b64_tr_b16 a[238:239], v21 offset:36864
 v_exp_f32 v174, v174
 v_mfma_f32_16x16x32_bf16 v[132:135], a[220:223], v[112:115], v[132:135]
 v_add_f32 v29, v29, v173
 v_cvt_pk_bf16_f32 v214, v172, v173
 v_mfma_f32_16x16x32_bf16 v[132:135], a[216:219], v[96:99], v[132:135]
 s_waitcnt lgkmcnt(6)
 v_exp_f32 v175, v175
 v_mfma_f32_16x16x32_bf16 a[0:3], a[224:227], v[192:195], a[0:3]
 ds_read_b64_tr_b16 a[240:241], v22 offset:32768
 s_mov_b32 m0, s55
 v_add_f32 v29, v29, v174
 v_mfma_f32_16x16x32_bf16 a[4:7], a[224:227], v[196:199], a[4:7]
 ds_read_b64_tr_b16 a[242:243], v22 offset:36864
 v_exp_f32 v176, v176
 v_mfma_f32_16x16x32_bf16 a[8:11], a[224:227], v[200:203], a[8:11]
 buffer_load_dwordx4 v33, s[8:11], s44 offen lds
 v_add_f32 v29, v29, v175
 v_cvt_pk_bf16_f32 v215, v174, v175
 v_mfma_f32_16x16x32_bf16 a[12:15], a[224:227], v[204:207], a[12:15]
 s_waitcnt lgkmcnt(6)
 v_exp_f32 v177, v177
 v_mfma_f32_16x16x32_bf16 a[28:31], a[228:231], v[204:207], a[28:31]
 ds_read_b64_tr_b16 a[244:245], v23 offset:32768
 v_add_f32 v30, v30, v176
 v_mfma_f32_16x16x32_bf16 a[24:27], a[228:231], v[200:203], a[24:27]
 ds_read_b64_tr_b16 a[246:247], v23 offset:36864
 v_exp_f32 v178, v178
 v_mfma_f32_16x16x32_bf16 a[20:23], a[228:231], v[196:199], a[20:23]
 v_add_f32 v30, v30, v177
 v_cvt_pk_bf16_f32 v216, v176, v177
 v_mfma_f32_16x16x32_bf16 a[16:19], a[228:231], v[192:195], a[16:19]
 s_waitcnt lgkmcnt(6)
 v_exp_f32 v179, v179
 v_mfma_f32_16x16x32_bf16 a[32:35], a[232:235], v[192:195], a[32:35]
 ds_read_b64_tr_b16 a[248:249], v24 offset:32768
 buffer_load_dwordx4 v34, s[12:15], s44 offen lds
 v_add_f32 v30, v30, v178
 v_mfma_f32_16x16x32_bf16 a[36:39], a[232:235], v[196:199], a[36:39]
 ds_read_b64_tr_b16 a[250:251], v24 offset:36864
 s_add_u32 s44, s44, 1024
 v_exp_f32 v180, v180
 v_mfma_f32_16x16x32_bf16 a[40:43], a[232:235], v[200:203], a[40:43]
 v_add_f32 v30, v30, v179
 v_cvt_pk_bf16_f32 v217, v178, v179
 v_mfma_f32_16x16x32_bf16 a[44:47], a[232:235], v[204:207], a[44:47]
 s_waitcnt lgkmcnt(6)
 v_exp_f32 v181, v181
 v_mfma_f32_16x16x32_bf16 a[60:63], a[236:239], v[204:207], a[60:63]
 ds_read_b64_tr_b16 a[252:253], v25 offset:32768
 v_add_f32 v30, v30, v180
 v_mfma_f32_16x16x32_bf16 a[56:59], a[236:239], v[200:203], a[56:59]
 ds_read_b64_tr_b16 a[254:255], v25 offset:36864
 v_exp_f32 v182, v182
 v_mfma_f32_16x16x32_bf16 a[52:55], a[236:239], v[196:199], a[52:55]
 v_add_f32 v30, v30, v181
 v_cvt_pk_bf16_f32 v218, v180, v181
 v_mfma_f32_16x16x32_bf16 a[48:51], a[236:239], v[192:195], a[48:51]
 s_waitcnt lgkmcnt(6)
 v_exp_f32 v183, v183
 v_mfma_f32_16x16x32_bf16 a[64:67], a[240:243], v[192:195], a[64:67]
 ds_read_b128 a[192:195], v14 offset:57344
 buffer_load_dwordx4 v33, s[8:11], s44 offen lds
 v_add_f32 v30, v30, v182
 v_mfma_f32_16x16x32_bf16 a[68:71], a[240:243], v[196:199], a[68:71]
 v_exp_f32 v184, v184
 v_mfma_f32_16x16x32_bf16 a[72:75], a[240:243], v[200:203], a[72:75]
 v_add_f32 v30, v30, v183
 v_cvt_pk_bf16_f32 v219, v182, v183
 v_mfma_f32_16x16x32_bf16 a[76:79], a[240:243], v[204:207], a[76:79]
 s_waitcnt lgkmcnt(5)
 v_exp_f32 v185, v185
 v_mfma_f32_16x16x32_bf16 a[92:95], a[244:247], v[204:207], a[92:95]
 ds_read_b128 a[196:199], v15 offset:57344
 v_add_f32 v31, v31, v184
 v_mfma_f32_16x16x32_bf16 a[88:91], a[244:247], v[200:203], a[88:91]
 v_exp_f32 v186, v186
 v_mfma_f32_16x16x32_bf16 a[84:87], a[244:247], v[196:199], a[84:87]
 buffer_load_dword v61, v0, s[60:63], 0 offen
 v_add_f32 v31, v31, v185
 v_cvt_pk_bf16_f32 v220, v184, v185
 v_mfma_f32_16x16x32_bf16 a[80:83], a[244:247], v[192:195], a[80:83]
 s_waitcnt lgkmcnt(4)
 v_exp_f32 v187, v187
 v_mfma_f32_16x16x32_bf16 a[96:99], a[248:251], v[192:195], a[96:99]
 ds_read_b128 a[200:203], v16 offset:57344
 s_lshl_b32 s79, s36, 13
 v_add_f32 v31, v31, v186
 v_mfma_f32_16x16x32_bf16 a[100:103], a[248:251], v[196:199], a[100:103]
 s_add_u32 s16, s86, 0x1700000
 s_addc_u32 s17, s87, 0
 v_exp_f32 v188, v188
 v_mfma_f32_16x16x32_bf16 a[104:107], a[248:251], v[200:203], a[104:107]
 s_mov_b32 s18, 0xf00000
 s_mov_b32 s19, 0x20000
 v_add_f32 v31, v31, v187
 v_cvt_pk_bf16_f32 v221, v186, v187
 v_mfma_f32_16x16x32_bf16 a[108:111], a[248:251], v[204:207], a[108:111]
 s_lshl_b32 s50, s71, 4
 s_waitcnt lgkmcnt(3)
 v_exp_f32 v189, v189
 v_mfma_f32_16x16x32_bf16 a[124:127], a[252:255], v[204:207], a[124:127]
 ds_read_b128 a[204:207], v17 offset:57344
 s_lshl_b32 s52, s36, 2
 v_add_f32 v31, v31, v188
 v_mfma_f32_16x16x32_bf16 a[120:123], a[252:255], v[200:203], a[120:123]
 s_add_u32 s50, s50, s52
 s_mul_i32 s52, s50, 114688
 v_exp_f32 v190, v190
 v_mfma_f32_16x16x32_bf16 a[116:119], a[252:255], v[196:199], a[116:119]
 s_and_b32 s53, s70, 1
 s_mul_i32 s53, s53, 229376
 v_add_f32 v31, v31, v189
 v_cvt_pk_bf16_f32 v222, v188, v189
 v_mfma_f32_16x16x32_bf16 a[112:115], a[252:255], v[192:195], a[112:115]
 s_waitcnt lgkmcnt(2)
 v_exp_f32 v191, v191
 v_mfma_f32_16x16x32_bf16 v[160:163], a[192:195], v[64:67], v[224:227]
 ds_read_b128 a[208:211], v14 offset:61440
 v_add_f32 v31, v31, v190
 v_lshlrev_b32 v36, 4, v1
 v_mfma_f32_16x16x32_bf16 v[160:163], a[196:199], v[80:83], v[160:163]
 v_exp_f32 v128, v128
 v_mfma_f32_16x16x32_bf16 v[168:171], a[196:199], v[84:87], v[228:231]
 v_add_f32 v31, v31, v191
 v_cvt_pk_bf16_f32 v223, v190, v191
 v_mfma_f32_16x16x32_bf16 v[168:171], a[192:195], v[68:71], v[168:171]
 v_exp_f32 v129, v129
 v_mfma_f32_16x16x32_bf16 v[176:179], a[192:195], v[72:75], v[232:235]
 ds_read_b128 a[212:215], v15 offset:61440
 v_add_f32 v28, v28, v128
 v_add_u32 v50, s52, v36
 v_mfma_f32_16x16x32_bf16 v[176:179], a[196:199], v[88:91], v[176:179]
 v_exp_f32 v130, v130
 v_mfma_f32_16x16x32_bf16 v[184:187], a[196:199], v[92:95], v[236:239]
 v_add_f32 v28, v28, v129
 v_cvt_pk_bf16_f32 v192, v128, v129
 v_mfma_f32_16x16x32_bf16 v[184:187], a[192:195], v[76:79], v[184:187]
 s_waitcnt lgkmcnt(2)
 v_exp_f32 v131, v131
 v_mfma_f32_16x16x32_bf16 v[184:187], a[200:203], v[108:111], v[184:187]
 ds_read_b128 a[216:219], v16 offset:61440
 v_add_f32 v28, v28, v130
 v_add_u32 v48, s53, v50
 v_mfma_f32_16x16x32_bf16 v[184:187], a[204:207], v[124:127], v[184:187]
 v_exp_f32 v132, v132
 v_mfma_f32_16x16x32_bf16 v[176:179], a[204:207], v[120:123], v[176:179]
 v_add_f32 v28, v28, v131
 v_cvt_pk_bf16_f32 v193, v130, v131
 v_mfma_f32_16x16x32_bf16 v[176:179], a[200:203], v[104:107], v[176:179]
 v_exp_f32 v133, v133
 v_mfma_f32_16x16x32_bf16 v[168:171], a[200:203], v[100:103], v[168:171]
 ds_read_b128 a[220:223], v17 offset:61440
 v_add_f32 v28, v28, v132
 v_add_u32 v49, 114688, v48
 v_mfma_f32_16x16x32_bf16 v[168:171], a[204:207], v[116:119], v[168:171]
 s_sub_u32 s53, 229376, s53
 v_exp_f32 v134, v134
 v_mfma_f32_16x16x32_bf16 v[160:163], a[204:207], v[112:115], v[160:163]
 v_add_f32 v28, v28, v133
 v_cvt_pk_bf16_f32 v194, v132, v133
 v_mfma_f32_16x16x32_bf16 v[160:163], a[200:203], v[96:99], v[160:163]
 s_waitcnt lgkmcnt(2)
 v_exp_f32 v135, v135
 v_mfma_f32_16x16x32_bf16 v[164:167], a[208:211], v[64:67], v[224:227]
 ds_read_b64_tr_b16 a[224:225], v18 offset:40960
 v_add_f32 v28, v28, v134
 v_add_u32 v50, s53, v50
 v_mfma_f32_16x16x32_bf16 v[164:167], a[212:215], v[80:83], v[164:167]
 ds_read_b64_tr_b16 a[226:227], v18 offset:45056
 v_exp_f32 v136, v136
 v_mfma_f32_16x16x32_bf16 v[172:175], a[212:215], v[84:87], v[228:231]
 v_add_f32 v28, v28, v135
 v_cvt_pk_bf16_f32 v195, v134, v135
 v_mfma_f32_16x16x32_bf16 v[172:175], a[208:211], v[68:71], v[172:175]
 v_exp_f32 v137, v137
 v_mfma_f32_16x16x32_bf16 v[180:183], a[208:211], v[72:75], v[232:235]
 ds_read_b64_tr_b16 a[228:229], v19 offset:40960
 v_add_f32 v29, v29, v136
 v_add_u32 v51, 114688, v50
 v_mfma_f32_16x16x32_bf16 v[180:183], a[212:215], v[88:91], v[180:183]
 ds_read_b64_tr_b16 a[230:231], v19 offset:45056
 s_and_b32 s53, s70, 2
 v_exp_f32 v138, v138
 v_mfma_f32_16x16x32_bf16 v[188:191], a[212:215], v[92:95], v[236:239]
 s_lshl_b32 s53, s53, 1
 v_add_f32 v29, v29, v137
 v_cvt_pk_bf16_f32 v196, v136, v137
 v_mfma_f32_16x16x32_bf16 v[188:191], a[208:211], v[76:79], v[188:191]
 s_waitcnt lgkmcnt(4)
 v_exp_f32 v139, v139
 v_mfma_f32_16x16x32_bf16 v[188:191], a[216:219], v[108:111], v[188:191]
 ds_read_b64_tr_b16 a[232:233], v20 offset:40960
 v_add_f32 v29, v29, v138
 v_lshrrev_b32 v36, 2, v1
 v_mfma_f32_16x16x32_bf16 v[188:191], a[220:223], v[124:127], v[188:191]
 ds_read_b64_tr_b16 a[234:235], v20 offset:45056
 v_exp_f32 v140, v140
 v_mfma_f32_16x16x32_bf16 v[180:183], a[220:223], v[120:123], v[180:183]
 v_add_f32 v29, v29, v139
 v_cvt_pk_bf16_f32 v197, v138, v139
 v_mfma_f32_16x16x32_bf16 v[180:183], a[216:219], v[104:107], v[180:183]
 v_exp_f32 v141, v141
 v_mfma_f32_16x16x32_bf16 v[172:175], a[216:219], v[100:103], v[172:175]
 ds_read_b64_tr_b16 a[236:237], v21 offset:40960
 v_add_f32 v29, v29, v140
 v_and_b32 v37, 7, v36
 v_mfma_f32_16x16x32_bf16 v[172:175], a[220:223], v[116:119], v[172:175]
 ds_read_b64_tr_b16 a[238:239], v21 offset:45056
 v_exp_f32 v142, v142
 v_mfma_f32_16x16x32_bf16 v[164:167], a[220:223], v[112:115], v[164:167]
 v_add_f32 v29, v29, v141
 v_cvt_pk_bf16_f32 v198, v140, v141
 v_mfma_f32_16x16x32_bf16 v[164:167], a[216:219], v[96:99], v[164:167]
 s_waitcnt lgkmcnt(6)
 v_exp_f32 v143, v143
 v_mfma_f32_16x16x32_bf16 a[0:3], a[224:227], v[208:211], a[0:3]
 ds_read_b64_tr_b16 a[240:241], v22 offset:40960
 v_add_f32 v29, v29, v142
 v_xor_b32 v37, s53, v37
 v_mfma_f32_16x16x32_bf16 a[4:7], a[224:227], v[212:215], a[4:7]
 ds_read_b64_tr_b16 a[242:243], v22 offset:45056
 v_exp_f32 v144, v144
 v_mfma_f32_16x16x32_bf16 a[8:11], a[224:227], v[216:219], a[8:11]
 v_add_f32 v29, v29, v143
 v_cvt_pk_bf16_f32 v199, v142, v143
 v_mfma_f32_16x16x32_bf16 a[12:15], a[224:227], v[220:223], a[12:15]
 s_waitcnt lgkmcnt(6)
 v_exp_f32 v145, v145
 v_mfma_f32_16x16x32_bf16 a[28:31], a[228:231], v[220:223], a[28:31]
 ds_read_b64_tr_b16 a[244:245], v23 offset:40960
 v_add_f32 v30, v30, v144
 v_mfma_f32_16x16x32_bf16 a[24:27], a[228:231], v[216:219], a[24:27]
 ds_read_b64_tr_b16 a[246:247], v23 offset:45056
 v_exp_f32 v146, v146
 v_mfma_f32_16x16x32_bf16 a[20:23], a[228:231], v[212:215], a[20:23]
 v_add_f32 v30, v30, v145
 v_cvt_pk_bf16_f32 v200, v144, v145
 v_mfma_f32_16x16x32_bf16 a[16:19], a[228:231], v[208:211], a[16:19]
 s_waitcnt lgkmcnt(6)
 v_exp_f32 v147, v147
 v_mfma_f32_16x16x32_bf16 a[32:35], a[232:235], v[208:211], a[32:35]
 ds_read_b64_tr_b16 a[248:249], v24 offset:40960
 v_add_f32 v30, v30, v146
 v_mfma_f32_16x16x32_bf16 a[36:39], a[232:235], v[212:215], a[36:39]
 ds_read_b64_tr_b16 a[250:251], v24 offset:45056
 v_exp_f32 v148, v148
 v_mfma_f32_16x16x32_bf16 a[40:43], a[232:235], v[216:219], a[40:43]
 v_add_f32 v30, v30, v147
 v_cvt_pk_bf16_f32 v201, v146, v147
 v_mfma_f32_16x16x32_bf16 a[44:47], a[232:235], v[220:223], a[44:47]
 s_waitcnt lgkmcnt(6)
 v_exp_f32 v149, v149
 v_mfma_f32_16x16x32_bf16 a[60:63], a[236:239], v[220:223], a[60:63]
 ds_read_b64_tr_b16 a[252:253], v25 offset:40960
 v_add_f32 v30, v30, v148
 v_mfma_f32_16x16x32_bf16 a[56:59], a[236:239], v[216:219], a[56:59]
 ds_read_b64_tr_b16 a[254:255], v25 offset:45056
 v_exp_f32 v150, v150
 v_mfma_f32_16x16x32_bf16 a[52:55], a[236:239], v[212:215], a[52:55]
 v_add_f32 v30, v30, v149
 v_cvt_pk_bf16_f32 v202, v148, v149
 v_mfma_f32_16x16x32_bf16 a[48:51], a[236:239], v[208:211], a[48:51]
 s_waitcnt vmcnt(20)
 s_waitcnt vmcnt(16)
 s_barrier
 s_waitcnt lgkmcnt(6)
 v_exp_f32 v151, v151
 v_mfma_f32_16x16x32_bf16 a[64:67], a[240:243], v[208:211], a[64:67]
 ds_read_b128 a[192:195], v14
 s_add_u32 s54, s39, 98304
 v_add_f32 v30, v30, v150
 v_mfma_f32_16x16x32_bf16 a[68:71], a[240:243], v[212:215], a[68:71]
 s_add_u32 m0, s40, 32768
 v_exp_f32 v152, v152
 v_mfma_f32_16x16x32_bf16 a[72:75], a[240:243], v[216:219], a[72:75]
 buffer_load_dwordx4 v8, s[24:27], s54 offen lds
 v_add_f32 v30, v30, v151
 v_cvt_pk_bf16_f32 v203, v150, v151
 v_mfma_f32_16x16x32_bf16 a[76:79], a[240:243], v[220:223], a[76:79]
 s_waitcnt lgkmcnt(5)
 v_exp_f32 v153, v153
 v_mfma_f32_16x16x32_bf16 a[92:95], a[244:247], v[220:223], a[92:95]
 ds_read_b128 a[196:199], v15
 v_add_f32 v31, v31, v152
 v_mfma_f32_16x16x32_bf16 a[88:91], a[244:247], v[216:219], a[88:91]
 v_exp_f32 v154, v154
 v_mfma_f32_16x16x32_bf16 a[84:87], a[244:247], v[212:215], a[84:87]
 buffer_load_dwordx4 v9, s[24:27], s54 offen offset:1024 lds
 v_add_f32 v31, v31, v153
 v_cvt_pk_bf16_f32 v204, v152, v153
 v_mfma_f32_16x16x32_bf16 a[80:83], a[244:247], v[208:211], a[80:83]
 s_waitcnt lgkmcnt(4)
 v_exp_f32 v155, v155
 v_mfma_f32_16x16x32_bf16 a[96:99], a[248:251], v[208:211], a[96:99]
 ds_read_b128 a[200:203], v16
 v_add_f32 v31, v31, v154
 v_mfma_f32_16x16x32_bf16 a[100:103], a[248:251], v[212:215], a[100:103]
 v_exp_f32 v156, v156
 v_mfma_f32_16x16x32_bf16 a[104:107], a[248:251], v[216:219], a[104:107]
 v_add_f32 v31, v31, v155
 v_cvt_pk_bf16_f32 v205, v154, v155
 v_mfma_f32_16x16x32_bf16 a[108:111], a[248:251], v[220:223], a[108:111]
 s_waitcnt lgkmcnt(3)
 v_exp_f32 v157, v157
 v_mfma_f32_16x16x32_bf16 a[124:127], a[252:255], v[220:223], a[124:127]
 ds_read_b128 a[204:207], v17
 buffer_load_dwordx4 v10, s[24:27], s54 offen offset:2048 lds
 v_add_f32 v31, v31, v156
 v_mfma_f32_16x16x32_bf16 a[120:123], a[252:255], v[216:219], a[120:123]
 v_exp_f32 v158, v158
 v_mfma_f32_16x16x32_bf16 a[116:119], a[252:255], v[212:215], a[116:119]
 v_add_f32 v31, v31, v157
 v_cvt_pk_bf16_f32 v206, v156, v157
 v_mfma_f32_16x16x32_bf16 a[112:115], a[252:255], v[208:211], a[112:115]
 s_waitcnt lgkmcnt(2)
 v_exp_f32 v159, v159
 v_mfma_f32_16x16x32_bf16 v[128:131], a[192:195], v[64:67], v[224:227]
 ds_read_b128 a[208:211], v14 offset:4096
 v_add_f32 v31, v31, v158
 v_mfma_f32_16x16x32_bf16 v[128:131], a[196:199], v[80:83], v[128:131]
 v_exp_f32 v160, v160
 v_mfma_f32_16x16x32_bf16 v[136:139], a[196:199], v[84:87], v[228:231]
 buffer_load_dwordx4 v11, s[24:27], s54 offen offset:3072 lds
 v_add_f32 v31, v31, v159
 v_cvt_pk_bf16_f32 v207, v158, v159
 v_mfma_f32_16x16x32_bf16 v[136:139], a[192:195], v[68:71], v[136:139]
 v_exp_f32 v161, v161
 v_mfma_f32_16x16x32_bf16 v[144:147], a[192:195], v[72:75], v[232:235]
 ds_read_b128 a[212:215], v15 offset:4096
 v_add_f32 v28, v28, v160
 v_mfma_f32_16x16x32_bf16 v[144:147], a[196:199], v[88:91], v[144:147]
 v_exp_f32 v162, v162
 v_mfma_f32_16x16x32_bf16 v[152:155], a[196:199], v[92:95], v[236:239]
 v_add_f32 v28, v28, v161
 v_cvt_pk_bf16_f32 v208, v160, v161
 v_mfma_f32_16x16x32_bf16 v[152:155], a[192:195], v[76:79], v[152:155]
 s_waitcnt lgkmcnt(2)
 v_exp_f32 v163, v163
 v_mfma_f32_16x16x32_bf16 v[152:155], a[200:203], v[108:111], v[152:155]
 ds_read_b128 a[216:219], v16 offset:4096
 s_add_u32 s54, s39, 81920
 v_add_f32 v28, v28, v162
 v_mfma_f32_16x16x32_bf16 v[152:155], a[204:207], v[124:127], v[152:155]
 s_add_u32 m0, s40, 81920
 v_exp_f32 v164, v164
 v_mfma_f32_16x16x32_bf16 v[144:147], a[204:207], v[120:123], v[144:147]
 buffer_load_dwordx4 v12, s[28:31], s54 offen lds
 v_add_f32 v28, v28, v163
 v_cvt_pk_bf16_f32 v209, v162, v163
 v_mfma_f32_16x16x32_bf16 v[144:147], a[200:203], v[104:107], v[144:147]
 v_exp_f32 v165, v165
 v_mfma_f32_16x16x32_bf16 v[136:139], a[200:203], v[100:103], v[136:139]
 ds_read_b128 a[220:223], v17 offset:4096
 v_add_f32 v28, v28, v164
 v_mfma_f32_16x16x32_bf16 v[136:139], a[204:207], v[116:119], v[136:139]
 v_exp_f32 v166, v166
 v_mfma_f32_16x16x32_bf16 v[128:131], a[204:207], v[112:115], v[128:131]
 buffer_load_dwordx4 v13, s[28:31], s54 offen offset:1024 lds
 v_add_f32 v28, v28, v165
 v_cvt_pk_bf16_f32 v210, v164, v165
 v_mfma_f32_16x16x32_bf16 v[128:131], a[200:203], v[96:99], v[128:131]
 s_waitcnt lgkmcnt(2)
 v_exp_f32 v167, v167
 v_mfma_f32_16x16x32_bf16 v[132:135], a[208:211], v[64:67], v[224:227]
 ds_read_b64_tr_b16 a[224:225], v18 offset:49152
 v_add_f32 v28, v28, v166
 v_mfma_f32_16x16x32_bf16 v[132:135], a[212:215], v[80:83], v[132:135]
 ds_read_b64_tr_b16 a[226:227], v18 offset:53248
 v_exp_f32 v168, v168
 v_mfma_f32_16x16x32_bf16 v[140:143], a[212:215], v[84:87], v[228:231]
 v_add_f32 v28, v28, v167
 v_cvt_pk_bf16_f32 v211, v166, v167
 v_mfma_f32_16x16x32_bf16 v[140:143], a[208:211], v[68:71], v[140:143]
 v_exp_f32 v169, v169
 v_mfma_f32_16x16x32_bf16 v[148:151], a[208:211], v[72:75], v[232:235]
 ds_read_b64_tr_b16 a[228:229], v19 offset:49152
 buffer_load_dwordx4 v12, s[28:31], s54 offen offset:2048 lds
 v_add_f32 v29, v29, v168
 v_mfma_f32_16x16x32_bf16 v[148:151], a[212:215], v[88:91], v[148:151]
 ds_read_b64_tr_b16 a[230:231], v19 offset:53248
 v_exp_f32 v170, v170
 v_mfma_f32_16x16x32_bf16 v[156:159], a[212:215], v[92:95], v[236:239]
 v_add_f32 v29, v29, v169
 v_cvt_pk_bf16_f32 v212, v168, v169
 v_mfma_f32_16x16x32_bf16 v[156:159], a[208:211], v[76:79], v[156:159]
 s_waitcnt lgkmcnt(4)
 v_exp_f32 v171, v171
 v_mfma_f32_16x16x32_bf16 v[156:159], a[216:219], v[108:111], v[156:159]
 ds_read_b64_tr_b16 a[232:233], v20 offset:49152
 v_add_f32 v29, v29, v170
 v_mfma_f32_16x16x32_bf16 v[156:159], a[220:223], v[124:127], v[156:159]
 ds_read_b64_tr_b16 a[234:235], v20 offset:53248
 v_exp_f32 v172, v172
 v_mfma_f32_16x16x32_bf16 v[148:151], a[220:223], v[120:123], v[148:151]
 buffer_load_dwordx4 v13, s[28:31], s54 offen offset:3072 lds
 v_add_f32 v29, v29, v171
 v_cvt_pk_bf16_f32 v213, v170, v171
 v_mfma_f32_16x16x32_bf16 v[148:151], a[216:219], v[104:107], v[148:151]
 v_exp_f32 v173, v173
 v_mfma_f32_16x16x32_bf16 v[140:143], a[216:219], v[100:103], v[140:143]
 ds_read_b64_tr_b16 a[236:237], v21 offset:49152
 v_add_f32 v29, v29, v172
 v_mfma_f32_16x16x32_bf16 v[140:143], a[220:223], v[116:119], v[140:143]
 ds_read_b64_tr_b16 a[238:239], v21 offset:53248
 v_exp_f32 v174, v174
 v_mfma_f32_16x16x32_bf16 v[132:135], a[220:223], v[112:115], v[132:135]
 v_add_f32 v29, v29, v173
 v_cvt_pk_bf16_f32 v214, v172, v173
 v_mfma_f32_16x16x32_bf16 v[132:135], a[216:219], v[96:99], v[132:135]
 s_waitcnt lgkmcnt(6)
 v_exp_f32 v175, v175
 v_mfma_f32_16x16x32_bf16 a[0:3], a[224:227], v[192:195], a[0:3]
 ds_read_b64_tr_b16 a[240:241], v22 offset:49152
 s_mov_b32 m0, s55
 v_add_f32 v29, v29, v174
 v_mfma_f32_16x16x32_bf16 a[4:7], a[224:227], v[196:199], a[4:7]
 ds_read_b64_tr_b16 a[242:243], v22 offset:53248
 v_exp_f32 v176, v176
 v_mfma_f32_16x16x32_bf16 a[8:11], a[224:227], v[200:203], a[8:11]
 buffer_load_dwordx4 v34, s[12:15], s44 offen lds
 s_add_u32 s44, s44, 1024
 v_add_f32 v29, v29, v175
 v_cvt_pk_bf16_f32 v215, v174, v175
 v_mfma_f32_16x16x32_bf16 a[12:15], a[224:227], v[204:207], a[12:15]
 s_waitcnt lgkmcnt(6)
 v_exp_f32 v177, v177
 v_mfma_f32_16x16x32_bf16 a[28:31], a[228:231], v[204:207], a[28:31]
 ds_read_b64_tr_b16 a[244:245], v23 offset:49152
 v_add_f32 v30, v30, v176
 v_mfma_f32_16x16x32_bf16 a[24:27], a[228:231], v[200:203], a[24:27]
 ds_read_b64_tr_b16 a[246:247], v23 offset:53248
 v_exp_f32 v178, v178
 v_mfma_f32_16x16x32_bf16 a[20:23], a[228:231], v[196:199], a[20:23]
 v_add_f32 v30, v30, v177
 v_cvt_pk_bf16_f32 v216, v176, v177
 v_mfma_f32_16x16x32_bf16 a[16:19], a[228:231], v[192:195], a[16:19]
 s_waitcnt lgkmcnt(6)
 v_exp_f32 v179, v179
 v_mfma_f32_16x16x32_bf16 a[32:35], a[232:235], v[192:195], a[32:35]
 ds_read_b64_tr_b16 a[248:249], v24 offset:49152
 buffer_load_dwordx4 v33, s[8:11], s44 offen lds
 v_add_f32 v30, v30, v178
 v_mfma_f32_16x16x32_bf16 a[36:39], a[232:235], v[196:199], a[36:39]
 ds_read_b64_tr_b16 a[250:251], v24 offset:53248
 v_exp_f32 v180, v180
 v_mfma_f32_16x16x32_bf16 a[40:43], a[232:235], v[200:203], a[40:43]
 v_add_f32 v30, v30, v179
 v_cvt_pk_bf16_f32 v217, v178, v179
 v_mfma_f32_16x16x32_bf16 a[44:47], a[232:235], v[204:207], a[44:47]
 s_waitcnt lgkmcnt(6)
 v_exp_f32 v181, v181
 v_mfma_f32_16x16x32_bf16 a[60:63], a[236:239], v[204:207], a[60:63]
 ds_read_b64_tr_b16 a[252:253], v25 offset:49152
 v_add_f32 v30, v30, v180
 v_mfma_f32_16x16x32_bf16 a[56:59], a[236:239], v[200:203], a[56:59]
 ds_read_b64_tr_b16 a[254:255], v25 offset:53248
 v_exp_f32 v182, v182
 v_mfma_f32_16x16x32_bf16 a[52:55], a[236:239], v[196:199], a[52:55]
 v_add_f32 v30, v30, v181
 v_cvt_pk_bf16_f32 v218, v180, v181
 v_mfma_f32_16x16x32_bf16 a[48:51], a[236:239], v[192:195], a[48:51]
 s_waitcnt lgkmcnt(6)
 v_exp_f32 v183, v183
 v_mfma_f32_16x16x32_bf16 a[64:67], a[240:243], v[192:195], a[64:67]
 ds_read_b128 a[192:195], v14 offset:8192
 buffer_load_dwordx4 v34, s[12:15], s44 offen lds
 v_add_f32 v30, v30, v182
 v_mfma_f32_16x16x32_bf16 a[68:71], a[240:243], v[196:199], a[68:71]
 s_add_u32 s44, s44, 1024
 v_exp_f32 v184, v184
 v_mfma_f32_16x16x32_bf16 a[72:75], a[240:243], v[200:203], a[72:75]
 v_add_f32 v30, v30, v183
 v_cvt_pk_bf16_f32 v219, v182, v183
 v_mfma_f32_16x16x32_bf16 a[76:79], a[240:243], v[204:207], a[76:79]
 s_waitcnt lgkmcnt(5)
 v_exp_f32 v185, v185
 v_mfma_f32_16x16x32_bf16 a[92:95], a[244:247], v[204:207], a[92:95]
 ds_read_b128 a[196:199], v15 offset:8192
 v_add_f32 v31, v31, v184
 v_mfma_f32_16x16x32_bf16 a[88:91], a[244:247], v[200:203], a[88:91]
 v_exp_f32 v186, v186
 v_mfma_f32_16x16x32_bf16 a[84:87], a[244:247], v[196:199], a[84:87]
 buffer_load_dword v61, v0, s[60:63], 0 offen
 v_add_f32 v31, v31, v185
 v_cvt_pk_bf16_f32 v220, v184, v185
 v_mfma_f32_16x16x32_bf16 a[80:83], a[244:247], v[192:195], a[80:83]
 s_waitcnt lgkmcnt(4)
 v_exp_f32 v187, v187
 v_mfma_f32_16x16x32_bf16 a[96:99], a[248:251], v[192:195], a[96:99]
 ds_read_b128 a[200:203], v16 offset:8192
 v_add_f32 v31, v31, v186
 v_lshlrev_b32 v36, 8, v36
 v_mfma_f32_16x16x32_bf16 a[100:103], a[248:251], v[196:199], a[100:103]
 v_exp_f32 v188, v188
 v_mfma_f32_16x16x32_bf16 a[104:107], a[248:251], v[200:203], a[104:107]
 v_add_f32 v31, v31, v187
 v_cvt_pk_bf16_f32 v221, v186, v187
 v_mfma_f32_16x16x32_bf16 a[108:111], a[248:251], v[204:207], a[108:111]
 s_waitcnt lgkmcnt(3)
 v_exp_f32 v189, v189
 v_mfma_f32_16x16x32_bf16 a[124:127], a[252:255], v[204:207], a[124:127]
 ds_read_b128 a[204:207], v17 offset:8192
 v_add_f32 v31, v31, v188
 v_and_b32 v38, 3, v1
 v_mfma_f32_16x16x32_bf16 a[120:123], a[252:255], v[200:203], a[120:123]
 v_exp_f32 v190, v190
 v_mfma_f32_16x16x32_bf16 a[116:119], a[252:255], v[196:199], a[116:119]
 v_add_f32 v31, v31, v189
 v_cvt_pk_bf16_f32 v222, v188, v189
 v_mfma_f32_16x16x32_bf16 a[112:115], a[252:255], v[192:195], a[112:115]
 s_waitcnt lgkmcnt(2)
 v_exp_f32 v191, v191
 v_mfma_f32_16x16x32_bf16 v[160:163], a[192:195], v[64:67], v[224:227]
 ds_read_b128 a[208:211], v14 offset:12288
 v_add_f32 v31, v31, v190
 v_lshl_add_u32 v36, v38, 3, v36
 v_mfma_f32_16x16x32_bf16 v[160:163], a[196:199], v[80:83], v[160:163]
 v_exp_f32 v128, v128
 v_mfma_f32_16x16x32_bf16 v[168:171], a[196:199], v[84:87], v[228:231]
 v_add_f32 v31, v31, v191
 v_cvt_pk_bf16_f32 v223, v190, v191
 v_mfma_f32_16x16x32_bf16 v[168:171], a[192:195], v[68:71], v[168:171]
 v_exp_f32 v129, v129
 v_mfma_f32_16x16x32_bf16 v[176:179], a[192:195], v[72:75], v[232:235]
 ds_read_b128 a[212:215], v15 offset:12288
 v_add_f32 v28, v28, v128
 v_xor_b32 v38, 0, v37
 v_mfma_f32_16x16x32_bf16 v[176:179], a[196:199], v[88:91], v[176:179]
 v_exp_f32 v130, v130
 v_mfma_f32_16x16x32_bf16 v[184:187], a[196:199], v[92:95], v[236:239]
 v_add_f32 v28, v28, v129
 v_cvt_pk_bf16_f32 v192, v128, v129
 v_mfma_f32_16x16x32_bf16 v[184:187], a[192:195], v[76:79], v[184:187]
 s_waitcnt lgkmcnt(2)
 v_exp_f32 v131, v131
 v_mfma_f32_16x16x32_bf16 v[184:187], a[200:203], v[108:111], v[184:187]
 ds_read_b128 a[216:219], v16 offset:12288
 v_add_f32 v28, v28, v130
 v_lshl_add_u32 v52, v38, 5, v36
 v_mfma_f32_16x16x32_bf16 v[184:187], a[204:207], v[124:127], v[184:187]
 v_exp_f32 v132, v132
 v_mfma_f32_16x16x32_bf16 v[176:179], a[204:207], v[120:123], v[176:179]
 v_add_f32 v28, v28, v131
 v_cvt_pk_bf16_f32 v193, v130, v131
 v_mfma_f32_16x16x32_bf16 v[176:179], a[200:203], v[104:107], v[176:179]
 v_exp_f32 v133, v133
 v_mfma_f32_16x16x32_bf16 v[168:171], a[200:203], v[100:103], v[168:171]
 ds_read_b128 a[220:223], v17 offset:12288
 v_add_f32 v28, v28, v132
 v_xor_b32 v38, 1, v37
 v_mfma_f32_16x16x32_bf16 v[168:171], a[204:207], v[116:119], v[168:171]
 v_exp_f32 v134, v134
 v_mfma_f32_16x16x32_bf16 v[160:163], a[204:207], v[112:115], v[160:163]
 v_add_f32 v28, v28, v133
 v_cvt_pk_bf16_f32 v194, v132, v133
 v_mfma_f32_16x16x32_bf16 v[160:163], a[200:203], v[96:99], v[160:163]
 s_waitcnt lgkmcnt(2)
 v_exp_f32 v135, v135
 v_mfma_f32_16x16x32_bf16 v[164:167], a[208:211], v[64:67], v[224:227]
 ds_read_b64_tr_b16 a[224:225], v18 offset:57344
 v_add_f32 v28, v28, v134
 v_lshl_add_u32 v53, v38, 5, v36
 v_mfma_f32_16x16x32_bf16 v[164:167], a[212:215], v[80:83], v[164:167]
 ds_read_b64_tr_b16 a[226:227], v18 offset:61440
 v_exp_f32 v136, v136
 v_mfma_f32_16x16x32_bf16 v[172:175], a[212:215], v[84:87], v[228:231]
 v_add_f32 v28, v28, v135
 v_cvt_pk_bf16_f32 v195, v134, v135
 v_mfma_f32_16x16x32_bf16 v[172:175], a[208:211], v[68:71], v[172:175]
 v_exp_f32 v137, v137
 v_mfma_f32_16x16x32_bf16 v[180:183], a[208:211], v[72:75], v[232:235]
 ds_read_b64_tr_b16 a[228:229], v19 offset:57344
 v_add_f32 v29, v29, v136
 v_xor_b32 v38, 2, v37
 v_mfma_f32_16x16x32_bf16 v[180:183], a[212:215], v[88:91], v[180:183]
 ds_read_b64_tr_b16 a[230:231], v19 offset:61440
 v_exp_f32 v138, v138
 v_mfma_f32_16x16x32_bf16 v[188:191], a[212:215], v[92:95], v[236:239]
 v_add_f32 v29, v29, v137
 v_cvt_pk_bf16_f32 v196, v136, v137
 v_mfma_f32_16x16x32_bf16 v[188:191], a[208:211], v[76:79], v[188:191]
 s_waitcnt lgkmcnt(4)
 v_exp_f32 v139, v139
 v_mfma_f32_16x16x32_bf16 v[188:191], a[216:219], v[108:111], v[188:191]
 ds_read_b64_tr_b16 a[232:233], v20 offset:57344
 v_add_f32 v29, v29, v138
 v_lshl_add_u32 v54, v38, 5, v36
 v_mfma_f32_16x16x32_bf16 v[188:191], a[220:223], v[124:127], v[188:191]
 ds_read_b64_tr_b16 a[234:235], v20 offset:61440
 v_exp_f32 v140, v140
 v_mfma_f32_16x16x32_bf16 v[180:183], a[220:223], v[120:123], v[180:183]
 v_add_f32 v29, v29, v139
 v_cvt_pk_bf16_f32 v197, v138, v139
 v_mfma_f32_16x16x32_bf16 v[180:183], a[216:219], v[104:107], v[180:183]
 v_exp_f32 v141, v141
 v_mfma_f32_16x16x32_bf16 v[172:175], a[216:219], v[100:103], v[172:175]
 ds_read_b64_tr_b16 a[236:237], v21 offset:57344
 v_add_f32 v29, v29, v140
 v_xor_b32 v38, 3, v37
 v_mfma_f32_16x16x32_bf16 v[172:175], a[220:223], v[116:119], v[172:175]
 ds_read_b64_tr_b16 a[238:239], v21 offset:61440
 v_exp_f32 v142, v142
 v_mfma_f32_16x16x32_bf16 v[164:167], a[220:223], v[112:115], v[164:167]
 v_add_f32 v29, v29, v141
 v_cvt_pk_bf16_f32 v198, v140, v141
 v_mfma_f32_16x16x32_bf16 v[164:167], a[216:219], v[96:99], v[164:167]
 s_waitcnt lgkmcnt(6)
 v_exp_f32 v143, v143
 v_mfma_f32_16x16x32_bf16 a[0:3], a[224:227], v[208:211], a[0:3]
 ds_read_b64_tr_b16 a[240:241], v22 offset:57344
 v_add_f32 v29, v29, v142
 v_lshl_add_u32 v55, v38, 5, v36
 v_mfma_f32_16x16x32_bf16 a[4:7], a[224:227], v[212:215], a[4:7]
 ds_read_b64_tr_b16 a[242:243], v22 offset:61440
 v_exp_f32 v144, v144
 v_mfma_f32_16x16x32_bf16 a[8:11], a[224:227], v[216:219], a[8:11]
 v_add_f32 v29, v29, v143
 v_cvt_pk_bf16_f32 v199, v142, v143
 v_mfma_f32_16x16x32_bf16 a[12:15], a[224:227], v[220:223], a[12:15]
 s_waitcnt lgkmcnt(6)
 v_exp_f32 v145, v145
 v_mfma_f32_16x16x32_bf16 a[28:31], a[228:231], v[220:223], a[28:31]
 ds_read_b64_tr_b16 a[244:245], v23 offset:57344
 v_add_f32 v30, v30, v144
 v_xor_b32 v38, 4, v37
 v_mfma_f32_16x16x32_bf16 a[24:27], a[228:231], v[216:219], a[24:27]
 ds_read_b64_tr_b16 a[246:247], v23 offset:61440
 v_exp_f32 v146, v146
 v_mfma_f32_16x16x32_bf16 a[20:23], a[228:231], v[212:215], a[20:23]
 v_add_f32 v30, v30, v145
 v_cvt_pk_bf16_f32 v200, v144, v145
 v_mfma_f32_16x16x32_bf16 a[16:19], a[228:231], v[208:211], a[16:19]
 s_waitcnt lgkmcnt(6)
 v_exp_f32 v147, v147
 v_mfma_f32_16x16x32_bf16 a[32:35], a[232:235], v[208:211], a[32:35]
 ds_read_b64_tr_b16 a[248:249], v24 offset:57344
 v_add_f32 v30, v30, v146
 v_lshl_add_u32 v56, v38, 5, v36
 v_mfma_f32_16x16x32_bf16 a[36:39], a[232:235], v[212:215], a[36:39]
 ds_read_b64_tr_b16 a[250:251], v24 offset:61440
 v_exp_f32 v148, v148
 v_mfma_f32_16x16x32_bf16 a[40:43], a[232:235], v[216:219], a[40:43]
 v_add_f32 v30, v30, v147
 v_cvt_pk_bf16_f32 v201, v146, v147
 v_mfma_f32_16x16x32_bf16 a[44:47], a[232:235], v[220:223], a[44:47]
 s_waitcnt lgkmcnt(6)
 v_exp_f32 v149, v149
 v_mfma_f32_16x16x32_bf16 a[60:63], a[236:239], v[220:223], a[60:63]
 ds_read_b64_tr_b16 a[252:253], v25 offset:57344
 v_add_f32 v30, v30, v148
 v_xor_b32 v38, 5, v37
 v_mfma_f32_16x16x32_bf16 a[56:59], a[236:239], v[216:219], a[56:59]
 ds_read_b64_tr_b16 a[254:255], v25 offset:61440
 v_exp_f32 v150, v150
 v_mfma_f32_16x16x32_bf16 a[52:55], a[236:239], v[212:215], a[52:55]
 v_add_f32 v30, v30, v149
 v_cvt_pk_bf16_f32 v202, v148, v149
 v_mfma_f32_16x16x32_bf16 a[48:51], a[236:239], v[208:211], a[48:51]
 s_waitcnt vmcnt(20)
 s_waitcnt vmcnt(16)
 s_barrier
 s_waitcnt lgkmcnt(6)
 v_exp_f32 v151, v151
 v_mfma_f32_16x16x32_bf16 a[64:67], a[240:243], v[208:211], a[64:67]
 ds_read_b128 a[192:195], v14 offset:16384
 v_add_f32 v30, v30, v150
 v_lshl_add_u32 v57, v38, 5, v36
 v_mfma_f32_16x16x32_bf16 a[68:71], a[240:243], v[212:215], a[68:71]
 v_exp_f32 v152, v152
 v_mfma_f32_16x16x32_bf16 a[72:75], a[240:243], v[216:219], a[72:75]
 v_add_f32 v30, v30, v151
 v_cvt_pk_bf16_f32 v203, v150, v151
 v_mfma_f32_16x16x32_bf16 a[76:79], a[240:243], v[220:223], a[76:79]
 s_waitcnt lgkmcnt(5)
 v_exp_f32 v153, v153
 v_mfma_f32_16x16x32_bf16 a[92:95], a[244:247], v[220:223], a[92:95]
 ds_read_b128 a[196:199], v15 offset:16384
 v_add_f32 v31, v31, v152
 v_xor_b32 v38, 6, v37
 v_mfma_f32_16x16x32_bf16 a[88:91], a[244:247], v[216:219], a[88:91]
 v_exp_f32 v154, v154
 v_mfma_f32_16x16x32_bf16 a[84:87], a[244:247], v[212:215], a[84:87]
 v_add_f32 v31, v31, v153
 v_cvt_pk_bf16_f32 v204, v152, v153
 v_mfma_f32_16x16x32_bf16 a[80:83], a[244:247], v[208:211], a[80:83]
 s_waitcnt lgkmcnt(4)
 v_exp_f32 v155, v155
 v_mfma_f32_16x16x32_bf16 a[96:99], a[248:251], v[208:211], a[96:99]
 ds_read_b128 a[200:203], v16 offset:16384
 v_add_f32 v31, v31, v154
 v_lshl_add_u32 v58, v38, 5, v36
 v_mfma_f32_16x16x32_bf16 a[100:103], a[248:251], v[212:215], a[100:103]
 v_exp_f32 v156, v156
 v_mfma_f32_16x16x32_bf16 a[104:107], a[248:251], v[216:219], a[104:107]
 v_add_f32 v31, v31, v155
 v_cvt_pk_bf16_f32 v205, v154, v155
 v_mfma_f32_16x16x32_bf16 a[108:111], a[248:251], v[220:223], a[108:111]
 s_waitcnt lgkmcnt(3)
 v_exp_f32 v157, v157
 v_mfma_f32_16x16x32_bf16 a[124:127], a[252:255], v[220:223], a[124:127]
 ds_read_b128 a[204:207], v17 offset:16384
 v_add_f32 v31, v31, v156
 v_xor_b32 v38, 7, v37
 v_mfma_f32_16x16x32_bf16 a[120:123], a[252:255], v[216:219], a[120:123]
 v_exp_f32 v158, v158
 v_mfma_f32_16x16x32_bf16 a[116:119], a[252:255], v[212:215], a[116:119]
 v_add_f32 v31, v31, v157
 v_cvt_pk_bf16_f32 v206, v156, v157
 v_mfma_f32_16x16x32_bf16 a[112:115], a[252:255], v[208:211], a[112:115]
 s_waitcnt lgkmcnt(2)
 v_exp_f32 v159, v159
 v_mfma_f32_16x16x32_bf16 v[128:131], a[192:195], v[64:67], v[224:227]
 ds_read_b128 a[208:211], v14 offset:20480
 v_add_f32 v31, v31, v158
 v_lshl_add_u32 v59, v38, 5, v36
 v_mfma_f32_16x16x32_bf16 v[128:131], a[196:199], v[80:83], v[128:131]
 s_mov_b32 s49, 0x10000
 s_add_u32 s54, s39, 114688
 v_exp_f32 v160, v160
 v_mfma_f32_16x16x32_bf16 v[136:139], a[196:199], v[84:87], v[228:231]
 s_add_u32 m0, s40, 49152
 v_add_f32 v31, v31, v159
 v_cvt_pk_bf16_f32 v207, v158, v159
 v_mfma_f32_16x16x32_bf16 v[136:139], a[192:195], v[68:71], v[136:139]
 buffer_load_dwordx4 v8, s[24:27], s54 offen lds
 buffer_load_dwordx4 v9, s[24:27], s54 offen offset:1024 lds
 v_exp_f32 v161, v161
 v_mfma_f32_16x16x32_bf16 v[144:147], a[192:195], v[72:75], v[232:235]
 ds_read_b128 a[212:215], v15 offset:20480
 buffer_load_dwordx4 v10, s[24:27], s54 offen offset:2048 lds
 v_add_f32 v28, v28, v160
 v_mfma_f32_16x16x32_bf16 v[144:147], a[196:199], v[88:91], v[144:147]
 buffer_load_dwordx4 v11, s[24:27], s54 offen offset:3072 lds
 v_exp_f32 v162, v162
 v_mfma_f32_16x16x32_bf16 v[152:155], a[196:199], v[92:95], v[236:239]
 v_add_f32 v28, v28, v161
 v_cvt_pk_bf16_f32 v208, v160, v161
 v_mfma_f32_16x16x32_bf16 v[152:155], a[192:195], v[76:79], v[152:155]
 s_waitcnt lgkmcnt(2)
 v_exp_f32 v163, v163
 v_mfma_f32_16x16x32_bf16 v[152:155], a[200:203], v[108:111], v[152:155]
 ds_read_b128 a[216:219], v16 offset:20480
 s_add_u32 s54, s39, 98304
 v_add_f32 v28, v28, v162
 v_mfma_f32_16x16x32_bf16 v[152:155], a[204:207], v[124:127], v[152:155]
 s_add_u32 m0, s40, 98304
 v_exp_f32 v164, v164
 v_mfma_f32_16x16x32_bf16 v[144:147], a[204:207], v[120:123], v[144:147]
 buffer_load_dwordx4 v12, s[28:31], s54 offen lds
 v_add_f32 v28, v28, v163
 v_cvt_pk_bf16_f32 v209, v162, v163
 v_mfma_f32_16x16x32_bf16 v[144:147], a[200:203], v[104:107], v[144:147]
 v_exp_f32 v165, v165
 v_mfma_f32_16x16x32_bf16 v[136:139], a[200:203], v[100:103], v[136:139]
 ds_read_b128 a[220:223], v17 offset:20480
 v_add_f32 v28, v28, v164
 v_mfma_f32_16x16x32_bf16 v[136:139], a[204:207], v[116:119], v[136:139]
 v_exp_f32 v166, v166
 v_mfma_f32_16x16x32_bf16 v[128:131], a[204:207], v[112:115], v[128:131]
 buffer_load_dwordx4 v13, s[28:31], s54 offen offset:1024 lds
 v_add_f32 v28, v28, v165
 v_cvt_pk_bf16_f32 v210, v164, v165
 v_mfma_f32_16x16x32_bf16 v[128:131], a[200:203], v[96:99], v[128:131]
 s_waitcnt lgkmcnt(2)
 v_exp_f32 v167, v167
 v_mfma_f32_16x16x32_bf16 v[132:135], a[208:211], v[64:67], v[224:227]
 ds_read_b64_tr_b16 a[224:225], v18
 v_add_f32 v28, v28, v166
 v_mfma_f32_16x16x32_bf16 v[132:135], a[212:215], v[80:83], v[132:135]
 ds_read_b64_tr_b16 a[226:227], v18 offset:4096
 v_exp_f32 v168, v168
 v_mfma_f32_16x16x32_bf16 v[140:143], a[212:215], v[84:87], v[228:231]
 v_add_f32 v28, v28, v167
 v_cvt_pk_bf16_f32 v211, v166, v167
 v_mfma_f32_16x16x32_bf16 v[140:143], a[208:211], v[68:71], v[140:143]
 v_exp_f32 v169, v169
 v_mfma_f32_16x16x32_bf16 v[148:151], a[208:211], v[72:75], v[232:235]
 ds_read_b64_tr_b16 a[228:229], v19
 buffer_load_dwordx4 v12, s[28:31], s54 offen offset:2048 lds
 v_add_f32 v29, v29, v168
 v_mfma_f32_16x16x32_bf16 v[148:151], a[212:215], v[88:91], v[148:151]
 ds_read_b64_tr_b16 a[230:231], v19 offset:4096
 v_exp_f32 v170, v170
 v_mfma_f32_16x16x32_bf16 v[156:159], a[212:215], v[92:95], v[236:239]
 v_add_f32 v29, v29, v169
 v_cvt_pk_bf16_f32 v212, v168, v169
 v_mfma_f32_16x16x32_bf16 v[156:159], a[208:211], v[76:79], v[156:159]
 s_waitcnt lgkmcnt(4)
 v_exp_f32 v171, v171
 v_mfma_f32_16x16x32_bf16 v[156:159], a[216:219], v[108:111], v[156:159]
 ds_read_b64_tr_b16 a[232:233], v20
 v_add_f32 v29, v29, v170
 v_mfma_f32_16x16x32_bf16 v[156:159], a[220:223], v[124:127], v[156:159]
 ds_read_b64_tr_b16 a[234:235], v20 offset:4096
 v_exp_f32 v172, v172
 v_mfma_f32_16x16x32_bf16 v[148:151], a[220:223], v[120:123], v[148:151]
 buffer_load_dwordx4 v13, s[28:31], s54 offen offset:3072 lds
 v_add_f32 v29, v29, v171
 v_cvt_pk_bf16_f32 v213, v170, v171
 v_mfma_f32_16x16x32_bf16 v[148:151], a[216:219], v[104:107], v[148:151]
 v_exp_f32 v173, v173
 v_mfma_f32_16x16x32_bf16 v[140:143], a[216:219], v[100:103], v[140:143]
 ds_read_b64_tr_b16 a[236:237], v21
 v_add_f32 v29, v29, v172
 v_mfma_f32_16x16x32_bf16 v[140:143], a[220:223], v[116:119], v[140:143]
 ds_read_b64_tr_b16 a[238:239], v21 offset:4096
 v_exp_f32 v174, v174
 v_mfma_f32_16x16x32_bf16 v[132:135], a[220:223], v[112:115], v[132:135]
 v_add_f32 v29, v29, v173
 v_cvt_pk_bf16_f32 v214, v172, v173
 v_mfma_f32_16x16x32_bf16 v[132:135], a[216:219], v[96:99], v[132:135]
 s_waitcnt lgkmcnt(6)
 v_exp_f32 v175, v175
 v_mfma_f32_16x16x32_bf16 a[0:3], a[224:227], v[192:195], a[0:3]
 ds_read_b64_tr_b16 a[240:241], v22
 s_mov_b32 m0, s55
 v_add_f32 v29, v29, v174
 v_mfma_f32_16x16x32_bf16 a[4:7], a[224:227], v[196:199], a[4:7]
 ds_read_b64_tr_b16 a[242:243], v22 offset:4096
 v_exp_f32 v176, v176
 v_mfma_f32_16x16x32_bf16 a[8:11], a[224:227], v[200:203], a[8:11]
 buffer_load_dwordx4 v33, s[8:11], s44 offen lds
 v_add_f32 v29, v29, v175
 v_cvt_pk_bf16_f32 v215, v174, v175
 v_mfma_f32_16x16x32_bf16 a[12:15], a[224:227], v[204:207], a[12:15]
 s_waitcnt lgkmcnt(6)
 v_exp_f32 v177, v177
 v_mfma_f32_16x16x32_bf16 a[28:31], a[228:231], v[204:207], a[28:31]
 ds_read_b64_tr_b16 a[244:245], v23
 v_add_f32 v30, v30, v176
 v_mfma_f32_16x16x32_bf16 a[24:27], a[228:231], v[200:203], a[24:27]
 ds_read_b64_tr_b16 a[246:247], v23 offset:4096
 v_exp_f32 v178, v178
 v_mfma_f32_16x16x32_bf16 a[20:23], a[228:231], v[196:199], a[20:23]
 v_add_f32 v30, v30, v177
 v_cvt_pk_bf16_f32 v216, v176, v177
 v_mfma_f32_16x16x32_bf16 a[16:19], a[228:231], v[192:195], a[16:19]
 s_waitcnt lgkmcnt(6)
 v_exp_f32 v179, v179
 v_mfma_f32_16x16x32_bf16 a[32:35], a[232:235], v[192:195], a[32:35]
 ds_read_b64_tr_b16 a[248:249], v24
 buffer_load_dwordx4 v34, s[12:15], s44 offen lds
 v_add_f32 v30, v30, v178
 v_mfma_f32_16x16x32_bf16 a[36:39], a[232:235], v[196:199], a[36:39]
 ds_read_b64_tr_b16 a[250:251], v24 offset:4096
 s_add_u32 s44, s44, 1024
 v_exp_f32 v180, v180
 v_mfma_f32_16x16x32_bf16 a[40:43], a[232:235], v[200:203], a[40:43]
 v_add_f32 v30, v30, v179
 v_cvt_pk_bf16_f32 v217, v178, v179
 v_mfma_f32_16x16x32_bf16 a[44:47], a[232:235], v[204:207], a[44:47]
 s_waitcnt lgkmcnt(6)
 v_exp_f32 v181, v181
 v_mfma_f32_16x16x32_bf16 a[60:63], a[236:239], v[204:207], a[60:63]
 ds_read_b64_tr_b16 a[252:253], v25
 v_add_f32 v30, v30, v180
 v_mfma_f32_16x16x32_bf16 a[56:59], a[236:239], v[200:203], a[56:59]
 ds_read_b64_tr_b16 a[254:255], v25 offset:4096
 v_exp_f32 v182, v182
 v_mfma_f32_16x16x32_bf16 a[52:55], a[236:239], v[196:199], a[52:55]
 v_add_f32 v30, v30, v181
 v_cvt_pk_bf16_f32 v218, v180, v181
 v_mfma_f32_16x16x32_bf16 a[48:51], a[236:239], v[192:195], a[48:51]
 s_waitcnt lgkmcnt(6)
 v_exp_f32 v183, v183
 v_mfma_f32_16x16x32_bf16 a[64:67], a[240:243], v[192:195], a[64:67]
 ds_read_b128 a[192:195], v14 offset:24576
 buffer_load_dwordx4 v33, s[8:11], s44 offen lds
 v_add_f32 v30, v30, v182
 v_mfma_f32_16x16x32_bf16 a[68:71], a[240:243], v[196:199], a[68:71]
 v_exp_f32 v184, v184
 v_mfma_f32_16x16x32_bf16 a[72:75], a[240:243], v[200:203], a[72:75]
 v_add_f32 v30, v30, v183
 v_cvt_pk_bf16_f32 v219, v182, v183
 v_mfma_f32_16x16x32_bf16 a[76:79], a[240:243], v[204:207], a[76:79]
 s_waitcnt lgkmcnt(5)
 v_exp_f32 v185, v185
 v_mfma_f32_16x16x32_bf16 a[92:95], a[244:247], v[204:207], a[92:95]
 ds_read_b128 a[196:199], v15 offset:24576
 v_add_f32 v31, v31, v184
 v_mfma_f32_16x16x32_bf16 a[88:91], a[244:247], v[200:203], a[88:91]
 v_exp_f32 v186, v186
 v_mfma_f32_16x16x32_bf16 a[84:87], a[244:247], v[196:199], a[84:87]
 buffer_load_dword v61, v0, s[60:63], 0 offen
 v_add_f32 v31, v31, v185
 v_cvt_pk_bf16_f32 v220, v184, v185
 v_mfma_f32_16x16x32_bf16 a[80:83], a[244:247], v[192:195], a[80:83]
 s_waitcnt lgkmcnt(4)
 v_exp_f32 v187, v187
 v_mfma_f32_16x16x32_bf16 a[96:99], a[248:251], v[192:195], a[96:99]
 ds_read_b128 a[200:203], v16 offset:24576
 s_lshl_b32 s52, s71, 8
 v_add_f32 v31, v31, v186
 v_mfma_f32_16x16x32_bf16 a[100:103], a[248:251], v[196:199], a[100:103]
 s_lshl_b32 s53, s36, 6
 v_exp_f32 v188, v188
 v_mfma_f32_16x16x32_bf16 a[104:107], a[248:251], v[200:203], a[104:107]
 s_add_u32 s52, s52, s53
 v_add_f32 v31, v31, v187
 v_cvt_pk_bf16_f32 v221, v186, v187
 v_mfma_f32_16x16x32_bf16 a[108:111], a[248:251], v[204:207], a[108:111]
 s_and_b32 s53, s70, 1
 s_waitcnt lgkmcnt(3)
 v_exp_f32 v189, v189
 v_mfma_f32_16x16x32_bf16 a[124:127], a[252:255], v[204:207], a[124:127]
 ds_read_b128 a[204:207], v17 offset:24576
 s_lshl_b32 s53, s53, 5
 v_add_f32 v31, v31, v188
 v_mfma_f32_16x16x32_bf16 a[120:123], a[252:255], v[200:203], a[120:123]
 s_add_u32 s52, s52, s53
 v_exp_f32 v190, v190
 v_mfma_f32_16x16x32_bf16 a[116:119], a[252:255], v[196:199], a[116:119]
 s_lshl_b32 s52, s52, 11
 v_add_f32 v31, v31, v189
 v_cvt_pk_bf16_f32 v222, v188, v189
 v_mfma_f32_16x16x32_bf16 a[112:115], a[252:255], v[192:195], a[112:115]
 s_waitcnt lgkmcnt(2)
 s_lshl_b32 s53, s76, 8
 v_exp_f32 v191, v191
 v_mfma_f32_16x16x32_bf16 v[160:163], a[192:195], v[64:67], v[224:227]
 ds_read_b128 a[208:211], v14 offset:28672
 s_add_u32 s52, s52, s53
 v_add_f32 v31, v31, v190
 v_mfma_f32_16x16x32_bf16 v[160:163], a[196:199], v[80:83], v[160:163]
 buffer_load_dwordx2 v[62:63], v60, s[56:59], 0 offen sc1
 s_lshr_b32 s53, s70, 1
 v_exp_f32 v128, v128
 v_mfma_f32_16x16x32_bf16 v[168:171], a[196:199], v[84:87], v[228:231]
 s_lshl_b32 s53, s53, 7
 v_add_f32 v31, v31, v191
 v_cvt_pk_bf16_f32 v223, v190, v191
 v_mfma_f32_16x16x32_bf16 v[168:171], a[192:195], v[68:71], v[168:171]
 s_add_u32 s52, s52, s53
 v_exp_f32 v129, v129
 v_mfma_f32_16x16x32_bf16 v[176:179], a[192:195], v[72:75], v[232:235]
 ds_read_b128 a[212:215], v15 offset:28672
 v_add_f32 v28, v28, v128
 v_and_b32 v36, 7, v1
 v_mfma_f32_16x16x32_bf16 v[176:179], a[196:199], v[88:91], v[176:179]
 v_exp_f32 v130, v130
 v_mfma_f32_16x16x32_bf16 v[184:187], a[196:199], v[92:95], v[236:239]
 v_add_f32 v28, v28, v129
 v_cvt_pk_bf16_f32 v192, v128, v129
 v_mfma_f32_16x16x32_bf16 v[184:187], a[192:195], v[76:79], v[184:187]
 s_waitcnt lgkmcnt(2)
 v_exp_f32 v131, v131
 v_mfma_f32_16x16x32_bf16 v[184:187], a[200:203], v[108:111], v[184:187]
 ds_read_b128 a[216:219], v16 offset:28672
 v_add_f32 v28, v28, v130
 v_lshlrev_b32 v36, 11, v36
 v_mfma_f32_16x16x32_bf16 v[184:187], a[204:207], v[124:127], v[184:187]
 v_exp_f32 v132, v132
 v_mfma_f32_16x16x32_bf16 v[176:179], a[204:207], v[120:123], v[176:179]
 v_add_f32 v28, v28, v131
 v_cvt_pk_bf16_f32 v193, v130, v131
 v_mfma_f32_16x16x32_bf16 v[176:179], a[200:203], v[104:107], v[176:179]
 v_exp_f32 v133, v133
 v_mfma_f32_16x16x32_bf16 v[168:171], a[200:203], v[100:103], v[168:171]
 ds_read_b128 a[220:223], v17 offset:28672
 v_add_f32 v28, v28, v132
 v_bfe_u32 v37, v1, 3, 1
 v_mfma_f32_16x16x32_bf16 v[168:171], a[204:207], v[116:119], v[168:171]
 v_exp_f32 v134, v134
 v_mfma_f32_16x16x32_bf16 v[160:163], a[204:207], v[112:115], v[160:163]
 v_add_f32 v28, v28, v133
 v_cvt_pk_bf16_f32 v194, v132, v133
 v_mfma_f32_16x16x32_bf16 v[160:163], a[200:203], v[96:99], v[160:163]
 s_waitcnt lgkmcnt(2)
 v_exp_f32 v135, v135
 v_mfma_f32_16x16x32_bf16 v[164:167], a[208:211], v[64:67], v[224:227]
 ds_read_b64_tr_b16 a[224:225], v18 offset:8192
 v_add_f32 v28, v28, v134
 v_lshl_add_u32 v36, v37, 6, v36
 v_mfma_f32_16x16x32_bf16 v[164:167], a[212:215], v[80:83], v[164:167]
 ds_read_b64_tr_b16 a[226:227], v18 offset:12288
 v_exp_f32 v136, v136
 v_mfma_f32_16x16x32_bf16 v[172:175], a[212:215], v[84:87], v[228:231]
 v_add_f32 v28, v28, v135
 v_cvt_pk_bf16_f32 v195, v134, v135
 v_mfma_f32_16x16x32_bf16 v[172:175], a[208:211], v[68:71], v[172:175]
 v_exp_f32 v137, v137
 v_mfma_f32_16x16x32_bf16 v[180:183], a[208:211], v[72:75], v[232:235]
 ds_read_b64_tr_b16 a[228:229], v19 offset:8192
 v_add_f32 v29, v29, v136
 v_bfe_u32 v37, v1, 4, 1
 v_mfma_f32_16x16x32_bf16 v[180:183], a[212:215], v[88:91], v[180:183]
 ds_read_b64_tr_b16 a[230:231], v19 offset:12288
 v_exp_f32 v138, v138
 v_mfma_f32_16x16x32_bf16 v[188:191], a[212:215], v[92:95], v[236:239]
 v_add_f32 v29, v29, v137
 v_cvt_pk_bf16_f32 v196, v136, v137
 v_mfma_f32_16x16x32_bf16 v[188:191], a[208:211], v[76:79], v[188:191]
 s_waitcnt lgkmcnt(4)
 v_exp_f32 v139, v139
 v_mfma_f32_16x16x32_bf16 v[188:191], a[216:219], v[108:111], v[188:191]
 ds_read_b64_tr_b16 a[232:233], v20 offset:8192
 v_add_f32 v29, v29, v138
 v_lshl_add_u32 v36, v37, 5, v36
 v_mfma_f32_16x16x32_bf16 v[188:191], a[220:223], v[124:127], v[188:191]
 ds_read_b64_tr_b16 a[234:235], v20 offset:12288
 v_exp_f32 v140, v140
 v_mfma_f32_16x16x32_bf16 v[180:183], a[220:223], v[120:123], v[180:183]
 v_add_f32 v29, v29, v139
 v_cvt_pk_bf16_f32 v197, v138, v139
 v_mfma_f32_16x16x32_bf16 v[180:183], a[216:219], v[104:107], v[180:183]
 v_exp_f32 v141, v141
 v_mfma_f32_16x16x32_bf16 v[172:175], a[216:219], v[100:103], v[172:175]
 ds_read_b64_tr_b16 a[236:237], v21 offset:8192
 v_add_f32 v29, v29, v140
 v_lshrrev_b32 v37, 5, v1
 v_mfma_f32_16x16x32_bf16 v[172:175], a[220:223], v[116:119], v[172:175]
 ds_read_b64_tr_b16 a[238:239], v21 offset:12288
 v_exp_f32 v142, v142
 v_mfma_f32_16x16x32_bf16 v[164:167], a[220:223], v[112:115], v[164:167]
 v_add_f32 v29, v29, v141
 v_cvt_pk_bf16_f32 v198, v140, v141
 v_mfma_f32_16x16x32_bf16 v[164:167], a[216:219], v[96:99], v[164:167]
 s_waitcnt lgkmcnt(6)
 v_exp_f32 v143, v143
 v_mfma_f32_16x16x32_bf16 a[0:3], a[224:227], v[208:211], a[0:3]
 ds_read_b64_tr_b16 a[240:241], v22 offset:8192
 v_add_f32 v29, v29, v142
 v_lshl_add_u32 v36, v37, 4, v36
 v_mfma_f32_16x16x32_bf16 a[4:7], a[224:227], v[212:215], a[4:7]
 ds_read_b64_tr_b16 a[242:243], v22 offset:12288
 v_exp_f32 v144, v144
 v_mfma_f32_16x16x32_bf16 a[8:11], a[224:227], v[216:219], a[8:11]
 v_add_f32 v29, v29, v143
 v_cvt_pk_bf16_f32 v199, v142, v143
 v_mfma_f32_16x16x32_bf16 a[12:15], a[224:227], v[220:223], a[12:15]
 s_waitcnt lgkmcnt(6)
 v_exp_f32 v145, v145
 v_mfma_f32_16x16x32_bf16 a[28:31], a[228:231], v[220:223], a[28:31]
 ds_read_b64_tr_b16 a[244:245], v23 offset:8192
 v_add_f32 v30, v30, v144
 v_add_u32 v39, s52, v36
 v_mfma_f32_16x16x32_bf16 a[24:27], a[228:231], v[216:219], a[24:27]
 ds_read_b64_tr_b16 a[246:247], v23 offset:12288
 s_mov_b32 s20, s64
 v_exp_f32 v146, v146
 v_mfma_f32_16x16x32_bf16 a[20:23], a[228:231], v[212:215], a[20:23]
 s_mov_b32 s21, s65
 s_mov_b32 s22, 0x400000
 v_add_f32 v30, v30, v145
 v_cvt_pk_bf16_f32 v200, v144, v145
 v_mfma_f32_16x16x32_bf16 a[16:19], a[228:231], v[208:211], a[16:19]
 s_mov_b32 s23, 0x20000
 s_waitcnt lgkmcnt(6)
 v_exp_f32 v147, v147
 v_mfma_f32_16x16x32_bf16 a[32:35], a[232:235], v[208:211], a[32:35]
 ds_read_b64_tr_b16 a[248:249], v24 offset:8192
 s_add_u32 m0, s55, 4096
 v_add_f32 v30, v30, v146
 v_mfma_f32_16x16x32_bf16 a[36:39], a[232:235], v[212:215], a[36:39]
 ds_read_b64_tr_b16 a[250:251], v24 offset:12288
 s_mov_b32 s52, 0
 v_exp_f32 v148, v148
 v_mfma_f32_16x16x32_bf16 a[40:43], a[232:235], v[216:219], a[40:43]
 buffer_load_dwordx4 v39, s[20:23], s52 offen lds
 s_add_u32 m0, s55, 5120
 v_add_f32 v30, v30, v147
 v_cvt_pk_bf16_f32 v201, v146, v147
 v_mfma_f32_16x16x32_bf16 a[44:47], a[232:235], v[220:223], a[44:47]
 s_mov_b32 s52, 16384
 s_waitcnt lgkmcnt(6)
 v_exp_f32 v149, v149
 v_mfma_f32_16x16x32_bf16 a[60:63], a[236:239], v[220:223], a[60:63]
 ds_read_b64_tr_b16 a[252:253], v25 offset:8192
 buffer_load_dwordx4 v39, s[20:23], s52 offen lds
 v_add_f32 v30, v30, v148
 v_mfma_f32_16x16x32_bf16 a[56:59], a[236:239], v[216:219], a[56:59]
 ds_read_b64_tr_b16 a[254:255], v25 offset:12288
 s_add_u32 m0, s55, 6144
 v_exp_f32 v150, v150
 v_mfma_f32_16x16x32_bf16 a[52:55], a[236:239], v[212:215], a[52:55]
 s_mov_b32 s52, 32768
 buffer_load_dwordx4 v39, s[20:23], s52 offen lds
 v_add_f32 v30, v30, v149
 v_cvt_pk_bf16_f32 v202, v148, v149
 v_mfma_f32_16x16x32_bf16 a[48:51], a[236:239], v[208:211], a[48:51]
 s_waitcnt vmcnt(24)
 s_waitcnt vmcnt(20)
 s_barrier
 s_waitcnt lgkmcnt(6)
 v_exp_f32 v151, v151
 v_mfma_f32_16x16x32_bf16 a[64:67], a[240:243], v[208:211], a[64:67]
 ds_read_b128 a[192:195], v14 offset:32768
 s_add_u32 m0, s55, 7168
 v_add_f32 v30, v30, v150
 v_mfma_f32_16x16x32_bf16 a[68:71], a[240:243], v[212:215], a[68:71]
 s_mov_b32 s52, 49152
 buffer_load_dwordx4 v39, s[20:23], s52 offen lds
 v_exp_f32 v152, v152
 v_mfma_f32_16x16x32_bf16 a[72:75], a[240:243], v[216:219], a[72:75]
 v_add_f32 v30, v30, v151
 v_cvt_pk_bf16_f32 v203, v150, v151
 v_mfma_f32_16x16x32_bf16 a[76:79], a[240:243], v[220:223], a[76:79]
 s_waitcnt lgkmcnt(5)
 v_exp_f32 v153, v153
 v_mfma_f32_16x16x32_bf16 a[92:95], a[244:247], v[220:223], a[92:95]
 ds_read_b128 a[196:199], v15 offset:32768
 v_add_f32 v31, v31, v152
 v_mfma_f32_16x16x32_bf16 a[88:91], a[244:247], v[216:219], a[88:91]
 v_exp_f32 v154, v154
 v_mfma_f32_16x16x32_bf16 a[84:87], a[244:247], v[212:215], a[84:87]
 v_add_f32 v31, v31, v153
 v_cvt_pk_bf16_f32 v204, v152, v153
 v_mfma_f32_16x16x32_bf16 a[80:83], a[244:247], v[208:211], a[80:83]
 s_waitcnt lgkmcnt(4)
 v_exp_f32 v155, v155
 v_mfma_f32_16x16x32_bf16 a[96:99], a[248:251], v[208:211], a[96:99]
 ds_read_b128 a[200:203], v16 offset:32768
 v_add_f32 v31, v31, v154
 v_mfma_f32_16x16x32_bf16 a[100:103], a[248:251], v[212:215], a[100:103]
 v_exp_f32 v156, v156
 v_mfma_f32_16x16x32_bf16 a[104:107], a[248:251], v[216:219], a[104:107]
 v_add_f32 v31, v31, v155
 v_cvt_pk_bf16_f32 v205, v154, v155
 v_mfma_f32_16x16x32_bf16 a[108:111], a[248:251], v[220:223], a[108:111]
 s_waitcnt lgkmcnt(3)
 v_exp_f32 v157, v157
 v_mfma_f32_16x16x32_bf16 a[124:127], a[252:255], v[220:223], a[124:127]
 ds_read_b128 a[204:207], v17 offset:32768
 v_add_f32 v31, v31, v156
 v_mfma_f32_16x16x32_bf16 a[120:123], a[252:255], v[216:219], a[120:123]
 v_exp_f32 v158, v158
 v_mfma_f32_16x16x32_bf16 a[116:119], a[252:255], v[212:215], a[116:119]
 v_add_f32 v31, v31, v157
 v_cvt_pk_bf16_f32 v206, v156, v157
 v_mfma_f32_16x16x32_bf16 a[112:115], a[252:255], v[208:211], a[112:115]
 s_waitcnt lgkmcnt(2)
 v_exp_f32 v159, v159
 v_mfma_f32_16x16x32_bf16 v[128:131], a[192:195], v[64:67], v[224:227]
 ds_read_b128 a[208:211], v14 offset:36864
 v_add_f32 v31, v31, v158
 v_mfma_f32_16x16x32_bf16 v[128:131], a[196:199], v[80:83], v[128:131]
 v_exp_f32 v160, v160
 v_mfma_f32_16x16x32_bf16 v[136:139], a[196:199], v[84:87], v[228:231]
 v_add_f32 v31, v31, v159
 v_cvt_pk_bf16_f32 v207, v158, v159
 v_mfma_f32_16x16x32_bf16 v[136:139], a[192:195], v[68:71], v[136:139]
 v_exp_f32 v161, v161
 v_mfma_f32_16x16x32_bf16 v[144:147], a[192:195], v[72:75], v[232:235]
 ds_read_b128 a[212:215], v15 offset:36864
 v_add_f32 v28, v28, v160
 v_mfma_f32_16x16x32_bf16 v[144:147], a[196:199], v[88:91], v[144:147]
 v_exp_f32 v162, v162
 v_mfma_f32_16x16x32_bf16 v[152:155], a[196:199], v[92:95], v[236:239]
 v_add_f32 v28, v28, v161
 v_cvt_pk_bf16_f32 v208, v160, v161
 v_mfma_f32_16x16x32_bf16 v[152:155], a[192:195], v[76:79], v[152:155]
 s_waitcnt lgkmcnt(2)
 v_exp_f32 v163, v163
 v_mfma_f32_16x16x32_bf16 v[152:155], a[200:203], v[108:111], v[152:155]
 ds_read_b128 a[216:219], v16 offset:36864
 s_add_u32 s54, s39, 114688
 v_add_f32 v28, v28, v162
 v_mfma_f32_16x16x32_bf16 v[152:155], a[204:207], v[124:127], v[152:155]
 s_add_u32 m0, s40, 114688
 v_exp_f32 v164, v164
 v_mfma_f32_16x16x32_bf16 v[144:147], a[204:207], v[120:123], v[144:147]
 buffer_load_dwordx4 v12, s[28:31], s54 offen lds
 v_add_f32 v28, v28, v163
 v_cvt_pk_bf16_f32 v209, v162, v163
 v_mfma_f32_16x16x32_bf16 v[144:147], a[200:203], v[104:107], v[144:147]
 v_exp_f32 v165, v165
 v_mfma_f32_16x16x32_bf16 v[136:139], a[200:203], v[100:103], v[136:139]
 ds_read_b128 a[220:223], v17 offset:36864
 v_add_f32 v28, v28, v164
 v_mfma_f32_16x16x32_bf16 v[136:139], a[204:207], v[116:119], v[136:139]
 v_exp_f32 v166, v166
 v_mfma_f32_16x16x32_bf16 v[128:131], a[204:207], v[112:115], v[128:131]
 buffer_load_dwordx4 v13, s[28:31], s54 offen offset:1024 lds
 v_add_f32 v28, v28, v165
 v_cvt_pk_bf16_f32 v210, v164, v165
 v_mfma_f32_16x16x32_bf16 v[128:131], a[200:203], v[96:99], v[128:131]
 s_waitcnt lgkmcnt(2)
 v_exp_f32 v167, v167
 v_mfma_f32_16x16x32_bf16 v[132:135], a[208:211], v[64:67], v[224:227]
 ds_read_b64_tr_b16 a[224:225], v18 offset:16384
 v_add_f32 v28, v28, v166
 v_mfma_f32_16x16x32_bf16 v[132:135], a[212:215], v[80:83], v[132:135]
 ds_read_b64_tr_b16 a[226:227], v18 offset:20480
 v_exp_f32 v168, v168
 v_mfma_f32_16x16x32_bf16 v[140:143], a[212:215], v[84:87], v[228:231]
 v_add_f32 v28, v28, v167
 v_cvt_pk_bf16_f32 v211, v166, v167
 v_mfma_f32_16x16x32_bf16 v[140:143], a[208:211], v[68:71], v[140:143]
 v_exp_f32 v169, v169
 v_mfma_f32_16x16x32_bf16 v[148:151], a[208:211], v[72:75], v[232:235]
 ds_read_b64_tr_b16 a[228:229], v19 offset:16384
 buffer_load_dwordx4 v12, s[28:31], s54 offen offset:2048 lds
 v_add_f32 v29, v29, v168
 v_mfma_f32_16x16x32_bf16 v[148:151], a[212:215], v[88:91], v[148:151]
 ds_read_b64_tr_b16 a[230:231], v19 offset:20480
 v_exp_f32 v170, v170
 v_mfma_f32_16x16x32_bf16 v[156:159], a[212:215], v[92:95], v[236:239]
 v_add_f32 v29, v29, v169
 v_cvt_pk_bf16_f32 v212, v168, v169
 v_mfma_f32_16x16x32_bf16 v[156:159], a[208:211], v[76:79], v[156:159]
 s_waitcnt lgkmcnt(4)
 v_exp_f32 v171, v171
 v_mfma_f32_16x16x32_bf16 v[156:159], a[216:219], v[108:111], v[156:159]
 ds_read_b64_tr_b16 a[232:233], v20 offset:16384
 v_add_f32 v29, v29, v170
 v_mfma_f32_16x16x32_bf16 v[156:159], a[220:223], v[124:127], v[156:159]
 ds_read_b64_tr_b16 a[234:235], v20 offset:20480
 v_exp_f32 v172, v172
 v_mfma_f32_16x16x32_bf16 v[148:151], a[220:223], v[120:123], v[148:151]
 buffer_load_dwordx4 v13, s[28:31], s54 offen offset:3072 lds
 v_add_f32 v29, v29, v171
 v_cvt_pk_bf16_f32 v213, v170, v171
 v_mfma_f32_16x16x32_bf16 v[148:151], a[216:219], v[104:107], v[148:151]
 v_exp_f32 v173, v173
 v_mfma_f32_16x16x32_bf16 v[140:143], a[216:219], v[100:103], v[140:143]
 ds_read_b64_tr_b16 a[236:237], v21 offset:16384
 v_add_f32 v29, v29, v172
 v_mfma_f32_16x16x32_bf16 v[140:143], a[220:223], v[116:119], v[140:143]
 ds_read_b64_tr_b16 a[238:239], v21 offset:20480
 v_exp_f32 v174, v174
 v_mfma_f32_16x16x32_bf16 v[132:135], a[220:223], v[112:115], v[132:135]
 v_add_f32 v29, v29, v173
 v_cvt_pk_bf16_f32 v214, v172, v173
 v_mfma_f32_16x16x32_bf16 v[132:135], a[216:219], v[96:99], v[132:135]
 s_waitcnt lgkmcnt(6)
 v_exp_f32 v175, v175
 v_mfma_f32_16x16x32_bf16 a[0:3], a[224:227], v[192:195], a[0:3]
 ds_read_b64_tr_b16 a[240:241], v22 offset:16384
 s_add_u32 m0, s79, 0
 v_add_f32 v29, v29, v174
 v_mfma_f32_16x16x32_bf16 a[4:7], a[224:227], v[196:199], a[4:7]
 ds_read_b64_tr_b16 a[242:243], v22 offset:20480
 v_exp_f32 v176, v176
 v_mfma_f32_16x16x32_bf16 a[8:11], a[224:227], v[200:203], a[8:11]
 buffer_load_dwordx4 v40, s[12:15], s77 offen  lds
 v_add_f32 v29, v29, v175
 v_cvt_pk_bf16_f32 v215, v174, v175
 v_mfma_f32_16x16x32_bf16 a[12:15], a[224:227], v[204:207], a[12:15]
 s_waitcnt lgkmcnt(6)
 v_exp_f32 v177, v177
 v_mfma_f32_16x16x32_bf16 a[28:31], a[228:231], v[204:207], a[28:31]
 ds_read_b64_tr_b16 a[244:245], v23 offset:16384
 v_add_f32 v30, v30, v176
 v_mfma_f32_16x16x32_bf16 a[24:27], a[228:231], v[200:203], a[24:27]
 ds_read_b64_tr_b16 a[246:247], v23 offset:20480
 v_exp_f32 v178, v178
 v_mfma_f32_16x16x32_bf16 a[20:23], a[228:231], v[196:199], a[20:23]
 buffer_load_dwordx4 v41, s[12:15], s77 offen offset:1024  lds
 v_add_f32 v30, v30, v177
 v_cvt_pk_bf16_f32 v216, v176, v177
 v_mfma_f32_16x16x32_bf16 a[16:19], a[228:231], v[192:195], a[16:19]
 s_waitcnt lgkmcnt(6)
 v_exp_f32 v179, v179
 v_mfma_f32_16x16x32_bf16 a[32:35], a[232:235], v[192:195], a[32:35]
 ds_read_b64_tr_b16 a[248:249], v24 offset:16384
 v_add_f32 v30, v30, v178
 v_mfma_f32_16x16x32_bf16 a[36:39], a[232:235], v[196:199], a[36:39]
 ds_read_b64_tr_b16 a[250:251], v24 offset:20480
 v_exp_f32 v180, v180
 v_mfma_f32_16x16x32_bf16 a[40:43], a[232:235], v[200:203], a[40:43]
 v_add_f32 v30, v30, v179
 v_cvt_pk_bf16_f32 v217, v178, v179
 v_mfma_f32_16x16x32_bf16 a[44:47], a[232:235], v[204:207], a[44:47]
 s_waitcnt lgkmcnt(6)
 v_exp_f32 v181, v181
 v_mfma_f32_16x16x32_bf16 a[60:63], a[236:239], v[204:207], a[60:63]
 ds_read_b64_tr_b16 a[252:253], v25 offset:16384
 buffer_load_dwordx4 v42, s[12:15], s77 offen offset:2048  lds
 v_add_f32 v30, v30, v180
 v_mfma_f32_16x16x32_bf16 a[56:59], a[236:239], v[200:203], a[56:59]
 ds_read_b64_tr_b16 a[254:255], v25 offset:20480
 v_exp_f32 v182, v182
 v_mfma_f32_16x16x32_bf16 a[52:55], a[236:239], v[196:199], a[52:55]
 v_add_f32 v30, v30, v181
 v_cvt_pk_bf16_f32 v218, v180, v181
 v_mfma_f32_16x16x32_bf16 a[48:51], a[236:239], v[192:195], a[48:51]
 s_waitcnt lgkmcnt(6)
 v_exp_f32 v183, v183
 v_mfma_f32_16x16x32_bf16 a[64:67], a[240:243], v[192:195], a[64:67]
 ds_read_b128 a[192:195], v14 offset:40960
 v_add_f32 v30, v30, v182
 v_mfma_f32_16x16x32_bf16 a[68:71], a[240:243], v[196:199], a[68:71]
 v_exp_f32 v184, v184
 v_mfma_f32_16x16x32_bf16 a[72:75], a[240:243], v[200:203], a[72:75]
 buffer_load_dwordx4 v43, s[12:15], s77 offen offset:3072  lds
 v_add_f32 v30, v30, v183
 v_cvt_pk_bf16_f32 v219, v182, v183
 v_mfma_f32_16x16x32_bf16 a[76:79], a[240:243], v[204:207], a[76:79]
 s_waitcnt lgkmcnt(5)
 v_exp_f32 v185, v185
 v_mfma_f32_16x16x32_bf16 a[92:95], a[244:247], v[204:207], a[92:95]
 ds_read_b128 a[196:199], v15 offset:40960
 v_add_f32 v31, v31, v184
 v_mfma_f32_16x16x32_bf16 a[88:91], a[244:247], v[200:203], a[88:91]
 v_exp_f32 v186, v186
 v_mfma_f32_16x16x32_bf16 a[84:87], a[244:247], v[196:199], a[84:87]
 buffer_load_dword v61, v0, s[60:63], 0 offen
 v_add_f32 v31, v31, v185
 v_cvt_pk_bf16_f32 v220, v184, v185
 v_mfma_f32_16x16x32_bf16 a[80:83], a[244:247], v[192:195], a[80:83]
 s_waitcnt lgkmcnt(4)
 v_exp_f32 v187, v187
 v_mfma_f32_16x16x32_bf16 a[96:99], a[248:251], v[192:195], a[96:99]
 ds_read_b128 a[200:203], v16 offset:40960
 s_add_u32 m0, s79, 4096
 v_add_f32 v31, v31, v186
 v_mfma_f32_16x16x32_bf16 a[100:103], a[248:251], v[196:199], a[100:103]
 v_exp_f32 v188, v188
 s_nop 0
 buffer_load_dwordx4 v44, s[12:15], s77 offen  lds
 v_mfma_f32_16x16x32_bf16 a[104:107], a[248:251], v[200:203], a[104:107]
 v_add_f32 v31, v31, v187
 v_cvt_pk_bf16_f32 v221, v186, v187
 v_mfma_f32_16x16x32_bf16 a[108:111], a[248:251], v[204:207], a[108:111]
 s_waitcnt lgkmcnt(3)
 v_exp_f32 v189, v189
 v_mfma_f32_16x16x32_bf16 a[124:127], a[252:255], v[204:207], a[124:127]
 ds_read_b128 a[204:207], v17 offset:40960
 v_add_f32 v31, v31, v188
 v_mfma_f32_16x16x32_bf16 a[120:123], a[252:255], v[200:203], a[120:123]
 v_exp_f32 v190, v190
 v_mfma_f32_16x16x32_bf16 a[116:119], a[252:255], v[196:199], a[116:119]
 buffer_load_dwordx4 v45, s[12:15], s77 offen offset:1024  lds
 v_add_f32 v31, v31, v189
 v_cvt_pk_bf16_f32 v222, v188, v189
 v_mfma_f32_16x16x32_bf16 a[112:115], a[252:255], v[192:195], a[112:115]
 s_waitcnt lgkmcnt(2)
 v_exp_f32 v191, v191
 v_mfma_f32_16x16x32_bf16 v[160:163], a[192:195], v[64:67], v[224:227]
 ds_read_b128 a[208:211], v14 offset:45056
 v_add_f32 v31, v31, v190
 v_mfma_f32_16x16x32_bf16 v[160:163], a[196:199], v[80:83], v[160:163]
 v_exp_f32 v128, v128
 v_mfma_f32_16x16x32_bf16 v[168:171], a[196:199], v[84:87], v[228:231]
 v_add_f32 v31, v31, v191
 v_cvt_pk_bf16_f32 v223, v190, v191
 v_mfma_f32_16x16x32_bf16 v[168:171], a[192:195], v[68:71], v[168:171]
 v_exp_f32 v129, v129
 v_mfma_f32_16x16x32_bf16 v[176:179], a[192:195], v[72:75], v[232:235]
 ds_read_b128 a[212:215], v15 offset:45056
 buffer_load_dwordx4 v46, s[12:15], s77 offen offset:2048  lds
 v_add_f32 v28, v28, v128
 v_mfma_f32_16x16x32_bf16 v[176:179], a[196:199], v[88:91], v[176:179]
 v_exp_f32 v130, v130
 v_mfma_f32_16x16x32_bf16 v[184:187], a[196:199], v[92:95], v[236:239]
 v_add_f32 v28, v28, v129
 v_cvt_pk_bf16_f32 v192, v128, v129
 v_mfma_f32_16x16x32_bf16 v[184:187], a[192:195], v[76:79], v[184:187]
 s_waitcnt lgkmcnt(2)
 v_exp_f32 v131, v131
 v_mfma_f32_16x16x32_bf16 v[184:187], a[200:203], v[108:111], v[184:187]
 ds_read_b128 a[216:219], v16 offset:45056
 v_add_f32 v28, v28, v130
 v_mfma_f32_16x16x32_bf16 v[184:187], a[204:207], v[124:127], v[184:187]
 v_exp_f32 v132, v132
 v_mfma_f32_16x16x32_bf16 v[176:179], a[204:207], v[120:123], v[176:179]
 buffer_load_dwordx4 v47, s[12:15], s77 offen offset:3072  lds
 s_add_u32 s77, s77, 262144
 v_add_f32 v28, v28, v131
 v_cvt_pk_bf16_f32 v193, v130, v131
 v_mfma_f32_16x16x32_bf16 v[176:179], a[200:203], v[104:107], v[176:179]
 v_exp_f32 v133, v133
 v_mfma_f32_16x16x32_bf16 v[168:171], a[200:203], v[100:103], v[168:171]
 ds_read_b128 a[220:223], v17 offset:45056
 v_add_f32 v28, v28, v132
 v_mfma_f32_16x16x32_bf16 v[168:171], a[204:207], v[116:119], v[168:171]
 v_exp_f32 v134, v134
 v_mfma_f32_16x16x32_bf16 v[160:163], a[204:207], v[112:115], v[160:163]
 v_add_f32 v28, v28, v133
 v_cvt_pk_bf16_f32 v194, v132, v133
 v_mfma_f32_16x16x32_bf16 v[160:163], a[200:203], v[96:99], v[160:163]
 s_waitcnt lgkmcnt(2)
 v_exp_f32 v135, v135
 v_mfma_f32_16x16x32_bf16 v[164:167], a[208:211], v[64:67], v[224:227]
 ds_read_b64_tr_b16 a[224:225], v18 offset:24576
 v_add_f32 v28, v28, v134
 v_mfma_f32_16x16x32_bf16 v[164:167], a[212:215], v[80:83], v[164:167]
 ds_read_b64_tr_b16 a[226:227], v18 offset:28672
 v_exp_f32 v136, v136
 v_mfma_f32_16x16x32_bf16 v[172:175], a[212:215], v[84:87], v[228:231]
 v_add_f32 v28, v28, v135
 v_cvt_pk_bf16_f32 v195, v134, v135
 v_mfma_f32_16x16x32_bf16 v[172:175], a[208:211], v[68:71], v[172:175]
 v_exp_f32 v137, v137
 v_mfma_f32_16x16x32_bf16 v[180:183], a[208:211], v[72:75], v[232:235]
 ds_read_b64_tr_b16 a[228:229], v19 offset:24576
 s_waitcnt vmcnt(17)
 v_add_f32 v29, v29, v136
 v_cmp_ne_u64 vcc, s[6:7], v[62:63]
 s_nop 0
 s_nop 0
 s_cbranch_vccz L_h_ok
L_h_spin:
 s_sleep 4
 buffer_load_dwordx2 v[62:63], v60, s[56:59], 0 offen sc1
 s_waitcnt vmcnt(0)
 v_cmp_ne_u64 vcc, s[6:7], v[62:63]
 s_nop 1
 s_cbranch_vccnz L_h_spin
L_h_ok:
 v_mfma_f32_16x16x32_bf16 v[180:183], a[212:215], v[88:91], v[180:183]
 ds_read_b64_tr_b16 a[230:231], v19 offset:28672
 v_exp_f32 v138, v138
 v_mfma_f32_16x16x32_bf16 v[188:191], a[212:215], v[92:95], v[236:239]
 v_add_f32 v29, v29, v137
 v_cvt_pk_bf16_f32 v196, v136, v137
 v_mfma_f32_16x16x32_bf16 v[188:191], a[208:211], v[76:79], v[188:191]
 s_waitcnt lgkmcnt(4)
 v_exp_f32 v139, v139
 v_mfma_f32_16x16x32_bf16 v[188:191], a[216:219], v[108:111], v[188:191]
 ds_read_b64_tr_b16 a[232:233], v20 offset:24576
 v_add_f32 v29, v29, v138
 v_mfma_f32_16x16x32_bf16 v[188:191], a[220:223], v[124:127], v[188:191]
 ds_read_b64_tr_b16 a[234:235], v20 offset:28672
 v_exp_f32 v140, v140
 v_mfma_f32_16x16x32_bf16 v[180:183], a[220:223], v[120:123], v[180:183]
 v_add_f32 v29, v29, v139
 v_cvt_pk_bf16_f32 v197, v138, v139
 v_mfma_f32_16x16x32_bf16 v[180:183], a[216:219], v[104:107], v[180:183]
 v_exp_f32 v141, v141
 v_mfma_f32_16x16x32_bf16 v[172:175], a[216:219], v[100:103], v[172:175]
 ds_read_b64_tr_b16 a[236:237], v21 offset:24576
 v_add_f32 v29, v29, v140
 v_mfma_f32_16x16x32_bf16 v[172:175], a[220:223], v[116:119], v[172:175]
 ds_read_b64_tr_b16 a[238:239], v21 offset:28672
 v_exp_f32 v142, v142
 v_mfma_f32_16x16x32_bf16 v[164:167], a[220:223], v[112:115], v[164:167]
 v_add_f32 v29, v29, v141
 v_cvt_pk_bf16_f32 v198, v140, v141
 v_mfma_f32_16x16x32_bf16 v[164:167], a[216:219], v[96:99], v[164:167]
 s_waitcnt lgkmcnt(6)
 v_exp_f32 v143, v143
 v_mfma_f32_16x16x32_bf16 a[0:3], a[224:227], v[208:211], a[0:3]
 ds_read_b64_tr_b16 a[240:241], v22 offset:24576
 v_add_f32 v29, v29, v142
 v_mfma_f32_16x16x32_bf16 a[4:7], a[224:227], v[212:215], a[4:7]
 ds_read_b64_tr_b16 a[242:243], v22 offset:28672
 v_exp_f32 v144, v144
 v_mfma_f32_16x16x32_bf16 a[8:11], a[224:227], v[216:219], a[8:11]
 v_add_f32 v29, v29, v143
 v_cvt_pk_bf16_f32 v199, v142, v143
 v_mfma_f32_16x16x32_bf16 a[12:15], a[224:227], v[220:223], a[12:15]
 s_waitcnt lgkmcnt(6)
 v_exp_f32 v145, v145
 v_mfma_f32_16x16x32_bf16 a[28:31], a[228:231], v[220:223], a[28:31]
 ds_read_b64_tr_b16 a[244:245], v23 offset:24576
 v_add_f32 v30, v30, v144
 v_mfma_f32_16x16x32_bf16 a[24:27], a[228:231], v[216:219], a[24:27]
 ds_read_b64_tr_b16 a[246:247], v23 offset:28672
 v_exp_f32 v146, v146
 v_mfma_f32_16x16x32_bf16 a[20:23], a[228:231], v[212:215], a[20:23]
 v_add_f32 v30, v30, v145
 v_cvt_pk_bf16_f32 v200, v144, v145
 v_mfma_f32_16x16x32_bf16 a[16:19], a[228:231], v[208:211], a[16:19]
 s_waitcnt lgkmcnt(6)
 v_exp_f32 v147, v147
 v_mfma_f32_16x16x32_bf16 a[32:35], a[232:235], v[208:211], a[32:35]
 ds_read_b64_tr_b16 a[248:249], v24 offset:24576
 v_add_f32 v30, v30, v146
 v_mfma_f32_16x16x32_bf16 a[36:39], a[232:235], v[212:215], a[36:39]
 ds_read_b64_tr_b16 a[250:251], v24 offset:28672
 v_exp_f32 v148, v148
 v_mfma_f32_16x16x32_bf16 a[40:43], a[232:235], v[216:219], a[40:43]
 v_add_f32 v30, v30, v147
 v_cvt_pk_bf16_f32 v201, v146, v147
 v_mfma_f32_16x16x32_bf16 a[44:47], a[232:235], v[220:223], a[44:47]
 s_waitcnt lgkmcnt(6)
 v_exp_f32 v149, v149
 v_mfma_f32_16x16x32_bf16 a[60:63], a[236:239], v[220:223], a[60:63]
 ds_read_b64_tr_b16 a[252:253], v25 offset:24576
 v_add_f32 v30, v30, v148
 v_mfma_f32_16x16x32_bf16 a[56:59], a[236:239], v[216:219], a[56:59]
 ds_read_b64_tr_b16 a[254:255], v25 offset:28672
 v_exp_f32 v150, v150
 v_mfma_f32_16x16x32_bf16 a[52:55], a[236:239], v[212:215], a[52:55]
 v_add_f32 v30, v30, v149
 v_cvt_pk_bf16_f32 v202, v148, v149
 v_mfma_f32_16x16x32_bf16 a[48:51], a[236:239], v[208:211], a[48:51]
 s_barrier
 s_waitcnt lgkmcnt(6)
 v_exp_f32 v151, v151
 v_mfma_f32_16x16x32_bf16 a[64:67], a[240:243], v[208:211], a[64:67]
 ds_read_b128 a[192:195], v14 offset:49152
 buffer_load_dwordx4 a[128:131], v48, s[16:19], s78 offen sc1
 v_add_f32 v30, v30, v150
 v_mfma_f32_16x16x32_bf16 a[68:71], a[240:243], v[212:215], a[68:71]
 v_exp_f32 v152, v152
 v_mfma_f32_16x16x32_bf16 a[72:75], a[240:243], v[216:219], a[72:75]
 v_add_f32 v30, v30, v151
 v_cvt_pk_bf16_f32 v203, v150, v151
 v_mfma_f32_16x16x32_bf16 a[76:79], a[240:243], v[220:223], a[76:79]
 s_waitcnt lgkmcnt(5)
 v_exp_f32 v153, v153
 v_mfma_f32_16x16x32_bf16 a[92:95], a[244:247], v[220:223], a[92:95]
 ds_read_b128 a[196:199], v15 offset:49152
 v_add_f32 v31, v31, v152
 v_mfma_f32_16x16x32_bf16 a[88:91], a[244:247], v[216:219], a[88:91]
 v_exp_f32 v154, v154
 v_mfma_f32_16x16x32_bf16 a[84:87], a[244:247], v[212:215], a[84:87]
 buffer_load_dwordx4 a[132:135], v49, s[16:19], s78 offen sc1
 v_add_f32 v31, v31, v153
 v_cvt_pk_bf16_f32 v204, v152, v153
 v_mfma_f32_16x16x32_bf16 a[80:83], a[244:247], v[208:211], a[80:83]
 s_waitcnt lgkmcnt(4)
 v_exp_f32 v155, v155
 v_mfma_f32_16x16x32_bf16 a[96:99], a[248:251], v[208:211], a[96:99]
 ds_read_b128 a[200:203], v16 offset:49152
 v_add_f32 v31, v31, v154
 v_mfma_f32_16x16x32_bf16 a[100:103], a[248:251], v[212:215], a[100:103]
 v_exp_f32 v156, v156
 v_mfma_f32_16x16x32_bf16 a[104:107], a[248:251], v[216:219], a[104:107]
 v_add_f32 v31, v31, v155
 v_cvt_pk_bf16_f32 v205, v154, v155
 v_mfma_f32_16x16x32_bf16 a[108:111], a[248:251], v[220:223], a[108:111]
 s_waitcnt lgkmcnt(3)
 v_exp_f32 v157, v157
 v_mfma_f32_16x16x32_bf16 a[124:127], a[252:255], v[220:223], a[124:127]
 ds_read_b128 a[204:207], v17 offset:49152
 buffer_load_dwordx4 a[136:139], v50, s[16:19], s78 offen sc1
 v_add_f32 v31, v31, v156
 v_mfma_f32_16x16x32_bf16 a[120:123], a[252:255], v[216:219], a[120:123]
 v_exp_f32 v158, v158
 v_mfma_f32_16x16x32_bf16 a[116:119], a[252:255], v[212:215], a[116:119]
 v_add_f32 v31, v31, v157
 v_cvt_pk_bf16_f32 v206, v156, v157
 v_mfma_f32_16x16x32_bf16 a[112:115], a[252:255], v[208:211], a[112:115]
 s_waitcnt lgkmcnt(2)
 v_exp_f32 v159, v159
 v_mfma_f32_16x16x32_bf16 v[128:131], a[192:195], v[64:67], v[224:227]
 ds_read_b128 a[208:211], v14 offset:53248
 v_add_f32 v31, v31, v158
 v_mfma_f32_16x16x32_bf16 v[128:131], a[196:199], v[80:83], v[128:131]
 v_exp_f32 v160, v160
 v_mfma_f32_16x16x32_bf16 v[136:139], a[196:199], v[84:87], v[228:231]
 buffer_load_dwordx4 a[140:143], v51, s[16:19], s78 offen sc1
 v_add_f32 v31, v31, v159
 v_cvt_pk_bf16_f32 v207, v158, v159
 v_mfma_f32_16x16x32_bf16 v[136:139], a[192:195], v[68:71], v[136:139]
 v_exp_f32 v161, v161
 v_mfma_f32_16x16x32_bf16 v[144:147], a[192:195], v[72:75], v[232:235]
 ds_read_b128 a[212:215], v15 offset:53248
 v_add_f32 v28, v28, v160
 v_mfma_f32_16x16x32_bf16 v[144:147], a[196:199], v[88:91], v[144:147]
 v_exp_f32 v162, v162
 v_mfma_f32_16x16x32_bf16 v[152:155], a[196:199], v[92:95], v[236:239]
 v_add_f32 v28, v28, v161
 v_cvt_pk_bf16_f32 v208, v160, v161
 v_mfma_f32_16x16x32_bf16 v[152:155], a[192:195], v[76:79], v[152:155]
 s_waitcnt lgkmcnt(2)
 v_exp_f32 v163, v163
 v_mfma_f32_16x16x32_bf16 v[152:155], a[200:203], v[108:111], v[152:155]
 ds_read_b128 a[216:219], v16 offset:53248
 buffer_load_dwordx4 a[144:147], v48, s[16:19], s78 offen offset:1024 sc1
 v_add_f32 v28, v28, v162
 v_mfma_f32_16x16x32_bf16 v[152:155], a[204:207], v[124:127], v[152:155]
 v_exp_f32 v164, v164
 v_mfma_f32_16x16x32_bf16 v[144:147], a[204:207], v[120:123], v[144:147]
 v_add_f32 v28, v28, v163
 v_cvt_pk_bf16_f32 v209, v162, v163
 v_mfma_f32_16x16x32_bf16 v[144:147], a[200:203], v[104:107], v[144:147]
 v_exp_f32 v165, v165
 v_mfma_f32_16x16x32_bf16 v[136:139], a[200:203], v[100:103], v[136:139]
 ds_read_b128 a[220:223], v17 offset:53248
 v_add_f32 v28, v28, v164
 v_mfma_f32_16x16x32_bf16 v[136:139], a[204:207], v[116:119], v[136:139]
 v_exp_f32 v166, v166
 v_mfma_f32_16x16x32_bf16 v[128:131], a[204:207], v[112:115], v[128:131]
 buffer_load_dwordx4 a[148:151], v49, s[16:19], s78 offen offset:1024 sc1
 v_add_f32 v28, v28, v165
 v_cvt_pk_bf16_f32 v210, v164, v165
 v_mfma_f32_16x16x32_bf16 v[128:131], a[200:203], v[96:99], v[128:131]
 s_waitcnt lgkmcnt(2)
 v_exp_f32 v167, v167
 v_mfma_f32_16x16x32_bf16 v[132:135], a[208:211], v[64:67], v[224:227]
 ds_read_b64_tr_b16 a[224:225], v18 offset:32768
 v_add_f32 v28, v28, v166
 v_mfma_f32_16x16x32_bf16 v[132:135], a[212:215], v[80:83], v[132:135]
 ds_read_b64_tr_b16 a[226:227], v18 offset:36864
 v_exp_f32 v168, v168
 v_mfma_f32_16x16x32_bf16 v[140:143], a[212:215], v[84:87], v[228:231]
 v_add_f32 v28, v28, v167
 v_cvt_pk_bf16_f32 v211, v166, v167
 v_mfma_f32_16x16x32_bf16 v[140:143], a[208:211], v[68:71], v[140:143]
 v_exp_f32 v169, v169
 v_mfma_f32_16x16x32_bf16 v[148:151], a[208:211], v[72:75], v[232:235]
 ds_read_b64_tr_b16 a[228:229], v19 offset:32768
 buffer_load_dwordx4 a[152:155], v50, s[16:19], s78 offen offset:1024 sc1
 v_add_f32 v29, v29, v168
 v_mfma_f32_16x16x32_bf16 v[148:151], a[212:215], v[88:91], v[148:151]
 ds_read_b64_tr_b16 a[230:231], v19 offset:36864
 v_exp_f32 v170, v170
 v_mfma_f32_16x16x32_bf16 v[156:159], a[212:215], v[92:95], v[236:239]
 v_add_f32 v29, v29, v169
 v_cvt_pk_bf16_f32 v212, v168, v169
 v_mfma_f32_16x16x32_bf16 v[156:159], a[208:211], v[76:79], v[156:159]
 s_waitcnt lgkmcnt(4)
 v_exp_f32 v171, v171
 v_mfma_f32_16x16x32_bf16 v[156:159], a[216:219], v[108:111], v[156:159]
 ds_read_b64_tr_b16 a[232:233], v20 offset:32768
 v_add_f32 v29, v29, v170
 v_mfma_f32_16x16x32_bf16 v[156:159], a[220:223], v[124:127], v[156:159]
 ds_read_b64_tr_b16 a[234:235], v20 offset:36864
 v_exp_f32 v172, v172
 v_mfma_f32_16x16x32_bf16 v[148:151], a[220:223], v[120:123], v[148:151]
 buffer_load_dwordx4 a[156:159], v51, s[16:19], s78 offen offset:1024 sc1
 v_add_f32 v29, v29, v171
 v_cvt_pk_bf16_f32 v213, v170, v171
 v_mfma_f32_16x16x32_bf16 v[148:151], a[216:219], v[104:107], v[148:151]
 v_exp_f32 v173, v173
 v_mfma_f32_16x16x32_bf16 v[140:143], a[216:219], v[100:103], v[140:143]
 ds_read_b64_tr_b16 a[236:237], v21 offset:32768
 v_add_f32 v29, v29, v172
 v_mfma_f32_16x16x32_bf16 v[140:143], a[220:223], v[116:119], v[140:143]
 ds_read_b64_tr_b16 a[238:239], v21 offset:36864
 v_exp_f32 v174, v174
 v_mfma_f32_16x16x32_bf16 v[132:135], a[220:223], v[112:115], v[132:135]
 v_add_f32 v29, v29, v173
 v_cvt_pk_bf16_f32 v214, v172, v173
 v_mfma_f32_16x16x32_bf16 v[132:135], a[216:219], v[96:99], v[132:135]
 s_waitcnt lgkmcnt(6)
 v_exp_f32 v175, v175
 v_mfma_f32_16x16x32_bf16 a[0:3], a[224:227], v[192:195], a[0:3]
 ds_read_b64_tr_b16 a[240:241], v22 offset:32768
 buffer_load_dwordx4 a[160:163], v48, s[16:19], s78 offen offset:2048 sc1
 v_add_f32 v29, v29, v174
 v_mfma_f32_16x16x32_bf16 a[4:7], a[224:227], v[196:199], a[4:7]
 ds_read_b64_tr_b16 a[242:243], v22 offset:36864
 v_exp_f32 v176, v176
 v_mfma_f32_16x16x32_bf16 a[8:11], a[224:227], v[200:203], a[8:11]
 v_add_f32 v29, v29, v175
 v_cvt_pk_bf16_f32 v215, v174, v175
 v_mfma_f32_16x16x32_bf16 a[12:15], a[224:227], v[204:207], a[12:15]
 s_waitcnt lgkmcnt(6)
 v_exp_f32 v177, v177
 v_mfma_f32_16x16x32_bf16 a[28:31], a[228:231], v[204:207], a[28:31]
 ds_read_b64_tr_b16 a[244:245], v23 offset:32768
 v_add_f32 v30, v30, v176
 v_mfma_f32_16x16x32_bf16 a[24:27], a[228:231], v[200:203], a[24:27]
 ds_read_b64_tr_b16 a[246:247], v23 offset:36864
 v_exp_f32 v178, v178
 v_mfma_f32_16x16x32_bf16 a[20:23], a[228:231], v[196:199], a[20:23]
 buffer_load_dwordx4 a[164:167], v49, s[16:19], s78 offen offset:2048 sc1
 v_add_f32 v30, v30, v177
 v_cvt_pk_bf16_f32 v216, v176, v177
 v_mfma_f32_16x16x32_bf16 a[16:19], a[228:231], v[192:195], a[16:19]
 s_waitcnt lgkmcnt(6)
 v_exp_f32 v179, v179
 v_mfma_f32_16x16x32_bf16 a[32:35], a[232:235], v[192:195], a[32:35]
 ds_read_b64_tr_b16 a[248:249], v24 offset:32768
 v_add_f32 v30, v30, v178
 v_mfma_f32_16x16x32_bf16 a[36:39], a[232:235], v[196:199], a[36:39]
 ds_read_b64_tr_b16 a[250:251], v24 offset:36864
 v_exp_f32 v180, v180
 v_mfma_f32_16x16x32_bf16 a[40:43], a[232:235], v[200:203], a[40:43]
 v_add_f32 v30, v30, v179
 v_cvt_pk_bf16_f32 v217, v178, v179
 v_mfma_f32_16x16x32_bf16 a[44:47], a[232:235], v[204:207], a[44:47]
 s_waitcnt lgkmcnt(6)
 v_exp_f32 v181, v181
 v_mfma_f32_16x16x32_bf16 a[60:63], a[236:239], v[204:207], a[60:63]
 ds_read_b64_tr_b16 a[252:253], v25 offset:32768
 buffer_load_dwordx4 a[168:171], v50, s[16:19], s78 offen offset:2048 sc1
 v_add_f32 v30, v30, v180
 v_mfma_f32_16x16x32_bf16 a[56:59], a[236:239], v[200:203], a[56:59]
 ds_read_b64_tr_b16 a[254:255], v25 offset:36864
 v_exp_f32 v182, v182
 v_mfma_f32_16x16x32_bf16 a[52:55], a[236:239], v[196:199], a[52:55]
 v_add_f32 v30, v30, v181
 v_cvt_pk_bf16_f32 v218, v180, v181
 v_mfma_f32_16x16x32_bf16 a[48:51], a[236:239], v[192:195], a[48:51]
 s_waitcnt lgkmcnt(6)
 v_exp_f32 v183, v183
 v_mfma_f32_16x16x32_bf16 a[64:67], a[240:243], v[192:195], a[64:67]
 ds_read_b128 a[192:195], v14 offset:57344
 v_add_f32 v30, v30, v182
 v_mfma_f32_16x16x32_bf16 a[68:71], a[240:243], v[196:199], a[68:71]
 v_exp_f32 v184, v184
 v_mfma_f32_16x16x32_bf16 a[72:75], a[240:243], v[200:203], a[72:75]
 buffer_load_dwordx4 a[172:175], v51, s[16:19], s78 offen offset:2048 sc1
 v_add_f32 v30, v30, v183
 v_cvt_pk_bf16_f32 v219, v182, v183
 v_mfma_f32_16x16x32_bf16 a[76:79], a[240:243], v[204:207], a[76:79]
 s_waitcnt lgkmcnt(5)
 v_exp_f32 v185, v185
 v_mfma_f32_16x16x32_bf16 a[92:95], a[244:247], v[204:207], a[92:95]
 ds_read_b128 a[196:199], v15 offset:57344
 v_add_f32 v31, v31, v184
 v_mfma_f32_16x16x32_bf16 a[88:91], a[244:247], v[200:203], a[88:91]
 v_exp_f32 v186, v186
 v_mfma_f32_16x16x32_bf16 a[84:87], a[244:247], v[196:199], a[84:87]
 buffer_load_dword v61, v0, s[60:63], 0 offen
 v_add_f32 v31, v31, v185
 v_cvt_pk_bf16_f32 v220, v184, v185
 v_mfma_f32_16x16x32_bf16 a[80:83], a[244:247], v[192:195], a[80:83]
 s_waitcnt lgkmcnt(4)
 v_exp_f32 v187, v187
 v_mfma_f32_16x16x32_bf16 a[96:99], a[248:251], v[192:195], a[96:99]
 ds_read_b128 a[200:203], v16 offset:57344
 buffer_load_dwordx4 a[176:179], v48, s[16:19], s78 offen offset:3072 sc1
 v_add_f32 v31, v31, v186
 v_mfma_f32_16x16x32_bf16 a[100:103], a[248:251], v[196:199], a[100:103]
 v_exp_f32 v188, v188
 v_mfma_f32_16x16x32_bf16 a[104:107], a[248:251], v[200:203], a[104:107]
 v_add_f32 v31, v31, v187
 v_cvt_pk_bf16_f32 v221, v186, v187
 v_mfma_f32_16x16x32_bf16 a[108:111], a[248:251], v[204:207], a[108:111]
 s_waitcnt lgkmcnt(3)
 v_exp_f32 v189, v189
 v_mfma_f32_16x16x32_bf16 a[124:127], a[252:255], v[204:207], a[124:127]
 ds_read_b128 a[204:207], v17 offset:57344
 v_add_f32 v31, v31, v188
 v_mfma_f32_16x16x32_bf16 a[120:123], a[252:255], v[200:203], a[120:123]
 v_exp_f32 v190, v190
 v_mfma_f32_16x16x32_bf16 a[116:119], a[252:255], v[196:199], a[116:119]
 buffer_load_dwordx4 a[180:183], v49, s[16:19], s78 offen offset:3072 sc1
 v_add_f32 v31, v31, v189
 v_cvt_pk_bf16_f32 v222, v188, v189
 v_mfma_f32_16x16x32_bf16 a[112:115], a[252:255], v[192:195], a[112:115]
 s_waitcnt lgkmcnt(2)
 v_exp_f32 v191, v191
 v_mfma_f32_16x16x32_bf16 v[160:163], a[192:195], v[64:67], v[224:227]
 ds_read_b128 a[208:211], v14 offset:61440
 v_add_f32 v31, v31, v190
 v_mfma_f32_16x16x32_bf16 v[160:163], a[196:199], v[80:83], v[160:163]
 v_exp_f32 v128, v128
 v_mfma_f32_16x16x32_bf16 v[168:171], a[196:199], v[84:87], v[228:231]
 v_add_f32 v31, v31, v191
 v_cvt_pk_bf16_f32 v223, v190, v191
 v_mfma_f32_16x16x32_bf16 v[168:171], a[192:195], v[68:71], v[168:171]
 v_exp_f32 v129, v129
 v_mfma_f32_16x16x32_bf16 v[176:179], a[192:195], v[72:75], v[232:235]
 ds_read_b128 a[212:215], v15 offset:61440
 buffer_load_dwordx4 a[184:187], v50, s[16:19], s78 offen offset:3072 sc1
 v_add_f32 v28, v28, v128
 v_mfma_f32_16x16x32_bf16 v[176:179], a[196:199], v[88:91], v[176:179]
 v_exp_f32 v130, v130
 v_mfma_f32_16x16x32_bf16 v[184:187], a[196:199], v[92:95], v[236:239]
 v_add_f32 v28, v28, v129
 v_cvt_pk_bf16_f32 v192, v128, v129
 v_mfma_f32_16x16x32_bf16 v[184:187], a[192:195], v[76:79], v[184:187]
 s_waitcnt lgkmcnt(2)
 v_exp_f32 v131, v131
 v_mfma_f32_16x16x32_bf16 v[184:187], a[200:203], v[108:111], v[184:187]
 ds_read_b128 a[216:219], v16 offset:61440
 v_add_f32 v28, v28, v130
 v_mfma_f32_16x16x32_bf16 v[184:187], a[204:207], v[124:127], v[184:187]
 v_exp_f32 v132, v132
 v_mfma_f32_16x16x32_bf16 v[176:179], a[204:207], v[120:123], v[176:179]
 buffer_load_dwordx4 a[188:191], v51, s[16:19], s78 offen offset:3072 sc1
 s_add_u32 s78, s78, 4096
 v_add_f32 v28, v28, v131
 v_cvt_pk_bf16_f32 v193, v130, v131
 v_mfma_f32_16x16x32_bf16 v[176:179], a[200:203], v[104:107], v[176:179]
 v_exp_f32 v133, v133
 v_mfma_f32_16x16x32_bf16 v[168:171], a[200:203], v[100:103], v[168:171]
 ds_read_b128 a[220:223], v17 offset:61440
 v_add_f32 v28, v28, v132
 v_mfma_f32_16x16x32_bf16 v[168:171], a[204:207], v[116:119], v[168:171]
 v_exp_f32 v134, v134
 v_mfma_f32_16x16x32_bf16 v[160:163], a[204:207], v[112:115], v[160:163]
 v_add_f32 v28, v28, v133
 v_cvt_pk_bf16_f32 v194, v132, v133
 v_mfma_f32_16x16x32_bf16 v[160:163], a[200:203], v[96:99], v[160:163]
 s_waitcnt lgkmcnt(2)
 v_exp_f32 v135, v135
 v_mfma_f32_16x16x32_bf16 v[164:167], a[208:211], v[64:67], v[224:227]
 ds_read_b64_tr_b16 a[224:225], v18 offset:40960
 v_add_f32 v28, v28, v134
 v_mfma_f32_16x16x32_bf16 v[164:167], a[212:215], v[80:83], v[164:167]
 ds_read_b64_tr_b16 a[226:227], v18 offset:45056
 v_exp_f32 v136, v136
 v_mfma_f32_16x16x32_bf16 v[172:175], a[212:215], v[84:87], v[228:231]
 v_add_f32 v28, v28, v135
 v_cvt_pk_bf16_f32 v195, v134, v135
 v_mfma_f32_16x16x32_bf16 v[172:175], a[208:211], v[68:71], v[172:175]
 v_exp_f32 v137, v137
 v_mfma_f32_16x16x32_bf16 v[180:183], a[208:211], v[72:75], v[232:235]
 ds_read_b64_tr_b16 a[228:229], v19 offset:40960
 v_add_f32 v29, v29, v136
 v_mfma_f32_16x16x32_bf16 v[180:183], a[212:215], v[88:91], v[180:183]
 ds_read_b64_tr_b16 a[230:231], v19 offset:45056
 v_exp_f32 v138, v138
 v_mfma_f32_16x16x32_bf16 v[188:191], a[212:215], v[92:95], v[236:239]
 v_add_f32 v29, v29, v137
 v_cvt_pk_bf16_f32 v196, v136, v137
 v_mfma_f32_16x16x32_bf16 v[188:191], a[208:211], v[76:79], v[188:191]
 s_waitcnt lgkmcnt(4)
 v_exp_f32 v139, v139
 v_mfma_f32_16x16x32_bf16 v[188:191], a[216:219], v[108:111], v[188:191]
 ds_read_b64_tr_b16 a[232:233], v20 offset:40960
 v_add_f32 v29, v29, v138
 v_mfma_f32_16x16x32_bf16 v[188:191], a[220:223], v[124:127], v[188:191]
 ds_read_b64_tr_b16 a[234:235], v20 offset:45056
 v_exp_f32 v140, v140
 v_mfma_f32_16x16x32_bf16 v[180:183], a[220:223], v[120:123], v[180:183]
 v_add_f32 v29, v29, v139
 v_cvt_pk_bf16_f32 v197, v138, v139
 v_mfma_f32_16x16x32_bf16 v[180:183], a[216:219], v[104:107], v[180:183]
 v_exp_f32 v141, v141
 v_mfma_f32_16x16x32_bf16 v[172:175], a[216:219], v[100:103], v[172:175]
 ds_read_b64_tr_b16 a[236:237], v21 offset:40960
 v_add_f32 v29, v29, v140
 v_mfma_f32_16x16x32_bf16 v[172:175], a[220:223], v[116:119], v[172:175]
 ds_read_b64_tr_b16 a[238:239], v21 offset:45056
 v_exp_f32 v142, v142
 v_mfma_f32_16x16x32_bf16 v[164:167], a[220:223], v[112:115], v[164:167]
 v_add_f32 v29, v29, v141
 v_cvt_pk_bf16_f32 v198, v140, v141
 v_mfma_f32_16x16x32_bf16 v[164:167], a[216:219], v[96:99], v[164:167]
 s_waitcnt lgkmcnt(6)
 v_exp_f32 v143, v143
 v_mfma_f32_16x16x32_bf16 a[0:3], a[224:227], v[208:211], a[0:3]
 ds_read_b64_tr_b16 a[240:241], v22 offset:40960
 v_add_f32 v29, v29, v142
 v_mfma_f32_16x16x32_bf16 a[4:7], a[224:227], v[212:215], a[4:7]
 ds_read_b64_tr_b16 a[242:243], v22 offset:45056
 v_exp_f32 v144, v144
 v_mfma_f32_16x16x32_bf16 a[8:11], a[224:227], v[216:219], a[8:11]
 v_add_f32 v29, v29, v143
 v_cvt_pk_bf16_f32 v199, v142, v143
 v_mfma_f32_16x16x32_bf16 a[12:15], a[224:227], v[220:223], a[12:15]
 s_waitcnt lgkmcnt(6)
 v_exp_f32 v145, v145
 v_mfma_f32_16x16x32_bf16 a[28:31], a[228:231], v[220:223], a[28:31]
 ds_read_b64_tr_b16 a[244:245], v23 offset:40960
 v_add_f32 v30, v30, v144
 v_mfma_f32_16x16x32_bf16 a[24:27], a[228:231], v[216:219], a[24:27]
 ds_read_b64_tr_b16 a[246:247], v23 offset:45056
 v_exp_f32 v146, v146
 v_mfma_f32_16x16x32_bf16 a[20:23], a[228:231], v[212:215], a[20:23]
 v_add_f32 v30, v30, v145
 v_cvt_pk_bf16_f32 v200, v144, v145
 v_mfma_f32_16x16x32_bf16 a[16:19], a[228:231], v[208:211], a[16:19]
 s_waitcnt lgkmcnt(6)
 v_exp_f32 v147, v147
 v_mfma_f32_16x16x32_bf16 a[32:35], a[232:235], v[208:211], a[32:35]
 ds_read_b64_tr_b16 a[248:249], v24 offset:40960
 v_add_f32 v30, v30, v146
 v_mfma_f32_16x16x32_bf16 a[36:39], a[232:235], v[212:215], a[36:39]
 ds_read_b64_tr_b16 a[250:251], v24 offset:45056
 v_exp_f32 v148, v148
 v_mfma_f32_16x16x32_bf16 a[40:43], a[232:235], v[216:219], a[40:43]
 v_add_f32 v30, v30, v147
 v_cvt_pk_bf16_f32 v201, v146, v147
 v_mfma_f32_16x16x32_bf16 a[44:47], a[232:235], v[220:223], a[44:47]
 s_waitcnt lgkmcnt(6)
 v_exp_f32 v149, v149
 v_mfma_f32_16x16x32_bf16 a[60:63], a[236:239], v[220:223], a[60:63]
 ds_read_b64_tr_b16 a[252:253], v25 offset:40960
 v_add_f32 v30, v30, v148
 v_mfma_f32_16x16x32_bf16 a[56:59], a[236:239], v[216:219], a[56:59]
 ds_read_b64_tr_b16 a[254:255], v25 offset:45056
 v_exp_f32 v150, v150
 v_mfma_f32_16x16x32_bf16 a[52:55], a[236:239], v[212:215], a[52:55]
 v_add_f32 v30, v30, v149
 v_cvt_pk_bf16_f32 v202, v148, v149
 v_mfma_f32_16x16x32_bf16 a[48:51], a[236:239], v[208:211], a[48:51]
 s_waitcnt vmcnt(26)
 s_barrier
 s_waitcnt lgkmcnt(6)
 v_exp_f32 v151, v151
 v_mfma_f32_16x16x32_bf16 a[64:67], a[240:243], v[208:211], a[64:67]
 ds_read_b64_tr_b16 a[224:225], v18 offset:49152
 s_add_u32 m0, s79, 32768
 v_add_f32 v30, v30, v150
 v_mfma_f32_16x16x32_bf16 a[68:71], a[240:243], v[212:215], a[68:71]
 ds_read_b64_tr_b16 a[226:227], v18 offset:53248
 v_exp_f32 v152, v152
 v_mfma_f32_16x16x32_bf16 a[72:75], a[240:243], v[216:219], a[72:75]
 buffer_load_dwordx4 v40, s[12:15], s77 offen  lds
 v_add_f32 v30, v30, v151
 v_cvt_pk_bf16_f32 v203, v150, v151
 v_mfma_f32_16x16x32_bf16 a[76:79], a[240:243], v[220:223], a[76:79]
 s_waitcnt lgkmcnt(6)
 v_exp_f32 v153, v153
 v_mfma_f32_16x16x32_bf16 a[92:95], a[244:247], v[220:223], a[92:95]
 ds_read_b64_tr_b16 a[228:229], v19 offset:49152
 v_add_f32 v31, v31, v152
 v_mfma_f32_16x16x32_bf16 a[88:91], a[244:247], v[216:219], a[88:91]
 ds_read_b64_tr_b16 a[230:231], v19 offset:53248
 v_exp_f32 v154, v154
 v_mfma_f32_16x16x32_bf16 a[84:87], a[244:247], v[212:215], a[84:87]
 buffer_load_dwordx4 v41, s[12:15], s77 offen offset:1024  lds
 v_add_f32 v31, v31, v153
 v_cvt_pk_bf16_f32 v204, v152, v153
 v_mfma_f32_16x16x32_bf16 a[80:83], a[244:247], v[208:211], a[80:83]
 s_waitcnt lgkmcnt(6)
 v_exp_f32 v155, v155
 v_mfma_f32_16x16x32_bf16 a[96:99], a[248:251], v[208:211], a[96:99]
 ds_read_b64_tr_b16 a[232:233], v20 offset:49152
 v_add_f32 v31, v31, v154
 v_mfma_f32_16x16x32_bf16 a[100:103], a[248:251], v[212:215], a[100:103]
 ds_read_b64_tr_b16 a[234:235], v20 offset:53248
 v_exp_f32 v156, v156
 v_mfma_f32_16x16x32_bf16 a[104:107], a[248:251], v[216:219], a[104:107]
 v_add_f32 v31, v31, v155
 v_cvt_pk_bf16_f32 v205, v154, v155
 v_mfma_f32_16x16x32_bf16 a[108:111], a[248:251], v[220:223], a[108:111]
 s_waitcnt lgkmcnt(6)
 v_exp_f32 v157, v157
 v_mfma_f32_16x16x32_bf16 a[124:127], a[252:255], v[220:223], a[124:127]
 ds_read_b64_tr_b16 a[236:237], v21 offset:49152
 buffer_load_dwordx4 v42, s[12:15], s77 offen offset:2048  lds
 v_add_f32 v31, v31, v156
 v_mfma_f32_16x16x32_bf16 a[120:123], a[252:255], v[216:219], a[120:123]
 ds_read_b64_tr_b16 a[238:239], v21 offset:53248
 v_exp_f32 v158, v158
 v_mfma_f32_16x16x32_bf16 a[116:119], a[252:255], v[212:215], a[116:119]
 v_add_f32 v31, v31, v157
 v_cvt_pk_bf16_f32 v206, v156, v157
 v_mfma_f32_16x16x32_bf16 a[112:115], a[252:255], v[208:211], a[112:115]
 s_waitcnt lgkmcnt(6)
 v_exp_f32 v159, v159
 v_mfma_f32_16x16x32_bf16 a[0:3], a[224:227], v[192:195], a[0:3]
 ds_read_b64_tr_b16 a[240:241], v22 offset:49152
 v_add_f32 v31, v31, v158
 v_exp_f32 v160, v160
 v_mfma_f32_16x16x32_bf16 a[4:7], a[224:227], v[196:199], a[4:7]
 ds_read_b64_tr_b16 a[242:243], v22 offset:53248
 v_exp_f32 v161, v161
 v_mfma_f32_16x16x32_bf16 a[8:11], a[224:227], v[200:203], a[8:11]
 buffer_load_dwordx4 v43, s[12:15], s77 offen offset:3072  lds
 v_add_f32 v31, v31, v159
 v_cvt_pk_bf16_f32 v207, v158, v159
 v_add_f32 v28, v28, v160
 v_exp_f32 v162, v162
 v_mfma_f32_16x16x32_bf16 a[12:15], a[224:227], v[204:207], a[12:15]
 s_waitcnt lgkmcnt(6)
 v_cvt_pk_bf16_f32 v208, v160, v161
 v_add_f32 v28, v28, v161
 v_exp_f32 v163, v163
 v_mfma_f32_16x16x32_bf16 a[28:31], a[228:231], v[204:207], a[28:31]
 ds_read_b64_tr_b16 a[244:245], v23 offset:49152
 v_add_f32 v28, v28, v162
 v_exp_f32 v164, v164
 v_mfma_f32_16x16x32_bf16 a[24:27], a[228:231], v[200:203], a[24:27]
 ds_read_b64_tr_b16 a[246:247], v23 offset:53248
 v_cvt_pk_bf16_f32 v209, v162, v163
 v_add_f32 v28, v28, v163
 v_exp_f32 v165, v165
 v_mfma_f32_16x16x32_bf16 a[20:23], a[228:231], v[196:199], a[20:23]
 v_add_f32 v28, v28, v164
 v_exp_f32 v166, v166
 v_mfma_f32_16x16x32_bf16 a[16:19], a[228:231], v[192:195], a[16:19]
 s_waitcnt lgkmcnt(6)
 v_cvt_pk_bf16_f32 v210, v164, v165
 v_add_f32 v28, v28, v165
 v_exp_f32 v167, v167
 v_mfma_f32_16x16x32_bf16 a[32:35], a[232:235], v[192:195], a[32:35]
 ds_read_b64_tr_b16 a[248:249], v24 offset:49152
 s_add_u32 m0, s79, 36864
 v_add_f32 v28, v28, v166
 v_exp_f32 v168, v168
 v_mfma_f32_16x16x32_bf16 a[36:39], a[232:235], v[196:199], a[36:39]
 ds_read_b64_tr_b16 a[250:251], v24 offset:53248
 v_cvt_pk_bf16_f32 v211, v166, v167
 v_add_f32 v28, v28, v167
 v_exp_f32 v169, v169
 v_mfma_f32_16x16x32_bf16 a[40:43], a[232:235], v[200:203], a[40:43]
 buffer_load_dwordx4 v44, s[12:15], s77 offen  lds
 v_add_f32 v29, v29, v168
 v_exp_f32 v170, v170
 v_mfma_f32_16x16x32_bf16 a[44:47], a[232:235], v[204:207], a[44:47]
 s_waitcnt lgkmcnt(6)
 v_cvt_pk_bf16_f32 v212, v168, v169
 v_add_f32 v29, v29, v169
 v_exp_f32 v171, v171
 v_mfma_f32_16x16x32_bf16 a[60:63], a[236:239], v[204:207], a[60:63]
 ds_read_b64_tr_b16 a[252:253], v25 offset:49152
 v_add_f32 v29, v29, v170
 v_exp_f32 v172, v172
 v_mfma_f32_16x16x32_bf16 a[56:59], a[236:239], v[200:203], a[56:59]
 ds_read_b64_tr_b16 a[254:255], v25 offset:53248
 v_cvt_pk_bf16_f32 v213, v170, v171
 v_add_f32 v29, v29, v171
 v_exp_f32 v173, v173
 v_mfma_f32_16x16x32_bf16 a[52:55], a[236:239], v[196:199], a[52:55]
 buffer_load_dwordx4 v45, s[12:15], s77 offen offset:1024  lds
 v_add_f32 v29, v29, v172
 v_exp_f32 v174, v174
 v_mfma_f32_16x16x32_bf16 a[48:51], a[236:239], v[192:195], a[48:51]
 s_waitcnt lgkmcnt(6)
 v_cvt_pk_bf16_f32 v214, v172, v173
 v_add_f32 v29, v29, v173
 v_exp_f32 v175, v175
 v_mfma_f32_16x16x32_bf16 a[64:67], a[240:243], v[192:195], a[64:67]
 ds_read_b64_tr_b16 a[224:225], v18 offset:57344
 v_add_f32 v29, v29, v174
 v_exp_f32 v176, v176
 v_mfma_f32_16x16x32_bf16 a[68:71], a[240:243], v[196:199], a[68:71]
 ds_read_b64_tr_b16 a[226:227], v18 offset:61440
 v_cvt_pk_bf16_f32 v215, v174, v175
 v_add_f32 v29, v29, v175
 v_exp_f32 v177, v177
 v_mfma_f32_16x16x32_bf16 a[72:75], a[240:243], v[200:203], a[72:75]
 v_add_f32 v30, v30, v176
 v_exp_f32 v178, v178
 v_mfma_f32_16x16x32_bf16 a[76:79], a[240:243], v[204:207], a[76:79]
 s_waitcnt lgkmcnt(6)
 v_cvt_pk_bf16_f32 v216, v176, v177
 v_add_f32 v30, v30, v177
 v_exp_f32 v179, v179
 v_mfma_f32_16x16x32_bf16 a[92:95], a[244:247], v[204:207], a[92:95]
 ds_read_b64_tr_b16 a[228:229], v19 offset:57344
 buffer_load_dwordx4 v46, s[12:15], s77 offen offset:2048  lds
 v_add_f32 v30, v30, v178
 v_exp_f32 v180, v180
 v_mfma_f32_16x16x32_bf16 a[88:91], a[244:247], v[200:203], a[88:91]
 ds_read_b64_tr_b16 a[230:231], v19 offset:61440
 v_cvt_pk_bf16_f32 v217, v178, v179
 v_add_f32 v30, v30, v179
 v_exp_f32 v181, v181
 v_mfma_f32_16x16x32_bf16 a[84:87], a[244:247], v[196:199], a[84:87]
 v_add_f32 v30, v30, v180
 v_exp_f32 v182, v182
 v_mfma_f32_16x16x32_bf16 a[80:83], a[244:247], v[192:195], a[80:83]
 s_waitcnt lgkmcnt(6)
 v_cvt_pk_bf16_f32 v218, v180, v181
 v_add_f32 v30, v30, v181
 v_exp_f32 v183, v183
 v_mfma_f32_16x16x32_bf16 a[96:99], a[248:251], v[192:195], a[96:99]
 ds_read_b64_tr_b16 a[232:233], v20 offset:57344
 v_add_f32 v30, v30, v182
 v_exp_f32 v184, v184
 v_mfma_f32_16x16x32_bf16 a[100:103], a[248:251], v[196:199], a[100:103]
 ds_read_b64_tr_b16 a[234:235], v20 offset:61440
 v_cvt_pk_bf16_f32 v219, v182, v183
 v_add_f32 v30, v30, v183
 v_exp_f32 v185, v185
 v_mfma_f32_16x16x32_bf16 a[104:107], a[248:251], v[200:203], a[104:107]
 buffer_load_dwordx4 v47, s[12:15], s77 offen offset:3072  lds
 s_add_u32 s77, s77, 262144
 v_add_f32 v31, v31, v184
 v_exp_f32 v186, v186
 v_mfma_f32_16x16x32_bf16 a[108:111], a[248:251], v[204:207], a[108:111]
 s_waitcnt lgkmcnt(6)
 v_cvt_pk_bf16_f32 v220, v184, v185
 v_add_f32 v31, v31, v185
 v_exp_f32 v187, v187
 v_mfma_f32_16x16x32_bf16 a[124:127], a[252:255], v[204:207], a[124:127]
 ds_read_b64_tr_b16 a[236:237], v21 offset:57344
 v_add_f32 v31, v31, v186
 v_exp_f32 v188, v188
 v_mfma_f32_16x16x32_bf16 a[120:123], a[252:255], v[200:203], a[120:123]
 ds_read_b64_tr_b16 a[238:239], v21 offset:61440
 v_cvt_pk_bf16_f32 v221, v186, v187
 v_add_f32 v31, v31, v187
 v_exp_f32 v189, v189
 v_mfma_f32_16x16x32_bf16 a[116:119], a[252:255], v[196:199], a[116:119]
 v_add_f32 v31, v31, v188
 v_exp_f32 v190, v190
 v_mfma_f32_16x16x32_bf16 a[112:115], a[252:255], v[192:195], a[112:115]
 s_waitcnt lgkmcnt(6)
 v_cvt_pk_bf16_f32 v222, v188, v189
 v_add_f32 v31, v31, v189
 v_exp_f32 v191, v191
 v_mfma_f32_16x16x32_bf16 a[0:3], a[224:227], v[208:211], a[0:3]
 ds_read_b64_tr_b16 a[240:241], v22 offset:57344
 v_add_f32 v31, v31, v190
 v_mfma_f32_16x16x32_bf16 a[4:7], a[224:227], v[212:215], a[4:7]
 ds_read_b64_tr_b16 a[242:243], v22 offset:61440
 v_cvt_pk_bf16_f32 v223, v190, v191
 v_add_f32 v31, v31, v191
 v_mfma_f32_16x16x32_bf16 a[8:11], a[224:227], v[216:219], a[8:11]
 v_mov_b32 v36, v28
 v_mov_b32 v37, v29
 v_mfma_f32_16x16x32_bf16 a[12:15], a[224:227], v[220:223], a[12:15]
 s_waitcnt lgkmcnt(6)
 v_mov_b32 v38, v30
 v_mov_b32 v39, v31
 v_mfma_f32_16x16x32_bf16 a[28:31], a[228:231], v[220:223], a[28:31]
 ds_read_b64_tr_b16 a[244:245], v23 offset:57344
 v_mfma_f32_16x16x32_bf16 a[24:27], a[228:231], v[216:219], a[24:27]
 ds_read_b64_tr_b16 a[246:247], v23 offset:61440
 v_permlane16_swap_b32 v28, v36
 v_mfma_f32_16x16x32_bf16 a[20:23], a[228:231], v[212:215], a[20:23]
 v_permlane16_swap_b32 v29, v37
 v_mfma_f32_16x16x32_bf16 a[16:19], a[228:231], v[208:211], a[16:19]
 s_waitcnt lgkmcnt(6)
 v_permlane16_swap_b32 v30, v38
 v_mfma_f32_16x16x32_bf16 a[32:35], a[232:235], v[208:211], a[32:35]
 ds_read_b64_tr_b16 a[248:249], v24 offset:57344
 v_permlane16_swap_b32 v31, v39
 v_mfma_f32_16x16x32_bf16 a[36:39], a[232:235], v[212:215], a[36:39]
 ds_read_b64_tr_b16 a[250:251], v24 offset:61440
 v_mfma_f32_16x16x32_bf16 a[40:43], a[232:235], v[216:219], a[40:43]
 v_add_f32 v28, v28, v36
 v_add_f32 v29, v29, v37
 v_mfma_f32_16x16x32_bf16 a[44:47], a[232:235], v[220:223], a[44:47]
 s_waitcnt lgkmcnt(6)
 v_add_f32 v30, v30, v38
 v_add_f32 v31, v31, v39
 v_mfma_f32_16x16x32_bf16 a[60:63], a[236:239], v[220:223], a[60:63]
 ds_read_b64_tr_b16 a[252:253], v25 offset:57344
 v_mov_b32 v36, v28
 v_mov_b32 v37, v29
 v_mfma_f32_16x16x32_bf16 a[56:59], a[236:239], v[216:219], a[56:59]
 ds_read_b64_tr_b16 a[254:255], v25 offset:61440
 v_mov_b32 v38, v30
 v_mov_b32 v39, v31
 v_mfma_f32_16x16x32_bf16 a[52:55], a[236:239], v[212:215], a[52:55]
 v_mfma_f32_16x16x32_bf16 a[48:51], a[236:239], v[208:211], a[48:51]
 s_waitcnt lgkmcnt(6)
 v_permlane32_swap_b32 v28, v36
 v_mfma_f32_16x16x32_bf16 a[64:67], a[240:243], v[208:211], a[64:67]
 v_permlane32_swap_b32 v29, v37
 v_mfma_f32_16x16x32_bf16 a[68:71], a[240:243], v[212:215], a[68:71]
 v_permlane32_swap_b32 v30, v38
 v_mfma_f32_16x16x32_bf16 a[72:75], a[240:243], v[216:219], a[72:75]
 v_permlane32_swap_b32 v31, v39
 v_mfma_f32_16x16x32_bf16 a[76:79], a[240:243], v[220:223], a[76:79]
 s_waitcnt lgkmcnt(4)
 v_mfma_f32_16x16x32_bf16 a[92:95], a[244:247], v[220:223], a[92:95]
 v_add_f32 v28, v28, v36
 v_add_f32 v29, v29, v37
 v_mfma_f32_16x16x32_bf16 a[88:91], a[244:247], v[216:219], a[88:91]
 v_add_f32 v30, v30, v38
 v_add_f32 v31, v31, v39
 v_mfma_f32_16x16x32_bf16 a[84:87], a[244:247], v[212:215], a[84:87]
 v_add_f32 v36, v28, v29
 v_add_f32 v37, v30, v31
 v_mfma_f32_16x16x32_bf16 a[80:83], a[244:247], v[208:211], a[80:83]
 s_mov_b32 s52, 0x53800000
 s_waitcnt lgkmcnt(2)
 v_add_f32 v36, v36, v37
 v_mfma_f32_16x16x32_bf16 a[96:99], a[248:251], v[208:211], a[96:99]
 v_cmp_nlt_f32 vcc, v36, s52
 v_mfma_f32_16x16x32_bf16 a[100:103], a[248:251], v[212:215], a[100:103]
 v_mfma_f32_16x16x32_bf16 a[104:107], a[248:251], v[216:219], a[104:107]
 v_mfma_f32_16x16x32_bf16 a[108:111], a[248:251], v[220:223], a[108:111]
 s_waitcnt lgkmcnt(0)
 v_mfma_f32_16x16x32_bf16 a[124:127], a[252:255], v[220:223], a[124:127]
 v_mfma_f32_16x16x32_bf16 a[120:123], a[252:255], v[216:219], a[120:123]
 v_mfma_f32_16x16x32_bf16 a[116:119], a[252:255], v[212:215], a[116:119]
 v_mfma_f32_16x16x32_bf16 a[112:115], a[252:255], v[208:211], a[112:115]
 s_cbranch_vccnz A_slow
A_done:
 buffer_load_dwordx4 a[192:195], v48, s[16:19], s78 offen sc1
 buffer_load_dwordx4 a[196:199], v49, s[16:19], s78 offen sc1
 buffer_load_dwordx4 a[200:203], v50, s[16:19], s78 offen sc1
 buffer_load_dwordx4 a[204:207], v51, s[16:19], s78 offen sc1
 v_rcp_f32 v28, v28
 v_rcp_f32 v29, v29
 v_rcp_f32 v30, v30
 v_rcp_f32 v31, v31
 s_waitcnt vmcnt(29)
 s_barrier
 ds_read_b64_tr_b16 v[64:65], v52
 ds_read_b64_tr_b16 v[66:67], v52 offset:4096
 ds_read_b64_tr_b16 v[68:69], v52 offset:8192
 ds_read_b64_tr_b16 v[70:71], v52 offset:12288
 ds_read_b64_tr_b16 v[72:73], v53
 ds_read_b64_tr_b16 v[74:75], v53 offset:4096
 ds_read_b64_tr_b16 v[76:77], v53 offset:8192
 ds_read_b64_tr_b16 v[78:79], v53 offset:12288
 ds_read_b64_tr_b16 v[80:81], v54
 ds_read_b64_tr_b16 v[82:83], v54 offset:4096
 s_bitcmp1_b32 s70, 0
 s_cbranch_scc1 C_short

 s_waitcnt vmcnt(28) lgkmcnt(8)
 v_mfma_f32_16x16x32_bf16 v[128:131], v[64:67], a[128:131], 0
 ds_read_b64_tr_b16 v[84:85], v54 offset:8192
 buffer_load_dwordx4 a[208:211], v48, s[16:19], s78 offen offset:1024 sc1
 s_waitcnt vmcnt(25) lgkmcnt(7)
 v_mfma_f32_16x16x32_bf16 v[128:131], v[68:71], a[144:147], v[128:131]
 ds_read_b64_tr_b16 v[86:87], v54 offset:12288
 s_waitcnt vmcnt(24)
 v_mfma_f32_16x16x32_bf16 v[132:135], v[68:71], a[148:151], 0
 s_lshl_b32 s50, s37, 4
 s_lshl_b32 s51, s36, 2
 v_mfma_f32_16x16x32_bf16 v[132:135], v[64:67], a[132:135], v[132:135]
 s_add_u32 s50, s50, s51
 v_mfma_f32_16x16x32_bf16 v[136:139], v[64:67], a[136:139], 0
 ds_read_b64_tr_b16 v[88:89], v55
 s_add_u32 m0, s79, 65536
 s_waitcnt vmcnt(23)
 v_mfma_f32_16x16x32_bf16 v[136:139], v[68:71], a[152:155], v[136:139]
 ds_read_b64_tr_b16 v[90:91], v55 offset:4096
 s_mul_i32 s50, s50, 131328
 s_waitcnt vmcnt(22)
 v_mfma_f32_16x16x32_bf16 v[140:143], v[68:71], a[156:159], 0
 buffer_load_dwordx4 v40, s[12:15], s77 offen  lds
 s_lshl_b32 s51, s38, 12
 v_mfma_f32_16x16x32_bf16 v[140:143], v[64:67], a[140:143], v[140:143]
 s_waitcnt lgkmcnt(6)
 v_mfma_f32_16x16x32_bf16 v[156:159], v[72:75], a[140:143], 0
 ds_read_b64_tr_b16 v[92:93], v55 offset:8192
 buffer_load_dwordx4 a[212:215], v49, s[16:19], s78 offen offset:1024 sc1
 v_mfma_f32_16x16x32_bf16 v[156:159], v[76:79], a[156:159], v[156:159]
 ds_read_b64_tr_b16 v[94:95], v55 offset:12288
 s_add_u32 s50, s50, s51
 v_mfma_f32_16x16x32_bf16 v[152:155], v[76:79], a[152:155], 0
 v_lshlrev_b32 v34, 4, v1
 v_accvgpr_read_b32 v96, a0
 v_mfma_f32_16x16x32_bf16 v[152:155], v[72:75], a[136:139], v[152:155]
 v_accvgpr_read_b32 v97, a1
 v_mfma_f32_16x16x32_bf16 v[148:151], v[72:75], a[132:135], 0
 ds_read_b64_tr_b16 v[64:65], v56
 v_accvgpr_read_b32 v98, a2
 v_mfma_f32_16x16x32_bf16 v[148:151], v[76:79], a[148:151], v[148:151]
 ds_read_b64_tr_b16 v[66:67], v56 offset:4096
 v_accvgpr_read_b32 v99, a3
 v_mfma_f32_16x16x32_bf16 v[144:147], v[76:79], a[144:147], 0
 v_accvgpr_read_b32 v100, a16
 v_accvgpr_read_b32 v101, a17
 v_mfma_f32_16x16x32_bf16 v[144:147], v[72:75], a[128:131], v[144:147]
 s_waitcnt lgkmcnt(6)
 v_mfma_f32_16x16x32_bf16 v[160:163], v[80:83], a[128:131], 0
 ds_read_b64_tr_b16 v[68:69], v56 offset:8192
 buffer_load_dwordx4 a[216:219], v50, s[16:19], s78 offen offset:1024 sc1
 v_mfma_f32_16x16x32_bf16 v[160:163], v[84:87], a[144:147], v[160:163]
 ds_read_b64_tr_b16 v[70:71], v56 offset:12288
 v_accvgpr_read_b32 v102, a18
 v_mfma_f32_16x16x32_bf16 v[164:167], v[84:87], a[148:151], 0
 v_accvgpr_read_b32 v103, a19
 v_mul_f32 v96, v96, v28
 v_mfma_f32_16x16x32_bf16 v[164:167], v[80:83], a[132:135], v[164:167]
 v_mul_f32 v97, v97, v28
 v_mfma_f32_16x16x32_bf16 v[168:171], v[80:83], a[136:139], 0
 ds_read_b64_tr_b16 v[72:73], v57
 buffer_load_dwordx4 v41, s[12:15], s77 offen offset:1024  lds
 v_mfma_f32_16x16x32_bf16 v[168:171], v[84:87], a[152:155], v[168:171]
 ds_read_b64_tr_b16 v[74:75], v57 offset:4096
 v_mul_f32 v98, v98, v28
 v_mfma_f32_16x16x32_bf16 v[172:175], v[84:87], a[156:159], 0
 v_mul_f32 v99, v99, v28
 v_mul_f32 v100, v100, v28
 v_mfma_f32_16x16x32_bf16 v[172:175], v[80:83], a[140:143], v[172:175]
 s_waitcnt lgkmcnt(6)
 v_mfma_f32_16x16x32_bf16 v[188:191], v[88:91], a[140:143], 0
 ds_read_b64_tr_b16 v[76:77], v57 offset:8192
 buffer_load_dwordx4 a[220:223], v51, s[16:19], s78 offen offset:1024 sc1
 v_mfma_f32_16x16x32_bf16 v[188:191], v[92:95], a[156:159], v[188:191]
 ds_read_b64_tr_b16 v[78:79], v57 offset:12288
 v_mul_f32 v101, v101, v28
 v_mfma_f32_16x16x32_bf16 v[184:187], v[92:95], a[152:155], 0
 v_mul_f32 v102, v102, v28
 v_mul_f32 v103, v103, v28
 v_mfma_f32_16x16x32_bf16 v[184:187], v[88:91], a[136:139], v[184:187]
 v_cvt_pk_bf16_f32 v112, v96, v97
 v_mfma_f32_16x16x32_bf16 v[180:183], v[88:91], a[132:135], 0
 ds_read_b64_tr_b16 v[80:81], v58
 v_cvt_pk_bf16_f32 v113, v98, v99
 v_mfma_f32_16x16x32_bf16 v[180:183], v[92:95], a[148:151], v[180:183]
 ds_read_b64_tr_b16 v[82:83], v58 offset:4096
 v_cvt_pk_bf16_f32 v114, v100, v101
 v_mfma_f32_16x16x32_bf16 v[176:179], v[92:95], a[144:147], 0
 v_cvt_pk_bf16_f32 v115, v102, v103
 buffer_store_dwordx4 v[112:115], v34, s[32:35], s50 offen sc1
 v_mfma_f32_16x16x32_bf16 v[176:179], v[88:91], a[128:131], v[176:179]
 s_waitcnt lgkmcnt(6)
 v_mfma_f32_16x16x32_bf16 v[192:195], v[64:67], a[128:131], 0
 ds_read_b64_tr_b16 v[84:85], v58 offset:8192
 buffer_load_dwordx4 a[224:227], v48, s[16:19], s78 offen offset:2048 sc1
 v_mfma_f32_16x16x32_bf16 v[192:195], v[68:71], a[144:147], v[192:195]
 ds_read_b64_tr_b16 v[86:87], v58 offset:12288
 v_accvgpr_read_b32 v104, a32
 v_mfma_f32_16x16x32_bf16 v[196:199], v[68:71], a[148:151], 0
 v_accvgpr_read_b32 v105, a33
 v_accvgpr_read_b32 v106, a34
 v_mfma_f32_16x16x32_bf16 v[196:199], v[64:67], a[132:135], v[196:199]
 v_accvgpr_read_b32 v107, a35
 v_mfma_f32_16x16x32_bf16 v[200:203], v[64:67], a[136:139], 0
 ds_read_b64_tr_b16 v[88:89], v59
 buffer_load_dwordx4 v42, s[12:15], s77 offen offset:2048  lds
 v_mfma_f32_16x16x32_bf16 v[200:203], v[68:71], a[152:155], v[200:203]
 ds_read_b64_tr_b16 v[90:91], v59 offset:4096
 v_accvgpr_read_b32 v108, a48
 v_mfma_f32_16x16x32_bf16 v[204:207], v[68:71], a[156:159], 0
 v_accvgpr_read_b32 v109, a49
 v_accvgpr_read_b32 v110, a50
 v_mfma_f32_16x16x32_bf16 v[204:207], v[64:67], a[140:143], v[204:207]
 s_waitcnt lgkmcnt(6)
 v_mfma_f32_16x16x32_bf16 v[220:223], v[72:75], a[140:143], 0
 ds_read_b64_tr_b16 v[92:93], v59 offset:8192
 buffer_load_dwordx4 a[228:231], v49, s[16:19], s78 offen offset:2048 sc1
 v_mfma_f32_16x16x32_bf16 v[220:223], v[76:79], a[156:159], v[220:223]
 ds_read_b64_tr_b16 v[94:95], v59 offset:12288
 v_accvgpr_read_b32 v111, a51
 v_mfma_f32_16x16x32_bf16 v[216:219], v[76:79], a[152:155], 0
 v_mul_f32 v104, v104, v28
 v_mul_f32 v105, v105, v28
 v_mfma_f32_16x16x32_bf16 v[216:219], v[72:75], a[136:139], v[216:219]
 v_mul_f32 v106, v106, v28
 v_mfma_f32_16x16x32_bf16 v[212:215], v[72:75], a[132:135], 0
 ds_read_b64_tr_b16 v[64:65], v52 offset:16384
 v_mul_f32 v107, v107, v28
 v_mfma_f32_16x16x32_bf16 v[212:215], v[76:79], a[148:151], v[212:215]
 ds_read_b64_tr_b16 v[66:67], v52 offset:20480
 v_mul_f32 v108, v108, v28
 v_mfma_f32_16x16x32_bf16 v[208:211], v[76:79], a[144:147], 0
 v_mul_f32 v109, v109, v28
 v_mul_f32 v110, v110, v28
 v_mfma_f32_16x16x32_bf16 v[208:211], v[72:75], a[128:131], v[208:211]
 s_waitcnt lgkmcnt(6)
 v_mfma_f32_16x16x32_bf16 v[224:227], v[80:83], a[128:131], 0
 ds_read_b64_tr_b16 v[68:69], v52 offset:24576
 buffer_load_dwordx4 a[232:235], v50, s[16:19], s78 offen offset:2048 sc1
 v_mfma_f32_16x16x32_bf16 v[224:227], v[84:87], a[144:147], v[224:227]
 ds_read_b64_tr_b16 v[70:71], v52 offset:28672
 v_mul_f32 v111, v111, v28
 v_mfma_f32_16x16x32_bf16 v[228:231], v[84:87], a[148:151], 0
 v_cvt_pk_bf16_f32 v116, v104, v105
 v_cvt_pk_bf16_f32 v117, v106, v107
 v_mfma_f32_16x16x32_bf16 v[228:231], v[80:83], a[132:135], v[228:231]
 v_cvt_pk_bf16_f32 v118, v108, v109
 v_mfma_f32_16x16x32_bf16 v[232:235], v[80:83], a[136:139], 0
 ds_read_b64_tr_b16 v[72:73], v53 offset:16384
 buffer_load_dwordx4 v43, s[12:15], s77 offen offset:3072  lds
 v_mfma_f32_16x16x32_bf16 v[232:235], v[84:87], a[152:155], v[232:235]
 ds_read_b64_tr_b16 v[74:75], v53 offset:20480
 v_cvt_pk_bf16_f32 v119, v110, v111
 v_mfma_f32_16x16x32_bf16 v[236:239], v[84:87], a[156:159], 0
 buffer_store_dwordx4 v[116:119], v34, s[32:35], s50 offen offset:1024 sc1
 v_accvgpr_read_b32 v96, a64
 v_mfma_f32_16x16x32_bf16 v[236:239], v[80:83], a[140:143], v[236:239]
 s_waitcnt lgkmcnt(6)
 v_mfma_f32_16x16x32_bf16 v[252:255], v[88:91], a[140:143], 0
 ds_read_b64_tr_b16 v[76:77], v53 offset:24576
 buffer_load_dwordx4 a[236:239], v51, s[16:19], s78 offen offset:2048 sc1
 v_mfma_f32_16x16x32_bf16 v[252:255], v[92:95], a[156:159], v[252:255]
 ds_read_b64_tr_b16 v[78:79], v53 offset:28672
 v_accvgpr_read_b32 v97, a65
 v_mfma_f32_16x16x32_bf16 v[248:251], v[92:95], a[152:155], 0
 v_accvgpr_read_b32 v98, a66
 v_accvgpr_read_b32 v99, a67
 v_mfma_f32_16x16x32_bf16 v[248:251], v[88:91], a[136:139], v[248:251]
 v_accvgpr_read_b32 v100, a80
 v_mfma_f32_16x16x32_bf16 v[244:247], v[88:91], a[132:135], 0
 ds_read_b64_tr_b16 v[80:81], v54 offset:16384
 v_accvgpr_read_b32 v101, a81
 v_mfma_f32_16x16x32_bf16 v[244:247], v[92:95], a[148:151], v[244:247]
 ds_read_b64_tr_b16 v[82:83], v54 offset:20480
 v_accvgpr_read_b32 v102, a82
 v_mfma_f32_16x16x32_bf16 v[240:243], v[92:95], a[144:147], 0
 v_accvgpr_read_b32 v103, a83
 v_mul_f32 v96, v96, v28
 v_mfma_f32_16x16x32_bf16 v[240:243], v[88:91], a[128:131], v[240:243]
 s_waitcnt lgkmcnt(6)
 s_waitcnt vmcnt(34)
 v_mfma_f32_16x16x32_bf16 v[128:131], v[64:67], a[160:163], v[128:131]
 ds_read_b64_tr_b16 v[84:85], v54 offset:24576
 buffer_load_dwordx4 a[240:243], v48, s[16:19], s78 offen offset:3072 sc1
 s_waitcnt vmcnt(30)
 v_mfma_f32_16x16x32_bf16 v[128:131], v[68:71], a[176:179], v[128:131]
 ds_read_b64_tr_b16 v[86:87], v54 offset:28672
 s_waitcnt vmcnt(29)
 v_mul_f32 v97, v97, v28
 v_mfma_f32_16x16x32_bf16 v[132:135], v[68:71], a[180:183], v[132:135]
 v_mul_f32 v98, v98, v28
 v_mul_f32 v99, v99, v28
 v_mfma_f32_16x16x32_bf16 v[132:135], v[64:67], a[164:167], v[132:135]
 v_mul_f32 v100, v100, v28
 v_mfma_f32_16x16x32_bf16 v[136:139], v[64:67], a[168:171], v[136:139]
 ds_read_b64_tr_b16 v[88:89], v55 offset:16384
 s_add_u32 m0, s79, 69632
 s_waitcnt vmcnt(28)
 v_mfma_f32_16x16x32_bf16 v[136:139], v[68:71], a[184:187], v[136:139]
 ds_read_b64_tr_b16 v[90:91], v55 offset:20480
 s_waitcnt vmcnt(27)
 v_mul_f32 v101, v101, v28
 v_mfma_f32_16x16x32_bf16 v[140:143], v[68:71], a[188:191], v[140:143]
 buffer_load_dwordx4 v44, s[12:15], s77 offen  lds
 v_mul_f32 v102, v102, v28
 v_mfma_f32_16x16x32_bf16 v[140:143], v[64:67], a[172:175], v[140:143]
 s_waitcnt lgkmcnt(6)
 v_mfma_f32_16x16x32_bf16 v[156:159], v[72:75], a[172:175], v[156:159]
 ds_read_b64_tr_b16 v[92:93], v55 offset:24576
 buffer_load_dwordx4 a[244:247], v49, s[16:19], s78 offen offset:3072 sc1
 v_mfma_f32_16x16x32_bf16 v[156:159], v[76:79], a[188:191], v[156:159]
 ds_read_b64_tr_b16 v[94:95], v55 offset:28672
 v_mul_f32 v103, v103, v28
 v_mfma_f32_16x16x32_bf16 v[152:155], v[76:79], a[184:187], v[152:155]
 v_cvt_pk_bf16_f32 v120, v96, v97
 v_cvt_pk_bf16_f32 v121, v98, v99
 v_mfma_f32_16x16x32_bf16 v[152:155], v[72:75], a[168:171], v[152:155]
 v_cvt_pk_bf16_f32 v122, v100, v101
 v_mfma_f32_16x16x32_bf16 v[148:151], v[72:75], a[164:167], v[148:151]
 ds_read_b64_tr_b16 v[64:65], v56 offset:16384
 v_cvt_pk_bf16_f32 v123, v102, v103
 v_mfma_f32_16x16x32_bf16 v[148:151], v[76:79], a[180:183], v[148:151]
 ds_read_b64_tr_b16 v[66:67], v56 offset:20480
 buffer_store_dwordx4 v[120:123], v34, s[32:35], s50 offen offset:2048 sc1
 v_mfma_f32_16x16x32_bf16 v[144:147], v[76:79], a[176:179], v[144:147]
 v_accvgpr_read_b32 v104, a96
 v_accvgpr_read_b32 v105, a97
 v_mfma_f32_16x16x32_bf16 v[144:147], v[72:75], a[160:163], v[144:147]
 s_waitcnt lgkmcnt(6)
 v_mfma_f32_16x16x32_bf16 v[160:163], v[80:83], a[160:163], v[160:163]
 ds_read_b64_tr_b16 v[68:69], v56 offset:24576
 buffer_load_dwordx4 a[248:251], v50, s[16:19], s78 offen offset:3072 sc1
 v_mfma_f32_16x16x32_bf16 v[160:163], v[84:87], a[176:179], v[160:163]
 ds_read_b64_tr_b16 v[70:71], v56 offset:28672
 v_accvgpr_read_b32 v106, a98
 v_mfma_f32_16x16x32_bf16 v[164:167], v[84:87], a[180:183], v[164:167]
 v_accvgpr_read_b32 v107, a99
 v_accvgpr_read_b32 v108, a112
 v_mfma_f32_16x16x32_bf16 v[164:167], v[80:83], a[164:167], v[164:167]
 v_accvgpr_read_b32 v109, a113
 v_mfma_f32_16x16x32_bf16 v[168:171], v[80:83], a[168:171], v[168:171]
 ds_read_b64_tr_b16 v[72:73], v57 offset:16384
 buffer_load_dwordx4 v45, s[12:15], s77 offen offset:1024  lds
 v_mfma_f32_16x16x32_bf16 v[168:171], v[84:87], a[184:187], v[168:171]
 ds_read_b64_tr_b16 v[74:75], v57 offset:20480
 v_accvgpr_read_b32 v110, a114
 v_mfma_f32_16x16x32_bf16 v[172:175], v[84:87], a[188:191], v[172:175]
 v_accvgpr_read_b32 v111, a115
 v_mul_f32 v104, v104, v28
 v_mfma_f32_16x16x32_bf16 v[172:175], v[80:83], a[172:175], v[172:175]
 s_waitcnt lgkmcnt(6)
 v_mfma_f32_16x16x32_bf16 v[188:191], v[88:91], a[172:175], v[188:191]
 ds_read_b64_tr_b16 v[76:77], v57 offset:24576
 buffer_load_dwordx4 a[252:255], v51, s[16:19], s78 offen offset:3072 sc1
 v_mfma_f32_16x16x32_bf16 v[188:191], v[92:95], a[188:191], v[188:191]
 ds_read_b64_tr_b16 v[78:79], v57 offset:28672
 s_add_u32 s78, s78, 4096
 v_mfma_f32_16x16x32_bf16 v[184:187], v[92:95], a[184:187], v[184:187]
 v_mul_f32 v105, v105, v28
 v_mul_f32 v106, v106, v28
 v_mfma_f32_16x16x32_bf16 v[184:187], v[88:91], a[168:171], v[184:187]
 v_mul_f32 v107, v107, v28
 v_mfma_f32_16x16x32_bf16 v[180:183], v[88:91], a[164:167], v[180:183]
 ds_read_b64_tr_b16 v[80:81], v58 offset:16384
 v_mul_f32 v108, v108, v28
 v_mfma_f32_16x16x32_bf16 v[180:183], v[92:95], a[180:183], v[180:183]
 ds_read_b64_tr_b16 v[82:83], v58 offset:20480
 v_mul_f32 v109, v109, v28
 v_mfma_f32_16x16x32_bf16 v[176:179], v[92:95], a[176:179], v[176:179]
 v_mul_f32 v110, v110, v28
 v_mul_f32 v111, v111, v28
 v_mfma_f32_16x16x32_bf16 v[176:179], v[88:91], a[160:163], v[176:179]
 s_waitcnt lgkmcnt(6)
 v_mfma_f32_16x16x32_bf16 v[192:195], v[64:67], a[160:163], v[192:195]
 ds_read_b64_tr_b16 v[84:85], v58 offset:24576
 buffer_load_dwordx4 a[128:131], v48, s[16:19], s78 offen sc1
 v_mfma_f32_16x16x32_bf16 v[192:195], v[68:71], a[176:179], v[192:195]
 ds_read_b64_tr_b16 v[86:87], v58 offset:28672
 v_cvt_pk_bf16_f32 v124, v104, v105
 v_mfma_f32_16x16x32_bf16 v[196:199], v[68:71], a[180:183], v[196:199]
 v_cvt_pk_bf16_f32 v125, v106, v107
 v_cvt_pk_bf16_f32 v126, v108, v109
 v_mfma_f32_16x16x32_bf16 v[196:199], v[64:67], a[164:167], v[196:199]
 v_cvt_pk_bf16_f32 v127, v110, v111
 v_mfma_f32_16x16x32_bf16 v[200:203], v[64:67], a[168:171], v[200:203]
 ds_read_b64_tr_b16 v[88:89], v59 offset:16384
 buffer_load_dwordx4 v46, s[12:15], s77 offen offset:2048  lds
 v_mfma_f32_16x16x32_bf16 v[200:203], v[68:71], a[184:187], v[200:203]
 ds_read_b64_tr_b16 v[90:91], v59 offset:20480
 buffer_store_dwordx4 v[124:127], v34, s[32:35], s50 offen offset:3072 sc1
 v_mfma_f32_16x16x32_bf16 v[204:207], v[68:71], a[188:191], v[204:207]
 s_add_u32 s50, s50, 131328
 v_accvgpr_read_b32 v96, a4
 v_mfma_f32_16x16x32_bf16 v[204:207], v[64:67], a[172:175], v[204:207]
 s_waitcnt lgkmcnt(6)
 v_mfma_f32_16x16x32_bf16 v[220:223], v[72:75], a[172:175], v[220:223]
 ds_read_b64_tr_b16 v[92:93], v59 offset:24576
 buffer_load_dwordx4 a[132:135], v49, s[16:19], s78 offen sc1
 v_mfma_f32_16x16x32_bf16 v[220:223], v[76:79], a[188:191], v[220:223]
 ds_read_b64_tr_b16 v[94:95], v59 offset:28672
 v_accvgpr_read_b32 v97, a5
 v_mfma_f32_16x16x32_bf16 v[216:219], v[76:79], a[184:187], v[216:219]
 v_accvgpr_read_b32 v98, a6
 v_accvgpr_read_b32 v99, a7
 v_mfma_f32_16x16x32_bf16 v[216:219], v[72:75], a[168:171], v[216:219]
 s_waitcnt vmcnt(29)
 s_barrier
 v_mfma_f32_16x16x32_bf16 v[212:215], v[72:75], a[164:167], v[212:215]
 ds_read_b64_tr_b16 v[64:65], v52 offset:32768
 v_accvgpr_read_b32 v100, a20
 v_mfma_f32_16x16x32_bf16 v[212:215], v[76:79], a[180:183], v[212:215]
 ds_read_b64_tr_b16 v[66:67], v52 offset:36864
 v_accvgpr_read_b32 v101, a21
 v_mfma_f32_16x16x32_bf16 v[208:211], v[76:79], a[176:179], v[208:211]
 v_accvgpr_read_b32 v102, a22
 v_accvgpr_read_b32 v103, a23
 v_mfma_f32_16x16x32_bf16 v[208:211], v[72:75], a[160:163], v[208:211]
 s_waitcnt lgkmcnt(6)
 v_mfma_f32_16x16x32_bf16 v[224:227], v[80:83], a[160:163], v[224:227]
 ds_read_b64_tr_b16 v[68:69], v52 offset:40960
 buffer_load_dwordx4 a[136:139], v50, s[16:19], s78 offen sc1
 v_mfma_f32_16x16x32_bf16 v[224:227], v[84:87], a[176:179], v[224:227]
 ds_read_b64_tr_b16 v[70:71], v52 offset:45056
 v_mul_f32 v96, v96, v29
 v_mfma_f32_16x16x32_bf16 v[228:231], v[84:87], a[180:183], v[228:231]
 v_mul_f32 v97, v97, v29
 v_mul_f32 v98, v98, v29
 v_mfma_f32_16x16x32_bf16 v[228:231], v[80:83], a[164:167], v[228:231]
 v_mul_f32 v99, v99, v29
 v_mfma_f32_16x16x32_bf16 v[232:235], v[80:83], a[168:171], v[232:235]
 ds_read_b64_tr_b16 v[72:73], v53 offset:32768
 buffer_load_dwordx4 v47, s[12:15], s77 offen offset:3072  lds
 v_mfma_f32_16x16x32_bf16 v[232:235], v[84:87], a[184:187], v[232:235]
 ds_read_b64_tr_b16 v[74:75], v53 offset:36864
 s_add_u32 s77, s77, 262144
 v_mfma_f32_16x16x32_bf16 v[236:239], v[84:87], a[188:191], v[236:239]
 v_mul_f32 v100, v100, v29
 v_mul_f32 v101, v101, v29
 v_mfma_f32_16x16x32_bf16 v[236:239], v[80:83], a[172:175], v[236:239]
 s_waitcnt lgkmcnt(6)
 v_mfma_f32_16x16x32_bf16 v[252:255], v[88:91], a[172:175], v[252:255]
 ds_read_b64_tr_b16 v[76:77], v53 offset:40960
 buffer_load_dwordx4 a[140:143], v51, s[16:19], s78 offen sc1
 v_mfma_f32_16x16x32_bf16 v[252:255], v[92:95], a[188:191], v[252:255]
 ds_read_b64_tr_b16 v[78:79], v53 offset:45056
 buffer_load_dword v61, v0, s[60:63], 0 offen
 v_mfma_f32_16x16x32_bf16 v[248:251], v[92:95], a[184:187], v[248:251]
 v_mul_f32 v102, v102, v29
 v_mul_f32 v103, v103, v29
 v_mfma_f32_16x16x32_bf16 v[248:251], v[88:91], a[168:171], v[248:251]
 v_cvt_pk_bf16_f32 v112, v96, v97
 v_mfma_f32_16x16x32_bf16 v[244:247], v[88:91], a[164:167], v[244:247]
 ds_read_b64_tr_b16 v[80:81], v54 offset:32768
 v_cvt_pk_bf16_f32 v113, v98, v99
 v_mfma_f32_16x16x32_bf16 v[244:247], v[92:95], a[180:183], v[244:247]
 ds_read_b64_tr_b16 v[82:83], v54 offset:36864
 v_cvt_pk_bf16_f32 v114, v100, v101
 v_mfma_f32_16x16x32_bf16 v[240:243], v[92:95], a[176:179], v[240:243]
 v_cvt_pk_bf16_f32 v115, v102, v103
 buffer_store_dwordx4 v[112:115], v34, s[32:35], s50 offen sc1
 v_mfma_f32_16x16x32_bf16 v[240:243], v[88:91], a[160:163], v[240:243]
 s_waitcnt lgkmcnt(6)
 s_waitcnt vmcnt(33)
 v_mfma_f32_16x16x32_bf16 v[128:131], v[64:67], a[192:195], v[128:131]
 ds_read_b64_tr_b16 v[84:85], v54 offset:40960
 buffer_load_dwordx4 a[144:147], v48, s[16:19], s78 offen offset:1024 sc1
 s_waitcnt vmcnt(30)
 v_mfma_f32_16x16x32_bf16 v[128:131], v[68:71], a[208:211], v[128:131]
 ds_read_b64_tr_b16 v[86:87], v54 offset:45056
 s_waitcnt vmcnt(28)
 v_accvgpr_read_b32 v104, a36
 v_mfma_f32_16x16x32_bf16 v[132:135], v[68:71], a[212:215], v[132:135]
 v_accvgpr_read_b32 v105, a37
 v_accvgpr_read_b32 v106, a38
 v_mfma_f32_16x16x32_bf16 v[132:135], v[64:67], a[196:199], v[132:135]
 v_accvgpr_read_b32 v107, a39
 v_mfma_f32_16x16x32_bf16 v[136:139], v[64:67], a[200:203], v[136:139]
 ds_read_b64_tr_b16 v[88:89], v55 offset:32768
 s_add_u32 m0, s79, 98304
 s_waitcnt vmcnt(27)
 v_mfma_f32_16x16x32_bf16 v[136:139], v[68:71], a[216:219], v[136:139]
 ds_read_b64_tr_b16 v[90:91], v55 offset:36864
 s_waitcnt vmcnt(25)
 v_accvgpr_read_b32 v108, a52
 v_mfma_f32_16x16x32_bf16 v[140:143], v[68:71], a[220:223], v[140:143]
 buffer_load_dwordx4 v40, s[12:15], s77 offen  lds
 v_accvgpr_read_b32 v109, a53
 v_mfma_f32_16x16x32_bf16 v[140:143], v[64:67], a[204:207], v[140:143]
 s_waitcnt lgkmcnt(6)
 v_mfma_f32_16x16x32_bf16 v[156:159], v[72:75], a[204:207], v[156:159]
 ds_read_b64_tr_b16 v[92:93], v55 offset:40960
 buffer_load_dwordx4 a[148:151], v49, s[16:19], s78 offen offset:1024 sc1
 v_accvgpr_read_b32 v110, a54
 v_mfma_f32_16x16x32_bf16 v[156:159], v[76:79], a[220:223], v[156:159]
 ds_read_b64_tr_b16 v[94:95], v55 offset:45056
 v_accvgpr_read_b32 v111, a55
 v_mfma_f32_16x16x32_bf16 v[152:155], v[76:79], a[216:219], v[152:155]
 v_mul_f32 v104, v104, v29
 v_mul_f32 v105, v105, v29
 v_mfma_f32_16x16x32_bf16 v[152:155], v[72:75], a[200:203], v[152:155]
 v_mul_f32 v106, v106, v29
 v_mfma_f32_16x16x32_bf16 v[148:151], v[72:75], a[196:199], v[148:151]
 ds_read_b64_tr_b16 v[64:65], v56 offset:32768
 v_mul_f32 v107, v107, v29
 v_mfma_f32_16x16x32_bf16 v[148:151], v[76:79], a[212:215], v[148:151]
 ds_read_b64_tr_b16 v[66:67], v56 offset:36864
 v_mul_f32 v108, v108, v29
 v_mfma_f32_16x16x32_bf16 v[144:147], v[76:79], a[208:211], v[144:147]
 v_mul_f32 v109, v109, v29
 v_mul_f32 v110, v110, v29
 v_mfma_f32_16x16x32_bf16 v[144:147], v[72:75], a[192:195], v[144:147]
 s_waitcnt lgkmcnt(6)
 v_mfma_f32_16x16x32_bf16 v[160:163], v[80:83], a[192:195], v[160:163]
 ds_read_b64_tr_b16 v[68:69], v56 offset:40960
 buffer_load_dwordx4 a[152:155], v50, s[16:19], s78 offen offset:1024 sc1
 v_mfma_f32_16x16x32_bf16 v[160:163], v[84:87], a[208:211], v[160:163]
 ds_read_b64_tr_b16 v[70:71], v56 offset:45056
 v_mul_f32 v111, v111, v29
 v_mfma_f32_16x16x32_bf16 v[164:167], v[84:87], a[212:215], v[164:167]
 v_cvt_pk_bf16_f32 v116, v104, v105
 v_cvt_pk_bf16_f32 v117, v106, v107
 v_mfma_f32_16x16x32_bf16 v[164:167], v[80:83], a[196:199], v[164:167]
 v_cvt_pk_bf16_f32 v118, v108, v109
 v_mfma_f32_16x16x32_bf16 v[168:171], v[80:83], a[200:203], v[168:171]
 ds_read_b64_tr_b16 v[72:73], v57 offset:32768
 buffer_load_dwordx4 v41, s[12:15], s77 offen offset:1024  lds
 v_mfma_f32_16x16x32_bf16 v[168:171], v[84:87], a[216:219], v[168:171]
 ds_read_b64_tr_b16 v[74:75], v57 offset:36864
 v_cvt_pk_bf16_f32 v119, v110, v111
 v_mfma_f32_16x16x32_bf16 v[172:175], v[84:87], a[220:223], v[172:175]
 buffer_store_dwordx4 v[116:119], v34, s[32:35], s50 offen offset:1024 sc1
 v_accvgpr_read_b32 v96, a68
 v_mfma_f32_16x16x32_bf16 v[172:175], v[80:83], a[204:207], v[172:175]
 s_waitcnt lgkmcnt(6)
 v_mfma_f32_16x16x32_bf16 v[188:191], v[88:91], a[204:207], v[188:191]
 ds_read_b64_tr_b16 v[76:77], v57 offset:40960
 buffer_load_dwordx4 a[156:159], v51, s[16:19], s78 offen offset:1024 sc1
 v_mfma_f32_16x16x32_bf16 v[188:191], v[92:95], a[220:223], v[188:191]
 ds_read_b64_tr_b16 v[78:79], v57 offset:45056
 v_accvgpr_read_b32 v97, a69
 v_mfma_f32_16x16x32_bf16 v[184:187], v[92:95], a[216:219], v[184:187]
 v_accvgpr_read_b32 v98, a70
 v_accvgpr_read_b32 v99, a71
 v_mfma_f32_16x16x32_bf16 v[184:187], v[88:91], a[200:203], v[184:187]
 v_accvgpr_read_b32 v100, a84
 v_mfma_f32_16x16x32_bf16 v[180:183], v[88:91], a[196:199], v[180:183]
 ds_read_b64_tr_b16 v[80:81], v58 offset:32768
 v_accvgpr_read_b32 v101, a85
 v_mfma_f32_16x16x32_bf16 v[180:183], v[92:95], a[212:215], v[180:183]
 ds_read_b64_tr_b16 v[82:83], v58 offset:36864
 v_accvgpr_read_b32 v102, a86
 v_mfma_f32_16x16x32_bf16 v[176:179], v[92:95], a[208:211], v[176:179]
 v_accvgpr_read_b32 v103, a87
 v_mul_f32 v96, v96, v29
 v_mfma_f32_16x16x32_bf16 v[176:179], v[88:91], a[192:195], v[176:179]
 s_waitcnt lgkmcnt(6)
 v_mfma_f32_16x16x32_bf16 v[192:195], v[64:67], a[192:195], v[192:195]
 ds_read_b64_tr_b16 v[84:85], v58 offset:40960
 buffer_load_dwordx4 a[160:163], v48, s[16:19], s78 offen offset:2048 sc1
 v_mfma_f32_16x16x32_bf16 v[192:195], v[68:71], a[208:211], v[192:195]
 ds_read_b64_tr_b16 v[86:87], v58 offset:45056
 v_mul_f32 v97, v97, v29
 v_mfma_f32_16x16x32_bf16 v[196:199], v[68:71], a[212:215], v[196:199]
 v_mul_f32 v98, v98, v29
 v_mul_f32 v99, v99, v29
 v_mfma_f32_16x16x32_bf16 v[196:199], v[64:67], a[196:199], v[196:199]
 v_mul_f32 v100, v100, v29
 v_mfma_f32_16x16x32_bf16 v[200:203], v[64:67], a[200:203], v[200:203]
 ds_read_b64_tr_b16 v[88:89], v59 offset:32768
 buffer_load_dwordx4 v42, s[12:15], s77 offen offset:2048  lds
 v_mfma_f32_16x16x32_bf16 v[200:203], v[68:71], a[216:219], v[200:203]
 ds_read_b64_tr_b16 v[90:91], v59 offset:36864
 v_mul_f32 v101, v101, v29
 v_mfma_f32_16x16x32_bf16 v[204:207], v[68:71], a[220:223], v[204:207]
 v_mul_f32 v102, v102, v29
 v_mul_f32 v103, v103, v29
 v_mfma_f32_16x16x32_bf16 v[204:207], v[64:67], a[204:207], v[204:207]
 s_waitcnt lgkmcnt(6)
 v_mfma_f32_16x16x32_bf16 v[220:223], v[72:75], a[204:207], v[220:223]
 ds_read_b64_tr_b16 v[92:93], v59 offset:40960
 buffer_load_dwordx4 a[164:167], v49, s[16:19], s78 offen offset:2048 sc1
 v_mfma_f32_16x16x32_bf16 v[220:223], v[76:79], a[220:223], v[220:223]
 ds_read_b64_tr_b16 v[94:95], v59 offset:45056
 v_cvt_pk_bf16_f32 v120, v96, v97
 v_mfma_f32_16x16x32_bf16 v[216:219], v[76:79], a[216:219], v[216:219]
 v_cvt_pk_bf16_f32 v121, v98, v99
 v_cvt_pk_bf16_f32 v122, v100, v101
 v_mfma_f32_16x16x32_bf16 v[216:219], v[72:75], a[200:203], v[216:219]
 v_cvt_pk_bf16_f32 v123, v102, v103
 v_mfma_f32_16x16x32_bf16 v[212:215], v[72:75], a[196:199], v[212:215]
 ds_read_b64_tr_b16 v[64:65], v52 offset:49152
 buffer_store_dwordx4 v[120:123], v34, s[32:35], s50 offen offset:2048 sc1
 v_mfma_f32_16x16x32_bf16 v[212:215], v[76:79], a[212:215], v[212:215]
 ds_read_b64_tr_b16 v[66:67], v52 offset:53248
 v_accvgpr_read_b32 v104, a100
 v_mfma_f32_16x16x32_bf16 v[208:211], v[76:79], a[208:211], v[208:211]
 v_accvgpr_read_b32 v105, a101
 v_accvgpr_read_b32 v106, a102
 v_mfma_f32_16x16x32_bf16 v[208:211], v[72:75], a[192:195], v[208:211]
 s_waitcnt lgkmcnt(6)
 v_mfma_f32_16x16x32_bf16 v[224:227], v[80:83], a[192:195], v[224:227]
 ds_read_b64_tr_b16 v[68:69], v52 offset:57344
 buffer_load_dwordx4 a[168:171], v50, s[16:19], s78 offen offset:2048 sc1
 v_mfma_f32_16x16x32_bf16 v[224:227], v[84:87], a[208:211], v[224:227]
 ds_read_b64_tr_b16 v[70:71], v52 offset:61440
 v_accvgpr_read_b32 v107, a103
 v_mfma_f32_16x16x32_bf16 v[228:231], v[84:87], a[212:215], v[228:231]
 v_xor_b32 v52, s49, v52
 v_accvgpr_read_b32 v108, a116
 v_mfma_f32_16x16x32_bf16 v[228:231], v[80:83], a[196:199], v[228:231]
 v_accvgpr_read_b32 v109, a117
 v_mfma_f32_16x16x32_bf16 v[232:235], v[80:83], a[200:203], v[232:235]
 ds_read_b64_tr_b16 v[72:73], v53 offset:49152
 buffer_load_dwordx4 v43, s[12:15], s77 offen offset:3072  lds
 v_mfma_f32_16x16x32_bf16 v[232:235], v[84:87], a[216:219], v[232:235]
 ds_read_b64_tr_b16 v[74:75], v53 offset:53248
 v_accvgpr_read_b32 v110, a118
 v_mfma_f32_16x16x32_bf16 v[236:239], v[84:87], a[220:223], v[236:239]
 v_accvgpr_read_b32 v111, a119
 v_mul_f32 v104, v104, v29
 v_mfma_f32_16x16x32_bf16 v[236:239], v[80:83], a[204:207], v[236:239]
 s_waitcnt lgkmcnt(6)
 v_mfma_f32_16x16x32_bf16 v[252:255], v[88:91], a[204:207], v[252:255]
 ds_read_b64_tr_b16 v[76:77], v53 offset:57344
 buffer_load_dwordx4 a[172:175], v51, s[16:19], s78 offen offset:2048 sc1
 v_mfma_f32_16x16x32_bf16 v[252:255], v[92:95], a[220:223], v[252:255]
 ds_read_b64_tr_b16 v[78:79], v53 offset:61440
 v_mul_f32 v105, v105, v29
 v_mfma_f32_16x16x32_bf16 v[248:251], v[92:95], a[216:219], v[248:251]
 v_xor_b32 v53, s49, v53
 v_mul_f32 v106, v106, v29
 v_mfma_f32_16x16x32_bf16 v[248:251], v[88:91], a[200:203], v[248:251]
 v_mul_f32 v107, v107, v29
 v_mfma_f32_16x16x32_bf16 v[244:247], v[88:91], a[196:199], v[244:247]
 ds_read_b64_tr_b16 v[80:81], v54 offset:49152
 v_mul_f32 v108, v108, v29
 v_mfma_f32_16x16x32_bf16 v[244:247], v[92:95], a[212:215], v[244:247]
 ds_read_b64_tr_b16 v[82:83], v54 offset:53248
 v_mul_f32 v109, v109, v29
 v_mfma_f32_16x16x32_bf16 v[240:243], v[92:95], a[208:211], v[240:243]
 v_mul_f32 v110, v110, v29
 v_mul_f32 v111, v111, v29
 v_mfma_f32_16x16x32_bf16 v[240:243], v[88:91], a[192:195], v[240:243]
 s_waitcnt lgkmcnt(6)
 s_waitcnt vmcnt(36)
 v_mfma_f32_16x16x32_bf16 v[128:131], v[64:67], a[224:227], v[128:131]
 ds_read_b64_tr_b16 v[84:85], v54 offset:57344
 buffer_load_dwordx4 a[176:179], v48, s[16:19], s78 offen offset:3072 sc1
 s_waitcnt vmcnt(30)
 v_mfma_f32_16x16x32_bf16 v[128:131], v[68:71], a[240:243], v[128:131]
 ds_read_b64_tr_b16 v[86:87], v54 offset:61440
 s_waitcnt vmcnt(28)
 v_cvt_pk_bf16_f32 v124, v104, v105
 v_mfma_f32_16x16x32_bf16 v[132:135], v[68:71], a[244:247], v[132:135]
 v_xor_b32 v54, s49, v54
 v_cvt_pk_bf16_f32 v125, v106, v107
 v_mfma_f32_16x16x32_bf16 v[132:135], v[64:67], a[228:231], v[132:135]
 v_cvt_pk_bf16_f32 v126, v108, v109
 v_mfma_f32_16x16x32_bf16 v[136:139], v[64:67], a[232:235], v[136:139]
 ds_read_b64_tr_b16 v[88:89], v55 offset:49152
 s_add_u32 m0, s79, 102400
 s_waitcnt vmcnt(26)
 v_mfma_f32_16x16x32_bf16 v[136:139], v[68:71], a[248:251], v[136:139]
 ds_read_b64_tr_b16 v[90:91], v55 offset:53248
 s_waitcnt vmcnt(24)
 v_cvt_pk_bf16_f32 v127, v110, v111
 v_mfma_f32_16x16x32_bf16 v[140:143], v[68:71], a[252:255], v[140:143]
 buffer_load_dwordx4 v44, s[12:15], s77 offen  lds
 buffer_store_dwordx4 v[124:127], v34, s[32:35], s50 offen offset:3072 sc1
 v_mfma_f32_16x16x32_bf16 v[140:143], v[64:67], a[236:239], v[140:143]
 s_waitcnt lgkmcnt(6)
 s_add_u32 s50, s50, 131328
 v_mfma_f32_16x16x32_bf16 v[156:159], v[72:75], a[236:239], v[156:159]
 ds_read_b64_tr_b16 v[92:93], v55 offset:57344
 buffer_load_dwordx4 a[180:183], v49, s[16:19], s78 offen offset:3072 sc1
 v_accvgpr_read_b32 v96, a8
 v_mfma_f32_16x16x32_bf16 v[156:159], v[76:79], a[252:255], v[156:159]
 ds_read_b64_tr_b16 v[94:95], v55 offset:61440
 v_accvgpr_read_b32 v97, a9
 v_mfma_f32_16x16x32_bf16 v[152:155], v[76:79], a[248:251], v[152:155]
 v_xor_b32 v55, s49, v55
 v_accvgpr_read_b32 v98, a10
 v_mfma_f32_16x16x32_bf16 v[152:155], v[72:75], a[232:235], v[152:155]
 v_accvgpr_read_b32 v99, a11
 v_mfma_f32_16x16x32_bf16 v[148:151], v[72:75], a[228:231], v[148:151]
 ds_read_b64_tr_b16 v[64:65], v56 offset:49152
 v_accvgpr_read_b32 v100, a24
 v_mfma_f32_16x16x32_bf16 v[148:151], v[76:79], a[244:247], v[148:151]
 ds_read_b64_tr_b16 v[66:67], v56 offset:53248
 v_accvgpr_read_b32 v101, a25
 v_mfma_f32_16x16x32_bf16 v[144:147], v[76:79], a[240:243], v[144:147]
 v_accvgpr_read_b32 v102, a26
 v_accvgpr_read_b32 v103, a27
 v_mfma_f32_16x16x32_bf16 v[144:147], v[72:75], a[224:227], v[144:147]
 s_waitcnt lgkmcnt(6)
 v_mfma_f32_16x16x32_bf16 v[160:163], v[80:83], a[224:227], v[160:163]
 ds_read_b64_tr_b16 v[68:69], v56 offset:57344
 buffer_load_dwordx4 a[184:187], v50, s[16:19], s78 offen offset:3072 sc1
 v_mfma_f32_16x16x32_bf16 v[160:163], v[84:87], a[240:243], v[160:163]
 ds_read_b64_tr_b16 v[70:71], v56 offset:61440
 v_mul_f32 v96, v96, v30
 v_mfma_f32_16x16x32_bf16 v[164:167], v[84:87], a[244:247], v[164:167]
 v_xor_b32 v56, s49, v56
 v_mul_f32 v97, v97, v30
 v_mfma_f32_16x16x32_bf16 v[164:167], v[80:83], a[228:231], v[164:167]
 v_mul_f32 v98, v98, v30
 v_mfma_f32_16x16x32_bf16 v[168:171], v[80:83], a[232:235], v[168:171]
 ds_read_b64_tr_b16 v[72:73], v57 offset:49152
 buffer_load_dwordx4 v45, s[12:15], s77 offen offset:1024  lds
 v_mul_f32 v99, v99, v30
 v_mfma_f32_16x16x32_bf16 v[168:171], v[84:87], a[248:251], v[168:171]
 ds_read_b64_tr_b16 v[74:75], v57 offset:53248
 v_mul_f32 v100, v100, v30
 v_mfma_f32_16x16x32_bf16 v[172:175], v[84:87], a[252:255], v[172:175]
 v_mul_f32 v101, v101, v30
 v_mul_f32 v102, v102, v30
 v_mfma_f32_16x16x32_bf16 v[172:175], v[80:83], a[236:239], v[172:175]
 s_waitcnt lgkmcnt(6)
 v_mfma_f32_16x16x32_bf16 v[188:191], v[88:91], a[236:239], v[188:191]
 ds_read_b64_tr_b16 v[76:77], v57 offset:57344
 buffer_load_dwordx4 a[188:191], v51, s[16:19], s78 offen offset:3072 sc1
 v_mfma_f32_16x16x32_bf16 v[188:191], v[92:95], a[252:255], v[188:191]
 ds_read_b64_tr_b16 v[78:79], v57 offset:61440
 s_add_u32 s78, s78, 4096
 v_mul_f32 v103, v103, v30
 v_mfma_f32_16x16x32_bf16 v[184:187], v[92:95], a[248:251], v[184:187]
 v_xor_b32 v57, s49, v57
 v_cvt_pk_bf16_f32 v112, v96, v97
 v_mfma_f32_16x16x32_bf16 v[184:187], v[88:91], a[232:235], v[184:187]
 v_cvt_pk_bf16_f32 v113, v98, v99
 v_mfma_f32_16x16x32_bf16 v[180:183], v[88:91], a[228:231], v[180:183]
 ds_read_b64_tr_b16 v[80:81], v58 offset:49152
 v_cvt_pk_bf16_f32 v114, v100, v101
 v_mfma_f32_16x16x32_bf16 v[180:183], v[92:95], a[244:247], v[180:183]
 ds_read_b64_tr_b16 v[82:83], v58 offset:53248
 v_cvt_pk_bf16_f32 v115, v102, v103
 v_mfma_f32_16x16x32_bf16 v[176:179], v[92:95], a[240:243], v[176:179]
 buffer_store_dwordx4 v[112:115], v34, s[32:35], s50 offen sc1
 v_accvgpr_read_b32 v104, a40
 v_mfma_f32_16x16x32_bf16 v[176:179], v[88:91], a[224:227], v[176:179]
 s_waitcnt lgkmcnt(6)
 v_mfma_f32_16x16x32_bf16 v[192:195], v[64:67], a[224:227], v[192:195]
 ds_read_b64_tr_b16 v[84:85], v58 offset:57344
 buffer_load_dwordx4 a[192:195], v48, s[16:19], s78 offen sc1
 v_mfma_f32_16x16x32_bf16 v[192:195], v[68:71], a[240:243], v[192:195]
 ds_read_b64_tr_b16 v[86:87], v58 offset:61440
 v_accvgpr_read_b32 v105, a41
 v_mfma_f32_16x16x32_bf16 v[196:199], v[68:71], a[244:247], v[196:199]
 v_xor_b32 v58, s49, v58
 v_accvgpr_read_b32 v106, a42
 v_mfma_f32_16x16x32_bf16 v[196:199], v[64:67], a[228:231], v[196:199]
 v_accvgpr_read_b32 v107, a43
 v_mfma_f32_16x16x32_bf16 v[200:203], v[64:67], a[232:235], v[200:203]
 ds_read_b64_tr_b16 v[88:89], v59 offset:49152
 buffer_load_dwordx4 v46, s[12:15], s77 offen offset:2048  lds
 v_accvgpr_read_b32 v108, a56
 v_mfma_f32_16x16x32_bf16 v[200:203], v[68:71], a[248:251], v[200:203]
 ds_read_b64_tr_b16 v[90:91], v59 offset:53248
 v_accvgpr_read_b32 v109, a57
 v_mfma_f32_16x16x32_bf16 v[204:207], v[68:71], a[252:255], v[204:207]
 v_accvgpr_read_b32 v110, a58
 v_accvgpr_read_b32 v111, a59
 v_mfma_f32_16x16x32_bf16 v[204:207], v[64:67], a[236:239], v[204:207]
 s_waitcnt lgkmcnt(6)
 v_mfma_f32_16x16x32_bf16 v[220:223], v[72:75], a[236:239], v[220:223]
 ds_read_b64_tr_b16 v[92:93], v59 offset:57344
 buffer_load_dwordx4 a[196:199], v49, s[16:19], s78 offen sc1
 v_mul_f32 v104, v104, v30
 v_mfma_f32_16x16x32_bf16 v[220:223], v[76:79], a[252:255], v[220:223]
 ds_read_b64_tr_b16 v[94:95], v59 offset:61440
 v_mul_f32 v105, v105, v30
 v_mfma_f32_16x16x32_bf16 v[216:219], v[76:79], a[248:251], v[216:219]
 v_xor_b32 v59, s49, v59
 v_mul_f32 v106, v106, v30
 v_mfma_f32_16x16x32_bf16 v[216:219], v[72:75], a[232:235], v[216:219]
 s_waitcnt vmcnt(28)
 s_barrier
 v_mfma_f32_16x16x32_bf16 v[212:215], v[72:75], a[228:231], v[212:215]
 ds_read_b64_tr_b16 v[64:65], v52
 v_mul_f32 v107, v107, v30
 v_mfma_f32_16x16x32_bf16 v[212:215], v[76:79], a[244:247], v[212:215]
 ds_read_b64_tr_b16 v[66:67], v52 offset:4096
 v_mul_f32 v108, v108, v30
 v_mfma_f32_16x16x32_bf16 v[208:211], v[76:79], a[240:243], v[208:211]
 v_mul_f32 v109, v109, v30
 v_mul_f32 v110, v110, v30
 v_mfma_f32_16x16x32_bf16 v[208:211], v[72:75], a[224:227], v[208:211]
 s_waitcnt lgkmcnt(6)
 v_mfma_f32_16x16x32_bf16 v[224:227], v[80:83], a[224:227], v[224:227]
 ds_read_b64_tr_b16 v[68:69], v52 offset:8192
 buffer_load_dwordx4 a[200:203], v50, s[16:19], s78 offen sc1
 v_mul_f32 v111, v111, v30
 v_mfma_f32_16x16x32_bf16 v[224:227], v[84:87], a[240:243], v[224:227]
 ds_read_b64_tr_b16 v[70:71], v52 offset:12288
 v_cvt_pk_bf16_f32 v116, v104, v105
 v_mfma_f32_16x16x32_bf16 v[228:231], v[84:87], a[244:247], v[228:231]
 v_cvt_pk_bf16_f32 v117, v106, v107
 v_cvt_pk_bf16_f32 v118, v108, v109
 v_mfma_f32_16x16x32_bf16 v[228:231], v[80:83], a[228:231], v[228:231]
 v_cvt_pk_bf16_f32 v119, v110, v111
 v_mfma_f32_16x16x32_bf16 v[232:235], v[80:83], a[232:235], v[232:235]
 ds_read_b64_tr_b16 v[72:73], v53
 buffer_load_dwordx4 v47, s[12:15], s77 offen offset:3072  lds
 v_mfma_f32_16x16x32_bf16 v[232:235], v[84:87], a[248:251], v[232:235]
 ds_read_b64_tr_b16 v[74:75], v53 offset:4096
 s_add_u32 s77, s77, 262144
 buffer_store_dwordx4 v[116:119], v34, s[32:35], s50 offen offset:1024 sc1
 v_mfma_f32_16x16x32_bf16 v[236:239], v[84:87], a[252:255], v[236:239]
 v_accvgpr_read_b32 v96, a72
 v_accvgpr_read_b32 v97, a73
 v_mfma_f32_16x16x32_bf16 v[236:239], v[80:83], a[236:239], v[236:239]
 s_waitcnt lgkmcnt(6)
 v_mfma_f32_16x16x32_bf16 v[252:255], v[88:91], a[236:239], v[252:255]
 ds_read_b64_tr_b16 v[76:77], v53 offset:8192
 buffer_load_dwordx4 a[204:207], v51, s[16:19], s78 offen sc1
 v_mfma_f32_16x16x32_bf16 v[252:255], v[92:95], a[252:255], v[252:255]
 ds_read_b64_tr_b16 v[78:79], v53 offset:12288
 buffer_load_dword v61, v0, s[60:63], 0 offen
 v_accvgpr_read_b32 v98, a74
 v_mfma_f32_16x16x32_bf16 v[248:251], v[92:95], a[248:251], v[248:251]
 v_accvgpr_read_b32 v99, a75
 v_accvgpr_read_b32 v100, a88
 v_mfma_f32_16x16x32_bf16 v[248:251], v[88:91], a[232:235], v[248:251]
 v_accvgpr_read_b32 v101, a89
 v_mfma_f32_16x16x32_bf16 v[244:247], v[88:91], a[228:231], v[244:247]
 ds_read_b64_tr_b16 v[80:81], v54
 v_accvgpr_read_b32 v102, a90
 v_mfma_f32_16x16x32_bf16 v[244:247], v[92:95], a[244:247], v[244:247]
 ds_read_b64_tr_b16 v[82:83], v54 offset:4096
 v_accvgpr_read_b32 v103, a91
 v_mfma_f32_16x16x32_bf16 v[240:243], v[92:95], a[240:243], v[240:243]
 v_mul_f32 v96, v96, v30
 v_mul_f32 v97, v97, v30
 v_mfma_f32_16x16x32_bf16 v[240:243], v[88:91], a[224:227], v[240:243]
 s_waitcnt lgkmcnt(6)
 v_mfma_f32_16x16x32_bf16 v[128:131], v[64:67], a[128:131], v[128:131]
 ds_read_b64_tr_b16 v[84:85], v54 offset:8192
 buffer_load_dwordx4 a[208:211], v48, s[16:19], s78 offen offset:1024 sc1
 s_waitcnt vmcnt(30)
 v_mfma_f32_16x16x32_bf16 v[128:131], v[68:71], a[144:147], v[128:131]
 ds_read_b64_tr_b16 v[86:87], v54 offset:12288
 s_waitcnt vmcnt(28)
 v_mul_f32 v98, v98, v30
 v_mfma_f32_16x16x32_bf16 v[132:135], v[68:71], a[148:151], v[132:135]
 v_mul_f32 v99, v99, v30
 v_mul_f32 v100, v100, v30
 v_mfma_f32_16x16x32_bf16 v[132:135], v[64:67], a[132:135], v[132:135]
 v_mul_f32 v101, v101, v30
 v_mfma_f32_16x16x32_bf16 v[136:139], v[64:67], a[136:139], v[136:139]
 ds_read_b64_tr_b16 v[88:89], v55
 s_add_u32 m0, s79, 0
 s_waitcnt vmcnt(27)
 v_mfma_f32_16x16x32_bf16 v[136:139], v[68:71], a[152:155], v[136:139]
 ds_read_b64_tr_b16 v[90:91], v55 offset:4096
 s_waitcnt vmcnt(24)
 v_mul_f32 v102, v102, v30
 v_mfma_f32_16x16x32_bf16 v[140:143], v[68:71], a[156:159], v[140:143]
 buffer_load_dwordx4 v40, s[12:15], s77 offen  lds
 v_mul_f32 v103, v103, v30
 v_mfma_f32_16x16x32_bf16 v[140:143], v[64:67], a[140:143], v[140:143]
 s_waitcnt lgkmcnt(6)
 v_mfma_f32_16x16x32_bf16 v[156:159], v[72:75], a[140:143], v[156:159]
 ds_read_b64_tr_b16 v[92:93], v55 offset:8192
 buffer_load_dwordx4 a[212:215], v49, s[16:19], s78 offen offset:1024 sc1
 v_cvt_pk_bf16_f32 v120, v96, v97
 v_mfma_f32_16x16x32_bf16 v[156:159], v[76:79], a[156:159], v[156:159]
 ds_read_b64_tr_b16 v[94:95], v55 offset:12288
 v_cvt_pk_bf16_f32 v121, v98, v99
 v_mfma_f32_16x16x32_bf16 v[152:155], v[76:79], a[152:155], v[152:155]
 v_cvt_pk_bf16_f32 v122, v100, v101
 v_cvt_pk_bf16_f32 v123, v102, v103
 v_mfma_f32_16x16x32_bf16 v[152:155], v[72:75], a[136:139], v[152:155]
 buffer_store_dwordx4 v[120:123], v34, s[32:35], s50 offen offset:2048 sc1
 v_mfma_f32_16x16x32_bf16 v[148:151], v[72:75], a[132:135], v[148:151]
 ds_read_b64_tr_b16 v[64:65], v56
 v_accvgpr_read_b32 v104, a104
 v_mfma_f32_16x16x32_bf16 v[148:151], v[76:79], a[148:151], v[148:151]
 ds_read_b64_tr_b16 v[66:67], v56 offset:4096
 v_accvgpr_read_b32 v105, a105
 v_mfma_f32_16x16x32_bf16 v[144:147], v[76:79], a[144:147], v[144:147]
 v_accvgpr_read_b32 v106, a106
 v_accvgpr_read_b32 v107, a107
 v_mfma_f32_16x16x32_bf16 v[144:147], v[72:75], a[128:131], v[144:147]
 s_waitcnt lgkmcnt(6)
 v_mfma_f32_16x16x32_bf16 v[160:163], v[80:83], a[128:131], v[160:163]
 ds_read_b64_tr_b16 v[68:69], v56 offset:8192
 buffer_load_dwordx4 a[216:219], v50, s[16:19], s78 offen offset:1024 sc1
 v_mfma_f32_16x16x32_bf16 v[160:163], v[84:87], a[144:147], v[160:163]
 ds_read_b64_tr_b16 v[70:71], v56 offset:12288
 v_accvgpr_read_b32 v108, a120
 v_mfma_f32_16x16x32_bf16 v[164:167], v[84:87], a[148:151], v[164:167]
 v_accvgpr_read_b32 v109, a121
 v_accvgpr_read_b32 v110, a122
 v_mfma_f32_16x16x32_bf16 v[164:167], v[80:83], a[132:135], v[164:167]
 v_accvgpr_read_b32 v111, a123
 v_mfma_f32_16x16x32_bf16 v[168:171], v[80:83], a[136:139], v[168:171]
 ds_read_b64_tr_b16 v[72:73], v57
 buffer_load_dwordx4 v41, s[12:15], s77 offen offset:1024  lds
 v_mfma_f32_16x16x32_bf16 v[168:171], v[84:87], a[152:155], v[168:171]
 ds_read_b64_tr_b16 v[74:75], v57 offset:4096
 v_mul_f32 v104, v104, v30
 v_mfma_f32_16x16x32_bf16 v[172:175], v[84:87], a[156:159], v[172:175]
 v_mul_f32 v105, v105, v30
 v_mul_f32 v106, v106, v30
 v_mfma_f32_16x16x32_bf16 v[172:175], v[80:83], a[140:143], v[172:175]
 s_waitcnt lgkmcnt(6)
 v_mfma_f32_16x16x32_bf16 v[188:191], v[88:91], a[140:143], v[188:191]
 ds_read_b64_tr_b16 v[76:77], v57 offset:8192
 buffer_load_dwordx4 a[220:223], v51, s[16:19], s78 offen offset:1024 sc1
 v_mfma_f32_16x16x32_bf16 v[188:191], v[92:95], a[156:159], v[188:191]
 ds_read_b64_tr_b16 v[78:79], v57 offset:12288
 v_mul_f32 v107, v107, v30
 v_mfma_f32_16x16x32_bf16 v[184:187], v[92:95], a[152:155], v[184:187]
 v_mul_f32 v108, v108, v30
 v_mul_f32 v109, v109, v30
 v_mfma_f32_16x16x32_bf16 v[184:187], v[88:91], a[136:139], v[184:187]
 v_mul_f32 v110, v110, v30
 v_mfma_f32_16x16x32_bf16 v[180:183], v[88:91], a[132:135], v[180:183]
 ds_read_b64_tr_b16 v[80:81], v58
 v_mul_f32 v111, v111, v30
 v_mfma_f32_16x16x32_bf16 v[180:183], v[92:95], a[148:151], v[180:183]
 ds_read_b64_tr_b16 v[82:83], v58 offset:4096
 v_cvt_pk_bf16_f32 v124, v104, v105
 v_mfma_f32_16x16x32_bf16 v[176:179], v[92:95], a[144:147], v[176:179]
 v_cvt_pk_bf16_f32 v125, v106, v107
 v_cvt_pk_bf16_f32 v126, v108, v109
 v_mfma_f32_16x16x32_bf16 v[176:179], v[88:91], a[128:131], v[176:179]
 s_waitcnt lgkmcnt(6)
 v_mfma_f32_16x16x32_bf16 v[192:195], v[64:67], a[128:131], v[192:195]
 ds_read_b64_tr_b16 v[84:85], v58 offset:8192
 buffer_load_dwordx4 a[224:227], v48, s[16:19], s78 offen offset:2048 sc1
 v_mfma_f32_16x16x32_bf16 v[192:195], v[68:71], a[144:147], v[192:195]
 ds_read_b64_tr_b16 v[86:87], v58 offset:12288
 v_cvt_pk_bf16_f32 v127, v110, v111
 v_mfma_f32_16x16x32_bf16 v[196:199], v[68:71], a[148:151], v[196:199]
 buffer_store_dwordx4 v[124:127], v34, s[32:35], s50 offen offset:3072 sc1
 s_add_u32 s50, s50, 131328
 v_mfma_f32_16x16x32_bf16 v[196:199], v[64:67], a[132:135], v[196:199]
 v_accvgpr_read_b32 v96, a12
 v_mfma_f32_16x16x32_bf16 v[200:203], v[64:67], a[136:139], v[200:203]
 ds_read_b64_tr_b16 v[88:89], v59
 buffer_load_dwordx4 v42, s[12:15], s77 offen offset:2048  lds
 v_mfma_f32_16x16x32_bf16 v[200:203], v[68:71], a[152:155], v[200:203]
 ds_read_b64_tr_b16 v[90:91], v59 offset:4096
 v_accvgpr_read_b32 v97, a13
 v_mfma_f32_16x16x32_bf16 v[204:207], v[68:71], a[156:159], v[204:207]
 v_accvgpr_read_b32 v98, a14
 v_accvgpr_read_b32 v99, a15
 v_mfma_f32_16x16x32_bf16 v[204:207], v[64:67], a[140:143], v[204:207]
 s_waitcnt lgkmcnt(6)
 v_mfma_f32_16x16x32_bf16 v[220:223], v[72:75], a[140:143], v[220:223]
 ds_read_b64_tr_b16 v[92:93], v59 offset:8192
 buffer_load_dwordx4 a[228:231], v49, s[16:19], s78 offen offset:2048 sc1
 v_mfma_f32_16x16x32_bf16 v[220:223], v[76:79], a[156:159], v[220:223]
 ds_read_b64_tr_b16 v[94:95], v59 offset:12288
 v_accvgpr_read_b32 v100, a28
 v_mfma_f32_16x16x32_bf16 v[216:219], v[76:79], a[152:155], v[216:219]
 v_accvgpr_read_b32 v101, a29
 v_accvgpr_read_b32 v102, a30
 v_mfma_f32_16x16x32_bf16 v[216:219], v[72:75], a[136:139], v[216:219]
 v_accvgpr_read_b32 v103, a31
 v_mfma_f32_16x16x32_bf16 v[212:215], v[72:75], a[132:135], v[212:215]
 ds_read_b64_tr_b16 v[64:65], v52 offset:16384
 v_mul_f32 v96, v96, v31
 v_mfma_f32_16x16x32_bf16 v[212:215], v[76:79], a[148:151], v[212:215]
 ds_read_b64_tr_b16 v[66:67], v52 offset:20480
 v_mul_f32 v97, v97, v31
 v_mfma_f32_16x16x32_bf16 v[208:211], v[76:79], a[144:147], v[208:211]
 v_mul_f32 v98, v98, v31
 v_mul_f32 v99, v99, v31
 v_mfma_f32_16x16x32_bf16 v[208:211], v[72:75], a[128:131], v[208:211]
 s_waitcnt lgkmcnt(6)
 v_mfma_f32_16x16x32_bf16 v[224:227], v[80:83], a[128:131], v[224:227]
 ds_read_b64_tr_b16 v[68:69], v52 offset:24576
 buffer_load_dwordx4 a[232:235], v50, s[16:19], s78 offen offset:2048 sc1
 v_mfma_f32_16x16x32_bf16 v[224:227], v[84:87], a[144:147], v[224:227]
 ds_read_b64_tr_b16 v[70:71], v52 offset:28672
 v_mul_f32 v100, v100, v31
 v_mfma_f32_16x16x32_bf16 v[228:231], v[84:87], a[148:151], v[228:231]
 v_mul_f32 v101, v101, v31
 v_mul_f32 v102, v102, v31
 v_mfma_f32_16x16x32_bf16 v[228:231], v[80:83], a[132:135], v[228:231]
 v_mul_f32 v103, v103, v31
 v_mfma_f32_16x16x32_bf16 v[232:235], v[80:83], a[136:139], v[232:235]
 ds_read_b64_tr_b16 v[72:73], v53 offset:16384
 buffer_load_dwordx4 v43, s[12:15], s77 offen offset:3072  lds
 v_mfma_f32_16x16x32_bf16 v[232:235], v[84:87], a[152:155], v[232:235]
 ds_read_b64_tr_b16 v[74:75], v53 offset:20480
 v_cvt_pk_bf16_f32 v112, v96, v97
 v_mfma_f32_16x16x32_bf16 v[236:239], v[84:87], a[156:159], v[236:239]
 v_cvt_pk_bf16_f32 v113, v98, v99
 v_cvt_pk_bf16_f32 v114, v100, v101
 v_mfma_f32_16x16x32_bf16 v[236:239], v[80:83], a[140:143], v[236:239]
 s_waitcnt lgkmcnt(6)
 v_mfma_f32_16x16x32_bf16 v[252:255], v[88:91], a[140:143], v[252:255]
 ds_read_b64_tr_b16 v[76:77], v53 offset:24576
 buffer_load_dwordx4 a[236:239], v51, s[16:19], s78 offen offset:2048 sc1
 v_mfma_f32_16x16x32_bf16 v[252:255], v[92:95], a[156:159], v[252:255]
 ds_read_b64_tr_b16 v[78:79], v53 offset:28672
 v_cvt_pk_bf16_f32 v115, v102, v103
 v_mfma_f32_16x16x32_bf16 v[248:251], v[92:95], a[152:155], v[248:251]
 buffer_store_dwordx4 v[112:115], v34, s[32:35], s50 offen sc1
 v_accvgpr_read_b32 v104, a44
 v_mfma_f32_16x16x32_bf16 v[248:251], v[88:91], a[136:139], v[248:251]
 v_accvgpr_read_b32 v105, a45
 v_mfma_f32_16x16x32_bf16 v[244:247], v[88:91], a[132:135], v[244:247]
 ds_read_b64_tr_b16 v[80:81], v54 offset:16384
 v_accvgpr_read_b32 v106, a46
 v_mfma_f32_16x16x32_bf16 v[244:247], v[92:95], a[148:151], v[244:247]
 ds_read_b64_tr_b16 v[82:83], v54 offset:20480
 v_accvgpr_read_b32 v107, a47
 v_mfma_f32_16x16x32_bf16 v[240:243], v[92:95], a[144:147], v[240:243]
 v_accvgpr_read_b32 v108, a60
 v_accvgpr_read_b32 v109, a61
 v_mfma_f32_16x16x32_bf16 v[240:243], v[88:91], a[128:131], v[240:243]
 s_waitcnt lgkmcnt(6)
 s_waitcnt vmcnt(37)
 v_mfma_f32_16x16x32_bf16 v[128:131], v[64:67], a[160:163], v[128:131]
 ds_read_b64_tr_b16 v[84:85], v54 offset:24576
 buffer_load_dwordx4 a[240:243], v48, s[16:19], s78 offen offset:3072 sc1
 s_waitcnt vmcnt(31)
 v_mfma_f32_16x16x32_bf16 v[128:131], v[68:71], a[176:179], v[128:131]
 ds_read_b64_tr_b16 v[86:87], v54 offset:28672
 s_waitcnt vmcnt(28)
 v_accvgpr_read_b32 v110, a62
 v_mfma_f32_16x16x32_bf16 v[132:135], v[68:71], a[180:183], v[132:135]
 v_accvgpr_read_b32 v111, a63
 v_mul_f32 v104, v104, v31
 v_mfma_f32_16x16x32_bf16 v[132:135], v[64:67], a[164:167], v[132:135]
 v_mul_f32 v105, v105, v31
 v_mfma_f32_16x16x32_bf16 v[136:139], v[64:67], a[168:171], v[136:139]
 ds_read_b64_tr_b16 v[88:89], v55 offset:16384
 s_add_u32 m0, s79, 4096
 s_waitcnt vmcnt(27)
 v_mfma_f32_16x16x32_bf16 v[136:139], v[68:71], a[184:187], v[136:139]
 ds_read_b64_tr_b16 v[90:91], v55 offset:20480
 s_waitcnt vmcnt(25)
 v_mul_f32 v106, v106, v31
 v_mfma_f32_16x16x32_bf16 v[140:143], v[68:71], a[188:191], v[140:143]
 buffer_load_dwordx4 v44, s[12:15], s77 offen  lds
 v_mul_f32 v107, v107, v31
 v_mfma_f32_16x16x32_bf16 v[140:143], v[64:67], a[172:175], v[140:143]
 s_waitcnt lgkmcnt(6)
 v_mfma_f32_16x16x32_bf16 v[156:159], v[72:75], a[172:175], v[156:159]
 ds_read_b64_tr_b16 v[92:93], v55 offset:24576
 buffer_load_dwordx4 a[244:247], v49, s[16:19], s78 offen offset:3072 sc1
 v_mfma_f32_16x16x32_bf16 v[156:159], v[76:79], a[188:191], v[156:159]
 ds_read_b64_tr_b16 v[94:95], v55 offset:28672
 v_mul_f32 v108, v108, v31
 v_mfma_f32_16x16x32_bf16 v[152:155], v[76:79], a[184:187], v[152:155]
 v_mul_f32 v109, v109, v31
 v_mul_f32 v110, v110, v31
 v_mfma_f32_16x16x32_bf16 v[152:155], v[72:75], a[168:171], v[152:155]
 v_mul_f32 v111, v111, v31
 v_mfma_f32_16x16x32_bf16 v[148:151], v[72:75], a[164:167], v[148:151]
 ds_read_b64_tr_b16 v[64:65], v56 offset:16384
 v_cvt_pk_bf16_f32 v116, v104, v105
 v_mfma_f32_16x16x32_bf16 v[148:151], v[76:79], a[180:183], v[148:151]
 ds_read_b64_tr_b16 v[66:67], v56 offset:20480
 v_cvt_pk_bf16_f32 v117, v106, v107
 v_mfma_f32_16x16x32_bf16 v[144:147], v[76:79], a[176:179], v[144:147]
 v_cvt_pk_bf16_f32 v118, v108, v109
 v_cvt_pk_bf16_f32 v119, v110, v111
 v_mfma_f32_16x16x32_bf16 v[144:147], v[72:75], a[160:163], v[144:147]
 s_waitcnt lgkmcnt(6)
 v_mfma_f32_16x16x32_bf16 v[160:163], v[80:83], a[160:163], v[160:163]
 ds_read_b64_tr_b16 v[68:69], v56 offset:24576
 buffer_load_dwordx4 a[248:251], v50, s[16:19], s78 offen offset:3072 sc1
 v_mfma_f32_16x16x32_bf16 v[160:163], v[84:87], a[176:179], v[160:163]
 ds_read_b64_tr_b16 v[70:71], v56 offset:28672
 buffer_store_dwordx4 v[116:119], v34, s[32:35], s50 offen offset:1024 sc1
 v_mfma_f32_16x16x32_bf16 v[164:167], v[84:87], a[180:183], v[164:167]
 v_accvgpr_read_b32 v96, a76
 v_accvgpr_read_b32 v97, a77
 v_mfma_f32_16x16x32_bf16 v[164:167], v[80:83], a[164:167], v[164:167]
 v_accvgpr_read_b32 v98, a78
 v_mfma_f32_16x16x32_bf16 v[168:171], v[80:83], a[168:171], v[168:171]
 ds_read_b64_tr_b16 v[72:73], v57 offset:16384
 buffer_load_dwordx4 v45, s[12:15], s77 offen offset:1024  lds
 v_mfma_f32_16x16x32_bf16 v[168:171], v[84:87], a[184:187], v[168:171]
 ds_read_b64_tr_b16 v[74:75], v57 offset:20480
 v_accvgpr_read_b32 v99, a79
 v_mfma_f32_16x16x32_bf16 v[172:175], v[84:87], a[188:191], v[172:175]
 v_accvgpr_read_b32 v100, a92
 v_accvgpr_read_b32 v101, a93
 v_mfma_f32_16x16x32_bf16 v[172:175], v[80:83], a[172:175], v[172:175]
 s_waitcnt lgkmcnt(6)
 v_mfma_f32_16x16x32_bf16 v[188:191], v[88:91], a[172:175], v[188:191]
 ds_read_b64_tr_b16 v[76:77], v57 offset:24576
 buffer_load_dwordx4 a[252:255], v51, s[16:19], s78 offen offset:3072 sc1
 v_mfma_f32_16x16x32_bf16 v[188:191], v[92:95], a[188:191], v[188:191]
 ds_read_b64_tr_b16 v[78:79], v57 offset:28672
 s_add_u32 s78, s78, 4096
 v_mfma_f32_16x16x32_bf16 v[184:187], v[92:95], a[184:187], v[184:187]
 v_accvgpr_read_b32 v102, a94
 v_accvgpr_read_b32 v103, a95
 v_mfma_f32_16x16x32_bf16 v[184:187], v[88:91], a[168:171], v[184:187]
 v_mul_f32 v96, v96, v31
 v_mfma_f32_16x16x32_bf16 v[180:183], v[88:91], a[164:167], v[180:183]
 ds_read_b64_tr_b16 v[80:81], v58 offset:16384
 v_mul_f32 v97, v97, v31
 v_mfma_f32_16x16x32_bf16 v[180:183], v[92:95], a[180:183], v[180:183]
 ds_read_b64_tr_b16 v[82:83], v58 offset:20480
 v_mul_f32 v98, v98, v31
 v_mfma_f32_16x16x32_bf16 v[176:179], v[92:95], a[176:179], v[176:179]
 v_mul_f32 v99, v99, v31
 v_mul_f32 v100, v100, v31
 v_mfma_f32_16x16x32_bf16 v[176:179], v[88:91], a[160:163], v[176:179]
 s_waitcnt lgkmcnt(6)
 v_mfma_f32_16x16x32_bf16 v[192:195], v[64:67], a[160:163], v[192:195]
 ds_read_b64_tr_b16 v[84:85], v58 offset:24576
 buffer_load_dwordx4 a[128:131], v48, s[16:19], s78 offen sc1
 v_mfma_f32_16x16x32_bf16 v[192:195], v[68:71], a[176:179], v[192:195]
 ds_read_b64_tr_b16 v[86:87], v58 offset:28672
 v_mul_f32 v101, v101, v31
 v_mfma_f32_16x16x32_bf16 v[196:199], v[68:71], a[180:183], v[196:199]
 v_mul_f32 v102, v102, v31
 v_mul_f32 v103, v103, v31
 v_mfma_f32_16x16x32_bf16 v[196:199], v[64:67], a[164:167], v[196:199]
 v_cvt_pk_bf16_f32 v120, v96, v97
 v_mfma_f32_16x16x32_bf16 v[200:203], v[64:67], a[168:171], v[200:203]
 ds_read_b64_tr_b16 v[88:89], v59 offset:16384
 buffer_load_dwordx4 v46, s[12:15], s77 offen offset:2048  lds
 v_mfma_f32_16x16x32_bf16 v[200:203], v[68:71], a[184:187], v[200:203]
 ds_read_b64_tr_b16 v[90:91], v59 offset:20480
 v_cvt_pk_bf16_f32 v121, v98, v99
 v_mfma_f32_16x16x32_bf16 v[204:207], v[68:71], a[188:191], v[204:207]
 v_cvt_pk_bf16_f32 v122, v100, v101
 v_cvt_pk_bf16_f32 v123, v102, v103
 v_mfma_f32_16x16x32_bf16 v[204:207], v[64:67], a[172:175], v[204:207]
 s_waitcnt lgkmcnt(6)
 v_mfma_f32_16x16x32_bf16 v[220:223], v[72:75], a[172:175], v[220:223]
 ds_read_b64_tr_b16 v[92:93], v59 offset:24576
 buffer_load_dwordx4 a[132:135], v49, s[16:19], s78 offen sc1
 v_mfma_f32_16x16x32_bf16 v[220:223], v[76:79], a[188:191], v[220:223]
 ds_read_b64_tr_b16 v[94:95], v59 offset:28672
 buffer_store_dwordx4 v[120:123], v34, s[32:35], s50 offen offset:2048 sc1
 v_mfma_f32_16x16x32_bf16 v[216:219], v[76:79], a[184:187], v[216:219]
 v_accvgpr_read_b32 v104, a108
 v_accvgpr_read_b32 v105, a109
 v_mfma_f32_16x16x32_bf16 v[216:219], v[72:75], a[168:171], v[216:219]
 s_waitcnt vmcnt(29)
 s_barrier
 v_mfma_f32_16x16x32_bf16 v[212:215], v[72:75], a[164:167], v[212:215]
 ds_read_b64_tr_b16 v[64:65], v52 offset:32768
 v_accvgpr_read_b32 v106, a110
 v_mfma_f32_16x16x32_bf16 v[212:215], v[76:79], a[180:183], v[212:215]
 ds_read_b64_tr_b16 v[66:67], v52 offset:36864
 v_accvgpr_read_b32 v107, a111
 v_mfma_f32_16x16x32_bf16 v[208:211], v[76:79], a[176:179], v[208:211]
 v_accvgpr_read_b32 v108, a124
 v_accvgpr_read_b32 v109, a125
 v_mfma_f32_16x16x32_bf16 v[208:211], v[72:75], a[160:163], v[208:211]
 s_waitcnt lgkmcnt(6)
 v_mfma_f32_16x16x32_bf16 v[224:227], v[80:83], a[160:163], v[224:227]
 ds_read_b64_tr_b16 v[68:69], v52 offset:40960
 buffer_load_dwordx4 a[136:139], v50, s[16:19], s78 offen sc1
 v_mfma_f32_16x16x32_bf16 v[224:227], v[84:87], a[176:179], v[224:227]
 ds_read_b64_tr_b16 v[70:71], v52 offset:45056
 v_accvgpr_read_b32 v110, a126
 v_mfma_f32_16x16x32_bf16 v[228:231], v[84:87], a[180:183], v[228:231]
 v_accvgpr_read_b32 v111, a127
 v_mul_f32 v104, v104, v31
 v_mfma_f32_16x16x32_bf16 v[228:231], v[80:83], a[164:167], v[228:231]
 v_mul_f32 v105, v105, v31
 v_mfma_f32_16x16x32_bf16 v[232:235], v[80:83], a[168:171], v[232:235]
 ds_read_b64_tr_b16 v[72:73], v53 offset:32768
 buffer_load_dwordx4 v47, s[12:15], s77 offen offset:3072  lds
 v_mfma_f32_16x16x32_bf16 v[232:235], v[84:87], a[184:187], v[232:235]
 ds_read_b64_tr_b16 v[74:75], v53 offset:36864
 s_add_u32 s77, s77, 262144
 v_mfma_f32_16x16x32_bf16 v[236:239], v[84:87], a[188:191], v[236:239]
 v_mul_f32 v106, v106, v31
 v_mul_f32 v107, v107, v31
 v_mfma_f32_16x16x32_bf16 v[236:239], v[80:83], a[172:175], v[236:239]
 s_waitcnt lgkmcnt(6)
 v_mfma_f32_16x16x32_bf16 v[252:255], v[88:91], a[172:175], v[252:255]
 ds_read_b64_tr_b16 v[76:77], v53 offset:40960
 buffer_load_dwordx4 a[140:143], v51, s[16:19], s78 offen sc1
 v_mfma_f32_16x16x32_bf16 v[252:255], v[92:95], a[188:191], v[252:255]
 ds_read_b64_tr_b16 v[78:79], v53 offset:45056
 buffer_load_dword v61, v0, s[60:63], 0 offen
 v_mul_f32 v108, v108, v31
 v_mfma_f32_16x16x32_bf16 v[248:251], v[92:95], a[184:187], v[248:251]
 v_mul_f32 v109, v109, v31
 v_mul_f32 v110, v110, v31
 v_mfma_f32_16x16x32_bf16 v[248:251], v[88:91], a[168:171], v[248:251]
 v_mul_f32 v111, v111, v31
 v_mfma_f32_16x16x32_bf16 v[244:247], v[88:91], a[164:167], v[244:247]
 ds_read_b64_tr_b16 v[80:81], v54 offset:32768
 v_cvt_pk_bf16_f32 v124, v104, v105
 v_mfma_f32_16x16x32_bf16 v[244:247], v[92:95], a[180:183], v[244:247]
 ds_read_b64_tr_b16 v[82:83], v54 offset:36864
 v_cvt_pk_bf16_f32 v125, v106, v107
 v_mfma_f32_16x16x32_bf16 v[240:243], v[92:95], a[176:179], v[240:243]
 v_cvt_pk_bf16_f32 v126, v108, v109
 v_cvt_pk_bf16_f32 v127, v110, v111
 v_mfma_f32_16x16x32_bf16 v[240:243], v[88:91], a[160:163], v[240:243]
 s_waitcnt lgkmcnt(6)
 buffer_store_dwordx4 v[124:127], v34, s[32:35], s50 offen offset:3072 sc1
 v_mfma_f32_16x16x32_bf16 v[128:131], v[64:67], a[192:195], v[128:131]
 ds_read_b64_tr_b16 v[84:85], v54 offset:40960
 buffer_load_dwordx4 a[144:147], v48, s[16:19], s78 offen offset:1024 sc1
 s_waitcnt vmcnt(31)
 v_mfma_f32_16x16x32_bf16 v[128:131], v[68:71], a[208:211], v[128:131]
 ds_read_b64_tr_b16 v[86:87], v54 offset:45056
 s_add_u32 s20, s86, 0x500000
 s_addc_u32 s21, s87, 0
 s_waitcnt vmcnt(29)
 v_mfma_f32_16x16x32_bf16 v[132:135], v[68:71], a[212:215], v[132:135]
 s_mov_b32 s22, 0x1100000
 s_mov_b32 s23, 0x20000
 v_mfma_f32_16x16x32_bf16 v[132:135], v[64:67], a[196:199], v[132:135]
 s_lshl_b32 s42, s70, 3
 v_mfma_f32_16x16x32_bf16 v[136:139], v[64:67], a[200:203], v[136:139]
 ds_read_b64_tr_b16 v[88:89], v55 offset:32768
 s_add_u32 m0, s79, 32768
 s_waitcnt vmcnt(27)
 v_mfma_f32_16x16x32_bf16 v[136:139], v[68:71], a[216:219], v[136:139]
 ds_read_b64_tr_b16 v[90:91], v55 offset:36864
 s_lshl_b32 s50, s71, 5
 s_waitcnt vmcnt(25)
 v_mfma_f32_16x16x32_bf16 v[140:143], v[68:71], a[220:223], v[140:143]
 buffer_load_dwordx4 v40, s[12:15], s77 offen  lds
 s_add_u32 s50, s50, s42
 v_mfma_f32_16x16x32_bf16 v[140:143], v[64:67], a[204:207], v[140:143]
 s_waitcnt lgkmcnt(6)
 v_mfma_f32_16x16x32_bf16 v[156:159], v[72:75], a[204:207], v[156:159]
 ds_read_b64_tr_b16 v[92:93], v55 offset:40960
 buffer_load_dwordx4 a[148:151], v49, s[16:19], s78 offen offset:1024 sc1
 v_mfma_f32_16x16x32_bf16 v[156:159], v[76:79], a[220:223], v[156:159]
 ds_read_b64_tr_b16 v[94:95], v55 offset:45056
 s_add_u32 s50, s50, 512
 v_mfma_f32_16x16x32_bf16 v[152:155], v[76:79], a[216:219], v[152:155]
 s_lshl_b32 s50, s50, 7
 v_and_b32 v60, 15, v1
 v_mfma_f32_16x16x32_bf16 v[152:155], v[72:75], a[200:203], v[152:155]
 v_min_u32 v60, 8, v60
 v_mfma_f32_16x16x32_bf16 v[148:151], v[72:75], a[196:199], v[148:151]
 ds_read_b64_tr_b16 v[64:65], v56 offset:32768
 v_lshl_add_u32 v60, v60, 7, s50
 v_mfma_f32_16x16x32_bf16 v[148:151], v[76:79], a[212:215], v[148:151]
 ds_read_b64_tr_b16 v[66:67], v56 offset:36864
 s_lshl_b32 s75, s42, 18
 v_mfma_f32_16x16x32_bf16 v[144:147], v[76:79], a[208:211], v[144:147]
 s_lshl_b32 s42, s42, 12
 s_lshl_b32 s50, s71, 4
 v_mfma_f32_16x16x32_bf16 v[144:147], v[72:75], a[192:195], v[144:147]
 s_waitcnt lgkmcnt(6)
 v_mfma_f32_16x16x32_bf16 v[160:163], v[80:83], a[192:195], v[160:163]
 ds_read_b64_tr_b16 v[68:69], v56 offset:40960
 buffer_load_dwordx4 a[152:155], v50, s[16:19], s78 offen offset:1024 sc1
 v_mfma_f32_16x16x32_bf16 v[160:163], v[84:87], a[208:211], v[160:163]
 ds_read_b64_tr_b16 v[70:71], v56 offset:45056
 s_lshl_b32 s52, s36, 2
 v_mfma_f32_16x16x32_bf16 v[164:167], v[84:87], a[212:215], v[164:167]
 s_add_u32 s50, s50, s52
 s_mul_i32 s52, s50, 131328
 v_mfma_f32_16x16x32_bf16 v[164:167], v[80:83], a[196:199], v[164:167]
 s_and_b32 s53, s70, 1
 v_mfma_f32_16x16x32_bf16 v[168:171], v[80:83], a[200:203], v[168:171]
 ds_read_b64_tr_b16 v[72:73], v57 offset:32768
 buffer_load_dwordx4 v41, s[12:15], s77 offen offset:1024  lds
 v_mfma_f32_16x16x32_bf16 v[168:171], v[84:87], a[216:219], v[168:171]
 ds_read_b64_tr_b16 v[74:75], v57 offset:36864
 s_mul_i32 s53, s53, 262656
 v_mfma_f32_16x16x32_bf16 v[172:175], v[84:87], a[220:223], v[172:175]
 v_lshlrev_b32 v24, 4, v1
 v_add_u32 v6, s52, v24
 v_mfma_f32_16x16x32_bf16 v[172:175], v[80:83], a[204:207], v[172:175]
 s_waitcnt lgkmcnt(6)
 v_mfma_f32_16x16x32_bf16 v[188:191], v[88:91], a[204:207], v[188:191]
 ds_read_b64_tr_b16 v[76:77], v57 offset:40960
 buffer_load_dwordx4 a[156:159], v51, s[16:19], s78 offen offset:1024 sc1
 v_mfma_f32_16x16x32_bf16 v[188:191], v[92:95], a[220:223], v[188:191]
 ds_read_b64_tr_b16 v[78:79], v57 offset:45056
 v_add_u32 v4, s53, v6
 v_mfma_f32_16x16x32_bf16 v[184:187], v[92:95], a[216:219], v[184:187]
 s_sub_u32 s53, 262656, s53
 v_add_u32 v5, 131328, v4
 v_mfma_f32_16x16x32_bf16 v[184:187], v[88:91], a[200:203], v[184:187]
 v_add_u32 v6, s53, v6
 v_mfma_f32_16x16x32_bf16 v[180:183], v[88:91], a[196:199], v[180:183]
 ds_read_b64_tr_b16 v[80:81], v58 offset:32768
 v_mfma_f32_16x16x32_bf16 v[180:183], v[92:95], a[212:215], v[180:183]
 ds_read_b64_tr_b16 v[82:83], v58 offset:36864
 v_add_u32 v7, 131328, v6
 v_mfma_f32_16x16x32_bf16 v[176:179], v[92:95], a[208:211], v[176:179]
 v_add_u32 v20, 32768, v27
 v_mfma_f32_16x16x32_bf16 v[176:179], v[88:91], a[192:195], v[176:179]
 s_waitcnt lgkmcnt(6)
 v_mfma_f32_16x16x32_bf16 v[192:195], v[64:67], a[192:195], v[192:195]
 ds_read_b64_tr_b16 v[84:85], v58 offset:40960
 buffer_load_dwordx4 a[160:163], v48, s[16:19], s78 offen offset:2048 sc1
 v_mfma_f32_16x16x32_bf16 v[192:195], v[68:71], a[208:211], v[192:195]
 ds_read_b64_tr_b16 v[86:87], v58 offset:45056
 s_mov_b32 s28, s82
 v_mfma_f32_16x16x32_bf16 v[196:199], v[68:71], a[212:215], v[196:199]
 s_mov_b32 s29, s83
 s_mov_b32 s30, 0x400000
 v_mfma_f32_16x16x32_bf16 v[196:199], v[64:67], a[196:199], v[196:199]
 s_mov_b32 s31, 0x20000
 v_mfma_f32_16x16x32_bf16 v[200:203], v[64:67], a[200:203], v[200:203]
 ds_read_b64_tr_b16 v[88:89], v59 offset:32768
 buffer_load_dwordx4 v42, s[12:15], s77 offen offset:2048  lds
 v_mfma_f32_16x16x32_bf16 v[200:203], v[68:71], a[216:219], v[200:203]
 ds_read_b64_tr_b16 v[90:91], v59 offset:36864
 s_add_u32 s60, s86, 0x4000000
 s_addc_u32 s61, s87, 0
 v_mfma_f32_16x16x32_bf16 v[204:207], v[68:71], a[220:223], v[204:207]
 s_mov_b32 s62, 0x1800000
 v_mfma_f32_16x16x32_bf16 v[204:207], v[64:67], a[204:207], v[204:207]
 s_waitcnt lgkmcnt(6)
 v_mfma_f32_16x16x32_bf16 v[220:223], v[72:75], a[204:207], v[220:223]
 ds_read_b64_tr_b16 v[92:93], v59 offset:40960
 buffer_load_dwordx4 a[164:167], v49, s[16:19], s78 offen offset:2048 sc1
 v_mfma_f32_16x16x32_bf16 v[220:223], v[76:79], a[220:223], v[220:223]
 ds_read_b64_tr_b16 v[94:95], v59 offset:45056
 s_mov_b32 s63, 0x20000
 v_mfma_f32_16x16x32_bf16 v[216:219], v[76:79], a[216:219], v[216:219]
 s_lshl_b32 s50, s71, 3
 s_add_u32 s50, s50, s76
 v_mfma_f32_16x16x32_bf16 v[216:219], v[72:75], a[200:203], v[216:219]
 s_lshl_b32 s50, s50, 2
 v_mfma_f32_16x16x32_bf16 v[212:215], v[72:75], a[196:199], v[212:215]
 ds_read_b64_tr_b16 v[64:65], v52 offset:49152
 s_add_u32 s51, s50, s70
 v_mfma_f32_16x16x32_bf16 v[212:215], v[76:79], a[212:215], v[212:215]
 ds_read_b64_tr_b16 v[66:67], v52 offset:53248
 s_add_u32 s52, s51, 768
 v_mfma_f32_16x16x32_bf16 v[208:211], v[76:79], a[208:211], v[208:211]
 v_mfma_f32_16x16x32_bf16 v[208:211], v[72:75], a[192:195], v[208:211]
 s_waitcnt lgkmcnt(6)
 v_mfma_f32_16x16x32_bf16 v[224:227], v[80:83], a[192:195], v[224:227]
 ds_read_b64_tr_b16 v[68:69], v52 offset:57344
 buffer_load_dwordx4 a[168:171], v50, s[16:19], s78 offen offset:2048 sc1
 v_mfma_f32_16x16x32_bf16 v[224:227], v[84:87], a[208:211], v[224:227]
 ds_read_b64_tr_b16 v[70:71], v52 offset:61440
 s_lshl_b32 s52, s52, 7
 v_mfma_f32_16x16x32_bf16 v[228:231], v[84:87], a[212:215], v[228:231]
 v_xor_b32 v52, s49, v52
 v_mov_b32 v21, s52
 v_mfma_f32_16x16x32_bf16 v[228:231], v[80:83], a[196:199], v[228:231]
 v_add_u32 v22, 32768, v21
 v_mfma_f32_16x16x32_bf16 v[232:235], v[80:83], a[200:203], v[232:235]
 ds_read_b64_tr_b16 v[72:73], v53 offset:49152
 buffer_load_dwordx4 v43, s[12:15], s77 offen offset:3072  lds
 v_mfma_f32_16x16x32_bf16 v[232:235], v[84:87], a[216:219], v[232:235]
 ds_read_b64_tr_b16 v[74:75], v53 offset:53248
 s_add_u32 s52, s50, 768
 v_mfma_f32_16x16x32_bf16 v[236:239], v[84:87], a[220:223], v[236:239]
 s_lshl_b32 s52, s52, 7
 v_and_b32 v23, 3, v1
 v_mfma_f32_16x16x32_bf16 v[236:239], v[80:83], a[204:207], v[236:239]
 s_waitcnt lgkmcnt(6)
 v_mfma_f32_16x16x32_bf16 v[252:255], v[88:91], a[204:207], v[252:255]
 ds_read_b64_tr_b16 v[76:77], v53 offset:57344
 buffer_load_dwordx4 a[172:175], v51, s[16:19], s78 offen offset:2048 sc1
 v_mfma_f32_16x16x32_bf16 v[252:255], v[92:95], a[220:223], v[252:255]
 ds_read_b64_tr_b16 v[78:79], v53 offset:61440
 v_lshl_add_u32 v23, v23, 7, s52
 v_mfma_f32_16x16x32_bf16 v[248:251], v[92:95], a[216:219], v[248:251]
 s_mul_i32 s53, s36, 12288
 v_xor_b32 v53, s49, v53
 v_mfma_f32_16x16x32_bf16 v[248:251], v[88:91], a[200:203], v[248:251]
 s_mul_i32 s33, s51, 49152
 v_mfma_f32_16x16x32_bf16 v[244:247], v[88:91], a[196:199], v[244:247]
 ds_read_b64_tr_b16 v[80:81], v54 offset:49152
 s_add_u32 s33, s33, s53
 v_mfma_f32_16x16x32_bf16 v[244:247], v[92:95], a[212:215], v[244:247]
 ds_read_b64_tr_b16 v[82:83], v54 offset:53248
 s_xor_b32 s52, s51, 1
 v_mfma_f32_16x16x32_bf16 v[240:243], v[92:95], a[208:211], v[240:243]
 s_mul_i32 s52, s52, 49152
 s_add_u32 s52, s52, s53
 v_mfma_f32_16x16x32_bf16 v[240:243], v[88:91], a[192:195], v[240:243]
 s_waitcnt lgkmcnt(6)
 s_waitcnt vmcnt(35)
 v_mfma_f32_16x16x32_bf16 v[128:131], v[64:67], a[224:227], v[128:131]
 ds_read_b64_tr_b16 v[84:85], v54 offset:57344
 buffer_load_dwordx4 a[176:179], v48, s[16:19], s78 offen offset:3072 sc1
 s_waitcnt vmcnt(28)
 v_mfma_f32_16x16x32_bf16 v[128:131], v[68:71], a[240:243], v[128:131]
 ds_read_b64_tr_b16 v[86:87], v54 offset:61440
 s_add_u32 s52, s52, 0
 s_waitcnt vmcnt(26)
 v_mfma_f32_16x16x32_bf16 v[132:135], v[68:71], a[244:247], v[132:135]
 v_xor_b32 v54, s49, v54
 v_add_u32 v25, s52, v24
 v_mfma_f32_16x16x32_bf16 v[132:135], v[64:67], a[228:231], v[132:135]
 s_xor_b32 s52, s51, 2
 v_mfma_f32_16x16x32_bf16 v[136:139], v[64:67], a[232:235], v[136:139]
 ds_read_b64_tr_b16 v[88:89], v55 offset:49152
 s_add_u32 m0, s79, 36864
 s_waitcnt vmcnt(25)
 v_mfma_f32_16x16x32_bf16 v[136:139], v[68:71], a[248:251], v[136:139]
 ds_read_b64_tr_b16 v[90:91], v55 offset:53248
 s_mul_i32 s52, s52, 49152
 s_waitcnt vmcnt(22)
 v_mfma_f32_16x16x32_bf16 v[140:143], v[68:71], a[252:255], v[140:143]
 buffer_load_dwordx4 v44, s[12:15], s77 offen  lds
 s_add_u32 s52, s52, s53
 v_mfma_f32_16x16x32_bf16 v[140:143], v[64:67], a[236:239], v[140:143]
 s_waitcnt lgkmcnt(6)
 v_mfma_f32_16x16x32_bf16 v[156:159], v[72:75], a[236:239], v[156:159]
 ds_read_b64_tr_b16 v[92:93], v55 offset:57344
 buffer_load_dwordx4 a[180:183], v49, s[16:19], s78 offen offset:3072 sc1
 v_mfma_f32_16x16x32_bf16 v[156:159], v[76:79], a[252:255], v[156:159]
 ds_read_b64_tr_b16 v[94:95], v55 offset:61440
 s_add_u32 s52, s52, 4096
 v_mfma_f32_16x16x32_bf16 v[152:155], v[76:79], a[248:251], v[152:155]
 v_xor_b32 v55, s49, v55
 v_add_u32 v26, s52, v24
 v_mfma_f32_16x16x32_bf16 v[152:155], v[72:75], a[232:235], v[152:155]
 s_xor_b32 s52, s51, 3
 v_mfma_f32_16x16x32_bf16 v[148:151], v[72:75], a[228:231], v[148:151]
 ds_read_b64_tr_b16 v[64:65], v56 offset:49152
 s_mul_i32 s52, s52, 49152
 v_mfma_f32_16x16x32_bf16 v[148:151], v[76:79], a[244:247], v[148:151]
 ds_read_b64_tr_b16 v[66:67], v56 offset:53248
 s_add_u32 s52, s52, s53
 v_mfma_f32_16x16x32_bf16 v[144:147], v[76:79], a[240:243], v[144:147]
 s_add_u32 s52, s52, 8192
 v_add_u32 v27, s52, v24
 v_mfma_f32_16x16x32_bf16 v[144:147], v[72:75], a[224:227], v[144:147]
 s_waitcnt lgkmcnt(6)
 v_mfma_f32_16x16x32_bf16 v[160:163], v[80:83], a[224:227], v[160:163]
 ds_read_b64_tr_b16 v[68:69], v56 offset:57344
 buffer_load_dwordx4 a[184:187], v50, s[16:19], s78 offen offset:3072 sc1
 v_mfma_f32_16x16x32_bf16 v[160:163], v[84:87], a[240:243], v[160:163]
 ds_read_b64_tr_b16 v[70:71], v56 offset:61440
 s_lshl_b32 s52, s71, 8
 v_mfma_f32_16x16x32_bf16 v[164:167], v[84:87], a[244:247], v[164:167]
 s_lshl_b32 s53, s36, 6
 v_xor_b32 v56, s49, v56
 v_mfma_f32_16x16x32_bf16 v[164:167], v[80:83], a[228:231], v[164:167]
 s_add_u32 s52, s52, s53
 v_mfma_f32_16x16x32_bf16 v[168:171], v[80:83], a[232:235], v[168:171]
 ds_read_b64_tr_b16 v[72:73], v57 offset:49152
 buffer_load_dwordx4 v45, s[12:15], s77 offen offset:1024  lds
 v_mfma_f32_16x16x32_bf16 v[168:171], v[84:87], a[248:251], v[168:171]
 ds_read_b64_tr_b16 v[74:75], v57 offset:53248
 s_and_b32 s53, s70, 1
 v_mfma_f32_16x16x32_bf16 v[172:175], v[84:87], a[252:255], v[172:175]
 s_lshl_b32 s53, s53, 5
 s_add_u32 s52, s52, s53
 v_mfma_f32_16x16x32_bf16 v[172:175], v[80:83], a[236:239], v[172:175]
 s_waitcnt lgkmcnt(6)
 v_mfma_f32_16x16x32_bf16 v[188:191], v[88:91], a[236:239], v[188:191]
 ds_read_b64_tr_b16 v[76:77], v57 offset:57344
 buffer_load_dwordx4 a[188:191], v51, s[16:19], s78 offen offset:3072 sc1
 v_mfma_f32_16x16x32_bf16 v[188:191], v[92:95], a[252:255], v[188:191]
 ds_read_b64_tr_b16 v[78:79], v57 offset:61440
 s_add_u32 s78, s78, 4096
 v_mfma_f32_16x16x32_bf16 v[184:187], v[92:95], a[248:251], v[184:187]
 s_lshl_b32 s52, s52, 11
 v_xor_b32 v57, s49, v57
 v_mfma_f32_16x16x32_bf16 v[184:187], v[88:91], a[232:235], v[184:187]
 s_lshl_b32 s53, s76, 8
 v_mfma_f32_16x16x32_bf16 v[180:183], v[88:91], a[228:231], v[180:183]
 ds_read_b64_tr_b16 v[80:81], v58 offset:49152
 s_add_u32 s52, s52, s53
 v_mfma_f32_16x16x32_bf16 v[180:183], v[92:95], a[244:247], v[180:183]
 ds_read_b64_tr_b16 v[82:83], v58 offset:53248
 s_lshr_b32 s53, s70, 1
 v_mfma_f32_16x16x32_bf16 v[176:179], v[92:95], a[240:243], v[176:179]
 s_lshl_b32 s53, s53, 7
 s_add_u32 s52, s52, s53
 v_mfma_f32_16x16x32_bf16 v[176:179], v[88:91], a[224:227], v[176:179]
 s_waitcnt lgkmcnt(6)
 v_mfma_f32_16x16x32_bf16 v[192:195], v[64:67], a[224:227], v[192:195]
 ds_read_b64_tr_b16 v[84:85], v58 offset:57344
 buffer_load_dwordx4 a[192:195], v48, s[16:19], s78 offen sc1
 v_mfma_f32_16x16x32_bf16 v[192:195], v[68:71], a[240:243], v[192:195]
 ds_read_b64_tr_b16 v[86:87], v58 offset:61440
 v_and_b32 v36, 7, v1
 v_mfma_f32_16x16x32_bf16 v[196:199], v[68:71], a[244:247], v[196:199]
 v_xor_b32 v58, s49, v58
 v_lshlrev_b32 v36, 11, v36
 v_mfma_f32_16x16x32_bf16 v[196:199], v[64:67], a[228:231], v[196:199]
 v_bfe_u32 v37, v1, 3, 1
 v_mfma_f32_16x16x32_bf16 v[200:203], v[64:67], a[232:235], v[200:203]
 ds_read_b64_tr_b16 v[88:89], v59 offset:49152
 buffer_load_dwordx4 v46, s[12:15], s77 offen offset:2048  lds
 v_mfma_f32_16x16x32_bf16 v[200:203], v[68:71], a[248:251], v[200:203]
 ds_read_b64_tr_b16 v[90:91], v59 offset:53248
 v_lshl_add_u32 v36, v37, 6, v36
 v_mfma_f32_16x16x32_bf16 v[204:207], v[68:71], a[252:255], v[204:207]
 v_bfe_u32 v37, v1, 4, 1
 v_lshl_add_u32 v36, v37, 5, v36
 v_mfma_f32_16x16x32_bf16 v[204:207], v[64:67], a[236:239], v[204:207]
 s_waitcnt lgkmcnt(6)
 v_mfma_f32_16x16x32_bf16 v[220:223], v[72:75], a[236:239], v[220:223]
 ds_read_b64_tr_b16 v[92:93], v59 offset:57344
 buffer_load_dwordx4 a[196:199], v49, s[16:19], s78 offen sc1
 v_mfma_f32_16x16x32_bf16 v[220:223], v[76:79], a[252:255], v[220:223]
 ds_read_b64_tr_b16 v[94:95], v59 offset:61440
 v_lshrrev_b32 v37, 5, v1
 v_mfma_f32_16x16x32_bf16 v[216:219], v[76:79], a[248:251], v[216:219]
 v_xor_b32 v59, s49, v59
 v_lshl_add_u32 v36, v37, 4, v36
 v_mfma_f32_16x16x32_bf16 v[216:219], v[72:75], a[232:235], v[216:219]
 s_waitcnt vmcnt(24)
 s_waitcnt vmcnt(21)
 s_barrier
 v_add_u32 v16, s52, v36
 v_mfma_f32_16x16x32_bf16 v[212:215], v[72:75], a[228:231], v[212:215]
 ds_read_b64_tr_b16 v[64:65], v52
 v_mfma_f32_16x16x32_bf16 v[212:215], v[76:79], a[244:247], v[212:215]
 ds_read_b64_tr_b16 v[66:67], v52 offset:4096
 v_mfma_f32_16x16x32_bf16 v[208:211], v[76:79], a[240:243], v[208:211]
 s_cmp_eq_u32 s36, 1
 s_cbranch_scc0 C_of_79
 buffer_store_dwordx2 v[2:3], v20, s[56:59], 0 offen sc1
C_of_79:
 v_mfma_f32_16x16x32_bf16 v[208:211], v[72:75], a[224:227], v[208:211]
 s_waitcnt lgkmcnt(6)
 v_mfma_f32_16x16x32_bf16 v[224:227], v[80:83], a[224:227], v[224:227]
 ds_read_b64_tr_b16 v[68:69], v52 offset:8192
 buffer_load_dwordx4 a[200:203], v50, s[16:19], s78 offen sc1
 v_mfma_f32_16x16x32_bf16 v[224:227], v[84:87], a[240:243], v[224:227]
 ds_read_b64_tr_b16 v[70:71], v52 offset:12288
 v_mfma_f32_16x16x32_bf16 v[228:231], v[84:87], a[244:247], v[228:231]
 v_mfma_f32_16x16x32_bf16 v[228:231], v[80:83], a[228:231], v[228:231]
 v_mfma_f32_16x16x32_bf16 v[232:235], v[80:83], a[232:235], v[232:235]
 ds_read_b64_tr_b16 v[72:73], v53
 buffer_load_dwordx4 v47, s[12:15], s77 offen offset:3072  lds
 v_mfma_f32_16x16x32_bf16 v[232:235], v[84:87], a[248:251], v[232:235]
 ds_read_b64_tr_b16 v[74:75], v53 offset:4096
 s_add_u32 s77, s77, 262144
 v_mfma_f32_16x16x32_bf16 v[236:239], v[84:87], a[252:255], v[236:239]
 v_mfma_f32_16x16x32_bf16 v[236:239], v[80:83], a[236:239], v[236:239]
 s_waitcnt lgkmcnt(6)
 v_mfma_f32_16x16x32_bf16 v[252:255], v[88:91], a[236:239], v[252:255]
 ds_read_b64_tr_b16 v[76:77], v53 offset:8192
 buffer_load_dwordx4 a[204:207], v51, s[16:19], s78 offen sc1
 v_mfma_f32_16x16x32_bf16 v[252:255], v[92:95], a[252:255], v[252:255]
 ds_read_b64_tr_b16 v[78:79], v53 offset:12288
 v_mfma_f32_16x16x32_bf16 v[248:251], v[92:95], a[248:251], v[248:251]
 v_mfma_f32_16x16x32_bf16 v[248:251], v[88:91], a[232:235], v[248:251]
 v_mfma_f32_16x16x32_bf16 v[244:247], v[88:91], a[228:231], v[244:247]
 ds_read_b64_tr_b16 v[80:81], v54
 v_mfma_f32_16x16x32_bf16 v[244:247], v[92:95], a[244:247], v[244:247]
 ds_read_b64_tr_b16 v[82:83], v54 offset:4096
 v_mfma_f32_16x16x32_bf16 v[240:243], v[92:95], a[240:243], v[240:243]
 v_mfma_f32_16x16x32_bf16 v[240:243], v[88:91], a[224:227], v[240:243]
 s_waitcnt lgkmcnt(6)
 v_mfma_f32_16x16x32_bf16 v[128:131], v[64:67], a[128:131], v[128:131]
 ds_read_b64_tr_b16 v[84:85], v54 offset:8192
 buffer_load_dwordx4 a[208:211], v48, s[16:19], s78 offen offset:1024 sc1
 s_waitcnt vmcnt(24)
 v_mfma_f32_16x16x32_bf16 v[128:131], v[68:71], a[144:147], v[128:131]
 ds_read_b64_tr_b16 v[86:87], v54 offset:12288
 s_waitcnt vmcnt(22)
 v_mfma_f32_16x16x32_bf16 v[132:135], v[68:71], a[148:151], v[132:135]
 v_mfma_f32_16x16x32_bf16 v[132:135], v[64:67], a[132:135], v[132:135]
 v_mfma_f32_16x16x32_bf16 v[136:139], v[64:67], a[136:139], v[136:139]
 ds_read_b64_tr_b16 v[88:89], v55
 s_add_u32 m0, s79, 65536
 s_waitcnt vmcnt(21)
 v_mfma_f32_16x16x32_bf16 v[136:139], v[68:71], a[152:155], v[136:139]
 ds_read_b64_tr_b16 v[90:91], v55 offset:4096
 s_waitcnt vmcnt(19)
 v_mfma_f32_16x16x32_bf16 v[140:143], v[68:71], a[156:159], v[140:143]
 buffer_load_dwordx4 v40, s[12:15], s77 offen  lds
 v_mfma_f32_16x16x32_bf16 v[140:143], v[64:67], a[140:143], v[140:143]
 s_waitcnt lgkmcnt(6)
 v_mfma_f32_16x16x32_bf16 v[156:159], v[72:75], a[140:143], v[156:159]
 ds_read_b64_tr_b16 v[92:93], v55 offset:8192
 buffer_load_dwordx4 a[212:215], v49, s[16:19], s78 offen offset:1024 sc1
 v_mfma_f32_16x16x32_bf16 v[156:159], v[76:79], a[156:159], v[156:159]
 ds_read_b64_tr_b16 v[94:95], v55 offset:12288
 v_mfma_f32_16x16x32_bf16 v[152:155], v[76:79], a[152:155], v[152:155]
 v_mfma_f32_16x16x32_bf16 v[152:155], v[72:75], a[136:139], v[152:155]
 v_mfma_f32_16x16x32_bf16 v[148:151], v[72:75], a[132:135], v[148:151]
 ds_read_b64_tr_b16 v[64:65], v56
 v_mfma_f32_16x16x32_bf16 v[148:151], v[76:79], a[148:151], v[148:151]
 ds_read_b64_tr_b16 v[66:67], v56 offset:4096
 v_mfma_f32_16x16x32_bf16 v[144:147], v[76:79], a[144:147], v[144:147]
 v_mfma_f32_16x16x32_bf16 v[144:147], v[72:75], a[128:131], v[144:147]
 s_waitcnt lgkmcnt(6)
 v_mfma_f32_16x16x32_bf16 v[160:163], v[80:83], a[128:131], v[160:163]
 ds_read_b64_tr_b16 v[68:69], v56 offset:8192
 buffer_load_dwordx4 a[216:219], v50, s[16:19], s78 offen offset:1024 sc1
 v_mfma_f32_16x16x32_bf16 v[160:163], v[84:87], a[144:147], v[160:163]
 ds_read_b64_tr_b16 v[70:71], v56 offset:12288
 v_mfma_f32_16x16x32_bf16 v[164:167], v[84:87], a[148:151], v[164:167]
 v_mfma_f32_16x16x32_bf16 v[164:167], v[80:83], a[132:135], v[164:167]
 v_mfma_f32_16x16x32_bf16 v[168:171], v[80:83], a[136:139], v[168:171]
 ds_read_b64_tr_b16 v[72:73], v57
 buffer_load_dwordx4 v41, s[12:15], s77 offen offset:1024  lds
 v_mfma_f32_16x16x32_bf16 v[168:171], v[84:87], a[152:155], v[168:171]
 ds_read_b64_tr_b16 v[74:75], v57 offset:4096
 v_mfma_f32_16x16x32_bf16 v[172:175], v[84:87], a[156:159], v[172:175]
 v_mfma_f32_16x16x32_bf16 v[172:175], v[80:83], a[140:143], v[172:175]
 s_waitcnt lgkmcnt(6)
 v_mfma_f32_16x16x32_bf16 v[188:191], v[88:91], a[140:143], v[188:191]
 ds_read_b64_tr_b16 v[76:77], v57 offset:8192
 buffer_load_dwordx4 a[220:223], v51, s[16:19], s78 offen offset:1024 sc1
 v_mfma_f32_16x16x32_bf16 v[188:191], v[92:95], a[156:159], v[188:191]
 ds_read_b64_tr_b16 v[78:79], v57 offset:12288
 v_mfma_f32_16x16x32_bf16 v[184:187], v[92:95], a[152:155], v[184:187]
 v_mfma_f32_16x16x32_bf16 v[184:187], v[88:91], a[136:139], v[184:187]
 v_mfma_f32_16x16x32_bf16 v[180:183], v[88:91], a[132:135], v[180:183]
 ds_read_b64_tr_b16 v[80:81], v58
 v_mfma_f32_16x16x32_bf16 v[180:183], v[92:95], a[148:151], v[180:183]
 ds_read_b64_tr_b16 v[82:83], v58 offset:4096
 v_mfma_f32_16x16x32_bf16 v[176:179], v[92:95], a[144:147], v[176:179]
 v_mfma_f32_16x16x32_bf16 v[176:179], v[88:91], a[128:131], v[176:179]
 s_waitcnt lgkmcnt(6)
 v_mfma_f32_16x16x32_bf16 v[192:195], v[64:67], a[128:131], v[192:195]
 ds_read_b64_tr_b16 v[84:85], v58 offset:8192
 buffer_load_dwordx4 a[224:227], v48, s[16:19], s78 offen offset:2048 sc1
 v_mfma_f32_16x16x32_bf16 v[192:195], v[68:71], a[144:147], v[192:195]
 ds_read_b64_tr_b16 v[86:87], v58 offset:12288
 v_mfma_f32_16x16x32_bf16 v[196:199], v[68:71], a[148:151], v[196:199]
 v_mfma_f32_16x16x32_bf16 v[196:199], v[64:67], a[132:135], v[196:199]
 v_mfma_f32_16x16x32_bf16 v[200:203], v[64:67], a[136:139], v[200:203]
 ds_read_b64_tr_b16 v[88:89], v59
 buffer_load_dwordx4 v42, s[12:15], s77 offen offset:2048  lds
 v_mfma_f32_16x16x32_bf16 v[200:203], v[68:71], a[152:155], v[200:203]
 ds_read_b64_tr_b16 v[90:91], v59 offset:4096
 v_mfma_f32_16x16x32_bf16 v[204:207], v[68:71], a[156:159], v[204:207]
 v_mfma_f32_16x16x32_bf16 v[204:207], v[64:67], a[140:143], v[204:207]
 s_waitcnt lgkmcnt(6)
 v_mfma_f32_16x16x32_bf16 v[220:223], v[72:75], a[140:143], v[220:223]
 ds_read_b64_tr_b16 v[92:93], v59 offset:8192
 buffer_load_dwordx4 a[228:231], v49, s[16:19], s78 offen offset:2048 sc1
 v_mfma_f32_16x16x32_bf16 v[220:223], v[76:79], a[156:159], v[220:223]
 ds_read_b64_tr_b16 v[94:95], v59 offset:12288
 v_mfma_f32_16x16x32_bf16 v[216:219], v[76:79], a[152:155], v[216:219]
 v_mfma_f32_16x16x32_bf16 v[216:219], v[72:75], a[136:139], v[216:219]
 v_mfma_f32_16x16x32_bf16 v[212:215], v[72:75], a[132:135], v[212:215]
 ds_read_b64_tr_b16 v[64:65], v52 offset:16384
 v_mfma_f32_16x16x32_bf16 v[212:215], v[76:79], a[148:151], v[212:215]
 ds_read_b64_tr_b16 v[66:67], v52 offset:20480
 v_mfma_f32_16x16x32_bf16 v[208:211], v[76:79], a[144:147], v[208:211]
 v_mfma_f32_16x16x32_bf16 v[208:211], v[72:75], a[128:131], v[208:211]
 s_waitcnt lgkmcnt(6)
 v_mfma_f32_16x16x32_bf16 v[224:227], v[80:83], a[128:131], v[224:227]
 ds_read_b64_tr_b16 v[68:69], v52 offset:24576
 buffer_load_dwordx4 a[232:235], v50, s[16:19], s78 offen offset:2048 sc1
 v_mfma_f32_16x16x32_bf16 v[224:227], v[84:87], a[144:147], v[224:227]
 ds_read_b64_tr_b16 v[70:71], v52 offset:28672
 v_mfma_f32_16x16x32_bf16 v[228:231], v[84:87], a[148:151], v[228:231]
 v_mfma_f32_16x16x32_bf16 v[228:231], v[80:83], a[132:135], v[228:231]
 v_mfma_f32_16x16x32_bf16 v[232:235], v[80:83], a[136:139], v[232:235]
 ds_read_b64_tr_b16 v[72:73], v53 offset:16384
 buffer_load_dwordx4 v43, s[12:15], s77 offen offset:3072  lds
 v_mfma_f32_16x16x32_bf16 v[232:235], v[84:87], a[152:155], v[232:235]
 ds_read_b64_tr_b16 v[74:75], v53 offset:20480
 v_mfma_f32_16x16x32_bf16 v[236:239], v[84:87], a[156:159], v[236:239]
 v_mfma_f32_16x16x32_bf16 v[236:239], v[80:83], a[140:143], v[236:239]
 s_waitcnt lgkmcnt(6)
 v_mfma_f32_16x16x32_bf16 v[252:255], v[88:91], a[140:143], v[252:255]
 ds_read_b64_tr_b16 v[76:77], v53 offset:24576
 buffer_load_dwordx4 a[236:239], v51, s[16:19], s78 offen offset:2048 sc1
 v_mfma_f32_16x16x32_bf16 v[252:255], v[92:95], a[156:159], v[252:255]
 ds_read_b64_tr_b16 v[78:79], v53 offset:28672
 v_mfma_f32_16x16x32_bf16 v[248:251], v[92:95], a[152:155], v[248:251]
 v_mfma_f32_16x16x32_bf16 v[248:251], v[88:91], a[136:139], v[248:251]
 v_mfma_f32_16x16x32_bf16 v[244:247], v[88:91], a[132:135], v[244:247]
 ds_read_b64_tr_b16 v[80:81], v54 offset:16384
 v_mfma_f32_16x16x32_bf16 v[244:247], v[92:95], a[148:151], v[244:247]
 ds_read_b64_tr_b16 v[82:83], v54 offset:20480
 v_mfma_f32_16x16x32_bf16 v[240:243], v[92:95], a[144:147], v[240:243]
 v_mfma_f32_16x16x32_bf16 v[240:243], v[88:91], a[128:131], v[240:243]
 s_waitcnt lgkmcnt(6)
 s_waitcnt vmcnt(29)
 v_mfma_f32_16x16x32_bf16 v[128:131], v[64:67], a[160:163], v[128:131]
 ds_read_b64_tr_b16 v[84:85], v54 offset:24576
 buffer_load_dwordx4 a[240:243], v48, s[16:19], s78 offen offset:3072 sc1
 s_waitcnt vmcnt(24)
 v_mfma_f32_16x16x32_bf16 v[128:131], v[68:71], a[176:179], v[128:131]
 ds_read_b64_tr_b16 v[86:87], v54 offset:28672
 s_waitcnt vmcnt(22)
 v_mfma_f32_16x16x32_bf16 v[132:135], v[68:71], a[180:183], v[132:135]
 v_mfma_f32_16x16x32_bf16 v[132:135], v[64:67], a[164:167], v[132:135]
 v_mfma_f32_16x16x32_bf16 v[136:139], v[64:67], a[168:171], v[136:139]
 ds_read_b64_tr_b16 v[88:89], v55 offset:16384
 s_add_u32 m0, s79, 69632
 s_waitcnt vmcnt(21)
 v_mfma_f32_16x16x32_bf16 v[136:139], v[68:71], a[184:187], v[136:139]
 ds_read_b64_tr_b16 v[90:91], v55 offset:20480
 s_waitcnt vmcnt(19)
 v_mfma_f32_16x16x32_bf16 v[140:143], v[68:71], a[188:191], v[140:143]
 buffer_load_dwordx4 v44, s[12:15], s77 offen  lds
 v_mfma_f32_16x16x32_bf16 v[140:143], v[64:67], a[172:175], v[140:143]
 s_waitcnt lgkmcnt(6)
 v_mfma_f32_16x16x32_bf16 v[156:159], v[72:75], a[172:175], v[156:159]
 ds_read_b64_tr_b16 v[92:93], v55 offset:24576
 buffer_load_dwordx4 a[244:247], v49, s[16:19], s78 offen offset:3072 sc1
 v_mfma_f32_16x16x32_bf16 v[156:159], v[76:79], a[188:191], v[156:159]
 ds_read_b64_tr_b16 v[94:95], v55 offset:28672
 v_mfma_f32_16x16x32_bf16 v[152:155], v[76:79], a[184:187], v[152:155]
 v_mfma_f32_16x16x32_bf16 v[152:155], v[72:75], a[168:171], v[152:155]
 v_mfma_f32_16x16x32_bf16 v[148:151], v[72:75], a[164:167], v[148:151]
 ds_read_b64_tr_b16 v[64:65], v56 offset:16384
 v_mfma_f32_16x16x32_bf16 v[148:151], v[76:79], a[180:183], v[148:151]
 ds_read_b64_tr_b16 v[66:67], v56 offset:20480
 v_mfma_f32_16x16x32_bf16 v[144:147], v[76:79], a[176:179], v[144:147]
 v_mfma_f32_16x16x32_bf16 v[144:147], v[72:75], a[160:163], v[144:147]
 s_waitcnt lgkmcnt(6)
 v_mfma_f32_16x16x32_bf16 v[160:163], v[80:83], a[160:163], v[160:163]
 ds_read_b64_tr_b16 v[68:69], v56 offset:24576
 buffer_load_dwordx4 a[248:251], v50, s[16:19], s78 offen offset:3072 sc1
 v_mfma_f32_16x16x32_bf16 v[160:163], v[84:87], a[176:179], v[160:163]
 ds_read_b64_tr_b16 v[70:71], v56 offset:28672
 v_mfma_f32_16x16x32_bf16 v[164:167], v[84:87], a[180:183], v[164:167]
 v_mfma_f32_16x16x32_bf16 v[164:167], v[80:83], a[164:167], v[164:167]
 v_mfma_f32_16x16x32_bf16 v[168:171], v[80:83], a[168:171], v[168:171]
 ds_read_b64_tr_b16 v[72:73], v57 offset:16384
 buffer_load_dwordx4 v45, s[12:15], s77 offen offset:1024  lds
 v_mfma_f32_16x16x32_bf16 v[168:171], v[84:87], a[184:187], v[168:171]
 ds_read_b64_tr_b16 v[74:75], v57 offset:20480
 v_mfma_f32_16x16x32_bf16 v[172:175], v[84:87], a[188:191], v[172:175]
 v_mfma_f32_16x16x32_bf16 v[172:175], v[80:83], a[172:175], v[172:175]
 s_waitcnt lgkmcnt(6)
 v_mfma_f32_16x16x32_bf16 v[188:191], v[88:91], a[172:175], v[188:191]
 ds_read_b64_tr_b16 v[76:77], v57 offset:24576
 buffer_load_dwordx4 a[252:255], v51, s[16:19], s78 offen offset:3072 sc1
 v_mfma_f32_16x16x32_bf16 v[188:191], v[92:95], a[188:191], v[188:191]
 ds_read_b64_tr_b16 v[78:79], v57 offset:28672
 s_add_u32 s78, s78, 4096
 v_mfma_f32_16x16x32_bf16 v[184:187], v[92:95], a[184:187], v[184:187]
 v_mfma_f32_16x16x32_bf16 v[184:187], v[88:91], a[168:171], v[184:187]
 v_mfma_f32_16x16x32_bf16 v[180:183], v[88:91], a[164:167], v[180:183]
 ds_read_b64_tr_b16 v[80:81], v58 offset:16384
 v_mfma_f32_16x16x32_bf16 v[180:183], v[92:95], a[180:183], v[180:183]
 ds_read_b64_tr_b16 v[82:83], v58 offset:20480
 v_mfma_f32_16x16x32_bf16 v[176:179], v[92:95], a[176:179], v[176:179]
 v_mfma_f32_16x16x32_bf16 v[176:179], v[88:91], a[160:163], v[176:179]
 s_waitcnt lgkmcnt(6)
 v_mfma_f32_16x16x32_bf16 v[192:195], v[64:67], a[160:163], v[192:195]
 ds_read_b64_tr_b16 v[84:85], v58 offset:24576
 buffer_load_dwordx4 a[128:131], v48, s[16:19], s78 offen sc1
 v_mfma_f32_16x16x32_bf16 v[192:195], v[68:71], a[176:179], v[192:195]
 ds_read_b64_tr_b16 v[86:87], v58 offset:28672
 v_mfma_f32_16x16x32_bf16 v[196:199], v[68:71], a[180:183], v[196:199]
 v_mfma_f32_16x16x32_bf16 v[196:199], v[64:67], a[164:167], v[196:199]
 v_mfma_f32_16x16x32_bf16 v[200:203], v[64:67], a[168:171], v[200:203]
 ds_read_b64_tr_b16 v[88:89], v59 offset:16384
 buffer_load_dwordx4 v46, s[12:15], s77 offen offset:2048  lds
 v_mfma_f32_16x16x32_bf16 v[200:203], v[68:71], a[184:187], v[200:203]
 ds_read_b64_tr_b16 v[90:91], v59 offset:20480
 v_mfma_f32_16x16x32_bf16 v[204:207], v[68:71], a[188:191], v[204:207]
 v_mfma_f32_16x16x32_bf16 v[204:207], v[64:67], a[172:175], v[204:207]
 s_waitcnt lgkmcnt(6)
 v_mfma_f32_16x16x32_bf16 v[220:223], v[72:75], a[172:175], v[220:223]
 ds_read_b64_tr_b16 v[92:93], v59 offset:24576
 buffer_load_dwordx4 a[132:135], v49, s[16:19], s78 offen sc1
 v_mfma_f32_16x16x32_bf16 v[220:223], v[76:79], a[188:191], v[220:223]
 ds_read_b64_tr_b16 v[94:95], v59 offset:28672
 v_mfma_f32_16x16x32_bf16 v[216:219], v[76:79], a[184:187], v[216:219]
 v_mfma_f32_16x16x32_bf16 v[216:219], v[72:75], a[168:171], v[216:219]
 s_waitcnt vmcnt(22)
 s_barrier
 v_mfma_f32_16x16x32_bf16 v[212:215], v[72:75], a[164:167], v[212:215]
 ds_read_b64_tr_b16 v[64:65], v52 offset:32768
 v_mfma_f32_16x16x32_bf16 v[212:215], v[76:79], a[180:183], v[212:215]
 ds_read_b64_tr_b16 v[66:67], v52 offset:36864
 v_mfma_f32_16x16x32_bf16 v[208:211], v[76:79], a[176:179], v[208:211]
 v_mfma_f32_16x16x32_bf16 v[208:211], v[72:75], a[160:163], v[208:211]
 s_waitcnt lgkmcnt(6)
 v_mfma_f32_16x16x32_bf16 v[224:227], v[80:83], a[160:163], v[224:227]
 ds_read_b64_tr_b16 v[68:69], v52 offset:40960
 buffer_load_dwordx4 a[136:139], v50, s[16:19], s78 offen sc1
 v_mfma_f32_16x16x32_bf16 v[224:227], v[84:87], a[176:179], v[224:227]
 ds_read_b64_tr_b16 v[70:71], v52 offset:45056
 v_mfma_f32_16x16x32_bf16 v[228:231], v[84:87], a[180:183], v[228:231]
 v_mfma_f32_16x16x32_bf16 v[228:231], v[80:83], a[164:167], v[228:231]
 v_mfma_f32_16x16x32_bf16 v[232:235], v[80:83], a[168:171], v[232:235]
 ds_read_b64_tr_b16 v[72:73], v53 offset:32768
 buffer_load_dwordx4 v47, s[12:15], s77 offen offset:3072  lds
 v_mfma_f32_16x16x32_bf16 v[232:235], v[84:87], a[184:187], v[232:235]
 ds_read_b64_tr_b16 v[74:75], v53 offset:36864
 s_add_u32 s77, s77, 262144
 v_mfma_f32_16x16x32_bf16 v[236:239], v[84:87], a[188:191], v[236:239]
 v_mfma_f32_16x16x32_bf16 v[236:239], v[80:83], a[172:175], v[236:239]
 s_waitcnt lgkmcnt(6)
 v_mfma_f32_16x16x32_bf16 v[252:255], v[88:91], a[172:175], v[252:255]
 ds_read_b64_tr_b16 v[76:77], v53 offset:40960
 buffer_load_dwordx4 a[140:143], v51, s[16:19], s78 offen sc1
 v_mfma_f32_16x16x32_bf16 v[252:255], v[92:95], a[188:191], v[252:255]
 ds_read_b64_tr_b16 v[78:79], v53 offset:45056
 v_mfma_f32_16x16x32_bf16 v[248:251], v[92:95], a[184:187], v[248:251]
 v_mfma_f32_16x16x32_bf16 v[248:251], v[88:91], a[168:171], v[248:251]
 v_mfma_f32_16x16x32_bf16 v[244:247], v[88:91], a[164:167], v[244:247]
 ds_read_b64_tr_b16 v[80:81], v54 offset:32768
 v_mfma_f32_16x16x32_bf16 v[244:247], v[92:95], a[180:183], v[244:247]
 ds_read_b64_tr_b16 v[82:83], v54 offset:36864
 v_mfma_f32_16x16x32_bf16 v[240:243], v[92:95], a[176:179], v[240:243]
 v_mfma_f32_16x16x32_bf16 v[240:243], v[88:91], a[160:163], v[240:243]
 s_waitcnt lgkmcnt(6)
 v_mfma_f32_16x16x32_bf16 v[128:131], v[64:67], a[192:195], v[128:131]
 ds_read_b64_tr_b16 v[84:85], v54 offset:40960
 buffer_load_dwordx4 a[144:147], v48, s[16:19], s78 offen offset:1024 sc1
 s_waitcnt vmcnt(24)
 v_mfma_f32_16x16x32_bf16 v[128:131], v[68:71], a[208:211], v[128:131]
 ds_read_b64_tr_b16 v[86:87], v54 offset:45056
 s_waitcnt vmcnt(22)
 v_mfma_f32_16x16x32_bf16 v[132:135], v[68:71], a[212:215], v[132:135]
 v_mfma_f32_16x16x32_bf16 v[132:135], v[64:67], a[196:199], v[132:135]
 v_mfma_f32_16x16x32_bf16 v[136:139], v[64:67], a[200:203], v[136:139]
 ds_read_b64_tr_b16 v[88:89], v55 offset:32768
 s_add_u32 m0, s79, 98304
 s_waitcnt vmcnt(21)
 v_mfma_f32_16x16x32_bf16 v[136:139], v[68:71], a[216:219], v[136:139]
 ds_read_b64_tr_b16 v[90:91], v55 offset:36864
 s_waitcnt vmcnt(19)
 v_mfma_f32_16x16x32_bf16 v[140:143], v[68:71], a[220:223], v[140:143]
 buffer_load_dwordx4 v40, s[8:11], s75 offen  lds
 v_mfma_f32_16x16x32_bf16 v[140:143], v[64:67], a[204:207], v[140:143]
 s_waitcnt lgkmcnt(6)
 v_mfma_f32_16x16x32_bf16 v[156:159], v[72:75], a[204:207], v[156:159]
 ds_read_b64_tr_b16 v[92:93], v55 offset:40960
 buffer_load_dwordx4 a[148:151], v49, s[16:19], s78 offen offset:1024 sc1
 v_mfma_f32_16x16x32_bf16 v[156:159], v[76:79], a[220:223], v[156:159]
 ds_read_b64_tr_b16 v[94:95], v55 offset:45056
 v_mfma_f32_16x16x32_bf16 v[152:155], v[76:79], a[216:219], v[152:155]
 v_mfma_f32_16x16x32_bf16 v[152:155], v[72:75], a[200:203], v[152:155]
 v_mfma_f32_16x16x32_bf16 v[148:151], v[72:75], a[196:199], v[148:151]
 ds_read_b64_tr_b16 v[64:65], v56 offset:32768
 v_mfma_f32_16x16x32_bf16 v[148:151], v[76:79], a[212:215], v[148:151]
 ds_read_b64_tr_b16 v[66:67], v56 offset:36864
 v_mfma_f32_16x16x32_bf16 v[144:147], v[76:79], a[208:211], v[144:147]
 v_mfma_f32_16x16x32_bf16 v[144:147], v[72:75], a[192:195], v[144:147]
 s_waitcnt lgkmcnt(6)
 v_mfma_f32_16x16x32_bf16 v[160:163], v[80:83], a[192:195], v[160:163]
 ds_read_b64_tr_b16 v[68:69], v56 offset:40960
 buffer_load_dwordx4 a[152:155], v50, s[16:19], s78 offen offset:1024 sc1
 v_mfma_f32_16x16x32_bf16 v[160:163], v[84:87], a[208:211], v[160:163]
 ds_read_b64_tr_b16 v[70:71], v56 offset:45056
 v_mfma_f32_16x16x32_bf16 v[164:167], v[84:87], a[212:215], v[164:167]
 v_mfma_f32_16x16x32_bf16 v[164:167], v[80:83], a[196:199], v[164:167]
 v_mfma_f32_16x16x32_bf16 v[168:171], v[80:83], a[200:203], v[168:171]
 ds_read_b64_tr_b16 v[72:73], v57 offset:32768
 buffer_load_dwordx4 v41, s[8:11], s75 offen offset:1024  lds
 v_mfma_f32_16x16x32_bf16 v[168:171], v[84:87], a[216:219], v[168:171]
 ds_read_b64_tr_b16 v[74:75], v57 offset:36864
 v_mfma_f32_16x16x32_bf16 v[172:175], v[84:87], a[220:223], v[172:175]
 v_mfma_f32_16x16x32_bf16 v[172:175], v[80:83], a[204:207], v[172:175]
 s_waitcnt lgkmcnt(6)
 v_mfma_f32_16x16x32_bf16 v[188:191], v[88:91], a[204:207], v[188:191]
 ds_read_b64_tr_b16 v[76:77], v57 offset:40960
 buffer_load_dwordx4 a[156:159], v51, s[16:19], s78 offen offset:1024 sc1
 v_mfma_f32_16x16x32_bf16 v[188:191], v[92:95], a[220:223], v[188:191]
 ds_read_b64_tr_b16 v[78:79], v57 offset:45056
 v_mfma_f32_16x16x32_bf16 v[184:187], v[92:95], a[216:219], v[184:187]
 v_mfma_f32_16x16x32_bf16 v[184:187], v[88:91], a[200:203], v[184:187]
 v_mfma_f32_16x16x32_bf16 v[180:183], v[88:91], a[196:199], v[180:183]
 ds_read_b64_tr_b16 v[80:81], v58 offset:32768
 v_mfma_f32_16x16x32_bf16 v[180:183], v[92:95], a[212:215], v[180:183]
 ds_read_b64_tr_b16 v[82:83], v58 offset:36864
 v_mfma_f32_16x16x32_bf16 v[176:179], v[92:95], a[208:211], v[176:179]
 v_mfma_f32_16x16x32_bf16 v[176:179], v[88:91], a[192:195], v[176:179]
 s_waitcnt lgkmcnt(6)
 v_mfma_f32_16x16x32_bf16 v[192:195], v[64:67], a[192:195], v[192:195]
 ds_read_b64_tr_b16 v[84:85], v58 offset:40960
 buffer_load_dwordx4 a[160:163], v48, s[16:19], s78 offen offset:2048 sc1
 buffer_load_dwordx2 v[62:63], v60, s[56:59], 0 offen sc1
 v_mfma_f32_16x16x32_bf16 v[192:195], v[68:71], a[208:211], v[192:195]
 ds_read_b64_tr_b16 v[86:87], v58 offset:45056
 v_mfma_f32_16x16x32_bf16 v[196:199], v[68:71], a[212:215], v[196:199]
 v_mfma_f32_16x16x32_bf16 v[196:199], v[64:67], a[196:199], v[196:199]
 v_mfma_f32_16x16x32_bf16 v[200:203], v[64:67], a[200:203], v[200:203]
 ds_read_b64_tr_b16 v[88:89], v59 offset:32768
 buffer_load_dwordx4 v42, s[8:11], s75 offen offset:2048  lds
 v_mfma_f32_16x16x32_bf16 v[200:203], v[68:71], a[216:219], v[200:203]
 ds_read_b64_tr_b16 v[90:91], v59 offset:36864
 v_mfma_f32_16x16x32_bf16 v[204:207], v[68:71], a[220:223], v[204:207]
 v_mfma_f32_16x16x32_bf16 v[204:207], v[64:67], a[204:207], v[204:207]
 s_waitcnt lgkmcnt(6)
 v_mfma_f32_16x16x32_bf16 v[220:223], v[72:75], a[204:207], v[220:223]
 ds_read_b64_tr_b16 v[92:93], v59 offset:40960
 buffer_load_dwordx4 a[164:167], v49, s[16:19], s78 offen offset:2048 sc1
 v_mfma_f32_16x16x32_bf16 v[220:223], v[76:79], a[220:223], v[220:223]
 ds_read_b64_tr_b16 v[94:95], v59 offset:45056
 v_mfma_f32_16x16x32_bf16 v[216:219], v[76:79], a[216:219], v[216:219]
 v_mfma_f32_16x16x32_bf16 v[216:219], v[72:75], a[200:203], v[216:219]
 v_mfma_f32_16x16x32_bf16 v[212:215], v[72:75], a[196:199], v[212:215]
 ds_read_b64_tr_b16 v[64:65], v52 offset:49152
 v_mfma_f32_16x16x32_bf16 v[212:215], v[76:79], a[212:215], v[212:215]
 ds_read_b64_tr_b16 v[66:67], v52 offset:53248
 v_mfma_f32_16x16x32_bf16 v[208:211], v[76:79], a[208:211], v[208:211]
 v_mfma_f32_16x16x32_bf16 v[208:211], v[72:75], a[192:195], v[208:211]
 s_waitcnt lgkmcnt(6)
 v_mfma_f32_16x16x32_bf16 v[224:227], v[80:83], a[192:195], v[224:227]
 ds_read_b64_tr_b16 v[68:69], v52 offset:57344
 buffer_load_dwordx4 a[168:171], v50, s[16:19], s78 offen offset:2048 sc1
 v_mfma_f32_16x16x32_bf16 v[224:227], v[84:87], a[208:211], v[224:227]
 ds_read_b64_tr_b16 v[70:71], v52 offset:61440
 v_mfma_f32_16x16x32_bf16 v[228:231], v[84:87], a[212:215], v[228:231]
 v_xor_b32 v52, s49, v52
 v_mfma_f32_16x16x32_bf16 v[228:231], v[80:83], a[196:199], v[228:231]
 v_mfma_f32_16x16x32_bf16 v[232:235], v[80:83], a[200:203], v[232:235]
 ds_read_b64_tr_b16 v[72:73], v53 offset:49152
 buffer_load_dwordx4 v43, s[8:11], s75 offen offset:3072  lds
 v_mfma_f32_16x16x32_bf16 v[232:235], v[84:87], a[216:219], v[232:235]
 ds_read_b64_tr_b16 v[74:75], v53 offset:53248
 v_mfma_f32_16x16x32_bf16 v[236:239], v[84:87], a[220:223], v[236:239]
 v_mfma_f32_16x16x32_bf16 v[236:239], v[80:83], a[204:207], v[236:239]
 s_waitcnt lgkmcnt(6)
 v_mfma_f32_16x16x32_bf16 v[252:255], v[88:91], a[204:207], v[252:255]
 ds_read_b64_tr_b16 v[76:77], v53 offset:57344
 buffer_load_dwordx4 a[172:175], v51, s[16:19], s78 offen offset:2048 sc1
 v_mfma_f32_16x16x32_bf16 v[252:255], v[92:95], a[220:223], v[252:255]
 ds_read_b64_tr_b16 v[78:79], v53 offset:61440
 v_mfma_f32_16x16x32_bf16 v[248:251], v[92:95], a[216:219], v[248:251]
 v_xor_b32 v53, s49, v53
 v_mfma_f32_16x16x32_bf16 v[248:251], v[88:91], a[200:203], v[248:251]
 v_mfma_f32_16x16x32_bf16 v[244:247], v[88:91], a[196:199], v[244:247]
 ds_read_b64_tr_b16 v[80:81], v54 offset:49152
 v_mfma_f32_16x16x32_bf16 v[244:247], v[92:95], a[212:215], v[244:247]
 ds_read_b64_tr_b16 v[82:83], v54 offset:53248
 v_mfma_f32_16x16x32_bf16 v[240:243], v[92:95], a[208:211], v[240:243]
 v_mfma_f32_16x16x32_bf16 v[240:243], v[88:91], a[192:195], v[240:243]
 s_waitcnt lgkmcnt(6)
 s_waitcnt vmcnt(30)
 v_mfma_f32_16x16x32_bf16 v[128:131], v[64:67], a[224:227], v[128:131]
 ds_read_b64_tr_b16 v[84:85], v54 offset:57344
 buffer_load_dwordx4 a[176:179], v48, s[16:19], s78 offen offset:3072 sc1
 s_waitcnt vmcnt(25)
 v_mfma_f32_16x16x32_bf16 v[128:131], v[68:71], a[240:243], v[128:131]
 ds_read_b64_tr_b16 v[86:87], v54 offset:61440
 s_waitcnt vmcnt(23)
 v_mfma_f32_16x16x32_bf16 v[132:135], v[68:71], a[244:247], v[132:135]
 v_xor_b32 v54, s49, v54
 v_mfma_f32_16x16x32_bf16 v[132:135], v[64:67], a[228:231], v[132:135]
 v_mfma_f32_16x16x32_bf16 v[136:139], v[64:67], a[232:235], v[136:139]
 ds_read_b64_tr_b16 v[88:89], v55 offset:49152
 s_add_u32 m0, s79, 102400
 s_waitcnt vmcnt(22)
 v_mfma_f32_16x16x32_bf16 v[136:139], v[68:71], a[248:251], v[136:139]
 ds_read_b64_tr_b16 v[90:91], v55 offset:53248
 s_waitcnt vmcnt(20)
 v_mfma_f32_16x16x32_bf16 v[140:143], v[68:71], a[252:255], v[140:143]
 buffer_load_dwordx4 v44, s[8:11], s75 offen  lds
 v_mfma_f32_16x16x32_bf16 v[140:143], v[64:67], a[236:239], v[140:143]
 s_waitcnt lgkmcnt(6)
 v_mfma_f32_16x16x32_bf16 v[156:159], v[72:75], a[236:239], v[156:159]
 ds_read_b64_tr_b16 v[92:93], v55 offset:57344
 buffer_load_dwordx4 a[180:183], v49, s[16:19], s78 offen offset:3072 sc1
 v_mfma_f32_16x16x32_bf16 v[156:159], v[76:79], a[252:255], v[156:159]
 ds_read_b64_tr_b16 v[94:95], v55 offset:61440
 v_mfma_f32_16x16x32_bf16 v[152:155], v[76:79], a[248:251], v[152:155]
 v_xor_b32 v55, s49, v55
 v_mfma_f32_16x16x32_bf16 v[152:155], v[72:75], a[232:235], v[152:155]
 v_mfma_f32_16x16x32_bf16 v[148:151], v[72:75], a[228:231], v[148:151]
 ds_read_b64_tr_b16 v[64:65], v56 offset:49152
 v_mfma_f32_16x16x32_bf16 v[148:151], v[76:79], a[244:247], v[148:151]
 ds_read_b64_tr_b16 v[66:67], v56 offset:53248
 v_mfma_f32_16x16x32_bf16 v[144:147], v[76:79], a[240:243], v[144:147]
 v_mfma_f32_16x16x32_bf16 v[144:147], v[72:75], a[224:227], v[144:147]
 s_waitcnt lgkmcnt(6)
 v_mfma_f32_16x16x32_bf16 v[160:163], v[80:83], a[224:227], v[160:163]
 ds_read_b64_tr_b16 v[68:69], v56 offset:57344
 buffer_load_dwordx4 a[184:187], v50, s[16:19], s78 offen offset:3072 sc1
 v_mfma_f32_16x16x32_bf16 v[160:163], v[84:87], a[240:243], v[160:163]
 ds_read_b64_tr_b16 v[70:71], v56 offset:61440
 v_mfma_f32_16x16x32_bf16 v[164:167], v[84:87], a[244:247], v[164:167]
 v_xor_b32 v56, s49, v56
 v_mfma_f32_16x16x32_bf16 v[164:167], v[80:83], a[228:231], v[164:167]
 v_mfma_f32_16x16x32_bf16 v[168:171], v[80:83], a[232:235], v[168:171]
 ds_read_b64_tr_b16 v[72:73], v57 offset:49152
 buffer_load_dwordx4 v45, s[8:11], s75 offen offset:1024  lds
 v_mfma_f32_16x16x32_bf16 v[168:171], v[84:87], a[248:251], v[168:171]
 ds_read_b64_tr_b16 v[74:75], v57 offset:53248
 v_mfma_f32_16x16x32_bf16 v[172:175], v[84:87], a[252:255], v[172:175]
 v_mfma_f32_16x16x32_bf16 v[172:175], v[80:83], a[236:239], v[172:175]
 s_waitcnt lgkmcnt(6)
 v_mfma_f32_16x16x32_bf16 v[188:191], v[88:91], a[236:239], v[188:191]
 ds_read_b64_tr_b16 v[76:77], v57 offset:57344
 buffer_load_dwordx4 a[188:191], v51, s[16:19], s78 offen offset:3072 sc1
 v_mfma_f32_16x16x32_bf16 v[188:191], v[92:95], a[252:255], v[188:191]
 ds_read_b64_tr_b16 v[78:79], v57 offset:61440
 s_add_u32 s78, s78, 4096
 v_mfma_f32_16x16x32_bf16 v[184:187], v[92:95], a[248:251], v[184:187]
 v_xor_b32 v57, s49, v57
 v_mfma_f32_16x16x32_bf16 v[184:187], v[88:91], a[232:235], v[184:187]
 v_mfma_f32_16x16x32_bf16 v[180:183], v[88:91], a[228:231], v[180:183]
 ds_read_b64_tr_b16 v[80:81], v58 offset:49152
 v_mfma_f32_16x16x32_bf16 v[180:183], v[92:95], a[244:247], v[180:183]
 ds_read_b64_tr_b16 v[82:83], v58 offset:53248
 v_mfma_f32_16x16x32_bf16 v[176:179], v[92:95], a[240:243], v[176:179]
 v_mfma_f32_16x16x32_bf16 v[176:179], v[88:91], a[224:227], v[176:179]
 s_waitcnt lgkmcnt(6)
 v_mfma_f32_16x16x32_bf16 v[192:195], v[64:67], a[224:227], v[192:195]
 ds_read_b64_tr_b16 v[84:85], v58 offset:57344
 v_mfma_f32_16x16x32_bf16 v[192:195], v[68:71], a[240:243], v[192:195]
 ds_read_b64_tr_b16 v[86:87], v58 offset:61440
 v_mfma_f32_16x16x32_bf16 v[196:199], v[68:71], a[244:247], v[196:199]
 v_xor_b32 v58, s49, v58
 v_mfma_f32_16x16x32_bf16 v[196:199], v[64:67], a[228:231], v[196:199]
 v_mfma_f32_16x16x32_bf16 v[200:203], v[64:67], a[232:235], v[200:203]
 ds_read_b64_tr_b16 v[88:89], v59 offset:49152
 buffer_load_dwordx4 v46, s[8:11], s75 offen offset:2048  lds
 v_mfma_f32_16x16x32_bf16 v[200:203], v[68:71], a[248:251], v[200:203]
 ds_read_b64_tr_b16 v[90:91], v59 offset:53248
 v_mfma_f32_16x16x32_bf16 v[204:207], v[68:71], a[252:255], v[204:207]
 v_mfma_f32_16x16x32_bf16 v[204:207], v[64:67], a[236:239], v[204:207]
 s_waitcnt lgkmcnt(6)
 v_mfma_f32_16x16x32_bf16 v[220:223], v[72:75], a[236:239], v[220:223]
 ds_read_b64_tr_b16 v[92:93], v59 offset:57344
 v_mfma_f32_16x16x32_bf16 v[220:223], v[76:79], a[252:255], v[220:223]
 ds_read_b64_tr_b16 v[94:95], v59 offset:61440
 v_mfma_f32_16x16x32_bf16 v[216:219], v[76:79], a[248:251], v[216:219]
 v_xor_b32 v59, s49, v59
 v_mfma_f32_16x16x32_bf16 v[216:219], v[72:75], a[232:235], v[216:219]
 s_waitcnt vmcnt(21)
 s_barrier
 v_mfma_f32_16x16x32_bf16 v[212:215], v[72:75], a[228:231], v[212:215]
 ds_read_b64_tr_b16 v[64:65], v52
 v_mfma_f32_16x16x32_bf16 v[212:215], v[76:79], a[244:247], v[212:215]
 ds_read_b64_tr_b16 v[66:67], v52 offset:4096
 v_mfma_f32_16x16x32_bf16 v[208:211], v[76:79], a[240:243], v[208:211]
 v_mfma_f32_16x16x32_bf16 v[208:211], v[72:75], a[224:227], v[208:211]
 s_waitcnt lgkmcnt(6)
 v_mfma_f32_16x16x32_bf16 v[224:227], v[80:83], a[224:227], v[224:227]
 ds_read_b64_tr_b16 v[68:69], v52 offset:8192
 v_mfma_f32_16x16x32_bf16 v[224:227], v[84:87], a[240:243], v[224:227]
 ds_read_b64_tr_b16 v[70:71], v52 offset:12288
 v_mfma_f32_16x16x32_bf16 v[228:231], v[84:87], a[244:247], v[228:231]
 v_mfma_f32_16x16x32_bf16 v[228:231], v[80:83], a[228:231], v[228:231]
 v_mfma_f32_16x16x32_bf16 v[232:235], v[80:83], a[232:235], v[232:235]
 ds_read_b64_tr_b16 v[72:73], v53
 buffer_load_dwordx4 v47, s[8:11], s75 offen offset:3072  lds
 v_mfma_f32_16x16x32_bf16 v[232:235], v[84:87], a[248:251], v[232:235]
 ds_read_b64_tr_b16 v[74:75], v53 offset:4096
 s_add_u32 s75, s75, 262144
 v_mfma_f32_16x16x32_bf16 v[236:239], v[84:87], a[252:255], v[236:239]
 v_mfma_f32_16x16x32_bf16 v[236:239], v[80:83], a[236:239], v[236:239]
 s_waitcnt lgkmcnt(6)
 v_mfma_f32_16x16x32_bf16 v[252:255], v[88:91], a[236:239], v[252:255]
 ds_read_b64_tr_b16 v[76:77], v53 offset:8192
 v_mfma_f32_16x16x32_bf16 v[252:255], v[92:95], a[252:255], v[252:255]
 ds_read_b64_tr_b16 v[78:79], v53 offset:12288
 v_mfma_f32_16x16x32_bf16 v[248:251], v[92:95], a[248:251], v[248:251]
 v_mfma_f32_16x16x32_bf16 v[248:251], v[88:91], a[232:235], v[248:251]
 v_mfma_f32_16x16x32_bf16 v[244:247], v[88:91], a[228:231], v[244:247]
 ds_read_b64_tr_b16 v[80:81], v54
 v_mfma_f32_16x16x32_bf16 v[244:247], v[92:95], a[244:247], v[244:247]
 ds_read_b64_tr_b16 v[82:83], v54 offset:4096
 v_mfma_f32_16x16x32_bf16 v[240:243], v[92:95], a[240:243], v[240:243]
 v_mfma_f32_16x16x32_bf16 v[240:243], v[88:91], a[224:227], v[240:243]
 s_waitcnt lgkmcnt(6)
 v_mfma_f32_16x16x32_bf16 v[128:131], v[64:67], a[128:131], v[128:131]
 ds_read_b64_tr_b16 v[84:85], v54 offset:8192
 s_waitcnt vmcnt(20)
 v_mfma_f32_16x16x32_bf16 v[128:131], v[68:71], a[144:147], v[128:131]
 ds_read_b64_tr_b16 v[86:87], v54 offset:12288
 s_waitcnt vmcnt(18)
 v_mfma_f32_16x16x32_bf16 v[132:135], v[68:71], a[148:151], v[132:135]
 v_mfma_f32_16x16x32_bf16 v[132:135], v[64:67], a[132:135], v[132:135]
 v_mfma_f32_16x16x32_bf16 v[136:139], v[64:67], a[136:139], v[136:139]
 ds_read_b64_tr_b16 v[88:89], v55
 s_add_u32 m0, s79, 0
 s_waitcnt vmcnt(17)
 v_mfma_f32_16x16x32_bf16 v[136:139], v[68:71], a[152:155], v[136:139]
 ds_read_b64_tr_b16 v[90:91], v55 offset:4096
 s_waitcnt vmcnt(15)
 v_mfma_f32_16x16x32_bf16 v[140:143], v[68:71], a[156:159], v[140:143]
 buffer_load_dwordx4 v40, s[8:11], s75 offen  lds
 v_mfma_f32_16x16x32_bf16 v[140:143], v[64:67], a[140:143], v[140:143]
 s_waitcnt lgkmcnt(6)
 v_mfma_f32_16x16x32_bf16 v[156:159], v[72:75], a[140:143], v[156:159]
 ds_read_b64_tr_b16 v[92:93], v55 offset:8192
 v_mfma_f32_16x16x32_bf16 v[156:159], v[76:79], a[156:159], v[156:159]
 ds_read_b64_tr_b16 v[94:95], v55 offset:12288
 v_mfma_f32_16x16x32_bf16 v[152:155], v[76:79], a[152:155], v[152:155]
 v_mfma_f32_16x16x32_bf16 v[152:155], v[72:75], a[136:139], v[152:155]
 v_mfma_f32_16x16x32_bf16 v[148:151], v[72:75], a[132:135], v[148:151]
 ds_read_b64_tr_b16 v[64:65], v56
 v_mfma_f32_16x16x32_bf16 v[148:151], v[76:79], a[148:151], v[148:151]
 ds_read_b64_tr_b16 v[66:67], v56 offset:4096
 v_mfma_f32_16x16x32_bf16 v[144:147], v[76:79], a[144:147], v[144:147]
 v_mfma_f32_16x16x32_bf16 v[144:147], v[72:75], a[128:131], v[144:147]
 s_waitcnt lgkmcnt(6)
 v_mfma_f32_16x16x32_bf16 v[160:163], v[80:83], a[128:131], v[160:163]
 ds_read_b64_tr_b16 v[68:69], v56 offset:8192
 v_mfma_f32_16x16x32_bf16 v[160:163], v[84:87], a[144:147], v[160:163]
 ds_read_b64_tr_b16 v[70:71], v56 offset:12288
 v_mfma_f32_16x16x32_bf16 v[164:167], v[84:87], a[148:151], v[164:167]
 v_mfma_f32_16x16x32_bf16 v[164:167], v[80:83], a[132:135], v[164:167]
 v_mfma_f32_16x16x32_bf16 v[168:171], v[80:83], a[136:139], v[168:171]
 ds_read_b64_tr_b16 v[72:73], v57
 buffer_load_dwordx4 v41, s[8:11], s75 offen offset:1024  lds
 v_mfma_f32_16x16x32_bf16 v[168:171], v[84:87], a[152:155], v[168:171]
 ds_read_b64_tr_b16 v[74:75], v57 offset:4096
 v_mfma_f32_16x16x32_bf16 v[172:175], v[84:87], a[156:159], v[172:175]
 v_mfma_f32_16x16x32_bf16 v[172:175], v[80:83], a[140:143], v[172:175]
 s_waitcnt lgkmcnt(6)
 v_mfma_f32_16x16x32_bf16 v[188:191], v[88:91], a[140:143], v[188:191]
 ds_read_b64_tr_b16 v[76:77], v57 offset:8192
 v_mfma_f32_16x16x32_bf16 v[188:191], v[92:95], a[156:159], v[188:191]
 ds_read_b64_tr_b16 v[78:79], v57 offset:12288
 v_mfma_f32_16x16x32_bf16 v[184:187], v[92:95], a[152:155], v[184:187]
 v_mfma_f32_16x16x32_bf16 v[184:187], v[88:91], a[136:139], v[184:187]
 v_mfma_f32_16x16x32_bf16 v[180:183], v[88:91], a[132:135], v[180:183]
 ds_read_b64_tr_b16 v[80:81], v58
 v_mfma_f32_16x16x32_bf16 v[180:183], v[92:95], a[148:151], v[180:183]
 ds_read_b64_tr_b16 v[82:83], v58 offset:4096
 v_mfma_f32_16x16x32_bf16 v[176:179], v[92:95], a[144:147], v[176:179]
 s_waitcnt vmcnt(15)
 v_cmp_ne_u64 vcc, s[6:7], v[62:63]
 s_nop 0
 s_nop 0
 s_cbranch_vccz L_o_79_ok
L_o_79_spin:
 s_sleep 4
 buffer_load_dwordx2 v[62:63], v60, s[56:59], 0 offen sc1
 s_waitcnt vmcnt(0)
 v_cmp_ne_u64 vcc, s[6:7], v[62:63]
 s_nop 1
 s_cbranch_vccnz L_o_79_spin
L_o_79_ok:
 v_mfma_f32_16x16x32_bf16 v[176:179], v[88:91], a[128:131], v[176:179]
 s_waitcnt lgkmcnt(6)
 v_mfma_f32_16x16x32_bf16 v[192:195], v[64:67], a[128:131], v[192:195]
 ds_read_b64_tr_b16 v[84:85], v58 offset:8192
 buffer_load_dwordx4 a[192:195], v4, s[20:23], s42 offen sc1
 v_mfma_f32_16x16x32_bf16 v[192:195], v[68:71], a[144:147], v[192:195]
 ds_read_b64_tr_b16 v[86:87], v58 offset:12288
 v_mfma_f32_16x16x32_bf16 v[196:199], v[68:71], a[148:151], v[196:199]
 v_mfma_f32_16x16x32_bf16 v[196:199], v[64:67], a[132:135], v[196:199]
 v_mfma_f32_16x16x32_bf16 v[200:203], v[64:67], a[136:139], v[200:203]
 ds_read_b64_tr_b16 v[88:89], v59
 buffer_load_dwordx4 v42, s[8:11], s75 offen offset:2048  lds
 v_mfma_f32_16x16x32_bf16 v[200:203], v[68:71], a[152:155], v[200:203]
 ds_read_b64_tr_b16 v[90:91], v59 offset:4096
 buffer_load_dwordx4 a[196:199], v5, s[20:23], s42 offen sc1
 v_mfma_f32_16x16x32_bf16 v[204:207], v[68:71], a[156:159], v[204:207]
 v_mfma_f32_16x16x32_bf16 v[204:207], v[64:67], a[140:143], v[204:207]
 s_waitcnt lgkmcnt(6)
 v_mfma_f32_16x16x32_bf16 v[220:223], v[72:75], a[140:143], v[220:223]
 ds_read_b64_tr_b16 v[92:93], v59 offset:8192
 v_mfma_f32_16x16x32_bf16 v[220:223], v[76:79], a[156:159], v[220:223]
 ds_read_b64_tr_b16 v[94:95], v59 offset:12288
 v_mfma_f32_16x16x32_bf16 v[216:219], v[76:79], a[152:155], v[216:219]
 buffer_load_dwordx4 a[200:203], v6, s[20:23], s42 offen sc1
 v_mfma_f32_16x16x32_bf16 v[216:219], v[72:75], a[136:139], v[216:219]
 v_mfma_f32_16x16x32_bf16 v[212:215], v[72:75], a[132:135], v[212:215]
 ds_read_b64_tr_b16 v[64:65], v52 offset:16384
 v_mfma_f32_16x16x32_bf16 v[212:215], v[76:79], a[148:151], v[212:215]
 ds_read_b64_tr_b16 v[66:67], v52 offset:20480
 v_mfma_f32_16x16x32_bf16 v[208:211], v[76:79], a[144:147], v[208:211]
 v_mfma_f32_16x16x32_bf16 v[208:211], v[72:75], a[128:131], v[208:211]
 s_waitcnt lgkmcnt(6)
 buffer_load_dwordx4 a[204:207], v7, s[20:23], s42 offen sc1
 v_mfma_f32_16x16x32_bf16 v[224:227], v[80:83], a[128:131], v[224:227]
 ds_read_b64_tr_b16 v[68:69], v52 offset:24576
 v_mfma_f32_16x16x32_bf16 v[224:227], v[84:87], a[144:147], v[224:227]
 ds_read_b64_tr_b16 v[70:71], v52 offset:28672
 v_mfma_f32_16x16x32_bf16 v[228:231], v[84:87], a[148:151], v[228:231]
 v_mfma_f32_16x16x32_bf16 v[228:231], v[80:83], a[132:135], v[228:231]
 v_mfma_f32_16x16x32_bf16 v[232:235], v[80:83], a[136:139], v[232:235]
 ds_read_b64_tr_b16 v[72:73], v53 offset:16384
 buffer_load_dwordx4 v43, s[8:11], s75 offen offset:3072  lds
 v_mfma_f32_16x16x32_bf16 v[232:235], v[84:87], a[152:155], v[232:235]
 ds_read_b64_tr_b16 v[74:75], v53 offset:20480
 buffer_load_dwordx4 a[208:211], v4, s[20:23], s42 offen offset:1024 sc1
 v_mfma_f32_16x16x32_bf16 v[236:239], v[84:87], a[156:159], v[236:239]
 v_mfma_f32_16x16x32_bf16 v[236:239], v[80:83], a[140:143], v[236:239]
 s_waitcnt lgkmcnt(6)
 v_mfma_f32_16x16x32_bf16 v[252:255], v[88:91], a[140:143], v[252:255]
 ds_read_b64_tr_b16 v[76:77], v53 offset:24576
 v_mfma_f32_16x16x32_bf16 v[252:255], v[92:95], a[156:159], v[252:255]
 ds_read_b64_tr_b16 v[78:79], v53 offset:28672
 buffer_load_dwordx4 a[212:215], v5, s[20:23], s42 offen offset:1024 sc1
 v_mfma_f32_16x16x32_bf16 v[248:251], v[92:95], a[152:155], v[248:251]
 v_mfma_f32_16x16x32_bf16 v[248:251], v[88:91], a[136:139], v[248:251]
 v_mfma_f32_16x16x32_bf16 v[244:247], v[88:91], a[132:135], v[244:247]
 ds_read_b64_tr_b16 v[80:81], v54 offset:16384
 v_mfma_f32_16x16x32_bf16 v[244:247], v[92:95], a[148:151], v[244:247]
 ds_read_b64_tr_b16 v[82:83], v54 offset:20480
 v_mfma_f32_16x16x32_bf16 v[240:243], v[92:95], a[144:147], v[240:243]
 buffer_load_dwordx4 a[216:219], v6, s[20:23], s42 offen offset:1024 sc1
 v_mfma_f32_16x16x32_bf16 v[240:243], v[88:91], a[128:131], v[240:243]
 s_waitcnt lgkmcnt(6)
 v_mfma_f32_16x16x32_bf16 v[128:131], v[64:67], a[160:163], v[128:131]
 ds_read_b64_tr_b16 v[84:85], v54 offset:24576
 s_waitcnt vmcnt(18)
 v_mfma_f32_16x16x32_bf16 v[128:131], v[68:71], a[176:179], v[128:131]
 ds_read_b64_tr_b16 v[86:87], v54 offset:28672
 s_waitcnt vmcnt(16)
 v_mfma_f32_16x16x32_bf16 v[132:135], v[68:71], a[180:183], v[132:135]
 v_mfma_f32_16x16x32_bf16 v[132:135], v[64:67], a[164:167], v[132:135]
 buffer_load_dwordx4 a[220:223], v7, s[20:23], s42 offen offset:1024 sc1
 v_mfma_f32_16x16x32_bf16 v[136:139], v[64:67], a[168:171], v[136:139]
 ds_read_b64_tr_b16 v[88:89], v55 offset:16384
 s_add_u32 m0, s79, 4096
 s_waitcnt vmcnt(16)
 v_mfma_f32_16x16x32_bf16 v[136:139], v[68:71], a[184:187], v[136:139]
 ds_read_b64_tr_b16 v[90:91], v55 offset:20480
 s_waitcnt vmcnt(14)
 v_mfma_f32_16x16x32_bf16 v[140:143], v[68:71], a[188:191], v[140:143]
 buffer_load_dwordx4 v44, s[8:11], s75 offen  lds
 v_mfma_f32_16x16x32_bf16 v[140:143], v[64:67], a[172:175], v[140:143]
 s_waitcnt lgkmcnt(6)
 v_mfma_f32_16x16x32_bf16 v[156:159], v[72:75], a[172:175], v[156:159]
 ds_read_b64_tr_b16 v[92:93], v55 offset:24576
 buffer_load_dwordx4 a[224:227], v4, s[20:23], s42 offen offset:2048 sc1
 v_mfma_f32_16x16x32_bf16 v[156:159], v[76:79], a[188:191], v[156:159]
 ds_read_b64_tr_b16 v[94:95], v55 offset:28672
 v_mfma_f32_16x16x32_bf16 v[152:155], v[76:79], a[184:187], v[152:155]
 v_mfma_f32_16x16x32_bf16 v[152:155], v[72:75], a[168:171], v[152:155]
 v_mfma_f32_16x16x32_bf16 v[148:151], v[72:75], a[164:167], v[148:151]
 ds_read_b64_tr_b16 v[64:65], v56 offset:16384
 v_mfma_f32_16x16x32_bf16 v[148:151], v[76:79], a[180:183], v[148:151]
 ds_read_b64_tr_b16 v[66:67], v56 offset:20480
 buffer_load_dwordx4 a[228:231], v5, s[20:23], s42 offen offset:2048 sc1
 v_mfma_f32_16x16x32_bf16 v[144:147], v[76:79], a[176:179], v[144:147]
 v_mfma_f32_16x16x32_bf16 v[144:147], v[72:75], a[160:163], v[144:147]
 s_waitcnt lgkmcnt(6)
 v_mfma_f32_16x16x32_bf16 v[160:163], v[80:83], a[160:163], v[160:163]
 ds_read_b64_tr_b16 v[68:69], v56 offset:24576
 v_mfma_f32_16x16x32_bf16 v[160:163], v[84:87], a[176:179], v[160:163]
 ds_read_b64_tr_b16 v[70:71], v56 offset:28672
 v_mfma_f32_16x16x32_bf16 v[164:167], v[84:87], a[180:183], v[164:167]
 buffer_load_dwordx4 a[232:235], v6, s[20:23], s42 offen offset:2048 sc1
 v_mfma_f32_16x16x32_bf16 v[164:167], v[80:83], a[164:167], v[164:167]
 v_mfma_f32_16x16x32_bf16 v[168:171], v[80:83], a[168:171], v[168:171]
 ds_read_b64_tr_b16 v[72:73], v57 offset:16384
 buffer_load_dwordx4 v45, s[8:11], s75 offen offset:1024  lds
 v_mfma_f32_16x16x32_bf16 v[168:171], v[84:87], a[184:187], v[168:171]
 ds_read_b64_tr_b16 v[74:75], v57 offset:20480
 v_mfma_f32_16x16x32_bf16 v[172:175], v[84:87], a[188:191], v[172:175]
 v_mfma_f32_16x16x32_bf16 v[172:175], v[80:83], a[172:175], v[172:175]
 s_waitcnt lgkmcnt(6)
 buffer_load_dwordx4 a[236:239], v7, s[20:23], s42 offen offset:2048 sc1
 v_mfma_f32_16x16x32_bf16 v[188:191], v[88:91], a[172:175], v[188:191]
 ds_read_b64_tr_b16 v[76:77], v57 offset:24576
 v_mfma_f32_16x16x32_bf16 v[188:191], v[92:95], a[188:191], v[188:191]
 ds_read_b64_tr_b16 v[78:79], v57 offset:28672
 v_mfma_f32_16x16x32_bf16 v[184:187], v[92:95], a[184:187], v[184:187]
 v_mfma_f32_16x16x32_bf16 v[184:187], v[88:91], a[168:171], v[184:187]
 v_mfma_f32_16x16x32_bf16 v[180:183], v[88:91], a[164:167], v[180:183]
 ds_read_b64_tr_b16 v[80:81], v58 offset:16384
 buffer_load_dwordx4 a[240:243], v4, s[20:23], s42 offen offset:3072 sc1
 v_mfma_f32_16x16x32_bf16 v[180:183], v[92:95], a[180:183], v[180:183]
 ds_read_b64_tr_b16 v[82:83], v58 offset:20480
 v_mfma_f32_16x16x32_bf16 v[176:179], v[92:95], a[176:179], v[176:179]
 v_mfma_f32_16x16x32_bf16 v[176:179], v[88:91], a[160:163], v[176:179]
 s_waitcnt lgkmcnt(6)
 v_mfma_f32_16x16x32_bf16 v[192:195], v[64:67], a[160:163], v[192:195]
 ds_read_b64_tr_b16 v[84:85], v58 offset:24576
 v_mfma_f32_16x16x32_bf16 v[192:195], v[68:71], a[176:179], v[192:195]
 ds_read_b64_tr_b16 v[86:87], v58 offset:28672
 buffer_load_dwordx4 a[244:247], v5, s[20:23], s42 offen offset:3072 sc1
 v_mfma_f32_16x16x32_bf16 v[196:199], v[68:71], a[180:183], v[196:199]
 v_mfma_f32_16x16x32_bf16 v[196:199], v[64:67], a[164:167], v[196:199]
 v_mfma_f32_16x16x32_bf16 v[200:203], v[64:67], a[168:171], v[200:203]
 ds_read_b64_tr_b16 v[88:89], v59 offset:16384
 buffer_load_dwordx4 v46, s[8:11], s75 offen offset:2048  lds
 v_mfma_f32_16x16x32_bf16 v[200:203], v[68:71], a[184:187], v[200:203]
 ds_read_b64_tr_b16 v[90:91], v59 offset:20480
 v_mfma_f32_16x16x32_bf16 v[204:207], v[68:71], a[188:191], v[204:207]
 buffer_load_dwordx4 a[248:251], v6, s[20:23], s42 offen offset:3072 sc1
 v_mfma_f32_16x16x32_bf16 v[204:207], v[64:67], a[172:175], v[204:207]
 s_waitcnt lgkmcnt(6)
 v_mfma_f32_16x16x32_bf16 v[220:223], v[72:75], a[172:175], v[220:223]
 ds_read_b64_tr_b16 v[92:93], v59 offset:24576
 v_mfma_f32_16x16x32_bf16 v[220:223], v[76:79], a[188:191], v[220:223]
 ds_read_b64_tr_b16 v[94:95], v59 offset:28672
 v_mfma_f32_16x16x32_bf16 v[216:219], v[76:79], a[184:187], v[216:219]
 v_mfma_f32_16x16x32_bf16 v[216:219], v[72:75], a[168:171], v[216:219]
 s_waitcnt vmcnt(22)
 s_barrier
 v_mfma_f32_16x16x32_bf16 v[212:215], v[72:75], a[164:167], v[212:215]
 ds_read_b64_tr_b16 v[64:65], v52 offset:32768
 buffer_load_dwordx4 a[252:255], v7, s[20:23], s42 offen offset:3072 sc1
 v_mfma_f32_16x16x32_bf16 v[212:215], v[76:79], a[180:183], v[212:215]
 ds_read_b64_tr_b16 v[66:67], v52 offset:36864
 s_add_u32 s42, s42, 4096
 v_mfma_f32_16x16x32_bf16 v[208:211], v[76:79], a[176:179], v[208:211]
 v_mfma_f32_16x16x32_bf16 v[208:211], v[72:75], a[160:163], v[208:211]
 s_waitcnt lgkmcnt(6)
 v_mfma_f32_16x16x32_bf16 v[224:227], v[80:83], a[160:163], v[224:227]
 ds_read_b64_tr_b16 v[68:69], v52 offset:40960
 buffer_load_dwordx4 a[128:131], v4, s[20:23], s42 offen sc1
 v_mfma_f32_16x16x32_bf16 v[224:227], v[84:87], a[176:179], v[224:227]
 ds_read_b64_tr_b16 v[70:71], v52 offset:45056
 v_mfma_f32_16x16x32_bf16 v[228:231], v[84:87], a[180:183], v[228:231]
 v_mfma_f32_16x16x32_bf16 v[228:231], v[80:83], a[164:167], v[228:231]
 v_mfma_f32_16x16x32_bf16 v[232:235], v[80:83], a[168:171], v[232:235]
 ds_read_b64_tr_b16 v[72:73], v53 offset:32768
 buffer_load_dwordx4 v47, s[8:11], s75 offen offset:3072  lds
 v_mfma_f32_16x16x32_bf16 v[232:235], v[84:87], a[184:187], v[232:235]
 ds_read_b64_tr_b16 v[74:75], v53 offset:36864
 s_add_u32 s75, s75, 262144
 v_mfma_f32_16x16x32_bf16 v[236:239], v[84:87], a[188:191], v[236:239]
 buffer_load_dwordx4 a[132:135], v5, s[20:23], s42 offen sc1
 v_mfma_f32_16x16x32_bf16 v[236:239], v[80:83], a[172:175], v[236:239]
 s_waitcnt lgkmcnt(6)
 v_mfma_f32_16x16x32_bf16 v[252:255], v[88:91], a[172:175], v[252:255]
 ds_read_b64_tr_b16 v[76:77], v53 offset:40960
 v_mfma_f32_16x16x32_bf16 v[252:255], v[92:95], a[188:191], v[252:255]
 ds_read_b64_tr_b16 v[78:79], v53 offset:45056
 v_mfma_f32_16x16x32_bf16 v[248:251], v[92:95], a[184:187], v[248:251]
 buffer_load_dwordx4 a[136:139], v6, s[20:23], s42 offen sc1
 v_mfma_f32_16x16x32_bf16 v[248:251], v[88:91], a[168:171], v[248:251]
 v_mfma_f32_16x16x32_bf16 v[244:247], v[88:91], a[164:167], v[244:247]
 ds_read_b64_tr_b16 v[80:81], v54 offset:32768
 v_mfma_f32_16x16x32_bf16 v[244:247], v[92:95], a[180:183], v[244:247]
 ds_read_b64_tr_b16 v[82:83], v54 offset:36864
 v_mfma_f32_16x16x32_bf16 v[240:243], v[92:95], a[176:179], v[240:243]
 v_mfma_f32_16x16x32_bf16 v[240:243], v[88:91], a[160:163], v[240:243]
 s_waitcnt lgkmcnt(6)
 buffer_load_dwordx4 a[140:143], v7, s[20:23], s42 offen sc1
 s_waitcnt vmcnt(25)
 v_mfma_f32_16x16x32_bf16 a[0:3], v[64:67], a[192:195], 0
 ds_read_b64_tr_b16 v[84:85], v54 offset:40960
 s_getpc_b64 s[16:17]
L_pc3_79:
 s_sub_u32 s16, s16, L_pc3_79-K_first
 s_subb_u32 s17, s17, 0
 s_waitcnt vmcnt(19)
 v_mfma_f32_16x16x32_bf16 a[0:3], v[68:71], a[208:211], a[0:3]
 ds_read_b64_tr_b16 v[86:87], v54 offset:45056
 s_mov_b32 s18, K_last-K_first
 s_waitcnt vmcnt(18)
 v_mfma_f32_16x16x32_bf16 a[4:7], v[68:71], a[212:215], 0
 s_mov_b32 s19, 0x20000
 v_mfma_f32_16x16x32_bf16 a[4:7], v[64:67], a[196:199], a[4:7]
 v_mfma_f32_16x16x32_bf16 a[8:11], v[64:67], a[200:203], 0
 ds_read_b64_tr_b16 v[88:89], v55 offset:32768
 s_add_u32 m0, s79, 32768
 s_waitcnt vmcnt(17)
 v_mfma_f32_16x16x32_bf16 a[8:11], v[68:71], a[216:219], a[8:11]
 ds_read_b64_tr_b16 v[90:91], v55 offset:36864
 s_waitcnt vmcnt(16)
 v_mfma_f32_16x16x32_bf16 a[12:15], v[68:71], a[220:223], 0
 buffer_load_dwordx4 v40, s[8:11], s75 offen  lds
 buffer_load_dwordx4 a[144:147], v4, s[20:23], s42 offen offset:1024 sc1
 v_mfma_f32_16x16x32_bf16 a[12:15], v[64:67], a[204:207], a[12:15]
 s_waitcnt lgkmcnt(6)
 v_mfma_f32_16x16x32_bf16 a[28:31], v[72:75], a[204:207], 0
 ds_read_b64_tr_b16 v[92:93], v55 offset:40960
 v_cvt_pk_bf16_f32 v112, v192, v193
 v_mfma_f32_16x16x32_bf16 a[28:31], v[76:79], a[220:223], a[28:31]
 ds_read_b64_tr_b16 v[94:95], v55 offset:45056
 v_cvt_pk_bf16_f32 v113, v194, v195
 v_mfma_f32_16x16x32_bf16 a[24:27], v[76:79], a[216:219], 0
 v_cvt_pk_bf16_f32 v114, v196, v197
 v_mfma_f32_16x16x32_bf16 a[24:27], v[72:75], a[200:203], a[24:27]
 buffer_load_dwordx4 a[148:151], v5, s[20:23], s42 offen offset:1024 sc1
 v_mfma_f32_16x16x32_bf16 a[20:23], v[72:75], a[196:199], 0
 ds_read_b64_tr_b16 v[64:65], v56 offset:32768
 v_cvt_pk_bf16_f32 v115, v198, v199
 v_mfma_f32_16x16x32_bf16 a[20:23], v[76:79], a[212:215], a[20:23]
 ds_read_b64_tr_b16 v[66:67], v56 offset:36864
 v_mfma_f32_16x16x32_bf16 a[16:19], v[76:79], a[208:211], 0
 v_mfma_f32_16x16x32_bf16 a[16:19], v[72:75], a[192:195], a[16:19]
 s_waitcnt lgkmcnt(6)
 v_mfma_f32_16x16x32_bf16 a[32:35], v[80:83], a[192:195], 0
 ds_read_b64_tr_b16 v[68:69], v56 offset:40960
 buffer_store_dwordx4 v[112:115], v26, s[60:63], 0 offen sc1
 v_mfma_f32_16x16x32_bf16 a[32:35], v[84:87], a[208:211], a[32:35]
 ds_read_b64_tr_b16 v[70:71], v56 offset:45056
 v_mfma_f32_16x16x32_bf16 a[36:39], v[84:87], a[212:215], 0
 buffer_load_dwordx4 a[152:155], v6, s[20:23], s42 offen offset:1024 sc1
 v_mfma_f32_16x16x32_bf16 a[36:39], v[80:83], a[196:199], a[36:39]
 v_mfma_f32_16x16x32_bf16 a[40:43], v[80:83], a[200:203], 0
 ds_read_b64_tr_b16 v[72:73], v57 offset:32768
 buffer_load_dwordx4 v41, s[8:11], s75 offen offset:1024  lds
 v_mfma_f32_16x16x32_bf16 a[40:43], v[84:87], a[216:219], a[40:43]
 ds_read_b64_tr_b16 v[74:75], v57 offset:36864
 v_cvt_pk_bf16_f32 v116, v200, v201
 v_mfma_f32_16x16x32_bf16 a[44:47], v[84:87], a[220:223], 0
 v_mfma_f32_16x16x32_bf16 a[44:47], v[80:83], a[204:207], a[44:47]
 s_waitcnt lgkmcnt(6)
 v_mfma_f32_16x16x32_bf16 a[60:63], v[88:91], a[204:207], 0
 ds_read_b64_tr_b16 v[76:77], v57 offset:40960
 v_mfma_f32_16x16x32_bf16 a[60:63], v[92:95], a[220:223], a[60:63]
 ds_read_b64_tr_b16 v[78:79], v57 offset:45056
 buffer_load_dwordx4 a[156:159], v7, s[20:23], s42 offen offset:1024 sc1
 v_mfma_f32_16x16x32_bf16 a[56:59], v[92:95], a[216:219], 0
 v_cvt_pk_bf16_f32 v117, v202, v203
 v_mfma_f32_16x16x32_bf16 a[56:59], v[88:91], a[200:203], a[56:59]
 v_mfma_f32_16x16x32_bf16 a[52:55], v[88:91], a[196:199], 0
 ds_read_b64_tr_b16 v[80:81], v58 offset:32768
 v_mfma_f32_16x16x32_bf16 a[52:55], v[92:95], a[212:215], a[52:55]
 ds_read_b64_tr_b16 v[82:83], v58 offset:36864
 v_mfma_f32_16x16x32_bf16 a[48:51], v[92:95], a[208:211], 0
 v_cvt_pk_bf16_f32 v118, v204, v205
 v_mfma_f32_16x16x32_bf16 a[48:51], v[88:91], a[192:195], a[48:51]
 s_waitcnt lgkmcnt(6)
 v_mfma_f32_16x16x32_bf16 a[64:67], v[64:67], a[192:195], 0
 ds_read_b64_tr_b16 v[84:85], v58 offset:40960
 buffer_load_dwordx4 a[160:163], v4, s[20:23], s42 offen offset:2048 sc1
 v_mfma_f32_16x16x32_bf16 a[64:67], v[68:71], a[208:211], a[64:67]
 ds_read_b64_tr_b16 v[86:87], v58 offset:45056
 v_mfma_f32_16x16x32_bf16 a[68:71], v[68:71], a[212:215], 0
 v_cvt_pk_bf16_f32 v119, v206, v207
 v_mfma_f32_16x16x32_bf16 a[68:71], v[64:67], a[196:199], a[68:71]
 v_mfma_f32_16x16x32_bf16 a[72:75], v[64:67], a[200:203], 0
 ds_read_b64_tr_b16 v[88:89], v59 offset:32768
 buffer_load_dwordx4 v42, s[8:11], s75 offen offset:2048  lds
 v_mfma_f32_16x16x32_bf16 a[72:75], v[68:71], a[216:219], a[72:75]
 ds_read_b64_tr_b16 v[90:91], v59 offset:36864
 v_mfma_f32_16x16x32_bf16 a[76:79], v[68:71], a[220:223], 0
 v_mfma_f32_16x16x32_bf16 a[76:79], v[64:67], a[204:207], a[76:79]
 s_waitcnt lgkmcnt(6)
 v_mfma_f32_16x16x32_bf16 a[92:95], v[72:75], a[204:207], 0
 ds_read_b64_tr_b16 v[92:93], v59 offset:40960
 buffer_load_dwordx4 a[164:167], v5, s[20:23], s42 offen offset:2048 sc1
 v_mfma_f32_16x16x32_bf16 a[92:95], v[76:79], a[220:223], a[92:95]
 ds_read_b64_tr_b16 v[94:95], v59 offset:45056
 buffer_store_dwordx4 v[116:119], v27, s[60:63], 0 offen sc1
 v_mfma_f32_16x16x32_bf16 a[88:91], v[76:79], a[216:219], 0
 v_mfma_f32_16x16x32_bf16 a[88:91], v[72:75], a[200:203], a[88:91]
 v_cvt_pk_bf16_f32 v120, v208, v209
 v_mfma_f32_16x16x32_bf16 a[84:87], v[72:75], a[196:199], 0
 ds_read_b64_tr_b16 v[64:65], v52 offset:49152
 v_mfma_f32_16x16x32_bf16 a[84:87], v[76:79], a[212:215], a[84:87]
 ds_read_b64_tr_b16 v[66:67], v52 offset:53248
 v_mfma_f32_16x16x32_bf16 a[80:83], v[76:79], a[208:211], 0
 v_mfma_f32_16x16x32_bf16 a[80:83], v[72:75], a[192:195], a[80:83]
 s_waitcnt lgkmcnt(6)
 v_mfma_f32_16x16x32_bf16 a[96:99], v[80:83], a[192:195], 0
 ds_read_b64_tr_b16 v[68:69], v52 offset:57344
 buffer_load_dwordx4 a[168:171], v6, s[20:23], s42 offen offset:2048 sc1
 v_mfma_f32_16x16x32_bf16 a[96:99], v[84:87], a[208:211], a[96:99]
 ds_read_b64_tr_b16 v[70:71], v52 offset:61440
 v_cvt_pk_bf16_f32 v121, v210, v211
 v_mfma_f32_16x16x32_bf16 a[100:103], v[84:87], a[212:215], 0
 v_xor_b32 v52, s49, v52
 v_mfma_f32_16x16x32_bf16 a[100:103], v[80:83], a[196:199], a[100:103]
 v_mfma_f32_16x16x32_bf16 a[104:107], v[80:83], a[200:203], 0
 ds_read_b64_tr_b16 v[72:73], v53 offset:49152
 buffer_load_dwordx4 v43, s[8:11], s75 offen offset:3072  lds
 v_mfma_f32_16x16x32_bf16 a[104:107], v[84:87], a[216:219], a[104:107]
 ds_read_b64_tr_b16 v[74:75], v53 offset:53248
 v_cvt_pk_bf16_f32 v122, v212, v213
 v_mfma_f32_16x16x32_bf16 a[108:111], v[84:87], a[220:223], 0
 v_mfma_f32_16x16x32_bf16 a[108:111], v[80:83], a[204:207], a[108:111]
 s_waitcnt lgkmcnt(6)
 v_mfma_f32_16x16x32_bf16 a[124:127], v[88:91], a[204:207], 0
 ds_read_b64_tr_b16 v[76:77], v53 offset:57344
 buffer_load_dwordx4 a[172:175], v7, s[20:23], s42 offen offset:2048 sc1
 v_mfma_f32_16x16x32_bf16 a[124:127], v[92:95], a[220:223], a[124:127]
 ds_read_b64_tr_b16 v[78:79], v53 offset:61440
 v_cvt_pk_bf16_f32 v123, v214, v215
 v_mfma_f32_16x16x32_bf16 a[120:123], v[92:95], a[216:219], 0
 v_xor_b32 v53, s49, v53
 v_mfma_f32_16x16x32_bf16 a[120:123], v[88:91], a[200:203], a[120:123]
 v_mfma_f32_16x16x32_bf16 a[116:119], v[88:91], a[196:199], 0
 ds_read_b64_tr_b16 v[80:81], v54 offset:49152
 v_mfma_f32_16x16x32_bf16 a[116:119], v[92:95], a[212:215], a[116:119]
 ds_read_b64_tr_b16 v[82:83], v54 offset:53248
 buffer_store_dwordx4 v[120:123], v26, s[60:63], 0 offen offset:1024 sc1
 v_mfma_f32_16x16x32_bf16 a[112:115], v[92:95], a[208:211], 0
 v_mfma_f32_16x16x32_bf16 a[112:115], v[88:91], a[192:195], a[112:115]
 s_waitcnt lgkmcnt(6)
 s_waitcnt vmcnt(29)
 v_mfma_f32_16x16x32_bf16 a[0:3], v[64:67], a[224:227], a[0:3]
 ds_read_b64_tr_b16 v[84:85], v54 offset:57344
 buffer_load_dwordx4 a[176:179], v4, s[20:23], s42 offen offset:3072 sc1
 s_waitcnt vmcnt(25)
 v_mfma_f32_16x16x32_bf16 a[0:3], v[68:71], a[240:243], a[0:3]
 ds_read_b64_tr_b16 v[86:87], v54 offset:61440
 s_waitcnt vmcnt(24)
 v_mfma_f32_16x16x32_bf16 a[4:7], v[68:71], a[244:247], a[4:7]
 v_xor_b32 v54, s49, v54
 v_cvt_pk_bf16_f32 v124, v216, v217
 v_mfma_f32_16x16x32_bf16 a[4:7], v[64:67], a[228:231], a[4:7]
 v_mfma_f32_16x16x32_bf16 a[8:11], v[64:67], a[232:235], a[8:11]
 ds_read_b64_tr_b16 v[88:89], v55 offset:49152
 s_add_u32 m0, s79, 36864
 s_waitcnt vmcnt(22)
 v_mfma_f32_16x16x32_bf16 a[8:11], v[68:71], a[248:251], a[8:11]
 ds_read_b64_tr_b16 v[90:91], v55 offset:53248
 s_waitcnt vmcnt(21)
 v_mfma_f32_16x16x32_bf16 a[12:15], v[68:71], a[252:255], a[12:15]
 buffer_load_dwordx4 v44, s[8:11], s75 offen  lds
 v_cvt_pk_bf16_f32 v125, v218, v219
 v_mfma_f32_16x16x32_bf16 a[12:15], v[64:67], a[236:239], a[12:15]
 s_waitcnt lgkmcnt(6)
 v_mfma_f32_16x16x32_bf16 a[28:31], v[72:75], a[236:239], a[28:31]
 ds_read_b64_tr_b16 v[92:93], v55 offset:57344
 buffer_load_dwordx4 a[180:183], v5, s[20:23], s42 offen offset:3072 sc1
 v_mfma_f32_16x16x32_bf16 a[28:31], v[76:79], a[252:255], a[28:31]
 ds_read_b64_tr_b16 v[94:95], v55 offset:61440
 v_mfma_f32_16x16x32_bf16 a[24:27], v[76:79], a[248:251], a[24:27]
 v_xor_b32 v55, s49, v55
 v_mfma_f32_16x16x32_bf16 a[24:27], v[72:75], a[232:235], a[24:27]
 v_cvt_pk_bf16_f32 v126, v220, v221
 v_mfma_f32_16x16x32_bf16 a[20:23], v[72:75], a[228:231], a[20:23]
 ds_read_b64_tr_b16 v[64:65], v56 offset:49152
 v_mfma_f32_16x16x32_bf16 a[20:23], v[76:79], a[244:247], a[20:23]
 ds_read_b64_tr_b16 v[66:67], v56 offset:53248
 v_mfma_f32_16x16x32_bf16 a[16:19], v[76:79], a[240:243], a[16:19]
 v_mfma_f32_16x16x32_bf16 a[16:19], v[72:75], a[224:227], a[16:19]
 s_waitcnt lgkmcnt(6)
 v_mfma_f32_16x16x32_bf16 a[32:35], v[80:83], a[224:227], a[32:35]
 ds_read_b64_tr_b16 v[68:69], v56 offset:57344
 buffer_load_dwordx4 a[184:187], v6, s[20:23], s42 offen offset:3072 sc1
 v_mfma_f32_16x16x32_bf16 a[32:35], v[84:87], a[240:243], a[32:35]
 ds_read_b64_tr_b16 v[70:71], v56 offset:61440
 v_cvt_pk_bf16_f32 v127, v222, v223
 v_mfma_f32_16x16x32_bf16 a[36:39], v[84:87], a[244:247], a[36:39]
 v_xor_b32 v56, s49, v56
 v_mfma_f32_16x16x32_bf16 a[36:39], v[80:83], a[228:231], a[36:39]
 v_mfma_f32_16x16x32_bf16 a[40:43], v[80:83], a[232:235], a[40:43]
 ds_read_b64_tr_b16 v[72:73], v57 offset:49152
 buffer_load_dwordx4 v45, s[8:11], s75 offen offset:1024  lds
 v_mfma_f32_16x16x32_bf16 a[40:43], v[84:87], a[248:251], a[40:43]
 ds_read_b64_tr_b16 v[74:75], v57 offset:53248
 buffer_store_dwordx4 v[124:127], v27, s[60:63], 0 offen offset:1024 sc1
 v_mfma_f32_16x16x32_bf16 a[44:47], v[84:87], a[252:255], a[44:47]
 v_mfma_f32_16x16x32_bf16 a[44:47], v[80:83], a[236:239], a[44:47]
 s_waitcnt lgkmcnt(6)
 v_mfma_f32_16x16x32_bf16 a[60:63], v[88:91], a[236:239], a[60:63]
 ds_read_b64_tr_b16 v[76:77], v57 offset:57344
 buffer_load_dwordx4 a[188:191], v7, s[20:23], s42 offen offset:3072 sc1
 v_mfma_f32_16x16x32_bf16 a[60:63], v[92:95], a[252:255], a[60:63]
 ds_read_b64_tr_b16 v[78:79], v57 offset:61440
 s_add_u32 s42, s42, 4096
 v_mfma_f32_16x16x32_bf16 a[56:59], v[92:95], a[248:251], a[56:59]
 v_xor_b32 v57, s49, v57
 v_cvt_pk_bf16_f32 v112, v224, v225
 v_mfma_f32_16x16x32_bf16 a[56:59], v[88:91], a[232:235], a[56:59]
 v_mfma_f32_16x16x32_bf16 a[52:55], v[88:91], a[228:231], a[52:55]
 ds_read_b64_tr_b16 v[80:81], v58 offset:49152
 v_mfma_f32_16x16x32_bf16 a[52:55], v[92:95], a[244:247], a[52:55]
 ds_read_b64_tr_b16 v[82:83], v58 offset:53248
 v_cvt_pk_bf16_f32 v113, v226, v227
 v_mfma_f32_16x16x32_bf16 a[48:51], v[92:95], a[240:243], a[48:51]
 v_mfma_f32_16x16x32_bf16 a[48:51], v[88:91], a[224:227], a[48:51]
 s_waitcnt lgkmcnt(6)
 v_mfma_f32_16x16x32_bf16 a[64:67], v[64:67], a[224:227], a[64:67]
 ds_read_b64_tr_b16 v[84:85], v58 offset:57344
 buffer_load_dwordx4 a[192:195], v4, s[20:23], s42 offen sc1
 v_mfma_f32_16x16x32_bf16 a[64:67], v[68:71], a[240:243], a[64:67]
 ds_read_b64_tr_b16 v[86:87], v58 offset:61440
 v_cvt_pk_bf16_f32 v114, v228, v229
 v_mfma_f32_16x16x32_bf16 a[68:71], v[68:71], a[244:247], a[68:71]
 v_xor_b32 v58, s49, v58
 v_mfma_f32_16x16x32_bf16 a[68:71], v[64:67], a[228:231], a[68:71]
 v_mfma_f32_16x16x32_bf16 a[72:75], v[64:67], a[232:235], a[72:75]
 ds_read_b64_tr_b16 v[88:89], v59 offset:49152
 buffer_load_dwordx4 v46, s[8:11], s75 offen offset:2048  lds
 v_mfma_f32_16x16x32_bf16 a[72:75], v[68:71], a[248:251], a[72:75]
 ds_read_b64_tr_b16 v[90:91], v59 offset:53248
 v_cvt_pk_bf16_f32 v115, v230, v231
 v_mfma_f32_16x16x32_bf16 a[76:79], v[68:71], a[252:255], a[76:79]
 v_mfma_f32_16x16x32_bf16 a[76:79], v[64:67], a[236:239], a[76:79]
 s_waitcnt lgkmcnt(6)
 v_mfma_f32_16x16x32_bf16 a[92:95], v[72:75], a[236:239], a[92:95]
 ds_read_b64_tr_b16 v[92:93], v59 offset:57344
 buffer_load_dwordx4 a[196:199], v5, s[20:23], s42 offen sc1
 v_mfma_f32_16x16x32_bf16 a[92:95], v[76:79], a[252:255], a[92:95]
 ds_read_b64_tr_b16 v[94:95], v59 offset:61440
 v_mfma_f32_16x16x32_bf16 a[88:91], v[76:79], a[248:251], a[88:91]
 buffer_store_dwordx4 v[112:115], v26, s[60:63], 0 offen offset:2048 sc1
 v_xor_b32 v59, s49, v59
 v_mfma_f32_16x16x32_bf16 a[88:91], v[72:75], a[232:235], a[88:91]
 s_waitcnt vmcnt(29)
 s_barrier
 v_mfma_f32_16x16x32_bf16 a[84:87], v[72:75], a[228:231], a[84:87]
 ds_read_b64_tr_b16 v[64:65], v52
 v_mfma_f32_16x16x32_bf16 a[84:87], v[76:79], a[244:247], a[84:87]
 ds_read_b64_tr_b16 v[66:67], v52 offset:4096
 v_mfma_f32_16x16x32_bf16 a[80:83], v[76:79], a[240:243], a[80:83]
 v_cvt_pk_bf16_f32 v116, v232, v233
 v_mfma_f32_16x16x32_bf16 a[80:83], v[72:75], a[224:227], a[80:83]
 s_waitcnt lgkmcnt(6)
 v_mfma_f32_16x16x32_bf16 a[96:99], v[80:83], a[224:227], a[96:99]
 ds_read_b64_tr_b16 v[68:69], v52 offset:8192
 buffer_load_dwordx4 a[200:203], v6, s[20:23], s42 offen sc1
 v_mfma_f32_16x16x32_bf16 a[96:99], v[84:87], a[240:243], a[96:99]
 ds_read_b64_tr_b16 v[70:71], v52 offset:12288
 v_mfma_f32_16x16x32_bf16 a[100:103], v[84:87], a[244:247], a[100:103]
 v_mfma_f32_16x16x32_bf16 a[100:103], v[80:83], a[228:231], a[100:103]
 v_cvt_pk_bf16_f32 v117, v234, v235
 v_mfma_f32_16x16x32_bf16 a[104:107], v[80:83], a[232:235], a[104:107]
 ds_read_b64_tr_b16 v[72:73], v53
 buffer_load_dwordx4 v47, s[8:11], s75 offen offset:3072  lds
 v_mfma_f32_16x16x32_bf16 a[104:107], v[84:87], a[248:251], a[104:107]
 ds_read_b64_tr_b16 v[74:75], v53 offset:4096
 s_add_u32 s75, s75, 262144
 v_mfma_f32_16x16x32_bf16 a[108:111], v[84:87], a[252:255], a[108:111]
 v_mfma_f32_16x16x32_bf16 a[108:111], v[80:83], a[236:239], a[108:111]
 s_waitcnt lgkmcnt(6)
 v_mfma_f32_16x16x32_bf16 a[124:127], v[88:91], a[236:239], a[124:127]
 ds_read_b64_tr_b16 v[76:77], v53 offset:8192
 buffer_load_dwordx4 a[204:207], v7, s[20:23], s42 offen sc1
 v_mfma_f32_16x16x32_bf16 a[124:127], v[92:95], a[252:255], a[124:127]
 ds_read_b64_tr_b16 v[78:79], v53 offset:12288
 buffer_load_dword v61, v0, s[16:19], 0 offen
 v_mfma_f32_16x16x32_bf16 a[120:123], v[92:95], a[248:251], a[120:123]
 v_cvt_pk_bf16_f32 v118, v236, v237
 v_mfma_f32_16x16x32_bf16 a[120:123], v[88:91], a[232:235], a[120:123]
 v_mfma_f32_16x16x32_bf16 a[116:119], v[88:91], a[228:231], a[116:119]
 ds_read_b64_tr_b16 v[80:81], v54
 v_cvt_pk_bf16_f32 v119, v238, v239
 v_mfma_f32_16x16x32_bf16 a[116:119], v[92:95], a[244:247], a[116:119]
 ds_read_b64_tr_b16 v[82:83], v54 offset:4096
 v_mfma_f32_16x16x32_bf16 a[112:115], v[92:95], a[240:243], a[112:115]
 v_mfma_f32_16x16x32_bf16 a[112:115], v[88:91], a[224:227], a[112:115]
 s_waitcnt lgkmcnt(6)
 v_mfma_f32_16x16x32_bf16 a[0:3], v[64:67], a[128:131], a[0:3]
 ds_read_b64_tr_b16 v[84:85], v54 offset:8192
 buffer_load_dwordx4 a[208:211], v4, s[20:23], s42 offen offset:1024 sc1
 s_waitcnt vmcnt(29)
 v_mfma_f32_16x16x32_bf16 a[0:3], v[68:71], a[144:147], a[0:3]
 ds_read_b64_tr_b16 v[86:87], v54 offset:12288
 buffer_store_dwordx4 v[116:119], v27, s[60:63], 0 offen offset:2048 sc1
 s_waitcnt vmcnt(29)
 v_mfma_f32_16x16x32_bf16 a[4:7], v[68:71], a[148:151], a[4:7]
 v_mfma_f32_16x16x32_bf16 a[4:7], v[64:67], a[132:135], a[4:7]
 v_mfma_f32_16x16x32_bf16 a[8:11], v[64:67], a[136:139], a[8:11]
 ds_read_b64_tr_b16 v[88:89], v55
 s_add_u32 m0, s79, 65536
 s_waitcnt vmcnt(27)
 v_mfma_f32_16x16x32_bf16 a[8:11], v[68:71], a[152:155], a[8:11]
 ds_read_b64_tr_b16 v[90:91], v55 offset:4096
 s_waitcnt vmcnt(25)
 v_cvt_pk_bf16_f32 v120, v240, v241
 v_mfma_f32_16x16x32_bf16 a[12:15], v[68:71], a[156:159], a[12:15]
 buffer_load_dwordx4 v40, s[8:11], s75 offen  lds
 v_mfma_f32_16x16x32_bf16 a[12:15], v[64:67], a[140:143], a[12:15]
 s_waitcnt lgkmcnt(6)
 v_mfma_f32_16x16x32_bf16 a[28:31], v[72:75], a[140:143], a[28:31]
 ds_read_b64_tr_b16 v[92:93], v55 offset:8192
 buffer_load_dwordx4 a[212:215], v5, s[20:23], s42 offen offset:1024 sc1
 v_mfma_f32_16x16x32_bf16 a[28:31], v[76:79], a[156:159], a[28:31]
 ds_read_b64_tr_b16 v[94:95], v55 offset:12288
 v_cvt_pk_bf16_f32 v121, v242, v243
 v_mfma_f32_16x16x32_bf16 a[24:27], v[76:79], a[152:155], a[24:27]
 v_mfma_f32_16x16x32_bf16 a[24:27], v[72:75], a[136:139], a[24:27]
 v_mfma_f32_16x16x32_bf16 a[20:23], v[72:75], a[132:135], a[20:23]
 ds_read_b64_tr_b16 v[64:65], v56
 v_mfma_f32_16x16x32_bf16 a[20:23], v[76:79], a[148:151], a[20:23]
 ds_read_b64_tr_b16 v[66:67], v56 offset:4096
 v_mfma_f32_16x16x32_bf16 a[16:19], v[76:79], a[144:147], a[16:19]
 v_cvt_pk_bf16_f32 v122, v244, v245
 v_mfma_f32_16x16x32_bf16 a[16:19], v[72:75], a[128:131], a[16:19]
 s_waitcnt lgkmcnt(6)
 v_mfma_f32_16x16x32_bf16 a[32:35], v[80:83], a[128:131], a[32:35]
 ds_read_b64_tr_b16 v[68:69], v56 offset:8192
 buffer_load_dwordx4 a[216:219], v6, s[20:23], s42 offen offset:1024 sc1
 v_mfma_f32_16x16x32_bf16 a[32:35], v[84:87], a[144:147], a[32:35]
 ds_read_b64_tr_b16 v[70:71], v56 offset:12288
 v_mfma_f32_16x16x32_bf16 a[36:39], v[84:87], a[148:151], a[36:39]
 v_cvt_pk_bf16_f32 v123, v246, v247
 v_mfma_f32_16x16x32_bf16 a[36:39], v[80:83], a[132:135], a[36:39]
 v_mfma_f32_16x16x32_bf16 a[40:43], v[80:83], a[136:139], a[40:43]
 ds_read_b64_tr_b16 v[72:73], v57
 buffer_load_dwordx4 v41, s[8:11], s75 offen offset:1024  lds
 v_mfma_f32_16x16x32_bf16 a[40:43], v[84:87], a[152:155], a[40:43]
 ds_read_b64_tr_b16 v[74:75], v57 offset:4096
 v_mfma_f32_16x16x32_bf16 a[44:47], v[84:87], a[156:159], a[44:47]
 v_mfma_f32_16x16x32_bf16 a[44:47], v[80:83], a[140:143], a[44:47]
 s_waitcnt lgkmcnt(6)
 v_mfma_f32_16x16x32_bf16 a[60:63], v[88:91], a[140:143], a[60:63]
 ds_read_b64_tr_b16 v[76:77], v57 offset:8192
 buffer_load_dwordx4 a[220:223], v7, s[20:23], s42 offen offset:1024 sc1
 v_mfma_f32_16x16x32_bf16 a[60:63], v[92:95], a[156:159], a[60:63]
 ds_read_b64_tr_b16 v[78:79], v57 offset:12288
 buffer_store_dwordx4 v[120:123], v26, s[60:63], 0 offen offset:3072 sc1
 v_mfma_f32_16x16x32_bf16 a[56:59], v[92:95], a[152:155], a[56:59]
 v_mfma_f32_16x16x32_bf16 a[56:59], v[88:91], a[136:139], a[56:59]
 v_cvt_pk_bf16_f32 v124, v248, v249
 v_mfma_f32_16x16x32_bf16 a[52:55], v[88:91], a[132:135], a[52:55]
 ds_read_b64_tr_b16 v[80:81], v58
 v_mfma_f32_16x16x32_bf16 a[52:55], v[92:95], a[148:151], a[52:55]
 ds_read_b64_tr_b16 v[82:83], v58 offset:4096
 v_mfma_f32_16x16x32_bf16 a[48:51], v[92:95], a[144:147], a[48:51]
 v_mfma_f32_16x16x32_bf16 a[48:51], v[88:91], a[128:131], a[48:51]
 s_waitcnt lgkmcnt(6)
 v_mfma_f32_16x16x32_bf16 a[64:67], v[64:67], a[128:131], a[64:67]
 ds_read_b64_tr_b16 v[84:85], v58 offset:8192
 buffer_load_dwordx4 a[224:227], v4, s[20:23], s42 offen offset:2048 sc1
 v_mfma_f32_16x16x32_bf16 a[64:67], v[68:71], a[144:147], a[64:67]
 ds_read_b64_tr_b16 v[86:87], v58 offset:12288
 v_cvt_pk_bf16_f32 v125, v250, v251
 v_mfma_f32_16x16x32_bf16 a[68:71], v[68:71], a[148:151], a[68:71]
 v_mfma_f32_16x16x32_bf16 a[68:71], v[64:67], a[132:135], a[68:71]
 v_mfma_f32_16x16x32_bf16 a[72:75], v[64:67], a[136:139], a[72:75]
 ds_read_b64_tr_b16 v[88:89], v59
 buffer_load_dwordx4 v42, s[8:11], s75 offen offset:2048  lds
 v_mfma_f32_16x16x32_bf16 a[72:75], v[68:71], a[152:155], a[72:75]
 ds_read_b64_tr_b16 v[90:91], v59 offset:4096
 v_cvt_pk_bf16_f32 v126, v252, v253
 v_mfma_f32_16x16x32_bf16 a[76:79], v[68:71], a[156:159], a[76:79]
 v_mfma_f32_16x16x32_bf16 a[76:79], v[64:67], a[140:143], a[76:79]
 s_waitcnt lgkmcnt(6)
 v_mfma_f32_16x16x32_bf16 a[92:95], v[72:75], a[140:143], a[92:95]
 ds_read_b64_tr_b16 v[92:93], v59 offset:8192
 buffer_load_dwordx4 a[228:231], v5, s[20:23], s42 offen offset:2048 sc1
 v_mfma_f32_16x16x32_bf16 a[92:95], v[76:79], a[156:159], a[92:95]
 ds_read_b64_tr_b16 v[94:95], v59 offset:12288
 v_cvt_pk_bf16_f32 v127, v254, v255
 v_mfma_f32_16x16x32_bf16 a[88:91], v[76:79], a[152:155], a[88:91]
 v_mfma_f32_16x16x32_bf16 a[88:91], v[72:75], a[136:139], a[88:91]
 v_mfma_f32_16x16x32_bf16 a[84:87], v[72:75], a[132:135], a[84:87]
 ds_read_b64_tr_b16 v[64:65], v52 offset:16384
 v_mfma_f32_16x16x32_bf16 a[84:87], v[76:79], a[148:151], a[84:87]
 ds_read_b64_tr_b16 v[66:67], v52 offset:20480
 buffer_store_dwordx4 v[124:127], v27, s[60:63], 0 offen offset:3072 sc1
 v_mfma_f32_16x16x32_bf16 a[80:83], v[76:79], a[144:147], a[80:83]
 v_mfma_f32_16x16x32_bf16 a[80:83], v[72:75], a[128:131], a[80:83]
 s_waitcnt lgkmcnt(6)
 v_mfma_f32_16x16x32_bf16 a[96:99], v[80:83], a[128:131], a[96:99]
 ds_read_b64_tr_b16 v[68:69], v52 offset:24576
 buffer_load_dwordx4 a[232:235], v6, s[20:23], s42 offen offset:2048 sc1
 v_mfma_f32_16x16x32_bf16 a[96:99], v[84:87], a[144:147], a[96:99]
 ds_read_b64_tr_b16 v[70:71], v52 offset:28672
 v_mfma_f32_16x16x32_bf16 a[100:103], v[84:87], a[148:151], a[100:103]
 v_cvt_pk_bf16_f32 v112, v136, v137
 v_mfma_f32_16x16x32_bf16 a[100:103], v[80:83], a[132:135], a[100:103]
 v_mfma_f32_16x16x32_bf16 a[104:107], v[80:83], a[136:139], a[104:107]
 ds_read_b64_tr_b16 v[72:73], v53 offset:16384
 buffer_load_dwordx4 v43, s[8:11], s75 offen offset:3072  lds
 v_mfma_f32_16x16x32_bf16 a[104:107], v[84:87], a[152:155], a[104:107]
 ds_read_b64_tr_b16 v[74:75], v53 offset:20480
 v_mfma_f32_16x16x32_bf16 a[108:111], v[84:87], a[156:159], a[108:111]
 v_cvt_pk_bf16_f32 v113, v138, v139
 v_mfma_f32_16x16x32_bf16 a[108:111], v[80:83], a[140:143], a[108:111]
 s_waitcnt lgkmcnt(6)
 v_mfma_f32_16x16x32_bf16 a[124:127], v[88:91], a[140:143], a[124:127]
 ds_read_b64_tr_b16 v[76:77], v53 offset:24576
 buffer_load_dwordx4 a[236:239], v7, s[20:23], s42 offen offset:2048 sc1
 v_mfma_f32_16x16x32_bf16 a[124:127], v[92:95], a[156:159], a[124:127]
 ds_read_b64_tr_b16 v[78:79], v53 offset:28672
 v_mfma_f32_16x16x32_bf16 a[120:123], v[92:95], a[152:155], a[120:123]
 v_mfma_f32_16x16x32_bf16 a[120:123], v[88:91], a[136:139], a[120:123]
 v_cvt_pk_bf16_f32 v114, v140, v141
 v_mfma_f32_16x16x32_bf16 a[116:119], v[88:91], a[132:135], a[116:119]
 ds_read_b64_tr_b16 v[80:81], v54 offset:16384
 v_mfma_f32_16x16x32_bf16 a[116:119], v[92:95], a[148:151], a[116:119]
 ds_read_b64_tr_b16 v[82:83], v54 offset:20480
 v_mfma_f32_16x16x32_bf16 a[112:115], v[92:95], a[144:147], a[112:115]
 v_mfma_f32_16x16x32_bf16 a[112:115], v[88:91], a[128:131], a[112:115]
 s_waitcnt lgkmcnt(6)
 s_waitcnt vmcnt(37)
 v_mfma_f32_16x16x32_bf16 a[0:3], v[64:67], a[160:163], a[0:3]
 ds_read_b64_tr_b16 v[84:85], v54 offset:24576
 buffer_load_dwordx4 a[240:243], v4, s[20:23], s42 offen offset:3072 sc1
 s_waitcnt vmcnt(30)
 v_mfma_f32_16x16x32_bf16 a[0:3], v[68:71], a[176:179], a[0:3]
 ds_read_b64_tr_b16 v[86:87], v54 offset:28672
 s_waitcnt vmcnt(28)
 v_cvt_pk_bf16_f32 v115, v142, v143
 v_mfma_f32_16x16x32_bf16 a[4:7], v[68:71], a[180:183], a[4:7]
 v_mfma_f32_16x16x32_bf16 a[4:7], v[64:67], a[164:167], a[4:7]
 v_mfma_f32_16x16x32_bf16 a[8:11], v[64:67], a[168:171], a[8:11]
 ds_read_b64_tr_b16 v[88:89], v55 offset:16384
 s_add_u32 m0, s79, 69632
 s_waitcnt vmcnt(27)
 v_mfma_f32_16x16x32_bf16 a[8:11], v[68:71], a[184:187], a[8:11]
 ds_read_b64_tr_b16 v[90:91], v55 offset:20480
 buffer_store_dwordx4 v[112:115], v25, s[60:63], 0 offen sc1
 s_waitcnt vmcnt(25)
 v_mfma_f32_16x16x32_bf16 a[12:15], v[68:71], a[188:191], a[12:15]
 buffer_load_dwordx4 v44, s[8:11], s75 offen  lds
 v_mfma_f32_16x16x32_bf16 a[12:15], v[64:67], a[172:175], a[12:15]
 s_waitcnt lgkmcnt(6)
 v_mfma_f32_16x16x32_bf16 a[28:31], v[72:75], a[172:175], a[28:31]
 ds_read_b64_tr_b16 v[92:93], v55 offset:24576
 buffer_load_dwordx4 a[244:247], v5, s[20:23], s42 offen offset:3072 sc1
 v_mfma_f32_16x16x32_bf16 a[28:31], v[76:79], a[188:191], a[28:31]
 ds_read_b64_tr_b16 v[94:95], v55 offset:28672
 v_cvt_pk_bf16_f32 v116, v152, v153
 v_mfma_f32_16x16x32_bf16 a[24:27], v[76:79], a[184:187], a[24:27]
 v_mfma_f32_16x16x32_bf16 a[24:27], v[72:75], a[168:171], a[24:27]
 v_mfma_f32_16x16x32_bf16 a[20:23], v[72:75], a[164:167], a[20:23]
 ds_read_b64_tr_b16 v[64:65], v56 offset:16384
 v_cvt_pk_bf16_f32 v117, v154, v155
 v_mfma_f32_16x16x32_bf16 a[20:23], v[76:79], a[180:183], a[20:23]
 ds_read_b64_tr_b16 v[66:67], v56 offset:20480
 v_mfma_f32_16x16x32_bf16 a[16:19], v[76:79], a[176:179], a[16:19]
 v_mfma_f32_16x16x32_bf16 a[16:19], v[72:75], a[160:163], a[16:19]
 s_waitcnt lgkmcnt(6)
 v_mfma_f32_16x16x32_bf16 a[32:35], v[80:83], a[160:163], a[32:35]
 ds_read_b64_tr_b16 v[68:69], v56 offset:24576
 buffer_load_dwordx4 a[248:251], v6, s[20:23], s42 offen offset:3072 sc1
 v_mfma_f32_16x16x32_bf16 a[32:35], v[84:87], a[176:179], a[32:35]
 ds_read_b64_tr_b16 v[70:71], v56 offset:28672
 v_cvt_pk_bf16_f32 v118, v156, v157
 v_mfma_f32_16x16x32_bf16 a[36:39], v[84:87], a[180:183], a[36:39]
 v_mfma_f32_16x16x32_bf16 a[36:39], v[80:83], a[164:167], a[36:39]
 v_mfma_f32_16x16x32_bf16 a[40:43], v[80:83], a[168:171], a[40:43]
 ds_read_b64_tr_b16 v[72:73], v57 offset:16384
 buffer_load_dwordx4 v45, s[8:11], s75 offen offset:1024  lds
 v_mfma_f32_16x16x32_bf16 a[40:43], v[84:87], a[184:187], a[40:43]
 ds_read_b64_tr_b16 v[74:75], v57 offset:20480
 v_cvt_pk_bf16_f32 v119, v158, v159
 v_mfma_f32_16x16x32_bf16 a[44:47], v[84:87], a[188:191], a[44:47]
 v_mfma_f32_16x16x32_bf16 a[44:47], v[80:83], a[172:175], a[44:47]
 s_waitcnt lgkmcnt(6)
 v_mfma_f32_16x16x32_bf16 a[60:63], v[88:91], a[172:175], a[60:63]
 ds_read_b64_tr_b16 v[76:77], v57 offset:24576
 buffer_load_dwordx4 a[252:255], v7, s[20:23], s42 offen offset:3072 sc1
 v_mfma_f32_16x16x32_bf16 a[60:63], v[92:95], a[188:191], a[60:63]
 ds_read_b64_tr_b16 v[78:79], v57 offset:28672
 s_add_u32 s42, s42, 4096
 v_mfma_f32_16x16x32_bf16 a[56:59], v[92:95], a[184:187], a[56:59]
 buffer_store_dwordx4 v[116:119], v25, s[60:63], 0 offen offset:1024 sc1
 v_mfma_f32_16x16x32_bf16 a[56:59], v[88:91], a[168:171], a[56:59]
 v_mfma_f32_16x16x32_bf16 a[52:55], v[88:91], a[164:167], a[52:55]
 ds_read_b64_tr_b16 v[80:81], v58 offset:16384
 v_mfma_f32_16x16x32_bf16 a[52:55], v[92:95], a[180:183], a[52:55]
 ds_read_b64_tr_b16 v[82:83], v58 offset:20480
 v_mfma_f32_16x16x32_bf16 a[48:51], v[92:95], a[176:179], a[48:51]
 v_cvt_pk_bf16_f32 v120, v168, v169
 v_mfma_f32_16x16x32_bf16 a[48:51], v[88:91], a[160:163], a[48:51]
 s_waitcnt lgkmcnt(6)
 v_mfma_f32_16x16x32_bf16 a[64:67], v[64:67], a[160:163], a[64:67]
 ds_read_b64_tr_b16 v[84:85], v58 offset:24576
 buffer_load_dwordx4 a[128:131], v4, s[20:23], s42 offen sc1
 v_mfma_f32_16x16x32_bf16 a[64:67], v[68:71], a[176:179], a[64:67]
 ds_read_b64_tr_b16 v[86:87], v58 offset:28672
 v_mfma_f32_16x16x32_bf16 a[68:71], v[68:71], a[180:183], a[68:71]
 v_mfma_f32_16x16x32_bf16 a[68:71], v[64:67], a[164:167], a[68:71]
 v_cvt_pk_bf16_f32 v121, v170, v171
 v_mfma_f32_16x16x32_bf16 a[72:75], v[64:67], a[168:171], a[72:75]
 ds_read_b64_tr_b16 v[88:89], v59 offset:16384
 buffer_load_dwordx4 v46, s[8:11], s75 offen offset:2048  lds
 v_mfma_f32_16x16x32_bf16 a[72:75], v[68:71], a[184:187], a[72:75]
 ds_read_b64_tr_b16 v[90:91], v59 offset:20480
 v_mfma_f32_16x16x32_bf16 a[76:79], v[68:71], a[188:191], a[76:79]
 v_mfma_f32_16x16x32_bf16 a[76:79], v[64:67], a[172:175], a[76:79]
 s_waitcnt lgkmcnt(6)
 v_mfma_f32_16x16x32_bf16 a[92:95], v[72:75], a[172:175], a[92:95]
 ds_read_b64_tr_b16 v[92:93], v59 offset:24576
 buffer_load_dwordx4 a[132:135], v5, s[20:23], s42 offen sc1
 v_mfma_f32_16x16x32_bf16 a[92:95], v[76:79], a[188:191], a[92:95]
 ds_read_b64_tr_b16 v[94:95], v59 offset:28672
 v_cvt_pk_bf16_f32 v122, v172, v173
 v_mfma_f32_16x16x32_bf16 a[88:91], v[76:79], a[184:187], a[88:91]
 v_mfma_f32_16x16x32_bf16 a[88:91], v[72:75], a[168:171], a[88:91]
 s_waitcnt vmcnt(28)
 s_barrier
 v_mfma_f32_16x16x32_bf16 a[84:87], v[72:75], a[164:167], a[84:87]
 ds_read_b64_tr_b16 v[64:65], v52 offset:32768
 v_cvt_pk_bf16_f32 v123, v174, v175
 v_mfma_f32_16x16x32_bf16 a[84:87], v[76:79], a[180:183], a[84:87]
 ds_read_b64_tr_b16 v[66:67], v52 offset:36864
 v_mfma_f32_16x16x32_bf16 a[80:83], v[76:79], a[176:179], a[80:83]
 v_mfma_f32_16x16x32_bf16 a[80:83], v[72:75], a[160:163], a[80:83]
 s_waitcnt lgkmcnt(6)
 v_mfma_f32_16x16x32_bf16 a[96:99], v[80:83], a[160:163], a[96:99]
 ds_read_b64_tr_b16 v[68:69], v52 offset:40960
 buffer_load_dwordx4 a[136:139], v6, s[20:23], s42 offen sc1
 v_mfma_f32_16x16x32_bf16 a[96:99], v[84:87], a[176:179], a[96:99]
 ds_read_b64_tr_b16 v[70:71], v52 offset:45056
 buffer_store_dwordx4 v[120:123], v25, s[60:63], 0 offen offset:2048 sc1
 v_mfma_f32_16x16x32_bf16 a[100:103], v[84:87], a[180:183], a[100:103]
 v_mfma_f32_16x16x32_bf16 a[100:103], v[80:83], a[164:167], a[100:103]
 v_mfma_f32_16x16x32_bf16 a[104:107], v[80:83], a[168:171], a[104:107]
 ds_read_b64_tr_b16 v[72:73], v53 offset:32768
 buffer_load_dwordx4 v47, s[8:11], s75 offen offset:3072  lds
 v_mfma_f32_16x16x32_bf16 a[104:107], v[84:87], a[184:187], a[104:107]
 ds_read_b64_tr_b16 v[74:75], v53 offset:36864
 s_add_u32 s75, s75, 262144
 v_mfma_f32_16x16x32_bf16 a[108:111], v[84:87], a[188:191], a[108:111]
 v_cvt_pk_bf16_f32 v124, v184, v185
 v_mfma_f32_16x16x32_bf16 a[108:111], v[80:83], a[172:175], a[108:111]
 s_waitcnt lgkmcnt(6)
 v_mfma_f32_16x16x32_bf16 a[124:127], v[88:91], a[172:175], a[124:127]
 ds_read_b64_tr_b16 v[76:77], v53 offset:40960
 buffer_load_dwordx4 a[140:143], v7, s[20:23], s42 offen sc1
 v_mfma_f32_16x16x32_bf16 a[124:127], v[92:95], a[188:191], a[124:127]
 ds_read_b64_tr_b16 v[78:79], v53 offset:45056
 buffer_load_dword v61, v0, s[16:19], 0 offen
 v_mfma_f32_16x16x32_bf16 a[120:123], v[92:95], a[184:187], a[120:123]
 v_cvt_pk_bf16_f32 v125, v186, v187
 v_mfma_f32_16x16x32_bf16 a[120:123], v[88:91], a[168:171], a[120:123]
 v_mfma_f32_16x16x32_bf16 a[116:119], v[88:91], a[164:167], a[116:119]
 ds_read_b64_tr_b16 v[80:81], v54 offset:32768
 v_mfma_f32_16x16x32_bf16 a[116:119], v[92:95], a[180:183], a[116:119]
 ds_read_b64_tr_b16 v[82:83], v54 offset:36864
 v_mfma_f32_16x16x32_bf16 a[112:115], v[92:95], a[176:179], a[112:115]
 v_cvt_pk_bf16_f32 v126, v188, v189
 v_mfma_f32_16x16x32_bf16 a[112:115], v[88:91], a[160:163], a[112:115]
 s_waitcnt lgkmcnt(6)
 v_mfma_f32_16x16x32_bf16 a[0:3], v[64:67], a[192:195], a[0:3]
 ds_read_b64_tr_b16 v[84:85], v54 offset:40960
 buffer_load_dwordx4 a[144:147], v4, s[20:23], s42 offen offset:1024 sc1
 s_waitcnt vmcnt(31)
 v_mfma_f32_16x16x32_bf16 a[0:3], v[68:71], a[208:211], a[0:3]
 ds_read_b64_tr_b16 v[86:87], v54 offset:45056
 s_waitcnt vmcnt(28)
 v_mfma_f32_16x16x32_bf16 a[4:7], v[68:71], a[212:215], a[4:7]
 v_cvt_pk_bf16_f32 v127, v190, v191
 v_mfma_f32_16x16x32_bf16 a[4:7], v[64:67], a[196:199], a[4:7]
 v_mfma_f32_16x16x32_bf16 a[8:11], v[64:67], a[200:203], a[8:11]
 ds_read_b64_tr_b16 v[88:89], v55 offset:32768
 s_add_u32 m0, s79, 98304
 s_waitcnt vmcnt(27)
 v_mfma_f32_16x16x32_bf16 a[8:11], v[68:71], a[216:219], a[8:11]
 ds_read_b64_tr_b16 v[90:91], v55 offset:36864
 s_waitcnt vmcnt(25)
 v_mfma_f32_16x16x32_bf16 a[12:15], v[68:71], a[220:223], a[12:15]
 buffer_load_dwordx4 v40, s[8:11], s75 offen  lds
 v_mfma_f32_16x16x32_bf16 a[12:15], v[64:67], a[204:207], a[12:15]
 s_waitcnt lgkmcnt(6)
 v_mfma_f32_16x16x32_bf16 a[28:31], v[72:75], a[204:207], a[28:31]
 ds_read_b64_tr_b16 v[92:93], v55 offset:40960
 buffer_load_dwordx4 a[148:151], v5, s[20:23], s42 offen offset:1024 sc1
 v_mfma_f32_16x16x32_bf16 a[28:31], v[76:79], a[220:223], a[28:31]
 ds_read_b64_tr_b16 v[94:95], v55 offset:45056
 buffer_store_dwordx4 v[124:127], v25, s[60:63], 0 offen offset:3072 sc1
 v_mfma_f32_16x16x32_bf16 a[24:27], v[76:79], a[216:219], a[24:27]
 v_mfma_f32_16x16x32_bf16 a[24:27], v[72:75], a[200:203], a[24:27]
 v_mov_b32 v136, v144
 v_mfma_f32_16x16x32_bf16 a[20:23], v[72:75], a[196:199], a[20:23]
 ds_read_b64_tr_b16 v[64:65], v56 offset:32768
 v_mfma_f32_16x16x32_bf16 a[20:23], v[76:79], a[212:215], a[20:23]
 ds_read_b64_tr_b16 v[66:67], v56 offset:36864
 v_mfma_f32_16x16x32_bf16 a[16:19], v[76:79], a[208:211], a[16:19]
 v_mfma_f32_16x16x32_bf16 a[16:19], v[72:75], a[192:195], a[16:19]
 s_waitcnt lgkmcnt(6)
 v_mfma_f32_16x16x32_bf16 a[32:35], v[80:83], a[192:195], a[32:35]
 ds_read_b64_tr_b16 v[68:69], v56 offset:40960
 buffer_load_dwordx4 a[152:155], v6, s[20:23], s42 offen offset:1024 sc1
 v_mfma_f32_16x16x32_bf16 a[32:35], v[84:87], a[208:211], a[32:35]
 ds_read_b64_tr_b16 v[70:71], v56 offset:45056
 v_mov_b32 v137, v145
 v_mfma_f32_16x16x32_bf16 a[36:39], v[84:87], a[212:215], a[36:39]
 v_mfma_f32_16x16x32_bf16 a[36:39], v[80:83], a[196:199], a[36:39]
 v_mfma_f32_16x16x32_bf16 a[40:43], v[80:83], a[200:203], a[40:43]
 ds_read_b64_tr_b16 v[72:73], v57 offset:32768
 buffer_load_dwordx4 v41, s[8:11], s75 offen offset:1024  lds
 v_mfma_f32_16x16x32_bf16 a[40:43], v[84:87], a[216:219], a[40:43]
 ds_read_b64_tr_b16 v[74:75], v57 offset:36864
 v_mov_b32 v138, v146
 v_mfma_f32_16x16x32_bf16 a[44:47], v[84:87], a[220:223], a[44:47]
 v_mfma_f32_16x16x32_bf16 a[44:47], v[80:83], a[204:207], a[44:47]
 s_waitcnt lgkmcnt(6)
 v_mfma_f32_16x16x32_bf16 a[60:63], v[88:91], a[204:207], a[60:63]
 ds_read_b64_tr_b16 v[76:77], v57 offset:40960
 buffer_load_dwordx4 a[156:159], v7, s[20:23], s42 offen offset:1024 sc1
 v_mfma_f32_16x16x32_bf16 a[60:63], v[92:95], a[220:223], a[60:63]
 ds_read_b64_tr_b16 v[78:79], v57 offset:45056
 v_mov_b32 v139, v147
 v_mfma_f32_16x16x32_bf16 a[56:59], v[92:95], a[216:219], a[56:59]
 v_mfma_f32_16x16x32_bf16 a[56:59], v[88:91], a[200:203], a[56:59]
 v_mfma_f32_16x16x32_bf16 a[52:55], v[88:91], a[196:199], a[52:55]
 ds_read_b64_tr_b16 v[80:81], v58 offset:32768
 v_mfma_f32_16x16x32_bf16 a[52:55], v[92:95], a[212:215], a[52:55]
 ds_read_b64_tr_b16 v[82:83], v58 offset:36864
 v_mov_b32 v140, v148
 v_mfma_f32_16x16x32_bf16 a[48:51], v[92:95], a[208:211], a[48:51]
 v_mfma_f32_16x16x32_bf16 a[48:51], v[88:91], a[192:195], a[48:51]
 s_waitcnt lgkmcnt(6)
 v_mfma_f32_16x16x32_bf16 a[64:67], v[64:67], a[192:195], a[64:67]
 ds_read_b64_tr_b16 v[84:85], v58 offset:40960
 buffer_load_dwordx4 a[160:163], v4, s[20:23], s42 offen offset:2048 sc1
 v_mfma_f32_16x16x32_bf16 a[64:67], v[68:71], a[208:211], a[64:67]
 ds_read_b64_tr_b16 v[86:87], v58 offset:45056
 v_mfma_f32_16x16x32_bf16 a[68:71], v[68:71], a[212:215], a[68:71]
 v_mov_b32 v141, v149
 v_mfma_f32_16x16x32_bf16 a[68:71], v[64:67], a[196:199], a[68:71]
 v_mfma_f32_16x16x32_bf16 a[72:75], v[64:67], a[200:203], a[72:75]
 ds_read_b64_tr_b16 v[88:89], v59 offset:32768
 buffer_load_dwordx4 v42, s[8:11], s75 offen offset:2048  lds
 v_mfma_f32_16x16x32_bf16 a[72:75], v[68:71], a[216:219], a[72:75]
 ds_read_b64_tr_b16 v[90:91], v59 offset:36864
 v_mfma_f32_16x16x32_bf16 a[76:79], v[68:71], a[220:223], a[76:79]
 v_mov_b32 v142, v150
 v_mfma_f32_16x16x32_bf16 a[76:79], v[64:67], a[204:207], a[76:79]
 s_waitcnt lgkmcnt(6)
 v_mfma_f32_16x16x32_bf16 a[92:95], v[72:75], a[204:207], a[92:95]
 ds_read_b64_tr_b16 v[92:93], v59 offset:40960
 buffer_load_dwordx4 a[164:167], v5, s[20:23], s42 offen offset:2048 sc1
 v_mfma_f32_16x16x32_bf16 a[92:95], v[76:79], a[220:223], a[92:95]
 ds_read_b64_tr_b16 v[94:95], v59 offset:45056
 v_mfma_f32_16x16x32_bf16 a[88:91], v[76:79], a[216:219], a[88:91]
 v_mov_b32 v143, v151
 v_mfma_f32_16x16x32_bf16 a[88:91], v[72:75], a[200:203], a[88:91]
 v_mfma_f32_16x16x32_bf16 a[84:87], v[72:75], a[196:199], a[84:87]
 ds_read_b64_tr_b16 v[64:65], v52 offset:49152
 v_mfma_f32_16x16x32_bf16 a[84:87], v[76:79], a[212:215], a[84:87]
 ds_read_b64_tr_b16 v[66:67], v52 offset:53248
 v_mfma_f32_16x16x32_bf16 a[80:83], v[76:79], a[208:211], a[80:83]
 v_mfma_f32_16x16x32_bf16 a[80:83], v[72:75], a[192:195], a[80:83]
 s_waitcnt lgkmcnt(6)
 v_mfma_f32_16x16x32_bf16 a[96:99], v[80:83], a[192:195], a[96:99]
 ds_read_b64_tr_b16 v[68:69], v52 offset:57344
 buffer_load_dwordx4 a[168:171], v6, s[20:23], s42 offen offset:2048 sc1
 v_mfma_f32_16x16x32_bf16 a[96:99], v[84:87], a[208:211], a[96:99]
 ds_read_b64_tr_b16 v[70:71], v52 offset:61440
 v_mov_b32 v144, v160
 v_mfma_f32_16x16x32_bf16 a[100:103], v[84:87], a[212:215], a[100:103]
 v_xor_b32 v52, s49, v52
 v_mfma_f32_16x16x32_bf16 a[100:103], v[80:83], a[196:199], a[100:103]
 v_mov_b32 v145, v161
 v_mfma_f32_16x16x32_bf16 a[104:107], v[80:83], a[200:203], a[104:107]
 ds_read_b64_tr_b16 v[72:73], v53 offset:49152
 buffer_load_dwordx4 v43, s[8:11], s75 offen offset:3072  lds
 v_mfma_f32_16x16x32_bf16 a[104:107], v[84:87], a[216:219], a[104:107]
 ds_read_b64_tr_b16 v[74:75], v53 offset:53248
 v_mfma_f32_16x16x32_bf16 a[108:111], v[84:87], a[220:223], a[108:111]
 v_mfma_f32_16x16x32_bf16 a[108:111], v[80:83], a[204:207], a[108:111]
 s_waitcnt lgkmcnt(6)
 v_mfma_f32_16x16x32_bf16 a[124:127], v[88:91], a[204:207], a[124:127]
 ds_read_b64_tr_b16 v[76:77], v53 offset:57344
 buffer_load_dwordx4 a[172:175], v7, s[20:23], s42 offen offset:2048 sc1
 v_mfma_f32_16x16x32_bf16 a[124:127], v[92:95], a[220:223], a[124:127]
 ds_read_b64_tr_b16 v[78:79], v53 offset:61440
 v_mov_b32 v146, v162
 v_mfma_f32_16x16x32_bf16 a[120:123], v[92:95], a[216:219], a[120:123]
 v_xor_b32 v53, s49, v53
 v_mfma_f32_16x16x32_bf16 a[120:123], v[88:91], a[200:203], a[120:123]
 v_mfma_f32_16x16x32_bf16 a[116:119], v[88:91], a[196:199], a[116:119]
 ds_read_b64_tr_b16 v[80:81], v54 offset:49152
 v_mov_b32 v147, v163
 v_mfma_f32_16x16x32_bf16 a[116:119], v[92:95], a[212:215], a[116:119]
 ds_read_b64_tr_b16 v[82:83], v54 offset:53248
 v_mfma_f32_16x16x32_bf16 a[112:115], v[92:95], a[208:211], a[112:115]
 v_mfma_f32_16x16x32_bf16 a[112:115], v[88:91], a[192:195], a[112:115]
 s_waitcnt lgkmcnt(6)
 s_waitcnt vmcnt(35)
 v_mfma_f32_16x16x32_bf16 a[0:3], v[64:67], a[224:227], a[0:3]
 ds_read_b64_tr_b16 v[84:85], v54 offset:57344
 buffer_load_dwordx4 a[176:179], v4, s[20:23], s42 offen offset:3072 sc1
 s_waitcnt vmcnt(29)
 v_mfma_f32_16x16x32_bf16 a[0:3], v[68:71], a[240:243], a[0:3]
 ds_read_b64_tr_b16 v[86:87], v54 offset:61440
 s_waitcnt vmcnt(26)
 v_mov_b32 v148, v164
 v_mfma_f32_16x16x32_bf16 a[4:7], v[68:71], a[244:247], a[4:7]
 v_xor_b32 v54, s49, v54
 v_mfma_f32_16x16x32_bf16 a[4:7], v[64:67], a[228:231], a[4:7]
 v_mfma_f32_16x16x32_bf16 a[8:11], v[64:67], a[232:235], a[8:11]
 ds_read_b64_tr_b16 v[88:89], v55 offset:49152
 s_add_u32 m0, s79, 102400
 s_waitcnt vmcnt(25)
 v_mfma_f32_16x16x32_bf16 a[8:11], v[68:71], a[248:251], a[8:11]
 ds_read_b64_tr_b16 v[90:91], v55 offset:53248
 s_waitcnt vmcnt(23)
 v_mov_b32 v149, v165
 v_mfma_f32_16x16x32_bf16 a[12:15], v[68:71], a[252:255], a[12:15]
 buffer_load_dwordx4 v44, s[8:11], s75 offen  lds
 v_mfma_f32_16x16x32_bf16 a[12:15], v[64:67], a[236:239], a[12:15]
 s_waitcnt lgkmcnt(6)
 v_mfma_f32_16x16x32_bf16 a[28:31], v[72:75], a[236:239], a[28:31]
 ds_read_b64_tr_b16 v[92:93], v55 offset:57344
 buffer_load_dwordx4 a[180:183], v5, s[20:23], s42 offen offset:3072 sc1
 v_mfma_f32_16x16x32_bf16 a[28:31], v[76:79], a[252:255], a[28:31]
 ds_read_b64_tr_b16 v[94:95], v55 offset:61440
 v_mfma_f32_16x16x32_bf16 a[24:27], v[76:79], a[248:251], a[24:27]
 v_xor_b32 v55, s49, v55
 v_mov_b32 v150, v166
 v_mfma_f32_16x16x32_bf16 a[24:27], v[72:75], a[232:235], a[24:27]
 v_mfma_f32_16x16x32_bf16 a[20:23], v[72:75], a[228:231], a[20:23]
 ds_read_b64_tr_b16 v[64:65], v56 offset:49152
 v_mfma_f32_16x16x32_bf16 a[20:23], v[76:79], a[244:247], a[20:23]
 ds_read_b64_tr_b16 v[66:67], v56 offset:53248
 v_mfma_f32_16x16x32_bf16 a[16:19], v[76:79], a[240:243], a[16:19]
 v_mov_b32 v151, v167
 v_mfma_f32_16x16x32_bf16 a[16:19], v[72:75], a[224:227], a[16:19]
 s_waitcnt lgkmcnt(6)
 v_mfma_f32_16x16x32_bf16 a[32:35], v[80:83], a[224:227], a[32:35]
 ds_read_b64_tr_b16 v[68:69], v56 offset:57344
 buffer_load_dwordx4 a[184:187], v6, s[20:23], s42 offen offset:3072 sc1
 v_mfma_f32_16x16x32_bf16 a[32:35], v[84:87], a[240:243], a[32:35]
 ds_read_b64_tr_b16 v[70:71], v56 offset:61440
 v_mfma_f32_16x16x32_bf16 a[36:39], v[84:87], a[244:247], a[36:39]
 v_xor_b32 v56, s49, v56
 v_mfma_f32_16x16x32_bf16 a[36:39], v[80:83], a[228:231], a[36:39]
 v_mov_b32 v152, v176
 v_mfma_f32_16x16x32_bf16 a[40:43], v[80:83], a[232:235], a[40:43]
 ds_read_b64_tr_b16 v[72:73], v57 offset:49152
 buffer_load_dwordx4 v45, s[8:11], s75 offen offset:1024  lds
 v_mfma_f32_16x16x32_bf16 a[40:43], v[84:87], a[248:251], a[40:43]
 ds_read_b64_tr_b16 v[74:75], v57 offset:53248
 v_mfma_f32_16x16x32_bf16 a[44:47], v[84:87], a[252:255], a[44:47]
 v_mfma_f32_16x16x32_bf16 a[44:47], v[80:83], a[236:239], a[44:47]
 s_waitcnt lgkmcnt(6)
 v_mfma_f32_16x16x32_bf16 a[60:63], v[88:91], a[236:239], a[60:63]
 ds_read_b64_tr_b16 v[76:77], v57 offset:57344
 buffer_load_dwordx4 a[188:191], v7, s[20:23], s42 offen offset:3072 sc1
 v_mfma_f32_16x16x32_bf16 a[60:63], v[92:95], a[252:255], a[60:63]
 ds_read_b64_tr_b16 v[78:79], v57 offset:61440
 s_add_u32 s42, s42, 4096
 v_mfma_f32_16x16x32_bf16 a[56:59], v[92:95], a[248:251], a[56:59]
 v_xor_b32 v57, s49, v57
 v_mov_b32 v153, v177
 v_mfma_f32_16x16x32_bf16 a[56:59], v[88:91], a[232:235], a[56:59]
 v_mfma_f32_16x16x32_bf16 a[52:55], v[88:91], a[228:231], a[52:55]
 ds_read_b64_tr_b16 v[80:81], v58 offset:49152
 v_mov_b32 v154, v178
 v_mfma_f32_16x16x32_bf16 a[52:55], v[92:95], a[244:247], a[52:55]
 ds_read_b64_tr_b16 v[82:83], v58 offset:53248
 v_mfma_f32_16x16x32_bf16 a[48:51], v[92:95], a[240:243], a[48:51]
 v_mfma_f32_16x16x32_bf16 a[48:51], v[88:91], a[224:227], a[48:51]
 s_waitcnt lgkmcnt(6)
 v_mfma_f32_16x16x32_bf16 a[64:67], v[64:67], a[224:227], a[64:67]
 ds_read_b64_tr_b16 v[84:85], v58 offset:57344
 buffer_load_dwordx4 a[192:195], v4, s[20:23], s42 offen sc1
 v_mfma_f32_16x16x32_bf16 a[64:67], v[68:71], a[240:243], a[64:67]
 ds_read_b64_tr_b16 v[86:87], v58 offset:61440
 v_mov_b32 v155, v179
 v_mfma_f32_16x16x32_bf16 a[68:71], v[68:71], a[244:247], a[68:71]
 v_xor_b32 v58, s49, v58
 v_mfma_f32_16x16x32_bf16 a[68:71], v[64:67], a[228:231], a[68:71]
 v_mfma_f32_16x16x32_bf16 a[72:75], v[64:67], a[232:235], a[72:75]
 ds_read_b64_tr_b16 v[88:89], v59 offset:49152
 buffer_load_dwordx4 v46, s[8:11], s75 offen offset:2048  lds
 v_mfma_f32_16x16x32_bf16 a[72:75], v[68:71], a[248:251], a[72:75]
 ds_read_b64_tr_b16 v[90:91], v59 offset:53248
 v_mov_b32 v156, v180
 v_mfma_f32_16x16x32_bf16 a[76:79], v[68:71], a[252:255], a[76:79]
 v_mfma_f32_16x16x32_bf16 a[76:79], v[64:67], a[236:239], a[76:79]
 s_waitcnt lgkmcnt(6)
 v_mfma_f32_16x16x32_bf16 a[92:95], v[72:75], a[236:239], a[92:95]
 ds_read_b64_tr_b16 v[92:93], v59 offset:57344
 buffer_load_dwordx4 a[196:199], v5, s[20:23], s42 offen sc1
 v_mfma_f32_16x16x32_bf16 a[92:95], v[76:79], a[252:255], a[92:95]
 ds_read_b64_tr_b16 v[94:95], v59 offset:61440
 v_mov_b32 v157, v181
 v_mfma_f32_16x16x32_bf16 a[88:91], v[76:79], a[248:251], a[88:91]
 v_xor_b32 v59, s49, v59
 v_mfma_f32_16x16x32_bf16 a[88:91], v[72:75], a[232:235], a[88:91]
 s_waitcnt vmcnt(24)
 s_barrier
 v_mfma_f32_16x16x32_bf16 a[84:87], v[72:75], a[228:231], a[84:87]
 ds_read_b64_tr_b16 v[64:65], v52
 v_mfma_f32_16x16x32_bf16 a[84:87], v[76:79], a[244:247], a[84:87]
 ds_read_b64_tr_b16 v[66:67], v52 offset:4096
 v_mfma_f32_16x16x32_bf16 a[80:83], v[76:79], a[240:243], a[80:83]
 v_mov_b32 v158, v182
 v_mfma_f32_16x16x32_bf16 a[80:83], v[72:75], a[224:227], a[80:83]
 s_waitcnt lgkmcnt(6)
 v_mfma_f32_16x16x32_bf16 a[96:99], v[80:83], a[224:227], a[96:99]
 ds_read_b64_tr_b16 v[68:69], v52 offset:8192
 buffer_load_dwordx4 a[200:203], v6, s[20:23], s42 offen sc1
 v_mfma_f32_16x16x32_bf16 a[96:99], v[84:87], a[240:243], a[96:99]
 ds_read_b64_tr_b16 v[70:71], v52 offset:12288
 v_mfma_f32_16x16x32_bf16 a[100:103], v[84:87], a[244:247], a[100:103]
 v_mov_b32 v159, v183
 v_mfma_f32_16x16x32_bf16 a[100:103], v[80:83], a[228:231], a[100:103]
 v_mfma_f32_16x16x32_bf16 a[104:107], v[80:83], a[232:235], a[104:107]
 ds_read_b64_tr_b16 v[72:73], v53
 buffer_load_dwordx4 v47, s[8:11], s75 offen offset:3072  lds
 v_mfma_f32_16x16x32_bf16 a[104:107], v[84:87], a[248:251], a[104:107]
 ds_read_b64_tr_b16 v[74:75], v53 offset:4096
 s_add_u32 s75, s75, 262144
 v_mfma_f32_16x16x32_bf16 a[108:111], v[84:87], a[252:255], a[108:111]
 v_mfma_f32_16x16x32_bf16 a[108:111], v[80:83], a[236:239], a[108:111]
 s_waitcnt lgkmcnt(6)
 v_mfma_f32_16x16x32_bf16 a[124:127], v[88:91], a[236:239], a[124:127]
 ds_read_b64_tr_b16 v[76:77], v53 offset:8192
 buffer_load_dwordx4 a[204:207], v7, s[20:23], s42 offen sc1
 v_mfma_f32_16x16x32_bf16 a[124:127], v[92:95], a[252:255], a[124:127]
 ds_read_b64_tr_b16 v[78:79], v53 offset:12288
 buffer_load_dword v61, v0, s[16:19], 0 offen
 v_mfma_f32_16x16x32_bf16 a[120:123], v[92:95], a[248:251], a[120:123]
 v_mfma_f32_16x16x32_bf16 a[120:123], v[88:91], a[232:235], a[120:123]
 v_mfma_f32_16x16x32_bf16 a[116:119], v[88:91], a[228:231], a[116:119]
 ds_read_b64_tr_b16 v[80:81], v54
 v_mfma_f32_16x16x32_bf16 a[116:119], v[92:95], a[244:247], a[116:119]
 ds_read_b64_tr_b16 v[82:83], v54 offset:4096
 v_mfma_f32_16x16x32_bf16 a[112:115], v[92:95], a[240:243], a[112:115]
 v_mfma_f32_16x16x32_bf16 a[112:115], v[88:91], a[224:227], a[112:115]
 s_waitcnt lgkmcnt(6)
 v_mfma_f32_16x16x32_bf16 a[0:3], v[64:67], a[128:131], a[0:3]
 ds_read_b64_tr_b16 v[84:85], v54 offset:8192
 buffer_load_dwordx4 a[208:211], v4, s[20:23], s42 offen offset:1024 sc1
 s_waitcnt vmcnt(26)
 v_mfma_f32_16x16x32_bf16 a[0:3], v[68:71], a[144:147], a[0:3]
 ds_read_b64_tr_b16 v[86:87], v54 offset:12288
 s_waitcnt vmcnt(24)
 v_mfma_f32_16x16x32_bf16 a[4:7], v[68:71], a[148:151], a[4:7]
 v_mfma_f32_16x16x32_bf16 a[4:7], v[64:67], a[132:135], a[4:7]
 v_mfma_f32_16x16x32_bf16 a[8:11], v[64:67], a[136:139], a[8:11]
 ds_read_b64_tr_b16 v[88:89], v55
 s_add_u32 m0, s79, 0
 s_waitcnt vmcnt(22)
 v_mfma_f32_16x16x32_bf16 a[8:11], v[68:71], a[152:155], a[8:11]
 ds_read_b64_tr_b16 v[90:91], v55 offset:4096
 s_waitcnt vmcnt(20)
 v_mfma_f32_16x16x32_bf16 a[12:15], v[68:71], a[156:159], a[12:15]
 buffer_load_dwordx4 v40, s[8:11], s75 offen  lds
 v_mfma_f32_16x16x32_bf16 a[12:15], v[64:67], a[140:143], a[12:15]
 s_waitcnt lgkmcnt(6)
 v_mfma_f32_16x16x32_bf16 a[28:31], v[72:75], a[140:143], a[28:31]
 ds_read_b64_tr_b16 v[92:93], v55 offset:8192
 buffer_load_dwordx4 a[212:215], v5, s[20:23], s42 offen offset:1024 sc1
 v_mfma_f32_16x16x32_bf16 a[28:31], v[76:79], a[156:159], a[28:31]
 ds_read_b64_tr_b16 v[94:95], v55 offset:12288
 v_mfma_f32_16x16x32_bf16 a[24:27], v[76:79], a[152:155], a[24:27]
 v_mfma_f32_16x16x32_bf16 a[24:27], v[72:75], a[136:139], a[24:27]
 v_mfma_f32_16x16x32_bf16 a[20:23], v[72:75], a[132:135], a[20:23]
 ds_read_b64_tr_b16 v[64:65], v56
 v_mfma_f32_16x16x32_bf16 a[20:23], v[76:79], a[148:151], a[20:23]
 ds_read_b64_tr_b16 v[66:67], v56 offset:4096
 v_mfma_f32_16x16x32_bf16 a[16:19], v[76:79], a[144:147], a[16:19]
 v_mfma_f32_16x16x32_bf16 a[16:19], v[72:75], a[128:131], a[16:19]
 s_waitcnt lgkmcnt(6)
 v_mfma_f32_16x16x32_bf16 a[32:35], v[80:83], a[128:131], a[32:35]
 ds_read_b64_tr_b16 v[68:69], v56 offset:8192
 buffer_load_dwordx4 a[216:219], v6, s[20:23], s42 offen offset:1024 sc1
 v_mfma_f32_16x16x32_bf16 a[32:35], v[84:87], a[144:147], a[32:35]
 ds_read_b64_tr_b16 v[70:71], v56 offset:12288
 v_mfma_f32_16x16x32_bf16 a[36:39], v[84:87], a[148:151], a[36:39]
 v_mfma_f32_16x16x32_bf16 a[36:39], v[80:83], a[132:135], a[36:39]
 v_mfma_f32_16x16x32_bf16 a[40:43], v[80:83], a[136:139], a[40:43]
 ds_read_b64_tr_b16 v[72:73], v57
 buffer_load_dwordx4 v41, s[8:11], s75 offen offset:1024  lds
 v_mfma_f32_16x16x32_bf16 a[40:43], v[84:87], a[152:155], a[40:43]
 ds_read_b64_tr_b16 v[74:75], v57 offset:4096
 v_mfma_f32_16x16x32_bf16 a[44:47], v[84:87], a[156:159], a[44:47]
 v_mfma_f32_16x16x32_bf16 a[44:47], v[80:83], a[140:143], a[44:47]
 s_waitcnt lgkmcnt(6)
 v_mfma_f32_16x16x32_bf16 a[60:63], v[88:91], a[140:143], a[60:63]
 ds_read_b64_tr_b16 v[76:77], v57 offset:8192
 buffer_load_dwordx4 a[220:223], v7, s[20:23], s42 offen offset:1024 sc1
 v_mfma_f32_16x16x32_bf16 a[60:63], v[92:95], a[156:159], a[60:63]
 ds_read_b64_tr_b16 v[78:79], v57 offset:12288
 v_mfma_f32_16x16x32_bf16 a[56:59], v[92:95], a[152:155], a[56:59]
 v_mfma_f32_16x16x32_bf16 a[56:59], v[88:91], a[136:139], a[56:59]
 v_mfma_f32_16x16x32_bf16 a[52:55], v[88:91], a[132:135], a[52:55]
 ds_read_b64_tr_b16 v[80:81], v58
 v_mfma_f32_16x16x32_bf16 a[52:55], v[92:95], a[148:151], a[52:55]
 ds_read_b64_tr_b16 v[82:83], v58 offset:4096
 v_mfma_f32_16x16x32_bf16 a[48:51], v[92:95], a[144:147], a[48:51]
 v_mfma_f32_16x16x32_bf16 a[48:51], v[88:91], a[128:131], a[48:51]
 s_waitcnt lgkmcnt(6)
 v_mfma_f32_16x16x32_bf16 a[64:67], v[64:67], a[128:131], a[64:67]
 ds_read_b64_tr_b16 v[84:85], v58 offset:8192
 buffer_load_dwordx4 a[224:227], v4, s[20:23], s42 offen offset:2048 sc1
 v_mfma_f32_16x16x32_bf16 a[64:67], v[68:71], a[144:147], a[64:67]
 ds_read_b64_tr_b16 v[86:87], v58 offset:12288
 v_mfma_f32_16x16x32_bf16 a[68:71], v[68:71], a[148:151], a[68:71]
 v_mfma_f32_16x16x32_bf16 a[68:71], v[64:67], a[132:135], a[68:71]
 v_mfma_f32_16x16x32_bf16 a[72:75], v[64:67], a[136:139], a[72:75]
 ds_read_b64_tr_b16 v[88:89], v59
 buffer_load_dwordx4 v42, s[8:11], s75 offen offset:2048  lds
 v_mfma_f32_16x16x32_bf16 a[72:75], v[68:71], a[152:155], a[72:75]
 ds_read_b64_tr_b16 v[90:91], v59 offset:4096
 v_mfma_f32_16x16x32_bf16 a[76:79], v[68:71], a[156:159], a[76:79]
 v_mfma_f32_16x16x32_bf16 a[76:79], v[64:67], a[140:143], a[76:79]
 s_waitcnt lgkmcnt(6)
 v_mfma_f32_16x16x32_bf16 a[92:95], v[72:75], a[140:143], a[92:95]
 ds_read_b64_tr_b16 v[92:93], v59 offset:8192
 buffer_load_dwordx4 a[228:231], v5, s[20:23], s42 offen offset:2048 sc1
 v_mfma_f32_16x16x32_bf16 a[92:95], v[76:79], a[156:159], a[92:95]
 ds_read_b64_tr_b16 v[94:95], v59 offset:12288
 v_mfma_f32_16x16x32_bf16 a[88:91], v[76:79], a[152:155], a[88:91]
 v_mfma_f32_16x16x32_bf16 a[88:91], v[72:75], a[136:139], a[88:91]
 v_mfma_f32_16x16x32_bf16 a[84:87], v[72:75], a[132:135], a[84:87]
 ds_read_b64_tr_b16 v[64:65], v52 offset:16384
 v_mfma_f32_16x16x32_bf16 a[84:87], v[76:79], a[148:151], a[84:87]
 ds_read_b64_tr_b16 v[66:67], v52 offset:20480
 v_mfma_f32_16x16x32_bf16 a[80:83], v[76:79], a[144:147], a[80:83]
 v_mfma_f32_16x16x32_bf16 a[80:83], v[72:75], a[128:131], a[80:83]
 s_waitcnt lgkmcnt(6)
 v_mfma_f32_16x16x32_bf16 a[96:99], v[80:83], a[128:131], a[96:99]
 ds_read_b64_tr_b16 v[68:69], v52 offset:24576
 buffer_load_dwordx4 a[232:235], v6, s[20:23], s42 offen offset:2048 sc1
 v_mfma_f32_16x16x32_bf16 a[96:99], v[84:87], a[144:147], a[96:99]
 ds_read_b64_tr_b16 v[70:71], v52 offset:28672
 v_mfma_f32_16x16x32_bf16 a[100:103], v[84:87], a[148:151], a[100:103]
 v_mfma_f32_16x16x32_bf16 a[100:103], v[80:83], a[132:135], a[100:103]
 v_mfma_f32_16x16x32_bf16 a[104:107], v[80:83], a[136:139], a[104:107]
 ds_read_b64_tr_b16 v[72:73], v53 offset:16384
 buffer_load_dwordx4 v43, s[8:11], s75 offen offset:3072  lds
 v_mfma_f32_16x16x32_bf16 a[104:107], v[84:87], a[152:155], a[104:107]
 ds_read_b64_tr_b16 v[74:75], v53 offset:20480
 v_mfma_f32_16x16x32_bf16 a[108:111], v[84:87], a[156:159], a[108:111]
 v_mfma_f32_16x16x32_bf16 a[108:111], v[80:83], a[140:143], a[108:111]
 s_waitcnt lgkmcnt(6)
 v_mfma_f32_16x16x32_bf16 a[124:127], v[88:91], a[140:143], a[124:127]
 ds_read_b64_tr_b16 v[76:77], v53 offset:24576
 buffer_load_dwordx4 a[236:239], v7, s[20:23], s42 offen offset:2048 sc1
 v_mfma_f32_16x16x32_bf16 a[124:127], v[92:95], a[156:159], a[124:127]
 ds_read_b64_tr_b16 v[78:79], v53 offset:28672
 v_mfma_f32_16x16x32_bf16 a[120:123], v[92:95], a[152:155], a[120:123]
 v_mfma_f32_16x16x32_bf16 a[120:123], v[88:91], a[136:139], a[120:123]
 v_mfma_f32_16x16x32_bf16 a[116:119], v[88:91], a[132:135], a[116:119]
 ds_read_b64_tr_b16 v[80:81], v54 offset:16384
 v_mfma_f32_16x16x32_bf16 a[116:119], v[92:95], a[148:151], a[116:119]
 ds_read_b64_tr_b16 v[82:83], v54 offset:20480
 v_mfma_f32_16x16x32_bf16 a[112:115], v[92:95], a[144:147], a[112:115]
 v_mfma_f32_16x16x32_bf16 a[112:115], v[88:91], a[128:131], a[112:115]
 s_waitcnt lgkmcnt(6)
 s_waitcnt vmcnt(30)
 v_mfma_f32_16x16x32_bf16 a[0:3], v[64:67], a[160:163], a[0:3]
 ds_read_b64_tr_b16 v[84:85], v54 offset:24576
 buffer_load_dwordx4 a[240:243], v4, s[20:23], s42 offen offset:3072 sc1
 s_waitcnt vmcnt(25)
 v_mfma_f32_16x16x32_bf16 a[0:3], v[68:71], a[176:179], a[0:3]
 ds_read_b64_tr_b16 v[86:87], v54 offset:28672
 s_waitcnt vmcnt(23)
 v_mfma_f32_16x16x32_bf16 a[4:7], v[68:71], a[180:183], a[4:7]
 v_mfma_f32_16x16x32_bf16 a[4:7], v[64:67], a[164:167], a[4:7]
 v_mfma_f32_16x16x32_bf16 a[8:11], v[64:67], a[168:171], a[8:11]
 ds_read_b64_tr_b16 v[88:89], v55 offset:16384
 s_add_u32 m0, s79, 4096
 s_waitcnt vmcnt(22)
 v_mfma_f32_16x16x32_bf16 a[8:11], v[68:71], a[184:187], a[8:11]
 ds_read_b64_tr_b16 v[90:91], v55 offset:20480
 s_waitcnt vmcnt(20)
 v_mfma_f32_16x16x32_bf16 a[12:15], v[68:71], a[188:191], a[12:15]
 buffer_load_dwordx4 v44, s[8:11], s75 offen  lds
 v_mfma_f32_16x16x32_bf16 a[12:15], v[64:67], a[172:175], a[12:15]
 s_waitcnt lgkmcnt(6)
 v_mfma_f32_16x16x32_bf16 a[28:31], v[72:75], a[172:175], a[28:31]
 ds_read_b64_tr_b16 v[92:93], v55 offset:24576
 buffer_load_dwordx4 a[244:247], v5, s[20:23], s42 offen offset:3072 sc1
 v_mfma_f32_16x16x32_bf16 a[28:31], v[76:79], a[188:191], a[28:31]
 ds_read_b64_tr_b16 v[94:95], v55 offset:28672
 v_mfma_f32_16x16x32_bf16 a[24:27], v[76:79], a[184:187], a[24:27]
 v_mfma_f32_16x16x32_bf16 a[24:27], v[72:75], a[168:171], a[24:27]
 v_mfma_f32_16x16x32_bf16 a[20:23], v[72:75], a[164:167], a[20:23]
 ds_read_b64_tr_b16 v[64:65], v56 offset:16384
 v_mfma_f32_16x16x32_bf16 a[20:23], v[76:79], a[180:183], a[20:23]
 ds_read_b64_tr_b16 v[66:67], v56 offset:20480
 v_mfma_f32_16x16x32_bf16 a[16:19], v[76:79], a[176:179], a[16:19]
 v_mfma_f32_16x16x32_bf16 a[16:19], v[72:75], a[160:163], a[16:19]
 s_waitcnt lgkmcnt(6)
 v_mfma_f32_16x16x32_bf16 a[32:35], v[80:83], a[160:163], a[32:35]
 ds_read_b64_tr_b16 v[68:69], v56 offset:24576
 buffer_load_dwordx4 a[248:251], v6, s[20:23], s42 offen offset:3072 sc1
 v_mfma_f32_16x16x32_bf16 a[32:35], v[84:87], a[176:179], a[32:35]
 ds_read_b64_tr_b16 v[70:71], v56 offset:28672
 v_mfma_f32_16x16x32_bf16 a[36:39], v[84:87], a[180:183], a[36:39]
 v_mfma_f32_16x16x32_bf16 a[36:39], v[80:83], a[164:167], a[36:39]
 v_mfma_f32_16x16x32_bf16 a[40:43], v[80:83], a[168:171], a[40:43]
 ds_read_b64_tr_b16 v[72:73], v57 offset:16384
 buffer_load_dwordx4 v45, s[8:11], s75 offen offset:1024  lds
 v_mfma_f32_16x16x32_bf16 a[40:43], v[84:87], a[184:187], a[40:43]
 ds_read_b64_tr_b16 v[74:75], v57 offset:20480
 v_mfma_f32_16x16x32_bf16 a[44:47], v[84:87], a[188:191], a[44:47]
 v_mfma_f32_16x16x32_bf16 a[44:47], v[80:83], a[172:175], a[44:47]
 s_waitcnt lgkmcnt(6)
 v_mfma_f32_16x16x32_bf16 a[60:63], v[88:91], a[172:175], a[60:63]
 ds_read_b64_tr_b16 v[76:77], v57 offset:24576
 buffer_load_dwordx4 a[252:255], v7, s[20:23], s42 offen offset:3072 sc1
 v_mfma_f32_16x16x32_bf16 a[60:63], v[92:95], a[188:191], a[60:63]
 ds_read_b64_tr_b16 v[78:79], v57 offset:28672
 s_add_u32 s42, s42, 4096
 v_mfma_f32_16x16x32_bf16 a[56:59], v[92:95], a[184:187], a[56:59]
 v_mfma_f32_16x16x32_bf16 a[56:59], v[88:91], a[168:171], a[56:59]
 v_mfma_f32_16x16x32_bf16 a[52:55], v[88:91], a[164:167], a[52:55]
 ds_read_b64_tr_b16 v[80:81], v58 offset:16384
 v_mfma_f32_16x16x32_bf16 a[52:55], v[92:95], a[180:183], a[52:55]
 ds_read_b64_tr_b16 v[82:83], v58 offset:20480
 v_mfma_f32_16x16x32_bf16 a[48:51], v[92:95], a[176:179], a[48:51]
 v_mfma_f32_16x16x32_bf16 a[48:51], v[88:91], a[160:163], a[48:51]
 s_waitcnt lgkmcnt(6)
 v_mfma_f32_16x16x32_bf16 a[64:67], v[64:67], a[160:163], a[64:67]
 ds_read_b64_tr_b16 v[84:85], v58 offset:24576
 buffer_load_dwordx4 a[128:131], v4, s[20:23], s42 offen sc1
 v_mfma_f32_16x16x32_bf16 a[64:67], v[68:71], a[176:179], a[64:67]
 ds_read_b64_tr_b16 v[86:87], v58 offset:28672
 v_mfma_f32_16x16x32_bf16 a[68:71], v[68:71], a[180:183], a[68:71]
 v_mfma_f32_16x16x32_bf16 a[68:71], v[64:67], a[164:167], a[68:71]
 v_mfma_f32_16x16x32_bf16 a[72:75], v[64:67], a[168:171], a[72:75]
 ds_read_b64_tr_b16 v[88:89], v59 offset:16384
 buffer_load_dwordx4 v46, s[8:11], s75 offen offset:2048  lds
 v_mfma_f32_16x16x32_bf16 a[72:75], v[68:71], a[184:187], a[72:75]
 ds_read_b64_tr_b16 v[90:91], v59 offset:20480
 v_mfma_f32_16x16x32_bf16 a[76:79], v[68:71], a[188:191], a[76:79]
 v_mfma_f32_16x16x32_bf16 a[76:79], v[64:67], a[172:175], a[76:79]
 s_waitcnt lgkmcnt(6)
 v_mfma_f32_16x16x32_bf16 a[92:95], v[72:75], a[172:175], a[92:95]
 ds_read_b64_tr_b16 v[92:93], v59 offset:24576
 buffer_load_dwordx4 a[132:135], v5, s[20:23], s42 offen sc1
 v_mfma_f32_16x16x32_bf16 a[92:95], v[76:79], a[188:191], a[92:95]
 ds_read_b64_tr_b16 v[94:95], v59 offset:28672
 v_mfma_f32_16x16x32_bf16 a[88:91], v[76:79], a[184:187], a[88:91]
 v_mfma_f32_16x16x32_bf16 a[88:91], v[72:75], a[168:171], a[88:91]
 s_waitcnt vmcnt(23)
 s_barrier
 v_mfma_f32_16x16x32_bf16 a[84:87], v[72:75], a[164:167], a[84:87]
 ds_read_b64_tr_b16 v[64:65], v52 offset:32768
 v_mfma_f32_16x16x32_bf16 a[84:87], v[76:79], a[180:183], a[84:87]
 ds_read_b64_tr_b16 v[66:67], v52 offset:36864
 v_mfma_f32_16x16x32_bf16 a[80:83], v[76:79], a[176:179], a[80:83]
 s_cmp_eq_u32 s36, 1
 s_cbranch_scc0 C_df_79
 buffer_store_dwordx2 v[2:3], v21, s[56:59], 0 offen sc1
C_df_79:
 v_mfma_f32_16x16x32_bf16 a[80:83], v[72:75], a[160:163], a[80:83]
 s_waitcnt lgkmcnt(6)
 v_mfma_f32_16x16x32_bf16 a[96:99], v[80:83], a[160:163], a[96:99]
 ds_read_b64_tr_b16 v[68:69], v52 offset:40960
 buffer_load_dwordx4 a[136:139], v6, s[20:23], s42 offen sc1
 v_mfma_f32_16x16x32_bf16 a[96:99], v[84:87], a[176:179], a[96:99]
 ds_read_b64_tr_b16 v[70:71], v52 offset:45056
 v_mfma_f32_16x16x32_bf16 a[100:103], v[84:87], a[180:183], a[100:103]
 v_mfma_f32_16x16x32_bf16 a[100:103], v[80:83], a[164:167], a[100:103]
 v_mfma_f32_16x16x32_bf16 a[104:107], v[80:83], a[168:171], a[104:107]
 ds_read_b64_tr_b16 v[72:73], v53 offset:32768
 buffer_load_dwordx4 v47, s[8:11], s75 offen offset:3072  lds
 v_mfma_f32_16x16x32_bf16 a[104:107], v[84:87], a[184:187], a[104:107]
 ds_read_b64_tr_b16 v[74:75], v53 offset:36864
 s_add_u32 s75, s75, 262144
 v_mfma_f32_16x16x32_bf16 a[108:111], v[84:87], a[188:191], a[108:111]
 v_mfma_f32_16x16x32_bf16 a[108:111], v[80:83], a[172:175], a[108:111]
 s_waitcnt lgkmcnt(6)
 v_mfma_f32_16x16x32_bf16 a[124:127], v[88:91], a[172:175], a[124:127]
 ds_read_b64_tr_b16 v[76:77], v53 offset:40960
 buffer_load_dwordx4 a[140:143], v7, s[20:23], s42 offen sc1
 v_mfma_f32_16x16x32_bf16 a[124:127], v[92:95], a[188:191], a[124:127]
 ds_read_b64_tr_b16 v[78:79], v53 offset:45056
 buffer_load_dword v61, v0, s[16:19], 0 offen
 v_mfma_f32_16x16x32_bf16 a[120:123], v[92:95], a[184:187], a[120:123]
 v_mfma_f32_16x16x32_bf16 a[120:123], v[88:91], a[168:171], a[120:123]
 v_mfma_f32_16x16x32_bf16 a[116:119], v[88:91], a[164:167], a[116:119]
 ds_read_b64_tr_b16 v[80:81], v54 offset:32768
 v_mfma_f32_16x16x32_bf16 a[116:119], v[92:95], a[180:183], a[116:119]
 ds_read_b64_tr_b16 v[82:83], v54 offset:36864
 v_mfma_f32_16x16x32_bf16 a[112:115], v[92:95], a[176:179], a[112:115]
 v_mfma_f32_16x16x32_bf16 a[112:115], v[88:91], a[160:163], a[112:115]
 s_waitcnt lgkmcnt(6)
 v_mfma_f32_16x16x32_bf16 a[0:3], v[64:67], a[192:195], a[0:3]
 ds_read_b64_tr_b16 v[84:85], v54 offset:40960
 buffer_load_dwordx4 a[144:147], v4, s[20:23], s42 offen offset:1024 sc1
 s_waitcnt vmcnt(25)
 v_mfma_f32_16x16x32_bf16 a[0:3], v[68:71], a[208:211], a[0:3]
 ds_read_b64_tr_b16 v[86:87], v54 offset:45056
 s_waitcnt vmcnt(23)
 v_mfma_f32_16x16x32_bf16 a[4:7], v[68:71], a[212:215], a[4:7]
 v_mfma_f32_16x16x32_bf16 a[4:7], v[64:67], a[196:199], a[4:7]
 v_mfma_f32_16x16x32_bf16 a[8:11], v[64:67], a[200:203], a[8:11]
 ds_read_b64_tr_b16 v[88:89], v55 offset:32768
 s_add_u32 m0, s79, 32768
 s_waitcnt vmcnt(22)
 v_mfma_f32_16x16x32_bf16 a[8:11], v[68:71], a[216:219], a[8:11]
 ds_read_b64_tr_b16 v[90:91], v55 offset:36864
 s_waitcnt vmcnt(20)
 v_mfma_f32_16x16x32_bf16 a[12:15], v[68:71], a[220:223], a[12:15]
 buffer_load_dwordx4 v40, s[8:11], s75 offen  lds
 v_mfma_f32_16x16x32_bf16 a[12:15], v[64:67], a[204:207], a[12:15]
 s_waitcnt lgkmcnt(6)
 v_mfma_f32_16x16x32_bf16 a[28:31], v[72:75], a[204:207], a[28:31]
 ds_read_b64_tr_b16 v[92:93], v55 offset:40960
 buffer_load_dwordx4 a[148:151], v5, s[20:23], s42 offen offset:1024 sc1
 v_mfma_f32_16x16x32_bf16 a[28:31], v[76:79], a[220:223], a[28:31]
 ds_read_b64_tr_b16 v[94:95], v55 offset:45056
 v_mfma_f32_16x16x32_bf16 a[24:27], v[76:79], a[216:219], a[24:27]
 v_mfma_f32_16x16x32_bf16 a[24:27], v[72:75], a[200:203], a[24:27]
 v_mfma_f32_16x16x32_bf16 a[20:23], v[72:75], a[196:199], a[20:23]
 ds_read_b64_tr_b16 v[64:65], v56 offset:32768
 v_mfma_f32_16x16x32_bf16 a[20:23], v[76:79], a[212:215], a[20:23]
 ds_read_b64_tr_b16 v[66:67], v56 offset:36864
 v_mfma_f32_16x16x32_bf16 a[16:19], v[76:79], a[208:211], a[16:19]
 v_mfma_f32_16x16x32_bf16 a[16:19], v[72:75], a[192:195], a[16:19]
 s_waitcnt lgkmcnt(6)
 v_mfma_f32_16x16x32_bf16 a[32:35], v[80:83], a[192:195], a[32:35]
 ds_read_b64_tr_b16 v[68:69], v56 offset:40960
 buffer_load_dwordx4 a[152:155], v6, s[20:23], s42 offen offset:1024 sc1
 v_mfma_f32_16x16x32_bf16 a[32:35], v[84:87], a[208:211], a[32:35]
 ds_read_b64_tr_b16 v[70:71], v56 offset:45056
 v_mfma_f32_16x16x32_bf16 a[36:39], v[84:87], a[212:215], a[36:39]
 v_mfma_f32_16x16x32_bf16 a[36:39], v[80:83], a[196:199], a[36:39]
 v_mfma_f32_16x16x32_bf16 a[40:43], v[80:83], a[200:203], a[40:43]
 ds_read_b64_tr_b16 v[72:73], v57 offset:32768
 buffer_load_dwordx4 v41, s[8:11], s75 offen offset:1024  lds
 v_mfma_f32_16x16x32_bf16 a[40:43], v[84:87], a[216:219], a[40:43]
 ds_read_b64_tr_b16 v[74:75], v57 offset:36864
 v_mfma_f32_16x16x32_bf16 a[44:47], v[84:87], a[220:223], a[44:47]
 v_mfma_f32_16x16x32_bf16 a[44:47], v[80:83], a[204:207], a[44:47]
 s_waitcnt lgkmcnt(6)
 v_mfma_f32_16x16x32_bf16 a[60:63], v[88:91], a[204:207], a[60:63]
 ds_read_b64_tr_b16 v[76:77], v57 offset:40960
 buffer_load_dwordx4 a[156:159], v7, s[20:23], s42 offen offset:1024 sc1
 v_mfma_f32_16x16x32_bf16 a[60:63], v[92:95], a[220:223], a[60:63]
 ds_read_b64_tr_b16 v[78:79], v57 offset:45056
 v_mfma_f32_16x16x32_bf16 a[56:59], v[92:95], a[216:219], a[56:59]
 v_mfma_f32_16x16x32_bf16 a[56:59], v[88:91], a[200:203], a[56:59]
 v_mfma_f32_16x16x32_bf16 a[52:55], v[88:91], a[196:199], a[52:55]
 ds_read_b64_tr_b16 v[80:81], v58 offset:32768
 v_mfma_f32_16x16x32_bf16 a[52:55], v[92:95], a[212:215], a[52:55]
 ds_read_b64_tr_b16 v[82:83], v58 offset:36864
 v_mfma_f32_16x16x32_bf16 a[48:51], v[92:95], a[208:211], a[48:51]
 v_mfma_f32_16x16x32_bf16 a[48:51], v[88:91], a[192:195], a[48:51]
 s_waitcnt lgkmcnt(6)
 v_mfma_f32_16x16x32_bf16 a[64:67], v[64:67], a[192:195], a[64:67]
 ds_read_b64_tr_b16 v[84:85], v58 offset:40960
 buffer_load_dwordx4 a[160:163], v4, s[20:23], s42 offen offset:2048 sc1
 v_mfma_f32_16x16x32_bf16 a[64:67], v[68:71], a[208:211], a[64:67]
 ds_read_b64_tr_b16 v[86:87], v58 offset:45056
 v_mfma_f32_16x16x32_bf16 a[68:71], v[68:71], a[212:215], a[68:71]
 v_mfma_f32_16x16x32_bf16 a[68:71], v[64:67], a[196:199], a[68:71]
 v_mfma_f32_16x16x32_bf16 a[72:75], v[64:67], a[200:203], a[72:75]
 ds_read_b64_tr_b16 v[88:89], v59 offset:32768
 buffer_load_dwordx4 v42, s[8:11], s75 offen offset:2048  lds
 v_mfma_f32_16x16x32_bf16 a[72:75], v[68:71], a[216:219], a[72:75]
 ds_read_b64_tr_b16 v[90:91], v59 offset:36864
 v_mfma_f32_16x16x32_bf16 a[76:79], v[68:71], a[220:223], a[76:79]
 v_mfma_f32_16x16x32_bf16 a[76:79], v[64:67], a[204:207], a[76:79]
 s_waitcnt lgkmcnt(6)
 v_mfma_f32_16x16x32_bf16 a[92:95], v[72:75], a[204:207], a[92:95]
 ds_read_b64_tr_b16 v[92:93], v59 offset:40960
 buffer_load_dwordx4 a[164:167], v5, s[20:23], s42 offen offset:2048 sc1
 v_mfma_f32_16x16x32_bf16 a[92:95], v[76:79], a[220:223], a[92:95]
 ds_read_b64_tr_b16 v[94:95], v59 offset:45056
 v_mfma_f32_16x16x32_bf16 a[88:91], v[76:79], a[216:219], a[88:91]
 v_mfma_f32_16x16x32_bf16 a[88:91], v[72:75], a[200:203], a[88:91]
 v_mfma_f32_16x16x32_bf16 a[84:87], v[72:75], a[196:199], a[84:87]
 ds_read_b64_tr_b16 v[64:65], v52 offset:49152
 v_mfma_f32_16x16x32_bf16 a[84:87], v[76:79], a[212:215], a[84:87]
 ds_read_b64_tr_b16 v[66:67], v52 offset:53248
 v_mfma_f32_16x16x32_bf16 a[80:83], v[76:79], a[208:211], a[80:83]
 v_mfma_f32_16x16x32_bf16 a[80:83], v[72:75], a[192:195], a[80:83]
 s_waitcnt lgkmcnt(6)
 v_mfma_f32_16x16x32_bf16 a[96:99], v[80:83], a[192:195], a[96:99]
 ds_read_b64_tr_b16 v[68:69], v52 offset:57344
 buffer_load_dwordx4 a[168:171], v6, s[20:23], s42 offen offset:2048 sc1
 v_mfma_f32_16x16x32_bf16 a[96:99], v[84:87], a[208:211], a[96:99]
 ds_read_b64_tr_b16 v[70:71], v52 offset:61440
 v_mfma_f32_16x16x32_bf16 a[100:103], v[84:87], a[212:215], a[100:103]
 v_xor_b32 v52, s49, v52
 v_mfma_f32_16x16x32_bf16 a[100:103], v[80:83], a[196:199], a[100:103]
 v_mfma_f32_16x16x32_bf16 a[104:107], v[80:83], a[200:203], a[104:107]
 ds_read_b64_tr_b16 v[72:73], v53 offset:49152
 buffer_load_dwordx4 v43, s[8:11], s75 offen offset:3072  lds
 v_mfma_f32_16x16x32_bf16 a[104:107], v[84:87], a[216:219], a[104:107]
 ds_read_b64_tr_b16 v[74:75], v53 offset:53248
 v_mfma_f32_16x16x32_bf16 a[108:111], v[84:87], a[220:223], a[108:111]
 v_mfma_f32_16x16x32_bf16 a[108:111], v[80:83], a[204:207], a[108:111]
 s_waitcnt lgkmcnt(6)
 v_mfma_f32_16x16x32_bf16 a[124:127], v[88:91], a[204:207], a[124:127]
 ds_read_b64_tr_b16 v[76:77], v53 offset:57344
 buffer_load_dwordx4 a[172:175], v7, s[20:23], s42 offen offset:2048 sc1
 v_mfma_f32_16x16x32_bf16 a[124:127], v[92:95], a[220:223], a[124:127]
 ds_read_b64_tr_b16 v[78:79], v53 offset:61440
 v_mfma_f32_16x16x32_bf16 a[120:123], v[92:95], a[216:219], a[120:123]
 v_xor_b32 v53, s49, v53
 v_mfma_f32_16x16x32_bf16 a[120:123], v[88:91], a[200:203], a[120:123]
 v_mfma_f32_16x16x32_bf16 a[116:119], v[88:91], a[196:199], a[116:119]
 ds_read_b64_tr_b16 v[80:81], v54 offset:49152
 v_mfma_f32_16x16x32_bf16 a[116:119], v[92:95], a[212:215], a[116:119]
 ds_read_b64_tr_b16 v[82:83], v54 offset:53248
 v_mfma_f32_16x16x32_bf16 a[112:115], v[92:95], a[208:211], a[112:115]
 v_mfma_f32_16x16x32_bf16 a[112:115], v[88:91], a[192:195], a[112:115]
 s_waitcnt lgkmcnt(6)
 s_waitcnt vmcnt(30)
 v_mfma_f32_16x16x32_bf16 a[0:3], v[64:67], a[224:227], a[0:3]
 ds_read_b64_tr_b16 v[84:85], v54 offset:57344
 buffer_load_dwordx4 a[176:179], v4, s[20:23], s42 offen offset:3072 sc1
 s_waitcnt vmcnt(25)
 v_mfma_f32_16x16x32_bf16 a[0:3], v[68:71], a[240:243], a[0:3]
 ds_read_b64_tr_b16 v[86:87], v54 offset:61440
 s_waitcnt vmcnt(23)
 v_mfma_f32_16x16x32_bf16 a[4:7], v[68:71], a[244:247], a[4:7]
 v_xor_b32 v54, s49, v54
 v_mfma_f32_16x16x32_bf16 a[4:7], v[64:67], a[228:231], a[4:7]
 v_mfma_f32_16x16x32_bf16 a[8:11], v[64:67], a[232:235], a[8:11]
 ds_read_b64_tr_b16 v[88:89], v55 offset:49152
 s_add_u32 m0, s79, 36864
 s_waitcnt vmcnt(22)
 v_mfma_f32_16x16x32_bf16 a[8:11], v[68:71], a[248:251], a[8:11]
 ds_read_b64_tr_b16 v[90:91], v55 offset:53248
 s_waitcnt vmcnt(20)
 v_mfma_f32_16x16x32_bf16 a[12:15], v[68:71], a[252:255], a[12:15]
 buffer_load_dwordx4 v44, s[8:11], s75 offen  lds
 v_mfma_f32_16x16x32_bf16 a[12:15], v[64:67], a[236:239], a[12:15]
 s_waitcnt lgkmcnt(6)
 v_mfma_f32_16x16x32_bf16 a[28:31], v[72:75], a[236:239], a[28:31]
 ds_read_b64_tr_b16 v[92:93], v55 offset:57344
 buffer_load_dwordx4 a[180:183], v5, s[20:23], s42 offen offset:3072 sc1
 v_mfma_f32_16x16x32_bf16 a[28:31], v[76:79], a[252:255], a[28:31]
 ds_read_b64_tr_b16 v[94:95], v55 offset:61440
 v_mfma_f32_16x16x32_bf16 a[24:27], v[76:79], a[248:251], a[24:27]
 v_xor_b32 v55, s49, v55
 v_mfma_f32_16x16x32_bf16 a[24:27], v[72:75], a[232:235], a[24:27]
 v_mfma_f32_16x16x32_bf16 a[20:23], v[72:75], a[228:231], a[20:23]
 ds_read_b64_tr_b16 v[64:65], v56 offset:49152
 v_mfma_f32_16x16x32_bf16 a[20:23], v[76:79], a[244:247], a[20:23]
 ds_read_b64_tr_b16 v[66:67], v56 offset:53248
 v_mfma_f32_16x16x32_bf16 a[16:19], v[76:79], a[240:243], a[16:19]
 v_mfma_f32_16x16x32_bf16 a[16:19], v[72:75], a[224:227], a[16:19]
 s_waitcnt lgkmcnt(6)
 v_mfma_f32_16x16x32_bf16 a[32:35], v[80:83], a[224:227], a[32:35]
 ds_read_b64_tr_b16 v[68:69], v56 offset:57344
 buffer_load_dwordx4 a[184:187], v6, s[20:23], s42 offen offset:3072 sc1
 v_mfma_f32_16x16x32_bf16 a[32:35], v[84:87], a[240:243], a[32:35]
 ds_read_b64_tr_b16 v[70:71], v56 offset:61440
 v_mfma_f32_16x16x32_bf16 a[36:39], v[84:87], a[244:247], a[36:39]
 v_xor_b32 v56, s49, v56
 v_mfma_f32_16x16x32_bf16 a[36:39], v[80:83], a[228:231], a[36:39]
 v_mfma_f32_16x16x32_bf16 a[40:43], v[80:83], a[232:235], a[40:43]
 ds_read_b64_tr_b16 v[72:73], v57 offset:49152
 buffer_load_dwordx4 v45, s[8:11], s75 offen offset:1024  lds
 v_mfma_f32_16x16x32_bf16 a[40:43], v[84:87], a[248:251], a[40:43]
 ds_read_b64_tr_b16 v[74:75], v57 offset:53248
 v_mfma_f32_16x16x32_bf16 a[44:47], v[84:87], a[252:255], a[44:47]
 v_mfma_f32_16x16x32_bf16 a[44:47], v[80:83], a[236:239], a[44:47]
 s_waitcnt lgkmcnt(6)
 v_mfma_f32_16x16x32_bf16 a[60:63], v[88:91], a[236:239], a[60:63]
 ds_read_b64_tr_b16 v[76:77], v57 offset:57344
 buffer_load_dwordx4 a[188:191], v7, s[20:23], s42 offen offset:3072 sc1
 v_mfma_f32_16x16x32_bf16 a[60:63], v[92:95], a[252:255], a[60:63]
 ds_read_b64_tr_b16 v[78:79], v57 offset:61440
 s_add_u32 s42, s42, 4096
 v_mfma_f32_16x16x32_bf16 a[56:59], v[92:95], a[248:251], a[56:59]
 v_xor_b32 v57, s49, v57
 v_mfma_f32_16x16x32_bf16 a[56:59], v[88:91], a[232:235], a[56:59]
 v_mfma_f32_16x16x32_bf16 a[52:55], v[88:91], a[228:231], a[52:55]
 ds_read_b64_tr_b16 v[80:81], v58 offset:49152
 v_mfma_f32_16x16x32_bf16 a[52:55], v[92:95], a[244:247], a[52:55]
 ds_read_b64_tr_b16 v[82:83], v58 offset:53248
 v_mfma_f32_16x16x32_bf16 a[48:51], v[92:95], a[240:243], a[48:51]
 v_mfma_f32_16x16x32_bf16 a[48:51], v[88:91], a[224:227], a[48:51]
 s_waitcnt lgkmcnt(6)
 v_mfma_f32_16x16x32_bf16 a[64:67], v[64:67], a[224:227], a[64:67]
 ds_read_b64_tr_b16 v[84:85], v58 offset:57344
 buffer_load_dwordx4 a[192:195], v4, s[20:23], s42 offen sc1
 v_mfma_f32_16x16x32_bf16 a[64:67], v[68:71], a[240:243], a[64:67]
 ds_read_b64_tr_b16 v[86:87], v58 offset:61440
 v_mfma_f32_16x16x32_bf16 a[68:71], v[68:71], a[244:247], a[68:71]
 v_xor_b32 v58, s49, v58
 v_mfma_f32_16x16x32_bf16 a[68:71], v[64:67], a[228:231], a[68:71]
 v_mfma_f32_16x16x32_bf16 a[72:75], v[64:67], a[232:235], a[72:75]
 ds_read_b64_tr_b16 v[88:89], v59 offset:49152
 buffer_load_dwordx4 v46, s[8:11], s75 offen offset:2048  lds
 v_mfma_f32_16x16x32_bf16 a[72:75], v[68:71], a[248:251], a[72:75]
 ds_read_b64_tr_b16 v[90:91], v59 offset:53248
 v_mfma_f32_16x16x32_bf16 a[76:79], v[68:71], a[252:255], a[76:79]
 v_mfma_f32_16x16x32_bf16 a[76:79], v[64:67], a[236:239], a[76:79]
 s_waitcnt lgkmcnt(6)
 v_mfma_f32_16x16x32_bf16 a[92:95], v[72:75], a[236:239], a[92:95]
 ds_read_b64_tr_b16 v[92:93], v59 offset:57344
 buffer_load_dwordx4 a[196:199], v5, s[20:23], s42 offen sc1
 v_mfma_f32_16x16x32_bf16 a[92:95], v[76:79], a[252:255], a[92:95]
 ds_read_b64_tr_b16 v[94:95], v59 offset:61440
 v_mfma_f32_16x16x32_bf16 a[88:91], v[76:79], a[248:251], a[88:91]
 v_xor_b32 v59, s49, v59
 v_mfma_f32_16x16x32_bf16 a[88:91], v[72:75], a[232:235], a[88:91]
 s_waitcnt vmcnt(23)
 s_barrier
 v_mfma_f32_16x16x32_bf16 a[84:87], v[72:75], a[228:231], a[84:87]
 ds_read_b64_tr_b16 v[64:65], v52
 v_mfma_f32_16x16x32_bf16 a[84:87], v[76:79], a[244:247], a[84:87]
 ds_read_b64_tr_b16 v[66:67], v52 offset:4096
 v_mfma_f32_16x16x32_bf16 a[80:83], v[76:79], a[240:243], a[80:83]
 v_mfma_f32_16x16x32_bf16 a[80:83], v[72:75], a[224:227], a[80:83]
 s_waitcnt lgkmcnt(6)
 v_mfma_f32_16x16x32_bf16 a[96:99], v[80:83], a[224:227], a[96:99]
 ds_read_b64_tr_b16 v[68:69], v52 offset:8192
 buffer_load_dwordx4 a[200:203], v6, s[20:23], s42 offen sc1
 v_mfma_f32_16x16x32_bf16 a[96:99], v[84:87], a[240:243], a[96:99]
 ds_read_b64_tr_b16 v[70:71], v52 offset:12288
 v_mfma_f32_16x16x32_bf16 a[100:103], v[84:87], a[244:247], a[100:103]
 v_mfma_f32_16x16x32_bf16 a[100:103], v[80:83], a[228:231], a[100:103]
 v_mfma_f32_16x16x32_bf16 a[104:107], v[80:83], a[232:235], a[104:107]
 ds_read_b64_tr_b16 v[72:73], v53
 buffer_load_dwordx4 v47, s[8:11], s75 offen offset:3072  lds
 v_mfma_f32_16x16x32_bf16 a[104:107], v[84:87], a[248:251], a[104:107]
 ds_read_b64_tr_b16 v[74:75], v53 offset:4096
 s_add_u32 s75, s75, 262144
 v_mfma_f32_16x16x32_bf16 a[108:111], v[84:87], a[252:255], a[108:111]
 v_mfma_f32_16x16x32_bf16 a[108:111], v[80:83], a[236:239], a[108:111]
 s_waitcnt lgkmcnt(6)
 v_mfma_f32_16x16x32_bf16 a[124:127], v[88:91], a[236:239], a[124:127]
 ds_read_b64_tr_b16 v[76:77], v53 offset:8192
 buffer_load_dwordx4 a[204:207], v7, s[20:23], s42 offen sc1
 v_mfma_f32_16x16x32_bf16 a[124:127], v[92:95], a[252:255], a[124:127]
 ds_read_b64_tr_b16 v[78:79], v53 offset:12288
 buffer_load_dword v61, v0, s[16:19], 0 offen
 v_mfma_f32_16x16x32_bf16 a[120:123], v[92:95], a[248:251], a[120:123]
 v_mfma_f32_16x16x32_bf16 a[120:123], v[88:91], a[232:235], a[120:123]
 v_mfma_f32_16x16x32_bf16 a[116:119], v[88:91], a[228:231], a[116:119]
 ds_read_b64_tr_b16 v[80:81], v54
 v_mfma_f32_16x16x32_bf16 a[116:119], v[92:95], a[244:247], a[116:119]
 ds_read_b64_tr_b16 v[82:83], v54 offset:4096
 v_mfma_f32_16x16x32_bf16 a[112:115], v[92:95], a[240:243], a[112:115]
 v_mfma_f32_16x16x32_bf16 a[112:115], v[88:91], a[224:227], a[112:115]
 s_waitcnt lgkmcnt(6)
 v_mfma_f32_16x16x32_bf16 a[0:3], v[64:67], a[128:131], a[0:3]
 ds_read_b64_tr_b16 v[84:85], v54 offset:8192
 buffer_load_dwordx4 a[208:211], v4, s[20:23], s42 offen offset:1024 sc1
 s_waitcnt vmcnt(25)
 v_mfma_f32_16x16x32_bf16 a[0:3], v[68:71], a[144:147], a[0:3]
 ds_read_b64_tr_b16 v[86:87], v54 offset:12288
 s_waitcnt vmcnt(23)
 v_mfma_f32_16x16x32_bf16 a[4:7], v[68:71], a[148:151], a[4:7]
 v_mfma_f32_16x16x32_bf16 a[4:7], v[64:67], a[132:135], a[4:7]
 v_mfma_f32_16x16x32_bf16 a[8:11], v[64:67], a[136:139], a[8:11]
 ds_read_b64_tr_b16 v[88:89], v55
 s_add_u32 m0, s79, 65536
 s_waitcnt vmcnt(22)
 v_mfma_f32_16x16x32_bf16 a[8:11], v[68:71], a[152:155], a[8:11]
 ds_read_b64_tr_b16 v[90:91], v55 offset:4096
 s_waitcnt vmcnt(20)
 v_mfma_f32_16x16x32_bf16 a[12:15], v[68:71], a[156:159], a[12:15]
 buffer_load_dwordx4 v40, s[8:11], s75 offen  lds
 v_mfma_f32_16x16x32_bf16 a[12:15], v[64:67], a[140:143], a[12:15]
 s_waitcnt lgkmcnt(6)
 v_mfma_f32_16x16x32_bf16 a[28:31], v[72:75], a[140:143], a[28:31]
 ds_read_b64_tr_b16 v[92:93], v55 offset:8192
 buffer_load_dwordx4 a[212:215], v5, s[20:23], s42 offen offset:1024 sc1
 v_mfma_f32_16x16x32_bf16 a[28:31], v[76:79], a[156:159], a[28:31]
 ds_read_b64_tr_b16 v[94:95], v55 offset:12288
 v_mfma_f32_16x16x32_bf16 a[24:27], v[76:79], a[152:155], a[24:27]
 v_mfma_f32_16x16x32_bf16 a[24:27], v[72:75], a[136:139], a[24:27]
 v_mfma_f32_16x16x32_bf16 a[20:23], v[72:75], a[132:135], a[20:23]
 ds_read_b64_tr_b16 v[64:65], v56
 v_mfma_f32_16x16x32_bf16 a[20:23], v[76:79], a[148:151], a[20:23]
 ds_read_b64_tr_b16 v[66:67], v56 offset:4096
 v_mfma_f32_16x16x32_bf16 a[16:19], v[76:79], a[144:147], a[16:19]
 v_mfma_f32_16x16x32_bf16 a[16:19], v[72:75], a[128:131], a[16:19]
 s_waitcnt lgkmcnt(6)
 v_mfma_f32_16x16x32_bf16 a[32:35], v[80:83], a[128:131], a[32:35]
 ds_read_b64_tr_b16 v[68:69], v56 offset:8192
 buffer_load_dwordx4 a[216:219], v6, s[20:23], s42 offen offset:1024 sc1
 v_mfma_f32_16x16x32_bf16 a[32:35], v[84:87], a[144:147], a[32:35]
 ds_read_b64_tr_b16 v[70:71], v56 offset:12288
 v_mfma_f32_16x16x32_bf16 a[36:39], v[84:87], a[148:151], a[36:39]
 v_mfma_f32_16x16x32_bf16 a[36:39], v[80:83], a[132:135], a[36:39]
 v_mfma_f32_16x16x32_bf16 a[40:43], v[80:83], a[136:139], a[40:43]
 ds_read_b64_tr_b16 v[72:73], v57
 buffer_load_dwordx4 v41, s[8:11], s75 offen offset:1024  lds
 v_mfma_f32_16x16x32_bf16 a[40:43], v[84:87], a[152:155], a[40:43]
 ds_read_b64_tr_b16 v[74:75], v57 offset:4096
 v_mfma_f32_16x16x32_bf16 a[44:47], v[84:87], a[156:159], a[44:47]
 v_mfma_f32_16x16x32_bf16 a[44:47], v[80:83], a[140:143], a[44:47]
 s_waitcnt lgkmcnt(6)
 v_mfma_f32_16x16x32_bf16 a[60:63], v[88:91], a[140:143], a[60:63]
 ds_read_b64_tr_b16 v[76:77], v57 offset:8192
 buffer_load_dwordx4 a[220:223], v7, s[20:23], s42 offen offset:1024 sc1
 v_mfma_f32_16x16x32_bf16 a[60:63], v[92:95], a[156:159], a[60:63]
 ds_read_b64_tr_b16 v[78:79], v57 offset:12288
 v_mfma_f32_16x16x32_bf16 a[56:59], v[92:95], a[152:155], a[56:59]
 v_mfma_f32_16x16x32_bf16 a[56:59], v[88:91], a[136:139], a[56:59]
 v_mfma_f32_16x16x32_bf16 a[52:55], v[88:91], a[132:135], a[52:55]
 ds_read_b64_tr_b16 v[80:81], v58
 v_mfma_f32_16x16x32_bf16 a[52:55], v[92:95], a[148:151], a[52:55]
 ds_read_b64_tr_b16 v[82:83], v58 offset:4096
 v_mfma_f32_16x16x32_bf16 a[48:51], v[92:95], a[144:147], a[48:51]
 v_mfma_f32_16x16x32_bf16 a[48:51], v[88:91], a[128:131], a[48:51]
 s_waitcnt lgkmcnt(6)
 v_mfma_f32_16x16x32_bf16 a[64:67], v[64:67], a[128:131], a[64:67]
 ds_read_b64_tr_b16 v[84:85], v58 offset:8192
 buffer_load_dwordx4 a[224:227], v4, s[20:23], s42 offen offset:2048 sc1
 v_mfma_f32_16x16x32_bf16 a[64:67], v[68:71], a[144:147], a[64:67]
 ds_read_b64_tr_b16 v[86:87], v58 offset:12288
 v_mfma_f32_16x16x32_bf16 a[68:71], v[68:71], a[148:151], a[68:71]
 v_mfma_f32_16x16x32_bf16 a[68:71], v[64:67], a[132:135], a[68:71]
 v_mfma_f32_16x16x32_bf16 a[72:75], v[64:67], a[136:139], a[72:75]
 ds_read_b64_tr_b16 v[88:89], v59
 buffer_load_dwordx4 v42, s[8:11], s75 offen offset:2048  lds
 v_mfma_f32_16x16x32_bf16 a[72:75], v[68:71], a[152:155], a[72:75]
 ds_read_b64_tr_b16 v[90:91], v59 offset:4096
 v_mfma_f32_16x16x32_bf16 a[76:79], v[68:71], a[156:159], a[76:79]
 v_mfma_f32_16x16x32_bf16 a[76:79], v[64:67], a[140:143], a[76:79]
 s_waitcnt lgkmcnt(6)
 v_mfma_f32_16x16x32_bf16 a[92:95], v[72:75], a[140:143], a[92:95]
 ds_read_b64_tr_b16 v[92:93], v59 offset:8192
 buffer_load_dwordx4 a[228:231], v5, s[20:23], s42 offen offset:2048 sc1
 v_mfma_f32_16x16x32_bf16 a[92:95], v[76:79], a[156:159], a[92:95]
 ds_read_b64_tr_b16 v[94:95], v59 offset:12288
 v_mfma_f32_16x16x32_bf16 a[88:91], v[76:79], a[152:155], a[88:91]
 v_mfma_f32_16x16x32_bf16 a[88:91], v[72:75], a[136:139], a[88:91]
 v_mfma_f32_16x16x32_bf16 a[84:87], v[72:75], a[132:135], a[84:87]
 ds_read_b64_tr_b16 v[64:65], v52 offset:16384
 v_mfma_f32_16x16x32_bf16 a[84:87], v[76:79], a[148:151], a[84:87]
 ds_read_b64_tr_b16 v[66:67], v52 offset:20480
 v_mfma_f32_16x16x32_bf16 a[80:83], v[76:79], a[144:147], a[80:83]
 v_mfma_f32_16x16x32_bf16 a[80:83], v[72:75], a[128:131], a[80:83]
 s_waitcnt lgkmcnt(6)
 v_mfma_f32_16x16x32_bf16 a[96:99], v[80:83], a[128:131], a[96:99]
 ds_read_b64_tr_b16 v[68:69], v52 offset:24576
 buffer_load_dwordx4 a[232:235], v6, s[20:23], s42 offen offset:2048 sc1
 v_mfma_f32_16x16x32_bf16 a[96:99], v[84:87], a[144:147], a[96:99]
 ds_read_b64_tr_b16 v[70:71], v52 offset:28672
 v_mfma_f32_16x16x32_bf16 a[100:103], v[84:87], a[148:151], a[100:103]
 v_mfma_f32_16x16x32_bf16 a[100:103], v[80:83], a[132:135], a[100:103]
 v_mfma_f32_16x16x32_bf16 a[104:107], v[80:83], a[136:139], a[104:107]
 ds_read_b64_tr_b16 v[72:73], v53 offset:16384
 buffer_load_dwordx4 v43, s[8:11], s75 offen offset:3072  lds
 v_mfma_f32_16x16x32_bf16 a[104:107], v[84:87], a[152:155], a[104:107]
 ds_read_b64_tr_b16 v[74:75], v53 offset:20480
 v_mfma_f32_16x16x32_bf16 a[108:111], v[84:87], a[156:159], a[108:111]
 v_mfma_f32_16x16x32_bf16 a[108:111], v[80:83], a[140:143], a[108:111]
 s_waitcnt lgkmcnt(6)
 v_mfma_f32_16x16x32_bf16 a[124:127], v[88:91], a[140:143], a[124:127]
 ds_read_b64_tr_b16 v[76:77], v53 offset:24576
 buffer_load_dwordx4 a[236:239], v7, s[20:23], s42 offen offset:2048 sc1
 v_mfma_f32_16x16x32_bf16 a[124:127], v[92:95], a[156:159], a[124:127]
 ds_read_b64_tr_b16 v[78:79], v53 offset:28672
 v_mfma_f32_16x16x32_bf16 a[120:123], v[92:95], a[152:155], a[120:123]
 v_mfma_f32_16x16x32_bf16 a[120:123], v[88:91], a[136:139], a[120:123]
 v_mfma_f32_16x16x32_bf16 a[116:119], v[88:91], a[132:135], a[116:119]
 ds_read_b64_tr_b16 v[80:81], v54 offset:16384
 v_mfma_f32_16x16x32_bf16 a[116:119], v[92:95], a[148:151], a[116:119]
 ds_read_b64_tr_b16 v[82:83], v54 offset:20480
 v_mfma_f32_16x16x32_bf16 a[112:115], v[92:95], a[144:147], a[112:115]
 v_mfma_f32_16x16x32_bf16 a[112:115], v[88:91], a[128:131], a[112:115]
 s_waitcnt lgkmcnt(6)
 s_waitcnt vmcnt(30)
 v_mfma_f32_16x16x32_bf16 a[0:3], v[64:67], a[160:163], a[0:3]
 ds_read_b64_tr_b16 v[84:85], v54 offset:24576
 buffer_load_dwordx4 a[240:243], v4, s[20:23], s42 offen offset:3072 sc1
 s_waitcnt vmcnt(25)
 v_mfma_f32_16x16x32_bf16 a[0:3], v[68:71], a[176:179], a[0:3]
 ds_read_b64_tr_b16 v[86:87], v54 offset:28672
 s_waitcnt vmcnt(23)
 v_mfma_f32_16x16x32_bf16 a[4:7], v[68:71], a[180:183], a[4:7]
 v_mfma_f32_16x16x32_bf16 a[4:7], v[64:67], a[164:167], a[4:7]
 v_mfma_f32_16x16x32_bf16 a[8:11], v[64:67], a[168:171], a[8:11]
 ds_read_b64_tr_b16 v[88:89], v55 offset:16384
 s_add_u32 m0, s79, 69632
 s_waitcnt vmcnt(22)
 v_mfma_f32_16x16x32_bf16 a[8:11], v[68:71], a[184:187], a[8:11]
 ds_read_b64_tr_b16 v[90:91], v55 offset:20480
 s_waitcnt vmcnt(20)
 v_mfma_f32_16x16x32_bf16 a[12:15], v[68:71], a[188:191], a[12:15]
 buffer_load_dwordx4 v44, s[8:11], s75 offen  lds
 v_mfma_f32_16x16x32_bf16 a[12:15], v[64:67], a[172:175], a[12:15]
 s_waitcnt lgkmcnt(6)
 v_mfma_f32_16x16x32_bf16 a[28:31], v[72:75], a[172:175], a[28:31]
 ds_read_b64_tr_b16 v[92:93], v55 offset:24576
 buffer_load_dwordx4 a[244:247], v5, s[20:23], s42 offen offset:3072 sc1
 v_mfma_f32_16x16x32_bf16 a[28:31], v[76:79], a[188:191], a[28:31]
 ds_read_b64_tr_b16 v[94:95], v55 offset:28672
 v_mfma_f32_16x16x32_bf16 a[24:27], v[76:79], a[184:187], a[24:27]
 v_mfma_f32_16x16x32_bf16 a[24:27], v[72:75], a[168:171], a[24:27]
 v_mfma_f32_16x16x32_bf16 a[20:23], v[72:75], a[164:167], a[20:23]
 ds_read_b64_tr_b16 v[64:65], v56 offset:16384
 v_mfma_f32_16x16x32_bf16 a[20:23], v[76:79], a[180:183], a[20:23]
 ds_read_b64_tr_b16 v[66:67], v56 offset:20480
 v_mfma_f32_16x16x32_bf16 a[16:19], v[76:79], a[176:179], a[16:19]
 v_mfma_f32_16x16x32_bf16 a[16:19], v[72:75], a[160:163], a[16:19]
 s_waitcnt lgkmcnt(6)
 v_mfma_f32_16x16x32_bf16 a[32:35], v[80:83], a[160:163], a[32:35]
 ds_read_b64_tr_b16 v[68:69], v56 offset:24576
 buffer_load_dwordx4 a[248:251], v6, s[20:23], s42 offen offset:3072 sc1
 v_mfma_f32_16x16x32_bf16 a[32:35], v[84:87], a[176:179], a[32:35]
 ds_read_b64_tr_b16 v[70:71], v56 offset:28672
 v_mfma_f32_16x16x32_bf16 a[36:39], v[84:87], a[180:183], a[36:39]
 v_mfma_f32_16x16x32_bf16 a[36:39], v[80:83], a[164:167], a[36:39]
 v_mfma_f32_16x16x32_bf16 a[40:43], v[80:83], a[168:171], a[40:43]
 ds_read_b64_tr_b16 v[72:73], v57 offset:16384
 buffer_load_dwordx4 v45, s[8:11], s75 offen offset:1024  lds
 v_mfma_f32_16x16x32_bf16 a[40:43], v[84:87], a[184:187], a[40:43]
 ds_read_b64_tr_b16 v[74:75], v57 offset:20480
 v_mfma_f32_16x16x32_bf16 a[44:47], v[84:87], a[188:191], a[44:47]
 v_mfma_f32_16x16x32_bf16 a[44:47], v[80:83], a[172:175], a[44:47]
 s_waitcnt lgkmcnt(6)
 v_mfma_f32_16x16x32_bf16 a[60:63], v[88:91], a[172:175], a[60:63]
 ds_read_b64_tr_b16 v[76:77], v57 offset:24576
 buffer_load_dwordx4 a[252:255], v7, s[20:23], s42 offen offset:3072 sc1
 v_mfma_f32_16x16x32_bf16 a[60:63], v[92:95], a[188:191], a[60:63]
 ds_read_b64_tr_b16 v[78:79], v57 offset:28672
 s_add_u32 s42, s42, 4096
 v_mfma_f32_16x16x32_bf16 a[56:59], v[92:95], a[184:187], a[56:59]
 v_mfma_f32_16x16x32_bf16 a[56:59], v[88:91], a[168:171], a[56:59]
 v_mfma_f32_16x16x32_bf16 a[52:55], v[88:91], a[164:167], a[52:55]
 ds_read_b64_tr_b16 v[80:81], v58 offset:16384
 v_mfma_f32_16x16x32_bf16 a[52:55], v[92:95], a[180:183], a[52:55]
 ds_read_b64_tr_b16 v[82:83], v58 offset:20480
 v_mfma_f32_16x16x32_bf16 a[48:51], v[92:95], a[176:179], a[48:51]
 v_mfma_f32_16x16x32_bf16 a[48:51], v[88:91], a[160:163], a[48:51]
 s_waitcnt lgkmcnt(6)
 v_mfma_f32_16x16x32_bf16 a[64:67], v[64:67], a[160:163], a[64:67]
 ds_read_b64_tr_b16 v[84:85], v58 offset:24576
 buffer_load_dwordx4 a[128:131], v4, s[20:23], s42 offen sc1
 v_mfma_f32_16x16x32_bf16 a[64:67], v[68:71], a[176:179], a[64:67]
 ds_read_b64_tr_b16 v[86:87], v58 offset:28672
 v_mfma_f32_16x16x32_bf16 a[68:71], v[68:71], a[180:183], a[68:71]
 v_mfma_f32_16x16x32_bf16 a[68:71], v[64:67], a[164:167], a[68:71]
 v_mfma_f32_16x16x32_bf16 a[72:75], v[64:67], a[168:171], a[72:75]
 ds_read_b64_tr_b16 v[88:89], v59 offset:16384
 buffer_load_dwordx4 v46, s[8:11], s75 offen offset:2048  lds
 v_mfma_f32_16x16x32_bf16 a[72:75], v[68:71], a[184:187], a[72:75]
 ds_read_b64_tr_b16 v[90:91], v59 offset:20480
 v_mfma_f32_16x16x32_bf16 a[76:79], v[68:71], a[188:191], a[76:79]
 v_mfma_f32_16x16x32_bf16 a[76:79], v[64:67], a[172:175], a[76:79]
 s_waitcnt lgkmcnt(6)
 v_mfma_f32_16x16x32_bf16 a[92:95], v[72:75], a[172:175], a[92:95]
 ds_read_b64_tr_b16 v[92:93], v59 offset:24576
 buffer_load_dwordx4 a[132:135], v5, s[20:23], s42 offen sc1
 v_mfma_f32_16x16x32_bf16 a[92:95], v[76:79], a[188:191], a[92:95]
 ds_read_b64_tr_b16 v[94:95], v59 offset:28672
 v_mfma_f32_16x16x32_bf16 a[88:91], v[76:79], a[184:187], a[88:91]
 v_mfma_f32_16x16x32_bf16 a[88:91], v[72:75], a[168:171], a[88:91]
 s_waitcnt vmcnt(23)
 s_barrier
 v_mfma_f32_16x16x32_bf16 a[84:87], v[72:75], a[164:167], a[84:87]
 ds_read_b64_tr_b16 v[64:65], v52 offset:32768
 v_mfma_f32_16x16x32_bf16 a[84:87], v[76:79], a[180:183], a[84:87]
 ds_read_b64_tr_b16 v[66:67], v52 offset:36864
 v_mfma_f32_16x16x32_bf16 a[80:83], v[76:79], a[176:179], a[80:83]
 v_mfma_f32_16x16x32_bf16 a[80:83], v[72:75], a[160:163], a[80:83]
 s_waitcnt lgkmcnt(6)
 v_mfma_f32_16x16x32_bf16 a[96:99], v[80:83], a[160:163], a[96:99]
 ds_read_b64_tr_b16 v[68:69], v52 offset:40960
 buffer_load_dwordx4 a[136:139], v6, s[20:23], s42 offen sc1
 v_mfma_f32_16x16x32_bf16 a[96:99], v[84:87], a[176:179], a[96:99]
 ds_read_b64_tr_b16 v[70:71], v52 offset:45056
 v_mfma_f32_16x16x32_bf16 a[100:103], v[84:87], a[180:183], a[100:103]
 v_mfma_f32_16x16x32_bf16 a[100:103], v[80:83], a[164:167], a[100:103]
 v_mfma_f32_16x16x32_bf16 a[104:107], v[80:83], a[168:171], a[104:107]
 ds_read_b64_tr_b16 v[72:73], v53 offset:32768
 buffer_load_dwordx4 v47, s[8:11], s75 offen offset:3072  lds
 v_mfma_f32_16x16x32_bf16 a[104:107], v[84:87], a[184:187], a[104:107]
 ds_read_b64_tr_b16 v[74:75], v53 offset:36864
 s_add_u32 s75, s75, 262144
 v_mfma_f32_16x16x32_bf16 a[108:111], v[84:87], a[188:191], a[108:111]
 v_mfma_f32_16x16x32_bf16 a[108:111], v[80:83], a[172:175], a[108:111]
 s_waitcnt lgkmcnt(6)
 v_mfma_f32_16x16x32_bf16 a[124:127], v[88:91], a[172:175], a[124:127]
 ds_read_b64_tr_b16 v[76:77], v53 offset:40960
 buffer_load_dwordx4 a[140:143], v7, s[20:23], s42 offen sc1
 v_mfma_f32_16x16x32_bf16 a[124:127], v[92:95], a[188:191], a[124:127]
 ds_read_b64_tr_b16 v[78:79], v53 offset:45056
 buffer_load_dword v61, v0, s[16:19], 0 offen
 v_mfma_f32_16x16x32_bf16 a[120:123], v[92:95], a[184:187], a[120:123]
 v_mfma_f32_16x16x32_bf16 a[120:123], v[88:91], a[168:171], a[120:123]
 v_mfma_f32_16x16x32_bf16 a[116:119], v[88:91], a[164:167], a[116:119]
 ds_read_b64_tr_b16 v[80:81], v54 offset:32768
 v_mfma_f32_16x16x32_bf16 a[116:119], v[92:95], a[180:183], a[116:119]
 ds_read_b64_tr_b16 v[82:83], v54 offset:36864
 v_mfma_f32_16x16x32_bf16 a[112:115], v[92:95], a[176:179], a[112:115]
 v_mfma_f32_16x16x32_bf16 a[112:115], v[88:91], a[160:163], a[112:115]
 s_waitcnt lgkmcnt(6)
 v_mfma_f32_16x16x32_bf16 a[0:3], v[64:67], a[192:195], a[0:3]
 ds_read_b64_tr_b16 v[84:85], v54 offset:40960
 buffer_load_dwordx4 a[144:147], v4, s[20:23], s42 offen offset:1024 sc1
 s_mov_b32 s54, 12582912
 s_waitcnt vmcnt(25)
 v_mfma_f32_16x16x32_bf16 a[0:3], v[68:71], a[208:211], a[0:3]
 ds_read_b64_tr_b16 v[86:87], v54 offset:45056
 s_waitcnt vmcnt(23)
 v_mfma_f32_16x16x32_bf16 a[4:7], v[68:71], a[212:215], a[4:7]
 v_mfma_f32_16x16x32_bf16 a[4:7], v[64:67], a[196:199], a[4:7]
 v_mfma_f32_16x16x32_bf16 a[8:11], v[64:67], a[200:203], a[8:11]
 ds_read_b64_tr_b16 v[88:89], v55 offset:32768
 s_add_u32 m0, s79, 98304
 s_waitcnt vmcnt(22)
 v_mfma_f32_16x16x32_bf16 a[8:11], v[68:71], a[216:219], a[8:11]
 ds_read_b64_tr_b16 v[90:91], v55 offset:36864
 s_waitcnt vmcnt(20)
 v_mfma_f32_16x16x32_bf16 a[12:15], v[68:71], a[220:223], a[12:15]
 buffer_load_dwordx4 v40, s[8:11], s75 offen  lds
 v_mfma_f32_16x16x32_bf16 a[12:15], v[64:67], a[204:207], a[12:15]
 s_waitcnt lgkmcnt(6)
 buffer_load_dwordx4 a[148:151], v5, s[20:23], s42 offen offset:1024 sc1
 v_mfma_f32_16x16x32_bf16 a[28:31], v[72:75], a[204:207], a[28:31]
 ds_read_b64_tr_b16 v[92:93], v55 offset:40960
 v_mfma_f32_16x16x32_bf16 a[28:31], v[76:79], a[220:223], a[28:31]
 ds_read_b64_tr_b16 v[94:95], v55 offset:45056
 v_mfma_f32_16x16x32_bf16 a[24:27], v[76:79], a[216:219], a[24:27]
 v_mfma_f32_16x16x32_bf16 a[24:27], v[72:75], a[200:203], a[24:27]
 v_mfma_f32_16x16x32_bf16 a[20:23], v[72:75], a[196:199], a[20:23]
 ds_read_b64_tr_b16 v[64:65], v56 offset:32768
 buffer_load_dwordx4 v41, s[8:11], s75 offen offset:1024  lds
 v_mfma_f32_16x16x32_bf16 a[20:23], v[76:79], a[212:215], a[20:23]
 ds_read_b64_tr_b16 v[66:67], v56 offset:36864
 v_mfma_f32_16x16x32_bf16 a[16:19], v[76:79], a[208:211], a[16:19]
 buffer_load_dwordx4 a[152:155], v6, s[20:23], s42 offen offset:1024 sc1
 v_mfma_f32_16x16x32_bf16 a[16:19], v[72:75], a[192:195], a[16:19]
 s_waitcnt lgkmcnt(6)
 v_mfma_f32_16x16x32_bf16 a[32:35], v[80:83], a[192:195], a[32:35]
 ds_read_b64_tr_b16 v[68:69], v56 offset:40960
 v_mfma_f32_16x16x32_bf16 a[32:35], v[84:87], a[208:211], a[32:35]
 ds_read_b64_tr_b16 v[70:71], v56 offset:45056
 v_mfma_f32_16x16x32_bf16 a[36:39], v[84:87], a[212:215], a[36:39]
 v_mfma_f32_16x16x32_bf16 a[36:39], v[80:83], a[196:199], a[36:39]
 v_mfma_f32_16x16x32_bf16 a[40:43], v[80:83], a[200:203], a[40:43]
 ds_read_b64_tr_b16 v[72:73], v57 offset:32768
 buffer_load_dwordx4 v42, s[8:11], s75 offen offset:2048  lds
 v_mfma_f32_16x16x32_bf16 a[40:43], v[84:87], a[216:219], a[40:43]
 ds_read_b64_tr_b16 v[74:75], v57 offset:36864
 buffer_load_dwordx4 a[156:159], v7, s[20:23], s42 offen offset:1024 sc1
 v_mfma_f32_16x16x32_bf16 a[44:47], v[84:87], a[220:223], a[44:47]
 v_mfma_f32_16x16x32_bf16 a[44:47], v[80:83], a[204:207], a[44:47]
 s_waitcnt lgkmcnt(6)
 v_mfma_f32_16x16x32_bf16 a[60:63], v[88:91], a[204:207], a[60:63]
 ds_read_b64_tr_b16 v[76:77], v57 offset:40960
 v_mfma_f32_16x16x32_bf16 a[60:63], v[92:95], a[220:223], a[60:63]
 ds_read_b64_tr_b16 v[78:79], v57 offset:45056
 v_mfma_f32_16x16x32_bf16 a[56:59], v[92:95], a[216:219], a[56:59]
 v_mfma_f32_16x16x32_bf16 a[56:59], v[88:91], a[200:203], a[56:59]
 v_mfma_f32_16x16x32_bf16 a[52:55], v[88:91], a[196:199], a[52:55]
 ds_read_b64_tr_b16 v[80:81], v58 offset:32768
 buffer_load_dwordx4 v43, s[8:11], s75 offen offset:3072  lds
 v_mfma_f32_16x16x32_bf16 a[52:55], v[92:95], a[212:215], a[52:55]
 ds_read_b64_tr_b16 v[82:83], v58 offset:36864
 buffer_load_dwordx4 a[160:163], v4, s[20:23], s42 offen offset:2048 sc1
 v_mfma_f32_16x16x32_bf16 a[48:51], v[92:95], a[208:211], a[48:51]
 v_mfma_f32_16x16x32_bf16 a[48:51], v[88:91], a[192:195], a[48:51]
 s_waitcnt lgkmcnt(6)
 v_mfma_f32_16x16x32_bf16 a[64:67], v[64:67], a[192:195], a[64:67]
 ds_read_b64_tr_b16 v[84:85], v58 offset:40960
 v_mfma_f32_16x16x32_bf16 a[64:67], v[68:71], a[208:211], a[64:67]
 ds_read_b64_tr_b16 v[86:87], v58 offset:45056
 buffer_load_dwordx4 a[164:167], v5, s[20:23], s42 offen offset:2048 sc1
 v_mfma_f32_16x16x32_bf16 a[68:71], v[68:71], a[212:215], a[68:71]
 v_mfma_f32_16x16x32_bf16 a[68:71], v[64:67], a[196:199], a[68:71]
 v_mfma_f32_16x16x32_bf16 a[72:75], v[64:67], a[200:203], a[72:75]
 ds_read_b64_tr_b16 v[88:89], v59 offset:32768
 s_add_u32 m0, s79, 102400
 v_mfma_f32_16x16x32_bf16 a[72:75], v[68:71], a[216:219], a[72:75]
 ds_read_b64_tr_b16 v[90:91], v59 offset:36864
 v_mfma_f32_16x16x32_bf16 a[76:79], v[68:71], a[220:223], a[76:79]
 buffer_load_dwordx4 v44, s[8:11], s75 offen  lds
 buffer_load_dwordx4 a[168:171], v6, s[20:23], s42 offen offset:2048 sc1
 v_mfma_f32_16x16x32_bf16 a[76:79], v[64:67], a[204:207], a[76:79]
 s_waitcnt lgkmcnt(6)
 v_mfma_f32_16x16x32_bf16 a[92:95], v[72:75], a[204:207], a[92:95]
 ds_read_b64_tr_b16 v[92:93], v59 offset:40960
 v_mfma_f32_16x16x32_bf16 a[92:95], v[76:79], a[220:223], a[92:95]
 ds_read_b64_tr_b16 v[94:95], v59 offset:45056
 v_mfma_f32_16x16x32_bf16 a[88:91], v[76:79], a[216:219], a[88:91]
 v_mfma_f32_16x16x32_bf16 a[88:91], v[72:75], a[200:203], a[88:91]
 buffer_load_dwordx4 a[172:175], v7, s[20:23], s42 offen offset:2048 sc1
 v_mfma_f32_16x16x32_bf16 a[84:87], v[72:75], a[196:199], a[84:87]
 ds_read_b64_tr_b16 v[64:65], v52 offset:49152
 buffer_load_dwordx4 v45, s[8:11], s75 offen offset:1024  lds
 buffer_load_dwordx2 v[62:63], v23, s[56:59], 0 offen sc1
 v_mfma_f32_16x16x32_bf16 a[84:87], v[76:79], a[212:215], a[84:87]
 ds_read_b64_tr_b16 v[66:67], v52 offset:53248
 v_mfma_f32_16x16x32_bf16 a[80:83], v[76:79], a[208:211], a[80:83]
 v_mfma_f32_16x16x32_bf16 a[80:83], v[72:75], a[192:195], a[80:83]
 s_waitcnt lgkmcnt(6)
 v_mfma_f32_16x16x32_bf16 a[96:99], v[80:83], a[192:195], a[96:99]
 ds_read_b64_tr_b16 v[68:69], v52 offset:57344
 buffer_load_dwordx4 a[176:179], v4, s[20:23], s42 offen offset:3072 sc1
 v_mfma_f32_16x16x32_bf16 a[96:99], v[84:87], a[208:211], a[96:99]
 ds_read_b64_tr_b16 v[70:71], v52 offset:61440
 v_mfma_f32_16x16x32_bf16 a[100:103], v[84:87], a[212:215], a[100:103]
 v_xor_b32 v52, s49, v52
 v_mfma_f32_16x16x32_bf16 a[100:103], v[80:83], a[196:199], a[100:103]
 v_mfma_f32_16x16x32_bf16 a[104:107], v[80:83], a[200:203], a[104:107]
 ds_read_b64_tr_b16 v[72:73], v53 offset:49152
 buffer_load_dwordx4 v46, s[8:11], s75 offen offset:2048  lds
 v_mfma_f32_16x16x32_bf16 a[104:107], v[84:87], a[216:219], a[104:107]
 ds_read_b64_tr_b16 v[74:75], v53 offset:53248
 buffer_load_dwordx4 a[180:183], v5, s[20:23], s42 offen offset:3072 sc1
 v_mfma_f32_16x16x32_bf16 a[108:111], v[84:87], a[220:223], a[108:111]
 v_mfma_f32_16x16x32_bf16 a[108:111], v[80:83], a[204:207], a[108:111]
 s_waitcnt lgkmcnt(6)
 v_mfma_f32_16x16x32_bf16 a[124:127], v[88:91], a[204:207], a[124:127]
 ds_read_b64_tr_b16 v[76:77], v53 offset:57344
 v_mfma_f32_16x16x32_bf16 a[124:127], v[92:95], a[220:223], a[124:127]
 ds_read_b64_tr_b16 v[78:79], v53 offset:61440
 v_mfma_f32_16x16x32_bf16 a[120:123], v[92:95], a[216:219], a[120:123]
 buffer_load_dwordx4 a[184:187], v6, s[20:23], s42 offen offset:3072 sc1
 v_xor_b32 v53, s49, v53
 v_mfma_f32_16x16x32_bf16 a[120:123], v[88:91], a[200:203], a[120:123]
 v_mfma_f32_16x16x32_bf16 a[116:119], v[88:91], a[196:199], a[116:119]
 ds_read_b64_tr_b16 v[80:81], v54 offset:49152
 buffer_load_dwordx4 v47, s[8:11], s75 offen offset:3072  lds
 v_mfma_f32_16x16x32_bf16 a[116:119], v[92:95], a[212:215], a[116:119]
 ds_read_b64_tr_b16 v[82:83], v54 offset:53248
 s_add_u32 s75, s75, 262144
 v_mfma_f32_16x16x32_bf16 a[112:115], v[92:95], a[208:211], a[112:115]
 v_mfma_f32_16x16x32_bf16 a[112:115], v[88:91], a[192:195], a[112:115]
 s_waitcnt lgkmcnt(6)
 buffer_load_dwordx4 a[188:191], v7, s[20:23], s42 offen offset:3072 sc1
 s_waitcnt vmcnt(39)
 v_mfma_f32_16x16x32_bf16 a[0:3], v[64:67], a[224:227], a[0:3]
 ds_read_b64_tr_b16 v[84:85], v54 offset:57344
 s_add_u32 s42, s42, 4096
 s_waitcnt vmcnt(33)
 v_mfma_f32_16x16x32_bf16 a[0:3], v[68:71], a[240:243], a[0:3]
 ds_read_b64_tr_b16 v[86:87], v54 offset:61440
 s_waitcnt vmcnt(31)
 v_mfma_f32_16x16x32_bf16 a[4:7], v[68:71], a[244:247], a[4:7]
 v_xor_b32 v54, s49, v54
 v_mfma_f32_16x16x32_bf16 a[4:7], v[64:67], a[228:231], a[4:7]
 v_mfma_f32_16x16x32_bf16 a[8:11], v[64:67], a[232:235], a[8:11]
 ds_read_b64_tr_b16 v[88:89], v55 offset:49152
 buffer_load_dwordx4 a[192:195], v4, s[20:23], s42 offen sc1
 s_waitcnt vmcnt(31)
 v_mfma_f32_16x16x32_bf16 a[8:11], v[68:71], a[248:251], a[8:11]
 ds_read_b64_tr_b16 v[90:91], v55 offset:53248
 s_waitcnt vmcnt(29)
 v_mfma_f32_16x16x32_bf16 a[12:15], v[68:71], a[252:255], a[12:15]
 v_mfma_f32_16x16x32_bf16 a[12:15], v[64:67], a[236:239], a[12:15]
 s_waitcnt lgkmcnt(6)
 v_mfma_f32_16x16x32_bf16 a[28:31], v[72:75], a[236:239], a[28:31]
 ds_read_b64_tr_b16 v[92:93], v55 offset:57344
 v_mfma_f32_16x16x32_bf16 a[28:31], v[76:79], a[252:255], a[28:31]
 ds_read_b64_tr_b16 v[94:95], v55 offset:61440
 buffer_load_dwordx4 a[196:199], v5, s[20:23], s42 offen sc1
 v_mfma_f32_16x16x32_bf16 a[24:27], v[76:79], a[248:251], a[24:27]
 v_xor_b32 v55, s49, v55
 v_mfma_f32_16x16x32_bf16 a[24:27], v[72:75], a[232:235], a[24:27]
 v_mfma_f32_16x16x32_bf16 a[20:23], v[72:75], a[228:231], a[20:23]
 ds_read_b64_tr_b16 v[64:65], v56 offset:49152
 v_mfma_f32_16x16x32_bf16 a[20:23], v[76:79], a[244:247], a[20:23]
 ds_read_b64_tr_b16 v[66:67], v56 offset:53248
 v_mfma_f32_16x16x32_bf16 a[16:19], v[76:79], a[240:243], a[16:19]
 buffer_load_dwordx4 a[200:203], v6, s[20:23], s42 offen sc1
 v_mfma_f32_16x16x32_bf16 a[16:19], v[72:75], a[224:227], a[16:19]
 s_waitcnt lgkmcnt(6)
 v_mfma_f32_16x16x32_bf16 a[32:35], v[80:83], a[224:227], a[32:35]
 ds_read_b64_tr_b16 v[68:69], v56 offset:57344
 v_mfma_f32_16x16x32_bf16 a[32:35], v[84:87], a[240:243], a[32:35]
 ds_read_b64_tr_b16 v[70:71], v56 offset:61440
 v_mfma_f32_16x16x32_bf16 a[36:39], v[84:87], a[244:247], a[36:39]
 v_xor_b32 v56, s49, v56
 v_mfma_f32_16x16x32_bf16 a[36:39], v[80:83], a[228:231], a[36:39]
 buffer_load_dwordx4 a[204:207], v7, s[20:23], s42 offen sc1
 v_mfma_f32_16x16x32_bf16 a[40:43], v[80:83], a[232:235], a[40:43]
 ds_read_b64_tr_b16 v[72:73], v57 offset:49152
 v_mfma_f32_16x16x32_bf16 a[40:43], v[84:87], a[248:251], a[40:43]
 ds_read_b64_tr_b16 v[74:75], v57 offset:53248
 v_mfma_f32_16x16x32_bf16 a[44:47], v[84:87], a[252:255], a[44:47]
 v_mfma_f32_16x16x32_bf16 a[44:47], v[80:83], a[236:239], a[44:47]
 s_waitcnt lgkmcnt(6)
 v_mfma_f32_16x16x32_bf16 a[60:63], v[88:91], a[236:239], a[60:63]
 ds_read_b64_tr_b16 v[76:77], v57 offset:57344
 buffer_load_dwordx4 a[208:211], v4, s[20:23], s42 offen offset:1024 sc1
 v_mfma_f32_16x16x32_bf16 a[60:63], v[92:95], a[252:255], a[60:63]
 ds_read_b64_tr_b16 v[78:79], v57 offset:61440
 v_mfma_f32_16x16x32_bf16 a[56:59], v[92:95], a[248:251], a[56:59]
 v_xor_b32 v57, s49, v57
 v_mfma_f32_16x16x32_bf16 a[56:59], v[88:91], a[232:235], a[56:59]
 v_mfma_f32_16x16x32_bf16 a[52:55], v[88:91], a[228:231], a[52:55]
 ds_read_b64_tr_b16 v[80:81], v58 offset:49152
 v_mfma_f32_16x16x32_bf16 a[52:55], v[92:95], a[244:247], a[52:55]
 ds_read_b64_tr_b16 v[82:83], v58 offset:53248
 v_mfma_f32_16x16x32_bf16 a[48:51], v[92:95], a[240:243], a[48:51]
 v_mfma_f32_16x16x32_bf16 a[48:51], v[88:91], a[224:227], a[48:51]
 s_waitcnt lgkmcnt(6)
 v_mfma_f32_16x16x32_bf16 a[64:67], v[64:67], a[224:227], a[64:67]
 ds_read_b64_tr_b16 v[84:85], v58 offset:57344
 buffer_load_dwordx4 a[212:215], v5, s[20:23], s42 offen offset:1024 sc1
 v_mfma_f32_16x16x32_bf16 a[64:67], v[68:71], a[240:243], a[64:67]
 ds_read_b64_tr_b16 v[86:87], v58 offset:61440
 v_mfma_f32_16x16x32_bf16 a[68:71], v[68:71], a[244:247], a[68:71]
 v_xor_b32 v58, s49, v58
 v_mfma_f32_16x16x32_bf16 a[68:71], v[64:67], a[228:231], a[68:71]
 v_mfma_f32_16x16x32_bf16 a[72:75], v[64:67], a[232:235], a[72:75]
 ds_read_b64_tr_b16 v[88:89], v59 offset:49152
 v_mfma_f32_16x16x32_bf16 a[72:75], v[68:71], a[248:251], a[72:75]
 ds_read_b64_tr_b16 v[90:91], v59 offset:53248
 v_mfma_f32_16x16x32_bf16 a[76:79], v[68:71], a[252:255], a[76:79]
 v_mfma_f32_16x16x32_bf16 a[76:79], v[64:67], a[236:239], a[76:79]
 s_waitcnt lgkmcnt(6)
 v_mfma_f32_16x16x32_bf16 a[92:95], v[72:75], a[236:239], a[92:95]
 ds_read_b64_tr_b16 v[92:93], v59 offset:57344
 buffer_load_dwordx4 a[216:219], v6, s[20:23], s42 offen offset:1024 sc1
 v_mfma_f32_16x16x32_bf16 a[92:95], v[76:79], a[252:255], a[92:95]
 ds_read_b64_tr_b16 v[94:95], v59 offset:61440
 v_mfma_f32_16x16x32_bf16 a[88:91], v[76:79], a[248:251], a[88:91]
 v_xor_b32 v59, s49, v59
 v_mfma_f32_16x16x32_bf16 a[88:91], v[72:75], a[232:235], a[88:91]
 s_waitcnt vmcnt(30)
 s_barrier
 v_mfma_f32_16x16x32_bf16 a[84:87], v[72:75], a[228:231], a[84:87]
 ds_read_b64_tr_b16 v[64:65], v52
 v_mfma_f32_16x16x32_bf16 a[84:87], v[76:79], a[244:247], a[84:87]
 ds_read_b64_tr_b16 v[66:67], v52 offset:4096
 v_mfma_f32_16x16x32_bf16 a[80:83], v[76:79], a[240:243], a[80:83]
 v_mfma_f32_16x16x32_bf16 a[80:83], v[72:75], a[224:227], a[80:83]
 s_waitcnt lgkmcnt(6)
 v_mfma_f32_16x16x32_bf16 a[96:99], v[80:83], a[224:227], a[96:99]
 ds_read_b64_tr_b16 v[68:69], v52 offset:8192
 buffer_load_dwordx4 a[220:223], v7, s[20:23], s42 offen offset:1024 sc1
 v_mfma_f32_16x16x32_bf16 a[96:99], v[84:87], a[240:243], a[96:99]
 ds_read_b64_tr_b16 v[70:71], v52 offset:12288
 v_mfma_f32_16x16x32_bf16 a[100:103], v[84:87], a[244:247], a[100:103]
 v_mfma_f32_16x16x32_bf16 a[100:103], v[80:83], a[228:231], a[100:103]
 v_mfma_f32_16x16x32_bf16 a[104:107], v[80:83], a[232:235], a[104:107]
 ds_read_b64_tr_b16 v[72:73], v53
 v_mfma_f32_16x16x32_bf16 a[104:107], v[84:87], a[248:251], a[104:107]
 ds_read_b64_tr_b16 v[74:75], v53 offset:4096
 v_mfma_f32_16x16x32_bf16 a[108:111], v[84:87], a[252:255], a[108:111]
 v_mfma_f32_16x16x32_bf16 a[108:111], v[80:83], a[236:239], a[108:111]
 s_waitcnt lgkmcnt(6)
 v_mfma_f32_16x16x32_bf16 a[124:127], v[88:91], a[236:239], a[124:127]
 ds_read_b64_tr_b16 v[76:77], v53 offset:8192
 buffer_load_dword v61, v0, s[16:19], 0 offen
 v_mfma_f32_16x16x32_bf16 a[124:127], v[92:95], a[252:255], a[124:127]
 ds_read_b64_tr_b16 v[78:79], v53 offset:12288
 v_mfma_f32_16x16x32_bf16 a[120:123], v[92:95], a[248:251], a[120:123]
 v_mfma_f32_16x16x32_bf16 a[120:123], v[88:91], a[232:235], a[120:123]
 v_mfma_f32_16x16x32_bf16 a[116:119], v[88:91], a[228:231], a[116:119]
 ds_read_b64_tr_b16 v[80:81], v54
 v_mfma_f32_16x16x32_bf16 a[116:119], v[92:95], a[244:247], a[116:119]
 ds_read_b64_tr_b16 v[82:83], v54 offset:4096
 v_mfma_f32_16x16x32_bf16 a[112:115], v[92:95], a[240:243], a[112:115]
 v_mfma_f32_16x16x32_bf16 a[112:115], v[88:91], a[224:227], a[112:115]
 s_waitcnt lgkmcnt(6)
 v_mfma_f32_16x16x32_bf16 a[0:3], v[64:67], a[128:131], a[0:3]
 ds_read_b64_tr_b16 v[84:85], v54 offset:8192
 buffer_load_dwordx4 a[224:227], v4, s[20:23], s42 offen offset:2048 sc1
 s_waitcnt vmcnt(30)
 v_mfma_f32_16x16x32_bf16 a[0:3], v[68:71], a[144:147], a[0:3]
 ds_read_b64_tr_b16 v[86:87], v54 offset:12288
 buffer_load_dwordx4 a[240:243], v4, s[20:23], s42 offen offset:3072 sc1
 s_waitcnt vmcnt(29)
 v_mfma_f32_16x16x32_bf16 a[4:7], v[68:71], a[148:151], a[4:7]
 v_mfma_f32_16x16x32_bf16 a[4:7], v[64:67], a[132:135], a[4:7]
 buffer_load_dwordx4 a[228:231], v5, s[20:23], s42 offen offset:2048 sc1
 v_mfma_f32_16x16x32_bf16 a[8:11], v[64:67], a[136:139], a[8:11]
 ds_read_b64_tr_b16 v[88:89], v55
 s_waitcnt vmcnt(28)
 v_mfma_f32_16x16x32_bf16 a[8:11], v[68:71], a[152:155], a[8:11]
 ds_read_b64_tr_b16 v[90:91], v55 offset:4096
 s_waitcnt vmcnt(26)
 v_mfma_f32_16x16x32_bf16 a[12:15], v[68:71], a[156:159], a[12:15]
 buffer_load_dwordx4 a[232:235], v6, s[20:23], s42 offen offset:2048 sc1
 v_mfma_f32_16x16x32_bf16 a[12:15], v[64:67], a[140:143], a[12:15]
 s_waitcnt lgkmcnt(6)
 v_mfma_f32_16x16x32_bf16 a[28:31], v[72:75], a[140:143], a[28:31]
 ds_read_b64_tr_b16 v[92:93], v55 offset:8192
 buffer_load_dwordx4 a[244:247], v5, s[20:23], s42 offen offset:3072 sc1
 v_mfma_f32_16x16x32_bf16 a[28:31], v[76:79], a[156:159], a[28:31]
 ds_read_b64_tr_b16 v[94:95], v55 offset:12288
 buffer_load_dwordx4 a[236:239], v7, s[20:23], s42 offen offset:2048 sc1
 v_mfma_f32_16x16x32_bf16 a[24:27], v[76:79], a[152:155], a[24:27]
 v_mfma_f32_16x16x32_bf16 a[24:27], v[72:75], a[136:139], a[24:27]
 v_mfma_f32_16x16x32_bf16 a[20:23], v[72:75], a[132:135], a[20:23]
 ds_read_b64_tr_b16 v[64:65], v56
 v_mfma_f32_16x16x32_bf16 a[20:23], v[76:79], a[148:151], a[20:23]
 ds_read_b64_tr_b16 v[66:67], v56 offset:4096
 v_mfma_f32_16x16x32_bf16 a[16:19], v[76:79], a[144:147], a[16:19]
 v_mfma_f32_16x16x32_bf16 a[16:19], v[72:75], a[128:131], a[16:19]
 s_waitcnt lgkmcnt(6)
 v_mfma_f32_16x16x32_bf16 a[32:35], v[80:83], a[128:131], a[32:35]
 ds_read_b64_tr_b16 v[68:69], v56 offset:8192
 buffer_load_dwordx4 a[248:251], v6, s[20:23], s42 offen offset:3072 sc1
 v_mfma_f32_16x16x32_bf16 a[32:35], v[84:87], a[144:147], a[32:35]
 ds_read_b64_tr_b16 v[70:71], v56 offset:12288
 v_mfma_f32_16x16x32_bf16 a[36:39], v[84:87], a[148:151], a[36:39]
 v_mfma_f32_16x16x32_bf16 a[36:39], v[80:83], a[132:135], a[36:39]
 v_mfma_f32_16x16x32_bf16 a[40:43], v[80:83], a[136:139], a[40:43]
 ds_read_b64_tr_b16 v[72:73], v57
 v_mfma_f32_16x16x32_bf16 a[40:43], v[84:87], a[152:155], a[40:43]
 ds_read_b64_tr_b16 v[74:75], v57 offset:4096
 v_mfma_f32_16x16x32_bf16 a[44:47], v[84:87], a[156:159], a[44:47]
 v_mfma_f32_16x16x32_bf16 a[44:47], v[80:83], a[140:143], a[44:47]
 s_waitcnt lgkmcnt(6)
 v_mfma_f32_16x16x32_bf16 a[60:63], v[88:91], a[140:143], a[60:63]
 ds_read_b64_tr_b16 v[76:77], v57 offset:8192
 buffer_load_dwordx4 a[252:255], v7, s[20:23], s42 offen offset:3072 sc1
 v_mfma_f32_16x16x32_bf16 a[60:63], v[92:95], a[156:159], a[60:63]
 ds_read_b64_tr_b16 v[78:79], v57 offset:12288
 s_add_u32 s42, s42, 4096
 v_mfma_f32_16x16x32_bf16 a[56:59], v[92:95], a[152:155], a[56:59]
 v_mfma_f32_16x16x32_bf16 a[56:59], v[88:91], a[136:139], a[56:59]
 v_mfma_f32_16x16x32_bf16 a[52:55], v[88:91], a[132:135], a[52:55]
 ds_read_b64_tr_b16 v[80:81], v58
 v_mfma_f32_16x16x32_bf16 a[52:55], v[92:95], a[148:151], a[52:55]
 ds_read_b64_tr_b16 v[82:83], v58 offset:4096
 v_mfma_f32_16x16x32_bf16 a[48:51], v[92:95], a[144:147], a[48:51]
 v_mfma_f32_16x16x32_bf16 a[48:51], v[88:91], a[128:131], a[48:51]
 s_waitcnt lgkmcnt(6)
 v_mfma_f32_16x16x32_bf16 a[64:67], v[64:67], a[128:131], a[64:67]
 ds_read_b64_tr_b16 v[84:85], v58 offset:8192
 v_mfma_f32_16x16x32_bf16 a[64:67], v[68:71], a[144:147], a[64:67]
 ds_read_b64_tr_b16 v[86:87], v58 offset:12288
 v_mfma_f32_16x16x32_bf16 a[68:71], v[68:71], a[148:151], a[68:71]
 v_mfma_f32_16x16x32_bf16 a[68:71], v[64:67], a[132:135], a[68:71]
 v_mfma_f32_16x16x32_bf16 a[72:75], v[64:67], a[136:139], a[72:75]
 ds_read_b64_tr_b16 v[88:89], v59
 v_mfma_f32_16x16x32_bf16 a[72:75], v[68:71], a[152:155], a[72:75]
 ds_read_b64_tr_b16 v[90:91], v59 offset:4096
 v_mfma_f32_16x16x32_bf16 a[76:79], v[68:71], a[156:159], a[76:79]
 v_mfma_f32_16x16x32_bf16 a[76:79], v[64:67], a[140:143], a[76:79]
 s_waitcnt lgkmcnt(6)
 v_mfma_f32_16x16x32_bf16 a[92:95], v[72:75], a[140:143], a[92:95]
 ds_read_b64_tr_b16 v[92:93], v59 offset:8192
 v_mfma_f32_16x16x32_bf16 a[92:95], v[76:79], a[156:159], a[92:95]
 ds_read_b64_tr_b16 v[94:95], v59 offset:12288
 v_mfma_f32_16x16x32_bf16 a[88:91], v[76:79], a[152:155], a[88:91]
 v_mfma_f32_16x16x32_bf16 a[88:91], v[72:75], a[136:139], a[88:91]
 v_mfma_f32_16x16x32_bf16 a[84:87], v[72:75], a[132:135], a[84:87]
 ds_read_b64_tr_b16 v[64:65], v56 offset:16384
 s_waitcnt vmcnt(23)
 v_cmp_ne_u64 vcc, s[6:7], v[62:63]
 s_nop 0
 s_nop 0
 s_cbranch_vccz L_d_79_ok
L_d_79_spin:
 s_sleep 4
 buffer_load_dwordx2 v[62:63], v23, s[56:59], 0 offen sc1
 s_waitcnt vmcnt(0)
 v_cmp_ne_u64 vcc, s[6:7], v[62:63]
 s_nop 1
 s_cbranch_vccnz L_d_79_spin
L_d_79_ok:
 v_mfma_f32_16x16x32_bf16 a[84:87], v[76:79], a[148:151], a[84:87]
 ds_read_b64_tr_b16 v[66:67], v56 offset:20480
 v_mfma_f32_16x16x32_bf16 a[80:83], v[76:79], a[144:147], a[80:83]
 s_add_u32 s52, s33, 0
 buffer_load_dwordx4 v[192:195], v24, s[60:63], s52 offen sc1
 v_mfma_f32_16x16x32_bf16 a[80:83], v[72:75], a[128:131], a[80:83]
 s_waitcnt lgkmcnt(6)
 v_mfma_f32_16x16x32_bf16 a[96:99], v[80:83], a[128:131], a[96:99]
 ds_read_b64_tr_b16 v[68:69], v56 offset:24576
 buffer_load_dwordx4 v[196:199], v24, s[60:63], s52 offen offset:1024 sc1
 v_mfma_f32_16x16x32_bf16 a[96:99], v[84:87], a[144:147], a[96:99]
 ds_read_b64_tr_b16 v[70:71], v56 offset:28672
 buffer_load_dwordx4 v[200:203], v24, s[60:63], s52 offen offset:2048 sc1
 v_mfma_f32_16x16x32_bf16 a[100:103], v[84:87], a[148:151], a[100:103]
 v_mfma_f32_16x16x32_bf16 a[100:103], v[80:83], a[132:135], a[100:103]
 s_waitcnt vmcnt(21)
 s_barrier
 v_mfma_f32_16x16x32_bf16 a[104:107], v[80:83], a[136:139], a[104:107]
 ds_read_b64_tr_b16 v[72:73], v56 offset:32768
 buffer_load_dwordx4 v[204:207], v24, s[60:63], s52 offen offset:3072 sc1
 v_mfma_f32_16x16x32_bf16 a[104:107], v[84:87], a[152:155], a[104:107]
 ds_read_b64_tr_b16 v[74:75], v56 offset:36864
 v_mfma_f32_16x16x32_bf16 a[108:111], v[84:87], a[156:159], a[108:111]
 v_mfma_f32_16x16x32_bf16 a[108:111], v[80:83], a[140:143], a[108:111]
 s_waitcnt lgkmcnt(6)
 v_mfma_f32_16x16x32_bf16 a[124:127], v[88:91], a[140:143], a[124:127]
 ds_read_b64_tr_b16 v[76:77], v56 offset:40960
 s_add_u32 s52, s52, 4096
 v_mfma_f32_16x16x32_bf16 a[124:127], v[92:95], a[156:159], a[124:127]
 ds_read_b64_tr_b16 v[78:79], v56 offset:45056
 v_mfma_f32_16x16x32_bf16 a[120:123], v[92:95], a[152:155], a[120:123]
 buffer_load_dwordx4 v[208:211], v24, s[60:63], s52 offen sc1
 v_mfma_f32_16x16x32_bf16 a[120:123], v[88:91], a[136:139], a[120:123]
 v_mfma_f32_16x16x32_bf16 a[116:119], v[88:91], a[132:135], a[116:119]
 ds_read_b64_tr_b16 v[80:81], v56 offset:49152
 v_mfma_f32_16x16x32_bf16 a[116:119], v[92:95], a[148:151], a[116:119]
 ds_read_b64_tr_b16 v[82:83], v56 offset:53248
 v_mfma_f32_16x16x32_bf16 a[112:115], v[92:95], a[144:147], a[112:115]
 buffer_load_dwordx4 v[212:215], v24, s[60:63], s52 offen offset:1024 sc1
 v_mfma_f32_16x16x32_bf16 a[112:115], v[88:91], a[128:131], a[112:115]
 s_waitcnt lgkmcnt(6)
 v_mfma_f32_16x16x32_bf16 a[64:67], v[64:67], a[160:163], a[64:67]
 ds_read_b64_tr_b16 v[84:85], v56 offset:57344
 v_mfma_f32_16x16x32_bf16 a[64:67], v[68:71], a[176:179], a[64:67]
 ds_read_b64_tr_b16 v[86:87], v56 offset:61440
 buffer_load_dwordx4 v[216:219], v24, s[60:63], s52 offen offset:2048 sc1
 v_mfma_f32_16x16x32_bf16 a[68:71], v[68:71], a[180:183], a[68:71]
 v_mfma_f32_16x16x32_bf16 a[68:71], v[64:67], a[164:167], a[68:71]
 v_mfma_f32_16x16x32_bf16 a[72:75], v[64:67], a[168:171], a[72:75]
 ds_read_b64_tr_b16 v[88:89], v57 offset:16384
 buffer_load_dwordx4 v[220:223], v24, s[60:63], s52 offen offset:3072 sc1
 v_mfma_f32_16x16x32_bf16 a[72:75], v[68:71], a[184:187], a[72:75]
 ds_read_b64_tr_b16 v[90:91], v57 offset:20480
 s_waitcnt vmcnt(25)
 v_mfma_f32_16x16x32_bf16 a[76:79], v[68:71], a[188:191], a[76:79]
 v_mfma_f32_16x16x32_bf16 a[76:79], v[64:67], a[172:175], a[76:79]
 s_waitcnt lgkmcnt(6)
 s_waitcnt vmcnt(21)
 v_mfma_f32_16x16x32_bf16 a[76:79], v[72:75], a[204:207], a[76:79]
 ds_read_b64_tr_b16 v[92:93], v57 offset:24576
 s_add_u32 s52, s52, 4096
 s_waitcnt vmcnt(17)
 v_mfma_f32_16x16x32_bf16 a[76:79], v[76:79], a[220:223], a[76:79]
 ds_read_b64_tr_b16 v[94:95], v57 offset:28672
 v_mfma_f32_16x16x32_bf16 a[72:75], v[76:79], a[216:219], a[72:75]
 buffer_load_dwordx4 v[224:227], v24, s[60:63], s52 offen sc1
 v_mfma_f32_16x16x32_bf16 a[72:75], v[72:75], a[200:203], a[72:75]
 v_mfma_f32_16x16x32_bf16 a[68:71], v[72:75], a[196:199], a[68:71]
 ds_read_b64_tr_b16 v[64:65], v57 offset:32768
 v_mfma_f32_16x16x32_bf16 a[68:71], v[76:79], a[212:215], a[68:71]
 ds_read_b64_tr_b16 v[66:67], v57 offset:36864
 v_mfma_f32_16x16x32_bf16 a[64:67], v[76:79], a[208:211], a[64:67]
 buffer_load_dwordx4 v[228:231], v24, s[60:63], s52 offen offset:1024 sc1
 v_mfma_f32_16x16x32_bf16 a[64:67], v[72:75], a[192:195], a[64:67]
 s_waitcnt lgkmcnt(6)
 s_waitcnt vmcnt(17)
 v_mfma_f32_16x16x32_bf16 a[64:67], v[80:83], a[224:227], a[64:67]
 ds_read_b64_tr_b16 v[68:69], v57 offset:40960
 s_waitcnt vmcnt(16)
 v_mfma_f32_16x16x32_bf16 a[64:67], v[84:87], a[240:243], a[64:67]
 ds_read_b64_tr_b16 v[70:71], v57 offset:45056
 buffer_load_dwordx4 v[232:235], v24, s[60:63], s52 offen offset:2048 sc1
 s_waitcnt vmcnt(14)
 v_mfma_f32_16x16x32_bf16 a[68:71], v[84:87], a[244:247], a[68:71]
 v_mfma_f32_16x16x32_bf16 a[68:71], v[80:83], a[228:231], a[68:71]
 v_mfma_f32_16x16x32_bf16 a[72:75], v[80:83], a[232:235], a[72:75]
 ds_read_b64_tr_b16 v[72:73], v57 offset:49152
 buffer_load_dwordx4 v[236:239], v24, s[60:63], s52 offen offset:3072 sc1
 s_waitcnt vmcnt(13)
 v_mfma_f32_16x16x32_bf16 a[72:75], v[84:87], a[248:251], a[72:75]
 ds_read_b64_tr_b16 v[74:75], v57 offset:53248
 s_waitcnt vmcnt(12)
 v_mfma_f32_16x16x32_bf16 a[76:79], v[84:87], a[252:255], a[76:79]
 v_mfma_f32_16x16x32_bf16 a[76:79], v[80:83], a[236:239], a[76:79]
 s_waitcnt lgkmcnt(6)
 v_mfma_f32_16x16x32_bf16 a[92:95], v[88:91], a[172:175], a[92:95]
 ds_read_b64_tr_b16 v[76:77], v57 offset:57344
 v_mfma_f32_16x16x32_bf16 a[92:95], v[92:95], a[188:191], a[92:95]
 ds_read_b64_tr_b16 v[78:79], v57 offset:61440
 v_mfma_f32_16x16x32_bf16 a[88:91], v[92:95], a[184:187], a[88:91]
 v_mfma_f32_16x16x32_bf16 a[88:91], v[88:91], a[168:171], a[88:91]
 v_accvgpr_read_b32 v160, a64
 v_mfma_f32_16x16x32_bf16 a[84:87], v[88:91], a[164:167], a[84:87]
 ds_read_b64_tr_b16 v[80:81], v58 offset:16384
 v_accvgpr_read_b32 v161, a65
 v_mfma_f32_16x16x32_bf16 a[84:87], v[92:95], a[180:183], a[84:87]
 ds_read_b64_tr_b16 v[82:83], v58 offset:20480
 v_accvgpr_read_b32 v162, a66
 v_mfma_f32_16x16x32_bf16 a[80:83], v[92:95], a[176:179], a[80:83]
 v_accvgpr_read_b32 v163, a67
 v_accvgpr_read_b32 v164, a68
 v_mfma_f32_16x16x32_bf16 a[80:83], v[88:91], a[160:163], a[80:83]
 s_waitcnt lgkmcnt(6)
 v_mfma_f32_16x16x32_bf16 a[80:83], v[64:67], a[192:195], a[80:83]
 ds_read_b64_tr_b16 v[84:85], v58 offset:24576
 v_accvgpr_read_b32 v165, a69
 v_mfma_f32_16x16x32_bf16 a[80:83], v[68:71], a[208:211], a[80:83]
 ds_read_b64_tr_b16 v[86:87], v58 offset:28672
 v_accvgpr_read_b32 v166, a70
 v_mfma_f32_16x16x32_bf16 a[84:87], v[68:71], a[212:215], a[84:87]
 v_accvgpr_read_b32 v167, a71
 v_cvt_pk_bf16_f32 v112, v160, v161
 v_mfma_f32_16x16x32_bf16 a[84:87], v[64:67], a[196:199], a[84:87]
 v_cvt_pk_bf16_f32 v113, v162, v163
 v_mfma_f32_16x16x32_bf16 a[88:91], v[64:67], a[200:203], a[88:91]
 ds_read_b64_tr_b16 v[88:89], v58 offset:32768
 v_cvt_pk_bf16_f32 v114, v164, v165
 v_mfma_f32_16x16x32_bf16 a[88:91], v[68:71], a[216:219], a[88:91]
 ds_read_b64_tr_b16 v[90:91], v58 offset:36864
 v_cvt_pk_bf16_f32 v115, v166, v167
 v_mfma_f32_16x16x32_bf16 a[92:95], v[68:71], a[220:223], a[92:95]
 buffer_store_dwordx4 v[112:115], v26, s[60:63], s54 offen sc1
 v_accvgpr_read_b32 v168, a72
 v_mfma_f32_16x16x32_bf16 a[92:95], v[64:67], a[204:207], a[92:95]
 s_waitcnt lgkmcnt(6)
 v_mfma_f32_16x16x32_bf16 a[92:95], v[72:75], a[236:239], a[92:95]
 ds_read_b64_tr_b16 v[92:93], v58 offset:40960
 v_accvgpr_read_b32 v169, a73
 v_mfma_f32_16x16x32_bf16 a[92:95], v[76:79], a[252:255], a[92:95]
 ds_read_b64_tr_b16 v[94:95], v58 offset:45056
 v_accvgpr_read_b32 v170, a74
 v_mfma_f32_16x16x32_bf16 a[88:91], v[76:79], a[248:251], a[88:91]
 v_accvgpr_read_b32 v171, a75
 v_accvgpr_read_b32 v172, a76
 v_mfma_f32_16x16x32_bf16 a[88:91], v[72:75], a[232:235], a[88:91]
 v_accvgpr_read_b32 v173, a77
 v_mfma_f32_16x16x32_bf16 a[84:87], v[72:75], a[228:231], a[84:87]
 ds_read_b64_tr_b16 v[64:65], v58 offset:49152
 v_accvgpr_read_b32 v174, a78
 v_mfma_f32_16x16x32_bf16 a[84:87], v[76:79], a[244:247], a[84:87]
 ds_read_b64_tr_b16 v[66:67], v58 offset:53248
 v_accvgpr_read_b32 v175, a79
 v_mfma_f32_16x16x32_bf16 a[80:83], v[76:79], a[240:243], a[80:83]
 v_cvt_pk_bf16_f32 v116, v168, v169
 v_cvt_pk_bf16_f32 v117, v170, v171
 v_mfma_f32_16x16x32_bf16 a[80:83], v[72:75], a[224:227], a[80:83]
 s_waitcnt lgkmcnt(6)
 v_mfma_f32_16x16x32_bf16 a[96:99], v[80:83], a[160:163], a[96:99]
 ds_read_b64_tr_b16 v[68:69], v58 offset:57344
 v_cvt_pk_bf16_f32 v118, v172, v173
 v_mfma_f32_16x16x32_bf16 a[96:99], v[84:87], a[176:179], a[96:99]
 ds_read_b64_tr_b16 v[70:71], v58 offset:61440
 v_cvt_pk_bf16_f32 v119, v174, v175
 v_mfma_f32_16x16x32_bf16 a[100:103], v[84:87], a[180:183], a[100:103]
 buffer_store_dwordx4 v[116:119], v27, s[60:63], s54 offen sc1
 v_mfma_f32_16x16x32_bf16 a[100:103], v[80:83], a[164:167], a[100:103]
 v_accvgpr_read_b32 v176, a80
 v_mfma_f32_16x16x32_bf16 a[104:107], v[80:83], a[168:171], a[104:107]
 ds_read_b64_tr_b16 v[72:73], v59 offset:16384
 v_accvgpr_read_b32 v177, a81
 v_mfma_f32_16x16x32_bf16 a[104:107], v[84:87], a[184:187], a[104:107]
 ds_read_b64_tr_b16 v[74:75], v59 offset:20480
 v_accvgpr_read_b32 v178, a82
 v_mfma_f32_16x16x32_bf16 a[108:111], v[84:87], a[188:191], a[108:111]
 v_accvgpr_read_b32 v179, a83
 v_accvgpr_read_b32 v180, a84
 v_mfma_f32_16x16x32_bf16 a[108:111], v[80:83], a[172:175], a[108:111]
 s_waitcnt lgkmcnt(6)
 v_mfma_f32_16x16x32_bf16 a[108:111], v[88:91], a[204:207], a[108:111]
 ds_read_b64_tr_b16 v[76:77], v59 offset:24576
 v_accvgpr_read_b32 v181, a85
 v_mfma_f32_16x16x32_bf16 a[108:111], v[92:95], a[220:223], a[108:111]
 ds_read_b64_tr_b16 v[78:79], v59 offset:28672
 v_accvgpr_read_b32 v182, a86
 v_mfma_f32_16x16x32_bf16 a[104:107], v[92:95], a[216:219], a[104:107]
 v_accvgpr_read_b32 v183, a87
 v_cvt_pk_bf16_f32 v120, v176, v177
 v_mfma_f32_16x16x32_bf16 a[104:107], v[88:91], a[200:203], a[104:107]
 v_cvt_pk_bf16_f32 v121, v178, v179
 v_mfma_f32_16x16x32_bf16 a[100:103], v[88:91], a[196:199], a[100:103]
 ds_read_b64_tr_b16 v[80:81], v59 offset:32768
 v_cvt_pk_bf16_f32 v122, v180, v181
 v_mfma_f32_16x16x32_bf16 a[100:103], v[92:95], a[212:215], a[100:103]
 ds_read_b64_tr_b16 v[82:83], v59 offset:36864
 v_cvt_pk_bf16_f32 v123, v182, v183
 v_mfma_f32_16x16x32_bf16 a[96:99], v[92:95], a[208:211], a[96:99]
 buffer_store_dwordx4 v[120:123], v26, s[60:63], s54 offen offset:1024 sc1
 v_accvgpr_read_b32 v184, a88
 v_mfma_f32_16x16x32_bf16 a[96:99], v[88:91], a[192:195], a[96:99]
 s_waitcnt lgkmcnt(6)
 v_mfma_f32_16x16x32_bf16 a[96:99], v[64:67], a[224:227], a[96:99]
 ds_read_b64_tr_b16 v[84:85], v59 offset:40960
 v_accvgpr_read_b32 v185, a89
 v_mfma_f32_16x16x32_bf16 a[96:99], v[68:71], a[240:243], a[96:99]
 ds_read_b64_tr_b16 v[86:87], v59 offset:45056
 v_accvgpr_read_b32 v186, a90
 v_mfma_f32_16x16x32_bf16 a[100:103], v[68:71], a[244:247], a[100:103]
 v_accvgpr_read_b32 v187, a91
 v_accvgpr_read_b32 v188, a92
 v_mfma_f32_16x16x32_bf16 a[100:103], v[64:67], a[228:231], a[100:103]
 v_accvgpr_read_b32 v189, a93
 v_mfma_f32_16x16x32_bf16 a[104:107], v[64:67], a[232:235], a[104:107]
 ds_read_b64_tr_b16 v[88:89], v59 offset:49152
 v_accvgpr_read_b32 v190, a94
 v_mfma_f32_16x16x32_bf16 a[104:107], v[68:71], a[248:251], a[104:107]
 ds_read_b64_tr_b16 v[90:91], v59 offset:53248
 v_accvgpr_read_b32 v191, a95
 v_mfma_f32_16x16x32_bf16 a[108:111], v[68:71], a[252:255], a[108:111]
 v_cvt_pk_bf16_f32 v124, v184, v185
 v_cvt_pk_bf16_f32 v125, v186, v187
 v_mfma_f32_16x16x32_bf16 a[108:111], v[64:67], a[236:239], a[108:111]
 s_waitcnt lgkmcnt(6)
 v_mfma_f32_16x16x32_bf16 a[124:127], v[72:75], a[172:175], a[124:127]
 ds_read_b64_tr_b16 v[92:93], v59 offset:57344
 v_cvt_pk_bf16_f32 v126, v188, v189
 v_mfma_f32_16x16x32_bf16 a[124:127], v[76:79], a[188:191], a[124:127]
 ds_read_b64_tr_b16 v[94:95], v59 offset:61440
 v_cvt_pk_bf16_f32 v127, v190, v191
 v_mfma_f32_16x16x32_bf16 a[120:123], v[76:79], a[184:187], a[120:123]
 buffer_store_dwordx4 v[124:127], v27, s[60:63], s54 offen offset:1024 sc1
 v_mfma_f32_16x16x32_bf16 a[120:123], v[72:75], a[168:171], a[120:123]
 v_accvgpr_read_b32 v160, a96
 v_mfma_f32_16x16x32_bf16 a[116:119], v[72:75], a[164:167], a[116:119]
 ds_read_b64_tr_b16 v[64:65], v52 offset:16384
 v_accvgpr_read_b32 v161, a97
 v_mfma_f32_16x16x32_bf16 a[116:119], v[76:79], a[180:183], a[116:119]
 ds_read_b64_tr_b16 v[66:67], v52 offset:20480
 v_accvgpr_read_b32 v162, a98
 v_mfma_f32_16x16x32_bf16 a[112:115], v[76:79], a[176:179], a[112:115]
 v_accvgpr_read_b32 v163, a99
 v_accvgpr_read_b32 v164, a100
 v_mfma_f32_16x16x32_bf16 a[112:115], v[72:75], a[160:163], a[112:115]
 s_waitcnt lgkmcnt(6)
 v_mfma_f32_16x16x32_bf16 a[112:115], v[80:83], a[192:195], a[112:115]
 ds_read_b64_tr_b16 v[68:69], v52 offset:24576
 v_accvgpr_read_b32 v165, a101
 v_mfma_f32_16x16x32_bf16 a[112:115], v[84:87], a[208:211], a[112:115]
 ds_read_b64_tr_b16 v[70:71], v52 offset:28672
 v_accvgpr_read_b32 v166, a102
 v_mfma_f32_16x16x32_bf16 a[116:119], v[84:87], a[212:215], a[116:119]
 v_accvgpr_read_b32 v167, a103
 v_cvt_pk_bf16_f32 v112, v160, v161
 v_mfma_f32_16x16x32_bf16 a[116:119], v[80:83], a[196:199], a[116:119]
 v_cvt_pk_bf16_f32 v113, v162, v163
 v_mfma_f32_16x16x32_bf16 a[120:123], v[80:83], a[200:203], a[120:123]
 ds_read_b64_tr_b16 v[72:73], v52 offset:32768
 v_cvt_pk_bf16_f32 v114, v164, v165
 v_mfma_f32_16x16x32_bf16 a[120:123], v[84:87], a[216:219], a[120:123]
 ds_read_b64_tr_b16 v[74:75], v52 offset:36864
 v_cvt_pk_bf16_f32 v115, v166, v167
 v_mfma_f32_16x16x32_bf16 a[124:127], v[84:87], a[220:223], a[124:127]
 buffer_store_dwordx4 v[112:115], v26, s[60:63], s54 offen offset:2048 sc1
 v_accvgpr_read_b32 v168, a104
 v_mfma_f32_16x16x32_bf16 a[124:127], v[80:83], a[204:207], a[124:127]
 s_waitcnt lgkmcnt(6)
 v_mfma_f32_16x16x32_bf16 a[124:127], v[88:91], a[236:239], a[124:127]
 ds_read_b64_tr_b16 v[76:77], v52 offset:40960
 v_accvgpr_read_b32 v169, a105
 v_mfma_f32_16x16x32_bf16 a[124:127], v[92:95], a[252:255], a[124:127]
 ds_read_b64_tr_b16 v[78:79], v52 offset:45056
 v_accvgpr_read_b32 v170, a106
 v_mfma_f32_16x16x32_bf16 a[120:123], v[92:95], a[248:251], a[120:123]
 v_accvgpr_read_b32 v171, a107
 v_accvgpr_read_b32 v172, a108
 v_mfma_f32_16x16x32_bf16 a[120:123], v[88:91], a[232:235], a[120:123]
 v_accvgpr_read_b32 v173, a109
 v_mfma_f32_16x16x32_bf16 a[116:119], v[88:91], a[228:231], a[116:119]
 ds_read_b64_tr_b16 v[80:81], v52 offset:49152
 v_accvgpr_read_b32 v174, a110
 v_mfma_f32_16x16x32_bf16 a[116:119], v[92:95], a[244:247], a[116:119]
 ds_read_b64_tr_b16 v[82:83], v52 offset:53248
 v_accvgpr_read_b32 v175, a111
 v_mfma_f32_16x16x32_bf16 a[112:115], v[92:95], a[240:243], a[112:115]
 v_cvt_pk_bf16_f32 v116, v168, v169
 v_cvt_pk_bf16_f32 v117, v170, v171
 v_mfma_f32_16x16x32_bf16 a[112:115], v[88:91], a[224:227], a[112:115]
 s_waitcnt lgkmcnt(6)
 v_mfma_f32_16x16x32_bf16 a[0:3], v[64:67], a[160:163], a[0:3]
 ds_read_b64_tr_b16 v[84:85], v52 offset:57344
 v_cvt_pk_bf16_f32 v118, v172, v173
 v_mfma_f32_16x16x32_bf16 a[0:3], v[68:71], a[176:179], a[0:3]
 ds_read_b64_tr_b16 v[86:87], v52 offset:61440
 v_cvt_pk_bf16_f32 v119, v174, v175
 v_mfma_f32_16x16x32_bf16 a[4:7], v[68:71], a[180:183], a[4:7]
 buffer_store_dwordx4 v[116:119], v27, s[60:63], s54 offen offset:2048 sc1
 v_mfma_f32_16x16x32_bf16 a[4:7], v[64:67], a[164:167], a[4:7]
 v_accvgpr_read_b32 v176, a112
 v_mfma_f32_16x16x32_bf16 a[8:11], v[64:67], a[168:171], a[8:11]
 ds_read_b64_tr_b16 v[88:89], v53 offset:16384
 v_accvgpr_read_b32 v177, a113
 v_mfma_f32_16x16x32_bf16 a[8:11], v[68:71], a[184:187], a[8:11]
 ds_read_b64_tr_b16 v[90:91], v53 offset:20480
 v_accvgpr_read_b32 v178, a114
 v_mfma_f32_16x16x32_bf16 a[12:15], v[68:71], a[188:191], a[12:15]
 v_accvgpr_read_b32 v179, a115
 v_accvgpr_read_b32 v180, a116
 v_mfma_f32_16x16x32_bf16 a[12:15], v[64:67], a[172:175], a[12:15]
 s_waitcnt lgkmcnt(6)
 v_mfma_f32_16x16x32_bf16 a[12:15], v[72:75], a[204:207], a[12:15]
 ds_read_b64_tr_b16 v[92:93], v53 offset:24576
 v_accvgpr_read_b32 v181, a117
 v_mfma_f32_16x16x32_bf16 a[12:15], v[76:79], a[220:223], a[12:15]
 ds_read_b64_tr_b16 v[94:95], v53 offset:28672
 v_accvgpr_read_b32 v182, a118
 v_mfma_f32_16x16x32_bf16 a[8:11], v[76:79], a[216:219], a[8:11]
 v_accvgpr_read_b32 v183, a119
 v_cvt_pk_bf16_f32 v120, v176, v177
 v_mfma_f32_16x16x32_bf16 a[8:11], v[72:75], a[200:203], a[8:11]
 v_cvt_pk_bf16_f32 v121, v178, v179
 v_mfma_f32_16x16x32_bf16 a[4:7], v[72:75], a[196:199], a[4:7]
 ds_read_b64_tr_b16 v[64:65], v53 offset:32768
 v_cvt_pk_bf16_f32 v122, v180, v181
 v_mfma_f32_16x16x32_bf16 a[4:7], v[76:79], a[212:215], a[4:7]
 ds_read_b64_tr_b16 v[66:67], v53 offset:36864
 v_cvt_pk_bf16_f32 v123, v182, v183
 v_mfma_f32_16x16x32_bf16 a[0:3], v[76:79], a[208:211], a[0:3]
 buffer_store_dwordx4 v[120:123], v26, s[60:63], s54 offen offset:3072 sc1
 v_accvgpr_read_b32 v184, a120
 v_mfma_f32_16x16x32_bf16 a[0:3], v[72:75], a[192:195], a[0:3]
 s_waitcnt lgkmcnt(6)
 v_mfma_f32_16x16x32_bf16 a[0:3], v[80:83], a[224:227], a[0:3]
 ds_read_b64_tr_b16 v[68:69], v53 offset:40960
 v_accvgpr_read_b32 v185, a121
 v_mfma_f32_16x16x32_bf16 a[0:3], v[84:87], a[240:243], a[0:3]
 ds_read_b64_tr_b16 v[70:71], v53 offset:45056
 v_accvgpr_read_b32 v186, a122
 v_mfma_f32_16x16x32_bf16 a[4:7], v[84:87], a[244:247], a[4:7]
 v_accvgpr_read_b32 v187, a123
 v_accvgpr_read_b32 v188, a124
 v_mfma_f32_16x16x32_bf16 a[4:7], v[80:83], a[228:231], a[4:7]
 v_accvgpr_read_b32 v189, a125
 v_mfma_f32_16x16x32_bf16 a[8:11], v[80:83], a[232:235], a[8:11]
 ds_read_b64_tr_b16 v[72:73], v53 offset:49152
 v_accvgpr_read_b32 v190, a126
 v_mfma_f32_16x16x32_bf16 a[8:11], v[84:87], a[248:251], a[8:11]
 ds_read_b64_tr_b16 v[74:75], v53 offset:53248
 v_accvgpr_read_b32 v191, a127
 v_mfma_f32_16x16x32_bf16 a[12:15], v[84:87], a[252:255], a[12:15]
 v_cvt_pk_bf16_f32 v124, v184, v185
 v_cvt_pk_bf16_f32 v125, v186, v187
 v_mfma_f32_16x16x32_bf16 a[12:15], v[80:83], a[236:239], a[12:15]
 s_waitcnt lgkmcnt(6)
 v_mfma_f32_16x16x32_bf16 a[28:31], v[88:91], a[172:175], a[28:31]
 ds_read_b64_tr_b16 v[76:77], v53 offset:57344
 v_cvt_pk_bf16_f32 v126, v188, v189
 v_mfma_f32_16x16x32_bf16 a[28:31], v[92:95], a[188:191], a[28:31]
 ds_read_b64_tr_b16 v[78:79], v53 offset:61440
 v_cvt_pk_bf16_f32 v127, v190, v191
 v_mfma_f32_16x16x32_bf16 a[24:27], v[92:95], a[184:187], a[24:27]
 buffer_store_dwordx4 v[124:127], v27, s[60:63], s54 offen offset:3072 sc1
 v_mfma_f32_16x16x32_bf16 a[24:27], v[88:91], a[168:171], a[24:27]
 v_accvgpr_read_b32 v160, a8
 v_mfma_f32_16x16x32_bf16 a[20:23], v[88:91], a[164:167], a[20:23]
 ds_read_b64_tr_b16 v[80:81], v54 offset:16384
 v_accvgpr_read_b32 v161, a9
 v_mfma_f32_16x16x32_bf16 a[20:23], v[92:95], a[180:183], a[20:23]
 ds_read_b64_tr_b16 v[82:83], v54 offset:20480
 v_accvgpr_read_b32 v162, a10
 v_mfma_f32_16x16x32_bf16 a[16:19], v[92:95], a[176:179], a[16:19]
 v_accvgpr_read_b32 v163, a11
 v_accvgpr_read_b32 v164, a12
 v_mfma_f32_16x16x32_bf16 a[16:19], v[88:91], a[160:163], a[16:19]
 s_waitcnt lgkmcnt(6)
 v_mfma_f32_16x16x32_bf16 a[16:19], v[64:67], a[192:195], a[16:19]
 ds_read_b64_tr_b16 v[84:85], v54 offset:24576
 v_accvgpr_read_b32 v165, a13
 v_mfma_f32_16x16x32_bf16 a[16:19], v[68:71], a[208:211], a[16:19]
 ds_read_b64_tr_b16 v[86:87], v54 offset:28672
 v_mfma_f32_16x16x32_bf16 a[20:23], v[68:71], a[212:215], a[20:23]
 v_accvgpr_read_b32 v166, a14
 v_mfma_f32_16x16x32_bf16 a[20:23], v[64:67], a[196:199], a[20:23]
 v_mfma_f32_16x16x32_bf16 a[24:27], v[64:67], a[200:203], a[24:27]
 ds_read_b64_tr_b16 v[88:89], v54 offset:32768
 v_accvgpr_read_b32 v167, a15
 v_mfma_f32_16x16x32_bf16 a[24:27], v[68:71], a[216:219], a[24:27]
 ds_read_b64_tr_b16 v[90:91], v54 offset:36864
 v_mfma_f32_16x16x32_bf16 a[28:31], v[68:71], a[220:223], a[28:31]
 v_cvt_pk_bf16_f32 v112, v160, v161
 v_mfma_f32_16x16x32_bf16 a[28:31], v[64:67], a[204:207], a[28:31]
 s_waitcnt lgkmcnt(6)
 v_mfma_f32_16x16x32_bf16 a[28:31], v[72:75], a[236:239], a[28:31]
 ds_read_b64_tr_b16 v[92:93], v54 offset:40960
 v_cvt_pk_bf16_f32 v113, v162, v163
 v_mfma_f32_16x16x32_bf16 a[28:31], v[76:79], a[252:255], a[28:31]
 ds_read_b64_tr_b16 v[94:95], v54 offset:45056
 v_cvt_pk_bf16_f32 v114, v164, v165
 v_mfma_f32_16x16x32_bf16 a[24:27], v[76:79], a[248:251], a[24:27]
 v_mfma_f32_16x16x32_bf16 a[24:27], v[72:75], a[232:235], a[24:27]
 v_cvt_pk_bf16_f32 v115, v166, v167
 v_mfma_f32_16x16x32_bf16 a[20:23], v[72:75], a[228:231], a[20:23]
 ds_read_b64_tr_b16 v[64:65], v54 offset:49152
 v_mfma_f32_16x16x32_bf16 a[20:23], v[76:79], a[244:247], a[20:23]
 ds_read_b64_tr_b16 v[66:67], v54 offset:53248
 buffer_store_dwordx4 v[112:115], v25, s[60:63], s54 offen sc1
 v_mfma_f32_16x16x32_bf16 a[16:19], v[76:79], a[240:243], a[16:19]
 v_mfma_f32_16x16x32_bf16 a[16:19], v[72:75], a[224:227], a[16:19]
 s_waitcnt lgkmcnt(6)
 v_mfma_f32_16x16x32_bf16 a[32:35], v[80:83], a[160:163], a[32:35]
 ds_read_b64_tr_b16 v[68:69], v54 offset:57344
 v_mfma_f32_16x16x32_bf16 a[32:35], v[84:87], a[176:179], a[32:35]
 ds_read_b64_tr_b16 v[70:71], v54 offset:61440
 v_mfma_f32_16x16x32_bf16 a[36:39], v[84:87], a[180:183], a[36:39]
 v_mfma_f32_16x16x32_bf16 a[36:39], v[80:83], a[164:167], a[36:39]
 v_accvgpr_read_b32 v168, a24
 v_mfma_f32_16x16x32_bf16 a[40:43], v[80:83], a[168:171], a[40:43]
 ds_read_b64_tr_b16 v[72:73], v55 offset:16384
 v_accvgpr_read_b32 v169, a25
 v_mfma_f32_16x16x32_bf16 a[40:43], v[84:87], a[184:187], a[40:43]
 ds_read_b64_tr_b16 v[74:75], v55 offset:20480
 v_accvgpr_read_b32 v170, a26
 v_mfma_f32_16x16x32_bf16 a[44:47], v[84:87], a[188:191], a[44:47]
 v_accvgpr_read_b32 v171, a27
 v_accvgpr_read_b32 v172, a28
 v_mfma_f32_16x16x32_bf16 a[44:47], v[80:83], a[172:175], a[44:47]
 s_waitcnt lgkmcnt(6)
 v_mfma_f32_16x16x32_bf16 a[44:47], v[88:91], a[204:207], a[44:47]
 ds_read_b64_tr_b16 v[76:77], v55 offset:24576
 v_accvgpr_read_b32 v173, a29
 v_mfma_f32_16x16x32_bf16 a[44:47], v[92:95], a[220:223], a[44:47]
 ds_read_b64_tr_b16 v[78:79], v55 offset:28672
 v_mfma_f32_16x16x32_bf16 a[40:43], v[92:95], a[216:219], a[40:43]
 v_accvgpr_read_b32 v174, a30
 v_mfma_f32_16x16x32_bf16 a[40:43], v[88:91], a[200:203], a[40:43]
 v_mfma_f32_16x16x32_bf16 a[36:39], v[88:91], a[196:199], a[36:39]
 ds_read_b64_tr_b16 v[80:81], v55 offset:32768
 v_accvgpr_read_b32 v175, a31
 v_mfma_f32_16x16x32_bf16 a[36:39], v[92:95], a[212:215], a[36:39]
 ds_read_b64_tr_b16 v[82:83], v55 offset:36864
 v_mfma_f32_16x16x32_bf16 a[32:35], v[92:95], a[208:211], a[32:35]
 v_cvt_pk_bf16_f32 v116, v168, v169
 v_mfma_f32_16x16x32_bf16 a[32:35], v[88:91], a[192:195], a[32:35]
 s_waitcnt lgkmcnt(6)
 v_mfma_f32_16x16x32_bf16 a[32:35], v[64:67], a[224:227], a[32:35]
 ds_read_b64_tr_b16 v[84:85], v55 offset:40960
 v_cvt_pk_bf16_f32 v117, v170, v171
 v_mfma_f32_16x16x32_bf16 a[32:35], v[68:71], a[240:243], a[32:35]
 ds_read_b64_tr_b16 v[86:87], v55 offset:45056
 v_cvt_pk_bf16_f32 v118, v172, v173
 v_mfma_f32_16x16x32_bf16 a[36:39], v[68:71], a[244:247], a[36:39]
 v_mfma_f32_16x16x32_bf16 a[36:39], v[64:67], a[228:231], a[36:39]
 v_cvt_pk_bf16_f32 v119, v174, v175
 v_mfma_f32_16x16x32_bf16 a[40:43], v[64:67], a[232:235], a[40:43]
 ds_read_b64_tr_b16 v[88:89], v55 offset:49152
 v_mfma_f32_16x16x32_bf16 a[40:43], v[68:71], a[248:251], a[40:43]
 ds_read_b64_tr_b16 v[90:91], v55 offset:53248
 buffer_store_dwordx4 v[116:119], v25, s[60:63], s54 offen offset:1024 sc1
 v_mfma_f32_16x16x32_bf16 a[44:47], v[68:71], a[252:255], a[44:47]
 v_mfma_f32_16x16x32_bf16 a[44:47], v[64:67], a[236:239], a[44:47]
 s_waitcnt lgkmcnt(6)
 v_mfma_f32_16x16x32_bf16 a[60:63], v[72:75], a[172:175], a[60:63]
 ds_read_b64_tr_b16 v[92:93], v55 offset:57344
 v_mfma_f32_16x16x32_bf16 a[60:63], v[76:79], a[188:191], a[60:63]
 ds_read_b64_tr_b16 v[94:95], v55 offset:61440
 v_mfma_f32_16x16x32_bf16 a[56:59], v[76:79], a[184:187], a[56:59]
 v_mfma_f32_16x16x32_bf16 a[56:59], v[72:75], a[168:171], a[56:59]
 v_accvgpr_read_b32 v176, a40
 v_mfma_f32_16x16x32_bf16 a[52:55], v[72:75], a[164:167], a[52:55]
 v_accvgpr_read_b32 v177, a41
 v_accvgpr_read_b32 v178, a42
 v_mfma_f32_16x16x32_bf16 a[52:55], v[76:79], a[180:183], a[52:55]
 v_accvgpr_read_b32 v179, a43
 v_mfma_f32_16x16x32_bf16 a[48:51], v[76:79], a[176:179], a[48:51]
 v_accvgpr_read_b32 v180, a44
 v_mfma_f32_16x16x32_bf16 a[48:51], v[72:75], a[160:163], a[48:51]
 s_waitcnt lgkmcnt(4)
 v_mfma_f32_16x16x32_bf16 a[48:51], v[80:83], a[192:195], a[48:51]
 v_accvgpr_read_b32 v181, a45
 v_mfma_f32_16x16x32_bf16 a[48:51], v[84:87], a[208:211], a[48:51]
 v_accvgpr_read_b32 v182, a46
 v_mfma_f32_16x16x32_bf16 a[52:55], v[84:87], a[212:215], a[52:55]
 v_mfma_f32_16x16x32_bf16 a[52:55], v[80:83], a[196:199], a[52:55]
 v_accvgpr_read_b32 v183, a47
 v_mfma_f32_16x16x32_bf16 a[56:59], v[80:83], a[200:203], a[56:59]
 v_cvt_pk_bf16_f32 v120, v176, v177
 v_mfma_f32_16x16x32_bf16 a[56:59], v[84:87], a[216:219], a[56:59]
 v_mfma_f32_16x16x32_bf16 a[60:63], v[84:87], a[220:223], a[60:63]
 v_cvt_pk_bf16_f32 v121, v178, v179
 v_mfma_f32_16x16x32_bf16 a[60:63], v[80:83], a[204:207], a[60:63]
 s_waitcnt lgkmcnt(0)
 v_mfma_f32_16x16x32_bf16 a[60:63], v[88:91], a[236:239], a[60:63]
 v_cvt_pk_bf16_f32 v122, v180, v181
 v_mfma_f32_16x16x32_bf16 a[60:63], v[92:95], a[252:255], a[60:63]
 v_cvt_pk_bf16_f32 v123, v182, v183
 v_mfma_f32_16x16x32_bf16 a[56:59], v[92:95], a[248:251], a[56:59]
 v_mfma_f32_16x16x32_bf16 a[56:59], v[88:91], a[232:235], a[56:59]
 buffer_store_dwordx4 v[120:123], v25, s[60:63], s54 offen offset:2048 sc1
 v_mfma_f32_16x16x32_bf16 a[52:55], v[88:91], a[228:231], a[52:55]
 v_mfma_f32_16x16x32_bf16 a[52:55], v[92:95], a[244:247], a[52:55]
 v_mfma_f32_16x16x32_bf16 a[48:51], v[92:95], a[240:243], a[48:51]
 v_mfma_f32_16x16x32_bf16 a[48:51], v[88:91], a[224:227], a[48:51]
 s_mov_b32 s53, 0xffff0000
 v_add_u32 v23, 32768, v23
 s_nop 4
 s_lshl_b32 s52, s36, 13
 s_add_u32 s52, s52, 135168
 v_and_b32 v36, 0x37, v1
 v_lshlrev_b32 v36, 4, v36
 v_bfe_u32 v37, v1, 3, 1
 v_lshl_add_u32 v36, v37, 10, v36
 v_add_u32 v39, s52, v36
 ds_read_b128 v[96:99], v39
 ds_read_b128 v[100:103], v39 offset:128
 ds_read_b128 v[104:107], v39 offset:2048
 ds_read_b128 v[108:111], v39 offset:2176
 v_accvgpr_read_b32 v184, a56
 v_accvgpr_read_b32 v185, a57
 v_accvgpr_read_b32 v186, a58
 v_accvgpr_read_b32 v187, a59
 v_accvgpr_read_b32 v188, a60
 v_accvgpr_read_b32 v189, a61
 v_accvgpr_read_b32 v190, a62
 v_accvgpr_read_b32 v191, a63
 v_cvt_pk_bf16_f32 v124, v184, v185
 v_cvt_pk_bf16_f32 v125, v186, v187
 v_cvt_pk_bf16_f32 v126, v188, v189
 v_cvt_pk_bf16_f32 v127, v190, v191
 buffer_store_dwordx4 v[124:127], v25, s[60:63], s54 offen offset:3072 sc1
 v_mov_b32 v28, 0xbfb8aa3b
 v_mov_b32 v29, v28
 s_waitcnt vmcnt(23)
 v_lshlrev_b32 v32, 16, v192
 v_and_b32 v33, s53, v192
 v_lshlrev_b32 v34, 16, v193
 v_and_b32 v35, s53, v193
 v_lshlrev_b32 v36, 16, v194
 v_and_b32 v37, s53, v194
 v_lshlrev_b32 v38, 16, v195
 v_and_b32 v39, s53, v195
 v_pk_add_f32 v[128:129], v[128:129], v[32:33]
 v_pk_add_f32 v[130:131], v[130:131], v[34:35]
 v_pk_add_f32 v[132:133], v[132:133], v[36:37]
 v_pk_add_f32 v[134:135], v[134:135], v[38:39]
 s_waitcnt vmcnt(19)
 v_lshlrev_b32 v40, 16, v208
 v_and_b32 v41, s53, v208
 v_lshlrev_b32 v42, 16, v209
 v_and_b32 v43, s53, v209
 v_lshlrev_b32 v44, 16, v210
 v_and_b32 v45, s53, v210
 v_lshlrev_b32 v46, 16, v211
 v_and_b32 v47, s53, v211
 v_pk_add_f32 v[128:129], v[128:129], v[40:41]
 v_pk_add_f32 v[130:131], v[130:131], v[42:43]
 v_pk_add_f32 v[132:133], v[132:133], v[44:45]
 v_pk_add_f32 v[134:135], v[134:135], v[46:47]
 s_waitcnt vmcnt(15)
 v_lshlrev_b32 v32, 16, v224
 v_and_b32 v33, s53, v224
 v_lshlrev_b32 v34, 16, v225
 v_and_b32 v35, s53, v225
 v_lshlrev_b32 v36, 16, v226
 v_and_b32 v37, s53, v226
 v_lshlrev_b32 v38, 16, v227
 v_and_b32 v39, s53, v227
 v_pk_add_f32 v[128:129], v[128:129], v[32:33]
 v_pk_add_f32 v[130:131], v[130:131], v[34:35]
 v_pk_add_f32 v[132:133], v[132:133], v[36:37]
 v_pk_add_f32 v[134:135], v[134:135], v[38:39]
 v_pk_mul_f32 v[48:49], v[128:129], v[28:29]
 v_pk_mul_f32 v[50:51], v[130:131], v[28:29]
 v_pk_mul_f32 v[52:53], v[132:133], v[28:29]
 v_pk_mul_f32 v[54:55], v[134:135], v[28:29]
 v_exp_f32 v48, v48
 v_exp_f32 v49, v49
 v_exp_f32 v50, v50
 v_exp_f32 v51, v51
 v_exp_f32 v52, v52
 v_exp_f32 v53, v53
 v_exp_f32 v54, v54
 v_exp_f32 v55, v55
 s_nop 0
 v_pk_add_f32 v[48:49], v[48:49], 1.0 op_sel_hi:[1,0]
 v_pk_add_f32 v[50:51], v[50:51], 1.0 op_sel_hi:[1,0]
 v_pk_add_f32 v[52:53], v[52:53], 1.0 op_sel_hi:[1,0]
 v_pk_add_f32 v[54:55], v[54:55], 1.0 op_sel_hi:[1,0]
 v_rcp_f32 v48, v48
 v_rcp_f32 v49, v49
 v_rcp_f32 v50, v50
 v_rcp_f32 v51, v51
 v_rcp_f32 v52, v52
 v_rcp_f32 v53, v53
 v_rcp_f32 v54, v54
 v_rcp_f32 v55, v55
 s_nop 0
 v_pk_mul_f32 v[128:129], v[128:129], v[48:49]
 v_pk_mul_f32 v[130:131], v[130:131], v[50:51]
 v_pk_mul_f32 v[132:133], v[132:133], v[52:53]
 v_pk_mul_f32 v[134:135], v[134:135], v[54:55]
 v_lshlrev_b32 v32, 16, v196
 v_and_b32 v33, s53, v196
 v_lshlrev_b32 v34, 16, v197
 v_and_b32 v35, s53, v197
 v_lshlrev_b32 v36, 16, v198
 v_and_b32 v37, s53, v198
 v_lshlrev_b32 v38, 16, v199
 v_and_b32 v39, s53, v199
 v_pk_add_f32 v[136:137], v[136:137], v[32:33]
 v_pk_add_f32 v[138:139], v[138:139], v[34:35]
 v_pk_add_f32 v[140:141], v[140:141], v[36:37]
 v_pk_add_f32 v[142:143], v[142:143], v[38:39]
 v_lshlrev_b32 v40, 16, v212
 v_and_b32 v41, s53, v212
 v_lshlrev_b32 v42, 16, v213
 v_and_b32 v43, s53, v213
 v_lshlrev_b32 v44, 16, v214
 v_and_b32 v45, s53, v214
 v_lshlrev_b32 v46, 16, v215
 v_and_b32 v47, s53, v215
 v_pk_add_f32 v[136:137], v[136:137], v[40:41]
 v_pk_add_f32 v[138:139], v[138:139], v[42:43]
 v_pk_add_f32 v[140:141], v[140:141], v[44:45]
 v_pk_add_f32 v[142:143], v[142:143], v[46:47]
 s_waitcnt vmcnt(14)
 v_lshlrev_b32 v32, 16, v228
 v_and_b32 v33, s53, v228
 v_lshlrev_b32 v34, 16, v229
 v_and_b32 v35, s53, v229
 v_lshlrev_b32 v36, 16, v230
 v_and_b32 v37, s53, v230
 v_lshlrev_b32 v38, 16, v231
 v_and_b32 v39, s53, v231
 v_pk_add_f32 v[136:137], v[136:137], v[32:33]
 v_pk_add_f32 v[138:139], v[138:139], v[34:35]
 v_pk_add_f32 v[140:141], v[140:141], v[36:37]
 v_pk_add_f32 v[142:143], v[142:143], v[38:39]
 v_pk_mul_f32 v[48:49], v[136:137], v[28:29]
 v_pk_mul_f32 v[50:51], v[138:139], v[28:29]
 v_pk_mul_f32 v[52:53], v[140:141], v[28:29]
 v_pk_mul_f32 v[54:55], v[142:143], v[28:29]
 v_exp_f32 v48, v48
 v_exp_f32 v49, v49
 v_exp_f32 v50, v50
 v_exp_f32 v51, v51
 v_exp_f32 v52, v52
 v_exp_f32 v53, v53
 v_exp_f32 v54, v54
 v_exp_f32 v55, v55
 s_nop 0
 v_pk_add_f32 v[48:49], v[48:49], 1.0 op_sel_hi:[1,0]
 v_pk_add_f32 v[50:51], v[50:51], 1.0 op_sel_hi:[1,0]
 v_pk_add_f32 v[52:53], v[52:53], 1.0 op_sel_hi:[1,0]
 v_pk_add_f32 v[54:55], v[54:55], 1.0 op_sel_hi:[1,0]
 v_rcp_f32 v48, v48
 v_rcp_f32 v49, v49
 v_rcp_f32 v50, v50
 v_rcp_f32 v51, v51
 v_rcp_f32 v52, v52
 v_rcp_f32 v53, v53
 v_rcp_f32 v54, v54
 v_rcp_f32 v55, v55
 s_nop 0
 v_pk_mul_f32 v[136:137], v[136:137], v[48:49]
 v_pk_mul_f32 v[138:139], v[138:139], v[50:51]
 v_pk_mul_f32 v[140:141], v[140:141], v[52:53]
 v_pk_mul_f32 v[142:143], v[142:143], v[54:55]
 v_lshlrev_b32 v32, 16, v200
 v_and_b32 v33, s53, v200
 v_lshlrev_b32 v34, 16, v201
 v_and_b32 v35, s53, v201
 v_lshlrev_b32 v36, 16, v202
 v_and_b32 v37, s53, v202
 v_lshlrev_b32 v38, 16, v203
 v_and_b32 v39, s53, v203
 v_pk_add_f32 v[144:145], v[144:145], v[32:33]
 v_pk_add_f32 v[146:147], v[146:147], v[34:35]
 v_pk_add_f32 v[148:149], v[148:149], v[36:37]
 v_pk_add_f32 v[150:151], v[150:151], v[38:39]
 v_lshlrev_b32 v40, 16, v216
 v_and_b32 v41, s53, v216
 v_lshlrev_b32 v42, 16, v217
 v_and_b32 v43, s53, v217
 v_lshlrev_b32 v44, 16, v218
 v_and_b32 v45, s53, v218
 v_lshlrev_b32 v46, 16, v219
 v_and_b32 v47, s53, v219
 v_pk_add_f32 v[144:145], v[144:145], v[40:41]
 v_pk_add_f32 v[146:147], v[146:147], v[42:43]
 v_pk_add_f32 v[148:149], v[148:149], v[44:45]
 v_pk_add_f32 v[150:151], v[150:151], v[46:47]
 s_waitcnt vmcnt(13)
 v_lshlrev_b32 v32, 16, v232
 v_and_b32 v33, s53, v232
 v_lshlrev_b32 v34, 16, v233
 v_and_b32 v35, s53, v233
 v_lshlrev_b32 v36, 16, v234
 v_and_b32 v37, s53, v234
 v_lshlrev_b32 v38, 16, v235
 v_and_b32 v39, s53, v235
 v_pk_add_f32 v[144:145], v[144:145], v[32:33]
 v_pk_add_f32 v[146:147], v[146:147], v[34:35]
 v_pk_add_f32 v[148:149], v[148:149], v[36:37]
 v_pk_add_f32 v[150:151], v[150:151], v[38:39]
 v_pk_mul_f32 v[48:49], v[144:145], v[28:29]
 v_pk_mul_f32 v[50:51], v[146:147], v[28:29]
 v_pk_mul_f32 v[52:53], v[148:149], v[28:29]
 v_pk_mul_f32 v[54:55], v[150:151], v[28:29]
 v_exp_f32 v48, v48
 v_exp_f32 v49, v49
 v_exp_f32 v50, v50
 v_exp_f32 v51, v51
 v_exp_f32 v52, v52
 v_exp_f32 v53, v53
 v_exp_f32 v54, v54
 v_exp_f32 v55, v55
 s_nop 0
 v_pk_add_f32 v[48:49], v[48:49], 1.0 op_sel_hi:[1,0]
 v_pk_add_f32 v[50:51], v[50:51], 1.0 op_sel_hi:[1,0]
 v_pk_add_f32 v[52:53], v[52:53], 1.0 op_sel_hi:[1,0]
 v_pk_add_f32 v[54:55], v[54:55], 1.0 op_sel_hi:[1,0]
 v_rcp_f32 v48, v48
 v_rcp_f32 v49, v49
 v_rcp_f32 v50, v50
 v_rcp_f32 v51, v51
 v_rcp_f32 v52, v52
 v_rcp_f32 v53, v53
 v_rcp_f32 v54, v54
 v_rcp_f32 v55, v55
 s_nop 0
 v_pk_mul_f32 v[144:145], v[144:145], v[48:49]
 v_pk_mul_f32 v[146:147], v[146:147], v[50:51]
 v_pk_mul_f32 v[148:149], v[148:149], v[52:53]
 v_pk_mul_f32 v[150:151], v[150:151], v[54:55]
 v_lshlrev_b32 v32, 16, v204
 v_and_b32 v33, s53, v204
 v_lshlrev_b32 v34, 16, v205
 v_and_b32 v35, s53, v205
 v_lshlrev_b32 v36, 16, v206
 v_and_b32 v37, s53, v206
 v_lshlrev_b32 v38, 16, v207
 v_and_b32 v39, s53, v207
 v_pk_add_f32 v[152:153], v[152:153], v[32:33]
 v_pk_add_f32 v[154:155], v[154:155], v[34:35]
 v_pk_add_f32 v[156:157], v[156:157], v[36:37]
 v_pk_add_f32 v[158:159], v[158:159], v[38:39]
 v_lshlrev_b32 v40, 16, v220
 v_and_b32 v41, s53, v220
 v_lshlrev_b32 v42, 16, v221
 v_and_b32 v43, s53, v221
 v_lshlrev_b32 v44, 16, v222
 v_and_b32 v45, s53, v222
 v_lshlrev_b32 v46, 16, v223
 v_and_b32 v47, s53, v223
 v_pk_add_f32 v[152:153], v[152:153], v[40:41]
 v_pk_add_f32 v[154:155], v[154:155], v[42:43]
 v_pk_add_f32 v[156:157], v[156:157], v[44:45]
 v_pk_add_f32 v[158:159], v[158:159], v[46:47]
 s_waitcnt vmcnt(12)
 v_lshlrev_b32 v32, 16, v236
 v_and_b32 v33, s53, v236
 v_lshlrev_b32 v34, 16, v237
 v_and_b32 v35, s53, v237
 v_lshlrev_b32 v36, 16, v238
 v_and_b32 v37, s53, v238
 v_lshlrev_b32 v38, 16, v239
 v_and_b32 v39, s53, v239
 v_pk_add_f32 v[152:153], v[152:153], v[32:33]
 v_pk_add_f32 v[154:155], v[154:155], v[34:35]
 v_pk_add_f32 v[156:157], v[156:157], v[36:37]
 v_pk_add_f32 v[158:159], v[158:159], v[38:39]
 v_pk_mul_f32 v[48:49], v[152:153], v[28:29]
 v_pk_mul_f32 v[50:51], v[154:155], v[28:29]
 v_pk_mul_f32 v[52:53], v[156:157], v[28:29]
 v_pk_mul_f32 v[54:55], v[158:159], v[28:29]
 v_exp_f32 v48, v48
 v_exp_f32 v49, v49
 v_exp_f32 v50, v50
 v_exp_f32 v51, v51
 v_exp_f32 v52, v52
 v_exp_f32 v53, v53
 v_exp_f32 v54, v54
 v_exp_f32 v55, v55
 s_nop 0
 v_pk_add_f32 v[48:49], v[48:49], 1.0 op_sel_hi:[1,0]
 v_pk_add_f32 v[50:51], v[50:51], 1.0 op_sel_hi:[1,0]
 v_pk_add_f32 v[52:53], v[52:53], 1.0 op_sel_hi:[1,0]
 v_pk_add_f32 v[54:55], v[54:55], 1.0 op_sel_hi:[1,0]
 v_rcp_f32 v48, v48
 v_rcp_f32 v49, v49
 v_rcp_f32 v50, v50
 v_rcp_f32 v51, v51
 v_rcp_f32 v52, v52
 v_rcp_f32 v53, v53
 v_rcp_f32 v54, v54
 v_rcp_f32 v55, v55
 s_nop 0
 v_pk_mul_f32 v[152:153], v[152:153], v[48:49]
 v_pk_mul_f32 v[154:155], v[154:155], v[50:51]
 v_pk_mul_f32 v[156:157], v[156:157], v[52:53]
 v_pk_mul_f32 v[158:159], v[158:159], v[54:55]
 v_accvgpr_read_b32 v64, a0
 v_accvgpr_read_b32 v65, a1
 v_accvgpr_read_b32 v66, a2
 v_accvgpr_read_b32 v67, a3
 v_accvgpr_read_b32 v68, a4
 v_accvgpr_read_b32 v69, a5
 v_accvgpr_read_b32 v70, a6
 v_accvgpr_read_b32 v71, a7
 v_accvgpr_read_b32 v72, a16
 v_accvgpr_read_b32 v73, a17
 v_accvgpr_read_b32 v74, a18
 v_accvgpr_read_b32 v75, a19
 v_accvgpr_read_b32 v76, a20
 v_accvgpr_read_b32 v77, a21
 v_accvgpr_read_b32 v78, a22
 v_accvgpr_read_b32 v79, a23
 v_accvgpr_read_b32 v80, a32
 v_accvgpr_read_b32 v81, a33
 v_accvgpr_read_b32 v82, a34
 v_accvgpr_read_b32 v83, a35
 v_accvgpr_read_b32 v84, a36
 v_accvgpr_read_b32 v85, a37
 v_accvgpr_read_b32 v86, a38
 v_accvgpr_read_b32 v87, a39
 v_accvgpr_read_b32 v88, a48
 v_accvgpr_read_b32 v89, a49
 v_accvgpr_read_b32 v90, a50
 v_accvgpr_read_b32 v91, a51
 v_accvgpr_read_b32 v92, a52
 v_accvgpr_read_b32 v93, a53
 v_accvgpr_read_b32 v94, a54
 v_accvgpr_read_b32 v95, a55
 s_waitcnt vmcnt(0)
 s_barrier
 s_cmp_eq_u32 s36, 1
 s_cbranch_scc0 C_got_79
 buffer_store_dwordx2 v[2:3], v22, s[56:59], 0 offen sc1
C_poll_79:
 buffer_load_dwordx2 v[36:37], v23, s[56:59], 0 offen sc1
 s_waitcnt vmcnt(0)
 v_cmp_ne_u64 vcc, s[6:7], v[36:37]
 s_nop 1
 s_cbranch_vccz C_got_79
 s_sleep 1
 s_branch C_poll_79
C_got_79:
 s_barrier
 s_add_u32 s52, s33, 12582912
 buffer_load_dwordx4 v[192:195], v24, s[60:63], s52 offen sc1
 buffer_load_dwordx4 v[196:199], v24, s[60:63], s52 offen offset:1024 sc1
 buffer_load_dwordx4 v[200:203], v24, s[60:63], s52 offen offset:2048 sc1
 buffer_load_dwordx4 v[204:207], v24, s[60:63], s52 offen offset:3072 sc1
 s_add_u32 s52, s52, 4096
 buffer_load_dwordx4 v[208:211], v24, s[60:63], s52 offen sc1
 buffer_load_dwordx4 v[212:215], v24, s[60:63], s52 offen offset:1024 sc1
 buffer_load_dwordx4 v[216:219], v24, s[60:63], s52 offen offset:2048 sc1
 buffer_load_dwordx4 v[220:223], v24, s[60:63], s52 offen offset:3072 sc1
 s_add_u32 s52, s52, 4096
 buffer_load_dwordx4 v[224:227], v24, s[60:63], s52 offen sc1
 buffer_load_dwordx4 v[228:231], v24, s[60:63], s52 offen offset:1024 sc1
 buffer_load_dwordx4 v[232:235], v24, s[60:63], s52 offen offset:2048 sc1
 buffer_load_dwordx4 v[236:239], v24, s[60:63], s52 offen offset:3072 sc1
 s_waitcnt lgkmcnt(3)
 v_lshlrev_b32 v160, 16, v96
 v_and_b32 v161, s53, v96
 v_lshlrev_b32 v162, 16, v97
 v_and_b32 v163, s53, v97
 v_lshlrev_b32 v164, 16, v98
 v_and_b32 v165, s53, v98
 v_lshlrev_b32 v166, 16, v99
 v_and_b32 v167, s53, v99
 s_waitcnt lgkmcnt(2)
 v_lshlrev_b32 v168, 16, v100
 v_and_b32 v169, s53, v100
 v_lshlrev_b32 v170, 16, v101
 v_and_b32 v171, s53, v101
 v_lshlrev_b32 v172, 16, v102
 v_and_b32 v173, s53, v102
 v_lshlrev_b32 v174, 16, v103
 v_and_b32 v175, s53, v103
 s_waitcnt lgkmcnt(1)
 v_lshlrev_b32 v176, 16, v104
 v_and_b32 v177, s53, v104
 v_lshlrev_b32 v178, 16, v105
 v_and_b32 v179, s53, v105
 v_lshlrev_b32 v180, 16, v106
 v_and_b32 v181, s53, v106
 v_lshlrev_b32 v182, 16, v107
 v_and_b32 v183, s53, v107
 s_waitcnt lgkmcnt(0)
 v_lshlrev_b32 v184, 16, v108
 v_and_b32 v185, s53, v108
 v_lshlrev_b32 v186, 16, v109
 v_and_b32 v187, s53, v109
 v_lshlrev_b32 v188, 16, v110
 v_and_b32 v189, s53, v110
 v_lshlrev_b32 v190, 16, v111
 v_and_b32 v191, s53, v111
 s_waitcnt vmcnt(11)
 v_lshlrev_b32 v32, 16, v192
 v_and_b32 v33, s53, v192
 v_lshlrev_b32 v34, 16, v193
 v_and_b32 v35, s53, v193
 v_lshlrev_b32 v36, 16, v194
 v_and_b32 v37, s53, v194
 v_lshlrev_b32 v38, 16, v195
 v_and_b32 v39, s53, v195
 v_pk_add_f32 v[64:65], v[64:65], v[32:33]
 v_pk_add_f32 v[66:67], v[66:67], v[34:35]
 v_pk_add_f32 v[68:69], v[68:69], v[36:37]
 v_pk_add_f32 v[70:71], v[70:71], v[38:39]
 s_waitcnt vmcnt(7)
 v_lshlrev_b32 v40, 16, v208
 v_and_b32 v41, s53, v208
 v_lshlrev_b32 v42, 16, v209
 v_and_b32 v43, s53, v209
 v_lshlrev_b32 v44, 16, v210
 v_and_b32 v45, s53, v210
 v_lshlrev_b32 v46, 16, v211
 v_and_b32 v47, s53, v211
 v_pk_add_f32 v[64:65], v[64:65], v[40:41]
 v_pk_add_f32 v[66:67], v[66:67], v[42:43]
 v_pk_add_f32 v[68:69], v[68:69], v[44:45]
 v_pk_add_f32 v[70:71], v[70:71], v[46:47]
 s_waitcnt vmcnt(3)
 v_lshlrev_b32 v32, 16, v224
 v_and_b32 v33, s53, v224
 v_lshlrev_b32 v34, 16, v225
 v_and_b32 v35, s53, v225
 v_lshlrev_b32 v36, 16, v226
 v_and_b32 v37, s53, v226
 v_lshlrev_b32 v38, 16, v227
 v_and_b32 v39, s53, v227
 v_pk_add_f32 v[64:65], v[64:65], v[32:33]
 v_pk_add_f32 v[66:67], v[66:67], v[34:35]
 v_pk_add_f32 v[68:69], v[68:69], v[36:37]
 v_pk_add_f32 v[70:71], v[70:71], v[38:39]
 v_lshlrev_b32 v32, 16, v196
 v_and_b32 v33, s53, v196
 v_lshlrev_b32 v34, 16, v197
 v_and_b32 v35, s53, v197
 v_lshlrev_b32 v36, 16, v198
 v_and_b32 v37, s53, v198
 v_lshlrev_b32 v38, 16, v199
 v_and_b32 v39, s53, v199
 v_pk_add_f32 v[72:73], v[72:73], v[32:33]
 v_pk_add_f32 v[74:75], v[74:75], v[34:35]
 v_pk_add_f32 v[76:77], v[76:77], v[36:37]
 v_pk_add_f32 v[78:79], v[78:79], v[38:39]
 v_lshlrev_b32 v40, 16, v212
 v_and_b32 v41, s53, v212
 v_lshlrev_b32 v42, 16, v213
 v_and_b32 v43, s53, v213
 v_lshlrev_b32 v44, 16, v214
 v_and_b32 v45, s53, v214
 v_lshlrev_b32 v46, 16, v215
 v_and_b32 v47, s53, v215
 v_pk_add_f32 v[72:73], v[72:73], v[40:41]
 v_pk_add_f32 v[74:75], v[74:75], v[42:43]
 v_pk_add_f32 v[76:77], v[76:77], v[44:45]
 v_pk_add_f32 v[78:79], v[78:79], v[46:47]
 s_waitcnt vmcnt(2)
 v_lshlrev_b32 v32, 16, v228
 v_and_b32 v33, s53, v228
 v_lshlrev_b32 v34, 16, v229
 v_and_b32 v35, s53, v229
 v_lshlrev_b32 v36, 16, v230
 v_and_b32 v37, s53, v230
 v_lshlrev_b32 v38, 16, v231
 v_and_b32 v39, s53, v231
 v_pk_add_f32 v[72:73], v[72:73], v[32:33]
 v_pk_add_f32 v[74:75], v[74:75], v[34:35]
 v_pk_add_f32 v[76:77], v[76:77], v[36:37]
 v_pk_add_f32 v[78:79], v[78:79], v[38:39]
 v_lshlrev_b32 v32, 16, v200
 v_and_b32 v33, s53, v200
 v_lshlrev_b32 v34, 16, v201
 v_and_b32 v35, s53, v201
 v_lshlrev_b32 v36, 16, v202
 v_and_b32 v37, s53, v202
 v_lshlrev_b32 v38, 16, v203
 v_and_b32 v39, s53, v203
 v_pk_add_f32 v[80:81], v[80:81], v[32:33]
 v_pk_add_f32 v[82:83], v[82:83], v[34:35]
 v_pk_add_f32 v[84:85], v[84:85], v[36:37]
 v_pk_add_f32 v[86:87], v[86:87], v[38:39]
 v_lshlrev_b32 v40, 16, v216
 v_and_b32 v41, s53, v216
 v_lshlrev_b32 v42, 16, v217
 v_and_b32 v43, s53, v217
 v_lshlrev_b32 v44, 16, v218
 v_and_b32 v45, s53, v218
 v_lshlrev_b32 v46, 16, v219
 v_and_b32 v47, s53, v219
 v_pk_add_f32 v[80:81], v[80:81], v[40:41]
 v_pk_add_f32 v[82:83], v[82:83], v[42:43]
 v_pk_add_f32 v[84:85], v[84:85], v[44:45]
 v_pk_add_f32 v[86:87], v[86:87], v[46:47]
 s_waitcnt vmcnt(1)
 v_lshlrev_b32 v32, 16, v232
 v_and_b32 v33, s53, v232
 v_lshlrev_b32 v34, 16, v233
 v_and_b32 v35, s53, v233
 v_lshlrev_b32 v36, 16, v234
 v_and_b32 v37, s53, v234
 v_lshlrev_b32 v38, 16, v235
 v_and_b32 v39, s53, v235
 v_pk_add_f32 v[80:81], v[80:81], v[32:33]
 v_pk_add_f32 v[82:83], v[82:83], v[34:35]
 v_pk_add_f32 v[84:85], v[84:85], v[36:37]
 v_pk_add_f32 v[86:87], v[86:87], v[38:39]
 v_lshlrev_b32 v32, 16, v204
 v_and_b32 v33, s53, v204
 v_lshlrev_b32 v34, 16, v205
 v_and_b32 v35, s53, v205
 v_lshlrev_b32 v36, 16, v206
 v_and_b32 v37, s53, v206
 v_lshlrev_b32 v38, 16, v207
 v_and_b32 v39, s53, v207
 v_pk_add_f32 v[88:89], v[88:89], v[32:33]
 v_pk_add_f32 v[90:91], v[90:91], v[34:35]
 v_pk_add_f32 v[92:93], v[92:93], v[36:37]
 v_pk_add_f32 v[94:95], v[94:95], v[38:39]
 v_lshlrev_b32 v40, 16, v220
 v_and_b32 v41, s53, v220
 v_lshlrev_b32 v42, 16, v221
 v_and_b32 v43, s53, v221
 v_lshlrev_b32 v44, 16, v222
 v_and_b32 v45, s53, v222
 v_lshlrev_b32 v46, 16, v223
 v_and_b32 v47, s53, v223
 v_pk_add_f32 v[88:89], v[88:89], v[40:41]
 v_pk_add_f32 v[90:91], v[90:91], v[42:43]
 v_pk_add_f32 v[92:93], v[92:93], v[44:45]
 v_pk_add_f32 v[94:95], v[94:95], v[46:47]
 s_waitcnt vmcnt(0)
 v_lshlrev_b32 v32, 16, v236
 v_and_b32 v33, s53, v236
 v_lshlrev_b32 v34, 16, v237
 v_and_b32 v35, s53, v237
 v_lshlrev_b32 v36, 16, v238
 v_and_b32 v37, s53, v238
 v_lshlrev_b32 v38, 16, v239
 v_and_b32 v39, s53, v239
 v_pk_add_f32 v[88:89], v[88:89], v[32:33]
 v_pk_add_f32 v[90:91], v[90:91], v[34:35]
 v_pk_add_f32 v[92:93], v[92:93], v[36:37]
 v_pk_add_f32 v[94:95], v[94:95], v[38:39]
 v_pk_mul_f32 v[64:65], v[64:65], v[128:129]
 v_pk_mul_f32 v[66:67], v[66:67], v[130:131]
 v_pk_mul_f32 v[68:69], v[68:69], v[132:133]
 v_pk_mul_f32 v[70:71], v[70:71], v[134:135]
 v_pk_mul_f32 v[72:73], v[72:73], v[136:137]
 v_pk_mul_f32 v[74:75], v[74:75], v[138:139]
 v_pk_mul_f32 v[76:77], v[76:77], v[140:141]
 v_pk_mul_f32 v[78:79], v[78:79], v[142:143]
 v_pk_mul_f32 v[80:81], v[80:81], v[144:145]
 v_pk_mul_f32 v[82:83], v[82:83], v[146:147]
 v_pk_mul_f32 v[84:85], v[84:85], v[148:149]
 v_pk_mul_f32 v[86:87], v[86:87], v[150:151]
 v_pk_mul_f32 v[88:89], v[88:89], v[152:153]
 v_pk_mul_f32 v[90:91], v[90:91], v[154:155]
 v_pk_mul_f32 v[92:93], v[92:93], v[156:157]
 v_pk_mul_f32 v[94:95], v[94:95], v[158:159]
 v_permlane16_swap_b32 v64, v72
 v_permlane16_swap_b32 v65, v73
 v_permlane16_swap_b32 v66, v74
 v_permlane16_swap_b32 v67, v75
 v_permlane16_swap_b32 v80, v88
 v_permlane16_swap_b32 v81, v89
 v_permlane16_swap_b32 v82, v90
 v_permlane16_swap_b32 v83, v91
 v_pk_add_f32 v[160:161], v[160:161], v[64:65]
 v_pk_add_f32 v[162:163], v[162:163], v[66:67]
 v_pk_add_f32 v[164:165], v[164:165], v[72:73]
 v_pk_add_f32 v[166:167], v[166:167], v[74:75]
 v_cvt_pk_bf16_f32 v112, v160, v161
 v_cvt_pk_bf16_f32 v113, v162, v163
 v_cvt_pk_bf16_f32 v114, v164, v165
 v_cvt_pk_bf16_f32 v115, v166, v167
 v_pk_add_f32 v[168:169], v[168:169], v[80:81]
 v_pk_add_f32 v[170:171], v[170:171], v[82:83]
 v_pk_add_f32 v[172:173], v[172:173], v[88:89]
 v_pk_add_f32 v[174:175], v[174:175], v[90:91]
 v_cvt_pk_bf16_f32 v116, v168, v169
 v_cvt_pk_bf16_f32 v117, v170, v171
 v_cvt_pk_bf16_f32 v118, v172, v173
 v_cvt_pk_bf16_f32 v119, v174, v175
 v_mov_b32 v32, v116
 v_mov_b32 v33, v117
 v_mov_b32 v34, v118
 v_mov_b32 v35, v119
 v_mov_b32_dpp v116, v112 row_ror:8 row_mask:0xf bank_mask:0x3
 v_mov_b32_dpp v117, v113 row_ror:8 row_mask:0xf bank_mask:0x3
 v_mov_b32_dpp v118, v114 row_ror:8 row_mask:0xf bank_mask:0x3
 v_mov_b32_dpp v119, v115 row_ror:8 row_mask:0xf bank_mask:0x3
 v_mov_b32_dpp v112, v32 row_ror:8 row_mask:0xf bank_mask:0xc
 v_mov_b32_dpp v113, v33 row_ror:8 row_mask:0xf bank_mask:0xc
 v_mov_b32_dpp v114, v34 row_ror:8 row_mask:0xf bank_mask:0xc
 v_mov_b32_dpp v115, v35 row_ror:8 row_mask:0xf bank_mask:0xc
 s_mov_b32 s50, 0
 s_mov_b32 s51, 16384
 buffer_store_dwordx4 v[112:115], v16, s[28:31], s50 offen sc1
 buffer_store_dwordx4 v[116:119], v16, s[28:31], s51 offen sc1
 v_permlane16_swap_b32 v68, v76
 v_permlane16_swap_b32 v69, v77
 v_permlane16_swap_b32 v70, v78
 v_permlane16_swap_b32 v71, v79
 v_permlane16_swap_b32 v84, v92
 v_permlane16_swap_b32 v85, v93
 v_permlane16_swap_b32 v86, v94
 v_permlane16_swap_b32 v87, v95
 v_pk_add_f32 v[176:177], v[176:177], v[68:69]
 v_pk_add_f32 v[178:179], v[178:179], v[70:71]
 v_pk_add_f32 v[180:181], v[180:181], v[76:77]
 v_pk_add_f32 v[182:183], v[182:183], v[78:79]
 v_cvt_pk_bf16_f32 v120, v176, v177
 v_cvt_pk_bf16_f32 v121, v178, v179
 v_cvt_pk_bf16_f32 v122, v180, v181
 v_cvt_pk_bf16_f32 v123, v182, v183
 v_pk_add_f32 v[184:185], v[184:185], v[84:85]
 v_pk_add_f32 v[186:187], v[186:187], v[86:87]
 v_pk_add_f32 v[188:189], v[188:189], v[92:93]
 v_pk_add_f32 v[190:191], v[190:191], v[94:95]
 v_cvt_pk_bf16_f32 v124, v184, v185
 v_cvt_pk_bf16_f32 v125, v186, v187
 v_cvt_pk_bf16_f32 v126, v188, v189
 v_cvt_pk_bf16_f32 v127, v190, v191
 v_mov_b32 v32, v124
 v_mov_b32 v33, v125
 v_mov_b32 v34, v126
 v_mov_b32 v35, v127
 v_mov_b32_dpp v124, v120 row_ror:8 row_mask:0xf bank_mask:0x3
 v_mov_b32_dpp v125, v121 row_ror:8 row_mask:0xf bank_mask:0x3
 v_mov_b32_dpp v126, v122 row_ror:8 row_mask:0xf bank_mask:0x3
 v_mov_b32_dpp v127, v123 row_ror:8 row_mask:0xf bank_mask:0x3
 v_mov_b32_dpp v120, v32 row_ror:8 row_mask:0xf bank_mask:0xc
 v_mov_b32_dpp v121, v33 row_ror:8 row_mask:0xf bank_mask:0xc
 v_mov_b32_dpp v122, v34 row_ror:8 row_mask:0xf bank_mask:0xc
 v_mov_b32_dpp v123, v35 row_ror:8 row_mask:0xf bank_mask:0xc
 s_mov_b32 s50, 32768
 s_mov_b32 s51, 49152
 buffer_store_dwordx4 v[120:123], v16, s[28:31], s50 offen sc1
 buffer_store_dwordx4 v[124:127], v16, s[28:31], s51 offen sc1
 s_endpgm
C_short:

 s_waitcnt vmcnt(28) lgkmcnt(8)
 v_mfma_f32_16x16x32_bf16 v[128:131], v[64:67], a[128:131], 0
 ds_read_b64_tr_b16 v[84:85], v54 offset:8192
 buffer_load_dwordx4 a[208:211], v48, s[16:19], s78 offen offset:1024 sc1
 s_waitcnt vmcnt(25) lgkmcnt(7)
 v_mfma_f32_16x16x32_bf16 v[128:131], v[68:71], a[144:147], v[128:131]
 ds_read_b64_tr_b16 v[86:87], v54 offset:12288
 s_waitcnt vmcnt(24)
 v_mfma_f32_16x16x32_bf16 v[132:135], v[68:71], a[148:151], 0
 s_lshl_b32 s50, s37, 4
 s_lshl_b32 s51, s36, 2
 v_mfma_f32_16x16x32_bf16 v[132:135], v[64:67], a[132:135], v[132:135]
 s_add_u32 s50, s50, s51
 v_mfma_f32_16x16x32_bf16 v[136:139], v[64:67], a[136:139], 0
 ds_read_b64_tr_b16 v[88:89], v55
 s_add_u32 m0, s79, 65536
 s_waitcnt vmcnt(23)
 v_mfma_f32_16x16x32_bf16 v[136:139], v[68:71], a[152:155], v[136:139]
 ds_read_b64_tr_b16 v[90:91], v55 offset:4096
 s_mul_i32 s50, s50, 131328
 s_waitcnt vmcnt(22)
 v_mfma_f32_16x16x32_bf16 v[140:143], v[68:71], a[156:159], 0
 buffer_load_dwordx4 v40, s[12:15], s77 offen  lds
 s_lshl_b32 s51, s38, 12
 v_mfma_f32_16x16x32_bf16 v[140:143], v[64:67], a[140:143], v[140:143]
 s_waitcnt lgkmcnt(6)
 v_mfma_f32_16x16x32_bf16 v[156:159], v[72:75], a[140:143], 0
 ds_read_b64_tr_b16 v[92:93], v55 offset:8192
 buffer_load_dwordx4 a[212:215], v49, s[16:19], s78 offen offset:1024 sc1
 v_mfma_f32_16x16x32_bf16 v[156:159], v[76:79], a[156:159], v[156:159]
 ds_read_b64_tr_b16 v[94:95], v55 offset:12288
 s_add_u32 s50, s50, s51
 v_mfma_f32_16x16x32_bf16 v[152:155], v[76:79], a[152:155], 0
 v_lshlrev_b32 v34, 4, v1
 v_accvgpr_read_b32 v96, a0
 v_mfma_f32_16x16x32_bf16 v[152:155], v[72:75], a[136:139], v[152:155]
 v_accvgpr_read_b32 v97, a1
 v_mfma_f32_16x16x32_bf16 v[148:151], v[72:75], a[132:135], 0
 ds_read_b64_tr_b16 v[64:65], v56
 v_accvgpr_read_b32 v98, a2
 v_mfma_f32_16x16x32_bf16 v[148:151], v[76:79], a[148:151], v[148:151]
 ds_read_b64_tr_b16 v[66:67], v56 offset:4096
 v_accvgpr_read_b32 v99, a3
 v_mfma_f32_16x16x32_bf16 v[144:147], v[76:79], a[144:147], 0
 v_accvgpr_read_b32 v100, a16
 v_accvgpr_read_b32 v101, a17
 v_mfma_f32_16x16x32_bf16 v[144:147], v[72:75], a[128:131], v[144:147]
 s_waitcnt lgkmcnt(6)
 v_mfma_f32_16x16x32_bf16 v[160:163], v[80:83], a[128:131], 0
 ds_read_b64_tr_b16 v[68:69], v56 offset:8192
 buffer_load_dwordx4 a[216:219], v50, s[16:19], s78 offen offset:1024 sc1
 v_mfma_f32_16x16x32_bf16 v[160:163], v[84:87], a[144:147], v[160:163]
 ds_read_b64_tr_b16 v[70:71], v56 offset:12288
 v_accvgpr_read_b32 v102, a18
 v_mfma_f32_16x16x32_bf16 v[164:167], v[84:87], a[148:151], 0
 v_accvgpr_read_b32 v103, a19
 v_mul_f32 v96, v96, v28
 v_mfma_f32_16x16x32_bf16 v[164:167], v[80:83], a[132:135], v[164:167]
 v_mul_f32 v97, v97, v28
 v_mfma_f32_16x16x32_bf16 v[168:171], v[80:83], a[136:139], 0
 ds_read_b64_tr_b16 v[72:73], v57
 buffer_load_dwordx4 v41, s[12:15], s77 offen offset:1024  lds
 v_mfma_f32_16x16x32_bf16 v[168:171], v[84:87], a[152:155], v[168:171]
 ds_read_b64_tr_b16 v[74:75], v57 offset:4096
 v_mul_f32 v98, v98, v28
 v_mfma_f32_16x16x32_bf16 v[172:175], v[84:87], a[156:159], 0
 v_mul_f32 v99, v99, v28
 v_mul_f32 v100, v100, v28
 v_mfma_f32_16x16x32_bf16 v[172:175], v[80:83], a[140:143], v[172:175]
 s_waitcnt lgkmcnt(6)
 v_mfma_f32_16x16x32_bf16 v[188:191], v[88:91], a[140:143], 0
 ds_read_b64_tr_b16 v[76:77], v57 offset:8192
 buffer_load_dwordx4 a[220:223], v51, s[16:19], s78 offen offset:1024 sc1
 v_mfma_f32_16x16x32_bf16 v[188:191], v[92:95], a[156:159], v[188:191]
 ds_read_b64_tr_b16 v[78:79], v57 offset:12288
 v_mul_f32 v101, v101, v28
 v_mfma_f32_16x16x32_bf16 v[184:187], v[92:95], a[152:155], 0
 v_mul_f32 v102, v102, v28
 v_mul_f32 v103, v103, v28
 v_mfma_f32_16x16x32_bf16 v[184:187], v[88:91], a[136:139], v[184:187]
 v_cvt_pk_bf16_f32 v112, v96, v97
 v_mfma_f32_16x16x32_bf16 v[180:183], v[88:91], a[132:135], 0
 ds_read_b64_tr_b16 v[80:81], v58
 v_cvt_pk_bf16_f32 v113, v98, v99
 v_mfma_f32_16x16x32_bf16 v[180:183], v[92:95], a[148:151], v[180:183]
 ds_read_b64_tr_b16 v[82:83], v58 offset:4096
 v_cvt_pk_bf16_f32 v114, v100, v101
 v_mfma_f32_16x16x32_bf16 v[176:179], v[92:95], a[144:147], 0
 v_cvt_pk_bf16_f32 v115, v102, v103
 buffer_store_dwordx4 v[112:115], v34, s[32:35], s50 offen sc1
 v_mfma_f32_16x16x32_bf16 v[176:179], v[88:91], a[128:131], v[176:179]
 s_waitcnt lgkmcnt(6)
 v_mfma_f32_16x16x32_bf16 v[192:195], v[64:67], a[128:131], 0
 ds_read_b64_tr_b16 v[84:85], v58 offset:8192
 buffer_load_dwordx4 a[224:227], v48, s[16:19], s78 offen offset:2048 sc1
 v_mfma_f32_16x16x32_bf16 v[192:195], v[68:71], a[144:147], v[192:195]
 ds_read_b64_tr_b16 v[86:87], v58 offset:12288
 v_accvgpr_read_b32 v104, a32
 v_mfma_f32_16x16x32_bf16 v[196:199], v[68:71], a[148:151], 0
 v_accvgpr_read_b32 v105, a33
 v_accvgpr_read_b32 v106, a34
 v_mfma_f32_16x16x32_bf16 v[196:199], v[64:67], a[132:135], v[196:199]
 v_accvgpr_read_b32 v107, a35
 v_mfma_f32_16x16x32_bf16 v[200:203], v[64:67], a[136:139], 0
 ds_read_b64_tr_b16 v[88:89], v59
 buffer_load_dwordx4 v42, s[12:15], s77 offen offset:2048  lds
 v_mfma_f32_16x16x32_bf16 v[200:203], v[68:71], a[152:155], v[200:203]
 ds_read_b64_tr_b16 v[90:91], v59 offset:4096
 v_accvgpr_read_b32 v108, a48
 v_mfma_f32_16x16x32_bf16 v[204:207], v[68:71], a[156:159], 0
 v_accvgpr_read_b32 v109, a49
 v_accvgpr_read_b32 v110, a50
 v_mfma_f32_16x16x32_bf16 v[204:207], v[64:67], a[140:143], v[204:207]
 s_waitcnt lgkmcnt(6)
 v_mfma_f32_16x16x32_bf16 v[220:223], v[72:75], a[140:143], 0
 ds_read_b64_tr_b16 v[92:93], v59 offset:8192
 buffer_load_dwordx4 a[228:231], v49, s[16:19], s78 offen offset:2048 sc1
 v_mfma_f32_16x16x32_bf16 v[220:223], v[76:79], a[156:159], v[220:223]
 ds_read_b64_tr_b16 v[94:95], v59 offset:12288
 v_accvgpr_read_b32 v111, a51
 v_mfma_f32_16x16x32_bf16 v[216:219], v[76:79], a[152:155], 0
 v_mul_f32 v104, v104, v28
 v_mul_f32 v105, v105, v28
 v_mfma_f32_16x16x32_bf16 v[216:219], v[72:75], a[136:139], v[216:219]
 v_mul_f32 v106, v106, v28
 v_mfma_f32_16x16x32_bf16 v[212:215], v[72:75], a[132:135], 0
 ds_read_b64_tr_b16 v[64:65], v52 offset:16384
 v_mul_f32 v107, v107, v28
 v_mfma_f32_16x16x32_bf16 v[212:215], v[76:79], a[148:151], v[212:215]
 ds_read_b64_tr_b16 v[66:67], v52 offset:20480
 v_mul_f32 v108, v108, v28
 v_mfma_f32_16x16x32_bf16 v[208:211], v[76:79], a[144:147], 0
 v_mul_f32 v109, v109, v28
 v_mul_f32 v110, v110, v28
 v_mfma_f32_16x16x32_bf16 v[208:211], v[72:75], a[128:131], v[208:211]
 s_waitcnt lgkmcnt(6)
 v_mfma_f32_16x16x32_bf16 v[224:227], v[80:83], a[128:131], 0
 ds_read_b64_tr_b16 v[68:69], v52 offset:24576
 buffer_load_dwordx4 a[232:235], v50, s[16:19], s78 offen offset:2048 sc1
 v_mfma_f32_16x16x32_bf16 v[224:227], v[84:87], a[144:147], v[224:227]
 ds_read_b64_tr_b16 v[70:71], v52 offset:28672
 v_mul_f32 v111, v111, v28
 v_mfma_f32_16x16x32_bf16 v[228:231], v[84:87], a[148:151], 0
 v_cvt_pk_bf16_f32 v116, v104, v105
 v_cvt_pk_bf16_f32 v117, v106, v107
 v_mfma_f32_16x16x32_bf16 v[228:231], v[80:83], a[132:135], v[228:231]
 v_cvt_pk_bf16_f32 v118, v108, v109
 v_mfma_f32_16x16x32_bf16 v[232:235], v[80:83], a[136:139], 0
 ds_read_b64_tr_b16 v[72:73], v53 offset:16384
 buffer_load_dwordx4 v43, s[12:15], s77 offen offset:3072  lds
 v_mfma_f32_16x16x32_bf16 v[232:235], v[84:87], a[152:155], v[232:235]
 ds_read_b64_tr_b16 v[74:75], v53 offset:20480
 v_cvt_pk_bf16_f32 v119, v110, v111
 v_mfma_f32_16x16x32_bf16 v[236:239], v[84:87], a[156:159], 0
 buffer_store_dwordx4 v[116:119], v34, s[32:35], s50 offen offset:1024 sc1
 v_accvgpr_read_b32 v96, a64
 v_mfma_f32_16x16x32_bf16 v[236:239], v[80:83], a[140:143], v[236:239]
 s_waitcnt lgkmcnt(6)
 v_mfma_f32_16x16x32_bf16 v[252:255], v[88:91], a[140:143], 0
 ds_read_b64_tr_b16 v[76:77], v53 offset:24576
 buffer_load_dwordx4 a[236:239], v51, s[16:19], s78 offen offset:2048 sc1
 v_mfma_f32_16x16x32_bf16 v[252:255], v[92:95], a[156:159], v[252:255]
 ds_read_b64_tr_b16 v[78:79], v53 offset:28672
 v_accvgpr_read_b32 v97, a65
 v_mfma_f32_16x16x32_bf16 v[248:251], v[92:95], a[152:155], 0
 v_accvgpr_read_b32 v98, a66
 v_accvgpr_read_b32 v99, a67
 v_mfma_f32_16x16x32_bf16 v[248:251], v[88:91], a[136:139], v[248:251]
 v_accvgpr_read_b32 v100, a80
 v_mfma_f32_16x16x32_bf16 v[244:247], v[88:91], a[132:135], 0
 ds_read_b64_tr_b16 v[80:81], v54 offset:16384
 v_accvgpr_read_b32 v101, a81
 v_mfma_f32_16x16x32_bf16 v[244:247], v[92:95], a[148:151], v[244:247]
 ds_read_b64_tr_b16 v[82:83], v54 offset:20480
 v_accvgpr_read_b32 v102, a82
 v_mfma_f32_16x16x32_bf16 v[240:243], v[92:95], a[144:147], 0
 v_accvgpr_read_b32 v103, a83
 v_mul_f32 v96, v96, v28
 v_mfma_f32_16x16x32_bf16 v[240:243], v[88:91], a[128:131], v[240:243]
 s_waitcnt lgkmcnt(6)
 s_waitcnt vmcnt(34)
 v_mfma_f32_16x16x32_bf16 v[128:131], v[64:67], a[160:163], v[128:131]
 ds_read_b64_tr_b16 v[84:85], v54 offset:24576
 buffer_load_dwordx4 a[240:243], v48, s[16:19], s78 offen offset:3072 sc1
 s_waitcnt vmcnt(30)
 v_mfma_f32_16x16x32_bf16 v[128:131], v[68:71], a[176:179], v[128:131]
 ds_read_b64_tr_b16 v[86:87], v54 offset:28672
 s_waitcnt vmcnt(29)
 v_mul_f32 v97, v97, v28
 v_mfma_f32_16x16x32_bf16 v[132:135], v[68:71], a[180:183], v[132:135]
 v_mul_f32 v98, v98, v28
 v_mul_f32 v99, v99, v28
 v_mfma_f32_16x16x32_bf16 v[132:135], v[64:67], a[164:167], v[132:135]
 v_mul_f32 v100, v100, v28
 v_mfma_f32_16x16x32_bf16 v[136:139], v[64:67], a[168:171], v[136:139]
 ds_read_b64_tr_b16 v[88:89], v55 offset:16384
 s_add_u32 m0, s79, 69632
 s_waitcnt vmcnt(28)
 v_mfma_f32_16x16x32_bf16 v[136:139], v[68:71], a[184:187], v[136:139]
 ds_read_b64_tr_b16 v[90:91], v55 offset:20480
 s_waitcnt vmcnt(27)
 v_mul_f32 v101, v101, v28
 v_mfma_f32_16x16x32_bf16 v[140:143], v[68:71], a[188:191], v[140:143]
 buffer_load_dwordx4 v44, s[12:15], s77 offen  lds
 v_mul_f32 v102, v102, v28
 v_mfma_f32_16x16x32_bf16 v[140:143], v[64:67], a[172:175], v[140:143]
 s_waitcnt lgkmcnt(6)
 v_mfma_f32_16x16x32_bf16 v[156:159], v[72:75], a[172:175], v[156:159]
 ds_read_b64_tr_b16 v[92:93], v55 offset:24576
 buffer_load_dwordx4 a[244:247], v49, s[16:19], s78 offen offset:3072 sc1
 v_mfma_f32_16x16x32_bf16 v[156:159], v[76:79], a[188:191], v[156:159]
 ds_read_b64_tr_b16 v[94:95], v55 offset:28672
 v_mul_f32 v103, v103, v28
 v_mfma_f32_16x16x32_bf16 v[152:155], v[76:79], a[184:187], v[152:155]
 v_cvt_pk_bf16_f32 v120, v96, v97
 v_cvt_pk_bf16_f32 v121, v98, v99
 v_mfma_f32_16x16x32_bf16 v[152:155], v[72:75], a[168:171], v[152:155]
 v_cvt_pk_bf16_f32 v122, v100, v101
 v_mfma_f32_16x16x32_bf16 v[148:151], v[72:75], a[164:167], v[148:151]
 ds_read_b64_tr_b16 v[64:65], v56 offset:16384
 v_cvt_pk_bf16_f32 v123, v102, v103
 v_mfma_f32_16x16x32_bf16 v[148:151], v[76:79], a[180:183], v[148:151]
 ds_read_b64_tr_b16 v[66:67], v56 offset:20480
 buffer_store_dwordx4 v[120:123], v34, s[32:35], s50 offen offset:2048 sc1
 v_mfma_f32_16x16x32_bf16 v[144:147], v[76:79], a[176:179], v[144:147]
 v_accvgpr_read_b32 v104, a96
 v_accvgpr_read_b32 v105, a97
 v_mfma_f32_16x16x32_bf16 v[144:147], v[72:75], a[160:163], v[144:147]
 s_waitcnt lgkmcnt(6)
 v_mfma_f32_16x16x32_bf16 v[160:163], v[80:83], a[160:163], v[160:163]
 ds_read_b64_tr_b16 v[68:69], v56 offset:24576
 buffer_load_dwordx4 a[248:251], v50, s[16:19], s78 offen offset:3072 sc1
 v_mfma_f32_16x16x32_bf16 v[160:163], v[84:87], a[176:179], v[160:163]
 ds_read_b64_tr_b16 v[70:71], v56 offset:28672
 v_accvgpr_read_b32 v106, a98
 v_mfma_f32_16x16x32_bf16 v[164:167], v[84:87], a[180:183], v[164:167]
 v_accvgpr_read_b32 v107, a99
 v_accvgpr_read_b32 v108, a112
 v_mfma_f32_16x16x32_bf16 v[164:167], v[80:83], a[164:167], v[164:167]
 v_accvgpr_read_b32 v109, a113
 v_mfma_f32_16x16x32_bf16 v[168:171], v[80:83], a[168:171], v[168:171]
 ds_read_b64_tr_b16 v[72:73], v57 offset:16384
 buffer_load_dwordx4 v45, s[12:15], s77 offen offset:1024  lds
 v_mfma_f32_16x16x32_bf16 v[168:171], v[84:87], a[184:187], v[168:171]
 ds_read_b64_tr_b16 v[74:75], v57 offset:20480
 v_accvgpr_read_b32 v110, a114
 v_mfma_f32_16x16x32_bf16 v[172:175], v[84:87], a[188:191], v[172:175]
 v_accvgpr_read_b32 v111, a115
 v_mul_f32 v104, v104, v28
 v_mfma_f32_16x16x32_bf16 v[172:175], v[80:83], a[172:175], v[172:175]
 s_waitcnt lgkmcnt(6)
 v_mfma_f32_16x16x32_bf16 v[188:191], v[88:91], a[172:175], v[188:191]
 ds_read_b64_tr_b16 v[76:77], v57 offset:24576
 buffer_load_dwordx4 a[252:255], v51, s[16:19], s78 offen offset:3072 sc1
 v_mfma_f32_16x16x32_bf16 v[188:191], v[92:95], a[188:191], v[188:191]
 ds_read_b64_tr_b16 v[78:79], v57 offset:28672
 s_add_u32 s78, s78, 4096
 v_mfma_f32_16x16x32_bf16 v[184:187], v[92:95], a[184:187], v[184:187]
 v_mul_f32 v105, v105, v28
 v_mul_f32 v106, v106, v28
 v_mfma_f32_16x16x32_bf16 v[184:187], v[88:91], a[168:171], v[184:187]
 v_mul_f32 v107, v107, v28
 v_mfma_f32_16x16x32_bf16 v[180:183], v[88:91], a[164:167], v[180:183]
 ds_read_b64_tr_b16 v[80:81], v58 offset:16384
 v_mul_f32 v108, v108, v28
 v_mfma_f32_16x16x32_bf16 v[180:183], v[92:95], a[180:183], v[180:183]
 ds_read_b64_tr_b16 v[82:83], v58 offset:20480
 v_mul_f32 v109, v109, v28
 v_mfma_f32_16x16x32_bf16 v[176:179], v[92:95], a[176:179], v[176:179]
 v_mul_f32 v110, v110, v28
 v_mul_f32 v111, v111, v28
 v_mfma_f32_16x16x32_bf16 v[176:179], v[88:91], a[160:163], v[176:179]
 s_waitcnt lgkmcnt(6)
 v_mfma_f32_16x16x32_bf16 v[192:195], v[64:67], a[160:163], v[192:195]
 ds_read_b64_tr_b16 v[84:85], v58 offset:24576
 buffer_load_dwordx4 a[128:131], v48, s[16:19], s78 offen sc1
 v_mfma_f32_16x16x32_bf16 v[192:195], v[68:71], a[176:179], v[192:195]
 ds_read_b64_tr_b16 v[86:87], v58 offset:28672
 v_cvt_pk_bf16_f32 v124, v104, v105
 v_mfma_f32_16x16x32_bf16 v[196:199], v[68:71], a[180:183], v[196:199]
 v_cvt_pk_bf16_f32 v125, v106, v107
 v_cvt_pk_bf16_f32 v126, v108, v109
 v_mfma_f32_16x16x32_bf16 v[196:199], v[64:67], a[164:167], v[196:199]
 v_cvt_pk_bf16_f32 v127, v110, v111
 v_mfma_f32_16x16x32_bf16 v[200:203], v[64:67], a[168:171], v[200:203]
 ds_read_b64_tr_b16 v[88:89], v59 offset:16384
 buffer_load_dwordx4 v46, s[12:15], s77 offen offset:2048  lds
 v_mfma_f32_16x16x32_bf16 v[200:203], v[68:71], a[184:187], v[200:203]
 ds_read_b64_tr_b16 v[90:91], v59 offset:20480
 buffer_store_dwordx4 v[124:127], v34, s[32:35], s50 offen offset:3072 sc1
 v_mfma_f32_16x16x32_bf16 v[204:207], v[68:71], a[188:191], v[204:207]
 s_add_u32 s50, s50, 131328
 v_accvgpr_read_b32 v96, a4
 v_mfma_f32_16x16x32_bf16 v[204:207], v[64:67], a[172:175], v[204:207]
 s_waitcnt lgkmcnt(6)
 v_mfma_f32_16x16x32_bf16 v[220:223], v[72:75], a[172:175], v[220:223]
 ds_read_b64_tr_b16 v[92:93], v59 offset:24576
 buffer_load_dwordx4 a[132:135], v49, s[16:19], s78 offen sc1
 v_mfma_f32_16x16x32_bf16 v[220:223], v[76:79], a[188:191], v[220:223]
 ds_read_b64_tr_b16 v[94:95], v59 offset:28672
 v_accvgpr_read_b32 v97, a5
 v_mfma_f32_16x16x32_bf16 v[216:219], v[76:79], a[184:187], v[216:219]
 v_accvgpr_read_b32 v98, a6
 v_accvgpr_read_b32 v99, a7
 v_mfma_f32_16x16x32_bf16 v[216:219], v[72:75], a[168:171], v[216:219]
 s_waitcnt vmcnt(29)
 s_barrier
 v_mfma_f32_16x16x32_bf16 v[212:215], v[72:75], a[164:167], v[212:215]
 ds_read_b64_tr_b16 v[64:65], v52 offset:32768
 v_accvgpr_read_b32 v100, a20
 v_mfma_f32_16x16x32_bf16 v[212:215], v[76:79], a[180:183], v[212:215]
 ds_read_b64_tr_b16 v[66:67], v52 offset:36864
 v_accvgpr_read_b32 v101, a21
 v_mfma_f32_16x16x32_bf16 v[208:211], v[76:79], a[176:179], v[208:211]
 v_accvgpr_read_b32 v102, a22
 v_accvgpr_read_b32 v103, a23
 v_mfma_f32_16x16x32_bf16 v[208:211], v[72:75], a[160:163], v[208:211]
 s_waitcnt lgkmcnt(6)
 v_mfma_f32_16x16x32_bf16 v[224:227], v[80:83], a[160:163], v[224:227]
 ds_read_b64_tr_b16 v[68:69], v52 offset:40960
 buffer_load_dwordx4 a[136:139], v50, s[16:19], s78 offen sc1
 v_mfma_f32_16x16x32_bf16 v[224:227], v[84:87], a[176:179], v[224:227]
 ds_read_b64_tr_b16 v[70:71], v52 offset:45056
 v_mul_f32 v96, v96, v29
 v_mfma_f32_16x16x32_bf16 v[228:231], v[84:87], a[180:183], v[228:231]
 v_mul_f32 v97, v97, v29
 v_mul_f32 v98, v98, v29
 v_mfma_f32_16x16x32_bf16 v[228:231], v[80:83], a[164:167], v[228:231]
 v_mul_f32 v99, v99, v29
 v_mfma_f32_16x16x32_bf16 v[232:235], v[80:83], a[168:171], v[232:235]
 ds_read_b64_tr_b16 v[72:73], v53 offset:32768
 buffer_load_dwordx4 v47, s[12:15], s77 offen offset:3072  lds
 v_mfma_f32_16x16x32_bf16 v[232:235], v[84:87], a[184:187], v[232:235]
 ds_read_b64_tr_b16 v[74:75], v53 offset:36864
 s_add_u32 s77, s77, 262144
 v_mfma_f32_16x16x32_bf16 v[236:239], v[84:87], a[188:191], v[236:239]
 v_mul_f32 v100, v100, v29
 v_mul_f32 v101, v101, v29
 v_mfma_f32_16x16x32_bf16 v[236:239], v[80:83], a[172:175], v[236:239]
 s_waitcnt lgkmcnt(6)
 v_mfma_f32_16x16x32_bf16 v[252:255], v[88:91], a[172:175], v[252:255]
 ds_read_b64_tr_b16 v[76:77], v53 offset:40960
 buffer_load_dwordx4 a[140:143], v51, s[16:19], s78 offen sc1
 v_mfma_f32_16x16x32_bf16 v[252:255], v[92:95], a[188:191], v[252:255]
 ds_read_b64_tr_b16 v[78:79], v53 offset:45056
 buffer_load_dword v61, v0, s[60:63], 0 offen
 v_mfma_f32_16x16x32_bf16 v[248:251], v[92:95], a[184:187], v[248:251]
 v_mul_f32 v102, v102, v29
 v_mul_f32 v103, v103, v29
 v_mfma_f32_16x16x32_bf16 v[248:251], v[88:91], a[168:171], v[248:251]
 v_cvt_pk_bf16_f32 v112, v96, v97
 v_mfma_f32_16x16x32_bf16 v[244:247], v[88:91], a[164:167], v[244:247]
 ds_read_b64_tr_b16 v[80:81], v54 offset:32768
 v_cvt_pk_bf16_f32 v113, v98, v99
 v_mfma_f32_16x16x32_bf16 v[244:247], v[92:95], a[180:183], v[244:247]
 ds_read_b64_tr_b16 v[82:83], v54 offset:36864
 v_cvt_pk_bf16_f32 v114, v100, v101
 v_mfma_f32_16x16x32_bf16 v[240:243], v[92:95], a[176:179], v[240:243]
 v_cvt_pk_bf16_f32 v115, v102, v103
 buffer_store_dwordx4 v[112:115], v34, s[32:35], s50 offen sc1
 v_mfma_f32_16x16x32_bf16 v[240:243], v[88:91], a[160:163], v[240:243]
 s_waitcnt lgkmcnt(6)
 s_waitcnt vmcnt(33)
 v_mfma_f32_16x16x32_bf16 v[128:131], v[64:67], a[192:195], v[128:131]
 ds_read_b64_tr_b16 v[84:85], v54 offset:40960
 buffer_load_dwordx4 a[144:147], v48, s[16:19], s78 offen offset:1024 sc1
 s_waitcnt vmcnt(30)
 v_mfma_f32_16x16x32_bf16 v[128:131], v[68:71], a[208:211], v[128:131]
 ds_read_b64_tr_b16 v[86:87], v54 offset:45056
 s_waitcnt vmcnt(28)
 v_accvgpr_read_b32 v104, a36
 v_mfma_f32_16x16x32_bf16 v[132:135], v[68:71], a[212:215], v[132:135]
 v_accvgpr_read_b32 v105, a37
 v_accvgpr_read_b32 v106, a38
 v_mfma_f32_16x16x32_bf16 v[132:135], v[64:67], a[196:199], v[132:135]
 v_accvgpr_read_b32 v107, a39
 v_mfma_f32_16x16x32_bf16 v[136:139], v[64:67], a[200:203], v[136:139]
 ds_read_b64_tr_b16 v[88:89], v55 offset:32768
 s_add_u32 m0, s79, 98304
 s_waitcnt vmcnt(27)
 v_mfma_f32_16x16x32_bf16 v[136:139], v[68:71], a[216:219], v[136:139]
 ds_read_b64_tr_b16 v[90:91], v55 offset:36864
 s_waitcnt vmcnt(25)
 v_accvgpr_read_b32 v108, a52
 v_mfma_f32_16x16x32_bf16 v[140:143], v[68:71], a[220:223], v[140:143]
 buffer_load_dwordx4 v40, s[12:15], s77 offen  lds
 v_accvgpr_read_b32 v109, a53
 v_mfma_f32_16x16x32_bf16 v[140:143], v[64:67], a[204:207], v[140:143]
 s_waitcnt lgkmcnt(6)
 v_mfma_f32_16x16x32_bf16 v[156:159], v[72:75], a[204:207], v[156:159]
 ds_read_b64_tr_b16 v[92:93], v55 offset:40960
 buffer_load_dwordx4 a[148:151], v49, s[16:19], s78 offen offset:1024 sc1
 v_accvgpr_read_b32 v110, a54
 v_mfma_f32_16x16x32_bf16 v[156:159], v[76:79], a[220:223], v[156:159]
 ds_read_b64_tr_b16 v[94:95], v55 offset:45056
 v_accvgpr_read_b32 v111, a55
 v_mfma_f32_16x16x32_bf16 v[152:155], v[76:79], a[216:219], v[152:155]
 v_mul_f32 v104, v104, v29
 v_mul_f32 v105, v105, v29
 v_mfma_f32_16x16x32_bf16 v[152:155], v[72:75], a[200:203], v[152:155]
 v_mul_f32 v106, v106, v29
 v_mfma_f32_16x16x32_bf16 v[148:151], v[72:75], a[196:199], v[148:151]
 ds_read_b64_tr_b16 v[64:65], v56 offset:32768
 v_mul_f32 v107, v107, v29
 v_mfma_f32_16x16x32_bf16 v[148:151], v[76:79], a[212:215], v[148:151]
 ds_read_b64_tr_b16 v[66:67], v56 offset:36864
 v_mul_f32 v108, v108, v29
 v_mfma_f32_16x16x32_bf16 v[144:147], v[76:79], a[208:211], v[144:147]
 v_mul_f32 v109, v109, v29
 v_mul_f32 v110, v110, v29
 v_mfma_f32_16x16x32_bf16 v[144:147], v[72:75], a[192:195], v[144:147]
 s_waitcnt lgkmcnt(6)
 v_mfma_f32_16x16x32_bf16 v[160:163], v[80:83], a[192:195], v[160:163]
 ds_read_b64_tr_b16 v[68:69], v56 offset:40960
 buffer_load_dwordx4 a[152:155], v50, s[16:19], s78 offen offset:1024 sc1
 v_mfma_f32_16x16x32_bf16 v[160:163], v[84:87], a[208:211], v[160:163]
 ds_read_b64_tr_b16 v[70:71], v56 offset:45056
 v_mul_f32 v111, v111, v29
 v_mfma_f32_16x16x32_bf16 v[164:167], v[84:87], a[212:215], v[164:167]
 v_cvt_pk_bf16_f32 v116, v104, v105
 v_cvt_pk_bf16_f32 v117, v106, v107
 v_mfma_f32_16x16x32_bf16 v[164:167], v[80:83], a[196:199], v[164:167]
 v_cvt_pk_bf16_f32 v118, v108, v109
 v_mfma_f32_16x16x32_bf16 v[168:171], v[80:83], a[200:203], v[168:171]
 ds_read_b64_tr_b16 v[72:73], v57 offset:32768
 buffer_load_dwordx4 v41, s[12:15], s77 offen offset:1024  lds
 v_mfma_f32_16x16x32_bf16 v[168:171], v[84:87], a[216:219], v[168:171]
 ds_read_b64_tr_b16 v[74:75], v57 offset:36864
 v_cvt_pk_bf16_f32 v119, v110, v111
 v_mfma_f32_16x16x32_bf16 v[172:175], v[84:87], a[220:223], v[172:175]
 buffer_store_dwordx4 v[116:119], v34, s[32:35], s50 offen offset:1024 sc1
 v_accvgpr_read_b32 v96, a68
 v_mfma_f32_16x16x32_bf16 v[172:175], v[80:83], a[204:207], v[172:175]
 s_waitcnt lgkmcnt(6)
 v_mfma_f32_16x16x32_bf16 v[188:191], v[88:91], a[204:207], v[188:191]
 ds_read_b64_tr_b16 v[76:77], v57 offset:40960
 buffer_load_dwordx4 a[156:159], v51, s[16:19], s78 offen offset:1024 sc1
 v_mfma_f32_16x16x32_bf16 v[188:191], v[92:95], a[220:223], v[188:191]
 ds_read_b64_tr_b16 v[78:79], v57 offset:45056
 v_accvgpr_read_b32 v97, a69
 v_mfma_f32_16x16x32_bf16 v[184:187], v[92:95], a[216:219], v[184:187]
 v_accvgpr_read_b32 v98, a70
 v_accvgpr_read_b32 v99, a71
 v_mfma_f32_16x16x32_bf16 v[184:187], v[88:91], a[200:203], v[184:187]
 v_accvgpr_read_b32 v100, a84
 v_mfma_f32_16x16x32_bf16 v[180:183], v[88:91], a[196:199], v[180:183]
 ds_read_b64_tr_b16 v[80:81], v58 offset:32768
 v_accvgpr_read_b32 v101, a85
 v_mfma_f32_16x16x32_bf16 v[180:183], v[92:95], a[212:215], v[180:183]
 ds_read_b64_tr_b16 v[82:83], v58 offset:36864
 v_accvgpr_read_b32 v102, a86
 v_mfma_f32_16x16x32_bf16 v[176:179], v[92:95], a[208:211], v[176:179]
 v_accvgpr_read_b32 v103, a87
 v_mul_f32 v96, v96, v29
 v_mfma_f32_16x16x32_bf16 v[176:179], v[88:91], a[192:195], v[176:179]
 s_waitcnt lgkmcnt(6)
 v_mfma_f32_16x16x32_bf16 v[192:195], v[64:67], a[192:195], v[192:195]
 ds_read_b64_tr_b16 v[84:85], v58 offset:40960
 buffer_load_dwordx4 a[160:163], v48, s[16:19], s78 offen offset:2048 sc1
 v_mfma_f32_16x16x32_bf16 v[192:195], v[68:71], a[208:211], v[192:195]
 ds_read_b64_tr_b16 v[86:87], v58 offset:45056
 v_mul_f32 v97, v97, v29
 v_mfma_f32_16x16x32_bf16 v[196:199], v[68:71], a[212:215], v[196:199]
 v_mul_f32 v98, v98, v29
 v_mul_f32 v99, v99, v29
 v_mfma_f32_16x16x32_bf16 v[196:199], v[64:67], a[196:199], v[196:199]
 v_mul_f32 v100, v100, v29
 v_mfma_f32_16x16x32_bf16 v[200:203], v[64:67], a[200:203], v[200:203]
 ds_read_b64_tr_b16 v[88:89], v59 offset:32768
 buffer_load_dwordx4 v42, s[12:15], s77 offen offset:2048  lds
 v_mfma_f32_16x16x32_bf16 v[200:203], v[68:71], a[216:219], v[200:203]
 ds_read_b64_tr_b16 v[90:91], v59 offset:36864
 v_mul_f32 v101, v101, v29
 v_mfma_f32_16x16x32_bf16 v[204:207], v[68:71], a[220:223], v[204:207]
 v_mul_f32 v102, v102, v29
 v_mul_f32 v103, v103, v29
 v_mfma_f32_16x16x32_bf16 v[204:207], v[64:67], a[204:207], v[204:207]
 s_waitcnt lgkmcnt(6)
 v_mfma_f32_16x16x32_bf16 v[220:223], v[72:75], a[204:207], v[220:223]
 ds_read_b64_tr_b16 v[92:93], v59 offset:40960
 buffer_load_dwordx4 a[164:167], v49, s[16:19], s78 offen offset:2048 sc1
 v_mfma_f32_16x16x32_bf16 v[220:223], v[76:79], a[220:223], v[220:223]
 ds_read_b64_tr_b16 v[94:95], v59 offset:45056
 v_cvt_pk_bf16_f32 v120, v96, v97
 v_mfma_f32_16x16x32_bf16 v[216:219], v[76:79], a[216:219], v[216:219]
 v_cvt_pk_bf16_f32 v121, v98, v99
 v_cvt_pk_bf16_f32 v122, v100, v101
 v_mfma_f32_16x16x32_bf16 v[216:219], v[72:75], a[200:203], v[216:219]
 v_cvt_pk_bf16_f32 v123, v102, v103
 v_mfma_f32_16x16x32_bf16 v[212:215], v[72:75], a[196:199], v[212:215]
 ds_read_b64_tr_b16 v[64:65], v52 offset:49152
 buffer_store_dwordx4 v[120:123], v34, s[32:35], s50 offen offset:2048 sc1
 v_mfma_f32_16x16x32_bf16 v[212:215], v[76:79], a[212:215], v[212:215]
 ds_read_b64_tr_b16 v[66:67], v52 offset:53248
 v_accvgpr_read_b32 v104, a100
 v_mfma_f32_16x16x32_bf16 v[208:211], v[76:79], a[208:211], v[208:211]
 v_accvgpr_read_b32 v105, a101
 v_accvgpr_read_b32 v106, a102
 v_mfma_f32_16x16x32_bf16 v[208:211], v[72:75], a[192:195], v[208:211]
 s_waitcnt lgkmcnt(6)
 v_mfma_f32_16x16x32_bf16 v[224:227], v[80:83], a[192:195], v[224:227]
 ds_read_b64_tr_b16 v[68:69], v52 offset:57344
 buffer_load_dwordx4 a[168:171], v50, s[16:19], s78 offen offset:2048 sc1
 v_mfma_f32_16x16x32_bf16 v[224:227], v[84:87], a[208:211], v[224:227]
 ds_read_b64_tr_b16 v[70:71], v52 offset:61440
 v_accvgpr_read_b32 v107, a103
 v_mfma_f32_16x16x32_bf16 v[228:231], v[84:87], a[212:215], v[228:231]
 v_xor_b32 v52, s49, v52
 v_accvgpr_read_b32 v108, a116
 v_mfma_f32_16x16x32_bf16 v[228:231], v[80:83], a[196:199], v[228:231]
 v_accvgpr_read_b32 v109, a117
 v_mfma_f32_16x16x32_bf16 v[232:235], v[80:83], a[200:203], v[232:235]
 ds_read_b64_tr_b16 v[72:73], v53 offset:49152
 buffer_load_dwordx4 v43, s[12:15], s77 offen offset:3072  lds
 v_mfma_f32_16x16x32_bf16 v[232:235], v[84:87], a[216:219], v[232:235]
 ds_read_b64_tr_b16 v[74:75], v53 offset:53248
 v_accvgpr_read_b32 v110, a118
 v_mfma_f32_16x16x32_bf16 v[236:239], v[84:87], a[220:223], v[236:239]
 v_accvgpr_read_b32 v111, a119
 v_mul_f32 v104, v104, v29
 v_mfma_f32_16x16x32_bf16 v[236:239], v[80:83], a[204:207], v[236:239]
 s_waitcnt lgkmcnt(6)
 v_mfma_f32_16x16x32_bf16 v[252:255], v[88:91], a[204:207], v[252:255]
 ds_read_b64_tr_b16 v[76:77], v53 offset:57344
 buffer_load_dwordx4 a[172:175], v51, s[16:19], s78 offen offset:2048 sc1
 v_mfma_f32_16x16x32_bf16 v[252:255], v[92:95], a[220:223], v[252:255]
 ds_read_b64_tr_b16 v[78:79], v53 offset:61440
 v_mul_f32 v105, v105, v29
 v_mfma_f32_16x16x32_bf16 v[248:251], v[92:95], a[216:219], v[248:251]
 v_xor_b32 v53, s49, v53
 v_mul_f32 v106, v106, v29
 v_mfma_f32_16x16x32_bf16 v[248:251], v[88:91], a[200:203], v[248:251]
 v_mul_f32 v107, v107, v29
 v_mfma_f32_16x16x32_bf16 v[244:247], v[88:91], a[196:199], v[244:247]
 ds_read_b64_tr_b16 v[80:81], v54 offset:49152
 v_mul_f32 v108, v108, v29
 v_mfma_f32_16x16x32_bf16 v[244:247], v[92:95], a[212:215], v[244:247]
 ds_read_b64_tr_b16 v[82:83], v54 offset:53248
 v_mul_f32 v109, v109, v29
 v_mfma_f32_16x16x32_bf16 v[240:243], v[92:95], a[208:211], v[240:243]
 v_mul_f32 v110, v110, v29
 v_mul_f32 v111, v111, v29
 v_mfma_f32_16x16x32_bf16 v[240:243], v[88:91], a[192:195], v[240:243]
 s_waitcnt lgkmcnt(6)
 s_waitcnt vmcnt(36)
 v_mfma_f32_16x16x32_bf16 v[128:131], v[64:67], a[224:227], v[128:131]
 ds_read_b64_tr_b16 v[84:85], v54 offset:57344
 buffer_load_dwordx4 a[176:179], v48, s[16:19], s78 offen offset:3072 sc1
 s_waitcnt vmcnt(30)
 v_mfma_f32_16x16x32_bf16 v[128:131], v[68:71], a[240:243], v[128:131]
 ds_read_b64_tr_b16 v[86:87], v54 offset:61440
 s_waitcnt vmcnt(28)
 v_cvt_pk_bf16_f32 v124, v104, v105
 v_mfma_f32_16x16x32_bf16 v[132:135], v[68:71], a[244:247], v[132:135]
 v_xor_b32 v54, s49, v54
 v_cvt_pk_bf16_f32 v125, v106, v107
 v_mfma_f32_16x16x32_bf16 v[132:135], v[64:67], a[228:231], v[132:135]
 v_cvt_pk_bf16_f32 v126, v108, v109
 v_mfma_f32_16x16x32_bf16 v[136:139], v[64:67], a[232:235], v[136:139]
 ds_read_b64_tr_b16 v[88:89], v55 offset:49152
 s_add_u32 m0, s79, 102400
 s_waitcnt vmcnt(26)
 v_mfma_f32_16x16x32_bf16 v[136:139], v[68:71], a[248:251], v[136:139]
 ds_read_b64_tr_b16 v[90:91], v55 offset:53248
 s_waitcnt vmcnt(24)
 v_cvt_pk_bf16_f32 v127, v110, v111
 v_mfma_f32_16x16x32_bf16 v[140:143], v[68:71], a[252:255], v[140:143]
 buffer_load_dwordx4 v44, s[12:15], s77 offen  lds
 buffer_store_dwordx4 v[124:127], v34, s[32:35], s50 offen offset:3072 sc1
 v_mfma_f32_16x16x32_bf16 v[140:143], v[64:67], a[236:239], v[140:143]
 s_waitcnt lgkmcnt(6)
 s_add_u32 s50, s50, 131328
 v_mfma_f32_16x16x32_bf16 v[156:159], v[72:75], a[236:239], v[156:159]
 ds_read_b64_tr_b16 v[92:93], v55 offset:57344
 buffer_load_dwordx4 a[180:183], v49, s[16:19], s78 offen offset:3072 sc1
 v_accvgpr_read_b32 v96, a8
 v_mfma_f32_16x16x32_bf16 v[156:159], v[76:79], a[252:255], v[156:159]
 ds_read_b64_tr_b16 v[94:95], v55 offset:61440
 v_accvgpr_read_b32 v97, a9
 v_mfma_f32_16x16x32_bf16 v[152:155], v[76:79], a[248:251], v[152:155]
 v_xor_b32 v55, s49, v55
 v_accvgpr_read_b32 v98, a10
 v_mfma_f32_16x16x32_bf16 v[152:155], v[72:75], a[232:235], v[152:155]
 v_accvgpr_read_b32 v99, a11
 v_mfma_f32_16x16x32_bf16 v[148:151], v[72:75], a[228:231], v[148:151]
 ds_read_b64_tr_b16 v[64:65], v56 offset:49152
 v_accvgpr_read_b32 v100, a24
 v_mfma_f32_16x16x32_bf16 v[148:151], v[76:79], a[244:247], v[148:151]
 ds_read_b64_tr_b16 v[66:67], v56 offset:53248
 v_accvgpr_read_b32 v101, a25
 v_mfma_f32_16x16x32_bf16 v[144:147], v[76:79], a[240:243], v[144:147]
 v_accvgpr_read_b32 v102, a26
 v_accvgpr_read_b32 v103, a27
 v_mfma_f32_16x16x32_bf16 v[144:147], v[72:75], a[224:227], v[144:147]
 s_waitcnt lgkmcnt(6)
 v_mfma_f32_16x16x32_bf16 v[160:163], v[80:83], a[224:227], v[160:163]
 ds_read_b64_tr_b16 v[68:69], v56 offset:57344
 buffer_load_dwordx4 a[184:187], v50, s[16:19], s78 offen offset:3072 sc1
 v_mfma_f32_16x16x32_bf16 v[160:163], v[84:87], a[240:243], v[160:163]
 ds_read_b64_tr_b16 v[70:71], v56 offset:61440
 v_mul_f32 v96, v96, v30
 v_mfma_f32_16x16x32_bf16 v[164:167], v[84:87], a[244:247], v[164:167]
 v_xor_b32 v56, s49, v56
 v_mul_f32 v97, v97, v30
 v_mfma_f32_16x16x32_bf16 v[164:167], v[80:83], a[228:231], v[164:167]
 v_mul_f32 v98, v98, v30
 v_mfma_f32_16x16x32_bf16 v[168:171], v[80:83], a[232:235], v[168:171]
 ds_read_b64_tr_b16 v[72:73], v57 offset:49152
 buffer_load_dwordx4 v45, s[12:15], s77 offen offset:1024  lds
 v_mul_f32 v99, v99, v30
 v_mfma_f32_16x16x32_bf16 v[168:171], v[84:87], a[248:251], v[168:171]
 ds_read_b64_tr_b16 v[74:75], v57 offset:53248
 v_mul_f32 v100, v100, v30
 v_mfma_f32_16x16x32_bf16 v[172:175], v[84:87], a[252:255], v[172:175]
 v_mul_f32 v101, v101, v30
 v_mul_f32 v102, v102, v30
 v_mfma_f32_16x16x32_bf16 v[172:175], v[80:83], a[236:239], v[172:175]
 s_waitcnt lgkmcnt(6)
 v_mfma_f32_16x16x32_bf16 v[188:191], v[88:91], a[236:239], v[188:191]
 ds_read_b64_tr_b16 v[76:77], v57 offset:57344
 buffer_load_dwordx4 a[188:191], v51, s[16:19], s78 offen offset:3072 sc1
 v_mfma_f32_16x16x32_bf16 v[188:191], v[92:95], a[252:255], v[188:191]
 ds_read_b64_tr_b16 v[78:79], v57 offset:61440
 s_add_u32 s78, s78, 4096
 v_mul_f32 v103, v103, v30
 v_mfma_f32_16x16x32_bf16 v[184:187], v[92:95], a[248:251], v[184:187]
 v_xor_b32 v57, s49, v57
 v_cvt_pk_bf16_f32 v112, v96, v97
 v_mfma_f32_16x16x32_bf16 v[184:187], v[88:91], a[232:235], v[184:187]
 v_cvt_pk_bf16_f32 v113, v98, v99
 v_mfma_f32_16x16x32_bf16 v[180:183], v[88:91], a[228:231], v[180:183]
 ds_read_b64_tr_b16 v[80:81], v58 offset:49152
 v_cvt_pk_bf16_f32 v114, v100, v101
 v_mfma_f32_16x16x32_bf16 v[180:183], v[92:95], a[244:247], v[180:183]
 ds_read_b64_tr_b16 v[82:83], v58 offset:53248
 v_cvt_pk_bf16_f32 v115, v102, v103
 v_mfma_f32_16x16x32_bf16 v[176:179], v[92:95], a[240:243], v[176:179]
 buffer_store_dwordx4 v[112:115], v34, s[32:35], s50 offen sc1
 v_accvgpr_read_b32 v104, a40
 v_mfma_f32_16x16x32_bf16 v[176:179], v[88:91], a[224:227], v[176:179]
 s_waitcnt lgkmcnt(6)
 v_mfma_f32_16x16x32_bf16 v[192:195], v[64:67], a[224:227], v[192:195]
 ds_read_b64_tr_b16 v[84:85], v58 offset:57344
 buffer_load_dwordx4 a[192:195], v48, s[16:19], s78 offen sc1
 v_mfma_f32_16x16x32_bf16 v[192:195], v[68:71], a[240:243], v[192:195]
 ds_read_b64_tr_b16 v[86:87], v58 offset:61440
 v_accvgpr_read_b32 v105, a41
 v_mfma_f32_16x16x32_bf16 v[196:199], v[68:71], a[244:247], v[196:199]
 v_xor_b32 v58, s49, v58
 v_accvgpr_read_b32 v106, a42
 v_mfma_f32_16x16x32_bf16 v[196:199], v[64:67], a[228:231], v[196:199]
 v_accvgpr_read_b32 v107, a43
 v_mfma_f32_16x16x32_bf16 v[200:203], v[64:67], a[232:235], v[200:203]
 ds_read_b64_tr_b16 v[88:89], v59 offset:49152
 buffer_load_dwordx4 v46, s[12:15], s77 offen offset:2048  lds
 v_accvgpr_read_b32 v108, a56
 v_mfma_f32_16x16x32_bf16 v[200:203], v[68:71], a[248:251], v[200:203]
 ds_read_b64_tr_b16 v[90:91], v59 offset:53248
 v_accvgpr_read_b32 v109, a57
 v_mfma_f32_16x16x32_bf16 v[204:207], v[68:71], a[252:255], v[204:207]
 v_accvgpr_read_b32 v110, a58
 v_accvgpr_read_b32 v111, a59
 v_mfma_f32_16x16x32_bf16 v[204:207], v[64:67], a[236:239], v[204:207]
 s_waitcnt lgkmcnt(6)
 v_mfma_f32_16x16x32_bf16 v[220:223], v[72:75], a[236:239], v[220:223]
 ds_read_b64_tr_b16 v[92:93], v59 offset:57344
 buffer_load_dwordx4 a[196:199], v49, s[16:19], s78 offen sc1
 v_mul_f32 v104, v104, v30
 v_mfma_f32_16x16x32_bf16 v[220:223], v[76:79], a[252:255], v[220:223]
 ds_read_b64_tr_b16 v[94:95], v59 offset:61440
 v_mul_f32 v105, v105, v30
 v_mfma_f32_16x16x32_bf16 v[216:219], v[76:79], a[248:251], v[216:219]
 v_xor_b32 v59, s49, v59
 v_mul_f32 v106, v106, v30
 v_mfma_f32_16x16x32_bf16 v[216:219], v[72:75], a[232:235], v[216:219]
 s_waitcnt vmcnt(28)
 s_barrier
 v_mfma_f32_16x16x32_bf16 v[212:215], v[72:75], a[228:231], v[212:215]
 ds_read_b64_tr_b16 v[64:65], v52
 v_mul_f32 v107, v107, v30
 v_mfma_f32_16x16x32_bf16 v[212:215], v[76:79], a[244:247], v[212:215]
 ds_read_b64_tr_b16 v[66:67], v52 offset:4096
 v_mul_f32 v108, v108, v30
 v_mfma_f32_16x16x32_bf16 v[208:211], v[76:79], a[240:243], v[208:211]
 v_mul_f32 v109, v109, v30
 v_mul_f32 v110, v110, v30
 v_mfma_f32_16x16x32_bf16 v[208:211], v[72:75], a[224:227], v[208:211]
 s_waitcnt lgkmcnt(6)
 v_mfma_f32_16x16x32_bf16 v[224:227], v[80:83], a[224:227], v[224:227]
 ds_read_b64_tr_b16 v[68:69], v52 offset:8192
 buffer_load_dwordx4 a[200:203], v50, s[16:19], s78 offen sc1
 v_mul_f32 v111, v111, v30
 v_mfma_f32_16x16x32_bf16 v[224:227], v[84:87], a[240:243], v[224:227]
 ds_read_b64_tr_b16 v[70:71], v52 offset:12288
 v_cvt_pk_bf16_f32 v116, v104, v105
 v_mfma_f32_16x16x32_bf16 v[228:231], v[84:87], a[244:247], v[228:231]
 v_cvt_pk_bf16_f32 v117, v106, v107
 v_cvt_pk_bf16_f32 v118, v108, v109
 v_mfma_f32_16x16x32_bf16 v[228:231], v[80:83], a[228:231], v[228:231]
 v_cvt_pk_bf16_f32 v119, v110, v111
 v_mfma_f32_16x16x32_bf16 v[232:235], v[80:83], a[232:235], v[232:235]
 ds_read_b64_tr_b16 v[72:73], v53
 buffer_load_dwordx4 v47, s[12:15], s77 offen offset:3072  lds
 v_mfma_f32_16x16x32_bf16 v[232:235], v[84:87], a[248:251], v[232:235]
 ds_read_b64_tr_b16 v[74:75], v53 offset:4096
 s_add_u32 s77, s77, 262144
 buffer_store_dwordx4 v[116:119], v34, s[32:35], s50 offen offset:1024 sc1
 v_mfma_f32_16x16x32_bf16 v[236:239], v[84:87], a[252:255], v[236:239]
 v_accvgpr_read_b32 v96, a72
 v_accvgpr_read_b32 v97, a73
 v_mfma_f32_16x16x32_bf16 v[236:239], v[80:83], a[236:239], v[236:239]
 s_waitcnt lgkmcnt(6)
 v_mfma_f32_16x16x32_bf16 v[252:255], v[88:91], a[236:239], v[252:255]
 ds_read_b64_tr_b16 v[76:77], v53 offset:8192
 buffer_load_dwordx4 a[204:207], v51, s[16:19], s78 offen sc1
 v_mfma_f32_16x16x32_bf16 v[252:255], v[92:95], a[252:255], v[252:255]
 ds_read_b64_tr_b16 v[78:79], v53 offset:12288
 buffer_load_dword v61, v0, s[60:63], 0 offen
 v_accvgpr_read_b32 v98, a74
 v_mfma_f32_16x16x32_bf16 v[248:251], v[92:95], a[248:251], v[248:251]
 v_accvgpr_read_b32 v99, a75
 v_accvgpr_read_b32 v100, a88
 v_mfma_f32_16x16x32_bf16 v[248:251], v[88:91], a[232:235], v[248:251]
 v_accvgpr_read_b32 v101, a89
 v_mfma_f32_16x16x32_bf16 v[244:247], v[88:91], a[228:231], v[244:247]
 ds_read_b64_tr_b16 v[80:81], v54
 v_accvgpr_read_b32 v102, a90
 v_mfma_f32_16x16x32_bf16 v[244:247], v[92:95], a[244:247], v[244:247]
 ds_read_b64_tr_b16 v[82:83], v54 offset:4096
 v_accvgpr_read_b32 v103, a91
 v_mfma_f32_16x16x32_bf16 v[240:243], v[92:95], a[240:243], v[240:243]
 v_mul_f32 v96, v96, v30
 v_mul_f32 v97, v97, v30
 v_mfma_f32_16x16x32_bf16 v[240:243], v[88:91], a[224:227], v[240:243]
 s_waitcnt lgkmcnt(6)
 v_mfma_f32_16x16x32_bf16 v[128:131], v[64:67], a[128:131], v[128:131]
 ds_read_b64_tr_b16 v[84:85], v54 offset:8192
 buffer_load_dwordx4 a[208:211], v48, s[16:19], s78 offen offset:1024 sc1
 s_waitcnt vmcnt(30)
 v_mfma_f32_16x16x32_bf16 v[128:131], v[68:71], a[144:147], v[128:131]
 ds_read_b64_tr_b16 v[86:87], v54 offset:12288
 s_waitcnt vmcnt(28)
 v_mul_f32 v98, v98, v30
 v_mfma_f32_16x16x32_bf16 v[132:135], v[68:71], a[148:151], v[132:135]
 v_mul_f32 v99, v99, v30
 v_mul_f32 v100, v100, v30
 v_mfma_f32_16x16x32_bf16 v[132:135], v[64:67], a[132:135], v[132:135]
 v_mul_f32 v101, v101, v30
 v_mfma_f32_16x16x32_bf16 v[136:139], v[64:67], a[136:139], v[136:139]
 ds_read_b64_tr_b16 v[88:89], v55
 s_add_u32 m0, s79, 0
 s_waitcnt vmcnt(27)
 v_mfma_f32_16x16x32_bf16 v[136:139], v[68:71], a[152:155], v[136:139]
 ds_read_b64_tr_b16 v[90:91], v55 offset:4096
 s_waitcnt vmcnt(24)
 v_mul_f32 v102, v102, v30
 v_mfma_f32_16x16x32_bf16 v[140:143], v[68:71], a[156:159], v[140:143]
 buffer_load_dwordx4 v40, s[12:15], s77 offen  lds
 v_mul_f32 v103, v103, v30
 v_mfma_f32_16x16x32_bf16 v[140:143], v[64:67], a[140:143], v[140:143]
 s_waitcnt lgkmcnt(6)
 v_mfma_f32_16x16x32_bf16 v[156:159], v[72:75], a[140:143], v[156:159]
 ds_read_b64_tr_b16 v[92:93], v55 offset:8192
 buffer_load_dwordx4 a[212:215], v49, s[16:19], s78 offen offset:1024 sc1
 v_cvt_pk_bf16_f32 v120, v96, v97
 v_mfma_f32_16x16x32_bf16 v[156:159], v[76:79], a[156:159], v[156:159]
 ds_read_b64_tr_b16 v[94:95], v55 offset:12288
 v_cvt_pk_bf16_f32 v121, v98, v99
 v_mfma_f32_16x16x32_bf16 v[152:155], v[76:79], a[152:155], v[152:155]
 v_cvt_pk_bf16_f32 v122, v100, v101
 v_cvt_pk_bf16_f32 v123, v102, v103
 v_mfma_f32_16x16x32_bf16 v[152:155], v[72:75], a[136:139], v[152:155]
 buffer_store_dwordx4 v[120:123], v34, s[32:35], s50 offen offset:2048 sc1
 v_mfma_f32_16x16x32_bf16 v[148:151], v[72:75], a[132:135], v[148:151]
 ds_read_b64_tr_b16 v[64:65], v56
 v_accvgpr_read_b32 v104, a104
 v_mfma_f32_16x16x32_bf16 v[148:151], v[76:79], a[148:151], v[148:151]
 ds_read_b64_tr_b16 v[66:67], v56 offset:4096
 v_accvgpr_read_b32 v105, a105
 v_mfma_f32_16x16x32_bf16 v[144:147], v[76:79], a[144:147], v[144:147]
 v_accvgpr_read_b32 v106, a106
 v_accvgpr_read_b32 v107, a107
 v_mfma_f32_16x16x32_bf16 v[144:147], v[72:75], a[128:131], v[144:147]
 s_waitcnt lgkmcnt(6)
 v_mfma_f32_16x16x32_bf16 v[160:163], v[80:83], a[128:131], v[160:163]
 ds_read_b64_tr_b16 v[68:69], v56 offset:8192
 buffer_load_dwordx4 a[216:219], v50, s[16:19], s78 offen offset:1024 sc1
 v_mfma_f32_16x16x32_bf16 v[160:163], v[84:87], a[144:147], v[160:163]
 ds_read_b64_tr_b16 v[70:71], v56 offset:12288
 v_accvgpr_read_b32 v108, a120
 v_mfma_f32_16x16x32_bf16 v[164:167], v[84:87], a[148:151], v[164:167]
 v_accvgpr_read_b32 v109, a121
 v_accvgpr_read_b32 v110, a122
 v_mfma_f32_16x16x32_bf16 v[164:167], v[80:83], a[132:135], v[164:167]
 v_accvgpr_read_b32 v111, a123
 v_mfma_f32_16x16x32_bf16 v[168:171], v[80:83], a[136:139], v[168:171]
 ds_read_b64_tr_b16 v[72:73], v57
 buffer_load_dwordx4 v41, s[12:15], s77 offen offset:1024  lds
 v_mfma_f32_16x16x32_bf16 v[168:171], v[84:87], a[152:155], v[168:171]
 ds_read_b64_tr_b16 v[74:75], v57 offset:4096
 v_mul_f32 v104, v104, v30
 v_mfma_f32_16x16x32_bf16 v[172:175], v[84:87], a[156:159], v[172:175]
 v_mul_f32 v105, v105, v30
 v_mul_f32 v106, v106, v30
 v_mfma_f32_16x16x32_bf16 v[172:175], v[80:83], a[140:143], v[172:175]
 s_waitcnt lgkmcnt(6)
 v_mfma_f32_16x16x32_bf16 v[188:191], v[88:91], a[140:143], v[188:191]
 ds_read_b64_tr_b16 v[76:77], v57 offset:8192
 buffer_load_dwordx4 a[220:223], v51, s[16:19], s78 offen offset:1024 sc1
 v_mfma_f32_16x16x32_bf16 v[188:191], v[92:95], a[156:159], v[188:191]
 ds_read_b64_tr_b16 v[78:79], v57 offset:12288
 v_mul_f32 v107, v107, v30
 v_mfma_f32_16x16x32_bf16 v[184:187], v[92:95], a[152:155], v[184:187]
 v_mul_f32 v108, v108, v30
 v_mul_f32 v109, v109, v30
 v_mfma_f32_16x16x32_bf16 v[184:187], v[88:91], a[136:139], v[184:187]
 v_mul_f32 v110, v110, v30
 v_mfma_f32_16x16x32_bf16 v[180:183], v[88:91], a[132:135], v[180:183]
 ds_read_b64_tr_b16 v[80:81], v58
 v_mul_f32 v111, v111, v30
 v_mfma_f32_16x16x32_bf16 v[180:183], v[92:95], a[148:151], v[180:183]
 ds_read_b64_tr_b16 v[82:83], v58 offset:4096
 v_cvt_pk_bf16_f32 v124, v104, v105
 v_mfma_f32_16x16x32_bf16 v[176:179], v[92:95], a[144:147], v[176:179]
 v_cvt_pk_bf16_f32 v125, v106, v107
 v_cvt_pk_bf16_f32 v126, v108, v109
 v_mfma_f32_16x16x32_bf16 v[176:179], v[88:91], a[128:131], v[176:179]
 s_waitcnt lgkmcnt(6)
 v_mfma_f32_16x16x32_bf16 v[192:195], v[64:67], a[128:131], v[192:195]
 ds_read_b64_tr_b16 v[84:85], v58 offset:8192
 buffer_load_dwordx4 a[224:227], v48, s[16:19], s78 offen offset:2048 sc1
 v_mfma_f32_16x16x32_bf16 v[192:195], v[68:71], a[144:147], v[192:195]
 ds_read_b64_tr_b16 v[86:87], v58 offset:12288
 v_cvt_pk_bf16_f32 v127, v110, v111
 v_mfma_f32_16x16x32_bf16 v[196:199], v[68:71], a[148:151], v[196:199]
 buffer_store_dwordx4 v[124:127], v34, s[32:35], s50 offen offset:3072 sc1
 s_add_u32 s50, s50, 131328
 v_mfma_f32_16x16x32_bf16 v[196:199], v[64:67], a[132:135], v[196:199]
 v_accvgpr_read_b32 v96, a12
 v_mfma_f32_16x16x32_bf16 v[200:203], v[64:67], a[136:139], v[200:203]
 ds_read_b64_tr_b16 v[88:89], v59
 buffer_load_dwordx4 v42, s[12:15], s77 offen offset:2048  lds
 v_mfma_f32_16x16x32_bf16 v[200:203], v[68:71], a[152:155], v[200:203]
 ds_read_b64_tr_b16 v[90:91], v59 offset:4096
 v_accvgpr_read_b32 v97, a13
 v_mfma_f32_16x16x32_bf16 v[204:207], v[68:71], a[156:159], v[204:207]
 v_accvgpr_read_b32 v98, a14
 v_accvgpr_read_b32 v99, a15
 v_mfma_f32_16x16x32_bf16 v[204:207], v[64:67], a[140:143], v[204:207]
 s_waitcnt lgkmcnt(6)
 v_mfma_f32_16x16x32_bf16 v[220:223], v[72:75], a[140:143], v[220:223]
 ds_read_b64_tr_b16 v[92:93], v59 offset:8192
 buffer_load_dwordx4 a[228:231], v49, s[16:19], s78 offen offset:2048 sc1
 v_mfma_f32_16x16x32_bf16 v[220:223], v[76:79], a[156:159], v[220:223]
 ds_read_b64_tr_b16 v[94:95], v59 offset:12288
 v_accvgpr_read_b32 v100, a28
 v_mfma_f32_16x16x32_bf16 v[216:219], v[76:79], a[152:155], v[216:219]
 v_accvgpr_read_b32 v101, a29
 v_accvgpr_read_b32 v102, a30
 v_mfma_f32_16x16x32_bf16 v[216:219], v[72:75], a[136:139], v[216:219]
 v_accvgpr_read_b32 v103, a31
 v_mfma_f32_16x16x32_bf16 v[212:215], v[72:75], a[132:135], v[212:215]
 ds_read_b64_tr_b16 v[64:65], v52 offset:16384
 v_mul_f32 v96, v96, v31
 v_mfma_f32_16x16x32_bf16 v[212:215], v[76:79], a[148:151], v[212:215]
 ds_read_b64_tr_b16 v[66:67], v52 offset:20480
 v_mul_f32 v97, v97, v31
 v_mfma_f32_16x16x32_bf16 v[208:211], v[76:79], a[144:147], v[208:211]
 v_mul_f32 v98, v98, v31
 v_mul_f32 v99, v99, v31
 v_mfma_f32_16x16x32_bf16 v[208:211], v[72:75], a[128:131], v[208:211]
 s_waitcnt lgkmcnt(6)
 v_mfma_f32_16x16x32_bf16 v[224:227], v[80:83], a[128:131], v[224:227]
 ds_read_b64_tr_b16 v[68:69], v52 offset:24576
 buffer_load_dwordx4 a[232:235], v50, s[16:19], s78 offen offset:2048 sc1
 v_mfma_f32_16x16x32_bf16 v[224:227], v[84:87], a[144:147], v[224:227]
 ds_read_b64_tr_b16 v[70:71], v52 offset:28672
 v_mul_f32 v100, v100, v31
 v_mfma_f32_16x16x32_bf16 v[228:231], v[84:87], a[148:151], v[228:231]
 v_mul_f32 v101, v101, v31
 v_mul_f32 v102, v102, v31
 v_mfma_f32_16x16x32_bf16 v[228:231], v[80:83], a[132:135], v[228:231]
 v_mul_f32 v103, v103, v31
 v_mfma_f32_16x16x32_bf16 v[232:235], v[80:83], a[136:139], v[232:235]
 ds_read_b64_tr_b16 v[72:73], v53 offset:16384
 buffer_load_dwordx4 v43, s[12:15], s77 offen offset:3072  lds
 v_mfma_f32_16x16x32_bf16 v[232:235], v[84:87], a[152:155], v[232:235]
 ds_read_b64_tr_b16 v[74:75], v53 offset:20480
 v_cvt_pk_bf16_f32 v112, v96, v97
 v_mfma_f32_16x16x32_bf16 v[236:239], v[84:87], a[156:159], v[236:239]
 v_cvt_pk_bf16_f32 v113, v98, v99
 v_cvt_pk_bf16_f32 v114, v100, v101
 v_mfma_f32_16x16x32_bf16 v[236:239], v[80:83], a[140:143], v[236:239]
 s_waitcnt lgkmcnt(6)
 v_mfma_f32_16x16x32_bf16 v[252:255], v[88:91], a[140:143], v[252:255]
 ds_read_b64_tr_b16 v[76:77], v53 offset:24576
 buffer_load_dwordx4 a[236:239], v51, s[16:19], s78 offen offset:2048 sc1
 v_mfma_f32_16x16x32_bf16 v[252:255], v[92:95], a[156:159], v[252:255]
 ds_read_b64_tr_b16 v[78:79], v53 offset:28672
 v_cvt_pk_bf16_f32 v115, v102, v103
 v_mfma_f32_16x16x32_bf16 v[248:251], v[92:95], a[152:155], v[248:251]
 buffer_store_dwordx4 v[112:115], v34, s[32:35], s50 offen sc1
 v_accvgpr_read_b32 v104, a44
 v_mfma_f32_16x16x32_bf16 v[248:251], v[88:91], a[136:139], v[248:251]
 v_accvgpr_read_b32 v105, a45
 v_mfma_f32_16x16x32_bf16 v[244:247], v[88:91], a[132:135], v[244:247]
 ds_read_b64_tr_b16 v[80:81], v54 offset:16384
 v_accvgpr_read_b32 v106, a46
 v_mfma_f32_16x16x32_bf16 v[244:247], v[92:95], a[148:151], v[244:247]
 ds_read_b64_tr_b16 v[82:83], v54 offset:20480
 v_accvgpr_read_b32 v107, a47
 v_mfma_f32_16x16x32_bf16 v[240:243], v[92:95], a[144:147], v[240:243]
 v_accvgpr_read_b32 v108, a60
 v_accvgpr_read_b32 v109, a61
 v_mfma_f32_16x16x32_bf16 v[240:243], v[88:91], a[128:131], v[240:243]
 s_waitcnt lgkmcnt(6)
 s_waitcnt vmcnt(37)
 v_mfma_f32_16x16x32_bf16 v[128:131], v[64:67], a[160:163], v[128:131]
 ds_read_b64_tr_b16 v[84:85], v54 offset:24576
 buffer_load_dwordx4 a[240:243], v48, s[16:19], s78 offen offset:3072 sc1
 s_waitcnt vmcnt(31)
 v_mfma_f32_16x16x32_bf16 v[128:131], v[68:71], a[176:179], v[128:131]
 ds_read_b64_tr_b16 v[86:87], v54 offset:28672
 s_waitcnt vmcnt(28)
 v_accvgpr_read_b32 v110, a62
 v_mfma_f32_16x16x32_bf16 v[132:135], v[68:71], a[180:183], v[132:135]
 v_accvgpr_read_b32 v111, a63
 v_mul_f32 v104, v104, v31
 v_mfma_f32_16x16x32_bf16 v[132:135], v[64:67], a[164:167], v[132:135]
 v_mul_f32 v105, v105, v31
 v_mfma_f32_16x16x32_bf16 v[136:139], v[64:67], a[168:171], v[136:139]
 ds_read_b64_tr_b16 v[88:89], v55 offset:16384
 s_add_u32 m0, s79, 4096
 s_waitcnt vmcnt(27)
 v_mfma_f32_16x16x32_bf16 v[136:139], v[68:71], a[184:187], v[136:139]
 ds_read_b64_tr_b16 v[90:91], v55 offset:20480
 s_waitcnt vmcnt(25)
 v_mul_f32 v106, v106, v31
 v_mfma_f32_16x16x32_bf16 v[140:143], v[68:71], a[188:191], v[140:143]
 buffer_load_dwordx4 v44, s[12:15], s77 offen  lds
 v_mul_f32 v107, v107, v31
 v_mfma_f32_16x16x32_bf16 v[140:143], v[64:67], a[172:175], v[140:143]
 s_waitcnt lgkmcnt(6)
 v_mfma_f32_16x16x32_bf16 v[156:159], v[72:75], a[172:175], v[156:159]
 ds_read_b64_tr_b16 v[92:93], v55 offset:24576
 buffer_load_dwordx4 a[244:247], v49, s[16:19], s78 offen offset:3072 sc1
 v_mfma_f32_16x16x32_bf16 v[156:159], v[76:79], a[188:191], v[156:159]
 ds_read_b64_tr_b16 v[94:95], v55 offset:28672
 v_mul_f32 v108, v108, v31
 v_mfma_f32_16x16x32_bf16 v[152:155], v[76:79], a[184:187], v[152:155]
 v_mul_f32 v109, v109, v31
 v_mul_f32 v110, v110, v31
 v_mfma_f32_16x16x32_bf16 v[152:155], v[72:75], a[168:171], v[152:155]
 v_mul_f32 v111, v111, v31
 v_mfma_f32_16x16x32_bf16 v[148:151], v[72:75], a[164:167], v[148:151]
 ds_read_b64_tr_b16 v[64:65], v56 offset:16384
 v_cvt_pk_bf16_f32 v116, v104, v105
 v_mfma_f32_16x16x32_bf16 v[148:151], v[76:79], a[180:183], v[148:151]
 ds_read_b64_tr_b16 v[66:67], v56 offset:20480
 v_cvt_pk_bf16_f32 v117, v106, v107
 v_mfma_f32_16x16x32_bf16 v[144:147], v[76:79], a[176:179], v[144:147]
 v_cvt_pk_bf16_f32 v118, v108, v109
 v_cvt_pk_bf16_f32 v119, v110, v111
 v_mfma_f32_16x16x32_bf16 v[144:147], v[72:75], a[160:163], v[144:147]
 s_waitcnt lgkmcnt(6)
 v_mfma_f32_16x16x32_bf16 v[160:163], v[80:83], a[160:163], v[160:163]
 ds_read_b64_tr_b16 v[68:69], v56 offset:24576
 buffer_load_dwordx4 a[248:251], v50, s[16:19], s78 offen offset:3072 sc1
 v_mfma_f32_16x16x32_bf16 v[160:163], v[84:87], a[176:179], v[160:163]
 ds_read_b64_tr_b16 v[70:71], v56 offset:28672
 buffer_store_dwordx4 v[116:119], v34, s[32:35], s50 offen offset:1024 sc1
 v_mfma_f32_16x16x32_bf16 v[164:167], v[84:87], a[180:183], v[164:167]
 v_accvgpr_read_b32 v96, a76
 v_accvgpr_read_b32 v97, a77
 v_mfma_f32_16x16x32_bf16 v[164:167], v[80:83], a[164:167], v[164:167]
 v_accvgpr_read_b32 v98, a78
 v_mfma_f32_16x16x32_bf16 v[168:171], v[80:83], a[168:171], v[168:171]
 ds_read_b64_tr_b16 v[72:73], v57 offset:16384
 buffer_load_dwordx4 v45, s[12:15], s77 offen offset:1024  lds
 v_mfma_f32_16x16x32_bf16 v[168:171], v[84:87], a[184:187], v[168:171]
 ds_read_b64_tr_b16 v[74:75], v57 offset:20480
 v_accvgpr_read_b32 v99, a79
 v_mfma_f32_16x16x32_bf16 v[172:175], v[84:87], a[188:191], v[172:175]
 v_accvgpr_read_b32 v100, a92
 v_accvgpr_read_b32 v101, a93
 v_mfma_f32_16x16x32_bf16 v[172:175], v[80:83], a[172:175], v[172:175]
 s_waitcnt lgkmcnt(6)
 v_mfma_f32_16x16x32_bf16 v[188:191], v[88:91], a[172:175], v[188:191]
 ds_read_b64_tr_b16 v[76:77], v57 offset:24576
 buffer_load_dwordx4 a[252:255], v51, s[16:19], s78 offen offset:3072 sc1
 v_mfma_f32_16x16x32_bf16 v[188:191], v[92:95], a[188:191], v[188:191]
 ds_read_b64_tr_b16 v[78:79], v57 offset:28672
 s_add_u32 s78, s78, 4096
 v_mfma_f32_16x16x32_bf16 v[184:187], v[92:95], a[184:187], v[184:187]
 v_accvgpr_read_b32 v102, a94
 v_accvgpr_read_b32 v103, a95
 v_mfma_f32_16x16x32_bf16 v[184:187], v[88:91], a[168:171], v[184:187]
 v_mul_f32 v96, v96, v31
 v_mfma_f32_16x16x32_bf16 v[180:183], v[88:91], a[164:167], v[180:183]
 ds_read_b64_tr_b16 v[80:81], v58 offset:16384
 v_mul_f32 v97, v97, v31
 v_mfma_f32_16x16x32_bf16 v[180:183], v[92:95], a[180:183], v[180:183]
 ds_read_b64_tr_b16 v[82:83], v58 offset:20480
 v_mul_f32 v98, v98, v31
 v_mfma_f32_16x16x32_bf16 v[176:179], v[92:95], a[176:179], v[176:179]
 v_mul_f32 v99, v99, v31
 v_mul_f32 v100, v100, v31
 v_mfma_f32_16x16x32_bf16 v[176:179], v[88:91], a[160:163], v[176:179]
 s_waitcnt lgkmcnt(6)
 v_mfma_f32_16x16x32_bf16 v[192:195], v[64:67], a[160:163], v[192:195]
 ds_read_b64_tr_b16 v[84:85], v58 offset:24576
 buffer_load_dwordx4 a[128:131], v48, s[16:19], s78 offen sc1
 v_mfma_f32_16x16x32_bf16 v[192:195], v[68:71], a[176:179], v[192:195]
 ds_read_b64_tr_b16 v[86:87], v58 offset:28672
 v_mul_f32 v101, v101, v31
 v_mfma_f32_16x16x32_bf16 v[196:199], v[68:71], a[180:183], v[196:199]
 v_mul_f32 v102, v102, v31
 v_mul_f32 v103, v103, v31
 v_mfma_f32_16x16x32_bf16 v[196:199], v[64:67], a[164:167], v[196:199]
 v_cvt_pk_bf16_f32 v120, v96, v97
 v_mfma_f32_16x16x32_bf16 v[200:203], v[64:67], a[168:171], v[200:203]
 ds_read_b64_tr_b16 v[88:89], v59 offset:16384
 buffer_load_dwordx4 v46, s[12:15], s77 offen offset:2048  lds
 v_mfma_f32_16x16x32_bf16 v[200:203], v[68:71], a[184:187], v[200:203]
 ds_read_b64_tr_b16 v[90:91], v59 offset:20480
 v_cvt_pk_bf16_f32 v121, v98, v99
 v_mfma_f32_16x16x32_bf16 v[204:207], v[68:71], a[188:191], v[204:207]
 v_cvt_pk_bf16_f32 v122, v100, v101
 v_cvt_pk_bf16_f32 v123, v102, v103
 v_mfma_f32_16x16x32_bf16 v[204:207], v[64:67], a[172:175], v[204:207]
 s_waitcnt lgkmcnt(6)
 v_mfma_f32_16x16x32_bf16 v[220:223], v[72:75], a[172:175], v[220:223]
 ds_read_b64_tr_b16 v[92:93], v59 offset:24576
 buffer_load_dwordx4 a[132:135], v49, s[16:19], s78 offen sc1
 v_mfma_f32_16x16x32_bf16 v[220:223], v[76:79], a[188:191], v[220:223]
 ds_read_b64_tr_b16 v[94:95], v59 offset:28672
 buffer_store_dwordx4 v[120:123], v34, s[32:35], s50 offen offset:2048 sc1
 v_mfma_f32_16x16x32_bf16 v[216:219], v[76:79], a[184:187], v[216:219]
 v_accvgpr_read_b32 v104, a108
 v_accvgpr_read_b32 v105, a109
 v_mfma_f32_16x16x32_bf16 v[216:219], v[72:75], a[168:171], v[216:219]
 s_waitcnt vmcnt(29)
 s_barrier
 v_mfma_f32_16x16x32_bf16 v[212:215], v[72:75], a[164:167], v[212:215]
 ds_read_b64_tr_b16 v[64:65], v52 offset:32768
 v_accvgpr_read_b32 v106, a110
 v_mfma_f32_16x16x32_bf16 v[212:215], v[76:79], a[180:183], v[212:215]
 ds_read_b64_tr_b16 v[66:67], v52 offset:36864
 v_accvgpr_read_b32 v107, a111
 v_mfma_f32_16x16x32_bf16 v[208:211], v[76:79], a[176:179], v[208:211]
 v_accvgpr_read_b32 v108, a124
 v_accvgpr_read_b32 v109, a125
 v_mfma_f32_16x16x32_bf16 v[208:211], v[72:75], a[160:163], v[208:211]
 s_waitcnt lgkmcnt(6)
 v_mfma_f32_16x16x32_bf16 v[224:227], v[80:83], a[160:163], v[224:227]
 ds_read_b64_tr_b16 v[68:69], v52 offset:40960
 buffer_load_dwordx4 a[136:139], v50, s[16:19], s78 offen sc1
 v_mfma_f32_16x16x32_bf16 v[224:227], v[84:87], a[176:179], v[224:227]
 ds_read_b64_tr_b16 v[70:71], v52 offset:45056
 v_accvgpr_read_b32 v110, a126
 v_mfma_f32_16x16x32_bf16 v[228:231], v[84:87], a[180:183], v[228:231]
 v_accvgpr_read_b32 v111, a127
 v_mul_f32 v104, v104, v31
 v_mfma_f32_16x16x32_bf16 v[228:231], v[80:83], a[164:167], v[228:231]
 v_mul_f32 v105, v105, v31
 v_mfma_f32_16x16x32_bf16 v[232:235], v[80:83], a[168:171], v[232:235]
 ds_read_b64_tr_b16 v[72:73], v53 offset:32768
 buffer_load_dwordx4 v47, s[12:15], s77 offen offset:3072  lds
 v_mfma_f32_16x16x32_bf16 v[232:235], v[84:87], a[184:187], v[232:235]
 ds_read_b64_tr_b16 v[74:75], v53 offset:36864
 s_add_u32 s77, s77, 262144
 v_mfma_f32_16x16x32_bf16 v[236:239], v[84:87], a[188:191], v[236:239]
 v_mul_f32 v106, v106, v31
 v_mul_f32 v107, v107, v31
 v_mfma_f32_16x16x32_bf16 v[236:239], v[80:83], a[172:175], v[236:239]
 s_waitcnt lgkmcnt(6)
 v_mfma_f32_16x16x32_bf16 v[252:255], v[88:91], a[172:175], v[252:255]
 ds_read_b64_tr_b16 v[76:77], v53 offset:40960
 buffer_load_dwordx4 a[140:143], v51, s[16:19], s78 offen sc1
 v_mfma_f32_16x16x32_bf16 v[252:255], v[92:95], a[188:191], v[252:255]
 ds_read_b64_tr_b16 v[78:79], v53 offset:45056
 buffer_load_dword v61, v0, s[60:63], 0 offen
 v_mul_f32 v108, v108, v31
 v_mfma_f32_16x16x32_bf16 v[248:251], v[92:95], a[184:187], v[248:251]
 v_mul_f32 v109, v109, v31
 v_mul_f32 v110, v110, v31
 v_mfma_f32_16x16x32_bf16 v[248:251], v[88:91], a[168:171], v[248:251]
 v_mul_f32 v111, v111, v31
 v_mfma_f32_16x16x32_bf16 v[244:247], v[88:91], a[164:167], v[244:247]
 ds_read_b64_tr_b16 v[80:81], v54 offset:32768
 v_cvt_pk_bf16_f32 v124, v104, v105
 v_mfma_f32_16x16x32_bf16 v[244:247], v[92:95], a[180:183], v[244:247]
 ds_read_b64_tr_b16 v[82:83], v54 offset:36864
 v_cvt_pk_bf16_f32 v125, v106, v107
 v_mfma_f32_16x16x32_bf16 v[240:243], v[92:95], a[176:179], v[240:243]
 v_cvt_pk_bf16_f32 v126, v108, v109
 v_cvt_pk_bf16_f32 v127, v110, v111
 v_mfma_f32_16x16x32_bf16 v[240:243], v[88:91], a[160:163], v[240:243]
 s_waitcnt lgkmcnt(6)
 buffer_store_dwordx4 v[124:127], v34, s[32:35], s50 offen offset:3072 sc1
 v_mfma_f32_16x16x32_bf16 v[128:131], v[64:67], a[192:195], v[128:131]
 ds_read_b64_tr_b16 v[84:85], v54 offset:40960
 buffer_load_dwordx4 a[144:147], v48, s[16:19], s78 offen offset:1024 sc1
 s_waitcnt vmcnt(31)
 v_mfma_f32_16x16x32_bf16 v[128:131], v[68:71], a[208:211], v[128:131]
 ds_read_b64_tr_b16 v[86:87], v54 offset:45056
 s_add_u32 s20, s86, 0x500000
 s_addc_u32 s21, s87, 0
 s_waitcnt vmcnt(29)
 v_mfma_f32_16x16x32_bf16 v[132:135], v[68:71], a[212:215], v[132:135]
 s_mov_b32 s22, 0x1100000
 s_mov_b32 s23, 0x20000
 v_mfma_f32_16x16x32_bf16 v[132:135], v[64:67], a[196:199], v[132:135]
 s_lshl_b32 s42, s70, 3
 v_mfma_f32_16x16x32_bf16 v[136:139], v[64:67], a[200:203], v[136:139]
 ds_read_b64_tr_b16 v[88:89], v55 offset:32768
 s_add_u32 m0, s79, 32768
 s_waitcnt vmcnt(27)
 v_mfma_f32_16x16x32_bf16 v[136:139], v[68:71], a[216:219], v[136:139]
 ds_read_b64_tr_b16 v[90:91], v55 offset:36864
 s_add_u32 s42, s42, 1
 s_waitcnt vmcnt(25)
 v_mfma_f32_16x16x32_bf16 v[140:143], v[68:71], a[220:223], v[140:143]
 buffer_load_dwordx4 v40, s[12:15], s77 offen  lds
 s_lshl_b32 s50, s71, 5
 v_mfma_f32_16x16x32_bf16 v[140:143], v[64:67], a[204:207], v[140:143]
 s_waitcnt lgkmcnt(6)
 v_mfma_f32_16x16x32_bf16 v[156:159], v[72:75], a[204:207], v[156:159]
 ds_read_b64_tr_b16 v[92:93], v55 offset:40960
 buffer_load_dwordx4 a[148:151], v49, s[16:19], s78 offen offset:1024 sc1
 v_mfma_f32_16x16x32_bf16 v[156:159], v[76:79], a[220:223], v[156:159]
 ds_read_b64_tr_b16 v[94:95], v55 offset:45056
 s_add_u32 s50, s50, s42
 v_mfma_f32_16x16x32_bf16 v[152:155], v[76:79], a[216:219], v[152:155]
 s_add_u32 s50, s50, 512
 s_lshl_b32 s50, s50, 7
 v_mfma_f32_16x16x32_bf16 v[152:155], v[72:75], a[200:203], v[152:155]
 v_and_b32 v60, 15, v1
 v_mfma_f32_16x16x32_bf16 v[148:151], v[72:75], a[196:199], v[148:151]
 ds_read_b64_tr_b16 v[64:65], v56 offset:32768
 v_min_u32 v60, 6, v60
 v_mfma_f32_16x16x32_bf16 v[148:151], v[76:79], a[212:215], v[148:151]
 ds_read_b64_tr_b16 v[66:67], v56 offset:36864
 v_lshl_add_u32 v60, v60, 7, s50
 v_mfma_f32_16x16x32_bf16 v[144:147], v[76:79], a[208:211], v[144:147]
 s_lshl_b32 s75, s42, 18
 s_lshl_b32 s42, s42, 12
 v_mfma_f32_16x16x32_bf16 v[144:147], v[72:75], a[192:195], v[144:147]
 s_waitcnt lgkmcnt(6)
 v_mfma_f32_16x16x32_bf16 v[160:163], v[80:83], a[192:195], v[160:163]
 ds_read_b64_tr_b16 v[68:69], v56 offset:40960
 buffer_load_dwordx4 a[152:155], v50, s[16:19], s78 offen offset:1024 sc1
 v_mfma_f32_16x16x32_bf16 v[160:163], v[84:87], a[208:211], v[160:163]
 ds_read_b64_tr_b16 v[70:71], v56 offset:45056
 s_lshl_b32 s50, s71, 4
 v_mfma_f32_16x16x32_bf16 v[164:167], v[84:87], a[212:215], v[164:167]
 s_lshl_b32 s52, s36, 2
 s_add_u32 s50, s50, s52
 v_mfma_f32_16x16x32_bf16 v[164:167], v[80:83], a[196:199], v[164:167]
 s_mul_i32 s52, s50, 131328
 v_mfma_f32_16x16x32_bf16 v[168:171], v[80:83], a[200:203], v[168:171]
 ds_read_b64_tr_b16 v[72:73], v57 offset:32768
 buffer_load_dwordx4 v41, s[12:15], s77 offen offset:1024  lds
 v_mfma_f32_16x16x32_bf16 v[168:171], v[84:87], a[216:219], v[168:171]
 ds_read_b64_tr_b16 v[74:75], v57 offset:36864
 s_and_b32 s53, s70, 1
 v_mfma_f32_16x16x32_bf16 v[172:175], v[84:87], a[220:223], v[172:175]
 s_mul_i32 s53, s53, 262656
 v_lshlrev_b32 v24, 4, v1
 v_mfma_f32_16x16x32_bf16 v[172:175], v[80:83], a[204:207], v[172:175]
 s_waitcnt lgkmcnt(6)
 v_mfma_f32_16x16x32_bf16 v[188:191], v[88:91], a[204:207], v[188:191]
 ds_read_b64_tr_b16 v[76:77], v57 offset:40960
 buffer_load_dwordx4 a[156:159], v51, s[16:19], s78 offen offset:1024 sc1
 v_mfma_f32_16x16x32_bf16 v[188:191], v[92:95], a[220:223], v[188:191]
 ds_read_b64_tr_b16 v[78:79], v57 offset:45056
 v_add_u32 v6, s52, v24
 v_mfma_f32_16x16x32_bf16 v[184:187], v[92:95], a[216:219], v[184:187]
 v_add_u32 v4, s53, v6
 v_add_u32 v5, 131328, v4
 v_mfma_f32_16x16x32_bf16 v[184:187], v[88:91], a[200:203], v[184:187]
 s_sub_u32 s53, 262656, s53
 v_mfma_f32_16x16x32_bf16 v[180:183], v[88:91], a[196:199], v[180:183]
 ds_read_b64_tr_b16 v[80:81], v58 offset:32768
 v_add_u32 v6, s53, v6
 v_mfma_f32_16x16x32_bf16 v[180:183], v[92:95], a[212:215], v[180:183]
 ds_read_b64_tr_b16 v[82:83], v58 offset:36864
 v_mfma_f32_16x16x32_bf16 v[176:179], v[92:95], a[208:211], v[176:179]
 v_add_u32 v7, 131328, v6
 v_mfma_f32_16x16x32_bf16 v[176:179], v[88:91], a[192:195], v[176:179]
 s_waitcnt lgkmcnt(6)
 v_mfma_f32_16x16x32_bf16 v[192:195], v[64:67], a[192:195], v[192:195]
 ds_read_b64_tr_b16 v[84:85], v58 offset:40960
 buffer_load_dwordx4 a[160:163], v48, s[16:19], s78 offen offset:2048 sc1
 v_mfma_f32_16x16x32_bf16 v[192:195], v[68:71], a[208:211], v[192:195]
 ds_read_b64_tr_b16 v[86:87], v58 offset:45056
 v_add_u32 v20, 32768, v27
 v_mfma_f32_16x16x32_bf16 v[196:199], v[68:71], a[212:215], v[196:199]
 s_mov_b32 s28, s82
 s_mov_b32 s29, s83
 v_mfma_f32_16x16x32_bf16 v[196:199], v[64:67], a[196:199], v[196:199]
 s_mov_b32 s30, 0x400000
 v_mfma_f32_16x16x32_bf16 v[200:203], v[64:67], a[200:203], v[200:203]
 ds_read_b64_tr_b16 v[88:89], v59 offset:32768
 buffer_load_dwordx4 v42, s[12:15], s77 offen offset:2048  lds
 v_mfma_f32_16x16x32_bf16 v[200:203], v[68:71], a[216:219], v[200:203]
 ds_read_b64_tr_b16 v[90:91], v59 offset:36864
 s_mov_b32 s31, 0x20000
 v_mfma_f32_16x16x32_bf16 v[204:207], v[68:71], a[220:223], v[204:207]
 s_add_u32 s60, s86, 0x4000000
 s_addc_u32 s61, s87, 0
 s_mov_b32 s62, 0x1800000
 v_mfma_f32_16x16x32_bf16 v[204:207], v[64:67], a[204:207], v[204:207]
 s_waitcnt lgkmcnt(6)
 v_mfma_f32_16x16x32_bf16 v[220:223], v[72:75], a[204:207], v[220:223]
 ds_read_b64_tr_b16 v[92:93], v59 offset:40960
 buffer_load_dwordx4 a[164:167], v49, s[16:19], s78 offen offset:2048 sc1
 v_mfma_f32_16x16x32_bf16 v[220:223], v[76:79], a[220:223], v[220:223]
 ds_read_b64_tr_b16 v[94:95], v59 offset:45056
 s_mov_b32 s63, 0x20000
 v_mfma_f32_16x16x32_bf16 v[216:219], v[76:79], a[216:219], v[216:219]
 s_lshl_b32 s50, s71, 3
 s_add_u32 s50, s50, s76
 v_mfma_f32_16x16x32_bf16 v[216:219], v[72:75], a[200:203], v[216:219]
 s_lshl_b32 s50, s50, 2
 v_mfma_f32_16x16x32_bf16 v[212:215], v[72:75], a[196:199], v[212:215]
 ds_read_b64_tr_b16 v[64:65], v52 offset:49152
 v_mfma_f32_16x16x32_bf16 v[212:215], v[76:79], a[212:215], v[212:215]
 ds_read_b64_tr_b16 v[66:67], v52 offset:53248
 s_add_u32 s51, s50, s70
 v_mfma_f32_16x16x32_bf16 v[208:211], v[76:79], a[208:211], v[208:211]
 s_add_u32 s52, s51, 768
 v_mfma_f32_16x16x32_bf16 v[208:211], v[72:75], a[192:195], v[208:211]
 s_waitcnt lgkmcnt(6)
 v_mfma_f32_16x16x32_bf16 v[224:227], v[80:83], a[192:195], v[224:227]
 ds_read_b64_tr_b16 v[68:69], v52 offset:57344
 buffer_load_dwordx4 a[168:171], v50, s[16:19], s78 offen offset:2048 sc1
 v_mfma_f32_16x16x32_bf16 v[224:227], v[84:87], a[208:211], v[224:227]
 ds_read_b64_tr_b16 v[70:71], v52 offset:61440
 s_lshl_b32 s52, s52, 7
 v_mfma_f32_16x16x32_bf16 v[228:231], v[84:87], a[212:215], v[228:231]
 v_xor_b32 v52, s49, v52
 v_mov_b32 v21, s52
 v_mfma_f32_16x16x32_bf16 v[228:231], v[80:83], a[196:199], v[228:231]
 v_add_u32 v22, 32768, v21
 v_mfma_f32_16x16x32_bf16 v[232:235], v[80:83], a[200:203], v[232:235]
 ds_read_b64_tr_b16 v[72:73], v53 offset:49152
 buffer_load_dwordx4 v43, s[12:15], s77 offen offset:3072  lds
 v_mfma_f32_16x16x32_bf16 v[232:235], v[84:87], a[216:219], v[232:235]
 ds_read_b64_tr_b16 v[74:75], v53 offset:53248
 s_add_u32 s52, s50, 768
 v_mfma_f32_16x16x32_bf16 v[236:239], v[84:87], a[220:223], v[236:239]
 s_lshl_b32 s52, s52, 7
 v_and_b32 v23, 3, v1
 v_mfma_f32_16x16x32_bf16 v[236:239], v[80:83], a[204:207], v[236:239]
 s_waitcnt lgkmcnt(6)
 v_mfma_f32_16x16x32_bf16 v[252:255], v[88:91], a[204:207], v[252:255]
 ds_read_b64_tr_b16 v[76:77], v53 offset:57344
 buffer_load_dwordx4 a[172:175], v51, s[16:19], s78 offen offset:2048 sc1
 v_mfma_f32_16x16x32_bf16 v[252:255], v[92:95], a[220:223], v[252:255]
 ds_read_b64_tr_b16 v[78:79], v53 offset:61440
 v_lshl_add_u32 v23, v23, 7, s52
 v_mfma_f32_16x16x32_bf16 v[248:251], v[92:95], a[216:219], v[248:251]
 s_mul_i32 s53, s36, 12288
 v_xor_b32 v53, s49, v53
 v_mfma_f32_16x16x32_bf16 v[248:251], v[88:91], a[200:203], v[248:251]
 s_mul_i32 s33, s51, 49152
 v_mfma_f32_16x16x32_bf16 v[244:247], v[88:91], a[196:199], v[244:247]
 ds_read_b64_tr_b16 v[80:81], v54 offset:49152
 s_add_u32 s33, s33, s53
 v_mfma_f32_16x16x32_bf16 v[244:247], v[92:95], a[212:215], v[244:247]
 ds_read_b64_tr_b16 v[82:83], v54 offset:53248
 s_xor_b32 s52, s51, 1
 v_mfma_f32_16x16x32_bf16 v[240:243], v[92:95], a[208:211], v[240:243]
 s_mul_i32 s52, s52, 49152
 s_add_u32 s52, s52, s53
 v_mfma_f32_16x16x32_bf16 v[240:243], v[88:91], a[192:195], v[240:243]
 s_waitcnt lgkmcnt(6)
 s_waitcnt vmcnt(35)
 v_mfma_f32_16x16x32_bf16 v[128:131], v[64:67], a[224:227], v[128:131]
 ds_read_b64_tr_b16 v[84:85], v54 offset:57344
 buffer_load_dwordx4 a[176:179], v48, s[16:19], s78 offen offset:3072 sc1
 s_waitcnt vmcnt(28)
 v_mfma_f32_16x16x32_bf16 v[128:131], v[68:71], a[240:243], v[128:131]
 ds_read_b64_tr_b16 v[86:87], v54 offset:61440
 s_add_u32 s52, s52, 0
 s_waitcnt vmcnt(26)
 v_mfma_f32_16x16x32_bf16 v[132:135], v[68:71], a[244:247], v[132:135]
 v_xor_b32 v54, s49, v54
 v_add_u32 v25, s52, v24
 v_mfma_f32_16x16x32_bf16 v[132:135], v[64:67], a[228:231], v[132:135]
 s_xor_b32 s52, s51, 2
 v_mfma_f32_16x16x32_bf16 v[136:139], v[64:67], a[232:235], v[136:139]
 ds_read_b64_tr_b16 v[88:89], v55 offset:49152
 s_add_u32 m0, s79, 36864
 s_waitcnt vmcnt(25)
 v_mfma_f32_16x16x32_bf16 v[136:139], v[68:71], a[248:251], v[136:139]
 ds_read_b64_tr_b16 v[90:91], v55 offset:53248
 s_mul_i32 s52, s52, 49152
 s_waitcnt vmcnt(22)
 v_mfma_f32_16x16x32_bf16 v[140:143], v[68:71], a[252:255], v[140:143]
 buffer_load_dwordx4 v44, s[12:15], s77 offen  lds
 s_add_u32 s52, s52, s53
 v_mfma_f32_16x16x32_bf16 v[140:143], v[64:67], a[236:239], v[140:143]
 s_waitcnt lgkmcnt(6)
 v_mfma_f32_16x16x32_bf16 v[156:159], v[72:75], a[236:239], v[156:159]
 ds_read_b64_tr_b16 v[92:93], v55 offset:57344
 buffer_load_dwordx4 a[180:183], v49, s[16:19], s78 offen offset:3072 sc1
 v_mfma_f32_16x16x32_bf16 v[156:159], v[76:79], a[252:255], v[156:159]
 ds_read_b64_tr_b16 v[94:95], v55 offset:61440
 s_add_u32 s52, s52, 4096
 v_mfma_f32_16x16x32_bf16 v[152:155], v[76:79], a[248:251], v[152:155]
 v_xor_b32 v55, s49, v55
 v_add_u32 v26, s52, v24
 v_mfma_f32_16x16x32_bf16 v[152:155], v[72:75], a[232:235], v[152:155]
 s_xor_b32 s52, s51, 3
 v_mfma_f32_16x16x32_bf16 v[148:151], v[72:75], a[228:231], v[148:151]
 ds_read_b64_tr_b16 v[64:65], v56 offset:49152
 s_mul_i32 s52, s52, 49152
 v_mfma_f32_16x16x32_bf16 v[148:151], v[76:79], a[244:247], v[148:151]
 ds_read_b64_tr_b16 v[66:67], v56 offset:53248
 s_add_u32 s52, s52, s53
 v_mfma_f32_16x16x32_bf16 v[144:147], v[76:79], a[240:243], v[144:147]
 s_add_u32 s52, s52, 8192
 v_add_u32 v27, s52, v24
 v_mfma_f32_16x16x32_bf16 v[144:147], v[72:75], a[224:227], v[144:147]
 s_waitcnt lgkmcnt(6)
 v_mfma_f32_16x16x32_bf16 v[160:163], v[80:83], a[224:227], v[160:163]
 ds_read_b64_tr_b16 v[68:69], v56 offset:57344
 buffer_load_dwordx4 a[184:187], v50, s[16:19], s78 offen offset:3072 sc1
 v_mfma_f32_16x16x32_bf16 v[160:163], v[84:87], a[240:243], v[160:163]
 ds_read_b64_tr_b16 v[70:71], v56 offset:61440
 s_lshl_b32 s52, s71, 8
 v_mfma_f32_16x16x32_bf16 v[164:167], v[84:87], a[244:247], v[164:167]
 s_lshl_b32 s53, s36, 6
 v_xor_b32 v56, s49, v56
 v_mfma_f32_16x16x32_bf16 v[164:167], v[80:83], a[228:231], v[164:167]
 s_add_u32 s52, s52, s53
 v_mfma_f32_16x16x32_bf16 v[168:171], v[80:83], a[232:235], v[168:171]
 ds_read_b64_tr_b16 v[72:73], v57 offset:49152
 buffer_load_dwordx4 v45, s[12:15], s77 offen offset:1024  lds
 v_mfma_f32_16x16x32_bf16 v[168:171], v[84:87], a[248:251], v[168:171]
 ds_read_b64_tr_b16 v[74:75], v57 offset:53248
 s_and_b32 s53, s70, 1
 v_mfma_f32_16x16x32_bf16 v[172:175], v[84:87], a[252:255], v[172:175]
 s_lshl_b32 s53, s53, 5
 s_add_u32 s52, s52, s53
 v_mfma_f32_16x16x32_bf16 v[172:175], v[80:83], a[236:239], v[172:175]
 s_waitcnt lgkmcnt(6)
 v_mfma_f32_16x16x32_bf16 v[188:191], v[88:91], a[236:239], v[188:191]
 ds_read_b64_tr_b16 v[76:77], v57 offset:57344
 buffer_load_dwordx4 a[188:191], v51, s[16:19], s78 offen offset:3072 sc1
 v_mfma_f32_16x16x32_bf16 v[188:191], v[92:95], a[252:255], v[188:191]
 ds_read_b64_tr_b16 v[78:79], v57 offset:61440
 s_add_u32 s78, s78, 4096
 v_mfma_f32_16x16x32_bf16 v[184:187], v[92:95], a[248:251], v[184:187]
 s_lshl_b32 s52, s52, 11
 v_xor_b32 v57, s49, v57
 v_mfma_f32_16x16x32_bf16 v[184:187], v[88:91], a[232:235], v[184:187]
 s_lshl_b32 s53, s76, 8
 v_mfma_f32_16x16x32_bf16 v[180:183], v[88:91], a[228:231], v[180:183]
 ds_read_b64_tr_b16 v[80:81], v58 offset:49152
 s_add_u32 s52, s52, s53
 v_mfma_f32_16x16x32_bf16 v[180:183], v[92:95], a[244:247], v[180:183]
 ds_read_b64_tr_b16 v[82:83], v58 offset:53248
 s_lshr_b32 s53, s70, 1
 v_mfma_f32_16x16x32_bf16 v[176:179], v[92:95], a[240:243], v[176:179]
 s_lshl_b32 s53, s53, 7
 s_add_u32 s52, s52, s53
 v_mfma_f32_16x16x32_bf16 v[176:179], v[88:91], a[224:227], v[176:179]
 s_waitcnt lgkmcnt(6)
 v_mfma_f32_16x16x32_bf16 v[192:195], v[64:67], a[224:227], v[192:195]
 ds_read_b64_tr_b16 v[84:85], v58 offset:57344
 buffer_load_dwordx4 a[192:195], v48, s[16:19], s78 offen sc1
 v_mfma_f32_16x16x32_bf16 v[192:195], v[68:71], a[240:243], v[192:195]
 ds_read_b64_tr_b16 v[86:87], v58 offset:61440
 v_and_b32 v36, 7, v1
 v_mfma_f32_16x16x32_bf16 v[196:199], v[68:71], a[244:247], v[196:199]
 v_xor_b32 v58, s49, v58
 v_lshlrev_b32 v36, 11, v36
 v_mfma_f32_16x16x32_bf16 v[196:199], v[64:67], a[228:231], v[196:199]
 v_bfe_u32 v37, v1, 3, 1
 v_mfma_f32_16x16x32_bf16 v[200:203], v[64:67], a[232:235], v[200:203]
 ds_read_b64_tr_b16 v[88:89], v59 offset:49152
 buffer_load_dwordx4 v46, s[12:15], s77 offen offset:2048  lds
 v_mfma_f32_16x16x32_bf16 v[200:203], v[68:71], a[248:251], v[200:203]
 ds_read_b64_tr_b16 v[90:91], v59 offset:53248
 v_lshl_add_u32 v36, v37, 6, v36
 v_mfma_f32_16x16x32_bf16 v[204:207], v[68:71], a[252:255], v[204:207]
 v_bfe_u32 v37, v1, 4, 1
 v_lshl_add_u32 v36, v37, 5, v36
 v_mfma_f32_16x16x32_bf16 v[204:207], v[64:67], a[236:239], v[204:207]
 s_waitcnt lgkmcnt(6)
 v_mfma_f32_16x16x32_bf16 v[220:223], v[72:75], a[236:239], v[220:223]
 ds_read_b64_tr_b16 v[92:93], v59 offset:57344
 buffer_load_dwordx4 a[196:199], v49, s[16:19], s78 offen sc1
 v_mfma_f32_16x16x32_bf16 v[220:223], v[76:79], a[252:255], v[220:223]
 ds_read_b64_tr_b16 v[94:95], v59 offset:61440
 v_lshrrev_b32 v37, 5, v1
 v_mfma_f32_16x16x32_bf16 v[216:219], v[76:79], a[248:251], v[216:219]
 v_xor_b32 v59, s49, v59
 v_lshl_add_u32 v36, v37, 4, v36
 v_mfma_f32_16x16x32_bf16 v[216:219], v[72:75], a[232:235], v[216:219]
 s_waitcnt vmcnt(24)
 s_waitcnt vmcnt(21)
 s_barrier
 v_add_u32 v16, s52, v36
 v_mfma_f32_16x16x32_bf16 v[212:215], v[72:75], a[228:231], v[212:215]
 ds_read_b64_tr_b16 v[64:65], v52
 v_mfma_f32_16x16x32_bf16 v[212:215], v[76:79], a[244:247], v[212:215]
 ds_read_b64_tr_b16 v[66:67], v52 offset:4096
 v_mfma_f32_16x16x32_bf16 v[208:211], v[76:79], a[240:243], v[208:211]
 s_cmp_eq_u32 s36, 1
 s_cbranch_scc0 C_of_77
 buffer_store_dwordx2 v[2:3], v20, s[56:59], 0 offen sc1
C_of_77:
 v_mfma_f32_16x16x32_bf16 v[208:211], v[72:75], a[224:227], v[208:211]
 s_waitcnt lgkmcnt(6)
 v_mfma_f32_16x16x32_bf16 v[224:227], v[80:83], a[224:227], v[224:227]
 ds_read_b64_tr_b16 v[68:69], v52 offset:8192
 buffer_load_dwordx4 a[200:203], v50, s[16:19], s78 offen sc1
 v_mfma_f32_16x16x32_bf16 v[224:227], v[84:87], a[240:243], v[224:227]
 ds_read_b64_tr_b16 v[70:71], v52 offset:12288
 v_mfma_f32_16x16x32_bf16 v[228:231], v[84:87], a[244:247], v[228:231]
 v_mfma_f32_16x16x32_bf16 v[228:231], v[80:83], a[228:231], v[228:231]
 v_mfma_f32_16x16x32_bf16 v[232:235], v[80:83], a[232:235], v[232:235]
 ds_read_b64_tr_b16 v[72:73], v53
 buffer_load_dwordx4 v47, s[12:15], s77 offen offset:3072  lds
 v_mfma_f32_16x16x32_bf16 v[232:235], v[84:87], a[248:251], v[232:235]
 ds_read_b64_tr_b16 v[74:75], v53 offset:4096
 s_add_u32 s77, s77, 262144
 v_mfma_f32_16x16x32_bf16 v[236:239], v[84:87], a[252:255], v[236:239]
 v_mfma_f32_16x16x32_bf16 v[236:239], v[80:83], a[236:239], v[236:239]
 s_waitcnt lgkmcnt(6)
 v_mfma_f32_16x16x32_bf16 v[252:255], v[88:91], a[236:239], v[252:255]
 ds_read_b64_tr_b16 v[76:77], v53 offset:8192
 buffer_load_dwordx4 a[204:207], v51, s[16:19], s78 offen sc1
 v_mfma_f32_16x16x32_bf16 v[252:255], v[92:95], a[252:255], v[252:255]
 ds_read_b64_tr_b16 v[78:79], v53 offset:12288
 v_mfma_f32_16x16x32_bf16 v[248:251], v[92:95], a[248:251], v[248:251]
 v_mfma_f32_16x16x32_bf16 v[248:251], v[88:91], a[232:235], v[248:251]
 v_mfma_f32_16x16x32_bf16 v[244:247], v[88:91], a[228:231], v[244:247]
 ds_read_b64_tr_b16 v[80:81], v54
 v_mfma_f32_16x16x32_bf16 v[244:247], v[92:95], a[244:247], v[244:247]
 ds_read_b64_tr_b16 v[82:83], v54 offset:4096
 v_mfma_f32_16x16x32_bf16 v[240:243], v[92:95], a[240:243], v[240:243]
 v_mfma_f32_16x16x32_bf16 v[240:243], v[88:91], a[224:227], v[240:243]
 s_waitcnt lgkmcnt(6)
 v_mfma_f32_16x16x32_bf16 v[128:131], v[64:67], a[128:131], v[128:131]
 ds_read_b64_tr_b16 v[84:85], v54 offset:8192
 buffer_load_dwordx4 a[208:211], v48, s[16:19], s78 offen offset:1024 sc1
 s_waitcnt vmcnt(24)
 v_mfma_f32_16x16x32_bf16 v[128:131], v[68:71], a[144:147], v[128:131]
 ds_read_b64_tr_b16 v[86:87], v54 offset:12288
 s_waitcnt vmcnt(22)
 v_mfma_f32_16x16x32_bf16 v[132:135], v[68:71], a[148:151], v[132:135]
 v_mfma_f32_16x16x32_bf16 v[132:135], v[64:67], a[132:135], v[132:135]
 v_mfma_f32_16x16x32_bf16 v[136:139], v[64:67], a[136:139], v[136:139]
 ds_read_b64_tr_b16 v[88:89], v55
 s_add_u32 m0, s79, 65536
 s_waitcnt vmcnt(21)
 v_mfma_f32_16x16x32_bf16 v[136:139], v[68:71], a[152:155], v[136:139]
 ds_read_b64_tr_b16 v[90:91], v55 offset:4096
 s_waitcnt vmcnt(19)
 v_mfma_f32_16x16x32_bf16 v[140:143], v[68:71], a[156:159], v[140:143]
 buffer_load_dwordx4 v40, s[12:15], s77 offen  lds
 v_mfma_f32_16x16x32_bf16 v[140:143], v[64:67], a[140:143], v[140:143]
 s_waitcnt lgkmcnt(6)
 v_mfma_f32_16x16x32_bf16 v[156:159], v[72:75], a[140:143], v[156:159]
 ds_read_b64_tr_b16 v[92:93], v55 offset:8192
 buffer_load_dwordx4 a[212:215], v49, s[16:19], s78 offen offset:1024 sc1
 v_mfma_f32_16x16x32_bf16 v[156:159], v[76:79], a[156:159], v[156:159]
 ds_read_b64_tr_b16 v[94:95], v55 offset:12288
 v_mfma_f32_16x16x32_bf16 v[152:155], v[76:79], a[152:155], v[152:155]
 v_mfma_f32_16x16x32_bf16 v[152:155], v[72:75], a[136:139], v[152:155]
 v_mfma_f32_16x16x32_bf16 v[148:151], v[72:75], a[132:135], v[148:151]
 ds_read_b64_tr_b16 v[64:65], v56
 v_mfma_f32_16x16x32_bf16 v[148:151], v[76:79], a[148:151], v[148:151]
 ds_read_b64_tr_b16 v[66:67], v56 offset:4096
 v_mfma_f32_16x16x32_bf16 v[144:147], v[76:79], a[144:147], v[144:147]
 v_mfma_f32_16x16x32_bf16 v[144:147], v[72:75], a[128:131], v[144:147]
 s_waitcnt lgkmcnt(6)
 v_mfma_f32_16x16x32_bf16 v[160:163], v[80:83], a[128:131], v[160:163]
 ds_read_b64_tr_b16 v[68:69], v56 offset:8192
 buffer_load_dwordx4 a[216:219], v50, s[16:19], s78 offen offset:1024 sc1
 v_mfma_f32_16x16x32_bf16 v[160:163], v[84:87], a[144:147], v[160:163]
 ds_read_b64_tr_b16 v[70:71], v56 offset:12288
 v_mfma_f32_16x16x32_bf16 v[164:167], v[84:87], a[148:151], v[164:167]
 v_mfma_f32_16x16x32_bf16 v[164:167], v[80:83], a[132:135], v[164:167]
 v_mfma_f32_16x16x32_bf16 v[168:171], v[80:83], a[136:139], v[168:171]
 ds_read_b64_tr_b16 v[72:73], v57
 buffer_load_dwordx4 v41, s[12:15], s77 offen offset:1024  lds
 v_mfma_f32_16x16x32_bf16 v[168:171], v[84:87], a[152:155], v[168:171]
 ds_read_b64_tr_b16 v[74:75], v57 offset:4096
 v_mfma_f32_16x16x32_bf16 v[172:175], v[84:87], a[156:159], v[172:175]
 v_mfma_f32_16x16x32_bf16 v[172:175], v[80:83], a[140:143], v[172:175]
 s_waitcnt lgkmcnt(6)
 v_mfma_f32_16x16x32_bf16 v[188:191], v[88:91], a[140:143], v[188:191]
 ds_read_b64_tr_b16 v[76:77], v57 offset:8192
 buffer_load_dwordx4 a[220:223], v51, s[16:19], s78 offen offset:1024 sc1
 v_mfma_f32_16x16x32_bf16 v[188:191], v[92:95], a[156:159], v[188:191]
 ds_read_b64_tr_b16 v[78:79], v57 offset:12288
 v_mfma_f32_16x16x32_bf16 v[184:187], v[92:95], a[152:155], v[184:187]
 v_mfma_f32_16x16x32_bf16 v[184:187], v[88:91], a[136:139], v[184:187]
 v_mfma_f32_16x16x32_bf16 v[180:183], v[88:91], a[132:135], v[180:183]
 ds_read_b64_tr_b16 v[80:81], v58
 v_mfma_f32_16x16x32_bf16 v[180:183], v[92:95], a[148:151], v[180:183]
 ds_read_b64_tr_b16 v[82:83], v58 offset:4096
 v_mfma_f32_16x16x32_bf16 v[176:179], v[92:95], a[144:147], v[176:179]
 v_mfma_f32_16x16x32_bf16 v[176:179], v[88:91], a[128:131], v[176:179]
 s_waitcnt lgkmcnt(6)
 v_mfma_f32_16x16x32_bf16 v[192:195], v[64:67], a[128:131], v[192:195]
 ds_read_b64_tr_b16 v[84:85], v58 offset:8192
 buffer_load_dwordx4 a[224:227], v48, s[16:19], s78 offen offset:2048 sc1
 v_mfma_f32_16x16x32_bf16 v[192:195], v[68:71], a[144:147], v[192:195]
 ds_read_b64_tr_b16 v[86:87], v58 offset:12288
 v_mfma_f32_16x16x32_bf16 v[196:199], v[68:71], a[148:151], v[196:199]
 v_mfma_f32_16x16x32_bf16 v[196:199], v[64:67], a[132:135], v[196:199]
 v_mfma_f32_16x16x32_bf16 v[200:203], v[64:67], a[136:139], v[200:203]
 ds_read_b64_tr_b16 v[88:89], v59
 buffer_load_dwordx4 v42, s[12:15], s77 offen offset:2048  lds
 v_mfma_f32_16x16x32_bf16 v[200:203], v[68:71], a[152:155], v[200:203]
 ds_read_b64_tr_b16 v[90:91], v59 offset:4096
 v_mfma_f32_16x16x32_bf16 v[204:207], v[68:71], a[156:159], v[204:207]
 v_mfma_f32_16x16x32_bf16 v[204:207], v[64:67], a[140:143], v[204:207]
 s_waitcnt lgkmcnt(6)
 v_mfma_f32_16x16x32_bf16 v[220:223], v[72:75], a[140:143], v[220:223]
 ds_read_b64_tr_b16 v[92:93], v59 offset:8192
 buffer_load_dwordx4 a[228:231], v49, s[16:19], s78 offen offset:2048 sc1
 v_mfma_f32_16x16x32_bf16 v[220:223], v[76:79], a[156:159], v[220:223]
 ds_read_b64_tr_b16 v[94:95], v59 offset:12288
 v_mfma_f32_16x16x32_bf16 v[216:219], v[76:79], a[152:155], v[216:219]
 v_mfma_f32_16x16x32_bf16 v[216:219], v[72:75], a[136:139], v[216:219]
 v_mfma_f32_16x16x32_bf16 v[212:215], v[72:75], a[132:135], v[212:215]
 ds_read_b64_tr_b16 v[64:65], v52 offset:16384
 v_mfma_f32_16x16x32_bf16 v[212:215], v[76:79], a[148:151], v[212:215]
 ds_read_b64_tr_b16 v[66:67], v52 offset:20480
 v_mfma_f32_16x16x32_bf16 v[208:211], v[76:79], a[144:147], v[208:211]
 v_mfma_f32_16x16x32_bf16 v[208:211], v[72:75], a[128:131], v[208:211]
 s_waitcnt lgkmcnt(6)
 v_mfma_f32_16x16x32_bf16 v[224:227], v[80:83], a[128:131], v[224:227]
 ds_read_b64_tr_b16 v[68:69], v52 offset:24576
 buffer_load_dwordx4 a[232:235], v50, s[16:19], s78 offen offset:2048 sc1
 v_mfma_f32_16x16x32_bf16 v[224:227], v[84:87], a[144:147], v[224:227]
 ds_read_b64_tr_b16 v[70:71], v52 offset:28672
 v_mfma_f32_16x16x32_bf16 v[228:231], v[84:87], a[148:151], v[228:231]
 v_mfma_f32_16x16x32_bf16 v[228:231], v[80:83], a[132:135], v[228:231]
 v_mfma_f32_16x16x32_bf16 v[232:235], v[80:83], a[136:139], v[232:235]
 ds_read_b64_tr_b16 v[72:73], v53 offset:16384
 buffer_load_dwordx4 v43, s[12:15], s77 offen offset:3072  lds
 v_mfma_f32_16x16x32_bf16 v[232:235], v[84:87], a[152:155], v[232:235]
 ds_read_b64_tr_b16 v[74:75], v53 offset:20480
 v_mfma_f32_16x16x32_bf16 v[236:239], v[84:87], a[156:159], v[236:239]
 v_mfma_f32_16x16x32_bf16 v[236:239], v[80:83], a[140:143], v[236:239]
 s_waitcnt lgkmcnt(6)
 v_mfma_f32_16x16x32_bf16 v[252:255], v[88:91], a[140:143], v[252:255]
 ds_read_b64_tr_b16 v[76:77], v53 offset:24576
 buffer_load_dwordx4 a[236:239], v51, s[16:19], s78 offen offset:2048 sc1
 v_mfma_f32_16x16x32_bf16 v[252:255], v[92:95], a[156:159], v[252:255]
 ds_read_b64_tr_b16 v[78:79], v53 offset:28672
 v_mfma_f32_16x16x32_bf16 v[248:251], v[92:95], a[152:155], v[248:251]
 v_mfma_f32_16x16x32_bf16 v[248:251], v[88:91], a[136:139], v[248:251]
 v_mfma_f32_16x16x32_bf16 v[244:247], v[88:91], a[132:135], v[244:247]
 ds_read_b64_tr_b16 v[80:81], v54 offset:16384
 v_mfma_f32_16x16x32_bf16 v[244:247], v[92:95], a[148:151], v[244:247]
 ds_read_b64_tr_b16 v[82:83], v54 offset:20480
 v_mfma_f32_16x16x32_bf16 v[240:243], v[92:95], a[144:147], v[240:243]
 v_mfma_f32_16x16x32_bf16 v[240:243], v[88:91], a[128:131], v[240:243]
 s_waitcnt lgkmcnt(6)
 s_waitcnt vmcnt(29)
 v_mfma_f32_16x16x32_bf16 v[128:131], v[64:67], a[160:163], v[128:131]
 ds_read_b64_tr_b16 v[84:85], v54 offset:24576
 buffer_load_dwordx4 a[240:243], v48, s[16:19], s78 offen offset:3072 sc1
 s_waitcnt vmcnt(24)
 v_mfma_f32_16x16x32_bf16 v[128:131], v[68:71], a[176:179], v[128:131]
 ds_read_b64_tr_b16 v[86:87], v54 offset:28672
 s_waitcnt vmcnt(22)
 v_mfma_f32_16x16x32_bf16 v[132:135], v[68:71], a[180:183], v[132:135]
 v_mfma_f32_16x16x32_bf16 v[132:135], v[64:67], a[164:167], v[132:135]
 v_mfma_f32_16x16x32_bf16 v[136:139], v[64:67], a[168:171], v[136:139]
 ds_read_b64_tr_b16 v[88:89], v55 offset:16384
 s_add_u32 m0, s79, 69632
 s_waitcnt vmcnt(21)
 v_mfma_f32_16x16x32_bf16 v[136:139], v[68:71], a[184:187], v[136:139]
 ds_read_b64_tr_b16 v[90:91], v55 offset:20480
 s_waitcnt vmcnt(19)
 v_mfma_f32_16x16x32_bf16 v[140:143], v[68:71], a[188:191], v[140:143]
 buffer_load_dwordx4 v44, s[12:15], s77 offen  lds
 v_mfma_f32_16x16x32_bf16 v[140:143], v[64:67], a[172:175], v[140:143]
 s_waitcnt lgkmcnt(6)
 v_mfma_f32_16x16x32_bf16 v[156:159], v[72:75], a[172:175], v[156:159]
 ds_read_b64_tr_b16 v[92:93], v55 offset:24576
 buffer_load_dwordx4 a[244:247], v49, s[16:19], s78 offen offset:3072 sc1
 v_mfma_f32_16x16x32_bf16 v[156:159], v[76:79], a[188:191], v[156:159]
 ds_read_b64_tr_b16 v[94:95], v55 offset:28672
 v_mfma_f32_16x16x32_bf16 v[152:155], v[76:79], a[184:187], v[152:155]
 v_mfma_f32_16x16x32_bf16 v[152:155], v[72:75], a[168:171], v[152:155]
 v_mfma_f32_16x16x32_bf16 v[148:151], v[72:75], a[164:167], v[148:151]
 ds_read_b64_tr_b16 v[64:65], v56 offset:16384
 v_mfma_f32_16x16x32_bf16 v[148:151], v[76:79], a[180:183], v[148:151]
 ds_read_b64_tr_b16 v[66:67], v56 offset:20480
 v_mfma_f32_16x16x32_bf16 v[144:147], v[76:79], a[176:179], v[144:147]
 v_mfma_f32_16x16x32_bf16 v[144:147], v[72:75], a[160:163], v[144:147]
 s_waitcnt lgkmcnt(6)
 v_mfma_f32_16x16x32_bf16 v[160:163], v[80:83], a[160:163], v[160:163]
 ds_read_b64_tr_b16 v[68:69], v56 offset:24576
 buffer_load_dwordx4 a[248:251], v50, s[16:19], s78 offen offset:3072 sc1
 v_mfma_f32_16x16x32_bf16 v[160:163], v[84:87], a[176:179], v[160:163]
 ds_read_b64_tr_b16 v[70:71], v56 offset:28672
 v_mfma_f32_16x16x32_bf16 v[164:167], v[84:87], a[180:183], v[164:167]
 v_mfma_f32_16x16x32_bf16 v[164:167], v[80:83], a[164:167], v[164:167]
 v_mfma_f32_16x16x32_bf16 v[168:171], v[80:83], a[168:171], v[168:171]
 ds_read_b64_tr_b16 v[72:73], v57 offset:16384
 buffer_load_dwordx4 v45, s[12:15], s77 offen offset:1024  lds
 v_mfma_f32_16x16x32_bf16 v[168:171], v[84:87], a[184:187], v[168:171]
 ds_read_b64_tr_b16 v[74:75], v57 offset:20480
 v_mfma_f32_16x16x32_bf16 v[172:175], v[84:87], a[188:191], v[172:175]
 v_mfma_f32_16x16x32_bf16 v[172:175], v[80:83], a[172:175], v[172:175]
 s_waitcnt lgkmcnt(6)
 v_mfma_f32_16x16x32_bf16 v[188:191], v[88:91], a[172:175], v[188:191]
 ds_read_b64_tr_b16 v[76:77], v57 offset:24576
 buffer_load_dwordx4 a[252:255], v51, s[16:19], s78 offen offset:3072 sc1
 v_mfma_f32_16x16x32_bf16 v[188:191], v[92:95], a[188:191], v[188:191]
 ds_read_b64_tr_b16 v[78:79], v57 offset:28672
 s_add_u32 s78, s78, 4096
 v_mfma_f32_16x16x32_bf16 v[184:187], v[92:95], a[184:187], v[184:187]
 v_mfma_f32_16x16x32_bf16 v[184:187], v[88:91], a[168:171], v[184:187]
 v_mfma_f32_16x16x32_bf16 v[180:183], v[88:91], a[164:167], v[180:183]
 ds_read_b64_tr_b16 v[80:81], v58 offset:16384
 v_mfma_f32_16x16x32_bf16 v[180:183], v[92:95], a[180:183], v[180:183]
 ds_read_b64_tr_b16 v[82:83], v58 offset:20480
 v_mfma_f32_16x16x32_bf16 v[176:179], v[92:95], a[176:179], v[176:179]
 v_mfma_f32_16x16x32_bf16 v[176:179], v[88:91], a[160:163], v[176:179]
 s_waitcnt lgkmcnt(6)
 v_mfma_f32_16x16x32_bf16 v[192:195], v[64:67], a[160:163], v[192:195]
 ds_read_b64_tr_b16 v[84:85], v58 offset:24576
 buffer_load_dwordx4 a[128:131], v48, s[16:19], s78 offen sc1
 v_mfma_f32_16x16x32_bf16 v[192:195], v[68:71], a[176:179], v[192:195]
 ds_read_b64_tr_b16 v[86:87], v58 offset:28672
 v_mfma_f32_16x16x32_bf16 v[196:199], v[68:71], a[180:183], v[196:199]
 v_mfma_f32_16x16x32_bf16 v[196:199], v[64:67], a[164:167], v[196:199]
 v_mfma_f32_16x16x32_bf16 v[200:203], v[64:67], a[168:171], v[200:203]
 ds_read_b64_tr_b16 v[88:89], v59 offset:16384
 buffer_load_dwordx4 v46, s[12:15], s77 offen offset:2048  lds
 v_mfma_f32_16x16x32_bf16 v[200:203], v[68:71], a[184:187], v[200:203]
 ds_read_b64_tr_b16 v[90:91], v59 offset:20480
 v_mfma_f32_16x16x32_bf16 v[204:207], v[68:71], a[188:191], v[204:207]
 v_mfma_f32_16x16x32_bf16 v[204:207], v[64:67], a[172:175], v[204:207]
 s_waitcnt lgkmcnt(6)
 v_mfma_f32_16x16x32_bf16 v[220:223], v[72:75], a[172:175], v[220:223]
 ds_read_b64_tr_b16 v[92:93], v59 offset:24576
 buffer_load_dwordx4 a[132:135], v49, s[16:19], s78 offen sc1
 v_mfma_f32_16x16x32_bf16 v[220:223], v[76:79], a[188:191], v[220:223]
 ds_read_b64_tr_b16 v[94:95], v59 offset:28672
 v_mfma_f32_16x16x32_bf16 v[216:219], v[76:79], a[184:187], v[216:219]
 v_mfma_f32_16x16x32_bf16 v[216:219], v[72:75], a[168:171], v[216:219]
 s_waitcnt vmcnt(22)
 s_barrier
 v_mfma_f32_16x16x32_bf16 v[212:215], v[72:75], a[164:167], v[212:215]
 ds_read_b64_tr_b16 v[64:65], v52 offset:32768
 v_mfma_f32_16x16x32_bf16 v[212:215], v[76:79], a[180:183], v[212:215]
 ds_read_b64_tr_b16 v[66:67], v52 offset:36864
 v_mfma_f32_16x16x32_bf16 v[208:211], v[76:79], a[176:179], v[208:211]
 v_mfma_f32_16x16x32_bf16 v[208:211], v[72:75], a[160:163], v[208:211]
 s_waitcnt lgkmcnt(6)
 v_mfma_f32_16x16x32_bf16 v[224:227], v[80:83], a[160:163], v[224:227]
 ds_read_b64_tr_b16 v[68:69], v52 offset:40960
 buffer_load_dwordx4 a[136:139], v50, s[16:19], s78 offen sc1
 v_mfma_f32_16x16x32_bf16 v[224:227], v[84:87], a[176:179], v[224:227]
 ds_read_b64_tr_b16 v[70:71], v52 offset:45056
 v_mfma_f32_16x16x32_bf16 v[228:231], v[84:87], a[180:183], v[228:231]
 v_mfma_f32_16x16x32_bf16 v[228:231], v[80:83], a[164:167], v[228:231]
 v_mfma_f32_16x16x32_bf16 v[232:235], v[80:83], a[168:171], v[232:235]
 ds_read_b64_tr_b16 v[72:73], v53 offset:32768
 buffer_load_dwordx4 v47, s[12:15], s77 offen offset:3072  lds
 v_mfma_f32_16x16x32_bf16 v[232:235], v[84:87], a[184:187], v[232:235]
 ds_read_b64_tr_b16 v[74:75], v53 offset:36864
 s_add_u32 s77, s77, 262144
 v_mfma_f32_16x16x32_bf16 v[236:239], v[84:87], a[188:191], v[236:239]
 v_mfma_f32_16x16x32_bf16 v[236:239], v[80:83], a[172:175], v[236:239]
 s_waitcnt lgkmcnt(6)
 v_mfma_f32_16x16x32_bf16 v[252:255], v[88:91], a[172:175], v[252:255]
 ds_read_b64_tr_b16 v[76:77], v53 offset:40960
 buffer_load_dwordx4 a[140:143], v51, s[16:19], s78 offen sc1
 v_mfma_f32_16x16x32_bf16 v[252:255], v[92:95], a[188:191], v[252:255]
 ds_read_b64_tr_b16 v[78:79], v53 offset:45056
 v_mfma_f32_16x16x32_bf16 v[248:251], v[92:95], a[184:187], v[248:251]
 v_mfma_f32_16x16x32_bf16 v[248:251], v[88:91], a[168:171], v[248:251]
 v_mfma_f32_16x16x32_bf16 v[244:247], v[88:91], a[164:167], v[244:247]
 ds_read_b64_tr_b16 v[80:81], v54 offset:32768
 v_mfma_f32_16x16x32_bf16 v[244:247], v[92:95], a[180:183], v[244:247]
 ds_read_b64_tr_b16 v[82:83], v54 offset:36864
 v_mfma_f32_16x16x32_bf16 v[240:243], v[92:95], a[176:179], v[240:243]
 v_mfma_f32_16x16x32_bf16 v[240:243], v[88:91], a[160:163], v[240:243]
 s_waitcnt lgkmcnt(6)
 v_mfma_f32_16x16x32_bf16 v[128:131], v[64:67], a[192:195], v[128:131]
 ds_read_b64_tr_b16 v[84:85], v54 offset:40960
 buffer_load_dwordx4 a[144:147], v48, s[16:19], s78 offen offset:1024 sc1
 s_waitcnt vmcnt(24)
 v_mfma_f32_16x16x32_bf16 v[128:131], v[68:71], a[208:211], v[128:131]
 ds_read_b64_tr_b16 v[86:87], v54 offset:45056
 s_waitcnt vmcnt(22)
 v_mfma_f32_16x16x32_bf16 v[132:135], v[68:71], a[212:215], v[132:135]
 v_mfma_f32_16x16x32_bf16 v[132:135], v[64:67], a[196:199], v[132:135]
 v_mfma_f32_16x16x32_bf16 v[136:139], v[64:67], a[200:203], v[136:139]
 ds_read_b64_tr_b16 v[88:89], v55 offset:32768
 s_add_u32 m0, s79, 98304
 s_waitcnt vmcnt(21)
 v_mfma_f32_16x16x32_bf16 v[136:139], v[68:71], a[216:219], v[136:139]
 ds_read_b64_tr_b16 v[90:91], v55 offset:36864
 s_waitcnt vmcnt(19)
 v_mfma_f32_16x16x32_bf16 v[140:143], v[68:71], a[220:223], v[140:143]
 buffer_load_dwordx4 v40, s[8:11], s75 offen  lds
 v_mfma_f32_16x16x32_bf16 v[140:143], v[64:67], a[204:207], v[140:143]
 s_waitcnt lgkmcnt(6)
 v_mfma_f32_16x16x32_bf16 v[156:159], v[72:75], a[204:207], v[156:159]
 ds_read_b64_tr_b16 v[92:93], v55 offset:40960
 buffer_load_dwordx4 a[148:151], v49, s[16:19], s78 offen offset:1024 sc1
 v_mfma_f32_16x16x32_bf16 v[156:159], v[76:79], a[220:223], v[156:159]
 ds_read_b64_tr_b16 v[94:95], v55 offset:45056
 v_mfma_f32_16x16x32_bf16 v[152:155], v[76:79], a[216:219], v[152:155]
 v_mfma_f32_16x16x32_bf16 v[152:155], v[72:75], a[200:203], v[152:155]
 v_mfma_f32_16x16x32_bf16 v[148:151], v[72:75], a[196:199], v[148:151]
 ds_read_b64_tr_b16 v[64:65], v56 offset:32768
 v_mfma_f32_16x16x32_bf16 v[148:151], v[76:79], a[212:215], v[148:151]
 ds_read_b64_tr_b16 v[66:67], v56 offset:36864
 v_mfma_f32_16x16x32_bf16 v[144:147], v[76:79], a[208:211], v[144:147]
 v_mfma_f32_16x16x32_bf16 v[144:147], v[72:75], a[192:195], v[144:147]
 s_waitcnt lgkmcnt(6)
 v_mfma_f32_16x16x32_bf16 v[160:163], v[80:83], a[192:195], v[160:163]
 ds_read_b64_tr_b16 v[68:69], v56 offset:40960
 buffer_load_dwordx4 a[152:155], v50, s[16:19], s78 offen offset:1024 sc1
 v_mfma_f32_16x16x32_bf16 v[160:163], v[84:87], a[208:211], v[160:163]
 ds_read_b64_tr_b16 v[70:71], v56 offset:45056
 v_mfma_f32_16x16x32_bf16 v[164:167], v[84:87], a[212:215], v[164:167]
 v_mfma_f32_16x16x32_bf16 v[164:167], v[80:83], a[196:199], v[164:167]
 v_mfma_f32_16x16x32_bf16 v[168:171], v[80:83], a[200:203], v[168:171]
 ds_read_b64_tr_b16 v[72:73], v57 offset:32768
 buffer_load_dwordx4 v41, s[8:11], s75 offen offset:1024  lds
 v_mfma_f32_16x16x32_bf16 v[168:171], v[84:87], a[216:219], v[168:171]
 ds_read_b64_tr_b16 v[74:75], v57 offset:36864
 v_mfma_f32_16x16x32_bf16 v[172:175], v[84:87], a[220:223], v[172:175]
 v_mfma_f32_16x16x32_bf16 v[172:175], v[80:83], a[204:207], v[172:175]
 s_waitcnt lgkmcnt(6)
 v_mfma_f32_16x16x32_bf16 v[188:191], v[88:91], a[204:207], v[188:191]
 ds_read_b64_tr_b16 v[76:77], v57 offset:40960
 buffer_load_dwordx4 a[156:159], v51, s[16:19], s78 offen offset:1024 sc1
 v_mfma_f32_16x16x32_bf16 v[188:191], v[92:95], a[220:223], v[188:191]
 ds_read_b64_tr_b16 v[78:79], v57 offset:45056
 v_mfma_f32_16x16x32_bf16 v[184:187], v[92:95], a[216:219], v[184:187]
 v_mfma_f32_16x16x32_bf16 v[184:187], v[88:91], a[200:203], v[184:187]
 v_mfma_f32_16x16x32_bf16 v[180:183], v[88:91], a[196:199], v[180:183]
 ds_read_b64_tr_b16 v[80:81], v58 offset:32768
 v_mfma_f32_16x16x32_bf16 v[180:183], v[92:95], a[212:215], v[180:183]
 ds_read_b64_tr_b16 v[82:83], v58 offset:36864
 v_mfma_f32_16x16x32_bf16 v[176:179], v[92:95], a[208:211], v[176:179]
 v_mfma_f32_16x16x32_bf16 v[176:179], v[88:91], a[192:195], v[176:179]
 s_waitcnt lgkmcnt(6)
 v_mfma_f32_16x16x32_bf16 v[192:195], v[64:67], a[192:195], v[192:195]
 ds_read_b64_tr_b16 v[84:85], v58 offset:40960
 buffer_load_dwordx4 a[160:163], v48, s[16:19], s78 offen offset:2048 sc1
 buffer_load_dwordx2 v[62:63], v60, s[56:59], 0 offen sc1
 v_mfma_f32_16x16x32_bf16 v[192:195], v[68:71], a[208:211], v[192:195]
 ds_read_b64_tr_b16 v[86:87], v58 offset:45056
 v_mfma_f32_16x16x32_bf16 v[196:199], v[68:71], a[212:215], v[196:199]
 v_mfma_f32_16x16x32_bf16 v[196:199], v[64:67], a[196:199], v[196:199]
 v_mfma_f32_16x16x32_bf16 v[200:203], v[64:67], a[200:203], v[200:203]
 ds_read_b64_tr_b16 v[88:89], v59 offset:32768
 buffer_load_dwordx4 v42, s[8:11], s75 offen offset:2048  lds
 v_mfma_f32_16x16x32_bf16 v[200:203], v[68:71], a[216:219], v[200:203]
 ds_read_b64_tr_b16 v[90:91], v59 offset:36864
 v_mfma_f32_16x16x32_bf16 v[204:207], v[68:71], a[220:223], v[204:207]
 v_mfma_f32_16x16x32_bf16 v[204:207], v[64:67], a[204:207], v[204:207]
 s_waitcnt lgkmcnt(6)
 v_mfma_f32_16x16x32_bf16 v[220:223], v[72:75], a[204:207], v[220:223]
 ds_read_b64_tr_b16 v[92:93], v59 offset:40960
 buffer_load_dwordx4 a[164:167], v49, s[16:19], s78 offen offset:2048 sc1
 v_mfma_f32_16x16x32_bf16 v[220:223], v[76:79], a[220:223], v[220:223]
 ds_read_b64_tr_b16 v[94:95], v59 offset:45056
 v_mfma_f32_16x16x32_bf16 v[216:219], v[76:79], a[216:219], v[216:219]
 v_mfma_f32_16x16x32_bf16 v[216:219], v[72:75], a[200:203], v[216:219]
 v_mfma_f32_16x16x32_bf16 v[212:215], v[72:75], a[196:199], v[212:215]
 ds_read_b64_tr_b16 v[64:65], v52 offset:49152
 v_mfma_f32_16x16x32_bf16 v[212:215], v[76:79], a[212:215], v[212:215]
 ds_read_b64_tr_b16 v[66:67], v52 offset:53248
 v_mfma_f32_16x16x32_bf16 v[208:211], v[76:79], a[208:211], v[208:211]
 v_mfma_f32_16x16x32_bf16 v[208:211], v[72:75], a[192:195], v[208:211]
 s_waitcnt lgkmcnt(6)
 v_mfma_f32_16x16x32_bf16 v[224:227], v[80:83], a[192:195], v[224:227]
 ds_read_b64_tr_b16 v[68:69], v52 offset:57344
 buffer_load_dwordx4 a[168:171], v50, s[16:19], s78 offen offset:2048 sc1
 v_mfma_f32_16x16x32_bf16 v[224:227], v[84:87], a[208:211], v[224:227]
 ds_read_b64_tr_b16 v[70:71], v52 offset:61440
 v_mfma_f32_16x16x32_bf16 v[228:231], v[84:87], a[212:215], v[228:231]
 v_xor_b32 v52, s49, v52
 v_mfma_f32_16x16x32_bf16 v[228:231], v[80:83], a[196:199], v[228:231]
 v_mfma_f32_16x16x32_bf16 v[232:235], v[80:83], a[200:203], v[232:235]
 ds_read_b64_tr_b16 v[72:73], v53 offset:49152
 buffer_load_dwordx4 v43, s[8:11], s75 offen offset:3072  lds
 v_mfma_f32_16x16x32_bf16 v[232:235], v[84:87], a[216:219], v[232:235]
 ds_read_b64_tr_b16 v[74:75], v53 offset:53248
 v_mfma_f32_16x16x32_bf16 v[236:239], v[84:87], a[220:223], v[236:239]
 v_mfma_f32_16x16x32_bf16 v[236:239], v[80:83], a[204:207], v[236:239]
 s_waitcnt lgkmcnt(6)
 v_mfma_f32_16x16x32_bf16 v[252:255], v[88:91], a[204:207], v[252:255]
 ds_read_b64_tr_b16 v[76:77], v53 offset:57344
 buffer_load_dwordx4 a[172:175], v51, s[16:19], s78 offen offset:2048 sc1
 v_mfma_f32_16x16x32_bf16 v[252:255], v[92:95], a[220:223], v[252:255]
 ds_read_b64_tr_b16 v[78:79], v53 offset:61440
 v_mfma_f32_16x16x32_bf16 v[248:251], v[92:95], a[216:219], v[248:251]
 v_xor_b32 v53, s49, v53
 v_mfma_f32_16x16x32_bf16 v[248:251], v[88:91], a[200:203], v[248:251]
 v_mfma_f32_16x16x32_bf16 v[244:247], v[88:91], a[196:199], v[244:247]
 ds_read_b64_tr_b16 v[80:81], v54 offset:49152
 v_mfma_f32_16x16x32_bf16 v[244:247], v[92:95], a[212:215], v[244:247]
 ds_read_b64_tr_b16 v[82:83], v54 offset:53248
 v_mfma_f32_16x16x32_bf16 v[240:243], v[92:95], a[208:211], v[240:243]
 v_mfma_f32_16x16x32_bf16 v[240:243], v[88:91], a[192:195], v[240:243]
 s_waitcnt lgkmcnt(6)
 s_waitcnt vmcnt(30)
 v_mfma_f32_16x16x32_bf16 v[128:131], v[64:67], a[224:227], v[128:131]
 ds_read_b64_tr_b16 v[84:85], v54 offset:57344
 buffer_load_dwordx4 a[176:179], v48, s[16:19], s78 offen offset:3072 sc1
 s_waitcnt vmcnt(25)
 v_mfma_f32_16x16x32_bf16 v[128:131], v[68:71], a[240:243], v[128:131]
 ds_read_b64_tr_b16 v[86:87], v54 offset:61440
 s_waitcnt vmcnt(23)
 v_mfma_f32_16x16x32_bf16 v[132:135], v[68:71], a[244:247], v[132:135]
 v_xor_b32 v54, s49, v54
 v_mfma_f32_16x16x32_bf16 v[132:135], v[64:67], a[228:231], v[132:135]
 v_mfma_f32_16x16x32_bf16 v[136:139], v[64:67], a[232:235], v[136:139]
 ds_read_b64_tr_b16 v[88:89], v55 offset:49152
 s_add_u32 m0, s79, 102400
 s_waitcnt vmcnt(22)
 v_mfma_f32_16x16x32_bf16 v[136:139], v[68:71], a[248:251], v[136:139]
 ds_read_b64_tr_b16 v[90:91], v55 offset:53248
 s_waitcnt vmcnt(20)
 v_mfma_f32_16x16x32_bf16 v[140:143], v[68:71], a[252:255], v[140:143]
 buffer_load_dwordx4 v44, s[8:11], s75 offen  lds
 v_mfma_f32_16x16x32_bf16 v[140:143], v[64:67], a[236:239], v[140:143]
 s_waitcnt lgkmcnt(6)
 v_mfma_f32_16x16x32_bf16 v[156:159], v[72:75], a[236:239], v[156:159]
 ds_read_b64_tr_b16 v[92:93], v55 offset:57344
 buffer_load_dwordx4 a[180:183], v49, s[16:19], s78 offen offset:3072 sc1
 v_mfma_f32_16x16x32_bf16 v[156:159], v[76:79], a[252:255], v[156:159]
 ds_read_b64_tr_b16 v[94:95], v55 offset:61440
 v_mfma_f32_16x16x32_bf16 v[152:155], v[76:79], a[248:251], v[152:155]
 v_xor_b32 v55, s49, v55
 v_mfma_f32_16x16x32_bf16 v[152:155], v[72:75], a[232:235], v[152:155]
 v_mfma_f32_16x16x32_bf16 v[148:151], v[72:75], a[228:231], v[148:151]
 ds_read_b64_tr_b16 v[64:65], v56 offset:49152
 v_mfma_f32_16x16x32_bf16 v[148:151], v[76:79], a[244:247], v[148:151]
 ds_read_b64_tr_b16 v[66:67], v56 offset:53248
 v_mfma_f32_16x16x32_bf16 v[144:147], v[76:79], a[240:243], v[144:147]
 v_mfma_f32_16x16x32_bf16 v[144:147], v[72:75], a[224:227], v[144:147]
 s_waitcnt lgkmcnt(6)
 v_mfma_f32_16x16x32_bf16 v[160:163], v[80:83], a[224:227], v[160:163]
 ds_read_b64_tr_b16 v[68:69], v56 offset:57344
 buffer_load_dwordx4 a[184:187], v50, s[16:19], s78 offen offset:3072 sc1
 v_mfma_f32_16x16x32_bf16 v[160:163], v[84:87], a[240:243], v[160:163]
 ds_read_b64_tr_b16 v[70:71], v56 offset:61440
 v_mfma_f32_16x16x32_bf16 v[164:167], v[84:87], a[244:247], v[164:167]
 v_xor_b32 v56, s49, v56
 v_mfma_f32_16x16x32_bf16 v[164:167], v[80:83], a[228:231], v[164:167]
 v_mfma_f32_16x16x32_bf16 v[168:171], v[80:83], a[232:235], v[168:171]
 ds_read_b64_tr_b16 v[72:73], v57 offset:49152
 buffer_load_dwordx4 v45, s[8:11], s75 offen offset:1024  lds
 v_mfma_f32_16x16x32_bf16 v[168:171], v[84:87], a[248:251], v[168:171]
 ds_read_b64_tr_b16 v[74:75], v57 offset:53248
 v_mfma_f32_16x16x32_bf16 v[172:175], v[84:87], a[252:255], v[172:175]
 v_mfma_f32_16x16x32_bf16 v[172:175], v[80:83], a[236:239], v[172:175]
 s_waitcnt lgkmcnt(6)
 v_mfma_f32_16x16x32_bf16 v[188:191], v[88:91], a[236:239], v[188:191]
 ds_read_b64_tr_b16 v[76:77], v57 offset:57344
 buffer_load_dwordx4 a[188:191], v51, s[16:19], s78 offen offset:3072 sc1
 v_mfma_f32_16x16x32_bf16 v[188:191], v[92:95], a[252:255], v[188:191]
 ds_read_b64_tr_b16 v[78:79], v57 offset:61440
 s_add_u32 s78, s78, 4096
 v_mfma_f32_16x16x32_bf16 v[184:187], v[92:95], a[248:251], v[184:187]
 v_xor_b32 v57, s49, v57
 v_mfma_f32_16x16x32_bf16 v[184:187], v[88:91], a[232:235], v[184:187]
 v_mfma_f32_16x16x32_bf16 v[180:183], v[88:91], a[228:231], v[180:183]
 ds_read_b64_tr_b16 v[80:81], v58 offset:49152
 v_mfma_f32_16x16x32_bf16 v[180:183], v[92:95], a[244:247], v[180:183]
 ds_read_b64_tr_b16 v[82:83], v58 offset:53248
 v_mfma_f32_16x16x32_bf16 v[176:179], v[92:95], a[240:243], v[176:179]
 v_mfma_f32_16x16x32_bf16 v[176:179], v[88:91], a[224:227], v[176:179]
 s_waitcnt lgkmcnt(6)
 v_mfma_f32_16x16x32_bf16 v[192:195], v[64:67], a[224:227], v[192:195]
 ds_read_b64_tr_b16 v[84:85], v58 offset:57344
 v_mfma_f32_16x16x32_bf16 v[192:195], v[68:71], a[240:243], v[192:195]
 ds_read_b64_tr_b16 v[86:87], v58 offset:61440
 v_mfma_f32_16x16x32_bf16 v[196:199], v[68:71], a[244:247], v[196:199]
 v_xor_b32 v58, s49, v58
 v_mfma_f32_16x16x32_bf16 v[196:199], v[64:67], a[228:231], v[196:199]
 v_mfma_f32_16x16x32_bf16 v[200:203], v[64:67], a[232:235], v[200:203]
 ds_read_b64_tr_b16 v[88:89], v59 offset:49152
 buffer_load_dwordx4 v46, s[8:11], s75 offen offset:2048  lds
 v_mfma_f32_16x16x32_bf16 v[200:203], v[68:71], a[248:251], v[200:203]
 ds_read_b64_tr_b16 v[90:91], v59 offset:53248
 v_mfma_f32_16x16x32_bf16 v[204:207], v[68:71], a[252:255], v[204:207]
 v_mfma_f32_16x16x32_bf16 v[204:207], v[64:67], a[236:239], v[204:207]
 s_waitcnt lgkmcnt(6)
 v_mfma_f32_16x16x32_bf16 v[220:223], v[72:75], a[236:239], v[220:223]
 ds_read_b64_tr_b16 v[92:93], v59 offset:57344
 v_mfma_f32_16x16x32_bf16 v[220:223], v[76:79], a[252:255], v[220:223]
 ds_read_b64_tr_b16 v[94:95], v59 offset:61440
 v_mfma_f32_16x16x32_bf16 v[216:219], v[76:79], a[248:251], v[216:219]
 v_xor_b32 v59, s49, v59
 v_mfma_f32_16x16x32_bf16 v[216:219], v[72:75], a[232:235], v[216:219]
 s_waitcnt vmcnt(21)
 s_barrier
 v_mfma_f32_16x16x32_bf16 v[212:215], v[72:75], a[228:231], v[212:215]
 ds_read_b64_tr_b16 v[64:65], v52
 v_mfma_f32_16x16x32_bf16 v[212:215], v[76:79], a[244:247], v[212:215]
 ds_read_b64_tr_b16 v[66:67], v52 offset:4096
 v_mfma_f32_16x16x32_bf16 v[208:211], v[76:79], a[240:243], v[208:211]
 v_mfma_f32_16x16x32_bf16 v[208:211], v[72:75], a[224:227], v[208:211]
 s_waitcnt lgkmcnt(6)
 v_mfma_f32_16x16x32_bf16 v[224:227], v[80:83], a[224:227], v[224:227]
 ds_read_b64_tr_b16 v[68:69], v52 offset:8192
 v_mfma_f32_16x16x32_bf16 v[224:227], v[84:87], a[240:243], v[224:227]
 ds_read_b64_tr_b16 v[70:71], v52 offset:12288
 v_mfma_f32_16x16x32_bf16 v[228:231], v[84:87], a[244:247], v[228:231]
 v_mfma_f32_16x16x32_bf16 v[228:231], v[80:83], a[228:231], v[228:231]
 v_mfma_f32_16x16x32_bf16 v[232:235], v[80:83], a[232:235], v[232:235]
 ds_read_b64_tr_b16 v[72:73], v53
 buffer_load_dwordx4 v47, s[8:11], s75 offen offset:3072  lds
 v_mfma_f32_16x16x32_bf16 v[232:235], v[84:87], a[248:251], v[232:235]
 ds_read_b64_tr_b16 v[74:75], v53 offset:4096
 s_add_u32 s75, s75, 262144
 v_mfma_f32_16x16x32_bf16 v[236:239], v[84:87], a[252:255], v[236:239]
 v_mfma_f32_16x16x32_bf16 v[236:239], v[80:83], a[236:239], v[236:239]
 s_waitcnt lgkmcnt(6)
 v_mfma_f32_16x16x32_bf16 v[252:255], v[88:91], a[236:239], v[252:255]
 ds_read_b64_tr_b16 v[76:77], v53 offset:8192
 v_mfma_f32_16x16x32_bf16 v[252:255], v[92:95], a[252:255], v[252:255]
 ds_read_b64_tr_b16 v[78:79], v53 offset:12288
 v_mfma_f32_16x16x32_bf16 v[248:251], v[92:95], a[248:251], v[248:251]
 v_mfma_f32_16x16x32_bf16 v[248:251], v[88:91], a[232:235], v[248:251]
 v_mfma_f32_16x16x32_bf16 v[244:247], v[88:91], a[228:231], v[244:247]
 ds_read_b64_tr_b16 v[80:81], v54
 v_mfma_f32_16x16x32_bf16 v[244:247], v[92:95], a[244:247], v[244:247]
 ds_read_b64_tr_b16 v[82:83], v54 offset:4096
 v_mfma_f32_16x16x32_bf16 v[240:243], v[92:95], a[240:243], v[240:243]
 v_mfma_f32_16x16x32_bf16 v[240:243], v[88:91], a[224:227], v[240:243]
 s_waitcnt lgkmcnt(6)
 v_mfma_f32_16x16x32_bf16 v[128:131], v[64:67], a[128:131], v[128:131]
 ds_read_b64_tr_b16 v[84:85], v54 offset:8192
 s_waitcnt vmcnt(20)
 v_mfma_f32_16x16x32_bf16 v[128:131], v[68:71], a[144:147], v[128:131]
 ds_read_b64_tr_b16 v[86:87], v54 offset:12288
 s_waitcnt vmcnt(18)
 v_mfma_f32_16x16x32_bf16 v[132:135], v[68:71], a[148:151], v[132:135]
 v_mfma_f32_16x16x32_bf16 v[132:135], v[64:67], a[132:135], v[132:135]
 v_mfma_f32_16x16x32_bf16 v[136:139], v[64:67], a[136:139], v[136:139]
 ds_read_b64_tr_b16 v[88:89], v55
 s_add_u32 m0, s79, 0
 s_waitcnt vmcnt(17)
 v_mfma_f32_16x16x32_bf16 v[136:139], v[68:71], a[152:155], v[136:139]
 ds_read_b64_tr_b16 v[90:91], v55 offset:4096
 s_waitcnt vmcnt(15)
 v_mfma_f32_16x16x32_bf16 v[140:143], v[68:71], a[156:159], v[140:143]
 buffer_load_dwordx4 v40, s[8:11], s75 offen  lds
 v_mfma_f32_16x16x32_bf16 v[140:143], v[64:67], a[140:143], v[140:143]
 s_waitcnt lgkmcnt(6)
 v_mfma_f32_16x16x32_bf16 v[156:159], v[72:75], a[140:143], v[156:159]
 ds_read_b64_tr_b16 v[92:93], v55 offset:8192
 v_mfma_f32_16x16x32_bf16 v[156:159], v[76:79], a[156:159], v[156:159]
 ds_read_b64_tr_b16 v[94:95], v55 offset:12288
 v_mfma_f32_16x16x32_bf16 v[152:155], v[76:79], a[152:155], v[152:155]
 v_mfma_f32_16x16x32_bf16 v[152:155], v[72:75], a[136:139], v[152:155]
 v_mfma_f32_16x16x32_bf16 v[148:151], v[72:75], a[132:135], v[148:151]
 ds_read_b64_tr_b16 v[64:65], v56
 v_mfma_f32_16x16x32_bf16 v[148:151], v[76:79], a[148:151], v[148:151]
 ds_read_b64_tr_b16 v[66:67], v56 offset:4096
 v_mfma_f32_16x16x32_bf16 v[144:147], v[76:79], a[144:147], v[144:147]
 v_mfma_f32_16x16x32_bf16 v[144:147], v[72:75], a[128:131], v[144:147]
 s_waitcnt lgkmcnt(6)
 v_mfma_f32_16x16x32_bf16 v[160:163], v[80:83], a[128:131], v[160:163]
 ds_read_b64_tr_b16 v[68:69], v56 offset:8192
 v_mfma_f32_16x16x32_bf16 v[160:163], v[84:87], a[144:147], v[160:163]
 ds_read_b64_tr_b16 v[70:71], v56 offset:12288
 v_mfma_f32_16x16x32_bf16 v[164:167], v[84:87], a[148:151], v[164:167]
 v_mfma_f32_16x16x32_bf16 v[164:167], v[80:83], a[132:135], v[164:167]
 v_mfma_f32_16x16x32_bf16 v[168:171], v[80:83], a[136:139], v[168:171]
 ds_read_b64_tr_b16 v[72:73], v57
 buffer_load_dwordx4 v41, s[8:11], s75 offen offset:1024  lds
 v_mfma_f32_16x16x32_bf16 v[168:171], v[84:87], a[152:155], v[168:171]
 ds_read_b64_tr_b16 v[74:75], v57 offset:4096
 v_mfma_f32_16x16x32_bf16 v[172:175], v[84:87], a[156:159], v[172:175]
 v_mfma_f32_16x16x32_bf16 v[172:175], v[80:83], a[140:143], v[172:175]
 s_waitcnt lgkmcnt(6)
 v_mfma_f32_16x16x32_bf16 v[188:191], v[88:91], a[140:143], v[188:191]
 ds_read_b64_tr_b16 v[76:77], v57 offset:8192
 v_mfma_f32_16x16x32_bf16 v[188:191], v[92:95], a[156:159], v[188:191]
 ds_read_b64_tr_b16 v[78:79], v57 offset:12288
 v_mfma_f32_16x16x32_bf16 v[184:187], v[92:95], a[152:155], v[184:187]
 v_mfma_f32_16x16x32_bf16 v[184:187], v[88:91], a[136:139], v[184:187]
 v_mfma_f32_16x16x32_bf16 v[180:183], v[88:91], a[132:135], v[180:183]
 ds_read_b64_tr_b16 v[80:81], v58
 v_mfma_f32_16x16x32_bf16 v[180:183], v[92:95], a[148:151], v[180:183]
 ds_read_b64_tr_b16 v[82:83], v58 offset:4096
 v_mfma_f32_16x16x32_bf16 v[176:179], v[92:95], a[144:147], v[176:179]
 s_waitcnt vmcnt(15)
 v_cmp_ne_u64 vcc, s[6:7], v[62:63]
 s_nop 0
 s_nop 0
 s_cbranch_vccz L_o_77_ok
L_o_77_spin:
 s_sleep 4
 buffer_load_dwordx2 v[62:63], v60, s[56:59], 0 offen sc1
 s_waitcnt vmcnt(0)
 v_cmp_ne_u64 vcc, s[6:7], v[62:63]
 s_nop 1
 s_cbranch_vccnz L_o_77_spin
L_o_77_ok:
 v_mfma_f32_16x16x32_bf16 v[176:179], v[88:91], a[128:131], v[176:179]
 s_waitcnt lgkmcnt(6)
 v_mfma_f32_16x16x32_bf16 v[192:195], v[64:67], a[128:131], v[192:195]
 ds_read_b64_tr_b16 v[84:85], v58 offset:8192
 buffer_load_dwordx4 a[192:195], v4, s[20:23], s42 offen sc1
 v_mfma_f32_16x16x32_bf16 v[192:195], v[68:71], a[144:147], v[192:195]
 ds_read_b64_tr_b16 v[86:87], v58 offset:12288
 v_mfma_f32_16x16x32_bf16 v[196:199], v[68:71], a[148:151], v[196:199]
 v_mfma_f32_16x16x32_bf16 v[196:199], v[64:67], a[132:135], v[196:199]
 v_mfma_f32_16x16x32_bf16 v[200:203], v[64:67], a[136:139], v[200:203]
 ds_read_b64_tr_b16 v[88:89], v59
 buffer_load_dwordx4 v42, s[8:11], s75 offen offset:2048  lds
 v_mfma_f32_16x16x32_bf16 v[200:203], v[68:71], a[152:155], v[200:203]
 ds_read_b64_tr_b16 v[90:91], v59 offset:4096
 buffer_load_dwordx4 a[196:199], v5, s[20:23], s42 offen sc1
 v_mfma_f32_16x16x32_bf16 v[204:207], v[68:71], a[156:159], v[204:207]
 v_mfma_f32_16x16x32_bf16 v[204:207], v[64:67], a[140:143], v[204:207]
 s_waitcnt lgkmcnt(6)
 v_mfma_f32_16x16x32_bf16 v[220:223], v[72:75], a[140:143], v[220:223]
 ds_read_b64_tr_b16 v[92:93], v59 offset:8192
 v_mfma_f32_16x16x32_bf16 v[220:223], v[76:79], a[156:159], v[220:223]
 ds_read_b64_tr_b16 v[94:95], v59 offset:12288
 v_mfma_f32_16x16x32_bf16 v[216:219], v[76:79], a[152:155], v[216:219]
 buffer_load_dwordx4 a[200:203], v6, s[20:23], s42 offen sc1
 v_mfma_f32_16x16x32_bf16 v[216:219], v[72:75], a[136:139], v[216:219]
 v_mfma_f32_16x16x32_bf16 v[212:215], v[72:75], a[132:135], v[212:215]
 ds_read_b64_tr_b16 v[64:65], v52 offset:16384
 v_mfma_f32_16x16x32_bf16 v[212:215], v[76:79], a[148:151], v[212:215]
 ds_read_b64_tr_b16 v[66:67], v52 offset:20480
 v_mfma_f32_16x16x32_bf16 v[208:211], v[76:79], a[144:147], v[208:211]
 v_mfma_f32_16x16x32_bf16 v[208:211], v[72:75], a[128:131], v[208:211]
 s_waitcnt lgkmcnt(6)
 buffer_load_dwordx4 a[204:207], v7, s[20:23], s42 offen sc1
 v_mfma_f32_16x16x32_bf16 v[224:227], v[80:83], a[128:131], v[224:227]
 ds_read_b64_tr_b16 v[68:69], v52 offset:24576
 v_mfma_f32_16x16x32_bf16 v[224:227], v[84:87], a[144:147], v[224:227]
 ds_read_b64_tr_b16 v[70:71], v52 offset:28672
 v_mfma_f32_16x16x32_bf16 v[228:231], v[84:87], a[148:151], v[228:231]
 v_mfma_f32_16x16x32_bf16 v[228:231], v[80:83], a[132:135], v[228:231]
 v_mfma_f32_16x16x32_bf16 v[232:235], v[80:83], a[136:139], v[232:235]
 ds_read_b64_tr_b16 v[72:73], v53 offset:16384
 buffer_load_dwordx4 v43, s[8:11], s75 offen offset:3072  lds
 v_mfma_f32_16x16x32_bf16 v[232:235], v[84:87], a[152:155], v[232:235]
 ds_read_b64_tr_b16 v[74:75], v53 offset:20480
 buffer_load_dwordx4 a[208:211], v4, s[20:23], s42 offen offset:1024 sc1
 v_mfma_f32_16x16x32_bf16 v[236:239], v[84:87], a[156:159], v[236:239]
 v_mfma_f32_16x16x32_bf16 v[236:239], v[80:83], a[140:143], v[236:239]
 s_waitcnt lgkmcnt(6)
 v_mfma_f32_16x16x32_bf16 v[252:255], v[88:91], a[140:143], v[252:255]
 ds_read_b64_tr_b16 v[76:77], v53 offset:24576
 v_mfma_f32_16x16x32_bf16 v[252:255], v[92:95], a[156:159], v[252:255]
 ds_read_b64_tr_b16 v[78:79], v53 offset:28672
 buffer_load_dwordx4 a[212:215], v5, s[20:23], s42 offen offset:1024 sc1
 v_mfma_f32_16x16x32_bf16 v[248:251], v[92:95], a[152:155], v[248:251]
 v_mfma_f32_16x16x32_bf16 v[248:251], v[88:91], a[136:139], v[248:251]
 v_mfma_f32_16x16x32_bf16 v[244:247], v[88:91], a[132:135], v[244:247]
 ds_read_b64_tr_b16 v[80:81], v54 offset:16384
 v_mfma_f32_16x16x32_bf16 v[244:247], v[92:95], a[148:151], v[244:247]
 ds_read_b64_tr_b16 v[82:83], v54 offset:20480
 v_mfma_f32_16x16x32_bf16 v[240:243], v[92:95], a[144:147], v[240:243]
 buffer_load_dwordx4 a[216:219], v6, s[20:23], s42 offen offset:1024 sc1
 v_mfma_f32_16x16x32_bf16 v[240:243], v[88:91], a[128:131], v[240:243]
 s_waitcnt lgkmcnt(6)
 v_mfma_f32_16x16x32_bf16 v[128:131], v[64:67], a[160:163], v[128:131]
 ds_read_b64_tr_b16 v[84:85], v54 offset:24576
 s_waitcnt vmcnt(18)
 v_mfma_f32_16x16x32_bf16 v[128:131], v[68:71], a[176:179], v[128:131]
 ds_read_b64_tr_b16 v[86:87], v54 offset:28672
 s_waitcnt vmcnt(16)
 v_mfma_f32_16x16x32_bf16 v[132:135], v[68:71], a[180:183], v[132:135]
 v_mfma_f32_16x16x32_bf16 v[132:135], v[64:67], a[164:167], v[132:135]
 buffer_load_dwordx4 a[220:223], v7, s[20:23], s42 offen offset:1024 sc1
 v_mfma_f32_16x16x32_bf16 v[136:139], v[64:67], a[168:171], v[136:139]
 ds_read_b64_tr_b16 v[88:89], v55 offset:16384
 s_add_u32 m0, s79, 4096
 s_waitcnt vmcnt(16)
 v_mfma_f32_16x16x32_bf16 v[136:139], v[68:71], a[184:187], v[136:139]
 ds_read_b64_tr_b16 v[90:91], v55 offset:20480
 s_waitcnt vmcnt(14)
 v_mfma_f32_16x16x32_bf16 v[140:143], v[68:71], a[188:191], v[140:143]
 buffer_load_dwordx4 v44, s[8:11], s75 offen  lds
 v_mfma_f32_16x16x32_bf16 v[140:143], v[64:67], a[172:175], v[140:143]
 s_waitcnt lgkmcnt(6)
 v_mfma_f32_16x16x32_bf16 v[156:159], v[72:75], a[172:175], v[156:159]
 ds_read_b64_tr_b16 v[92:93], v55 offset:24576
 buffer_load_dwordx4 a[224:227], v4, s[20:23], s42 offen offset:2048 sc1
 v_mfma_f32_16x16x32_bf16 v[156:159], v[76:79], a[188:191], v[156:159]
 ds_read_b64_tr_b16 v[94:95], v55 offset:28672
 v_mfma_f32_16x16x32_bf16 v[152:155], v[76:79], a[184:187], v[152:155]
 v_mfma_f32_16x16x32_bf16 v[152:155], v[72:75], a[168:171], v[152:155]
 v_mfma_f32_16x16x32_bf16 v[148:151], v[72:75], a[164:167], v[148:151]
 ds_read_b64_tr_b16 v[64:65], v56 offset:16384
 v_mfma_f32_16x16x32_bf16 v[148:151], v[76:79], a[180:183], v[148:151]
 ds_read_b64_tr_b16 v[66:67], v56 offset:20480
 buffer_load_dwordx4 a[228:231], v5, s[20:23], s42 offen offset:2048 sc1
 v_mfma_f32_16x16x32_bf16 v[144:147], v[76:79], a[176:179], v[144:147]
 v_mfma_f32_16x16x32_bf16 v[144:147], v[72:75], a[160:163], v[144:147]
 s_waitcnt lgkmcnt(6)
 v_mfma_f32_16x16x32_bf16 v[160:163], v[80:83], a[160:163], v[160:163]
 ds_read_b64_tr_b16 v[68:69], v56 offset:24576
 v_mfma_f32_16x16x32_bf16 v[160:163], v[84:87], a[176:179], v[160:163]
 ds_read_b64_tr_b16 v[70:71], v56 offset:28672
 v_mfma_f32_16x16x32_bf16 v[164:167], v[84:87], a[180:183], v[164:167]
 buffer_load_dwordx4 a[232:235], v6, s[20:23], s42 offen offset:2048 sc1
 v_mfma_f32_16x16x32_bf16 v[164:167], v[80:83], a[164:167], v[164:167]
 v_mfma_f32_16x16x32_bf16 v[168:171], v[80:83], a[168:171], v[168:171]
 ds_read_b64_tr_b16 v[72:73], v57 offset:16384
 buffer_load_dwordx4 v45, s[8:11], s75 offen offset:1024  lds
 v_mfma_f32_16x16x32_bf16 v[168:171], v[84:87], a[184:187], v[168:171]
 ds_read_b64_tr_b16 v[74:75], v57 offset:20480
 v_mfma_f32_16x16x32_bf16 v[172:175], v[84:87], a[188:191], v[172:175]
 v_mfma_f32_16x16x32_bf16 v[172:175], v[80:83], a[172:175], v[172:175]
 s_waitcnt lgkmcnt(6)
 buffer_load_dwordx4 a[236:239], v7, s[20:23], s42 offen offset:2048 sc1
 v_mfma_f32_16x16x32_bf16 v[188:191], v[88:91], a[172:175], v[188:191]
 ds_read_b64_tr_b16 v[76:77], v57 offset:24576
 v_mfma_f32_16x16x32_bf16 v[188:191], v[92:95], a[188:191], v[188:191]
 ds_read_b64_tr_b16 v[78:79], v57 offset:28672
 v_mfma_f32_16x16x32_bf16 v[184:187], v[92:95], a[184:187], v[184:187]
 v_mfma_f32_16x16x32_bf16 v[184:187], v[88:91], a[168:171], v[184:187]
 v_mfma_f32_16x16x32_bf16 v[180:183], v[88:91], a[164:167], v[180:183]
 ds_read_b64_tr_b16 v[80:81], v58 offset:16384
 buffer_load_dwordx4 a[240:243], v4, s[20:23], s42 offen offset:3072 sc1
 v_mfma_f32_16x16x32_bf16 v[180:183], v[92:95], a[180:183], v[180:183]
 ds_read_b64_tr_b16 v[82:83], v58 offset:20480
 v_mfma_f32_16x16x32_bf16 v[176:179], v[92:95], a[176:179], v[176:179]
 v_mfma_f32_16x16x32_bf16 v[176:179], v[88:91], a[160:163], v[176:179]
 s_waitcnt lgkmcnt(6)
 v_mfma_f32_16x16x32_bf16 v[192:195], v[64:67], a[160:163], v[192:195]
 ds_read_b64_tr_b16 v[84:85], v58 offset:24576
 v_mfma_f32_16x16x32_bf16 v[192:195], v[68:71], a[176:179], v[192:195]
 ds_read_b64_tr_b16 v[86:87], v58 offset:28672
 buffer_load_dwordx4 a[244:247], v5, s[20:23], s42 offen offset:3072 sc1
 v_mfma_f32_16x16x32_bf16 v[196:199], v[68:71], a[180:183], v[196:199]
 v_mfma_f32_16x16x32_bf16 v[196:199], v[64:67], a[164:167], v[196:199]
 v_mfma_f32_16x16x32_bf16 v[200:203], v[64:67], a[168:171], v[200:203]
 ds_read_b64_tr_b16 v[88:89], v59 offset:16384
 buffer_load_dwordx4 v46, s[8:11], s75 offen offset:2048  lds
 v_mfma_f32_16x16x32_bf16 v[200:203], v[68:71], a[184:187], v[200:203]
 ds_read_b64_tr_b16 v[90:91], v59 offset:20480
 v_mfma_f32_16x16x32_bf16 v[204:207], v[68:71], a[188:191], v[204:207]
 buffer_load_dwordx4 a[248:251], v6, s[20:23], s42 offen offset:3072 sc1
 v_mfma_f32_16x16x32_bf16 v[204:207], v[64:67], a[172:175], v[204:207]
 s_waitcnt lgkmcnt(6)
 v_mfma_f32_16x16x32_bf16 v[220:223], v[72:75], a[172:175], v[220:223]
 ds_read_b64_tr_b16 v[92:93], v59 offset:24576
 v_mfma_f32_16x16x32_bf16 v[220:223], v[76:79], a[188:191], v[220:223]
 ds_read_b64_tr_b16 v[94:95], v59 offset:28672
 v_mfma_f32_16x16x32_bf16 v[216:219], v[76:79], a[184:187], v[216:219]
 v_mfma_f32_16x16x32_bf16 v[216:219], v[72:75], a[168:171], v[216:219]
 s_waitcnt vmcnt(22)
 s_barrier
 v_mfma_f32_16x16x32_bf16 v[212:215], v[72:75], a[164:167], v[212:215]
 ds_read_b64_tr_b16 v[64:65], v52 offset:32768
 buffer_load_dwordx4 a[252:255], v7, s[20:23], s42 offen offset:3072 sc1
 v_mfma_f32_16x16x32_bf16 v[212:215], v[76:79], a[180:183], v[212:215]
 ds_read_b64_tr_b16 v[66:67], v52 offset:36864
 s_add_u32 s42, s42, 4096
 v_mfma_f32_16x16x32_bf16 v[208:211], v[76:79], a[176:179], v[208:211]
 v_mfma_f32_16x16x32_bf16 v[208:211], v[72:75], a[160:163], v[208:211]
 s_waitcnt lgkmcnt(6)
 v_mfma_f32_16x16x32_bf16 v[224:227], v[80:83], a[160:163], v[224:227]
 ds_read_b64_tr_b16 v[68:69], v52 offset:40960
 buffer_load_dwordx4 a[128:131], v4, s[20:23], s42 offen sc1
 v_mfma_f32_16x16x32_bf16 v[224:227], v[84:87], a[176:179], v[224:227]
 ds_read_b64_tr_b16 v[70:71], v52 offset:45056
 v_mfma_f32_16x16x32_bf16 v[228:231], v[84:87], a[180:183], v[228:231]
 v_mfma_f32_16x16x32_bf16 v[228:231], v[80:83], a[164:167], v[228:231]
 v_mfma_f32_16x16x32_bf16 v[232:235], v[80:83], a[168:171], v[232:235]
 ds_read_b64_tr_b16 v[72:73], v53 offset:32768
 buffer_load_dwordx4 v47, s[8:11], s75 offen offset:3072  lds
 v_mfma_f32_16x16x32_bf16 v[232:235], v[84:87], a[184:187], v[232:235]
 ds_read_b64_tr_b16 v[74:75], v53 offset:36864
 s_add_u32 s75, s75, 262144
 v_mfma_f32_16x16x32_bf16 v[236:239], v[84:87], a[188:191], v[236:239]
 buffer_load_dwordx4 a[132:135], v5, s[20:23], s42 offen sc1
 v_mfma_f32_16x16x32_bf16 v[236:239], v[80:83], a[172:175], v[236:239]
 s_waitcnt lgkmcnt(6)
 v_mfma_f32_16x16x32_bf16 v[252:255], v[88:91], a[172:175], v[252:255]
 ds_read_b64_tr_b16 v[76:77], v53 offset:40960
 v_mfma_f32_16x16x32_bf16 v[252:255], v[92:95], a[188:191], v[252:255]
 ds_read_b64_tr_b16 v[78:79], v53 offset:45056
 v_mfma_f32_16x16x32_bf16 v[248:251], v[92:95], a[184:187], v[248:251]
 buffer_load_dwordx4 a[136:139], v6, s[20:23], s42 offen sc1
 v_mfma_f32_16x16x32_bf16 v[248:251], v[88:91], a[168:171], v[248:251]
 v_mfma_f32_16x16x32_bf16 v[244:247], v[88:91], a[164:167], v[244:247]
 ds_read_b64_tr_b16 v[80:81], v54 offset:32768
 v_mfma_f32_16x16x32_bf16 v[244:247], v[92:95], a[180:183], v[244:247]
 ds_read_b64_tr_b16 v[82:83], v54 offset:36864
 v_mfma_f32_16x16x32_bf16 v[240:243], v[92:95], a[176:179], v[240:243]
 v_mfma_f32_16x16x32_bf16 v[240:243], v[88:91], a[160:163], v[240:243]
 s_waitcnt lgkmcnt(6)
 buffer_load_dwordx4 a[140:143], v7, s[20:23], s42 offen sc1
 s_waitcnt vmcnt(25)
 v_mfma_f32_16x16x32_bf16 a[0:3], v[64:67], a[192:195], 0
 ds_read_b64_tr_b16 v[84:85], v54 offset:40960
 s_getpc_b64 s[16:17]
L_pc3_77:
 s_sub_u32 s16, s16, L_pc3_77-K_first
 s_subb_u32 s17, s17, 0
 s_waitcnt vmcnt(19)
 v_mfma_f32_16x16x32_bf16 a[0:3], v[68:71], a[208:211], a[0:3]
 ds_read_b64_tr_b16 v[86:87], v54 offset:45056
 s_mov_b32 s18, K_last-K_first
 s_waitcnt vmcnt(18)
 v_mfma_f32_16x16x32_bf16 a[4:7], v[68:71], a[212:215], 0
 s_mov_b32 s19, 0x20000
 v_mfma_f32_16x16x32_bf16 a[4:7], v[64:67], a[196:199], a[4:7]
 v_mfma_f32_16x16x32_bf16 a[8:11], v[64:67], a[200:203], 0
 ds_read_b64_tr_b16 v[88:89], v55 offset:32768
 s_add_u32 m0, s79, 32768
 s_waitcnt vmcnt(17)
 v_mfma_f32_16x16x32_bf16 a[8:11], v[68:71], a[216:219], a[8:11]
 ds_read_b64_tr_b16 v[90:91], v55 offset:36864
 s_waitcnt vmcnt(16)
 v_mfma_f32_16x16x32_bf16 a[12:15], v[68:71], a[220:223], 0
 buffer_load_dwordx4 v40, s[8:11], s75 offen  lds
 buffer_load_dwordx4 a[144:147], v4, s[20:23], s42 offen offset:1024 sc1
 v_mfma_f32_16x16x32_bf16 a[12:15], v[64:67], a[204:207], a[12:15]
 s_waitcnt lgkmcnt(6)
 v_mfma_f32_16x16x32_bf16 a[28:31], v[72:75], a[204:207], 0
 ds_read_b64_tr_b16 v[92:93], v55 offset:40960
 v_cvt_pk_bf16_f32 v112, v192, v193
 v_mfma_f32_16x16x32_bf16 a[28:31], v[76:79], a[220:223], a[28:31]
 ds_read_b64_tr_b16 v[94:95], v55 offset:45056
 v_cvt_pk_bf16_f32 v113, v194, v195
 v_mfma_f32_16x16x32_bf16 a[24:27], v[76:79], a[216:219], 0
 v_cvt_pk_bf16_f32 v114, v196, v197
 v_mfma_f32_16x16x32_bf16 a[24:27], v[72:75], a[200:203], a[24:27]
 buffer_load_dwordx4 a[148:151], v5, s[20:23], s42 offen offset:1024 sc1
 v_mfma_f32_16x16x32_bf16 a[20:23], v[72:75], a[196:199], 0
 ds_read_b64_tr_b16 v[64:65], v56 offset:32768
 v_cvt_pk_bf16_f32 v115, v198, v199
 v_mfma_f32_16x16x32_bf16 a[20:23], v[76:79], a[212:215], a[20:23]
 ds_read_b64_tr_b16 v[66:67], v56 offset:36864
 v_mfma_f32_16x16x32_bf16 a[16:19], v[76:79], a[208:211], 0
 v_mfma_f32_16x16x32_bf16 a[16:19], v[72:75], a[192:195], a[16:19]
 s_waitcnt lgkmcnt(6)
 v_mfma_f32_16x16x32_bf16 a[32:35], v[80:83], a[192:195], 0
 ds_read_b64_tr_b16 v[68:69], v56 offset:40960
 buffer_store_dwordx4 v[112:115], v26, s[60:63], 0 offen sc1
 v_mfma_f32_16x16x32_bf16 a[32:35], v[84:87], a[208:211], a[32:35]
 ds_read_b64_tr_b16 v[70:71], v56 offset:45056
 v_mfma_f32_16x16x32_bf16 a[36:39], v[84:87], a[212:215], 0
 buffer_load_dwordx4 a[152:155], v6, s[20:23], s42 offen offset:1024 sc1
 v_mfma_f32_16x16x32_bf16 a[36:39], v[80:83], a[196:199], a[36:39]
 v_mfma_f32_16x16x32_bf16 a[40:43], v[80:83], a[200:203], 0
 ds_read_b64_tr_b16 v[72:73], v57 offset:32768
 buffer_load_dwordx4 v41, s[8:11], s75 offen offset:1024  lds
 v_mfma_f32_16x16x32_bf16 a[40:43], v[84:87], a[216:219], a[40:43]
 ds_read_b64_tr_b16 v[74:75], v57 offset:36864
 v_cvt_pk_bf16_f32 v116, v200, v201
 v_mfma_f32_16x16x32_bf16 a[44:47], v[84:87], a[220:223], 0
 v_mfma_f32_16x16x32_bf16 a[44:47], v[80:83], a[204:207], a[44:47]
 s_waitcnt lgkmcnt(6)
 v_mfma_f32_16x16x32_bf16 a[60:63], v[88:91], a[204:207], 0
 ds_read_b64_tr_b16 v[76:77], v57 offset:40960
 v_mfma_f32_16x16x32_bf16 a[60:63], v[92:95], a[220:223], a[60:63]
 ds_read_b64_tr_b16 v[78:79], v57 offset:45056
 buffer_load_dwordx4 a[156:159], v7, s[20:23], s42 offen offset:1024 sc1
 v_mfma_f32_16x16x32_bf16 a[56:59], v[92:95], a[216:219], 0
 v_cvt_pk_bf16_f32 v117, v202, v203
 v_mfma_f32_16x16x32_bf16 a[56:59], v[88:91], a[200:203], a[56:59]
 v_mfma_f32_16x16x32_bf16 a[52:55], v[88:91], a[196:199], 0
 ds_read_b64_tr_b16 v[80:81], v58 offset:32768
 v_mfma_f32_16x16x32_bf16 a[52:55], v[92:95], a[212:215], a[52:55]
 ds_read_b64_tr_b16 v[82:83], v58 offset:36864
 v_mfma_f32_16x16x32_bf16 a[48:51], v[92:95], a[208:211], 0
 v_cvt_pk_bf16_f32 v118, v204, v205
 v_mfma_f32_16x16x32_bf16 a[48:51], v[88:91], a[192:195], a[48:51]
 s_waitcnt lgkmcnt(6)
 v_mfma_f32_16x16x32_bf16 a[64:67], v[64:67], a[192:195], 0
 ds_read_b64_tr_b16 v[84:85], v58 offset:40960
 buffer_load_dwordx4 a[160:163], v4, s[20:23], s42 offen offset:2048 sc1
 v_mfma_f32_16x16x32_bf16 a[64:67], v[68:71], a[208:211], a[64:67]
 ds_read_b64_tr_b16 v[86:87], v58 offset:45056
 v_mfma_f32_16x16x32_bf16 a[68:71], v[68:71], a[212:215], 0
 v_cvt_pk_bf16_f32 v119, v206, v207
 v_mfma_f32_16x16x32_bf16 a[68:71], v[64:67], a[196:199], a[68:71]
 v_mfma_f32_16x16x32_bf16 a[72:75], v[64:67], a[200:203], 0
 ds_read_b64_tr_b16 v[88:89], v59 offset:32768
 buffer_load_dwordx4 v42, s[8:11], s75 offen offset:2048  lds
 v_mfma_f32_16x16x32_bf16 a[72:75], v[68:71], a[216:219], a[72:75]
 ds_read_b64_tr_b16 v[90:91], v59 offset:36864
 v_mfma_f32_16x16x32_bf16 a[76:79], v[68:71], a[220:223], 0
 v_mfma_f32_16x16x32_bf16 a[76:79], v[64:67], a[204:207], a[76:79]
 s_waitcnt lgkmcnt(6)
 v_mfma_f32_16x16x32_bf16 a[92:95], v[72:75], a[204:207], 0
 ds_read_b64_tr_b16 v[92:93], v59 offset:40960
 buffer_load_dwordx4 a[164:167], v5, s[20:23], s42 offen offset:2048 sc1
 v_mfma_f32_16x16x32_bf16 a[92:95], v[76:79], a[220:223], a[92:95]
 ds_read_b64_tr_b16 v[94:95], v59 offset:45056
 buffer_store_dwordx4 v[116:119], v27, s[60:63], 0 offen sc1
 v_mfma_f32_16x16x32_bf16 a[88:91], v[76:79], a[216:219], 0
 v_mfma_f32_16x16x32_bf16 a[88:91], v[72:75], a[200:203], a[88:91]
 v_cvt_pk_bf16_f32 v120, v208, v209
 v_mfma_f32_16x16x32_bf16 a[84:87], v[72:75], a[196:199], 0
 ds_read_b64_tr_b16 v[64:65], v52 offset:49152
 v_mfma_f32_16x16x32_bf16 a[84:87], v[76:79], a[212:215], a[84:87]
 ds_read_b64_tr_b16 v[66:67], v52 offset:53248
 v_mfma_f32_16x16x32_bf16 a[80:83], v[76:79], a[208:211], 0
 v_mfma_f32_16x16x32_bf16 a[80:83], v[72:75], a[192:195], a[80:83]
 s_waitcnt lgkmcnt(6)
 v_mfma_f32_16x16x32_bf16 a[96:99], v[80:83], a[192:195], 0
 ds_read_b64_tr_b16 v[68:69], v52 offset:57344
 buffer_load_dwordx4 a[168:171], v6, s[20:23], s42 offen offset:2048 sc1
 v_mfma_f32_16x16x32_bf16 a[96:99], v[84:87], a[208:211], a[96:99]
 ds_read_b64_tr_b16 v[70:71], v52 offset:61440
 v_cvt_pk_bf16_f32 v121, v210, v211
 v_mfma_f32_16x16x32_bf16 a[100:103], v[84:87], a[212:215], 0
 v_xor_b32 v52, s49, v52
 v_mfma_f32_16x16x32_bf16 a[100:103], v[80:83], a[196:199], a[100:103]
 v_mfma_f32_16x16x32_bf16 a[104:107], v[80:83], a[200:203], 0
 ds_read_b64_tr_b16 v[72:73], v53 offset:49152
 buffer_load_dwordx4 v43, s[8:11], s75 offen offset:3072  lds
 v_mfma_f32_16x16x32_bf16 a[104:107], v[84:87], a[216:219], a[104:107]
 ds_read_b64_tr_b16 v[74:75], v53 offset:53248
 v_cvt_pk_bf16_f32 v122, v212, v213
 v_mfma_f32_16x16x32_bf16 a[108:111], v[84:87], a[220:223], 0
 v_mfma_f32_16x16x32_bf16 a[108:111], v[80:83], a[204:207], a[108:111]
 s_waitcnt lgkmcnt(6)
 v_mfma_f32_16x16x32_bf16 a[124:127], v[88:91], a[204:207], 0
 ds_read_b64_tr_b16 v[76:77], v53 offset:57344
 buffer_load_dwordx4 a[172:175], v7, s[20:23], s42 offen offset:2048 sc1
 v_mfma_f32_16x16x32_bf16 a[124:127], v[92:95], a[220:223], a[124:127]
 ds_read_b64_tr_b16 v[78:79], v53 offset:61440
 v_cvt_pk_bf16_f32 v123, v214, v215
 v_mfma_f32_16x16x32_bf16 a[120:123], v[92:95], a[216:219], 0
 v_xor_b32 v53, s49, v53
 v_mfma_f32_16x16x32_bf16 a[120:123], v[88:91], a[200:203], a[120:123]
 v_mfma_f32_16x16x32_bf16 a[116:119], v[88:91], a[196:199], 0
 ds_read_b64_tr_b16 v[80:81], v54 offset:49152
 v_mfma_f32_16x16x32_bf16 a[116:119], v[92:95], a[212:215], a[116:119]
 ds_read_b64_tr_b16 v[82:83], v54 offset:53248
 buffer_store_dwordx4 v[120:123], v26, s[60:63], 0 offen offset:1024 sc1
 v_mfma_f32_16x16x32_bf16 a[112:115], v[92:95], a[208:211], 0
 v_mfma_f32_16x16x32_bf16 a[112:115], v[88:91], a[192:195], a[112:115]
 s_waitcnt lgkmcnt(6)
 s_waitcnt vmcnt(29)
 v_mfma_f32_16x16x32_bf16 a[0:3], v[64:67], a[224:227], a[0:3]
 ds_read_b64_tr_b16 v[84:85], v54 offset:57344
 buffer_load_dwordx4 a[176:179], v4, s[20:23], s42 offen offset:3072 sc1
 s_waitcnt vmcnt(25)
 v_mfma_f32_16x16x32_bf16 a[0:3], v[68:71], a[240:243], a[0:3]
 ds_read_b64_tr_b16 v[86:87], v54 offset:61440
 s_waitcnt vmcnt(24)
 v_mfma_f32_16x16x32_bf16 a[4:7], v[68:71], a[244:247], a[4:7]
 v_xor_b32 v54, s49, v54
 v_cvt_pk_bf16_f32 v124, v216, v217
 v_mfma_f32_16x16x32_bf16 a[4:7], v[64:67], a[228:231], a[4:7]
 v_mfma_f32_16x16x32_bf16 a[8:11], v[64:67], a[232:235], a[8:11]
 ds_read_b64_tr_b16 v[88:89], v55 offset:49152
 s_add_u32 m0, s79, 36864
 s_waitcnt vmcnt(22)
 v_mfma_f32_16x16x32_bf16 a[8:11], v[68:71], a[248:251], a[8:11]
 ds_read_b64_tr_b16 v[90:91], v55 offset:53248
 s_waitcnt vmcnt(21)
 v_mfma_f32_16x16x32_bf16 a[12:15], v[68:71], a[252:255], a[12:15]
 buffer_load_dwordx4 v44, s[8:11], s75 offen  lds
 v_cvt_pk_bf16_f32 v125, v218, v219
 v_mfma_f32_16x16x32_bf16 a[12:15], v[64:67], a[236:239], a[12:15]
 s_waitcnt lgkmcnt(6)
 v_mfma_f32_16x16x32_bf16 a[28:31], v[72:75], a[236:239], a[28:31]
 ds_read_b64_tr_b16 v[92:93], v55 offset:57344
 buffer_load_dwordx4 a[180:183], v5, s[20:23], s42 offen offset:3072 sc1
 v_mfma_f32_16x16x32_bf16 a[28:31], v[76:79], a[252:255], a[28:31]
 ds_read_b64_tr_b16 v[94:95], v55 offset:61440
 v_mfma_f32_16x16x32_bf16 a[24:27], v[76:79], a[248:251], a[24:27]
 v_xor_b32 v55, s49, v55
 v_mfma_f32_16x16x32_bf16 a[24:27], v[72:75], a[232:235], a[24:27]
 v_cvt_pk_bf16_f32 v126, v220, v221
 v_mfma_f32_16x16x32_bf16 a[20:23], v[72:75], a[228:231], a[20:23]
 ds_read_b64_tr_b16 v[64:65], v56 offset:49152
 v_mfma_f32_16x16x32_bf16 a[20:23], v[76:79], a[244:247], a[20:23]
 ds_read_b64_tr_b16 v[66:67], v56 offset:53248
 v_mfma_f32_16x16x32_bf16 a[16:19], v[76:79], a[240:243], a[16:19]
 v_mfma_f32_16x16x32_bf16 a[16:19], v[72:75], a[224:227], a[16:19]
 s_waitcnt lgkmcnt(6)
 v_mfma_f32_16x16x32_bf16 a[32:35], v[80:83], a[224:227], a[32:35]
 ds_read_b64_tr_b16 v[68:69], v56 offset:57344
 buffer_load_dwordx4 a[184:187], v6, s[20:23], s42 offen offset:3072 sc1
 v_mfma_f32_16x16x32_bf16 a[32:35], v[84:87], a[240:243], a[32:35]
 ds_read_b64_tr_b16 v[70:71], v56 offset:61440
 v_cvt_pk_bf16_f32 v127, v222, v223
 v_mfma_f32_16x16x32_bf16 a[36:39], v[84:87], a[244:247], a[36:39]
 v_xor_b32 v56, s49, v56
 v_mfma_f32_16x16x32_bf16 a[36:39], v[80:83], a[228:231], a[36:39]
 v_mfma_f32_16x16x32_bf16 a[40:43], v[80:83], a[232:235], a[40:43]
 ds_read_b64_tr_b16 v[72:73], v57 offset:49152
 buffer_load_dwordx4 v45, s[8:11], s75 offen offset:1024  lds
 v_mfma_f32_16x16x32_bf16 a[40:43], v[84:87], a[248:251], a[40:43]
 ds_read_b64_tr_b16 v[74:75], v57 offset:53248
 buffer_store_dwordx4 v[124:127], v27, s[60:63], 0 offen offset:1024 sc1
 v_mfma_f32_16x16x32_bf16 a[44:47], v[84:87], a[252:255], a[44:47]
 v_mfma_f32_16x16x32_bf16 a[44:47], v[80:83], a[236:239], a[44:47]
 s_waitcnt lgkmcnt(6)
 v_mfma_f32_16x16x32_bf16 a[60:63], v[88:91], a[236:239], a[60:63]
 ds_read_b64_tr_b16 v[76:77], v57 offset:57344
 buffer_load_dwordx4 a[188:191], v7, s[20:23], s42 offen offset:3072 sc1
 v_mfma_f32_16x16x32_bf16 a[60:63], v[92:95], a[252:255], a[60:63]
 ds_read_b64_tr_b16 v[78:79], v57 offset:61440
 s_add_u32 s42, s42, 4096
 v_mfma_f32_16x16x32_bf16 a[56:59], v[92:95], a[248:251], a[56:59]
 v_xor_b32 v57, s49, v57
 v_cvt_pk_bf16_f32 v112, v224, v225
 v_mfma_f32_16x16x32_bf16 a[56:59], v[88:91], a[232:235], a[56:59]
 v_mfma_f32_16x16x32_bf16 a[52:55], v[88:91], a[228:231], a[52:55]
 ds_read_b64_tr_b16 v[80:81], v58 offset:49152
 v_mfma_f32_16x16x32_bf16 a[52:55], v[92:95], a[244:247], a[52:55]
 ds_read_b64_tr_b16 v[82:83], v58 offset:53248
 v_cvt_pk_bf16_f32 v113, v226, v227
 v_mfma_f32_16x16x32_bf16 a[48:51], v[92:95], a[240:243], a[48:51]
 v_mfma_f32_16x16x32_bf16 a[48:51], v[88:91], a[224:227], a[48:51]
 s_waitcnt lgkmcnt(6)
 v_mfma_f32_16x16x32_bf16 a[64:67], v[64:67], a[224:227], a[64:67]
 ds_read_b64_tr_b16 v[84:85], v58 offset:57344
 buffer_load_dwordx4 a[192:195], v4, s[20:23], s42 offen sc1
 v_mfma_f32_16x16x32_bf16 a[64:67], v[68:71], a[240:243], a[64:67]
 ds_read_b64_tr_b16 v[86:87], v58 offset:61440
 v_cvt_pk_bf16_f32 v114, v228, v229
 v_mfma_f32_16x16x32_bf16 a[68:71], v[68:71], a[244:247], a[68:71]
 v_xor_b32 v58, s49, v58
 v_mfma_f32_16x16x32_bf16 a[68:71], v[64:67], a[228:231], a[68:71]
 v_mfma_f32_16x16x32_bf16 a[72:75], v[64:67], a[232:235], a[72:75]
 ds_read_b64_tr_b16 v[88:89], v59 offset:49152
 buffer_load_dwordx4 v46, s[8:11], s75 offen offset:2048  lds
 v_mfma_f32_16x16x32_bf16 a[72:75], v[68:71], a[248:251], a[72:75]
 ds_read_b64_tr_b16 v[90:91], v59 offset:53248
 v_cvt_pk_bf16_f32 v115, v230, v231
 v_mfma_f32_16x16x32_bf16 a[76:79], v[68:71], a[252:255], a[76:79]
 v_mfma_f32_16x16x32_bf16 a[76:79], v[64:67], a[236:239], a[76:79]
 s_waitcnt lgkmcnt(6)
 v_mfma_f32_16x16x32_bf16 a[92:95], v[72:75], a[236:239], a[92:95]
 ds_read_b64_tr_b16 v[92:93], v59 offset:57344
 buffer_load_dwordx4 a[196:199], v5, s[20:23], s42 offen sc1
 v_mfma_f32_16x16x32_bf16 a[92:95], v[76:79], a[252:255], a[92:95]
 ds_read_b64_tr_b16 v[94:95], v59 offset:61440
 v_mfma_f32_16x16x32_bf16 a[88:91], v[76:79], a[248:251], a[88:91]
 buffer_store_dwordx4 v[112:115], v26, s[60:63], 0 offen offset:2048 sc1
 v_xor_b32 v59, s49, v59
 v_mfma_f32_16x16x32_bf16 a[88:91], v[72:75], a[232:235], a[88:91]
 s_waitcnt vmcnt(29)
 s_barrier
 v_mfma_f32_16x16x32_bf16 a[84:87], v[72:75], a[228:231], a[84:87]
 ds_read_b64_tr_b16 v[64:65], v52
 v_mfma_f32_16x16x32_bf16 a[84:87], v[76:79], a[244:247], a[84:87]
 ds_read_b64_tr_b16 v[66:67], v52 offset:4096
 v_mfma_f32_16x16x32_bf16 a[80:83], v[76:79], a[240:243], a[80:83]
 v_cvt_pk_bf16_f32 v116, v232, v233
 v_mfma_f32_16x16x32_bf16 a[80:83], v[72:75], a[224:227], a[80:83]
 s_waitcnt lgkmcnt(6)
 v_mfma_f32_16x16x32_bf16 a[96:99], v[80:83], a[224:227], a[96:99]
 ds_read_b64_tr_b16 v[68:69], v52 offset:8192
 buffer_load_dwordx4 a[200:203], v6, s[20:23], s42 offen sc1
 v_mfma_f32_16x16x32_bf16 a[96:99], v[84:87], a[240:243], a[96:99]
 ds_read_b64_tr_b16 v[70:71], v52 offset:12288
 v_mfma_f32_16x16x32_bf16 a[100:103], v[84:87], a[244:247], a[100:103]
 v_mfma_f32_16x16x32_bf16 a[100:103], v[80:83], a[228:231], a[100:103]
 v_cvt_pk_bf16_f32 v117, v234, v235
 v_mfma_f32_16x16x32_bf16 a[104:107], v[80:83], a[232:235], a[104:107]
 ds_read_b64_tr_b16 v[72:73], v53
 buffer_load_dwordx4 v47, s[8:11], s75 offen offset:3072  lds
 v_mfma_f32_16x16x32_bf16 a[104:107], v[84:87], a[248:251], a[104:107]
 ds_read_b64_tr_b16 v[74:75], v53 offset:4096
 s_add_u32 s75, s75, 262144
 v_mfma_f32_16x16x32_bf16 a[108:111], v[84:87], a[252:255], a[108:111]
 v_mfma_f32_16x16x32_bf16 a[108:111], v[80:83], a[236:239], a[108:111]
 s_waitcnt lgkmcnt(6)
 v_mfma_f32_16x16x32_bf16 a[124:127], v[88:91], a[236:239], a[124:127]
 ds_read_b64_tr_b16 v[76:77], v53 offset:8192
 buffer_load_dwordx4 a[204:207], v7, s[20:23], s42 offen sc1
 v_mfma_f32_16x16x32_bf16 a[124:127], v[92:95], a[252:255], a[124:127]
 ds_read_b64_tr_b16 v[78:79], v53 offset:12288
 buffer_load_dword v61, v0, s[16:19], 0 offen
 v_mfma_f32_16x16x32_bf16 a[120:123], v[92:95], a[248:251], a[120:123]
 v_cvt_pk_bf16_f32 v118, v236, v237
 v_mfma_f32_16x16x32_bf16 a[120:123], v[88:91], a[232:235], a[120:123]
 v_mfma_f32_16x16x32_bf16 a[116:119], v[88:91], a[228:231], a[116:119]
 ds_read_b64_tr_b16 v[80:81], v54
 v_cvt_pk_bf16_f32 v119, v238, v239
 v_mfma_f32_16x16x32_bf16 a[116:119], v[92:95], a[244:247], a[116:119]
 ds_read_b64_tr_b16 v[82:83], v54 offset:4096
 v_mfma_f32_16x16x32_bf16 a[112:115], v[92:95], a[240:243], a[112:115]
 v_mfma_f32_16x16x32_bf16 a[112:115], v[88:91], a[224:227], a[112:115]
 s_waitcnt lgkmcnt(6)
 v_mfma_f32_16x16x32_bf16 a[0:3], v[64:67], a[128:131], a[0:3]
 ds_read_b64_tr_b16 v[84:85], v54 offset:8192
 buffer_load_dwordx4 a[208:211], v4, s[20:23], s42 offen offset:1024 sc1
 s_waitcnt vmcnt(29)
 v_mfma_f32_16x16x32_bf16 a[0:3], v[68:71], a[144:147], a[0:3]
 ds_read_b64_tr_b16 v[86:87], v54 offset:12288
 buffer_store_dwordx4 v[116:119], v27, s[60:63], 0 offen offset:2048 sc1
 s_waitcnt vmcnt(29)
 v_mfma_f32_16x16x32_bf16 a[4:7], v[68:71], a[148:151], a[4:7]
 v_mfma_f32_16x16x32_bf16 a[4:7], v[64:67], a[132:135], a[4:7]
 v_mfma_f32_16x16x32_bf16 a[8:11], v[64:67], a[136:139], a[8:11]
 ds_read_b64_tr_b16 v[88:89], v55
 s_add_u32 m0, s79, 65536
 s_waitcnt vmcnt(27)
 v_mfma_f32_16x16x32_bf16 a[8:11], v[68:71], a[152:155], a[8:11]
 ds_read_b64_tr_b16 v[90:91], v55 offset:4096
 s_waitcnt vmcnt(25)
 v_cvt_pk_bf16_f32 v120, v240, v241
 v_mfma_f32_16x16x32_bf16 a[12:15], v[68:71], a[156:159], a[12:15]
 buffer_load_dwordx4 v40, s[8:11], s75 offen  lds
 v_mfma_f32_16x16x32_bf16 a[12:15], v[64:67], a[140:143], a[12:15]
 s_waitcnt lgkmcnt(6)
 v_mfma_f32_16x16x32_bf16 a[28:31], v[72:75], a[140:143], a[28:31]
 ds_read_b64_tr_b16 v[92:93], v55 offset:8192
 buffer_load_dwordx4 a[212:215], v5, s[20:23], s42 offen offset:1024 sc1
 v_mfma_f32_16x16x32_bf16 a[28:31], v[76:79], a[156:159], a[28:31]
 ds_read_b64_tr_b16 v[94:95], v55 offset:12288
 v_cvt_pk_bf16_f32 v121, v242, v243
 v_mfma_f32_16x16x32_bf16 a[24:27], v[76:79], a[152:155], a[24:27]
 v_mfma_f32_16x16x32_bf16 a[24:27], v[72:75], a[136:139], a[24:27]
 v_mfma_f32_16x16x32_bf16 a[20:23], v[72:75], a[132:135], a[20:23]
 ds_read_b64_tr_b16 v[64:65], v56
 v_mfma_f32_16x16x32_bf16 a[20:23], v[76:79], a[148:151], a[20:23]
 ds_read_b64_tr_b16 v[66:67], v56 offset:4096
 v_mfma_f32_16x16x32_bf16 a[16:19], v[76:79], a[144:147], a[16:19]
 v_cvt_pk_bf16_f32 v122, v244, v245
 v_mfma_f32_16x16x32_bf16 a[16:19], v[72:75], a[128:131], a[16:19]
 s_waitcnt lgkmcnt(6)
 v_mfma_f32_16x16x32_bf16 a[32:35], v[80:83], a[128:131], a[32:35]
 ds_read_b64_tr_b16 v[68:69], v56 offset:8192
 buffer_load_dwordx4 a[216:219], v6, s[20:23], s42 offen offset:1024 sc1
 v_mfma_f32_16x16x32_bf16 a[32:35], v[84:87], a[144:147], a[32:35]
 ds_read_b64_tr_b16 v[70:71], v56 offset:12288
 v_mfma_f32_16x16x32_bf16 a[36:39], v[84:87], a[148:151], a[36:39]
 v_cvt_pk_bf16_f32 v123, v246, v247
 v_mfma_f32_16x16x32_bf16 a[36:39], v[80:83], a[132:135], a[36:39]
 v_mfma_f32_16x16x32_bf16 a[40:43], v[80:83], a[136:139], a[40:43]
 ds_read_b64_tr_b16 v[72:73], v57
 buffer_load_dwordx4 v41, s[8:11], s75 offen offset:1024  lds
 v_mfma_f32_16x16x32_bf16 a[40:43], v[84:87], a[152:155], a[40:43]
 ds_read_b64_tr_b16 v[74:75], v57 offset:4096
 v_mfma_f32_16x16x32_bf16 a[44:47], v[84:87], a[156:159], a[44:47]
 v_mfma_f32_16x16x32_bf16 a[44:47], v[80:83], a[140:143], a[44:47]
 s_waitcnt lgkmcnt(6)
 v_mfma_f32_16x16x32_bf16 a[60:63], v[88:91], a[140:143], a[60:63]
 ds_read_b64_tr_b16 v[76:77], v57 offset:8192
 buffer_load_dwordx4 a[220:223], v7, s[20:23], s42 offen offset:1024 sc1
 v_mfma_f32_16x16x32_bf16 a[60:63], v[92:95], a[156:159], a[60:63]
 ds_read_b64_tr_b16 v[78:79], v57 offset:12288
 buffer_store_dwordx4 v[120:123], v26, s[60:63], 0 offen offset:3072 sc1
 v_mfma_f32_16x16x32_bf16 a[56:59], v[92:95], a[152:155], a[56:59]
 v_mfma_f32_16x16x32_bf16 a[56:59], v[88:91], a[136:139], a[56:59]
 v_cvt_pk_bf16_f32 v124, v248, v249
 v_mfma_f32_16x16x32_bf16 a[52:55], v[88:91], a[132:135], a[52:55]
 ds_read_b64_tr_b16 v[80:81], v58
 v_mfma_f32_16x16x32_bf16 a[52:55], v[92:95], a[148:151], a[52:55]
 ds_read_b64_tr_b16 v[82:83], v58 offset:4096
 v_mfma_f32_16x16x32_bf16 a[48:51], v[92:95], a[144:147], a[48:51]
 v_mfma_f32_16x16x32_bf16 a[48:51], v[88:91], a[128:131], a[48:51]
 s_waitcnt lgkmcnt(6)
 v_mfma_f32_16x16x32_bf16 a[64:67], v[64:67], a[128:131], a[64:67]
 ds_read_b64_tr_b16 v[84:85], v58 offset:8192
 buffer_load_dwordx4 a[224:227], v4, s[20:23], s42 offen offset:2048 sc1
 v_mfma_f32_16x16x32_bf16 a[64:67], v[68:71], a[144:147], a[64:67]
 ds_read_b64_tr_b16 v[86:87], v58 offset:12288
 v_cvt_pk_bf16_f32 v125, v250, v251
 v_mfma_f32_16x16x32_bf16 a[68:71], v[68:71], a[148:151], a[68:71]
 v_mfma_f32_16x16x32_bf16 a[68:71], v[64:67], a[132:135], a[68:71]
 v_mfma_f32_16x16x32_bf16 a[72:75], v[64:67], a[136:139], a[72:75]
 ds_read_b64_tr_b16 v[88:89], v59
 buffer_load_dwordx4 v42, s[8:11], s75 offen offset:2048  lds
 v_mfma_f32_16x16x32_bf16 a[72:75], v[68:71], a[152:155], a[72:75]
 ds_read_b64_tr_b16 v[90:91], v59 offset:4096
 v_cvt_pk_bf16_f32 v126, v252, v253
 v_mfma_f32_16x16x32_bf16 a[76:79], v[68:71], a[156:159], a[76:79]
 v_mfma_f32_16x16x32_bf16 a[76:79], v[64:67], a[140:143], a[76:79]
 s_waitcnt lgkmcnt(6)
 v_mfma_f32_16x16x32_bf16 a[92:95], v[72:75], a[140:143], a[92:95]
 ds_read_b64_tr_b16 v[92:93], v59 offset:8192
 buffer_load_dwordx4 a[228:231], v5, s[20:23], s42 offen offset:2048 sc1
 v_mfma_f32_16x16x32_bf16 a[92:95], v[76:79], a[156:159], a[92:95]
 ds_read_b64_tr_b16 v[94:95], v59 offset:12288
 v_cvt_pk_bf16_f32 v127, v254, v255
 v_mfma_f32_16x16x32_bf16 a[88:91], v[76:79], a[152:155], a[88:91]
 v_mfma_f32_16x16x32_bf16 a[88:91], v[72:75], a[136:139], a[88:91]
 v_mfma_f32_16x16x32_bf16 a[84:87], v[72:75], a[132:135], a[84:87]
 ds_read_b64_tr_b16 v[64:65], v52 offset:16384
 v_mfma_f32_16x16x32_bf16 a[84:87], v[76:79], a[148:151], a[84:87]
 ds_read_b64_tr_b16 v[66:67], v52 offset:20480
 buffer_store_dwordx4 v[124:127], v27, s[60:63], 0 offen offset:3072 sc1
 v_mfma_f32_16x16x32_bf16 a[80:83], v[76:79], a[144:147], a[80:83]
 v_mfma_f32_16x16x32_bf16 a[80:83], v[72:75], a[128:131], a[80:83]
 s_waitcnt lgkmcnt(6)
 v_mfma_f32_16x16x32_bf16 a[96:99], v[80:83], a[128:131], a[96:99]
 ds_read_b64_tr_b16 v[68:69], v52 offset:24576
 buffer_load_dwordx4 a[232:235], v6, s[20:23], s42 offen offset:2048 sc1
 v_mfma_f32_16x16x32_bf16 a[96:99], v[84:87], a[144:147], a[96:99]
 ds_read_b64_tr_b16 v[70:71], v52 offset:28672
 v_mfma_f32_16x16x32_bf16 a[100:103], v[84:87], a[148:151], a[100:103]
 v_cvt_pk_bf16_f32 v112, v136, v137
 v_mfma_f32_16x16x32_bf16 a[100:103], v[80:83], a[132:135], a[100:103]
 v_mfma_f32_16x16x32_bf16 a[104:107], v[80:83], a[136:139], a[104:107]
 ds_read_b64_tr_b16 v[72:73], v53 offset:16384
 buffer_load_dwordx4 v43, s[8:11], s75 offen offset:3072  lds
 v_mfma_f32_16x16x32_bf16 a[104:107], v[84:87], a[152:155], a[104:107]
 ds_read_b64_tr_b16 v[74:75], v53 offset:20480
 v_mfma_f32_16x16x32_bf16 a[108:111], v[84:87], a[156:159], a[108:111]
 v_cvt_pk_bf16_f32 v113, v138, v139
 v_mfma_f32_16x16x32_bf16 a[108:111], v[80:83], a[140:143], a[108:111]
 s_waitcnt lgkmcnt(6)
 v_mfma_f32_16x16x32_bf16 a[124:127], v[88:91], a[140:143], a[124:127]
 ds_read_b64_tr_b16 v[76:77], v53 offset:24576
 buffer_load_dwordx4 a[236:239], v7, s[20:23], s42 offen offset:2048 sc1
 v_mfma_f32_16x16x32_bf16 a[124:127], v[92:95], a[156:159], a[124:127]
 ds_read_b64_tr_b16 v[78:79], v53 offset:28672
 v_mfma_f32_16x16x32_bf16 a[120:123], v[92:95], a[152:155], a[120:123]
 v_mfma_f32_16x16x32_bf16 a[120:123], v[88:91], a[136:139], a[120:123]
 v_cvt_pk_bf16_f32 v114, v140, v141
 v_mfma_f32_16x16x32_bf16 a[116:119], v[88:91], a[132:135], a[116:119]
 ds_read_b64_tr_b16 v[80:81], v54 offset:16384
 v_mfma_f32_16x16x32_bf16 a[116:119], v[92:95], a[148:151], a[116:119]
 ds_read_b64_tr_b16 v[82:83], v54 offset:20480
 v_mfma_f32_16x16x32_bf16 a[112:115], v[92:95], a[144:147], a[112:115]
 v_mfma_f32_16x16x32_bf16 a[112:115], v[88:91], a[128:131], a[112:115]
 s_waitcnt lgkmcnt(6)
 s_waitcnt vmcnt(37)
 v_mfma_f32_16x16x32_bf16 a[0:3], v[64:67], a[160:163], a[0:3]
 ds_read_b64_tr_b16 v[84:85], v54 offset:24576
 buffer_load_dwordx4 a[240:243], v4, s[20:23], s42 offen offset:3072 sc1
 s_waitcnt vmcnt(30)
 v_mfma_f32_16x16x32_bf16 a[0:3], v[68:71], a[176:179], a[0:3]
 ds_read_b64_tr_b16 v[86:87], v54 offset:28672
 s_waitcnt vmcnt(28)
 v_cvt_pk_bf16_f32 v115, v142, v143
 v_mfma_f32_16x16x32_bf16 a[4:7], v[68:71], a[180:183], a[4:7]
 v_mfma_f32_16x16x32_bf16 a[4:7], v[64:67], a[164:167], a[4:7]
 v_mfma_f32_16x16x32_bf16 a[8:11], v[64:67], a[168:171], a[8:11]
 ds_read_b64_tr_b16 v[88:89], v55 offset:16384
 s_add_u32 m0, s79, 69632
 s_waitcnt vmcnt(27)
 v_mfma_f32_16x16x32_bf16 a[8:11], v[68:71], a[184:187], a[8:11]
 ds_read_b64_tr_b16 v[90:91], v55 offset:20480
 buffer_store_dwordx4 v[112:115], v25, s[60:63], 0 offen sc1
 s_waitcnt vmcnt(25)
 v_mfma_f32_16x16x32_bf16 a[12:15], v[68:71], a[188:191], a[12:15]
 buffer_load_dwordx4 v44, s[8:11], s75 offen  lds
 v_mfma_f32_16x16x32_bf16 a[12:15], v[64:67], a[172:175], a[12:15]
 s_waitcnt lgkmcnt(6)
 v_mfma_f32_16x16x32_bf16 a[28:31], v[72:75], a[172:175], a[28:31]
 ds_read_b64_tr_b16 v[92:93], v55 offset:24576
 buffer_load_dwordx4 a[244:247], v5, s[20:23], s42 offen offset:3072 sc1
 v_mfma_f32_16x16x32_bf16 a[28:31], v[76:79], a[188:191], a[28:31]
 ds_read_b64_tr_b16 v[94:95], v55 offset:28672
 v_cvt_pk_bf16_f32 v116, v152, v153
 v_mfma_f32_16x16x32_bf16 a[24:27], v[76:79], a[184:187], a[24:27]
 v_mfma_f32_16x16x32_bf16 a[24:27], v[72:75], a[168:171], a[24:27]
 v_mfma_f32_16x16x32_bf16 a[20:23], v[72:75], a[164:167], a[20:23]
 ds_read_b64_tr_b16 v[64:65], v56 offset:16384
 v_cvt_pk_bf16_f32 v117, v154, v155
 v_mfma_f32_16x16x32_bf16 a[20:23], v[76:79], a[180:183], a[20:23]
 ds_read_b64_tr_b16 v[66:67], v56 offset:20480
 v_mfma_f32_16x16x32_bf16 a[16:19], v[76:79], a[176:179], a[16:19]
 v_mfma_f32_16x16x32_bf16 a[16:19], v[72:75], a[160:163], a[16:19]
 s_waitcnt lgkmcnt(6)
 v_mfma_f32_16x16x32_bf16 a[32:35], v[80:83], a[160:163], a[32:35]
 ds_read_b64_tr_b16 v[68:69], v56 offset:24576
 buffer_load_dwordx4 a[248:251], v6, s[20:23], s42 offen offset:3072 sc1
 v_mfma_f32_16x16x32_bf16 a[32:35], v[84:87], a[176:179], a[32:35]
 ds_read_b64_tr_b16 v[70:71], v56 offset:28672
 v_cvt_pk_bf16_f32 v118, v156, v157
 v_mfma_f32_16x16x32_bf16 a[36:39], v[84:87], a[180:183], a[36:39]
 v_mfma_f32_16x16x32_bf16 a[36:39], v[80:83], a[164:167], a[36:39]
 v_mfma_f32_16x16x32_bf16 a[40:43], v[80:83], a[168:171], a[40:43]
 ds_read_b64_tr_b16 v[72:73], v57 offset:16384
 buffer_load_dwordx4 v45, s[8:11], s75 offen offset:1024  lds
 v_mfma_f32_16x16x32_bf16 a[40:43], v[84:87], a[184:187], a[40:43]
 ds_read_b64_tr_b16 v[74:75], v57 offset:20480
 v_cvt_pk_bf16_f32 v119, v158, v159
 v_mfma_f32_16x16x32_bf16 a[44:47], v[84:87], a[188:191], a[44:47]
 v_mfma_f32_16x16x32_bf16 a[44:47], v[80:83], a[172:175], a[44:47]
 s_waitcnt lgkmcnt(6)
 v_mfma_f32_16x16x32_bf16 a[60:63], v[88:91], a[172:175], a[60:63]
 ds_read_b64_tr_b16 v[76:77], v57 offset:24576
 buffer_load_dwordx4 a[252:255], v7, s[20:23], s42 offen offset:3072 sc1
 v_mfma_f32_16x16x32_bf16 a[60:63], v[92:95], a[188:191], a[60:63]
 ds_read_b64_tr_b16 v[78:79], v57 offset:28672
 s_add_u32 s42, s42, 4096
 v_mfma_f32_16x16x32_bf16 a[56:59], v[92:95], a[184:187], a[56:59]
 buffer_store_dwordx4 v[116:119], v25, s[60:63], 0 offen offset:1024 sc1
 v_mfma_f32_16x16x32_bf16 a[56:59], v[88:91], a[168:171], a[56:59]
 v_mfma_f32_16x16x32_bf16 a[52:55], v[88:91], a[164:167], a[52:55]
 ds_read_b64_tr_b16 v[80:81], v58 offset:16384
 v_mfma_f32_16x16x32_bf16 a[52:55], v[92:95], a[180:183], a[52:55]
 ds_read_b64_tr_b16 v[82:83], v58 offset:20480
 v_mfma_f32_16x16x32_bf16 a[48:51], v[92:95], a[176:179], a[48:51]
 v_cvt_pk_bf16_f32 v120, v168, v169
 v_mfma_f32_16x16x32_bf16 a[48:51], v[88:91], a[160:163], a[48:51]
 s_waitcnt lgkmcnt(6)
 v_mfma_f32_16x16x32_bf16 a[64:67], v[64:67], a[160:163], a[64:67]
 ds_read_b64_tr_b16 v[84:85], v58 offset:24576
 buffer_load_dwordx4 a[128:131], v4, s[20:23], s42 offen sc1
 v_mfma_f32_16x16x32_bf16 a[64:67], v[68:71], a[176:179], a[64:67]
 ds_read_b64_tr_b16 v[86:87], v58 offset:28672
 v_mfma_f32_16x16x32_bf16 a[68:71], v[68:71], a[180:183], a[68:71]
 v_mfma_f32_16x16x32_bf16 a[68:71], v[64:67], a[164:167], a[68:71]
 v_cvt_pk_bf16_f32 v121, v170, v171
 v_mfma_f32_16x16x32_bf16 a[72:75], v[64:67], a[168:171], a[72:75]
 ds_read_b64_tr_b16 v[88:89], v59 offset:16384
 buffer_load_dwordx4 v46, s[8:11], s75 offen offset:2048  lds
 v_mfma_f32_16x16x32_bf16 a[72:75], v[68:71], a[184:187], a[72:75]
 ds_read_b64_tr_b16 v[90:91], v59 offset:20480
 v_mfma_f32_16x16x32_bf16 a[76:79], v[68:71], a[188:191], a[76:79]
 v_mfma_f32_16x16x32_bf16 a[76:79], v[64:67], a[172:175], a[76:79]
 s_waitcnt lgkmcnt(6)
 v_mfma_f32_16x16x32_bf16 a[92:95], v[72:75], a[172:175], a[92:95]
 ds_read_b64_tr_b16 v[92:93], v59 offset:24576
 buffer_load_dwordx4 a[132:135], v5, s[20:23], s42 offen sc1
 v_mfma_f32_16x16x32_bf16 a[92:95], v[76:79], a[188:191], a[92:95]
 ds_read_b64_tr_b16 v[94:95], v59 offset:28672
 v_cvt_pk_bf16_f32 v122, v172, v173
 v_mfma_f32_16x16x32_bf16 a[88:91], v[76:79], a[184:187], a[88:91]
 v_mfma_f32_16x16x32_bf16 a[88:91], v[72:75], a[168:171], a[88:91]
 s_waitcnt vmcnt(28)
 s_barrier
 v_mfma_f32_16x16x32_bf16 a[84:87], v[72:75], a[164:167], a[84:87]
 ds_read_b64_tr_b16 v[64:65], v52 offset:32768
 v_cvt_pk_bf16_f32 v123, v174, v175
 v_mfma_f32_16x16x32_bf16 a[84:87], v[76:79], a[180:183], a[84:87]
 ds_read_b64_tr_b16 v[66:67], v52 offset:36864
 v_mfma_f32_16x16x32_bf16 a[80:83], v[76:79], a[176:179], a[80:83]
 v_mfma_f32_16x16x32_bf16 a[80:83], v[72:75], a[160:163], a[80:83]
 s_waitcnt lgkmcnt(6)
 v_mfma_f32_16x16x32_bf16 a[96:99], v[80:83], a[160:163], a[96:99]
 ds_read_b64_tr_b16 v[68:69], v52 offset:40960
 buffer_load_dwordx4 a[136:139], v6, s[20:23], s42 offen sc1
 v_mfma_f32_16x16x32_bf16 a[96:99], v[84:87], a[176:179], a[96:99]
 ds_read_b64_tr_b16 v[70:71], v52 offset:45056
 buffer_store_dwordx4 v[120:123], v25, s[60:63], 0 offen offset:2048 sc1
 v_mfma_f32_16x16x32_bf16 a[100:103], v[84:87], a[180:183], a[100:103]
 v_mfma_f32_16x16x32_bf16 a[100:103], v[80:83], a[164:167], a[100:103]
 v_mfma_f32_16x16x32_bf16 a[104:107], v[80:83], a[168:171], a[104:107]
 ds_read_b64_tr_b16 v[72:73], v53 offset:32768
 buffer_load_dwordx4 v47, s[8:11], s75 offen offset:3072  lds
 v_mfma_f32_16x16x32_bf16 a[104:107], v[84:87], a[184:187], a[104:107]
 ds_read_b64_tr_b16 v[74:75], v53 offset:36864
 s_add_u32 s75, s75, 262144
 v_mfma_f32_16x16x32_bf16 a[108:111], v[84:87], a[188:191], a[108:111]
 v_cvt_pk_bf16_f32 v124, v184, v185
 v_mfma_f32_16x16x32_bf16 a[108:111], v[80:83], a[172:175], a[108:111]
 s_waitcnt lgkmcnt(6)
 v_mfma_f32_16x16x32_bf16 a[124:127], v[88:91], a[172:175], a[124:127]
 ds_read_b64_tr_b16 v[76:77], v53 offset:40960
 buffer_load_dwordx4 a[140:143], v7, s[20:23], s42 offen sc1
 v_mfma_f32_16x16x32_bf16 a[124:127], v[92:95], a[188:191], a[124:127]
 ds_read_b64_tr_b16 v[78:79], v53 offset:45056
 buffer_load_dword v61, v0, s[16:19], 0 offen
 v_mfma_f32_16x16x32_bf16 a[120:123], v[92:95], a[184:187], a[120:123]
 v_cvt_pk_bf16_f32 v125, v186, v187
 v_mfma_f32_16x16x32_bf16 a[120:123], v[88:91], a[168:171], a[120:123]
 v_mfma_f32_16x16x32_bf16 a[116:119], v[88:91], a[164:167], a[116:119]
 ds_read_b64_tr_b16 v[80:81], v54 offset:32768
 v_mfma_f32_16x16x32_bf16 a[116:119], v[92:95], a[180:183], a[116:119]
 ds_read_b64_tr_b16 v[82:83], v54 offset:36864
 v_mfma_f32_16x16x32_bf16 a[112:115], v[92:95], a[176:179], a[112:115]
 v_cvt_pk_bf16_f32 v126, v188, v189
 v_mfma_f32_16x16x32_bf16 a[112:115], v[88:91], a[160:163], a[112:115]
 s_waitcnt lgkmcnt(6)
 v_mfma_f32_16x16x32_bf16 a[0:3], v[64:67], a[192:195], a[0:3]
 ds_read_b64_tr_b16 v[84:85], v54 offset:40960
 buffer_load_dwordx4 a[144:147], v4, s[20:23], s42 offen offset:1024 sc1
 s_waitcnt vmcnt(31)
 v_mfma_f32_16x16x32_bf16 a[0:3], v[68:71], a[208:211], a[0:3]
 ds_read_b64_tr_b16 v[86:87], v54 offset:45056
 s_waitcnt vmcnt(28)
 v_mfma_f32_16x16x32_bf16 a[4:7], v[68:71], a[212:215], a[4:7]
 v_cvt_pk_bf16_f32 v127, v190, v191
 v_mfma_f32_16x16x32_bf16 a[4:7], v[64:67], a[196:199], a[4:7]
 v_mfma_f32_16x16x32_bf16 a[8:11], v[64:67], a[200:203], a[8:11]
 ds_read_b64_tr_b16 v[88:89], v55 offset:32768
 s_add_u32 m0, s79, 98304
 s_waitcnt vmcnt(27)
 v_mfma_f32_16x16x32_bf16 a[8:11], v[68:71], a[216:219], a[8:11]
 ds_read_b64_tr_b16 v[90:91], v55 offset:36864
 s_waitcnt vmcnt(25)
 v_mfma_f32_16x16x32_bf16 a[12:15], v[68:71], a[220:223], a[12:15]
 buffer_load_dwordx4 v40, s[8:11], s75 offen  lds
 v_mfma_f32_16x16x32_bf16 a[12:15], v[64:67], a[204:207], a[12:15]
 s_waitcnt lgkmcnt(6)
 v_mfma_f32_16x16x32_bf16 a[28:31], v[72:75], a[204:207], a[28:31]
 ds_read_b64_tr_b16 v[92:93], v55 offset:40960
 buffer_load_dwordx4 a[148:151], v5, s[20:23], s42 offen offset:1024 sc1
 v_mfma_f32_16x16x32_bf16 a[28:31], v[76:79], a[220:223], a[28:31]
 ds_read_b64_tr_b16 v[94:95], v55 offset:45056
 buffer_store_dwordx4 v[124:127], v25, s[60:63], 0 offen offset:3072 sc1
 v_mfma_f32_16x16x32_bf16 a[24:27], v[76:79], a[216:219], a[24:27]
 v_mfma_f32_16x16x32_bf16 a[24:27], v[72:75], a[200:203], a[24:27]
 v_mov_b32 v136, v144
 v_mfma_f32_16x16x32_bf16 a[20:23], v[72:75], a[196:199], a[20:23]
 ds_read_b64_tr_b16 v[64:65], v56 offset:32768
 v_mfma_f32_16x16x32_bf16 a[20:23], v[76:79], a[212:215], a[20:23]
 ds_read_b64_tr_b16 v[66:67], v56 offset:36864
 v_mfma_f32_16x16x32_bf16 a[16:19], v[76:79], a[208:211], a[16:19]
 v_mfma_f32_16x16x32_bf16 a[16:19], v[72:75], a[192:195], a[16:19]
 s_waitcnt lgkmcnt(6)
 v_mfma_f32_16x16x32_bf16 a[32:35], v[80:83], a[192:195], a[32:35]
 ds_read_b64_tr_b16 v[68:69], v56 offset:40960
 buffer_load_dwordx4 a[152:155], v6, s[20:23], s42 offen offset:1024 sc1
 v_mfma_f32_16x16x32_bf16 a[32:35], v[84:87], a[208:211], a[32:35]
 ds_read_b64_tr_b16 v[70:71], v56 offset:45056
 v_mov_b32 v137, v145
 v_mfma_f32_16x16x32_bf16 a[36:39], v[84:87], a[212:215], a[36:39]
 v_mfma_f32_16x16x32_bf16 a[36:39], v[80:83], a[196:199], a[36:39]
 v_mfma_f32_16x16x32_bf16 a[40:43], v[80:83], a[200:203], a[40:43]
 ds_read_b64_tr_b16 v[72:73], v57 offset:32768
 buffer_load_dwordx4 v41, s[8:11], s75 offen offset:1024  lds
 v_mfma_f32_16x16x32_bf16 a[40:43], v[84:87], a[216:219], a[40:43]
 ds_read_b64_tr_b16 v[74:75], v57 offset:36864
 v_mov_b32 v138, v146
 v_mfma_f32_16x16x32_bf16 a[44:47], v[84:87], a[220:223], a[44:47]
 v_mfma_f32_16x16x32_bf16 a[44:47], v[80:83], a[204:207], a[44:47]
 s_waitcnt lgkmcnt(6)
 v_mfma_f32_16x16x32_bf16 a[60:63], v[88:91], a[204:207], a[60:63]
 ds_read_b64_tr_b16 v[76:77], v57 offset:40960
 buffer_load_dwordx4 a[156:159], v7, s[20:23], s42 offen offset:1024 sc1
 v_mfma_f32_16x16x32_bf16 a[60:63], v[92:95], a[220:223], a[60:63]
 ds_read_b64_tr_b16 v[78:79], v57 offset:45056
 v_mov_b32 v139, v147
 v_mfma_f32_16x16x32_bf16 a[56:59], v[92:95], a[216:219], a[56:59]
 v_mfma_f32_16x16x32_bf16 a[56:59], v[88:91], a[200:203], a[56:59]
 v_mfma_f32_16x16x32_bf16 a[52:55], v[88:91], a[196:199], a[52:55]
 ds_read_b64_tr_b16 v[80:81], v58 offset:32768
 v_mfma_f32_16x16x32_bf16 a[52:55], v[92:95], a[212:215], a[52:55]
 ds_read_b64_tr_b16 v[82:83], v58 offset:36864
 v_mov_b32 v140, v148
 v_mfma_f32_16x16x32_bf16 a[48:51], v[92:95], a[208:211], a[48:51]
 v_mfma_f32_16x16x32_bf16 a[48:51], v[88:91], a[192:195], a[48:51]
 s_waitcnt lgkmcnt(6)
 v_mfma_f32_16x16x32_bf16 a[64:67], v[64:67], a[192:195], a[64:67]
 ds_read_b64_tr_b16 v[84:85], v58 offset:40960
 buffer_load_dwordx4 a[160:163], v4, s[20:23], s42 offen offset:2048 sc1
 v_mfma_f32_16x16x32_bf16 a[64:67], v[68:71], a[208:211], a[64:67]
 ds_read_b64_tr_b16 v[86:87], v58 offset:45056
 v_mfma_f32_16x16x32_bf16 a[68:71], v[68:71], a[212:215], a[68:71]
 v_mov_b32 v141, v149
 v_mfma_f32_16x16x32_bf16 a[68:71], v[64:67], a[196:199], a[68:71]
 v_mfma_f32_16x16x32_bf16 a[72:75], v[64:67], a[200:203], a[72:75]
 ds_read_b64_tr_b16 v[88:89], v59 offset:32768
 buffer_load_dwordx4 v42, s[8:11], s75 offen offset:2048  lds
 v_mfma_f32_16x16x32_bf16 a[72:75], v[68:71], a[216:219], a[72:75]
 ds_read_b64_tr_b16 v[90:91], v59 offset:36864
 v_mfma_f32_16x16x32_bf16 a[76:79], v[68:71], a[220:223], a[76:79]
 v_mov_b32 v142, v150
 v_mfma_f32_16x16x32_bf16 a[76:79], v[64:67], a[204:207], a[76:79]
 s_waitcnt lgkmcnt(6)
 v_mfma_f32_16x16x32_bf16 a[92:95], v[72:75], a[204:207], a[92:95]
 ds_read_b64_tr_b16 v[92:93], v59 offset:40960
 buffer_load_dwordx4 a[164:167], v5, s[20:23], s42 offen offset:2048 sc1
 v_mfma_f32_16x16x32_bf16 a[92:95], v[76:79], a[220:223], a[92:95]
 ds_read_b64_tr_b16 v[94:95], v59 offset:45056
 v_mfma_f32_16x16x32_bf16 a[88:91], v[76:79], a[216:219], a[88:91]
 v_mov_b32 v143, v151
 v_mfma_f32_16x16x32_bf16 a[88:91], v[72:75], a[200:203], a[88:91]
 v_mfma_f32_16x16x32_bf16 a[84:87], v[72:75], a[196:199], a[84:87]
 ds_read_b64_tr_b16 v[64:65], v52 offset:49152
 v_mfma_f32_16x16x32_bf16 a[84:87], v[76:79], a[212:215], a[84:87]
 ds_read_b64_tr_b16 v[66:67], v52 offset:53248
 v_mfma_f32_16x16x32_bf16 a[80:83], v[76:79], a[208:211], a[80:83]
 v_mfma_f32_16x16x32_bf16 a[80:83], v[72:75], a[192:195], a[80:83]
 s_waitcnt lgkmcnt(6)
 v_mfma_f32_16x16x32_bf16 a[96:99], v[80:83], a[192:195], a[96:99]
 ds_read_b64_tr_b16 v[68:69], v52 offset:57344
 buffer_load_dwordx4 a[168:171], v6, s[20:23], s42 offen offset:2048 sc1
 v_mfma_f32_16x16x32_bf16 a[96:99], v[84:87], a[208:211], a[96:99]
 ds_read_b64_tr_b16 v[70:71], v52 offset:61440
 v_mov_b32 v144, v160
 v_mfma_f32_16x16x32_bf16 a[100:103], v[84:87], a[212:215], a[100:103]
 v_xor_b32 v52, s49, v52
 v_mfma_f32_16x16x32_bf16 a[100:103], v[80:83], a[196:199], a[100:103]
 v_mov_b32 v145, v161
 v_mfma_f32_16x16x32_bf16 a[104:107], v[80:83], a[200:203], a[104:107]
 ds_read_b64_tr_b16 v[72:73], v53 offset:49152
 buffer_load_dwordx4 v43, s[8:11], s75 offen offset:3072  lds
 v_mfma_f32_16x16x32_bf16 a[104:107], v[84:87], a[216:219], a[104:107]
 ds_read_b64_tr_b16 v[74:75], v53 offset:53248
 v_mfma_f32_16x16x32_bf16 a[108:111], v[84:87], a[220:223], a[108:111]
 v_mfma_f32_16x16x32_bf16 a[108:111], v[80:83], a[204:207], a[108:111]
 s_waitcnt lgkmcnt(6)
 v_mfma_f32_16x16x32_bf16 a[124:127], v[88:91], a[204:207], a[124:127]
 ds_read_b64_tr_b16 v[76:77], v53 offset:57344
 buffer_load_dwordx4 a[172:175], v7, s[20:23], s42 offen offset:2048 sc1
 v_mfma_f32_16x16x32_bf16 a[124:127], v[92:95], a[220:223], a[124:127]
 ds_read_b64_tr_b16 v[78:79], v53 offset:61440
 v_mov_b32 v146, v162
 v_mfma_f32_16x16x32_bf16 a[120:123], v[92:95], a[216:219], a[120:123]
 v_xor_b32 v53, s49, v53
 v_mfma_f32_16x16x32_bf16 a[120:123], v[88:91], a[200:203], a[120:123]
 v_mfma_f32_16x16x32_bf16 a[116:119], v[88:91], a[196:199], a[116:119]
 ds_read_b64_tr_b16 v[80:81], v54 offset:49152
 v_mov_b32 v147, v163
 v_mfma_f32_16x16x32_bf16 a[116:119], v[92:95], a[212:215], a[116:119]
 ds_read_b64_tr_b16 v[82:83], v54 offset:53248
 v_mfma_f32_16x16x32_bf16 a[112:115], v[92:95], a[208:211], a[112:115]
 v_mfma_f32_16x16x32_bf16 a[112:115], v[88:91], a[192:195], a[112:115]
 s_waitcnt lgkmcnt(6)
 s_waitcnt vmcnt(35)
 v_mfma_f32_16x16x32_bf16 a[0:3], v[64:67], a[224:227], a[0:3]
 ds_read_b64_tr_b16 v[84:85], v54 offset:57344
 buffer_load_dwordx4 a[176:179], v4, s[20:23], s42 offen offset:3072 sc1
 s_waitcnt vmcnt(29)
 v_mfma_f32_16x16x32_bf16 a[0:3], v[68:71], a[240:243], a[0:3]
 ds_read_b64_tr_b16 v[86:87], v54 offset:61440
 s_waitcnt vmcnt(26)
 v_mov_b32 v148, v164
 v_mfma_f32_16x16x32_bf16 a[4:7], v[68:71], a[244:247], a[4:7]
 v_xor_b32 v54, s49, v54
 v_mfma_f32_16x16x32_bf16 a[4:7], v[64:67], a[228:231], a[4:7]
 v_mfma_f32_16x16x32_bf16 a[8:11], v[64:67], a[232:235], a[8:11]
 ds_read_b64_tr_b16 v[88:89], v55 offset:49152
 s_add_u32 m0, s79, 102400
 s_waitcnt vmcnt(25)
 v_mfma_f32_16x16x32_bf16 a[8:11], v[68:71], a[248:251], a[8:11]
 ds_read_b64_tr_b16 v[90:91], v55 offset:53248
 s_waitcnt vmcnt(23)
 v_mov_b32 v149, v165
 v_mfma_f32_16x16x32_bf16 a[12:15], v[68:71], a[252:255], a[12:15]
 buffer_load_dwordx4 v44, s[8:11], s75 offen  lds
 v_mfma_f32_16x16x32_bf16 a[12:15], v[64:67], a[236:239], a[12:15]
 s_waitcnt lgkmcnt(6)
 v_mfma_f32_16x16x32_bf16 a[28:31], v[72:75], a[236:239], a[28:31]
 ds_read_b64_tr_b16 v[92:93], v55 offset:57344
 buffer_load_dwordx4 a[180:183], v5, s[20:23], s42 offen offset:3072 sc1
 v_mfma_f32_16x16x32_bf16 a[28:31], v[76:79], a[252:255], a[28:31]
 ds_read_b64_tr_b16 v[94:95], v55 offset:61440
 v_mfma_f32_16x16x32_bf16 a[24:27], v[76:79], a[248:251], a[24:27]
 v_xor_b32 v55, s49, v55
 v_mov_b32 v150, v166
 v_mfma_f32_16x16x32_bf16 a[24:27], v[72:75], a[232:235], a[24:27]
 v_mfma_f32_16x16x32_bf16 a[20:23], v[72:75], a[228:231], a[20:23]
 ds_read_b64_tr_b16 v[64:65], v56 offset:49152
 v_mfma_f32_16x16x32_bf16 a[20:23], v[76:79], a[244:247], a[20:23]
 ds_read_b64_tr_b16 v[66:67], v56 offset:53248
 v_mfma_f32_16x16x32_bf16 a[16:19], v[76:79], a[240:243], a[16:19]
 v_mov_b32 v151, v167
 v_mfma_f32_16x16x32_bf16 a[16:19], v[72:75], a[224:227], a[16:19]
 s_waitcnt lgkmcnt(6)
 v_mfma_f32_16x16x32_bf16 a[32:35], v[80:83], a[224:227], a[32:35]
 ds_read_b64_tr_b16 v[68:69], v56 offset:57344
 buffer_load_dwordx4 a[184:187], v6, s[20:23], s42 offen offset:3072 sc1
 v_mfma_f32_16x16x32_bf16 a[32:35], v[84:87], a[240:243], a[32:35]
 ds_read_b64_tr_b16 v[70:71], v56 offset:61440
 v_mfma_f32_16x16x32_bf16 a[36:39], v[84:87], a[244:247], a[36:39]
 v_xor_b32 v56, s49, v56
 v_mfma_f32_16x16x32_bf16 a[36:39], v[80:83], a[228:231], a[36:39]
 v_mov_b32 v152, v176
 v_mfma_f32_16x16x32_bf16 a[40:43], v[80:83], a[232:235], a[40:43]
 ds_read_b64_tr_b16 v[72:73], v57 offset:49152
 buffer_load_dwordx4 v45, s[8:11], s75 offen offset:1024  lds
 v_mfma_f32_16x16x32_bf16 a[40:43], v[84:87], a[248:251], a[40:43]
 ds_read_b64_tr_b16 v[74:75], v57 offset:53248
 v_mfma_f32_16x16x32_bf16 a[44:47], v[84:87], a[252:255], a[44:47]
 v_mfma_f32_16x16x32_bf16 a[44:47], v[80:83], a[236:239], a[44:47]
 s_waitcnt lgkmcnt(6)
 v_mfma_f32_16x16x32_bf16 a[60:63], v[88:91], a[236:239], a[60:63]
 ds_read_b64_tr_b16 v[76:77], v57 offset:57344
 buffer_load_dwordx4 a[188:191], v7, s[20:23], s42 offen offset:3072 sc1
 v_mfma_f32_16x16x32_bf16 a[60:63], v[92:95], a[252:255], a[60:63]
 ds_read_b64_tr_b16 v[78:79], v57 offset:61440
 s_add_u32 s42, s42, 4096
 v_mfma_f32_16x16x32_bf16 a[56:59], v[92:95], a[248:251], a[56:59]
 v_xor_b32 v57, s49, v57
 v_mov_b32 v153, v177
 v_mfma_f32_16x16x32_bf16 a[56:59], v[88:91], a[232:235], a[56:59]
 v_mfma_f32_16x16x32_bf16 a[52:55], v[88:91], a[228:231], a[52:55]
 ds_read_b64_tr_b16 v[80:81], v58 offset:49152
 v_mov_b32 v154, v178
 v_mfma_f32_16x16x32_bf16 a[52:55], v[92:95], a[244:247], a[52:55]
 ds_read_b64_tr_b16 v[82:83], v58 offset:53248
 v_mfma_f32_16x16x32_bf16 a[48:51], v[92:95], a[240:243], a[48:51]
 v_mfma_f32_16x16x32_bf16 a[48:51], v[88:91], a[224:227], a[48:51]
 s_waitcnt lgkmcnt(6)
 v_mfma_f32_16x16x32_bf16 a[64:67], v[64:67], a[224:227], a[64:67]
 ds_read_b64_tr_b16 v[84:85], v58 offset:57344
 buffer_load_dwordx4 a[192:195], v4, s[20:23], s42 offen sc1
 v_mfma_f32_16x16x32_bf16 a[64:67], v[68:71], a[240:243], a[64:67]
 ds_read_b64_tr_b16 v[86:87], v58 offset:61440
 v_mov_b32 v155, v179
 v_mfma_f32_16x16x32_bf16 a[68:71], v[68:71], a[244:247], a[68:71]
 v_xor_b32 v58, s49, v58
 v_mfma_f32_16x16x32_bf16 a[68:71], v[64:67], a[228:231], a[68:71]
 v_mfma_f32_16x16x32_bf16 a[72:75], v[64:67], a[232:235], a[72:75]
 ds_read_b64_tr_b16 v[88:89], v59 offset:49152
 buffer_load_dwordx4 v46, s[8:11], s75 offen offset:2048  lds
 v_mfma_f32_16x16x32_bf16 a[72:75], v[68:71], a[248:251], a[72:75]
 ds_read_b64_tr_b16 v[90:91], v59 offset:53248
 v_mov_b32 v156, v180
 v_mfma_f32_16x16x32_bf16 a[76:79], v[68:71], a[252:255], a[76:79]
 v_mfma_f32_16x16x32_bf16 a[76:79], v[64:67], a[236:239], a[76:79]
 s_waitcnt lgkmcnt(6)
 v_mfma_f32_16x16x32_bf16 a[92:95], v[72:75], a[236:239], a[92:95]
 ds_read_b64_tr_b16 v[92:93], v59 offset:57344
 buffer_load_dwordx4 a[196:199], v5, s[20:23], s42 offen sc1
 v_mfma_f32_16x16x32_bf16 a[92:95], v[76:79], a[252:255], a[92:95]
 ds_read_b64_tr_b16 v[94:95], v59 offset:61440
 v_mov_b32 v157, v181
 v_mfma_f32_16x16x32_bf16 a[88:91], v[76:79], a[248:251], a[88:91]
 v_xor_b32 v59, s49, v59
 v_mfma_f32_16x16x32_bf16 a[88:91], v[72:75], a[232:235], a[88:91]
 s_waitcnt vmcnt(24)
 s_barrier
 v_mfma_f32_16x16x32_bf16 a[84:87], v[72:75], a[228:231], a[84:87]
 ds_read_b64_tr_b16 v[64:65], v52
 v_mfma_f32_16x16x32_bf16 a[84:87], v[76:79], a[244:247], a[84:87]
 ds_read_b64_tr_b16 v[66:67], v52 offset:4096
 v_mfma_f32_16x16x32_bf16 a[80:83], v[76:79], a[240:243], a[80:83]
 v_mov_b32 v158, v182
 v_mfma_f32_16x16x32_bf16 a[80:83], v[72:75], a[224:227], a[80:83]
 s_waitcnt lgkmcnt(6)
 v_mfma_f32_16x16x32_bf16 a[96:99], v[80:83], a[224:227], a[96:99]
 ds_read_b64_tr_b16 v[68:69], v52 offset:8192
 buffer_load_dwordx4 a[200:203], v6, s[20:23], s42 offen sc1
 v_mfma_f32_16x16x32_bf16 a[96:99], v[84:87], a[240:243], a[96:99]
 ds_read_b64_tr_b16 v[70:71], v52 offset:12288
 v_mfma_f32_16x16x32_bf16 a[100:103], v[84:87], a[244:247], a[100:103]
 v_mov_b32 v159, v183
 v_mfma_f32_16x16x32_bf16 a[100:103], v[80:83], a[228:231], a[100:103]
 v_mfma_f32_16x16x32_bf16 a[104:107], v[80:83], a[232:235], a[104:107]
 ds_read_b64_tr_b16 v[72:73], v53
 buffer_load_dwordx4 v47, s[8:11], s75 offen offset:3072  lds
 v_mfma_f32_16x16x32_bf16 a[104:107], v[84:87], a[248:251], a[104:107]
 ds_read_b64_tr_b16 v[74:75], v53 offset:4096
 s_add_u32 s75, s75, 262144
 v_mfma_f32_16x16x32_bf16 a[108:111], v[84:87], a[252:255], a[108:111]
 v_mfma_f32_16x16x32_bf16 a[108:111], v[80:83], a[236:239], a[108:111]
 s_waitcnt lgkmcnt(6)
 v_mfma_f32_16x16x32_bf16 a[124:127], v[88:91], a[236:239], a[124:127]
 ds_read_b64_tr_b16 v[76:77], v53 offset:8192
 buffer_load_dwordx4 a[204:207], v7, s[20:23], s42 offen sc1
 v_mfma_f32_16x16x32_bf16 a[124:127], v[92:95], a[252:255], a[124:127]
 ds_read_b64_tr_b16 v[78:79], v53 offset:12288
 buffer_load_dword v61, v0, s[16:19], 0 offen
 v_mfma_f32_16x16x32_bf16 a[120:123], v[92:95], a[248:251], a[120:123]
 v_mfma_f32_16x16x32_bf16 a[120:123], v[88:91], a[232:235], a[120:123]
 v_mfma_f32_16x16x32_bf16 a[116:119], v[88:91], a[228:231], a[116:119]
 ds_read_b64_tr_b16 v[80:81], v54
 v_mfma_f32_16x16x32_bf16 a[116:119], v[92:95], a[244:247], a[116:119]
 ds_read_b64_tr_b16 v[82:83], v54 offset:4096
 v_mfma_f32_16x16x32_bf16 a[112:115], v[92:95], a[240:243], a[112:115]
 v_mfma_f32_16x16x32_bf16 a[112:115], v[88:91], a[224:227], a[112:115]
 s_waitcnt lgkmcnt(6)
 v_mfma_f32_16x16x32_bf16 a[0:3], v[64:67], a[128:131], a[0:3]
 ds_read_b64_tr_b16 v[84:85], v54 offset:8192
 buffer_load_dwordx4 a[208:211], v4, s[20:23], s42 offen offset:1024 sc1
 s_waitcnt vmcnt(26)
 v_mfma_f32_16x16x32_bf16 a[0:3], v[68:71], a[144:147], a[0:3]
 ds_read_b64_tr_b16 v[86:87], v54 offset:12288
 s_waitcnt vmcnt(24)
 v_mfma_f32_16x16x32_bf16 a[4:7], v[68:71], a[148:151], a[4:7]
 v_mfma_f32_16x16x32_bf16 a[4:7], v[64:67], a[132:135], a[4:7]
 v_mfma_f32_16x16x32_bf16 a[8:11], v[64:67], a[136:139], a[8:11]
 ds_read_b64_tr_b16 v[88:89], v55
 s_add_u32 m0, s79, 0
 s_waitcnt vmcnt(22)
 v_mfma_f32_16x16x32_bf16 a[8:11], v[68:71], a[152:155], a[8:11]
 ds_read_b64_tr_b16 v[90:91], v55 offset:4096
 s_waitcnt vmcnt(20)
 v_mfma_f32_16x16x32_bf16 a[12:15], v[68:71], a[156:159], a[12:15]
 buffer_load_dwordx4 v40, s[8:11], s75 offen  lds
 v_mfma_f32_16x16x32_bf16 a[12:15], v[64:67], a[140:143], a[12:15]
 s_waitcnt lgkmcnt(6)
 v_mfma_f32_16x16x32_bf16 a[28:31], v[72:75], a[140:143], a[28:31]
 ds_read_b64_tr_b16 v[92:93], v55 offset:8192
 buffer_load_dwordx4 a[212:215], v5, s[20:23], s42 offen offset:1024 sc1
 v_mfma_f32_16x16x32_bf16 a[28:31], v[76:79], a[156:159], a[28:31]
 ds_read_b64_tr_b16 v[94:95], v55 offset:12288
 v_mfma_f32_16x16x32_bf16 a[24:27], v[76:79], a[152:155], a[24:27]
 v_mfma_f32_16x16x32_bf16 a[24:27], v[72:75], a[136:139], a[24:27]
 v_mfma_f32_16x16x32_bf16 a[20:23], v[72:75], a[132:135], a[20:23]
 ds_read_b64_tr_b16 v[64:65], v56
 v_mfma_f32_16x16x32_bf16 a[20:23], v[76:79], a[148:151], a[20:23]
 ds_read_b64_tr_b16 v[66:67], v56 offset:4096
 v_mfma_f32_16x16x32_bf16 a[16:19], v[76:79], a[144:147], a[16:19]
 v_mfma_f32_16x16x32_bf16 a[16:19], v[72:75], a[128:131], a[16:19]
 s_waitcnt lgkmcnt(6)
 v_mfma_f32_16x16x32_bf16 a[32:35], v[80:83], a[128:131], a[32:35]
 ds_read_b64_tr_b16 v[68:69], v56 offset:8192
 buffer_load_dwordx4 a[216:219], v6, s[20:23], s42 offen offset:1024 sc1
 v_mfma_f32_16x16x32_bf16 a[32:35], v[84:87], a[144:147], a[32:35]
 ds_read_b64_tr_b16 v[70:71], v56 offset:12288
 v_mfma_f32_16x16x32_bf16 a[36:39], v[84:87], a[148:151], a[36:39]
 v_mfma_f32_16x16x32_bf16 a[36:39], v[80:83], a[132:135], a[36:39]
 v_mfma_f32_16x16x32_bf16 a[40:43], v[80:83], a[136:139], a[40:43]
 ds_read_b64_tr_b16 v[72:73], v57
 buffer_load_dwordx4 v41, s[8:11], s75 offen offset:1024  lds
 v_mfma_f32_16x16x32_bf16 a[40:43], v[84:87], a[152:155], a[40:43]
 ds_read_b64_tr_b16 v[74:75], v57 offset:4096
 v_mfma_f32_16x16x32_bf16 a[44:47], v[84:87], a[156:159], a[44:47]
 v_mfma_f32_16x16x32_bf16 a[44:47], v[80:83], a[140:143], a[44:47]
 s_waitcnt lgkmcnt(6)
 v_mfma_f32_16x16x32_bf16 a[60:63], v[88:91], a[140:143], a[60:63]
 ds_read_b64_tr_b16 v[76:77], v57 offset:8192
 buffer_load_dwordx4 a[220:223], v7, s[20:23], s42 offen offset:1024 sc1
 v_mfma_f32_16x16x32_bf16 a[60:63], v[92:95], a[156:159], a[60:63]
 ds_read_b64_tr_b16 v[78:79], v57 offset:12288
 v_mfma_f32_16x16x32_bf16 a[56:59], v[92:95], a[152:155], a[56:59]
 v_mfma_f32_16x16x32_bf16 a[56:59], v[88:91], a[136:139], a[56:59]
 v_mfma_f32_16x16x32_bf16 a[52:55], v[88:91], a[132:135], a[52:55]
 ds_read_b64_tr_b16 v[80:81], v58
 v_mfma_f32_16x16x32_bf16 a[52:55], v[92:95], a[148:151], a[52:55]
 ds_read_b64_tr_b16 v[82:83], v58 offset:4096
 v_mfma_f32_16x16x32_bf16 a[48:51], v[92:95], a[144:147], a[48:51]
 v_mfma_f32_16x16x32_bf16 a[48:51], v[88:91], a[128:131], a[48:51]
 s_waitcnt lgkmcnt(6)
 v_mfma_f32_16x16x32_bf16 a[64:67], v[64:67], a[128:131], a[64:67]
 ds_read_b64_tr_b16 v[84:85], v58 offset:8192
 buffer_load_dwordx4 a[224:227], v4, s[20:23], s42 offen offset:2048 sc1
 v_mfma_f32_16x16x32_bf16 a[64:67], v[68:71], a[144:147], a[64:67]
 ds_read_b64_tr_b16 v[86:87], v58 offset:12288
 v_mfma_f32_16x16x32_bf16 a[68:71], v[68:71], a[148:151], a[68:71]
 v_mfma_f32_16x16x32_bf16 a[68:71], v[64:67], a[132:135], a[68:71]
 v_mfma_f32_16x16x32_bf16 a[72:75], v[64:67], a[136:139], a[72:75]
 ds_read_b64_tr_b16 v[88:89], v59
 buffer_load_dwordx4 v42, s[8:11], s75 offen offset:2048  lds
 v_mfma_f32_16x16x32_bf16 a[72:75], v[68:71], a[152:155], a[72:75]
 ds_read_b64_tr_b16 v[90:91], v59 offset:4096
 v_mfma_f32_16x16x32_bf16 a[76:79], v[68:71], a[156:159], a[76:79]
 v_mfma_f32_16x16x32_bf16 a[76:79], v[64:67], a[140:143], a[76:79]
 s_waitcnt lgkmcnt(6)
 v_mfma_f32_16x16x32_bf16 a[92:95], v[72:75], a[140:143], a[92:95]
 ds_read_b64_tr_b16 v[92:93], v59 offset:8192
 buffer_load_dwordx4 a[228:231], v5, s[20:23], s42 offen offset:2048 sc1
 v_mfma_f32_16x16x32_bf16 a[92:95], v[76:79], a[156:159], a[92:95]
 ds_read_b64_tr_b16 v[94:95], v59 offset:12288
 v_mfma_f32_16x16x32_bf16 a[88:91], v[76:79], a[152:155], a[88:91]
 v_mfma_f32_16x16x32_bf16 a[88:91], v[72:75], a[136:139], a[88:91]
 v_mfma_f32_16x16x32_bf16 a[84:87], v[72:75], a[132:135], a[84:87]
 ds_read_b64_tr_b16 v[64:65], v52 offset:16384
 v_mfma_f32_16x16x32_bf16 a[84:87], v[76:79], a[148:151], a[84:87]
 ds_read_b64_tr_b16 v[66:67], v52 offset:20480
 v_mfma_f32_16x16x32_bf16 a[80:83], v[76:79], a[144:147], a[80:83]
 v_mfma_f32_16x16x32_bf16 a[80:83], v[72:75], a[128:131], a[80:83]
 s_waitcnt lgkmcnt(6)
 v_mfma_f32_16x16x32_bf16 a[96:99], v[80:83], a[128:131], a[96:99]
 ds_read_b64_tr_b16 v[68:69], v52 offset:24576
 buffer_load_dwordx4 a[232:235], v6, s[20:23], s42 offen offset:2048 sc1
 v_mfma_f32_16x16x32_bf16 a[96:99], v[84:87], a[144:147], a[96:99]
 ds_read_b64_tr_b16 v[70:71], v52 offset:28672
 v_mfma_f32_16x16x32_bf16 a[100:103], v[84:87], a[148:151], a[100:103]
 v_mfma_f32_16x16x32_bf16 a[100:103], v[80:83], a[132:135], a[100:103]
 v_mfma_f32_16x16x32_bf16 a[104:107], v[80:83], a[136:139], a[104:107]
 ds_read_b64_tr_b16 v[72:73], v53 offset:16384
 buffer_load_dwordx4 v43, s[8:11], s75 offen offset:3072  lds
 v_mfma_f32_16x16x32_bf16 a[104:107], v[84:87], a[152:155], a[104:107]
 ds_read_b64_tr_b16 v[74:75], v53 offset:20480
 v_mfma_f32_16x16x32_bf16 a[108:111], v[84:87], a[156:159], a[108:111]
 v_mfma_f32_16x16x32_bf16 a[108:111], v[80:83], a[140:143], a[108:111]
 s_waitcnt lgkmcnt(6)
 v_mfma_f32_16x16x32_bf16 a[124:127], v[88:91], a[140:143], a[124:127]
 ds_read_b64_tr_b16 v[76:77], v53 offset:24576
 buffer_load_dwordx4 a[236:239], v7, s[20:23], s42 offen offset:2048 sc1
 v_mfma_f32_16x16x32_bf16 a[124:127], v[92:95], a[156:159], a[124:127]
 ds_read_b64_tr_b16 v[78:79], v53 offset:28672
 v_mfma_f32_16x16x32_bf16 a[120:123], v[92:95], a[152:155], a[120:123]
 v_mfma_f32_16x16x32_bf16 a[120:123], v[88:91], a[136:139], a[120:123]
 v_mfma_f32_16x16x32_bf16 a[116:119], v[88:91], a[132:135], a[116:119]
 ds_read_b64_tr_b16 v[80:81], v54 offset:16384
 v_mfma_f32_16x16x32_bf16 a[116:119], v[92:95], a[148:151], a[116:119]
 ds_read_b64_tr_b16 v[82:83], v54 offset:20480
 v_mfma_f32_16x16x32_bf16 a[112:115], v[92:95], a[144:147], a[112:115]
 v_mfma_f32_16x16x32_bf16 a[112:115], v[88:91], a[128:131], a[112:115]
 s_waitcnt lgkmcnt(6)
 s_waitcnt vmcnt(30)
 v_mfma_f32_16x16x32_bf16 a[0:3], v[64:67], a[160:163], a[0:3]
 ds_read_b64_tr_b16 v[84:85], v54 offset:24576
 buffer_load_dwordx4 a[240:243], v4, s[20:23], s42 offen offset:3072 sc1
 s_waitcnt vmcnt(25)
 v_mfma_f32_16x16x32_bf16 a[0:3], v[68:71], a[176:179], a[0:3]
 ds_read_b64_tr_b16 v[86:87], v54 offset:28672
 s_waitcnt vmcnt(23)
 v_mfma_f32_16x16x32_bf16 a[4:7], v[68:71], a[180:183], a[4:7]
 v_mfma_f32_16x16x32_bf16 a[4:7], v[64:67], a[164:167], a[4:7]
 v_mfma_f32_16x16x32_bf16 a[8:11], v[64:67], a[168:171], a[8:11]
 ds_read_b64_tr_b16 v[88:89], v55 offset:16384
 s_add_u32 m0, s79, 4096
 s_waitcnt vmcnt(22)
 v_mfma_f32_16x16x32_bf16 a[8:11], v[68:71], a[184:187], a[8:11]
 ds_read_b64_tr_b16 v[90:91], v55 offset:20480
 s_waitcnt vmcnt(20)
 v_mfma_f32_16x16x32_bf16 a[12:15], v[68:71], a[188:191], a[12:15]
 buffer_load_dwordx4 v44, s[8:11], s75 offen  lds
 v_mfma_f32_16x16x32_bf16 a[12:15], v[64:67], a[172:175], a[12:15]
 s_waitcnt lgkmcnt(6)
 v_mfma_f32_16x16x32_bf16 a[28:31], v[72:75], a[172:175], a[28:31]
 ds_read_b64_tr_b16 v[92:93], v55 offset:24576
 buffer_load_dwordx4 a[244:247], v5, s[20:23], s42 offen offset:3072 sc1
 v_mfma_f32_16x16x32_bf16 a[28:31], v[76:79], a[188:191], a[28:31]
 ds_read_b64_tr_b16 v[94:95], v55 offset:28672
 v_mfma_f32_16x16x32_bf16 a[24:27], v[76:79], a[184:187], a[24:27]
 v_mfma_f32_16x16x32_bf16 a[24:27], v[72:75], a[168:171], a[24:27]
 v_mfma_f32_16x16x32_bf16 a[20:23], v[72:75], a[164:167], a[20:23]
 ds_read_b64_tr_b16 v[64:65], v56 offset:16384
 v_mfma_f32_16x16x32_bf16 a[20:23], v[76:79], a[180:183], a[20:23]
 ds_read_b64_tr_b16 v[66:67], v56 offset:20480
 v_mfma_f32_16x16x32_bf16 a[16:19], v[76:79], a[176:179], a[16:19]
 v_mfma_f32_16x16x32_bf16 a[16:19], v[72:75], a[160:163], a[16:19]
 s_waitcnt lgkmcnt(6)
 v_mfma_f32_16x16x32_bf16 a[32:35], v[80:83], a[160:163], a[32:35]
 ds_read_b64_tr_b16 v[68:69], v56 offset:24576
 buffer_load_dwordx4 a[248:251], v6, s[20:23], s42 offen offset:3072 sc1
 v_mfma_f32_16x16x32_bf16 a[32:35], v[84:87], a[176:179], a[32:35]
 ds_read_b64_tr_b16 v[70:71], v56 offset:28672
 v_mfma_f32_16x16x32_bf16 a[36:39], v[84:87], a[180:183], a[36:39]
 v_mfma_f32_16x16x32_bf16 a[36:39], v[80:83], a[164:167], a[36:39]
 v_mfma_f32_16x16x32_bf16 a[40:43], v[80:83], a[168:171], a[40:43]
 ds_read_b64_tr_b16 v[72:73], v57 offset:16384
 buffer_load_dwordx4 v45, s[8:11], s75 offen offset:1024  lds
 v_mfma_f32_16x16x32_bf16 a[40:43], v[84:87], a[184:187], a[40:43]
 ds_read_b64_tr_b16 v[74:75], v57 offset:20480
 v_mfma_f32_16x16x32_bf16 a[44:47], v[84:87], a[188:191], a[44:47]
 v_mfma_f32_16x16x32_bf16 a[44:47], v[80:83], a[172:175], a[44:47]
 s_waitcnt lgkmcnt(6)
 v_mfma_f32_16x16x32_bf16 a[60:63], v[88:91], a[172:175], a[60:63]
 ds_read_b64_tr_b16 v[76:77], v57 offset:24576
 buffer_load_dwordx4 a[252:255], v7, s[20:23], s42 offen offset:3072 sc1
 v_mfma_f32_16x16x32_bf16 a[60:63], v[92:95], a[188:191], a[60:63]
 ds_read_b64_tr_b16 v[78:79], v57 offset:28672
 s_add_u32 s42, s42, 4096
 v_mfma_f32_16x16x32_bf16 a[56:59], v[92:95], a[184:187], a[56:59]
 v_mfma_f32_16x16x32_bf16 a[56:59], v[88:91], a[168:171], a[56:59]
 v_mfma_f32_16x16x32_bf16 a[52:55], v[88:91], a[164:167], a[52:55]
 ds_read_b64_tr_b16 v[80:81], v58 offset:16384
 v_mfma_f32_16x16x32_bf16 a[52:55], v[92:95], a[180:183], a[52:55]
 ds_read_b64_tr_b16 v[82:83], v58 offset:20480
 v_mfma_f32_16x16x32_bf16 a[48:51], v[92:95], a[176:179], a[48:51]
 v_mfma_f32_16x16x32_bf16 a[48:51], v[88:91], a[160:163], a[48:51]
 s_waitcnt lgkmcnt(6)
 v_mfma_f32_16x16x32_bf16 a[64:67], v[64:67], a[160:163], a[64:67]
 ds_read_b64_tr_b16 v[84:85], v58 offset:24576
 buffer_load_dwordx4 a[128:131], v4, s[20:23], s42 offen sc1
 v_mfma_f32_16x16x32_bf16 a[64:67], v[68:71], a[176:179], a[64:67]
 ds_read_b64_tr_b16 v[86:87], v58 offset:28672
 v_mfma_f32_16x16x32_bf16 a[68:71], v[68:71], a[180:183], a[68:71]
 v_mfma_f32_16x16x32_bf16 a[68:71], v[64:67], a[164:167], a[68:71]
 v_mfma_f32_16x16x32_bf16 a[72:75], v[64:67], a[168:171], a[72:75]
 ds_read_b64_tr_b16 v[88:89], v59 offset:16384
 buffer_load_dwordx4 v46, s[8:11], s75 offen offset:2048  lds
 v_mfma_f32_16x16x32_bf16 a[72:75], v[68:71], a[184:187], a[72:75]
 ds_read_b64_tr_b16 v[90:91], v59 offset:20480
 v_mfma_f32_16x16x32_bf16 a[76:79], v[68:71], a[188:191], a[76:79]
 v_mfma_f32_16x16x32_bf16 a[76:79], v[64:67], a[172:175], a[76:79]
 s_waitcnt lgkmcnt(6)
 v_mfma_f32_16x16x32_bf16 a[92:95], v[72:75], a[172:175], a[92:95]
 ds_read_b64_tr_b16 v[92:93], v59 offset:24576
 buffer_load_dwordx4 a[132:135], v5, s[20:23], s42 offen sc1
 v_mfma_f32_16x16x32_bf16 a[92:95], v[76:79], a[188:191], a[92:95]
 ds_read_b64_tr_b16 v[94:95], v59 offset:28672
 v_mfma_f32_16x16x32_bf16 a[88:91], v[76:79], a[184:187], a[88:91]
 v_mfma_f32_16x16x32_bf16 a[88:91], v[72:75], a[168:171], a[88:91]
 s_waitcnt vmcnt(23)
 s_barrier
 v_mfma_f32_16x16x32_bf16 a[84:87], v[72:75], a[164:167], a[84:87]
 ds_read_b64_tr_b16 v[64:65], v52 offset:32768
 v_mfma_f32_16x16x32_bf16 a[84:87], v[76:79], a[180:183], a[84:87]
 ds_read_b64_tr_b16 v[66:67], v52 offset:36864
 v_mfma_f32_16x16x32_bf16 a[80:83], v[76:79], a[176:179], a[80:83]
 s_cmp_eq_u32 s36, 1
 s_cbranch_scc0 C_df_77
 buffer_store_dwordx2 v[2:3], v21, s[56:59], 0 offen sc1
C_df_77:
 v_mfma_f32_16x16x32_bf16 a[80:83], v[72:75], a[160:163], a[80:83]
 s_waitcnt lgkmcnt(6)
 v_mfma_f32_16x16x32_bf16 a[96:99], v[80:83], a[160:163], a[96:99]
 ds_read_b64_tr_b16 v[68:69], v52 offset:40960
 buffer_load_dwordx4 a[136:139], v6, s[20:23], s42 offen sc1
 v_mfma_f32_16x16x32_bf16 a[96:99], v[84:87], a[176:179], a[96:99]
 ds_read_b64_tr_b16 v[70:71], v52 offset:45056
 v_mfma_f32_16x16x32_bf16 a[100:103], v[84:87], a[180:183], a[100:103]
 v_mfma_f32_16x16x32_bf16 a[100:103], v[80:83], a[164:167], a[100:103]
 v_mfma_f32_16x16x32_bf16 a[104:107], v[80:83], a[168:171], a[104:107]
 ds_read_b64_tr_b16 v[72:73], v53 offset:32768
 buffer_load_dwordx4 v47, s[8:11], s75 offen offset:3072  lds
 v_mfma_f32_16x16x32_bf16 a[104:107], v[84:87], a[184:187], a[104:107]
 ds_read_b64_tr_b16 v[74:75], v53 offset:36864
 s_add_u32 s75, s75, 262144
 v_mfma_f32_16x16x32_bf16 a[108:111], v[84:87], a[188:191], a[108:111]
 v_mfma_f32_16x16x32_bf16 a[108:111], v[80:83], a[172:175], a[108:111]
 s_waitcnt lgkmcnt(6)
 v_mfma_f32_16x16x32_bf16 a[124:127], v[88:91], a[172:175], a[124:127]
 ds_read_b64_tr_b16 v[76:77], v53 offset:40960
 buffer_load_dwordx4 a[140:143], v7, s[20:23], s42 offen sc1
 v_mfma_f32_16x16x32_bf16 a[124:127], v[92:95], a[188:191], a[124:127]
 ds_read_b64_tr_b16 v[78:79], v53 offset:45056
 buffer_load_dword v61, v0, s[16:19], 0 offen
 v_mfma_f32_16x16x32_bf16 a[120:123], v[92:95], a[184:187], a[120:123]
 v_mfma_f32_16x16x32_bf16 a[120:123], v[88:91], a[168:171], a[120:123]
 v_mfma_f32_16x16x32_bf16 a[116:119], v[88:91], a[164:167], a[116:119]
 ds_read_b64_tr_b16 v[80:81], v54 offset:32768
 v_mfma_f32_16x16x32_bf16 a[116:119], v[92:95], a[180:183], a[116:119]
 ds_read_b64_tr_b16 v[82:83], v54 offset:36864
 v_mfma_f32_16x16x32_bf16 a[112:115], v[92:95], a[176:179], a[112:115]
 v_mfma_f32_16x16x32_bf16 a[112:115], v[88:91], a[160:163], a[112:115]
 s_waitcnt lgkmcnt(6)
 v_mfma_f32_16x16x32_bf16 a[0:3], v[64:67], a[192:195], a[0:3]
 ds_read_b64_tr_b16 v[84:85], v54 offset:40960
 buffer_load_dwordx4 a[144:147], v4, s[20:23], s42 offen offset:1024 sc1
 s_mov_b32 s54, 12582912
 s_waitcnt vmcnt(25)
 v_mfma_f32_16x16x32_bf16 a[0:3], v[68:71], a[208:211], a[0:3]
 ds_read_b64_tr_b16 v[86:87], v54 offset:45056
 s_waitcnt vmcnt(23)
 v_mfma_f32_16x16x32_bf16 a[4:7], v[68:71], a[212:215], a[4:7]
 v_mfma_f32_16x16x32_bf16 a[4:7], v[64:67], a[196:199], a[4:7]
 v_mfma_f32_16x16x32_bf16 a[8:11], v[64:67], a[200:203], a[8:11]
 ds_read_b64_tr_b16 v[88:89], v55 offset:32768
 s_add_u32 m0, s79, 32768
 s_waitcnt vmcnt(22)
 v_mfma_f32_16x16x32_bf16 a[8:11], v[68:71], a[216:219], a[8:11]
 ds_read_b64_tr_b16 v[90:91], v55 offset:36864
 s_waitcnt vmcnt(20)
 v_mfma_f32_16x16x32_bf16 a[12:15], v[68:71], a[220:223], a[12:15]
 buffer_load_dwordx4 v40, s[8:11], s75 offen  lds
 v_mfma_f32_16x16x32_bf16 a[12:15], v[64:67], a[204:207], a[12:15]
 s_waitcnt lgkmcnt(6)
 buffer_load_dwordx4 a[148:151], v5, s[20:23], s42 offen offset:1024 sc1
 v_mfma_f32_16x16x32_bf16 a[28:31], v[72:75], a[204:207], a[28:31]
 ds_read_b64_tr_b16 v[92:93], v55 offset:40960
 v_mfma_f32_16x16x32_bf16 a[28:31], v[76:79], a[220:223], a[28:31]
 ds_read_b64_tr_b16 v[94:95], v55 offset:45056
 v_mfma_f32_16x16x32_bf16 a[24:27], v[76:79], a[216:219], a[24:27]
 v_mfma_f32_16x16x32_bf16 a[24:27], v[72:75], a[200:203], a[24:27]
 v_mfma_f32_16x16x32_bf16 a[20:23], v[72:75], a[196:199], a[20:23]
 ds_read_b64_tr_b16 v[64:65], v56 offset:32768
 buffer_load_dwordx4 v41, s[8:11], s75 offen offset:1024  lds
 v_mfma_f32_16x16x32_bf16 a[20:23], v[76:79], a[212:215], a[20:23]
 ds_read_b64_tr_b16 v[66:67], v56 offset:36864
 v_mfma_f32_16x16x32_bf16 a[16:19], v[76:79], a[208:211], a[16:19]
 buffer_load_dwordx4 a[152:155], v6, s[20:23], s42 offen offset:1024 sc1
 v_mfma_f32_16x16x32_bf16 a[16:19], v[72:75], a[192:195], a[16:19]
 s_waitcnt lgkmcnt(6)
 v_mfma_f32_16x16x32_bf16 a[32:35], v[80:83], a[192:195], a[32:35]
 ds_read_b64_tr_b16 v[68:69], v56 offset:40960
 v_mfma_f32_16x16x32_bf16 a[32:35], v[84:87], a[208:211], a[32:35]
 ds_read_b64_tr_b16 v[70:71], v56 offset:45056
 v_mfma_f32_16x16x32_bf16 a[36:39], v[84:87], a[212:215], a[36:39]
 v_mfma_f32_16x16x32_bf16 a[36:39], v[80:83], a[196:199], a[36:39]
 v_mfma_f32_16x16x32_bf16 a[40:43], v[80:83], a[200:203], a[40:43]
 ds_read_b64_tr_b16 v[72:73], v57 offset:32768
 buffer_load_dwordx4 v42, s[8:11], s75 offen offset:2048  lds
 v_mfma_f32_16x16x32_bf16 a[40:43], v[84:87], a[216:219], a[40:43]
 ds_read_b64_tr_b16 v[74:75], v57 offset:36864
 buffer_load_dwordx4 a[156:159], v7, s[20:23], s42 offen offset:1024 sc1
 v_mfma_f32_16x16x32_bf16 a[44:47], v[84:87], a[220:223], a[44:47]
 v_mfma_f32_16x16x32_bf16 a[44:47], v[80:83], a[204:207], a[44:47]
 s_waitcnt lgkmcnt(6)
 v_mfma_f32_16x16x32_bf16 a[60:63], v[88:91], a[204:207], a[60:63]
 ds_read_b64_tr_b16 v[76:77], v57 offset:40960
 v_mfma_f32_16x16x32_bf16 a[60:63], v[92:95], a[220:223], a[60:63]
 ds_read_b64_tr_b16 v[78:79], v57 offset:45056
 v_mfma_f32_16x16x32_bf16 a[56:59], v[92:95], a[216:219], a[56:59]
 v_mfma_f32_16x16x32_bf16 a[56:59], v[88:91], a[200:203], a[56:59]
 v_mfma_f32_16x16x32_bf16 a[52:55], v[88:91], a[196:199], a[52:55]
 ds_read_b64_tr_b16 v[80:81], v58 offset:32768
 buffer_load_dwordx4 v43, s[8:11], s75 offen offset:3072  lds
 v_mfma_f32_16x16x32_bf16 a[52:55], v[92:95], a[212:215], a[52:55]
 ds_read_b64_tr_b16 v[82:83], v58 offset:36864
 buffer_load_dwordx4 a[160:163], v4, s[20:23], s42 offen offset:2048 sc1
 v_mfma_f32_16x16x32_bf16 a[48:51], v[92:95], a[208:211], a[48:51]
 v_mfma_f32_16x16x32_bf16 a[48:51], v[88:91], a[192:195], a[48:51]
 s_waitcnt lgkmcnt(6)
 v_mfma_f32_16x16x32_bf16 a[64:67], v[64:67], a[192:195], a[64:67]
 ds_read_b64_tr_b16 v[84:85], v58 offset:40960
 v_mfma_f32_16x16x32_bf16 a[64:67], v[68:71], a[208:211], a[64:67]
 ds_read_b64_tr_b16 v[86:87], v58 offset:45056
 buffer_load_dwordx4 a[164:167], v5, s[20:23], s42 offen offset:2048 sc1
 v_mfma_f32_16x16x32_bf16 a[68:71], v[68:71], a[212:215], a[68:71]
 v_mfma_f32_16x16x32_bf16 a[68:71], v[64:67], a[196:199], a[68:71]
 v_mfma_f32_16x16x32_bf16 a[72:75], v[64:67], a[200:203], a[72:75]
 ds_read_b64_tr_b16 v[88:89], v59 offset:32768
 s_add_u32 m0, s79, 36864
 v_mfma_f32_16x16x32_bf16 a[72:75], v[68:71], a[216:219], a[72:75]
 ds_read_b64_tr_b16 v[90:91], v59 offset:36864
 v_mfma_f32_16x16x32_bf16 a[76:79], v[68:71], a[220:223], a[76:79]
 buffer_load_dwordx4 v44, s[8:11], s75 offen  lds
 buffer_load_dwordx4 a[168:171], v6, s[20:23], s42 offen offset:2048 sc1
 v_mfma_f32_16x16x32_bf16 a[76:79], v[64:67], a[204:207], a[76:79]
 s_waitcnt lgkmcnt(6)
 v_mfma_f32_16x16x32_bf16 a[92:95], v[72:75], a[204:207], a[92:95]
 ds_read_b64_tr_b16 v[92:93], v59 offset:40960
 v_mfma_f32_16x16x32_bf16 a[92:95], v[76:79], a[220:223], a[92:95]
 ds_read_b64_tr_b16 v[94:95], v59 offset:45056
 v_mfma_f32_16x16x32_bf16 a[88:91], v[76:79], a[216:219], a[88:91]
 v_mfma_f32_16x16x32_bf16 a[88:91], v[72:75], a[200:203], a[88:91]
 buffer_load_dwordx4 a[172:175], v7, s[20:23], s42 offen offset:2048 sc1
 v_mfma_f32_16x16x32_bf16 a[84:87], v[72:75], a[196:199], a[84:87]
 ds_read_b64_tr_b16 v[64:65], v52 offset:49152
 buffer_load_dwordx4 v45, s[8:11], s75 offen offset:1024  lds
 buffer_load_dwordx2 v[62:63], v23, s[56:59], 0 offen sc1
 v_mfma_f32_16x16x32_bf16 a[84:87], v[76:79], a[212:215], a[84:87]
 ds_read_b64_tr_b16 v[66:67], v52 offset:53248
 v_mfma_f32_16x16x32_bf16 a[80:83], v[76:79], a[208:211], a[80:83]
 v_mfma_f32_16x16x32_bf16 a[80:83], v[72:75], a[192:195], a[80:83]
 s_waitcnt lgkmcnt(6)
 v_mfma_f32_16x16x32_bf16 a[96:99], v[80:83], a[192:195], a[96:99]
 ds_read_b64_tr_b16 v[68:69], v52 offset:57344
 buffer_load_dwordx4 a[176:179], v4, s[20:23], s42 offen offset:3072 sc1
 v_mfma_f32_16x16x32_bf16 a[96:99], v[84:87], a[208:211], a[96:99]
 ds_read_b64_tr_b16 v[70:71], v52 offset:61440
 v_mfma_f32_16x16x32_bf16 a[100:103], v[84:87], a[212:215], a[100:103]
 v_xor_b32 v52, s49, v52
 v_mfma_f32_16x16x32_bf16 a[100:103], v[80:83], a[196:199], a[100:103]
 v_mfma_f32_16x16x32_bf16 a[104:107], v[80:83], a[200:203], a[104:107]
 ds_read_b64_tr_b16 v[72:73], v53 offset:49152
 buffer_load_dwordx4 v46, s[8:11], s75 offen offset:2048  lds
 v_mfma_f32_16x16x32_bf16 a[104:107], v[84:87], a[216:219], a[104:107]
 ds_read_b64_tr_b16 v[74:75], v53 offset:53248
 buffer_load_dwordx4 a[180:183], v5, s[20:23], s42 offen offset:3072 sc1
 v_mfma_f32_16x16x32_bf16 a[108:111], v[84:87], a[220:223], a[108:111]
 v_mfma_f32_16x16x32_bf16 a[108:111], v[80:83], a[204:207], a[108:111]
 s_waitcnt lgkmcnt(6)
 v_mfma_f32_16x16x32_bf16 a[124:127], v[88:91], a[204:207], a[124:127]
 ds_read_b64_tr_b16 v[76:77], v53 offset:57344
 v_mfma_f32_16x16x32_bf16 a[124:127], v[92:95], a[220:223], a[124:127]
 ds_read_b64_tr_b16 v[78:79], v53 offset:61440
 v_mfma_f32_16x16x32_bf16 a[120:123], v[92:95], a[216:219], a[120:123]
 buffer_load_dwordx4 a[184:187], v6, s[20:23], s42 offen offset:3072 sc1
 v_xor_b32 v53, s49, v53
 v_mfma_f32_16x16x32_bf16 a[120:123], v[88:91], a[200:203], a[120:123]
 v_mfma_f32_16x16x32_bf16 a[116:119], v[88:91], a[196:199], a[116:119]
 ds_read_b64_tr_b16 v[80:81], v54 offset:49152
 buffer_load_dwordx4 v47, s[8:11], s75 offen offset:3072  lds
 v_mfma_f32_16x16x32_bf16 a[116:119], v[92:95], a[212:215], a[116:119]
 ds_read_b64_tr_b16 v[82:83], v54 offset:53248
 s_add_u32 s75, s75, 262144
 v_mfma_f32_16x16x32_bf16 a[112:115], v[92:95], a[208:211], a[112:115]
 v_mfma_f32_16x16x32_bf16 a[112:115], v[88:91], a[192:195], a[112:115]
 s_waitcnt lgkmcnt(6)
 buffer_load_dwordx4 a[188:191], v7, s[20:23], s42 offen offset:3072 sc1
 s_waitcnt vmcnt(39)
 v_mfma_f32_16x16x32_bf16 a[0:3], v[64:67], a[224:227], a[0:3]
 ds_read_b64_tr_b16 v[84:85], v54 offset:57344
 s_add_u32 s42, s42, 4096
 s_waitcnt vmcnt(33)
 v_mfma_f32_16x16x32_bf16 a[0:3], v[68:71], a[240:243], a[0:3]
 ds_read_b64_tr_b16 v[86:87], v54 offset:61440
 s_waitcnt vmcnt(31)
 v_mfma_f32_16x16x32_bf16 a[4:7], v[68:71], a[244:247], a[4:7]
 v_xor_b32 v54, s49, v54
 v_mfma_f32_16x16x32_bf16 a[4:7], v[64:67], a[228:231], a[4:7]
 v_mfma_f32_16x16x32_bf16 a[8:11], v[64:67], a[232:235], a[8:11]
 ds_read_b64_tr_b16 v[88:89], v55 offset:49152
 buffer_load_dwordx4 a[192:195], v4, s[20:23], s42 offen sc1
 s_waitcnt vmcnt(31)
 v_mfma_f32_16x16x32_bf16 a[8:11], v[68:71], a[248:251], a[8:11]
 ds_read_b64_tr_b16 v[90:91], v55 offset:53248
 s_waitcnt vmcnt(29)
 v_mfma_f32_16x16x32_bf16 a[12:15], v[68:71], a[252:255], a[12:15]
 v_mfma_f32_16x16x32_bf16 a[12:15], v[64:67], a[236:239], a[12:15]
 s_waitcnt lgkmcnt(6)
 v_mfma_f32_16x16x32_bf16 a[28:31], v[72:75], a[236:239], a[28:31]
 ds_read_b64_tr_b16 v[92:93], v55 offset:57344
 v_mfma_f32_16x16x32_bf16 a[28:31], v[76:79], a[252:255], a[28:31]
 ds_read_b64_tr_b16 v[94:95], v55 offset:61440
 buffer_load_dwordx4 a[196:199], v5, s[20:23], s42 offen sc1
 v_mfma_f32_16x16x32_bf16 a[24:27], v[76:79], a[248:251], a[24:27]
 v_xor_b32 v55, s49, v55
 v_mfma_f32_16x16x32_bf16 a[24:27], v[72:75], a[232:235], a[24:27]
 v_mfma_f32_16x16x32_bf16 a[20:23], v[72:75], a[228:231], a[20:23]
 ds_read_b64_tr_b16 v[64:65], v56 offset:49152
 v_mfma_f32_16x16x32_bf16 a[20:23], v[76:79], a[244:247], a[20:23]
 ds_read_b64_tr_b16 v[66:67], v56 offset:53248
 v_mfma_f32_16x16x32_bf16 a[16:19], v[76:79], a[240:243], a[16:19]
 buffer_load_dwordx4 a[200:203], v6, s[20:23], s42 offen sc1
 v_mfma_f32_16x16x32_bf16 a[16:19], v[72:75], a[224:227], a[16:19]
 s_waitcnt lgkmcnt(6)
 v_mfma_f32_16x16x32_bf16 a[32:35], v[80:83], a[224:227], a[32:35]
 ds_read_b64_tr_b16 v[68:69], v56 offset:57344
 v_mfma_f32_16x16x32_bf16 a[32:35], v[84:87], a[240:243], a[32:35]
 ds_read_b64_tr_b16 v[70:71], v56 offset:61440
 v_mfma_f32_16x16x32_bf16 a[36:39], v[84:87], a[244:247], a[36:39]
 v_xor_b32 v56, s49, v56
 v_mfma_f32_16x16x32_bf16 a[36:39], v[80:83], a[228:231], a[36:39]
 buffer_load_dwordx4 a[204:207], v7, s[20:23], s42 offen sc1
 v_mfma_f32_16x16x32_bf16 a[40:43], v[80:83], a[232:235], a[40:43]
 ds_read_b64_tr_b16 v[72:73], v57 offset:49152
 v_mfma_f32_16x16x32_bf16 a[40:43], v[84:87], a[248:251], a[40:43]
 ds_read_b64_tr_b16 v[74:75], v57 offset:53248
 v_mfma_f32_16x16x32_bf16 a[44:47], v[84:87], a[252:255], a[44:47]
 v_mfma_f32_16x16x32_bf16 a[44:47], v[80:83], a[236:239], a[44:47]
 s_waitcnt lgkmcnt(6)
 v_mfma_f32_16x16x32_bf16 a[60:63], v[88:91], a[236:239], a[60:63]
 ds_read_b64_tr_b16 v[76:77], v57 offset:57344
 buffer_load_dwordx4 a[208:211], v4, s[20:23], s42 offen offset:1024 sc1
 v_mfma_f32_16x16x32_bf16 a[60:63], v[92:95], a[252:255], a[60:63]
 ds_read_b64_tr_b16 v[78:79], v57 offset:61440
 v_mfma_f32_16x16x32_bf16 a[56:59], v[92:95], a[248:251], a[56:59]
 v_xor_b32 v57, s49, v57
 v_mfma_f32_16x16x32_bf16 a[56:59], v[88:91], a[232:235], a[56:59]
 v_mfma_f32_16x16x32_bf16 a[52:55], v[88:91], a[228:231], a[52:55]
 ds_read_b64_tr_b16 v[80:81], v58 offset:49152
 v_mfma_f32_16x16x32_bf16 a[52:55], v[92:95], a[244:247], a[52:55]
 ds_read_b64_tr_b16 v[82:83], v58 offset:53248
 v_mfma_f32_16x16x32_bf16 a[48:51], v[92:95], a[240:243], a[48:51]
 v_mfma_f32_16x16x32_bf16 a[48:51], v[88:91], a[224:227], a[48:51]
 s_waitcnt lgkmcnt(6)
 v_mfma_f32_16x16x32_bf16 a[64:67], v[64:67], a[224:227], a[64:67]
 ds_read_b64_tr_b16 v[84:85], v58 offset:57344
 buffer_load_dwordx4 a[212:215], v5, s[20:23], s42 offen offset:1024 sc1
 v_mfma_f32_16x16x32_bf16 a[64:67], v[68:71], a[240:243], a[64:67]
 ds_read_b64_tr_b16 v[86:87], v58 offset:61440
 v_mfma_f32_16x16x32_bf16 a[68:71], v[68:71], a[244:247], a[68:71]
 v_xor_b32 v58, s49, v58
 v_mfma_f32_16x16x32_bf16 a[68:71], v[64:67], a[228:231], a[68:71]
 v_mfma_f32_16x16x32_bf16 a[72:75], v[64:67], a[232:235], a[72:75]
 ds_read_b64_tr_b16 v[88:89], v59 offset:49152
 v_mfma_f32_16x16x32_bf16 a[72:75], v[68:71], a[248:251], a[72:75]
 ds_read_b64_tr_b16 v[90:91], v59 offset:53248
 v_mfma_f32_16x16x32_bf16 a[76:79], v[68:71], a[252:255], a[76:79]
 v_mfma_f32_16x16x32_bf16 a[76:79], v[64:67], a[236:239], a[76:79]
 s_waitcnt lgkmcnt(6)
 v_mfma_f32_16x16x32_bf16 a[92:95], v[72:75], a[236:239], a[92:95]
 ds_read_b64_tr_b16 v[92:93], v59 offset:57344
 buffer_load_dwordx4 a[216:219], v6, s[20:23], s42 offen offset:1024 sc1
 v_mfma_f32_16x16x32_bf16 a[92:95], v[76:79], a[252:255], a[92:95]
 ds_read_b64_tr_b16 v[94:95], v59 offset:61440
 v_mfma_f32_16x16x32_bf16 a[88:91], v[76:79], a[248:251], a[88:91]
 v_xor_b32 v59, s49, v59
 v_mfma_f32_16x16x32_bf16 a[88:91], v[72:75], a[232:235], a[88:91]
 s_waitcnt vmcnt(30)
 s_barrier
 v_mfma_f32_16x16x32_bf16 a[84:87], v[72:75], a[228:231], a[84:87]
 ds_read_b64_tr_b16 v[64:65], v52
 v_mfma_f32_16x16x32_bf16 a[84:87], v[76:79], a[244:247], a[84:87]
 ds_read_b64_tr_b16 v[66:67], v52 offset:4096
 v_mfma_f32_16x16x32_bf16 a[80:83], v[76:79], a[240:243], a[80:83]
 v_mfma_f32_16x16x32_bf16 a[80:83], v[72:75], a[224:227], a[80:83]
 s_waitcnt lgkmcnt(6)
 v_mfma_f32_16x16x32_bf16 a[96:99], v[80:83], a[224:227], a[96:99]
 ds_read_b64_tr_b16 v[68:69], v52 offset:8192
 buffer_load_dwordx4 a[220:223], v7, s[20:23], s42 offen offset:1024 sc1
 v_mfma_f32_16x16x32_bf16 a[96:99], v[84:87], a[240:243], a[96:99]
 ds_read_b64_tr_b16 v[70:71], v52 offset:12288
 v_mfma_f32_16x16x32_bf16 a[100:103], v[84:87], a[244:247], a[100:103]
 v_mfma_f32_16x16x32_bf16 a[100:103], v[80:83], a[228:231], a[100:103]
 v_mfma_f32_16x16x32_bf16 a[104:107], v[80:83], a[232:235], a[104:107]
 ds_read_b64_tr_b16 v[72:73], v53
 v_mfma_f32_16x16x32_bf16 a[104:107], v[84:87], a[248:251], a[104:107]
 ds_read_b64_tr_b16 v[74:75], v53 offset:4096
 v_mfma_f32_16x16x32_bf16 a[108:111], v[84:87], a[252:255], a[108:111]
 v_mfma_f32_16x16x32_bf16 a[108:111], v[80:83], a[236:239], a[108:111]
 s_waitcnt lgkmcnt(6)
 v_mfma_f32_16x16x32_bf16 a[124:127], v[88:91], a[236:239], a[124:127]
 ds_read_b64_tr_b16 v[76:77], v53 offset:8192
 buffer_load_dword v61, v0, s[16:19], 0 offen
 v_mfma_f32_16x16x32_bf16 a[124:127], v[92:95], a[252:255], a[124:127]
 ds_read_b64_tr_b16 v[78:79], v53 offset:12288
 v_mfma_f32_16x16x32_bf16 a[120:123], v[92:95], a[248:251], a[120:123]
 v_mfma_f32_16x16x32_bf16 a[120:123], v[88:91], a[232:235], a[120:123]
 v_mfma_f32_16x16x32_bf16 a[116:119], v[88:91], a[228:231], a[116:119]
 ds_read_b64_tr_b16 v[80:81], v54
 v_mfma_f32_16x16x32_bf16 a[116:119], v[92:95], a[244:247], a[116:119]
 ds_read_b64_tr_b16 v[82:83], v54 offset:4096
 v_mfma_f32_16x16x32_bf16 a[112:115], v[92:95], a[240:243], a[112:115]
 v_mfma_f32_16x16x32_bf16 a[112:115], v[88:91], a[224:227], a[112:115]
 s_waitcnt lgkmcnt(6)
 v_mfma_f32_16x16x32_bf16 a[0:3], v[64:67], a[128:131], a[0:3]
 ds_read_b64_tr_b16 v[84:85], v54 offset:8192
 buffer_load_dwordx4 a[224:227], v4, s[20:23], s42 offen offset:2048 sc1
 s_waitcnt vmcnt(30)
 v_mfma_f32_16x16x32_bf16 a[0:3], v[68:71], a[144:147], a[0:3]
 ds_read_b64_tr_b16 v[86:87], v54 offset:12288
 buffer_load_dwordx4 a[240:243], v4, s[20:23], s42 offen offset:3072 sc1
 s_waitcnt vmcnt(29)
 v_mfma_f32_16x16x32_bf16 a[4:7], v[68:71], a[148:151], a[4:7]
 v_mfma_f32_16x16x32_bf16 a[4:7], v[64:67], a[132:135], a[4:7]
 buffer_load_dwordx4 a[228:231], v5, s[20:23], s42 offen offset:2048 sc1
 v_mfma_f32_16x16x32_bf16 a[8:11], v[64:67], a[136:139], a[8:11]
 ds_read_b64_tr_b16 v[88:89], v55
 s_waitcnt vmcnt(28)
 v_mfma_f32_16x16x32_bf16 a[8:11], v[68:71], a[152:155], a[8:11]
 ds_read_b64_tr_b16 v[90:91], v55 offset:4096
 s_waitcnt vmcnt(26)
 v_mfma_f32_16x16x32_bf16 a[12:15], v[68:71], a[156:159], a[12:15]
 buffer_load_dwordx4 a[232:235], v6, s[20:23], s42 offen offset:2048 sc1
 v_mfma_f32_16x16x32_bf16 a[12:15], v[64:67], a[140:143], a[12:15]
 s_waitcnt lgkmcnt(6)
 v_mfma_f32_16x16x32_bf16 a[28:31], v[72:75], a[140:143], a[28:31]
 ds_read_b64_tr_b16 v[92:93], v55 offset:8192
 buffer_load_dwordx4 a[244:247], v5, s[20:23], s42 offen offset:3072 sc1
 v_mfma_f32_16x16x32_bf16 a[28:31], v[76:79], a[156:159], a[28:31]
 ds_read_b64_tr_b16 v[94:95], v55 offset:12288
 buffer_load_dwordx4 a[236:239], v7, s[20:23], s42 offen offset:2048 sc1
 v_mfma_f32_16x16x32_bf16 a[24:27], v[76:79], a[152:155], a[24:27]
 v_mfma_f32_16x16x32_bf16 a[24:27], v[72:75], a[136:139], a[24:27]
 v_mfma_f32_16x16x32_bf16 a[20:23], v[72:75], a[132:135], a[20:23]
 ds_read_b64_tr_b16 v[64:65], v56
 v_mfma_f32_16x16x32_bf16 a[20:23], v[76:79], a[148:151], a[20:23]
 ds_read_b64_tr_b16 v[66:67], v56 offset:4096
 v_mfma_f32_16x16x32_bf16 a[16:19], v[76:79], a[144:147], a[16:19]
 v_mfma_f32_16x16x32_bf16 a[16:19], v[72:75], a[128:131], a[16:19]
 s_waitcnt lgkmcnt(6)
 v_mfma_f32_16x16x32_bf16 a[32:35], v[80:83], a[128:131], a[32:35]
 ds_read_b64_tr_b16 v[68:69], v56 offset:8192
 buffer_load_dwordx4 a[248:251], v6, s[20:23], s42 offen offset:3072 sc1
 v_mfma_f32_16x16x32_bf16 a[32:35], v[84:87], a[144:147], a[32:35]
 ds_read_b64_tr_b16 v[70:71], v56 offset:12288
 v_mfma_f32_16x16x32_bf16 a[36:39], v[84:87], a[148:151], a[36:39]
 v_mfma_f32_16x16x32_bf16 a[36:39], v[80:83], a[132:135], a[36:39]
 v_mfma_f32_16x16x32_bf16 a[40:43], v[80:83], a[136:139], a[40:43]
 ds_read_b64_tr_b16 v[72:73], v57
 v_mfma_f32_16x16x32_bf16 a[40:43], v[84:87], a[152:155], a[40:43]
 ds_read_b64_tr_b16 v[74:75], v57 offset:4096
 v_mfma_f32_16x16x32_bf16 a[44:47], v[84:87], a[156:159], a[44:47]
 v_mfma_f32_16x16x32_bf16 a[44:47], v[80:83], a[140:143], a[44:47]
 s_waitcnt lgkmcnt(6)
 v_mfma_f32_16x16x32_bf16 a[60:63], v[88:91], a[140:143], a[60:63]
 ds_read_b64_tr_b16 v[76:77], v57 offset:8192
 buffer_load_dwordx4 a[252:255], v7, s[20:23], s42 offen offset:3072 sc1
 v_mfma_f32_16x16x32_bf16 a[60:63], v[92:95], a[156:159], a[60:63]
 ds_read_b64_tr_b16 v[78:79], v57 offset:12288
 s_add_u32 s42, s42, 4096
 v_mfma_f32_16x16x32_bf16 a[56:59], v[92:95], a[152:155], a[56:59]
 v_mfma_f32_16x16x32_bf16 a[56:59], v[88:91], a[136:139], a[56:59]
 v_mfma_f32_16x16x32_bf16 a[52:55], v[88:91], a[132:135], a[52:55]
 ds_read_b64_tr_b16 v[80:81], v58
 v_mfma_f32_16x16x32_bf16 a[52:55], v[92:95], a[148:151], a[52:55]
 ds_read_b64_tr_b16 v[82:83], v58 offset:4096
 v_mfma_f32_16x16x32_bf16 a[48:51], v[92:95], a[144:147], a[48:51]
 v_mfma_f32_16x16x32_bf16 a[48:51], v[88:91], a[128:131], a[48:51]
 s_waitcnt lgkmcnt(6)
 v_mfma_f32_16x16x32_bf16 a[64:67], v[64:67], a[128:131], a[64:67]
 ds_read_b64_tr_b16 v[84:85], v58 offset:8192
 v_mfma_f32_16x16x32_bf16 a[64:67], v[68:71], a[144:147], a[64:67]
 ds_read_b64_tr_b16 v[86:87], v58 offset:12288
 v_mfma_f32_16x16x32_bf16 a[68:71], v[68:71], a[148:151], a[68:71]
 v_mfma_f32_16x16x32_bf16 a[68:71], v[64:67], a[132:135], a[68:71]
 v_mfma_f32_16x16x32_bf16 a[72:75], v[64:67], a[136:139], a[72:75]
 ds_read_b64_tr_b16 v[88:89], v59
 v_mfma_f32_16x16x32_bf16 a[72:75], v[68:71], a[152:155], a[72:75]
 ds_read_b64_tr_b16 v[90:91], v59 offset:4096
 v_mfma_f32_16x16x32_bf16 a[76:79], v[68:71], a[156:159], a[76:79]
 v_mfma_f32_16x16x32_bf16 a[76:79], v[64:67], a[140:143], a[76:79]
 s_waitcnt lgkmcnt(6)
 v_mfma_f32_16x16x32_bf16 a[92:95], v[72:75], a[140:143], a[92:95]
 ds_read_b64_tr_b16 v[92:93], v59 offset:8192
 v_mfma_f32_16x16x32_bf16 a[92:95], v[76:79], a[156:159], a[92:95]
 ds_read_b64_tr_b16 v[94:95], v59 offset:12288
 v_mfma_f32_16x16x32_bf16 a[88:91], v[76:79], a[152:155], a[88:91]
 v_mfma_f32_16x16x32_bf16 a[88:91], v[72:75], a[136:139], a[88:91]
 v_mfma_f32_16x16x32_bf16 a[84:87], v[72:75], a[132:135], a[84:87]
 ds_read_b64_tr_b16 v[64:65], v56 offset:16384
 s_waitcnt vmcnt(23)
 v_cmp_ne_u64 vcc, s[6:7], v[62:63]
 s_nop 0
 s_nop 0
 s_cbranch_vccz L_d_77_ok
L_d_77_spin:
 s_sleep 4
 buffer_load_dwordx2 v[62:63], v23, s[56:59], 0 offen sc1
 s_waitcnt vmcnt(0)
 v_cmp_ne_u64 vcc, s[6:7], v[62:63]
 s_nop 1
 s_cbranch_vccnz L_d_77_spin
L_d_77_ok:
 v_mfma_f32_16x16x32_bf16 a[84:87], v[76:79], a[148:151], a[84:87]
 ds_read_b64_tr_b16 v[66:67], v56 offset:20480
 v_mfma_f32_16x16x32_bf16 a[80:83], v[76:79], a[144:147], a[80:83]
 s_add_u32 s52, s33, 0
 buffer_load_dwordx4 v[192:195], v24, s[60:63], s52 offen sc1
 v_mfma_f32_16x16x32_bf16 a[80:83], v[72:75], a[128:131], a[80:83]
 s_waitcnt lgkmcnt(6)
 v_mfma_f32_16x16x32_bf16 a[96:99], v[80:83], a[128:131], a[96:99]
 ds_read_b64_tr_b16 v[68:69], v56 offset:24576
 buffer_load_dwordx4 v[196:199], v24, s[60:63], s52 offen offset:1024 sc1
 v_mfma_f32_16x16x32_bf16 a[96:99], v[84:87], a[144:147], a[96:99]
 ds_read_b64_tr_b16 v[70:71], v56 offset:28672
 buffer_load_dwordx4 v[200:203], v24, s[60:63], s52 offen offset:2048 sc1
 v_mfma_f32_16x16x32_bf16 a[100:103], v[84:87], a[148:151], a[100:103]
 v_mfma_f32_16x16x32_bf16 a[100:103], v[80:83], a[132:135], a[100:103]
 s_waitcnt vmcnt(21)
 s_barrier
 v_mfma_f32_16x16x32_bf16 a[104:107], v[80:83], a[136:139], a[104:107]
 ds_read_b64_tr_b16 v[72:73], v56 offset:32768
 buffer_load_dwordx4 v[204:207], v24, s[60:63], s52 offen offset:3072 sc1
 v_mfma_f32_16x16x32_bf16 a[104:107], v[84:87], a[152:155], a[104:107]
 ds_read_b64_tr_b16 v[74:75], v56 offset:36864
 v_mfma_f32_16x16x32_bf16 a[108:111], v[84:87], a[156:159], a[108:111]
 v_mfma_f32_16x16x32_bf16 a[108:111], v[80:83], a[140:143], a[108:111]
 s_waitcnt lgkmcnt(6)
 v_mfma_f32_16x16x32_bf16 a[124:127], v[88:91], a[140:143], a[124:127]
 ds_read_b64_tr_b16 v[76:77], v56 offset:40960
 s_add_u32 s52, s52, 4096
 v_mfma_f32_16x16x32_bf16 a[124:127], v[92:95], a[156:159], a[124:127]
 ds_read_b64_tr_b16 v[78:79], v56 offset:45056
 v_mfma_f32_16x16x32_bf16 a[120:123], v[92:95], a[152:155], a[120:123]
 buffer_load_dwordx4 v[208:211], v24, s[60:63], s52 offen sc1
 v_mfma_f32_16x16x32_bf16 a[120:123], v[88:91], a[136:139], a[120:123]
 v_mfma_f32_16x16x32_bf16 a[116:119], v[88:91], a[132:135], a[116:119]
 ds_read_b64_tr_b16 v[80:81], v56 offset:49152
 v_mfma_f32_16x16x32_bf16 a[116:119], v[92:95], a[148:151], a[116:119]
 ds_read_b64_tr_b16 v[82:83], v56 offset:53248
 v_mfma_f32_16x16x32_bf16 a[112:115], v[92:95], a[144:147], a[112:115]
 buffer_load_dwordx4 v[212:215], v24, s[60:63], s52 offen offset:1024 sc1
 v_mfma_f32_16x16x32_bf16 a[112:115], v[88:91], a[128:131], a[112:115]
 s_waitcnt lgkmcnt(6)
 v_mfma_f32_16x16x32_bf16 a[64:67], v[64:67], a[160:163], a[64:67]
 ds_read_b64_tr_b16 v[84:85], v56 offset:57344
 v_mfma_f32_16x16x32_bf16 a[64:67], v[68:71], a[176:179], a[64:67]
 ds_read_b64_tr_b16 v[86:87], v56 offset:61440
 buffer_load_dwordx4 v[216:219], v24, s[60:63], s52 offen offset:2048 sc1
 v_mfma_f32_16x16x32_bf16 a[68:71], v[68:71], a[180:183], a[68:71]
 v_mfma_f32_16x16x32_bf16 a[68:71], v[64:67], a[164:167], a[68:71]
 v_mfma_f32_16x16x32_bf16 a[72:75], v[64:67], a[168:171], a[72:75]
 ds_read_b64_tr_b16 v[88:89], v57 offset:16384
 buffer_load_dwordx4 v[220:223], v24, s[60:63], s52 offen offset:3072 sc1
 v_mfma_f32_16x16x32_bf16 a[72:75], v[68:71], a[184:187], a[72:75]
 ds_read_b64_tr_b16 v[90:91], v57 offset:20480
 s_waitcnt vmcnt(25)
 v_mfma_f32_16x16x32_bf16 a[76:79], v[68:71], a[188:191], a[76:79]
 v_mfma_f32_16x16x32_bf16 a[76:79], v[64:67], a[172:175], a[76:79]
 s_waitcnt lgkmcnt(6)
 s_waitcnt vmcnt(21)
 v_mfma_f32_16x16x32_bf16 a[76:79], v[72:75], a[204:207], a[76:79]
 ds_read_b64_tr_b16 v[92:93], v57 offset:24576
 s_add_u32 s52, s52, 4096
 s_waitcnt vmcnt(17)
 v_mfma_f32_16x16x32_bf16 a[76:79], v[76:79], a[220:223], a[76:79]
 ds_read_b64_tr_b16 v[94:95], v57 offset:28672
 v_mfma_f32_16x16x32_bf16 a[72:75], v[76:79], a[216:219], a[72:75]
 buffer_load_dwordx4 v[224:227], v24, s[60:63], s52 offen sc1
 v_mfma_f32_16x16x32_bf16 a[72:75], v[72:75], a[200:203], a[72:75]
 v_mfma_f32_16x16x32_bf16 a[68:71], v[72:75], a[196:199], a[68:71]
 ds_read_b64_tr_b16 v[64:65], v57 offset:32768
 v_mfma_f32_16x16x32_bf16 a[68:71], v[76:79], a[212:215], a[68:71]
 ds_read_b64_tr_b16 v[66:67], v57 offset:36864
 v_mfma_f32_16x16x32_bf16 a[64:67], v[76:79], a[208:211], a[64:67]
 buffer_load_dwordx4 v[228:231], v24, s[60:63], s52 offen offset:1024 sc1
 v_mfma_f32_16x16x32_bf16 a[64:67], v[72:75], a[192:195], a[64:67]
 s_waitcnt lgkmcnt(6)
 s_waitcnt vmcnt(17)
 v_mfma_f32_16x16x32_bf16 a[64:67], v[80:83], a[224:227], a[64:67]
 ds_read_b64_tr_b16 v[68:69], v57 offset:40960
 s_waitcnt vmcnt(16)
 v_mfma_f32_16x16x32_bf16 a[64:67], v[84:87], a[240:243], a[64:67]
 ds_read_b64_tr_b16 v[70:71], v57 offset:45056
 buffer_load_dwordx4 v[232:235], v24, s[60:63], s52 offen offset:2048 sc1
 s_waitcnt vmcnt(14)
 v_mfma_f32_16x16x32_bf16 a[68:71], v[84:87], a[244:247], a[68:71]
 v_mfma_f32_16x16x32_bf16 a[68:71], v[80:83], a[228:231], a[68:71]
 v_mfma_f32_16x16x32_bf16 a[72:75], v[80:83], a[232:235], a[72:75]
 ds_read_b64_tr_b16 v[72:73], v57 offset:49152
 buffer_load_dwordx4 v[236:239], v24, s[60:63], s52 offen offset:3072 sc1
 s_waitcnt vmcnt(13)
 v_mfma_f32_16x16x32_bf16 a[72:75], v[84:87], a[248:251], a[72:75]
 ds_read_b64_tr_b16 v[74:75], v57 offset:53248
 s_waitcnt vmcnt(12)
 v_mfma_f32_16x16x32_bf16 a[76:79], v[84:87], a[252:255], a[76:79]
 v_mfma_f32_16x16x32_bf16 a[76:79], v[80:83], a[236:239], a[76:79]
 s_waitcnt lgkmcnt(6)
 v_mfma_f32_16x16x32_bf16 a[92:95], v[88:91], a[172:175], a[92:95]
 ds_read_b64_tr_b16 v[76:77], v57 offset:57344
 v_mfma_f32_16x16x32_bf16 a[92:95], v[92:95], a[188:191], a[92:95]
 ds_read_b64_tr_b16 v[78:79], v57 offset:61440
 v_mfma_f32_16x16x32_bf16 a[88:91], v[92:95], a[184:187], a[88:91]
 v_mfma_f32_16x16x32_bf16 a[88:91], v[88:91], a[168:171], a[88:91]
 v_accvgpr_read_b32 v160, a64
 v_mfma_f32_16x16x32_bf16 a[84:87], v[88:91], a[164:167], a[84:87]
 ds_read_b64_tr_b16 v[80:81], v58 offset:16384
 v_accvgpr_read_b32 v161, a65
 v_mfma_f32_16x16x32_bf16 a[84:87], v[92:95], a[180:183], a[84:87]
 ds_read_b64_tr_b16 v[82:83], v58 offset:20480
 v_accvgpr_read_b32 v162, a66
 v_mfma_f32_16x16x32_bf16 a[80:83], v[92:95], a[176:179], a[80:83]
 v_accvgpr_read_b32 v163, a67
 v_accvgpr_read_b32 v164, a68
 v_mfma_f32_16x16x32_bf16 a[80:83], v[88:91], a[160:163], a[80:83]
 s_waitcnt lgkmcnt(6)
 v_mfma_f32_16x16x32_bf16 a[80:83], v[64:67], a[192:195], a[80:83]
 ds_read_b64_tr_b16 v[84:85], v58 offset:24576
 v_accvgpr_read_b32 v165, a69
 v_mfma_f32_16x16x32_bf16 a[80:83], v[68:71], a[208:211], a[80:83]
 ds_read_b64_tr_b16 v[86:87], v58 offset:28672
 v_accvgpr_read_b32 v166, a70
 v_mfma_f32_16x16x32_bf16 a[84:87], v[68:71], a[212:215], a[84:87]
 v_accvgpr_read_b32 v167, a71
 v_cvt_pk_bf16_f32 v112, v160, v161
 v_mfma_f32_16x16x32_bf16 a[84:87], v[64:67], a[196:199], a[84:87]
 v_cvt_pk_bf16_f32 v113, v162, v163
 v_mfma_f32_16x16x32_bf16 a[88:91], v[64:67], a[200:203], a[88:91]
 ds_read_b64_tr_b16 v[88:89], v58 offset:32768
 v_cvt_pk_bf16_f32 v114, v164, v165
 v_mfma_f32_16x16x32_bf16 a[88:91], v[68:71], a[216:219], a[88:91]
 ds_read_b64_tr_b16 v[90:91], v58 offset:36864
 v_cvt_pk_bf16_f32 v115, v166, v167
 v_mfma_f32_16x16x32_bf16 a[92:95], v[68:71], a[220:223], a[92:95]
 buffer_store_dwordx4 v[112:115], v26, s[60:63], s54 offen sc1
 v_accvgpr_read_b32 v168, a72
 v_mfma_f32_16x16x32_bf16 a[92:95], v[64:67], a[204:207], a[92:95]
 s_waitcnt lgkmcnt(6)
 v_mfma_f32_16x16x32_bf16 a[92:95], v[72:75], a[236:239], a[92:95]
 ds_read_b64_tr_b16 v[92:93], v58 offset:40960
 v_accvgpr_read_b32 v169, a73
 v_mfma_f32_16x16x32_bf16 a[92:95], v[76:79], a[252:255], a[92:95]
 ds_read_b64_tr_b16 v[94:95], v58 offset:45056
 v_accvgpr_read_b32 v170, a74
 v_mfma_f32_16x16x32_bf16 a[88:91], v[76:79], a[248:251], a[88:91]
 v_accvgpr_read_b32 v171, a75
 v_accvgpr_read_b32 v172, a76
 v_mfma_f32_16x16x32_bf16 a[88:91], v[72:75], a[232:235], a[88:91]
 v_accvgpr_read_b32 v173, a77
 v_mfma_f32_16x16x32_bf16 a[84:87], v[72:75], a[228:231], a[84:87]
 ds_read_b64_tr_b16 v[64:65], v58 offset:49152
 v_accvgpr_read_b32 v174, a78
 v_mfma_f32_16x16x32_bf16 a[84:87], v[76:79], a[244:247], a[84:87]
 ds_read_b64_tr_b16 v[66:67], v58 offset:53248
 v_accvgpr_read_b32 v175, a79
 v_mfma_f32_16x16x32_bf16 a[80:83], v[76:79], a[240:243], a[80:83]
 v_cvt_pk_bf16_f32 v116, v168, v169
 v_cvt_pk_bf16_f32 v117, v170, v171
 v_mfma_f32_16x16x32_bf16 a[80:83], v[72:75], a[224:227], a[80:83]
 s_waitcnt lgkmcnt(6)
 v_mfma_f32_16x16x32_bf16 a[96:99], v[80:83], a[160:163], a[96:99]
 ds_read_b64_tr_b16 v[68:69], v58 offset:57344
 v_cvt_pk_bf16_f32 v118, v172, v173
 v_mfma_f32_16x16x32_bf16 a[96:99], v[84:87], a[176:179], a[96:99]
 ds_read_b64_tr_b16 v[70:71], v58 offset:61440
 v_cvt_pk_bf16_f32 v119, v174, v175
 v_mfma_f32_16x16x32_bf16 a[100:103], v[84:87], a[180:183], a[100:103]
 buffer_store_dwordx4 v[116:119], v27, s[60:63], s54 offen sc1
 v_mfma_f32_16x16x32_bf16 a[100:103], v[80:83], a[164:167], a[100:103]
 v_accvgpr_read_b32 v176, a80
 v_mfma_f32_16x16x32_bf16 a[104:107], v[80:83], a[168:171], a[104:107]
 ds_read_b64_tr_b16 v[72:73], v59 offset:16384
 v_accvgpr_read_b32 v177, a81
 v_mfma_f32_16x16x32_bf16 a[104:107], v[84:87], a[184:187], a[104:107]
 ds_read_b64_tr_b16 v[74:75], v59 offset:20480
 v_accvgpr_read_b32 v178, a82
 v_mfma_f32_16x16x32_bf16 a[108:111], v[84:87], a[188:191], a[108:111]
 v_accvgpr_read_b32 v179, a83
 v_accvgpr_read_b32 v180, a84
 v_mfma_f32_16x16x32_bf16 a[108:111], v[80:83], a[172:175], a[108:111]
 s_waitcnt lgkmcnt(6)
 v_mfma_f32_16x16x32_bf16 a[108:111], v[88:91], a[204:207], a[108:111]
 ds_read_b64_tr_b16 v[76:77], v59 offset:24576
 v_accvgpr_read_b32 v181, a85
 v_mfma_f32_16x16x32_bf16 a[108:111], v[92:95], a[220:223], a[108:111]
 ds_read_b64_tr_b16 v[78:79], v59 offset:28672
 v_accvgpr_read_b32 v182, a86
 v_mfma_f32_16x16x32_bf16 a[104:107], v[92:95], a[216:219], a[104:107]
 v_accvgpr_read_b32 v183, a87
 v_cvt_pk_bf16_f32 v120, v176, v177
 v_mfma_f32_16x16x32_bf16 a[104:107], v[88:91], a[200:203], a[104:107]
 v_cvt_pk_bf16_f32 v121, v178, v179
 v_mfma_f32_16x16x32_bf16 a[100:103], v[88:91], a[196:199], a[100:103]
 ds_read_b64_tr_b16 v[80:81], v59 offset:32768
 v_cvt_pk_bf16_f32 v122, v180, v181
 v_mfma_f32_16x16x32_bf16 a[100:103], v[92:95], a[212:215], a[100:103]
 ds_read_b64_tr_b16 v[82:83], v59 offset:36864
 v_cvt_pk_bf16_f32 v123, v182, v183
 v_mfma_f32_16x16x32_bf16 a[96:99], v[92:95], a[208:211], a[96:99]
 buffer_store_dwordx4 v[120:123], v26, s[60:63], s54 offen offset:1024 sc1
 v_accvgpr_read_b32 v184, a88
 v_mfma_f32_16x16x32_bf16 a[96:99], v[88:91], a[192:195], a[96:99]
 s_waitcnt lgkmcnt(6)
 v_mfma_f32_16x16x32_bf16 a[96:99], v[64:67], a[224:227], a[96:99]
 ds_read_b64_tr_b16 v[84:85], v59 offset:40960
 v_accvgpr_read_b32 v185, a89
 v_mfma_f32_16x16x32_bf16 a[96:99], v[68:71], a[240:243], a[96:99]
 ds_read_b64_tr_b16 v[86:87], v59 offset:45056
 v_accvgpr_read_b32 v186, a90
 v_mfma_f32_16x16x32_bf16 a[100:103], v[68:71], a[244:247], a[100:103]
 v_accvgpr_read_b32 v187, a91
 v_accvgpr_read_b32 v188, a92
 v_mfma_f32_16x16x32_bf16 a[100:103], v[64:67], a[228:231], a[100:103]
 v_accvgpr_read_b32 v189, a93
 v_mfma_f32_16x16x32_bf16 a[104:107], v[64:67], a[232:235], a[104:107]
 ds_read_b64_tr_b16 v[88:89], v59 offset:49152
 v_accvgpr_read_b32 v190, a94
 v_mfma_f32_16x16x32_bf16 a[104:107], v[68:71], a[248:251], a[104:107]
 ds_read_b64_tr_b16 v[90:91], v59 offset:53248
 v_accvgpr_read_b32 v191, a95
 v_mfma_f32_16x16x32_bf16 a[108:111], v[68:71], a[252:255], a[108:111]
 v_cvt_pk_bf16_f32 v124, v184, v185
 v_cvt_pk_bf16_f32 v125, v186, v187
 v_mfma_f32_16x16x32_bf16 a[108:111], v[64:67], a[236:239], a[108:111]
 s_waitcnt lgkmcnt(6)
 v_mfma_f32_16x16x32_bf16 a[124:127], v[72:75], a[172:175], a[124:127]
 ds_read_b64_tr_b16 v[92:93], v59 offset:57344
 v_cvt_pk_bf16_f32 v126, v188, v189
 v_mfma_f32_16x16x32_bf16 a[124:127], v[76:79], a[188:191], a[124:127]
 ds_read_b64_tr_b16 v[94:95], v59 offset:61440
 v_cvt_pk_bf16_f32 v127, v190, v191
 v_mfma_f32_16x16x32_bf16 a[120:123], v[76:79], a[184:187], a[120:123]
 buffer_store_dwordx4 v[124:127], v27, s[60:63], s54 offen offset:1024 sc1
 v_mfma_f32_16x16x32_bf16 a[120:123], v[72:75], a[168:171], a[120:123]
 v_accvgpr_read_b32 v160, a96
 v_mfma_f32_16x16x32_bf16 a[116:119], v[72:75], a[164:167], a[116:119]
 ds_read_b64_tr_b16 v[64:65], v52 offset:16384
 v_accvgpr_read_b32 v161, a97
 v_mfma_f32_16x16x32_bf16 a[116:119], v[76:79], a[180:183], a[116:119]
 ds_read_b64_tr_b16 v[66:67], v52 offset:20480
 v_accvgpr_read_b32 v162, a98
 v_mfma_f32_16x16x32_bf16 a[112:115], v[76:79], a[176:179], a[112:115]
 v_accvgpr_read_b32 v163, a99
 v_accvgpr_read_b32 v164, a100
 v_mfma_f32_16x16x32_bf16 a[112:115], v[72:75], a[160:163], a[112:115]
 s_waitcnt lgkmcnt(6)
 v_mfma_f32_16x16x32_bf16 a[112:115], v[80:83], a[192:195], a[112:115]
 ds_read_b64_tr_b16 v[68:69], v52 offset:24576
 v_accvgpr_read_b32 v165, a101
 v_mfma_f32_16x16x32_bf16 a[112:115], v[84:87], a[208:211], a[112:115]
 ds_read_b64_tr_b16 v[70:71], v52 offset:28672
 v_accvgpr_read_b32 v166, a102
 v_mfma_f32_16x16x32_bf16 a[116:119], v[84:87], a[212:215], a[116:119]
 v_accvgpr_read_b32 v167, a103
 v_cvt_pk_bf16_f32 v112, v160, v161
 v_mfma_f32_16x16x32_bf16 a[116:119], v[80:83], a[196:199], a[116:119]
 v_cvt_pk_bf16_f32 v113, v162, v163
 v_mfma_f32_16x16x32_bf16 a[120:123], v[80:83], a[200:203], a[120:123]
 ds_read_b64_tr_b16 v[72:73], v52 offset:32768
 v_cvt_pk_bf16_f32 v114, v164, v165
 v_mfma_f32_16x16x32_bf16 a[120:123], v[84:87], a[216:219], a[120:123]
 ds_read_b64_tr_b16 v[74:75], v52 offset:36864
 v_cvt_pk_bf16_f32 v115, v166, v167
 v_mfma_f32_16x16x32_bf16 a[124:127], v[84:87], a[220:223], a[124:127]
 buffer_store_dwordx4 v[112:115], v26, s[60:63], s54 offen offset:2048 sc1
 v_accvgpr_read_b32 v168, a104
 v_mfma_f32_16x16x32_bf16 a[124:127], v[80:83], a[204:207], a[124:127]
 s_waitcnt lgkmcnt(6)
 v_mfma_f32_16x16x32_bf16 a[124:127], v[88:91], a[236:239], a[124:127]
 ds_read_b64_tr_b16 v[76:77], v52 offset:40960
 v_accvgpr_read_b32 v169, a105
 v_mfma_f32_16x16x32_bf16 a[124:127], v[92:95], a[252:255], a[124:127]
 ds_read_b64_tr_b16 v[78:79], v52 offset:45056
 v_accvgpr_read_b32 v170, a106
 v_mfma_f32_16x16x32_bf16 a[120:123], v[92:95], a[248:251], a[120:123]
 v_accvgpr_read_b32 v171, a107
 v_accvgpr_read_b32 v172, a108
 v_mfma_f32_16x16x32_bf16 a[120:123], v[88:91], a[232:235], a[120:123]
 v_accvgpr_read_b32 v173, a109
 v_mfma_f32_16x16x32_bf16 a[116:119], v[88:91], a[228:231], a[116:119]
 ds_read_b64_tr_b16 v[80:81], v52 offset:49152
 v_accvgpr_read_b32 v174, a110
 v_mfma_f32_16x16x32_bf16 a[116:119], v[92:95], a[244:247], a[116:119]
 ds_read_b64_tr_b16 v[82:83], v52 offset:53248
 v_accvgpr_read_b32 v175, a111
 v_mfma_f32_16x16x32_bf16 a[112:115], v[92:95], a[240:243], a[112:115]
 v_cvt_pk_bf16_f32 v116, v168, v169
 v_cvt_pk_bf16_f32 v117, v170, v171
 v_mfma_f32_16x16x32_bf16 a[112:115], v[88:91], a[224:227], a[112:115]
 s_waitcnt lgkmcnt(6)
 v_mfma_f32_16x16x32_bf16 a[0:3], v[64:67], a[160:163], a[0:3]
 ds_read_b64_tr_b16 v[84:85], v52 offset:57344
 v_cvt_pk_bf16_f32 v118, v172, v173
 v_mfma_f32_16x16x32_bf16 a[0:3], v[68:71], a[176:179], a[0:3]
 ds_read_b64_tr_b16 v[86:87], v52 offset:61440
 v_cvt_pk_bf16_f32 v119, v174, v175
 v_mfma_f32_16x16x32_bf16 a[4:7], v[68:71], a[180:183], a[4:7]
 buffer_store_dwordx4 v[116:119], v27, s[60:63], s54 offen offset:2048 sc1
 v_mfma_f32_16x16x32_bf16 a[4:7], v[64:67], a[164:167], a[4:7]
 v_accvgpr_read_b32 v176, a112
 v_mfma_f32_16x16x32_bf16 a[8:11], v[64:67], a[168:171], a[8:11]
 ds_read_b64_tr_b16 v[88:89], v53 offset:16384
 v_accvgpr_read_b32 v177, a113
 v_mfma_f32_16x16x32_bf16 a[8:11], v[68:71], a[184:187], a[8:11]
 ds_read_b64_tr_b16 v[90:91], v53 offset:20480
 v_accvgpr_read_b32 v178, a114
 v_mfma_f32_16x16x32_bf16 a[12:15], v[68:71], a[188:191], a[12:15]
 v_accvgpr_read_b32 v179, a115
 v_accvgpr_read_b32 v180, a116
 v_mfma_f32_16x16x32_bf16 a[12:15], v[64:67], a[172:175], a[12:15]
 s_waitcnt lgkmcnt(6)
 v_mfma_f32_16x16x32_bf16 a[12:15], v[72:75], a[204:207], a[12:15]
 ds_read_b64_tr_b16 v[92:93], v53 offset:24576
 v_accvgpr_read_b32 v181, a117
 v_mfma_f32_16x16x32_bf16 a[12:15], v[76:79], a[220:223], a[12:15]
 ds_read_b64_tr_b16 v[94:95], v53 offset:28672
 v_accvgpr_read_b32 v182, a118
 v_mfma_f32_16x16x32_bf16 a[8:11], v[76:79], a[216:219], a[8:11]
 v_accvgpr_read_b32 v183, a119
 v_cvt_pk_bf16_f32 v120, v176, v177
 v_mfma_f32_16x16x32_bf16 a[8:11], v[72:75], a[200:203], a[8:11]
 v_cvt_pk_bf16_f32 v121, v178, v179
 v_mfma_f32_16x16x32_bf16 a[4:7], v[72:75], a[196:199], a[4:7]
 ds_read_b64_tr_b16 v[64:65], v53 offset:32768
 v_cvt_pk_bf16_f32 v122, v180, v181
 v_mfma_f32_16x16x32_bf16 a[4:7], v[76:79], a[212:215], a[4:7]
 ds_read_b64_tr_b16 v[66:67], v53 offset:36864
 v_cvt_pk_bf16_f32 v123, v182, v183
 v_mfma_f32_16x16x32_bf16 a[0:3], v[76:79], a[208:211], a[0:3]
 buffer_store_dwordx4 v[120:123], v26, s[60:63], s54 offen offset:3072 sc1
 v_accvgpr_read_b32 v184, a120
 v_mfma_f32_16x16x32_bf16 a[0:3], v[72:75], a[192:195], a[0:3]
 s_waitcnt lgkmcnt(6)
 v_mfma_f32_16x16x32_bf16 a[0:3], v[80:83], a[224:227], a[0:3]
 ds_read_b64_tr_b16 v[68:69], v53 offset:40960
 v_accvgpr_read_b32 v185, a121
 v_mfma_f32_16x16x32_bf16 a[0:3], v[84:87], a[240:243], a[0:3]
 ds_read_b64_tr_b16 v[70:71], v53 offset:45056
 v_accvgpr_read_b32 v186, a122
 v_mfma_f32_16x16x32_bf16 a[4:7], v[84:87], a[244:247], a[4:7]
 v_accvgpr_read_b32 v187, a123
 v_accvgpr_read_b32 v188, a124
 v_mfma_f32_16x16x32_bf16 a[4:7], v[80:83], a[228:231], a[4:7]
 v_accvgpr_read_b32 v189, a125
 v_mfma_f32_16x16x32_bf16 a[8:11], v[80:83], a[232:235], a[8:11]
 ds_read_b64_tr_b16 v[72:73], v53 offset:49152
 v_accvgpr_read_b32 v190, a126
 v_mfma_f32_16x16x32_bf16 a[8:11], v[84:87], a[248:251], a[8:11]
 ds_read_b64_tr_b16 v[74:75], v53 offset:53248
 v_accvgpr_read_b32 v191, a127
 v_mfma_f32_16x16x32_bf16 a[12:15], v[84:87], a[252:255], a[12:15]
 v_cvt_pk_bf16_f32 v124, v184, v185
 v_cvt_pk_bf16_f32 v125, v186, v187
 v_mfma_f32_16x16x32_bf16 a[12:15], v[80:83], a[236:239], a[12:15]
 s_waitcnt lgkmcnt(6)
 v_mfma_f32_16x16x32_bf16 a[28:31], v[88:91], a[172:175], a[28:31]
 ds_read_b64_tr_b16 v[76:77], v53 offset:57344
 v_cvt_pk_bf16_f32 v126, v188, v189
 v_mfma_f32_16x16x32_bf16 a[28:31], v[92:95], a[188:191], a[28:31]
 ds_read_b64_tr_b16 v[78:79], v53 offset:61440
 v_cvt_pk_bf16_f32 v127, v190, v191
 v_mfma_f32_16x16x32_bf16 a[24:27], v[92:95], a[184:187], a[24:27]
 buffer_store_dwordx4 v[124:127], v27, s[60:63], s54 offen offset:3072 sc1
 v_mfma_f32_16x16x32_bf16 a[24:27], v[88:91], a[168:171], a[24:27]
 v_accvgpr_read_b32 v160, a8
 v_mfma_f32_16x16x32_bf16 a[20:23], v[88:91], a[164:167], a[20:23]
 ds_read_b64_tr_b16 v[80:81], v54 offset:16384
 v_accvgpr_read_b32 v161, a9
 v_mfma_f32_16x16x32_bf16 a[20:23], v[92:95], a[180:183], a[20:23]
 ds_read_b64_tr_b16 v[82:83], v54 offset:20480
 v_accvgpr_read_b32 v162, a10
 v_mfma_f32_16x16x32_bf16 a[16:19], v[92:95], a[176:179], a[16:19]
 v_accvgpr_read_b32 v163, a11
 v_accvgpr_read_b32 v164, a12
 v_mfma_f32_16x16x32_bf16 a[16:19], v[88:91], a[160:163], a[16:19]
 s_waitcnt lgkmcnt(6)
 v_mfma_f32_16x16x32_bf16 a[16:19], v[64:67], a[192:195], a[16:19]
 ds_read_b64_tr_b16 v[84:85], v54 offset:24576
 v_accvgpr_read_b32 v165, a13
 v_mfma_f32_16x16x32_bf16 a[16:19], v[68:71], a[208:211], a[16:19]
 ds_read_b64_tr_b16 v[86:87], v54 offset:28672
 v_mfma_f32_16x16x32_bf16 a[20:23], v[68:71], a[212:215], a[20:23]
 v_accvgpr_read_b32 v166, a14
 v_mfma_f32_16x16x32_bf16 a[20:23], v[64:67], a[196:199], a[20:23]
 v_mfma_f32_16x16x32_bf16 a[24:27], v[64:67], a[200:203], a[24:27]
 ds_read_b64_tr_b16 v[88:89], v54 offset:32768
 v_accvgpr_read_b32 v167, a15
 v_mfma_f32_16x16x32_bf16 a[24:27], v[68:71], a[216:219], a[24:27]
 ds_read_b64_tr_b16 v[90:91], v54 offset:36864
 v_mfma_f32_16x16x32_bf16 a[28:31], v[68:71], a[220:223], a[28:31]
 v_cvt_pk_bf16_f32 v112, v160, v161
 v_mfma_f32_16x16x32_bf16 a[28:31], v[64:67], a[204:207], a[28:31]
 s_waitcnt lgkmcnt(6)
 v_mfma_f32_16x16x32_bf16 a[28:31], v[72:75], a[236:239], a[28:31]
 ds_read_b64_tr_b16 v[92:93], v54 offset:40960
 v_cvt_pk_bf16_f32 v113, v162, v163
 v_mfma_f32_16x16x32_bf16 a[28:31], v[76:79], a[252:255], a[28:31]
 ds_read_b64_tr_b16 v[94:95], v54 offset:45056
 v_cvt_pk_bf16_f32 v114, v164, v165
 v_mfma_f32_16x16x32_bf16 a[24:27], v[76:79], a[248:251], a[24:27]
 v_mfma_f32_16x16x32_bf16 a[24:27], v[72:75], a[232:235], a[24:27]
 v_cvt_pk_bf16_f32 v115, v166, v167
 v_mfma_f32_16x16x32_bf16 a[20:23], v[72:75], a[228:231], a[20:23]
 ds_read_b64_tr_b16 v[64:65], v54 offset:49152
 v_mfma_f32_16x16x32_bf16 a[20:23], v[76:79], a[244:247], a[20:23]
 ds_read_b64_tr_b16 v[66:67], v54 offset:53248
 buffer_store_dwordx4 v[112:115], v25, s[60:63], s54 offen sc1
 v_mfma_f32_16x16x32_bf16 a[16:19], v[76:79], a[240:243], a[16:19]
 v_mfma_f32_16x16x32_bf16 a[16:19], v[72:75], a[224:227], a[16:19]
 s_waitcnt lgkmcnt(6)
 v_mfma_f32_16x16x32_bf16 a[32:35], v[80:83], a[160:163], a[32:35]
 ds_read_b64_tr_b16 v[68:69], v54 offset:57344
 v_mfma_f32_16x16x32_bf16 a[32:35], v[84:87], a[176:179], a[32:35]
 ds_read_b64_tr_b16 v[70:71], v54 offset:61440
 v_mfma_f32_16x16x32_bf16 a[36:39], v[84:87], a[180:183], a[36:39]
 v_mfma_f32_16x16x32_bf16 a[36:39], v[80:83], a[164:167], a[36:39]
 v_accvgpr_read_b32 v168, a24
 v_mfma_f32_16x16x32_bf16 a[40:43], v[80:83], a[168:171], a[40:43]
 ds_read_b64_tr_b16 v[72:73], v55 offset:16384
 v_accvgpr_read_b32 v169, a25
 v_mfma_f32_16x16x32_bf16 a[40:43], v[84:87], a[184:187], a[40:43]
 ds_read_b64_tr_b16 v[74:75], v55 offset:20480
 v_accvgpr_read_b32 v170, a26
 v_mfma_f32_16x16x32_bf16 a[44:47], v[84:87], a[188:191], a[44:47]
 v_accvgpr_read_b32 v171, a27
 v_accvgpr_read_b32 v172, a28
 v_mfma_f32_16x16x32_bf16 a[44:47], v[80:83], a[172:175], a[44:47]
 s_waitcnt lgkmcnt(6)
 v_mfma_f32_16x16x32_bf16 a[44:47], v[88:91], a[204:207], a[44:47]
 ds_read_b64_tr_b16 v[76:77], v55 offset:24576
 v_accvgpr_read_b32 v173, a29
 v_mfma_f32_16x16x32_bf16 a[44:47], v[92:95], a[220:223], a[44:47]
 ds_read_b64_tr_b16 v[78:79], v55 offset:28672
 v_mfma_f32_16x16x32_bf16 a[40:43], v[92:95], a[216:219], a[40:43]
 v_accvgpr_read_b32 v174, a30
 v_mfma_f32_16x16x32_bf16 a[40:43], v[88:91], a[200:203], a[40:43]
 v_mfma_f32_16x16x32_bf16 a[36:39], v[88:91], a[196:199], a[36:39]
 ds_read_b64_tr_b16 v[80:81], v55 offset:32768
 v_accvgpr_read_b32 v175, a31
 v_mfma_f32_16x16x32_bf16 a[36:39], v[92:95], a[212:215], a[36:39]
 ds_read_b64_tr_b16 v[82:83], v55 offset:36864
 v_mfma_f32_16x16x32_bf16 a[32:35], v[92:95], a[208:211], a[32:35]
 v_cvt_pk_bf16_f32 v116, v168, v169
 v_mfma_f32_16x16x32_bf16 a[32:35], v[88:91], a[192:195], a[32:35]
 s_waitcnt lgkmcnt(6)
 v_mfma_f32_16x16x32_bf16 a[32:35], v[64:67], a[224:227], a[32:35]
 ds_read_b64_tr_b16 v[84:85], v55 offset:40960
 v_cvt_pk_bf16_f32 v117, v170, v171
 v_mfma_f32_16x16x32_bf16 a[32:35], v[68:71], a[240:243], a[32:35]
 ds_read_b64_tr_b16 v[86:87], v55 offset:45056
 v_cvt_pk_bf16_f32 v118, v172, v173
 v_mfma_f32_16x16x32_bf16 a[36:39], v[68:71], a[244:247], a[36:39]
 v_mfma_f32_16x16x32_bf16 a[36:39], v[64:67], a[228:231], a[36:39]
 v_cvt_pk_bf16_f32 v119, v174, v175
 v_mfma_f32_16x16x32_bf16 a[40:43], v[64:67], a[232:235], a[40:43]
 ds_read_b64_tr_b16 v[88:89], v55 offset:49152
 v_mfma_f32_16x16x32_bf16 a[40:43], v[68:71], a[248:251], a[40:43]
 ds_read_b64_tr_b16 v[90:91], v55 offset:53248
 buffer_store_dwordx4 v[116:119], v25, s[60:63], s54 offen offset:1024 sc1
 v_mfma_f32_16x16x32_bf16 a[44:47], v[68:71], a[252:255], a[44:47]
 v_mfma_f32_16x16x32_bf16 a[44:47], v[64:67], a[236:239], a[44:47]
 s_waitcnt lgkmcnt(6)
 v_mfma_f32_16x16x32_bf16 a[60:63], v[72:75], a[172:175], a[60:63]
 ds_read_b64_tr_b16 v[92:93], v55 offset:57344
 v_mfma_f32_16x16x32_bf16 a[60:63], v[76:79], a[188:191], a[60:63]
 ds_read_b64_tr_b16 v[94:95], v55 offset:61440
 v_mfma_f32_16x16x32_bf16 a[56:59], v[76:79], a[184:187], a[56:59]
 v_mfma_f32_16x16x32_bf16 a[56:59], v[72:75], a[168:171], a[56:59]
 v_accvgpr_read_b32 v176, a40
 v_mfma_f32_16x16x32_bf16 a[52:55], v[72:75], a[164:167], a[52:55]
 v_accvgpr_read_b32 v177, a41
 v_accvgpr_read_b32 v178, a42
 v_mfma_f32_16x16x32_bf16 a[52:55], v[76:79], a[180:183], a[52:55]
 v_accvgpr_read_b32 v179, a43
 v_mfma_f32_16x16x32_bf16 a[48:51], v[76:79], a[176:179], a[48:51]
 v_accvgpr_read_b32 v180, a44
 v_mfma_f32_16x16x32_bf16 a[48:51], v[72:75], a[160:163], a[48:51]
 s_waitcnt lgkmcnt(4)
 v_mfma_f32_16x16x32_bf16 a[48:51], v[80:83], a[192:195], a[48:51]
 v_accvgpr_read_b32 v181, a45
 v_mfma_f32_16x16x32_bf16 a[48:51], v[84:87], a[208:211], a[48:51]
 v_accvgpr_read_b32 v182, a46
 v_mfma_f32_16x16x32_bf16 a[52:55], v[84:87], a[212:215], a[52:55]
 v_mfma_f32_16x16x32_bf16 a[52:55], v[80:83], a[196:199], a[52:55]
 v_accvgpr_read_b32 v183, a47
 v_mfma_f32_16x16x32_bf16 a[56:59], v[80:83], a[200:203], a[56:59]
 v_cvt_pk_bf16_f32 v120, v176, v177
 v_mfma_f32_16x16x32_bf16 a[56:59], v[84:87], a[216:219], a[56:59]
 v_mfma_f32_16x16x32_bf16 a[60:63], v[84:87], a[220:223], a[60:63]
 v_cvt_pk_bf16_f32 v121, v178, v179
 v_mfma_f32_16x16x32_bf16 a[60:63], v[80:83], a[204:207], a[60:63]
 s_waitcnt lgkmcnt(0)
 v_mfma_f32_16x16x32_bf16 a[60:63], v[88:91], a[236:239], a[60:63]
 v_cvt_pk_bf16_f32 v122, v180, v181
 v_mfma_f32_16x16x32_bf16 a[60:63], v[92:95], a[252:255], a[60:63]
 v_cvt_pk_bf16_f32 v123, v182, v183
 v_mfma_f32_16x16x32_bf16 a[56:59], v[92:95], a[248:251], a[56:59]
 v_mfma_f32_16x16x32_bf16 a[56:59], v[88:91], a[232:235], a[56:59]
 buffer_store_dwordx4 v[120:123], v25, s[60:63], s54 offen offset:2048 sc1
 v_mfma_f32_16x16x32_bf16 a[52:55], v[88:91], a[228:231], a[52:55]
 v_mfma_f32_16x16x32_bf16 a[52:55], v[92:95], a[244:247], a[52:55]
 v_mfma_f32_16x16x32_bf16 a[48:51], v[92:95], a[240:243], a[48:51]
 v_mfma_f32_16x16x32_bf16 a[48:51], v[88:91], a[224:227], a[48:51]
 s_mov_b32 s53, 0xffff0000
 v_add_u32 v23, 32768, v23
 s_nop 4
 s_lshl_b32 s52, s36, 13
 s_add_u32 s52, s52, 135168
 v_and_b32 v36, 0x37, v1
 v_lshlrev_b32 v36, 4, v36
 v_bfe_u32 v37, v1, 3, 1
 v_lshl_add_u32 v36, v37, 10, v36
 v_add_u32 v39, s52, v36
 ds_read_b128 v[96:99], v39
 ds_read_b128 v[100:103], v39 offset:128
 ds_read_b128 v[104:107], v39 offset:2048
 ds_read_b128 v[108:111], v39 offset:2176
 v_accvgpr_read_b32 v184, a56
 v_accvgpr_read_b32 v185, a57
 v_accvgpr_read_b32 v186, a58
 v_accvgpr_read_b32 v187, a59
 v_accvgpr_read_b32 v188, a60
 v_accvgpr_read_b32 v189, a61
 v_accvgpr_read_b32 v190, a62
 v_accvgpr_read_b32 v191, a63
 v_cvt_pk_bf16_f32 v124, v184, v185
 v_cvt_pk_bf16_f32 v125, v186, v187
 v_cvt_pk_bf16_f32 v126, v188, v189
 v_cvt_pk_bf16_f32 v127, v190, v191
 buffer_store_dwordx4 v[124:127], v25, s[60:63], s54 offen offset:3072 sc1
 v_mov_b32 v28, 0xbfb8aa3b
 v_mov_b32 v29, v28
 s_waitcnt vmcnt(23)
 v_lshlrev_b32 v32, 16, v192
 v_and_b32 v33, s53, v192
 v_lshlrev_b32 v34, 16, v193
 v_and_b32 v35, s53, v193
 v_lshlrev_b32 v36, 16, v194
 v_and_b32 v37, s53, v194
 v_lshlrev_b32 v38, 16, v195
 v_and_b32 v39, s53, v195
 v_pk_add_f32 v[128:129], v[128:129], v[32:33]
 v_pk_add_f32 v[130:131], v[130:131], v[34:35]
 v_pk_add_f32 v[132:133], v[132:133], v[36:37]
 v_pk_add_f32 v[134:135], v[134:135], v[38:39]
 s_waitcnt vmcnt(19)
 v_lshlrev_b32 v40, 16, v208
 v_and_b32 v41, s53, v208
 v_lshlrev_b32 v42, 16, v209
 v_and_b32 v43, s53, v209
 v_lshlrev_b32 v44, 16, v210
 v_and_b32 v45, s53, v210
 v_lshlrev_b32 v46, 16, v211
 v_and_b32 v47, s53, v211
 v_pk_add_f32 v[128:129], v[128:129], v[40:41]
 v_pk_add_f32 v[130:131], v[130:131], v[42:43]
 v_pk_add_f32 v[132:133], v[132:133], v[44:45]
 v_pk_add_f32 v[134:135], v[134:135], v[46:47]
 s_waitcnt vmcnt(15)
 v_lshlrev_b32 v32, 16, v224
 v_and_b32 v33, s53, v224
 v_lshlrev_b32 v34, 16, v225
 v_and_b32 v35, s53, v225
 v_lshlrev_b32 v36, 16, v226
 v_and_b32 v37, s53, v226
 v_lshlrev_b32 v38, 16, v227
 v_and_b32 v39, s53, v227
 v_pk_add_f32 v[128:129], v[128:129], v[32:33]
 v_pk_add_f32 v[130:131], v[130:131], v[34:35]
 v_pk_add_f32 v[132:133], v[132:133], v[36:37]
 v_pk_add_f32 v[134:135], v[134:135], v[38:39]
 v_pk_mul_f32 v[48:49], v[128:129], v[28:29]
 v_pk_mul_f32 v[50:51], v[130:131], v[28:29]
 v_pk_mul_f32 v[52:53], v[132:133], v[28:29]
 v_pk_mul_f32 v[54:55], v[134:135], v[28:29]
 v_exp_f32 v48, v48
 v_exp_f32 v49, v49
 v_exp_f32 v50, v50
 v_exp_f32 v51, v51
 v_exp_f32 v52, v52
 v_exp_f32 v53, v53
 v_exp_f32 v54, v54
 v_exp_f32 v55, v55
 s_nop 0
 v_pk_add_f32 v[48:49], v[48:49], 1.0 op_sel_hi:[1,0]
 v_pk_add_f32 v[50:51], v[50:51], 1.0 op_sel_hi:[1,0]
 v_pk_add_f32 v[52:53], v[52:53], 1.0 op_sel_hi:[1,0]
 v_pk_add_f32 v[54:55], v[54:55], 1.0 op_sel_hi:[1,0]
 v_rcp_f32 v48, v48
 v_rcp_f32 v49, v49
 v_rcp_f32 v50, v50
 v_rcp_f32 v51, v51
 v_rcp_f32 v52, v52
 v_rcp_f32 v53, v53
 v_rcp_f32 v54, v54
 v_rcp_f32 v55, v55
 s_nop 0
 v_pk_mul_f32 v[128:129], v[128:129], v[48:49]
 v_pk_mul_f32 v[130:131], v[130:131], v[50:51]
 v_pk_mul_f32 v[132:133], v[132:133], v[52:53]
 v_pk_mul_f32 v[134:135], v[134:135], v[54:55]
 v_lshlrev_b32 v32, 16, v196
 v_and_b32 v33, s53, v196
 v_lshlrev_b32 v34, 16, v197
 v_and_b32 v35, s53, v197
 v_lshlrev_b32 v36, 16, v198
 v_and_b32 v37, s53, v198
 v_lshlrev_b32 v38, 16, v199
 v_and_b32 v39, s53, v199
 v_pk_add_f32 v[136:137], v[136:137], v[32:33]
 v_pk_add_f32 v[138:139], v[138:139], v[34:35]
 v_pk_add_f32 v[140:141], v[140:141], v[36:37]
 v_pk_add_f32 v[142:143], v[142:143], v[38:39]
 v_lshlrev_b32 v40, 16, v212
 v_and_b32 v41, s53, v212
 v_lshlrev_b32 v42, 16, v213
 v_and_b32 v43, s53, v213
 v_lshlrev_b32 v44, 16, v214
 v_and_b32 v45, s53, v214
 v_lshlrev_b32 v46, 16, v215
 v_and_b32 v47, s53, v215
 v_pk_add_f32 v[136:137], v[136:137], v[40:41]
 v_pk_add_f32 v[138:139], v[138:139], v[42:43]
 v_pk_add_f32 v[140:141], v[140:141], v[44:45]
 v_pk_add_f32 v[142:143], v[142:143], v[46:47]
 s_waitcnt vmcnt(14)
 v_lshlrev_b32 v32, 16, v228
 v_and_b32 v33, s53, v228
 v_lshlrev_b32 v34, 16, v229
 v_and_b32 v35, s53, v229
 v_lshlrev_b32 v36, 16, v230
 v_and_b32 v37, s53, v230
 v_lshlrev_b32 v38, 16, v231
 v_and_b32 v39, s53, v231
 v_pk_add_f32 v[136:137], v[136:137], v[32:33]
 v_pk_add_f32 v[138:139], v[138:139], v[34:35]
 v_pk_add_f32 v[140:141], v[140:141], v[36:37]
 v_pk_add_f32 v[142:143], v[142:143], v[38:39]
 v_pk_mul_f32 v[48:49], v[136:137], v[28:29]
 v_pk_mul_f32 v[50:51], v[138:139], v[28:29]
 v_pk_mul_f32 v[52:53], v[140:141], v[28:29]
 v_pk_mul_f32 v[54:55], v[142:143], v[28:29]
 v_exp_f32 v48, v48
 v_exp_f32 v49, v49
 v_exp_f32 v50, v50
 v_exp_f32 v51, v51
 v_exp_f32 v52, v52
 v_exp_f32 v53, v53
 v_exp_f32 v54, v54
 v_exp_f32 v55, v55
 s_nop 0
 v_pk_add_f32 v[48:49], v[48:49], 1.0 op_sel_hi:[1,0]
 v_pk_add_f32 v[50:51], v[50:51], 1.0 op_sel_hi:[1,0]
 v_pk_add_f32 v[52:53], v[52:53], 1.0 op_sel_hi:[1,0]
 v_pk_add_f32 v[54:55], v[54:55], 1.0 op_sel_hi:[1,0]
 v_rcp_f32 v48, v48
 v_rcp_f32 v49, v49
 v_rcp_f32 v50, v50
 v_rcp_f32 v51, v51
 v_rcp_f32 v52, v52
 v_rcp_f32 v53, v53
 v_rcp_f32 v54, v54
 v_rcp_f32 v55, v55
 s_nop 0
 v_pk_mul_f32 v[136:137], v[136:137], v[48:49]
 v_pk_mul_f32 v[138:139], v[138:139], v[50:51]
 v_pk_mul_f32 v[140:141], v[140:141], v[52:53]
 v_pk_mul_f32 v[142:143], v[142:143], v[54:55]
 v_lshlrev_b32 v32, 16, v200
 v_and_b32 v33, s53, v200
 v_lshlrev_b32 v34, 16, v201
 v_and_b32 v35, s53, v201
 v_lshlrev_b32 v36, 16, v202
 v_and_b32 v37, s53, v202
 v_lshlrev_b32 v38, 16, v203
 v_and_b32 v39, s53, v203
 v_pk_add_f32 v[144:145], v[144:145], v[32:33]
 v_pk_add_f32 v[146:147], v[146:147], v[34:35]
 v_pk_add_f32 v[148:149], v[148:149], v[36:37]
 v_pk_add_f32 v[150:151], v[150:151], v[38:39]
 v_lshlrev_b32 v40, 16, v216
 v_and_b32 v41, s53, v216
 v_lshlrev_b32 v42, 16, v217
 v_and_b32 v43, s53, v217
 v_lshlrev_b32 v44, 16, v218
 v_and_b32 v45, s53, v218
 v_lshlrev_b32 v46, 16, v219
 v_and_b32 v47, s53, v219
 v_pk_add_f32 v[144:145], v[144:145], v[40:41]
 v_pk_add_f32 v[146:147], v[146:147], v[42:43]
 v_pk_add_f32 v[148:149], v[148:149], v[44:45]
 v_pk_add_f32 v[150:151], v[150:151], v[46:47]
 s_waitcnt vmcnt(13)
 v_lshlrev_b32 v32, 16, v232
 v_and_b32 v33, s53, v232
 v_lshlrev_b32 v34, 16, v233
 v_and_b32 v35, s53, v233
 v_lshlrev_b32 v36, 16, v234
 v_and_b32 v37, s53, v234
 v_lshlrev_b32 v38, 16, v235
 v_and_b32 v39, s53, v235
 v_pk_add_f32 v[144:145], v[144:145], v[32:33]
 v_pk_add_f32 v[146:147], v[146:147], v[34:35]
 v_pk_add_f32 v[148:149], v[148:149], v[36:37]
 v_pk_add_f32 v[150:151], v[150:151], v[38:39]
 v_pk_mul_f32 v[48:49], v[144:145], v[28:29]
 v_pk_mul_f32 v[50:51], v[146:147], v[28:29]
 v_pk_mul_f32 v[52:53], v[148:149], v[28:29]
 v_pk_mul_f32 v[54:55], v[150:151], v[28:29]
 v_exp_f32 v48, v48
 v_exp_f32 v49, v49
 v_exp_f32 v50, v50
 v_exp_f32 v51, v51
 v_exp_f32 v52, v52
 v_exp_f32 v53, v53
 v_exp_f32 v54, v54
 v_exp_f32 v55, v55
 s_nop 0
 v_pk_add_f32 v[48:49], v[48:49], 1.0 op_sel_hi:[1,0]
 v_pk_add_f32 v[50:51], v[50:51], 1.0 op_sel_hi:[1,0]
 v_pk_add_f32 v[52:53], v[52:53], 1.0 op_sel_hi:[1,0]
 v_pk_add_f32 v[54:55], v[54:55], 1.0 op_sel_hi:[1,0]
 v_rcp_f32 v48, v48
 v_rcp_f32 v49, v49
 v_rcp_f32 v50, v50
 v_rcp_f32 v51, v51
 v_rcp_f32 v52, v52
 v_rcp_f32 v53, v53
 v_rcp_f32 v54, v54
 v_rcp_f32 v55, v55
 s_nop 0
 v_pk_mul_f32 v[144:145], v[144:145], v[48:49]
 v_pk_mul_f32 v[146:147], v[146:147], v[50:51]
 v_pk_mul_f32 v[148:149], v[148:149], v[52:53]
 v_pk_mul_f32 v[150:151], v[150:151], v[54:55]
 v_lshlrev_b32 v32, 16, v204
 v_and_b32 v33, s53, v204
 v_lshlrev_b32 v34, 16, v205
 v_and_b32 v35, s53, v205
 v_lshlrev_b32 v36, 16, v206
 v_and_b32 v37, s53, v206
 v_lshlrev_b32 v38, 16, v207
 v_and_b32 v39, s53, v207
 v_pk_add_f32 v[152:153], v[152:153], v[32:33]
 v_pk_add_f32 v[154:155], v[154:155], v[34:35]
 v_pk_add_f32 v[156:157], v[156:157], v[36:37]
 v_pk_add_f32 v[158:159], v[158:159], v[38:39]
 v_lshlrev_b32 v40, 16, v220
 v_and_b32 v41, s53, v220
 v_lshlrev_b32 v42, 16, v221
 v_and_b32 v43, s53, v221
 v_lshlrev_b32 v44, 16, v222
 v_and_b32 v45, s53, v222
 v_lshlrev_b32 v46, 16, v223
 v_and_b32 v47, s53, v223
 v_pk_add_f32 v[152:153], v[152:153], v[40:41]
 v_pk_add_f32 v[154:155], v[154:155], v[42:43]
 v_pk_add_f32 v[156:157], v[156:157], v[44:45]
 v_pk_add_f32 v[158:159], v[158:159], v[46:47]
 s_waitcnt vmcnt(12)
 v_lshlrev_b32 v32, 16, v236
 v_and_b32 v33, s53, v236
 v_lshlrev_b32 v34, 16, v237
 v_and_b32 v35, s53, v237
 v_lshlrev_b32 v36, 16, v238
 v_and_b32 v37, s53, v238
 v_lshlrev_b32 v38, 16, v239
 v_and_b32 v39, s53, v239
 v_pk_add_f32 v[152:153], v[152:153], v[32:33]
 v_pk_add_f32 v[154:155], v[154:155], v[34:35]
 v_pk_add_f32 v[156:157], v[156:157], v[36:37]
 v_pk_add_f32 v[158:159], v[158:159], v[38:39]
 v_pk_mul_f32 v[48:49], v[152:153], v[28:29]
 v_pk_mul_f32 v[50:51], v[154:155], v[28:29]
 v_pk_mul_f32 v[52:53], v[156:157], v[28:29]
 v_pk_mul_f32 v[54:55], v[158:159], v[28:29]
 v_exp_f32 v48, v48
 v_exp_f32 v49, v49
 v_exp_f32 v50, v50
 v_exp_f32 v51, v51
 v_exp_f32 v52, v52
 v_exp_f32 v53, v53
 v_exp_f32 v54, v54
 v_exp_f32 v55, v55
 s_nop 0
 v_pk_add_f32 v[48:49], v[48:49], 1.0 op_sel_hi:[1,0]
 v_pk_add_f32 v[50:51], v[50:51], 1.0 op_sel_hi:[1,0]
 v_pk_add_f32 v[52:53], v[52:53], 1.0 op_sel_hi:[1,0]
 v_pk_add_f32 v[54:55], v[54:55], 1.0 op_sel_hi:[1,0]
 v_rcp_f32 v48, v48
 v_rcp_f32 v49, v49
 v_rcp_f32 v50, v50
 v_rcp_f32 v51, v51
 v_rcp_f32 v52, v52
 v_rcp_f32 v53, v53
 v_rcp_f32 v54, v54
 v_rcp_f32 v55, v55
 s_nop 0
 v_pk_mul_f32 v[152:153], v[152:153], v[48:49]
 v_pk_mul_f32 v[154:155], v[154:155], v[50:51]
 v_pk_mul_f32 v[156:157], v[156:157], v[52:53]
 v_pk_mul_f32 v[158:159], v[158:159], v[54:55]
 v_accvgpr_read_b32 v64, a0
 v_accvgpr_read_b32 v65, a1
 v_accvgpr_read_b32 v66, a2
 v_accvgpr_read_b32 v67, a3
 v_accvgpr_read_b32 v68, a4
 v_accvgpr_read_b32 v69, a5
 v_accvgpr_read_b32 v70, a6
 v_accvgpr_read_b32 v71, a7
 v_accvgpr_read_b32 v72, a16
 v_accvgpr_read_b32 v73, a17
 v_accvgpr_read_b32 v74, a18
 v_accvgpr_read_b32 v75, a19
 v_accvgpr_read_b32 v76, a20
 v_accvgpr_read_b32 v77, a21
 v_accvgpr_read_b32 v78, a22
 v_accvgpr_read_b32 v79, a23
 v_accvgpr_read_b32 v80, a32
 v_accvgpr_read_b32 v81, a33
 v_accvgpr_read_b32 v82, a34
 v_accvgpr_read_b32 v83, a35
 v_accvgpr_read_b32 v84, a36
 v_accvgpr_read_b32 v85, a37
 v_accvgpr_read_b32 v86, a38
 v_accvgpr_read_b32 v87, a39
 v_accvgpr_read_b32 v88, a48
 v_accvgpr_read_b32 v89, a49
 v_accvgpr_read_b32 v90, a50
 v_accvgpr_read_b32 v91, a51
 v_accvgpr_read_b32 v92, a52
 v_accvgpr_read_b32 v93, a53
 v_accvgpr_read_b32 v94, a54
 v_accvgpr_read_b32 v95, a55
 s_waitcnt vmcnt(0)
 s_barrier
 s_cmp_eq_u32 s36, 1
 s_cbranch_scc0 C_got_77
 buffer_store_dwordx2 v[2:3], v22, s[56:59], 0 offen sc1
C_poll_77:
 buffer_load_dwordx2 v[36:37], v23, s[56:59], 0 offen sc1
 s_waitcnt vmcnt(0)
 v_cmp_ne_u64 vcc, s[6:7], v[36:37]
 s_nop 1
 s_cbranch_vccz C_got_77
 s_sleep 1
 s_branch C_poll_77
C_got_77:
 s_barrier
 s_add_u32 s52, s33, 12582912
 buffer_load_dwordx4 v[192:195], v24, s[60:63], s52 offen sc1
 buffer_load_dwordx4 v[196:199], v24, s[60:63], s52 offen offset:1024 sc1
 buffer_load_dwordx4 v[200:203], v24, s[60:63], s52 offen offset:2048 sc1
 buffer_load_dwordx4 v[204:207], v24, s[60:63], s52 offen offset:3072 sc1
 s_add_u32 s52, s52, 4096
 buffer_load_dwordx4 v[208:211], v24, s[60:63], s52 offen sc1
 buffer_load_dwordx4 v[212:215], v24, s[60:63], s52 offen offset:1024 sc1
 buffer_load_dwordx4 v[216:219], v24, s[60:63], s52 offen offset:2048 sc1
 buffer_load_dwordx4 v[220:223], v24, s[60:63], s52 offen offset:3072 sc1
 s_add_u32 s52, s52, 4096
 buffer_load_dwordx4 v[224:227], v24, s[60:63], s52 offen sc1
 buffer_load_dwordx4 v[228:231], v24, s[60:63], s52 offen offset:1024 sc1
 buffer_load_dwordx4 v[232:235], v24, s[60:63], s52 offen offset:2048 sc1
 buffer_load_dwordx4 v[236:239], v24, s[60:63], s52 offen offset:3072 sc1
 s_waitcnt lgkmcnt(3)
 v_lshlrev_b32 v160, 16, v96
 v_and_b32 v161, s53, v96
 v_lshlrev_b32 v162, 16, v97
 v_and_b32 v163, s53, v97
 v_lshlrev_b32 v164, 16, v98
 v_and_b32 v165, s53, v98
 v_lshlrev_b32 v166, 16, v99
 v_and_b32 v167, s53, v99
 s_waitcnt lgkmcnt(2)
 v_lshlrev_b32 v168, 16, v100
 v_and_b32 v169, s53, v100
 v_lshlrev_b32 v170, 16, v101
 v_and_b32 v171, s53, v101
 v_lshlrev_b32 v172, 16, v102
 v_and_b32 v173, s53, v102
 v_lshlrev_b32 v174, 16, v103
 v_and_b32 v175, s53, v103
 s_waitcnt lgkmcnt(1)
 v_lshlrev_b32 v176, 16, v104
 v_and_b32 v177, s53, v104
 v_lshlrev_b32 v178, 16, v105
 v_and_b32 v179, s53, v105
 v_lshlrev_b32 v180, 16, v106
 v_and_b32 v181, s53, v106
 v_lshlrev_b32 v182, 16, v107
 v_and_b32 v183, s53, v107
 s_waitcnt lgkmcnt(0)
 v_lshlrev_b32 v184, 16, v108
 v_and_b32 v185, s53, v108
 v_lshlrev_b32 v186, 16, v109
 v_and_b32 v187, s53, v109
 v_lshlrev_b32 v188, 16, v110
 v_and_b32 v189, s53, v110
 v_lshlrev_b32 v190, 16, v111
 v_and_b32 v191, s53, v111
 s_waitcnt vmcnt(11)
 v_lshlrev_b32 v32, 16, v192
 v_and_b32 v33, s53, v192
 v_lshlrev_b32 v34, 16, v193
 v_and_b32 v35, s53, v193
 v_lshlrev_b32 v36, 16, v194
 v_and_b32 v37, s53, v194
 v_lshlrev_b32 v38, 16, v195
 v_and_b32 v39, s53, v195
 v_pk_add_f32 v[64:65], v[64:65], v[32:33]
 v_pk_add_f32 v[66:67], v[66:67], v[34:35]
 v_pk_add_f32 v[68:69], v[68:69], v[36:37]
 v_pk_add_f32 v[70:71], v[70:71], v[38:39]
 s_waitcnt vmcnt(7)
 v_lshlrev_b32 v40, 16, v208
 v_and_b32 v41, s53, v208
 v_lshlrev_b32 v42, 16, v209
 v_and_b32 v43, s53, v209
 v_lshlrev_b32 v44, 16, v210
 v_and_b32 v45, s53, v210
 v_lshlrev_b32 v46, 16, v211
 v_and_b32 v47, s53, v211
 v_pk_add_f32 v[64:65], v[64:65], v[40:41]
 v_pk_add_f32 v[66:67], v[66:67], v[42:43]
 v_pk_add_f32 v[68:69], v[68:69], v[44:45]
 v_pk_add_f32 v[70:71], v[70:71], v[46:47]
 s_waitcnt vmcnt(3)
 v_lshlrev_b32 v32, 16, v224
 v_and_b32 v33, s53, v224
 v_lshlrev_b32 v34, 16, v225
 v_and_b32 v35, s53, v225
 v_lshlrev_b32 v36, 16, v226
 v_and_b32 v37, s53, v226
 v_lshlrev_b32 v38, 16, v227
 v_and_b32 v39, s53, v227
 v_pk_add_f32 v[64:65], v[64:65], v[32:33]
 v_pk_add_f32 v[66:67], v[66:67], v[34:35]
 v_pk_add_f32 v[68:69], v[68:69], v[36:37]
 v_pk_add_f32 v[70:71], v[70:71], v[38:39]
 v_lshlrev_b32 v32, 16, v196
 v_and_b32 v33, s53, v196
 v_lshlrev_b32 v34, 16, v197
 v_and_b32 v35, s53, v197
 v_lshlrev_b32 v36, 16, v198
 v_and_b32 v37, s53, v198
 v_lshlrev_b32 v38, 16, v199
 v_and_b32 v39, s53, v199
 v_pk_add_f32 v[72:73], v[72:73], v[32:33]
 v_pk_add_f32 v[74:75], v[74:75], v[34:35]
 v_pk_add_f32 v[76:77], v[76:77], v[36:37]
 v_pk_add_f32 v[78:79], v[78:79], v[38:39]
 v_lshlrev_b32 v40, 16, v212
 v_and_b32 v41, s53, v212
 v_lshlrev_b32 v42, 16, v213
 v_and_b32 v43, s53, v213
 v_lshlrev_b32 v44, 16, v214
 v_and_b32 v45, s53, v214
 v_lshlrev_b32 v46, 16, v215
 v_and_b32 v47, s53, v215
 v_pk_add_f32 v[72:73], v[72:73], v[40:41]
 v_pk_add_f32 v[74:75], v[74:75], v[42:43]
 v_pk_add_f32 v[76:77], v[76:77], v[44:45]
 v_pk_add_f32 v[78:79], v[78:79], v[46:47]
 s_waitcnt vmcnt(2)
 v_lshlrev_b32 v32, 16, v228
 v_and_b32 v33, s53, v228
 v_lshlrev_b32 v34, 16, v229
 v_and_b32 v35, s53, v229
 v_lshlrev_b32 v36, 16, v230
 v_and_b32 v37, s53, v230
 v_lshlrev_b32 v38, 16, v231
 v_and_b32 v39, s53, v231
 v_pk_add_f32 v[72:73], v[72:73], v[32:33]
 v_pk_add_f32 v[74:75], v[74:75], v[34:35]
 v_pk_add_f32 v[76:77], v[76:77], v[36:37]
 v_pk_add_f32 v[78:79], v[78:79], v[38:39]
 v_lshlrev_b32 v32, 16, v200
 v_and_b32 v33, s53, v200
 v_lshlrev_b32 v34, 16, v201
 v_and_b32 v35, s53, v201
 v_lshlrev_b32 v36, 16, v202
 v_and_b32 v37, s53, v202
 v_lshlrev_b32 v38, 16, v203
 v_and_b32 v39, s53, v203
 v_pk_add_f32 v[80:81], v[80:81], v[32:33]
 v_pk_add_f32 v[82:83], v[82:83], v[34:35]
 v_pk_add_f32 v[84:85], v[84:85], v[36:37]
 v_pk_add_f32 v[86:87], v[86:87], v[38:39]
 v_lshlrev_b32 v40, 16, v216
 v_and_b32 v41, s53, v216
 v_lshlrev_b32 v42, 16, v217
 v_and_b32 v43, s53, v217
 v_lshlrev_b32 v44, 16, v218
 v_and_b32 v45, s53, v218
 v_lshlrev_b32 v46, 16, v219
 v_and_b32 v47, s53, v219
 v_pk_add_f32 v[80:81], v[80:81], v[40:41]
 v_pk_add_f32 v[82:83], v[82:83], v[42:43]
 v_pk_add_f32 v[84:85], v[84:85], v[44:45]
 v_pk_add_f32 v[86:87], v[86:87], v[46:47]
 s_waitcnt vmcnt(1)
 v_lshlrev_b32 v32, 16, v232
 v_and_b32 v33, s53, v232
 v_lshlrev_b32 v34, 16, v233
 v_and_b32 v35, s53, v233
 v_lshlrev_b32 v36, 16, v234
 v_and_b32 v37, s53, v234
 v_lshlrev_b32 v38, 16, v235
 v_and_b32 v39, s53, v235
 v_pk_add_f32 v[80:81], v[80:81], v[32:33]
 v_pk_add_f32 v[82:83], v[82:83], v[34:35]
 v_pk_add_f32 v[84:85], v[84:85], v[36:37]
 v_pk_add_f32 v[86:87], v[86:87], v[38:39]
 v_lshlrev_b32 v32, 16, v204
 v_and_b32 v33, s53, v204
 v_lshlrev_b32 v34, 16, v205
 v_and_b32 v35, s53, v205
 v_lshlrev_b32 v36, 16, v206
 v_and_b32 v37, s53, v206
 v_lshlrev_b32 v38, 16, v207
 v_and_b32 v39, s53, v207
 v_pk_add_f32 v[88:89], v[88:89], v[32:33]
 v_pk_add_f32 v[90:91], v[90:91], v[34:35]
 v_pk_add_f32 v[92:93], v[92:93], v[36:37]
 v_pk_add_f32 v[94:95], v[94:95], v[38:39]
 v_lshlrev_b32 v40, 16, v220
 v_and_b32 v41, s53, v220
 v_lshlrev_b32 v42, 16, v221
 v_and_b32 v43, s53, v221
 v_lshlrev_b32 v44, 16, v222
 v_and_b32 v45, s53, v222
 v_lshlrev_b32 v46, 16, v223
 v_and_b32 v47, s53, v223
 v_pk_add_f32 v[88:89], v[88:89], v[40:41]
 v_pk_add_f32 v[90:91], v[90:91], v[42:43]
 v_pk_add_f32 v[92:93], v[92:93], v[44:45]
 v_pk_add_f32 v[94:95], v[94:95], v[46:47]
 s_waitcnt vmcnt(0)
 v_lshlrev_b32 v32, 16, v236
 v_and_b32 v33, s53, v236
 v_lshlrev_b32 v34, 16, v237
 v_and_b32 v35, s53, v237
 v_lshlrev_b32 v36, 16, v238
 v_and_b32 v37, s53, v238
 v_lshlrev_b32 v38, 16, v239
 v_and_b32 v39, s53, v239
 v_pk_add_f32 v[88:89], v[88:89], v[32:33]
 v_pk_add_f32 v[90:91], v[90:91], v[34:35]
 v_pk_add_f32 v[92:93], v[92:93], v[36:37]
 v_pk_add_f32 v[94:95], v[94:95], v[38:39]
 v_pk_mul_f32 v[64:65], v[64:65], v[128:129]
 v_pk_mul_f32 v[66:67], v[66:67], v[130:131]
 v_pk_mul_f32 v[68:69], v[68:69], v[132:133]
 v_pk_mul_f32 v[70:71], v[70:71], v[134:135]
 v_pk_mul_f32 v[72:73], v[72:73], v[136:137]
 v_pk_mul_f32 v[74:75], v[74:75], v[138:139]
 v_pk_mul_f32 v[76:77], v[76:77], v[140:141]
 v_pk_mul_f32 v[78:79], v[78:79], v[142:143]
 v_pk_mul_f32 v[80:81], v[80:81], v[144:145]
 v_pk_mul_f32 v[82:83], v[82:83], v[146:147]
 v_pk_mul_f32 v[84:85], v[84:85], v[148:149]
 v_pk_mul_f32 v[86:87], v[86:87], v[150:151]
 v_pk_mul_f32 v[88:89], v[88:89], v[152:153]
 v_pk_mul_f32 v[90:91], v[90:91], v[154:155]
 v_pk_mul_f32 v[92:93], v[92:93], v[156:157]
 v_pk_mul_f32 v[94:95], v[94:95], v[158:159]
 v_permlane16_swap_b32 v64, v72
 v_permlane16_swap_b32 v65, v73
 v_permlane16_swap_b32 v66, v74
 v_permlane16_swap_b32 v67, v75
 v_permlane16_swap_b32 v80, v88
 v_permlane16_swap_b32 v81, v89
 v_permlane16_swap_b32 v82, v90
 v_permlane16_swap_b32 v83, v91
 v_pk_add_f32 v[160:161], v[160:161], v[64:65]
 v_pk_add_f32 v[162:163], v[162:163], v[66:67]
 v_pk_add_f32 v[164:165], v[164:165], v[72:73]
 v_pk_add_f32 v[166:167], v[166:167], v[74:75]
 v_cvt_pk_bf16_f32 v112, v160, v161
 v_cvt_pk_bf16_f32 v113, v162, v163
 v_cvt_pk_bf16_f32 v114, v164, v165
 v_cvt_pk_bf16_f32 v115, v166, v167
 v_pk_add_f32 v[168:169], v[168:169], v[80:81]
 v_pk_add_f32 v[170:171], v[170:171], v[82:83]
 v_pk_add_f32 v[172:173], v[172:173], v[88:89]
 v_pk_add_f32 v[174:175], v[174:175], v[90:91]
 v_cvt_pk_bf16_f32 v116, v168, v169
 v_cvt_pk_bf16_f32 v117, v170, v171
 v_cvt_pk_bf16_f32 v118, v172, v173
 v_cvt_pk_bf16_f32 v119, v174, v175
 v_mov_b32 v32, v116
 v_mov_b32 v33, v117
 v_mov_b32 v34, v118
 v_mov_b32 v35, v119
 v_mov_b32_dpp v116, v112 row_ror:8 row_mask:0xf bank_mask:0x3
 v_mov_b32_dpp v117, v113 row_ror:8 row_mask:0xf bank_mask:0x3
 v_mov_b32_dpp v118, v114 row_ror:8 row_mask:0xf bank_mask:0x3
 v_mov_b32_dpp v119, v115 row_ror:8 row_mask:0xf bank_mask:0x3
 v_mov_b32_dpp v112, v32 row_ror:8 row_mask:0xf bank_mask:0xc
 v_mov_b32_dpp v113, v33 row_ror:8 row_mask:0xf bank_mask:0xc
 v_mov_b32_dpp v114, v34 row_ror:8 row_mask:0xf bank_mask:0xc
 v_mov_b32_dpp v115, v35 row_ror:8 row_mask:0xf bank_mask:0xc
 s_mov_b32 s50, 0
 s_mov_b32 s51, 16384
 buffer_store_dwordx4 v[112:115], v16, s[28:31], s50 offen sc1
 buffer_store_dwordx4 v[116:119], v16, s[28:31], s51 offen sc1
 v_permlane16_swap_b32 v68, v76
 v_permlane16_swap_b32 v69, v77
 v_permlane16_swap_b32 v70, v78
 v_permlane16_swap_b32 v71, v79
 v_permlane16_swap_b32 v84, v92
 v_permlane16_swap_b32 v85, v93
 v_permlane16_swap_b32 v86, v94
 v_permlane16_swap_b32 v87, v95
 v_pk_add_f32 v[176:177], v[176:177], v[68:69]
 v_pk_add_f32 v[178:179], v[178:179], v[70:71]
 v_pk_add_f32 v[180:181], v[180:181], v[76:77]
 v_pk_add_f32 v[182:183], v[182:183], v[78:79]
 v_cvt_pk_bf16_f32 v120, v176, v177
 v_cvt_pk_bf16_f32 v121, v178, v179
 v_cvt_pk_bf16_f32 v122, v180, v181
 v_cvt_pk_bf16_f32 v123, v182, v183
 v_pk_add_f32 v[184:185], v[184:185], v[84:85]
 v_pk_add_f32 v[186:187], v[186:187], v[86:87]
 v_pk_add_f32 v[188:189], v[188:189], v[92:93]
 v_pk_add_f32 v[190:191], v[190:191], v[94:95]
 v_cvt_pk_bf16_f32 v124, v184, v185
 v_cvt_pk_bf16_f32 v125, v186, v187
 v_cvt_pk_bf16_f32 v126, v188, v189
 v_cvt_pk_bf16_f32 v127, v190, v191
 v_mov_b32 v32, v124
 v_mov_b32 v33, v125
 v_mov_b32 v34, v126
 v_mov_b32 v35, v127
 v_mov_b32_dpp v124, v120 row_ror:8 row_mask:0xf bank_mask:0x3
 v_mov_b32_dpp v125, v121 row_ror:8 row_mask:0xf bank_mask:0x3
 v_mov_b32_dpp v126, v122 row_ror:8 row_mask:0xf bank_mask:0x3
 v_mov_b32_dpp v127, v123 row_ror:8 row_mask:0xf bank_mask:0x3
 v_mov_b32_dpp v120, v32 row_ror:8 row_mask:0xf bank_mask:0xc
 v_mov_b32_dpp v121, v33 row_ror:8 row_mask:0xf bank_mask:0xc
 v_mov_b32_dpp v122, v34 row_ror:8 row_mask:0xf bank_mask:0xc
 v_mov_b32_dpp v123, v35 row_ror:8 row_mask:0xf bank_mask:0xc
 s_mov_b32 s50, 32768
 s_mov_b32 s51, 49152
 buffer_store_dwordx4 v[120:123], v16, s[28:31], s50 offen sc1
 buffer_store_dwordx4 v[124:127], v16, s[28:31], s51 offen sc1
 s_endpgm
A_slow:
 s_waitcnt vmcnt(0) lgkmcnt(0)
 s_mov_b32 s24, s66
 s_mov_b32 s25, s67
 s_mov_b32 s26, 0x200000
 s_mov_b32 s27, 0x20000
 s_mov_b32 s28, s68
 s_mov_b32 s29, s69
 s_mov_b32 s30, 0x200000
 s_mov_b32 s31, 0x20000
 s_lshr_b32 s50, s38, 3
 s_lshl_b32 s50, s50, 19
 s_add_u32 s50, s50, 393216
 v_bfe_u32 v36, v1, 4, 1
 v_lshlrev_b32 v36, 1, v36
 v_lshrrev_b32 v37, 5, v1
 v_or_b32 v36, v36, v37
 v_and_b32 v14, 15, v1
 v_lshlrev_b32 v14, 8, v14
 v_lshl_add_u32 v14, v36, 4, v14
 v_add_u32 v15, 0x1000, v14
 v_lshrrev_b32 v36, 4, v1
 v_and_b32 v37, 15, v1
 v_lshlrev_b32 v38, 1, v36
 v_xor_b32 v37, v37, v38
 v_lshlrev_b32 v36, 8, v36
 v_lshl_add_u32 v8, v37, 4, v36
 v_xor_b32 v9, 128, v8
 v_add_u32 v10, 0x1000, v8
 v_add_u32 v11, 0x1000, v9
 s_lshl_b32 s52, s36, 13
 s_add_u32 s52, s52, 0x10000
 v_lshrrev_b32 v36, 2, v1
 v_and_b32 v37, 7, v36
 v_lshlrev_b32 v36, 8, v36
 v_and_b32 v38, 3, v1
 v_lshl_add_u32 v36, v38, 3, v36
 v_add_u32 v36, s52, v36
 v_xor_b32 v38, 0, v37
 v_lshl_add_u32 v18, v38, 5, v36
 v_xor_b32 v38, 1, v37
 v_lshl_add_u32 v19, v38, 5, v36
 v_xor_b32 v38, 2, v37
 v_lshl_add_u32 v20, v38, 5, v36
 v_xor_b32 v38, 3, v37
 v_lshl_add_u32 v21, v38, 5, v36
 v_xor_b32 v38, 4, v37
 v_lshl_add_u32 v22, v38, 5, v36
 v_xor_b32 v38, 5, v37
 v_lshl_add_u32 v23, v38, 5, v36
 v_xor_b32 v38, 6, v37
 v_lshl_add_u32 v24, v38, 5, v36
 v_xor_b32 v38, 7, v37
 v_lshl_add_u32 v25, v38, 5, v36
 v_mov_b32 v32, 0xff800000
 v_mov_b32 v33, 0xff800000
 v_mov_b32 v34, 0xff800000
 v_mov_b32 v35, 0xff800000
 s_mov_b32 s51, s50
 s_mov_b32 s53, 16
Z1_loop:
 buffer_load_dwordx4 a[192:195], v14, s[24:27], s51 offen
 buffer_load_dwordx4 a[196:199], v14, s[24:27], s51 offen offset:64
 buffer_load_dwordx4 a[200:203], v14, s[24:27], s51 offen offset:128
 buffer_load_dwordx4 a[204:207], v14, s[24:27], s51 offen offset:192
 buffer_load_dwordx4 a[208:211], v15, s[24:27], s51 offen
 buffer_load_dwordx4 a[212:215], v15, s[24:27], s51 offen offset:64
 buffer_load_dwordx4 a[216:219], v15, s[24:27], s51 offen offset:128
 buffer_load_dwordx4 a[220:223], v15, s[24:27], s51 offen offset:192
 s_waitcnt vmcnt(7)
 v_mfma_f32_16x16x32_bf16 v[128:131], a[192:195], v[64:67], 0
 s_waitcnt vmcnt(6)
 v_mfma_f32_16x16x32_bf16 v[128:131], a[196:199], v[80:83], v[128:131]
 v_mfma_f32_16x16x32_bf16 v[136:139], a[196:199], v[84:87], 0
 v_mfma_f32_16x16x32_bf16 v[136:139], a[192:195], v[68:71], v[136:139]
 v_mfma_f32_16x16x32_bf16 v[144:147], a[192:195], v[72:75], 0
 v_mfma_f32_16x16x32_bf16 v[144:147], a[196:199], v[88:91], v[144:147]
 v_mfma_f32_16x16x32_bf16 v[152:155], a[196:199], v[92:95], 0
 v_mfma_f32_16x16x32_bf16 v[152:155], a[192:195], v[76:79], v[152:155]
 s_waitcnt vmcnt(5)
 v_mfma_f32_16x16x32_bf16 v[152:155], a[200:203], v[108:111], v[152:155]
 s_waitcnt vmcnt(4)
 v_mfma_f32_16x16x32_bf16 v[152:155], a[204:207], v[124:127], v[152:155]
 v_mfma_f32_16x16x32_bf16 v[144:147], a[204:207], v[120:123], v[144:147]
 v_mfma_f32_16x16x32_bf16 v[144:147], a[200:203], v[104:107], v[144:147]
 v_mfma_f32_16x16x32_bf16 v[136:139], a[200:203], v[100:103], v[136:139]
 v_mfma_f32_16x16x32_bf16 v[136:139], a[204:207], v[116:119], v[136:139]
 v_mfma_f32_16x16x32_bf16 v[128:131], a[204:207], v[112:115], v[128:131]
 v_mfma_f32_16x16x32_bf16 v[128:131], a[200:203], v[96:99], v[128:131]
 s_waitcnt vmcnt(3)
 v_mfma_f32_16x16x32_bf16 v[132:135], a[208:211], v[64:67], 0
 s_waitcnt vmcnt(2)
 v_mfma_f32_16x16x32_bf16 v[132:135], a[212:215], v[80:83], v[132:135]
 v_mfma_f32_16x16x32_bf16 v[140:143], a[212:215], v[84:87], 0
 v_mfma_f32_16x16x32_bf16 v[140:143], a[208:211], v[68:71], v[140:143]
 v_mfma_f32_16x16x32_bf16 v[148:151], a[208:211], v[72:75], 0
 v_mfma_f32_16x16x32_bf16 v[148:151], a[212:215], v[88:91], v[148:151]
 v_mfma_f32_16x16x32_bf16 v[156:159], a[212:215], v[92:95], 0
 v_mfma_f32_16x16x32_bf16 v[156:159], a[208:211], v[76:79], v[156:159]
 s_waitcnt vmcnt(1)
 v_mfma_f32_16x16x32_bf16 v[156:159], a[216:219], v[108:111], v[156:159]
 s_waitcnt vmcnt(0)
 v_mfma_f32_16x16x32_bf16 v[156:159], a[220:223], v[124:127], v[156:159]
 v_mfma_f32_16x16x32_bf16 v[148:151], a[220:223], v[120:123], v[148:151]
 v_mfma_f32_16x16x32_bf16 v[148:151], a[216:219], v[104:107], v[148:151]
 v_mfma_f32_16x16x32_bf16 v[140:143], a[216:219], v[100:103], v[140:143]
 v_mfma_f32_16x16x32_bf16 v[140:143], a[220:223], v[116:119], v[140:143]
 v_mfma_f32_16x16x32_bf16 v[132:135], a[220:223], v[112:115], v[132:135]
 v_mfma_f32_16x16x32_bf16 v[132:135], a[216:219], v[96:99], v[132:135]
 s_nop 7
 v_max3_f32 v32, v32, v129, v130
 v_max_f32 v32, v32, v128
 v_max3_f32 v32, v32, v131, v132
 v_max3_f32 v32, v32, v133, v134
 v_max_f32 v32, v32, v135
 v_max3_f32 v33, v33, v137, v138
 v_max_f32 v33, v33, v136
 v_max3_f32 v33, v33, v139, v140
 v_max3_f32 v33, v33, v141, v142
 v_max_f32 v33, v33, v143
 v_max3_f32 v34, v34, v145, v146
 v_max_f32 v34, v34, v144
 v_max3_f32 v34, v34, v147, v148
 v_max3_f32 v34, v34, v149, v150
 v_max_f32 v34, v34, v151
 v_max3_f32 v35, v35, v153, v154
 v_max_f32 v35, v35, v152
 v_max3_f32 v35, v35, v155, v156
 v_max3_f32 v35, v35, v157, v158
 v_max_f32 v35, v35, v159
 s_add_u32 s51, s51, 8192
 s_sub_u32 s53, s53, 1
 s_cmp_lg_u32 s53, 0
 s_cbranch_scc1 Z1_loop
 v_mov_b32 v36, v32
 v_mov_b32 v37, v33
 v_mov_b32 v38, v34
 v_mov_b32 v39, v35
 s_nop 0
 v_permlane16_swap_b32 v32, v36
 v_permlane16_swap_b32 v33, v37
 v_permlane16_swap_b32 v34, v38
 v_permlane16_swap_b32 v35, v39
 s_nop 0
 v_max_f32 v32, v32, v36
 v_max_f32 v33, v33, v37
 v_max_f32 v34, v34, v38
 v_max_f32 v35, v35, v39
 v_mov_b32 v36, v32
 v_mov_b32 v37, v33
 v_mov_b32 v38, v34
 v_mov_b32 v39, v35
 s_nop 0
 v_permlane32_swap_b32 v32, v36
 v_permlane32_swap_b32 v33, v37
 v_permlane32_swap_b32 v34, v38
 v_permlane32_swap_b32 v35, v39
 s_nop 0
 v_max_f32 v32, v32, v36
 v_max_f32 v33, v33, v37
 v_max_f32 v34, v34, v38
 v_max_f32 v35, v35, v39
 v_sub_f32 v224, 0, v32
 v_sub_f32 v225, 0, v32
 v_pk_mul_f32 v[226:227], v[224:225], 1.0 op_sel_hi:[1,0]
 v_sub_f32 v228, 0, v33
 v_sub_f32 v229, 0, v33
 v_pk_mul_f32 v[230:231], v[228:229], 1.0 op_sel_hi:[1,0]
 v_sub_f32 v232, 0, v34
 v_sub_f32 v233, 0, v34
 v_pk_mul_f32 v[234:235], v[232:233], 1.0 op_sel_hi:[1,0]
 v_sub_f32 v236, 0, v35
 v_sub_f32 v237, 0, v35
 v_pk_mul_f32 v[238:239], v[236:237], 1.0 op_sel_hi:[1,0]
 v_accvgpr_write_b32 a0, 0
 v_accvgpr_write_b32 a1, 0
 v_accvgpr_write_b32 a2, 0
 v_accvgpr_write_b32 a3, 0
 v_accvgpr_write_b32 a4, 0
 v_accvgpr_write_b32 a5, 0
 v_accvgpr_write_b32 a6, 0
 v_accvgpr_write_b32 a7, 0
 v_accvgpr_write_b32 a8, 0
 v_accvgpr_write_b32 a9, 0
 v_accvgpr_write_b32 a10, 0
 v_accvgpr_write_b32 a11, 0
 v_accvgpr_write_b32 a12, 0
 v_accvgpr_write_b32 a13, 0
 v_accvgpr_write_b32 a14, 0
 v_accvgpr_write_b32 a15, 0
 v_accvgpr_write_b32 a16, 0
 v_accvgpr_write_b32 a17, 0
 v_accvgpr_write_b32 a18, 0
 v_accvgpr_write_b32 a19, 0
 v_accvgpr_write_b32 a20, 0
 v_accvgpr_write_b32 a21, 0
 v_accvgpr_write_b32 a22, 0
 v_accvgpr_write_b32 a23, 0
 v_accvgpr_write_b32 a24, 0
 v_accvgpr_write_b32 a25, 0
 v_accvgpr_write_b32 a26, 0
 v_accvgpr_write_b32 a27, 0
 v_accvgpr_write_b32 a28, 0
 v_accvgpr_write_b32 a29, 0
 v_accvgpr_write_b32 a30, 0
 v_accvgpr_write_b32 a31, 0
 v_accvgpr_write_b32 a32, 0
 v_accvgpr_write_b32 a33, 0
 v_accvgpr_write_b32 a34, 0
 v_accvgpr_write_b32 a35, 0
 v_accvgpr_write_b32 a36, 0
 v_accvgpr_write_b32 a37, 0
 v_accvgpr_write_b32 a38, 0
 v_accvgpr_write_b32 a39, 0
 v_accvgpr_write_b32 a40, 0
 v_accvgpr_write_b32 a41, 0
 v_accvgpr_write_b32 a42, 0
 v_accvgpr_write_b32 a43, 0
 v_accvgpr_write_b32 a44, 0
 v_accvgpr_write_b32 a45, 0
 v_accvgpr_write_b32 a46, 0
 v_accvgpr_write_b32 a47, 0
 v_accvgpr_write_b32 a48, 0
 v_accvgpr_write_b32 a49, 0
 v_accvgpr_write_b32 a50, 0
 v_accvgpr_write_b32 a51, 0
 v_accvgpr_write_b32 a52, 0
 v_accvgpr_write_b32 a53, 0
 v_accvgpr_write_b32 a54, 0
 v_accvgpr_write_b32 a55, 0
 v_accvgpr_write_b32 a56, 0
 v_accvgpr_write_b32 a57, 0
 v_accvgpr_write_b32 a58, 0
 v_accvgpr_write_b32 a59, 0
 v_accvgpr_write_b32 a60, 0
 v_accvgpr_write_b32 a61, 0
 v_accvgpr_write_b32 a62, 0
 v_accvgpr_write_b32 a63, 0
 v_accvgpr_write_b32 a64, 0
 v_accvgpr_write_b32 a65, 0
 v_accvgpr_write_b32 a66, 0
 v_accvgpr_write_b32 a67, 0
 v_accvgpr_write_b32 a68, 0
 v_accvgpr_write_b32 a69, 0
 v_accvgpr_write_b32 a70, 0
 v_accvgpr_write_b32 a71, 0
 v_accvgpr_write_b32 a72, 0
 v_accvgpr_write_b32 a73, 0
 v_accvgpr_write_b32 a74, 0
 v_accvgpr_write_b32 a75, 0
 v_accvgpr_write_b32 a76, 0
 v_accvgpr_write_b32 a77, 0
 v_accvgpr_write_b32 a78, 0
 v_accvgpr_write_b32 a79, 0
 v_accvgpr_write_b32 a80, 0
 v_accvgpr_write_b32 a81, 0
 v_accvgpr_write_b32 a82, 0
 v_accvgpr_write_b32 a83, 0
 v_accvgpr_write_b32 a84, 0
 v_accvgpr_write_b32 a85, 0
 v_accvgpr_write_b32 a86, 0
 v_accvgpr_write_b32 a87, 0
 v_accvgpr_write_b32 a88, 0
 v_accvgpr_write_b32 a89, 0
 v_accvgpr_write_b32 a90, 0
 v_accvgpr_write_b32 a91, 0
 v_accvgpr_write_b32 a92, 0
 v_accvgpr_write_b32 a93, 0
 v_accvgpr_write_b32 a94, 0
 v_accvgpr_write_b32 a95, 0
 v_accvgpr_write_b32 a96, 0
 v_accvgpr_write_b32 a97, 0
 v_accvgpr_write_b32 a98, 0
 v_accvgpr_write_b32 a99, 0
 v_accvgpr_write_b32 a100, 0
 v_accvgpr_write_b32 a101, 0
 v_accvgpr_write_b32 a102, 0
 v_accvgpr_write_b32 a103, 0
 v_accvgpr_write_b32 a104, 0
 v_accvgpr_write_b32 a105, 0
 v_accvgpr_write_b32 a106, 0
 v_accvgpr_write_b32 a107, 0
 v_accvgpr_write_b32 a108, 0
 v_accvgpr_write_b32 a109, 0
 v_accvgpr_write_b32 a110, 0
 v_accvgpr_write_b32 a111, 0
 v_accvgpr_write_b32 a112, 0
 v_accvgpr_write_b32 a113, 0
 v_accvgpr_write_b32 a114, 0
 v_accvgpr_write_b32 a115, 0
 v_accvgpr_write_b32 a116, 0
 v_accvgpr_write_b32 a117, 0
 v_accvgpr_write_b32 a118, 0
 v_accvgpr_write_b32 a119, 0
 v_accvgpr_write_b32 a120, 0
 v_accvgpr_write_b32 a121, 0
 v_accvgpr_write_b32 a122, 0
 v_accvgpr_write_b32 a123, 0
 v_accvgpr_write_b32 a124, 0
 v_accvgpr_write_b32 a125, 0
 v_accvgpr_write_b32 a126, 0
 v_accvgpr_write_b32 a127, 0
 v_mov_b32 v28, 0
 v_mov_b32 v29, 0
 v_mov_b32 v30, 0
 v_mov_b32 v31, 0
 s_mov_b32 s51, s50
 s_mov_b32 s53, 16
Z2_loop:
 buffer_load_dwordx4 a[192:195], v14, s[24:27], s51 offen
 buffer_load_dwordx4 a[196:199], v14, s[24:27], s51 offen offset:64
 buffer_load_dwordx4 a[200:203], v14, s[24:27], s51 offen offset:128
 buffer_load_dwordx4 a[204:207], v14, s[24:27], s51 offen offset:192
 buffer_load_dwordx4 a[208:211], v15, s[24:27], s51 offen
 buffer_load_dwordx4 a[212:215], v15, s[24:27], s51 offen offset:64
 buffer_load_dwordx4 a[216:219], v15, s[24:27], s51 offen offset:128
 buffer_load_dwordx4 a[220:223], v15, s[24:27], s51 offen offset:192
 s_add_u32 m0, s52, 0
 s_nop 0
 buffer_load_dwordx4 v8, s[28:31], s51 offen lds
 buffer_load_dwordx4 v9, s[28:31], s51 offen offset:1024 lds
 buffer_load_dwordx4 v8, s[28:31], s51 offen offset:2048 lds
 buffer_load_dwordx4 v9, s[28:31], s51 offen offset:3072 lds
 s_add_u32 m0, s52, 4096
 s_nop 0
 buffer_load_dwordx4 v10, s[28:31], s51 offen lds
 buffer_load_dwordx4 v11, s[28:31], s51 offen offset:1024 lds
 buffer_load_dwordx4 v10, s[28:31], s51 offen offset:2048 lds
 buffer_load_dwordx4 v11, s[28:31], s51 offen offset:3072 lds
 s_waitcnt vmcnt(15)
 v_mfma_f32_16x16x32_bf16 v[128:131], a[192:195], v[64:67], v[224:227]
 s_waitcnt vmcnt(14)
 v_mfma_f32_16x16x32_bf16 v[128:131], a[196:199], v[80:83], v[128:131]
 v_mfma_f32_16x16x32_bf16 v[136:139], a[196:199], v[84:87], v[228:231]
 v_mfma_f32_16x16x32_bf16 v[136:139], a[192:195], v[68:71], v[136:139]
 v_mfma_f32_16x16x32_bf16 v[144:147], a[192:195], v[72:75], v[232:235]
 v_mfma_f32_16x16x32_bf16 v[144:147], a[196:199], v[88:91], v[144:147]
 v_mfma_f32_16x16x32_bf16 v[152:155], a[196:199], v[92:95], v[236:239]
 v_mfma_f32_16x16x32_bf16 v[152:155], a[192:195], v[76:79], v[152:155]
 s_waitcnt vmcnt(13)
 v_mfma_f32_16x16x32_bf16 v[152:155], a[200:203], v[108:111], v[152:155]
 s_waitcnt vmcnt(12)
 v_mfma_f32_16x16x32_bf16 v[152:155], a[204:207], v[124:127], v[152:155]
 v_mfma_f32_16x16x32_bf16 v[144:147], a[204:207], v[120:123], v[144:147]
 v_mfma_f32_16x16x32_bf16 v[144:147], a[200:203], v[104:107], v[144:147]
 v_mfma_f32_16x16x32_bf16 v[136:139], a[200:203], v[100:103], v[136:139]
 v_mfma_f32_16x16x32_bf16 v[136:139], a[204:207], v[116:119], v[136:139]
 v_mfma_f32_16x16x32_bf16 v[128:131], a[204:207], v[112:115], v[128:131]
 v_mfma_f32_16x16x32_bf16 v[128:131], a[200:203], v[96:99], v[128:131]
 s_waitcnt vmcnt(11)
 v_mfma_f32_16x16x32_bf16 v[132:135], a[208:211], v[64:67], v[224:227]
 s_waitcnt vmcnt(10)
 v_mfma_f32_16x16x32_bf16 v[132:135], a[212:215], v[80:83], v[132:135]
 v_mfma_f32_16x16x32_bf16 v[140:143], a[212:215], v[84:87], v[228:231]
 v_mfma_f32_16x16x32_bf16 v[140:143], a[208:211], v[68:71], v[140:143]
 v_mfma_f32_16x16x32_bf16 v[148:151], a[208:211], v[72:75], v[232:235]
 v_mfma_f32_16x16x32_bf16 v[148:151], a[212:215], v[88:91], v[148:151]
 v_mfma_f32_16x16x32_bf16 v[156:159], a[212:215], v[92:95], v[236:239]
 v_mfma_f32_16x16x32_bf16 v[156:159], a[208:211], v[76:79], v[156:159]
 s_waitcnt vmcnt(9)
 v_mfma_f32_16x16x32_bf16 v[156:159], a[216:219], v[108:111], v[156:159]
 s_waitcnt vmcnt(8)
 v_mfma_f32_16x16x32_bf16 v[156:159], a[220:223], v[124:127], v[156:159]
 v_mfma_f32_16x16x32_bf16 v[148:151], a[220:223], v[120:123], v[148:151]
 v_mfma_f32_16x16x32_bf16 v[148:151], a[216:219], v[104:107], v[148:151]
 v_mfma_f32_16x16x32_bf16 v[140:143], a[216:219], v[100:103], v[140:143]
 v_mfma_f32_16x16x32_bf16 v[140:143], a[220:223], v[116:119], v[140:143]
 v_mfma_f32_16x16x32_bf16 v[132:135], a[220:223], v[112:115], v[132:135]
 v_mfma_f32_16x16x32_bf16 v[132:135], a[216:219], v[96:99], v[132:135]
 s_nop 7
 v_exp_f32 v128, v128
 v_exp_f32 v129, v129
 v_exp_f32 v130, v130
 v_exp_f32 v131, v131
 v_exp_f32 v132, v132
 v_exp_f32 v133, v133
 v_exp_f32 v134, v134
 v_exp_f32 v135, v135
 v_exp_f32 v136, v136
 v_exp_f32 v137, v137
 v_exp_f32 v138, v138
 v_exp_f32 v139, v139
 v_exp_f32 v140, v140
 v_exp_f32 v141, v141
 v_exp_f32 v142, v142
 v_exp_f32 v143, v143
 v_exp_f32 v144, v144
 v_exp_f32 v145, v145
 v_exp_f32 v146, v146
 v_exp_f32 v147, v147
 v_exp_f32 v148, v148
 v_exp_f32 v149, v149
 v_exp_f32 v150, v150
 v_exp_f32 v151, v151
 v_exp_f32 v152, v152
 v_exp_f32 v153, v153
 v_exp_f32 v154, v154
 v_exp_f32 v155, v155
 v_exp_f32 v156, v156
 v_exp_f32 v157, v157
 v_exp_f32 v158, v158
 v_exp_f32 v159, v159
 v_add_f32 v28, v28, v128
 v_add_f32 v28, v28, v129
 v_add_f32 v28, v28, v130
 v_add_f32 v28, v28, v131
 v_add_f32 v28, v28, v132
 v_add_f32 v28, v28, v133
 v_add_f32 v28, v28, v134
 v_add_f32 v28, v28, v135
 v_add_f32 v29, v29, v136
 v_add_f32 v29, v29, v137
 v_add_f32 v29, v29, v138
 v_add_f32 v29, v29, v139
 v_add_f32 v29, v29, v140
 v_add_f32 v29, v29, v141
 v_add_f32 v29, v29, v142
 v_add_f32 v29, v29, v143
 v_add_f32 v30, v30, v144
 v_add_f32 v30, v30, v145
 v_add_f32 v30, v30, v146
 v_add_f32 v30, v30, v147
 v_add_f32 v30, v30, v148
 v_add_f32 v30, v30, v149
 v_add_f32 v30, v30, v150
 v_add_f32 v30, v30, v151
 v_add_f32 v31, v31, v152
 v_add_f32 v31, v31, v153
 v_add_f32 v31, v31, v154
 v_add_f32 v31, v31, v155
 v_add_f32 v31, v31, v156
 v_add_f32 v31, v31, v157
 v_add_f32 v31, v31, v158
 v_add_f32 v31, v31, v159
 v_cvt_pk_bf16_f32 v192, v128, v129
 v_cvt_pk_bf16_f32 v193, v130, v131
 v_cvt_pk_bf16_f32 v194, v132, v133
 v_cvt_pk_bf16_f32 v195, v134, v135
 v_cvt_pk_bf16_f32 v196, v136, v137
 v_cvt_pk_bf16_f32 v197, v138, v139
 v_cvt_pk_bf16_f32 v198, v140, v141
 v_cvt_pk_bf16_f32 v199, v142, v143
 v_cvt_pk_bf16_f32 v200, v144, v145
 v_cvt_pk_bf16_f32 v201, v146, v147
 v_cvt_pk_bf16_f32 v202, v148, v149
 v_cvt_pk_bf16_f32 v203, v150, v151
 v_cvt_pk_bf16_f32 v204, v152, v153
 v_cvt_pk_bf16_f32 v205, v154, v155
 v_cvt_pk_bf16_f32 v206, v156, v157
 v_cvt_pk_bf16_f32 v207, v158, v159
 s_waitcnt vmcnt(0)
 ds_read_b64_tr_b16 a[224:225], v18
 ds_read_b64_tr_b16 a[226:227], v18 offset:4096
 ds_read_b64_tr_b16 a[228:229], v19
 ds_read_b64_tr_b16 a[230:231], v19 offset:4096
 ds_read_b64_tr_b16 a[232:233], v20
 ds_read_b64_tr_b16 a[234:235], v20 offset:4096
 ds_read_b64_tr_b16 a[236:237], v21
 ds_read_b64_tr_b16 a[238:239], v21 offset:4096
 ds_read_b64_tr_b16 a[240:241], v22
 ds_read_b64_tr_b16 a[242:243], v22 offset:4096
 ds_read_b64_tr_b16 a[244:245], v23
 ds_read_b64_tr_b16 a[246:247], v23 offset:4096
 ds_read_b64_tr_b16 a[248:249], v24
 ds_read_b64_tr_b16 a[250:251], v24 offset:4096
 ds_read_b64_tr_b16 a[252:253], v25
 ds_read_b64_tr_b16 a[254:255], v25 offset:4096
 s_waitcnt lgkmcnt(14)
 v_mfma_f32_16x16x32_bf16 a[0:3], a[224:227], v[192:195], a[0:3]
 v_mfma_f32_16x16x32_bf16 a[4:7], a[224:227], v[196:199], a[4:7]
 v_mfma_f32_16x16x32_bf16 a[8:11], a[224:227], v[200:203], a[8:11]
 v_mfma_f32_16x16x32_bf16 a[12:15], a[224:227], v[204:207], a[12:15]
 s_waitcnt lgkmcnt(12)
 v_mfma_f32_16x16x32_bf16 a[28:31], a[228:231], v[204:207], a[28:31]
 v_mfma_f32_16x16x32_bf16 a[24:27], a[228:231], v[200:203], a[24:27]
 v_mfma_f32_16x16x32_bf16 a[20:23], a[228:231], v[196:199], a[20:23]
 v_mfma_f32_16x16x32_bf16 a[16:19], a[228:231], v[192:195], a[16:19]
 s_waitcnt lgkmcnt(10)
 v_mfma_f32_16x16x32_bf16 a[32:35], a[232:235], v[192:195], a[32:35]
 v_mfma_f32_16x16x32_bf16 a[36:39], a[232:235], v[196:199], a[36:39]
 v_mfma_f32_16x16x32_bf16 a[40:43], a[232:235], v[200:203], a[40:43]
 v_mfma_f32_16x16x32_bf16 a[44:47], a[232:235], v[204:207], a[44:47]
 s_waitcnt lgkmcnt(8)
 v_mfma_f32_16x16x32_bf16 a[60:63], a[236:239], v[204:207], a[60:63]
 v_mfma_f32_16x16x32_bf16 a[56:59], a[236:239], v[200:203], a[56:59]
 v_mfma_f32_16x16x32_bf16 a[52:55], a[236:239], v[196:199], a[52:55]
 v_mfma_f32_16x16x32_bf16 a[48:51], a[236:239], v[192:195], a[48:51]
 s_waitcnt lgkmcnt(6)
 v_mfma_f32_16x16x32_bf16 a[64:67], a[240:243], v[192:195], a[64:67]
 v_mfma_f32_16x16x32_bf16 a[68:71], a[240:243], v[196:199], a[68:71]
 v_mfma_f32_16x16x32_bf16 a[72:75], a[240:243], v[200:203], a[72:75]
 v_mfma_f32_16x16x32_bf16 a[76:79], a[240:243], v[204:207], a[76:79]
 s_waitcnt lgkmcnt(4)
 v_mfma_f32_16x16x32_bf16 a[92:95], a[244:247], v[204:207], a[92:95]
 v_mfma_f32_16x16x32_bf16 a[88:91], a[244:247], v[200:203], a[88:91]
 v_mfma_f32_16x16x32_bf16 a[84:87], a[244:247], v[196:199], a[84:87]
 v_mfma_f32_16x16x32_bf16 a[80:83], a[244:247], v[192:195], a[80:83]
 s_waitcnt lgkmcnt(2)
 v_mfma_f32_16x16x32_bf16 a[96:99], a[248:251], v[192:195], a[96:99]
 v_mfma_f32_16x16x32_bf16 a[100:103], a[248:251], v[196:199], a[100:103]
 v_mfma_f32_16x16x32_bf16 a[104:107], a[248:251], v[200:203], a[104:107]
 v_mfma_f32_16x16x32_bf16 a[108:111], a[248:251], v[204:207], a[108:111]
 s_waitcnt lgkmcnt(0)
 v_mfma_f32_16x16x32_bf16 a[124:127], a[252:255], v[204:207], a[124:127]
 v_mfma_f32_16x16x32_bf16 a[120:123], a[252:255], v[200:203], a[120:123]
 v_mfma_f32_16x16x32_bf16 a[116:119], a[252:255], v[196:199], a[116:119]
 v_mfma_f32_16x16x32_bf16 a[112:115], a[252:255], v[192:195], a[112:115]
 s_add_u32 s51, s51, 8192
 s_sub_u32 s53, s53, 1
 s_cmp_lg_u32 s53, 0
 s_cbranch_scc1 Z2_loop
 s_nop 7
 v_mov_b32 v36, v28
 v_mov_b32 v37, v29
 v_mov_b32 v38, v30
 v_mov_b32 v39, v31
 s_nop 1
 v_permlane16_swap_b32 v28, v36
 v_permlane16_swap_b32 v29, v37
 v_permlane16_swap_b32 v30, v38
 v_permlane16_swap_b32 v31, v39
 s_nop 1
 v_add_f32 v28, v28, v36
 v_add_f32 v29, v29, v37
 v_add_f32 v30, v30, v38
 v_add_f32 v31, v31, v39
 v_mov_b32 v36, v28
 v_mov_b32 v37, v29
 v_mov_b32 v38, v30
 v_mov_b32 v39, v31
 s_nop 1
 v_permlane32_swap_b32 v28, v36
 v_permlane32_swap_b32 v29, v37
 v_permlane32_swap_b32 v30, v38
 v_permlane32_swap_b32 v31, v39
 s_nop 1
 v_add_f32 v28, v28, v36
 v_add_f32 v29, v29, v37
 v_add_f32 v30, v30, v38
 v_add_f32 v31, v31, v39
 s_branch A_done
K_last:
.section .rodata,"a"
.p2align 6
.amdhsa_kernel recurrent_scan__sliding_block_cached__geglu_ffn__prompt_kernel
  .amdhsa_next_free_vgpr 512
  .amdhsa_next_free_sgpr 102
  .amdhsa_accum_offset 256
  .amdhsa_group_segment_fixed_size 0
  .amdhsa_kernarg_size 96
  .amdhsa_user_sgpr_count 2
  .amdhsa_user_sgpr_kernarg_segment_ptr 1
  .amdhsa_system_sgpr_workgroup_id_x 1
  .amdhsa_float_denorm_mode_32 3
.end_amdhsa_kernel
```
